```python
import torch

def _softmax(x, axis=-1):
    return torch.softmax(x, dim=axis)
def _gelu(x):
    return torch.nn.functional.gelu(x, approximate="tanh")
def _silu(x):
    return torch.nn.functional.silu(x)
def _sigmoid(x):
    return torch.sigmoid(x)
def _layernorm(x, axis=-1, eps=1e-5):
    m = x.mean(dim=axis, keepdim=True)
    v = x.var(dim=axis, keepdim=True, unbiased=False)
    return (x - m) / torch.sqrt(v + eps)
def _scatter_add(tgt, idx, src, axis=0):
    return tgt.clone().index_add_(axis, idx, src)
def _segment_sum(src, seg, n):
    out = torch.zeros((n,) + src.shape[1:], dtype=src.dtype)
    return out.index_add_(0, seg, src)
def _pad(x, pw):
    flat = tuple(v for pair in reversed(pw) for v in pair)
    return torch.nn.functional.pad(x, flat)

kernel_name = 'standalone__kv_cache_quant_int4_int2_kv_with_per_channel_or_per_token_scales__sampling'

def setup_inputs():

    _w = (lambda a: (lambda t: t.to(torch.bfloat16) if t.is_floating_point() else t)(torch.as_tensor(a)))
    B = 8
    Sq = 4
    Skv = 4096
    Hq = 32
    Hkv = 32
    Dh = 192
    bits = 2
    G = 64
    if G <= 0 or G >= Skv:
        G = max(1, Skv // 2)
    Skv = (Skv // G) * G
    ngk = Skv // G
    qmax = (1 << bits) - 1
    return {
        "q": _w((lambda *s: torch.randn(*s, dtype=torch.bfloat16) * 3.2)(B, Hq, Sq, Dh)),
        "qk": _w(torch.randint(0, qmax + 1, (B, Hkv, Skv, Dh)).to(torch.int32)),
        "qv": _w(torch.randint(0, qmax + 1, (B, Hkv, Skv, Dh)).to(torch.int32)),
        "k_scales": _w(torch.abs((lambda *s: torch.randn(*s, dtype=torch.bfloat16) * 3.2)(B, Hkv, ngk, Dh)) * 0.05 + 0.02),
        "k_zeros": _w((lambda *s: torch.randn(*s, dtype=torch.bfloat16) * 3.2)(B, Hkv, ngk, Dh) + float(qmax) / 2.0),
        "v_scales": _w(torch.abs((lambda *s: torch.randn(*s, dtype=torch.bfloat16) * 0.05)(B, Hkv, Skv, 1)) * 0.05 + 0.02),
        "v_zeros": _w((lambda *s: torch.randn(*s, dtype=torch.bfloat16) * 0.05)(B, Hkv, Skv, 1) + float(qmax) / 2.0),
    }

def reference(q, qk, qv, k_scales, k_zeros, v_scales, v_zeros):
    B, Hq, Sq, Dh = q.shape
    Hkv, Skv = qk.shape[1], qk.shape[2]
    ngk = k_scales.shape[2]
    G = Skv // ngk
    ks = (lambda x, n, axis: torch.repeat_interleave(x, n, dim=axis))(k_scales, G, axis=2)
    kz = (lambda x, n, axis: torch.repeat_interleave(x, n, dim=axis))(k_zeros, G, axis=2)
    k = ((lambda x, dt: x.to(dt))(qk, q.dtype) - kz) * ks
    v = ((lambda x, dt: x.to(dt))(qv, q.dtype) - v_zeros) * v_scales
    rep = Hq // Hkv
    if rep > 1:
        k = (lambda x, n, axis: torch.repeat_interleave(x, n, dim=axis))(k, rep, axis=1)
        v = (lambda x, n, axis: torch.repeat_interleave(x, n, dim=axis))(v, rep, axis=1)
    scale = float(Dh) ** -0.5
    logits = torch.einsum("bhqd,bhkd->bhqk", q, k) * scale
    p = _softmax(logits, axis=-1)
    o = torch.einsum("bhqk,bhkd->bhqd", p, v)
    return o
```

```asm
; @launch grid=(256,1,1) block=(256,1,1) lds=87040
.amdgcn_target "amdgcn-amd-amdhsa--gfx950"
.text
.globl standalone__kv_cache_quant_int4_int2_kv_with_per_channel_or_per_token_scales__sampling_kernel
.p2align 8
.type standalone__kv_cache_quant_int4_int2_kv_with_per_channel_or_per_token_scales__sampling_kernel,@function
standalone__kv_cache_quant_int4_int2_kv_with_per_channel_or_per_token_scales__sampling_kernel:
  s_cmp_ge_u32 s2, 256
  s_cbranch_scc1 L_end
  s_load_dwordx16 s[44:59], s[0:1], 0
  v_lshrrev_b32 v1, 6, v0
  v_and_b32 v0, 63, v0
  v_readfirstlane_b32 s3, v1
  v_and_b32 v56, 3, v0
  v_bfe_u32 v57, v0, 2, 2
  v_lshrrev_b32 v58, 4, v0
  v_and_b32 v59, 15, v0
  v_lshlrev_b32 v88, 4, v56
  v_lshl_add_u32 v88, v58, 6, v88
  v_lshrrev_b32 v52, 1, v88
  v_mul_u32_u24 v89, 768, v57
  v_add_u32 v36, v88, v89
  v_mul_u32_u24 v89, 768, v58
  v_lshl_add_u32 v44, v59, 4, v89
  v_add_u32 v37, 3072, v36
  v_add_u32 v45, 3072, v44
  v_add_u32 v38, 6144, v36
  v_add_u32 v46, 6144, v44
  v_add_u32 v39, 9216, v36
  v_add_u32 v47, 9216, v44
  v_add_u32 v40, 12288, v36
  v_add_u32 v48, 12288, v44
  v_add_u32 v41, 15360, v36
  v_add_u32 v49, 15360, v44
  v_add_u32 v42, 18432, v36
  v_add_u32 v50, 18432, v44
  v_add_u32 v43, 21504, v36
  v_add_u32 v51, 21504, v44
  v_and_b32 v89, 7, v0
  v_mul_u32_u24 v89, 8, v89
  v_mul_u32_u24 v53, 2, v58
  v_add_u32 v53, v53, v89
  v_mul_u32_u24 v89, 384, v57
  v_add_u32 v89, v89, v52
  v_lshlrev_b32 v55, 4, v58
  v_lshrrev_b32 v54, 2, v0
  v_lshlrev_b32 v54, 4, v54
  s_mul_i32 s70, s3, 8192
  v_add_u32 v54, s70, v54
  v_mov_b32 v62, 0
  v_mov_b32 v63, 0
  s_mov_b32 s65, 0xffff0000
  s_mov_b32 s66, 0x3fb8aa3b
  s_mov_b32 s68, 0x3d93cd3a
  s_mov_b32 s69, 0x3d93cd3a
  s_mov_b32 s72, 0x11111111
  s_mov_b32 s73, 0x11111111
  s_mov_b32 s74, 0x22222222
  s_mov_b32 s75, 0x22222222
  s_mov_b32 s76, 0x44444444
  s_mov_b32 s77, 0x44444444
  s_mov_b32 s78, 0x88888888
  s_mov_b32 s79, 0x88888888
  s_mul_i32 s60, s2, 3145728
  s_mul_i32 s70, s3, 24576
  s_add_u32 s60, s60, s70
  s_mov_b32 s67, s60
  s_lshl_b32 s62, s2, 6
  s_lshr_b32 s70, s3, 1
  s_add_u32 s62, s62, s70
  s_mul_i32 s62, s62, 384
  s_lshl_b32 s63, s2, 13
  s_lshl_b32 s70, s3, 6
  s_add_u32 s63, s63, s70
  s_mul_i32 s70, s2, 1536
  s_waitcnt lgkmcnt(0)
  s_mov_b32 s36, s44
  s_and_b32 s37, s45, 0xffff
  s_mov_b32 s38, 393216
  s_mov_b32 s39, 0x20000
  s_mov_b32 s8, s46
  s_and_b32 s9, s47, 0xffff
  s_mov_b32 s10, 805306368
  s_mov_b32 s11, 0x20000
  s_mov_b32 s16, s46
  s_and_b32 s17, s47, 0xffff
  s_mov_b32 s18, 805306368
  s_mov_b32 s19, 0x20000
  s_mov_b32 s12, s48
  s_and_b32 s13, s49, 0xffff
  s_mov_b32 s14, 805306368
  s_mov_b32 s15, 0x20000
  s_mov_b32 s20, s50
  s_and_b32 s21, s51, 0xffff
  s_mov_b32 s22, 6291456
  s_mov_b32 s23, 0x20000
  s_mov_b32 s24, s52
  s_and_b32 s25, s53, 0xffff
  s_mov_b32 s26, 6291456
  s_mov_b32 s27, 0x20000
  s_mov_b32 s28, s54
  s_and_b32 s29, s55, 0xffff
  s_mov_b32 s30, 2097152
  s_mov_b32 s31, 0x20000
  s_mov_b32 s32, s56
  s_and_b32 s33, s57, 0xffff
  s_mov_b32 s34, 2097152
  s_mov_b32 s35, 0x20000
  s_mov_b32 s40, s58
  s_and_b32 s41, s59, 0xffff
  s_mov_b32 s42, 393216
  s_mov_b32 s43, 0x20000
  buffer_load_dwordx2 v[110:111], v52, s[20:23], s62 offen offset:0 nt
  buffer_load_dwordx2 v[116:117], v52, s[24:27], s62 offen offset:0 nt
  buffer_load_dwordx2 v[112:113], v52, s[20:23], s62 offen offset:128 nt
  buffer_load_dwordx2 v[118:119], v52, s[24:27], s62 offen offset:128 nt
  buffer_load_dwordx2 v[114:115], v52, s[20:23], s62 offen offset:256 nt
  buffer_load_dwordx2 v[120:121], v52, s[24:27], s62 offen offset:256 nt
  buffer_load_dwordx2 v[104:105], v89, s[36:39], s70 offen offset:0
  buffer_load_dwordx2 v[106:107], v89, s[36:39], s70 offen offset:128
  buffer_load_dwordx2 v[108:109], v89, s[36:39], s70 offen offset:256
  buffer_load_short_d16_hi v62, v53, s[32:35], s63 offen nt
  buffer_load_short_d16_hi v63, v53, s[28:31], s63 offen nt
  buffer_load_dwordx4 v[4:7], v36, s[8:11], s60 offen offset:0 nt
  buffer_load_dwordx4 v[8:11], v36, s[8:11], s60 offen offset:256 nt
  buffer_load_dwordx4 v[12:15], v36, s[8:11], s60 offen offset:512 nt
  buffer_load_dwordx4 v[16:19], v37, s[8:11], s60 offen offset:0 nt
  buffer_load_dwordx4 v[20:23], v37, s[8:11], s60 offen offset:256 nt
  buffer_load_dwordx4 v[24:27], v37, s[8:11], s60 offen offset:512 nt
  buffer_load_dwordx4 v[28:31], v38, s[8:11], s60 offen offset:0 nt
  v_mov_b32 v72, 0
  v_mov_b32 v73, 0
  v_mov_b32 v74, 0
  v_mov_b32 v75, 0
  v_mov_b32 v76, 0
  v_mov_b32 v77, 0
  v_mov_b32 v78, 0
  v_mov_b32 v79, 0
  v_mov_b32 v80, 0
  v_mov_b32 v81, 0
  v_mov_b32 v82, 0
  v_mov_b32 v83, 0
  v_mov_b32 v84, 0xff800000
  v_mov_b32 v86, 0x7f800000
  v_mov_b32 v87, 0
  s_mov_b32 s64, 32
L_k:
  s_waitcnt vmcnt(6)
  buffer_load_dwordx4 v[32:35], v38, s[8:11], s60 offen offset:256 nt
  v_cvt_f32_i32 v56, v4
  v_cvt_f32_i32 v57, v5
  v_cvt_f32_i32 v58, v6
  v_cvt_f32_i32 v59, v7
  v_lshlrev_b32 v134, 16, v116
  v_and_b32 v135, s65, v116
  v_lshlrev_b32 v136, 16, v117
  v_and_b32 v137, s65, v117
  v_lshlrev_b32 v122, 16, v110
  v_and_b32 v123, s65, v110
  v_lshlrev_b32 v124, 16, v111
  v_and_b32 v125, s65, v111
  v_pk_add_f32 v[56:57], v[56:57], v[134:135] neg_lo:[0,1] neg_hi:[0,1]
  v_pk_add_f32 v[58:59], v[58:59], v[136:137] neg_lo:[0,1] neg_hi:[0,1]
  v_cvt_pk_bf16_f32 v60, v56, v57
  v_cvt_pk_bf16_f32 v61, v58, v59
  v_lshlrev_b32 v56, 16, v60
  v_and_b32 v57, s65, v60
  v_lshlrev_b32 v58, 16, v61
  v_and_b32 v59, s65, v61
  v_pk_mul_f32 v[56:57], v[56:57], v[122:123]
  v_pk_mul_f32 v[58:59], v[58:59], v[124:125]
  v_cvt_pk_bf16_f32 v148, v56, v57
  v_cvt_pk_bf16_f32 v149, v58, v59
  s_waitcnt vmcnt(6)
  buffer_load_dwordx4 v[4:7], v38, s[8:11], s60 offen offset:512 nt
  v_cvt_f32_i32 v56, v8
  v_cvt_f32_i32 v57, v9
  v_cvt_f32_i32 v58, v10
  v_cvt_f32_i32 v59, v11
  v_lshlrev_b32 v138, 16, v118
  v_and_b32 v139, s65, v118
  v_lshlrev_b32 v140, 16, v119
  v_and_b32 v141, s65, v119
  v_lshlrev_b32 v126, 16, v112
  v_and_b32 v127, s65, v112
  v_lshlrev_b32 v128, 16, v113
  v_and_b32 v129, s65, v113
  v_pk_add_f32 v[56:57], v[56:57], v[138:139] neg_lo:[0,1] neg_hi:[0,1]
  v_pk_add_f32 v[58:59], v[58:59], v[140:141] neg_lo:[0,1] neg_hi:[0,1]
  v_cvt_pk_bf16_f32 v60, v56, v57
  v_cvt_pk_bf16_f32 v61, v58, v59
  v_lshlrev_b32 v56, 16, v60
  v_and_b32 v57, s65, v60
  v_lshlrev_b32 v58, 16, v61
  v_and_b32 v59, s65, v61
  v_pk_mul_f32 v[56:57], v[56:57], v[126:127]
  v_pk_mul_f32 v[58:59], v[58:59], v[128:129]
  v_cvt_pk_bf16_f32 v150, v56, v57
  v_cvt_pk_bf16_f32 v151, v58, v59
  s_nop 1
  v_mfma_f32_16x16x32_bf16 v[156:159], v[148:151], v[104:107], 0
  s_waitcnt vmcnt(6)
  buffer_load_dwordx4 v[8:11], v39, s[8:11], s60 offen offset:0 nt
  v_cvt_f32_i32 v56, v12
  v_cvt_f32_i32 v57, v13
  v_cvt_f32_i32 v58, v14
  v_cvt_f32_i32 v59, v15
  v_lshlrev_b32 v142, 16, v120
  v_and_b32 v143, s65, v120
  v_lshlrev_b32 v144, 16, v121
  v_and_b32 v145, s65, v121
  v_lshlrev_b32 v130, 16, v114
  v_and_b32 v131, s65, v114
  v_lshlrev_b32 v132, 16, v115
  v_and_b32 v133, s65, v115
  v_pk_add_f32 v[56:57], v[56:57], v[142:143] neg_lo:[0,1] neg_hi:[0,1]
  v_pk_add_f32 v[58:59], v[58:59], v[144:145] neg_lo:[0,1] neg_hi:[0,1]
  v_cvt_pk_bf16_f32 v60, v56, v57
  v_cvt_pk_bf16_f32 v61, v58, v59
  v_lshlrev_b32 v56, 16, v60
  v_and_b32 v57, s65, v60
  v_lshlrev_b32 v58, 16, v61
  v_and_b32 v59, s65, v61
  v_pk_mul_f32 v[56:57], v[56:57], v[130:131]
  v_pk_mul_f32 v[58:59], v[58:59], v[132:133]
  v_cvt_pk_bf16_f32 v152, v56, v57
  v_cvt_pk_bf16_f32 v153, v58, v59
  s_nop 1
  v_mfma_f32_16x16x16_bf16 v[156:159], v[152:153], v[108:109], v[156:159]
  s_waitcnt vmcnt(6)
  buffer_load_dwordx4 v[12:15], v39, s[8:11], s60 offen offset:256 nt
  v_cvt_f32_i32 v56, v16
  v_cvt_f32_i32 v57, v17
  v_cvt_f32_i32 v58, v18
  v_cvt_f32_i32 v59, v19
  s_add_u32 s62, s62, 768
  buffer_load_dwordx2 v[110:111], v52, s[20:23], s62 offen offset:0 nt
  buffer_load_dwordx2 v[116:117], v52, s[24:27], s62 offen offset:0 nt
  buffer_load_dwordx2 v[112:113], v52, s[20:23], s62 offen offset:128 nt
  buffer_load_dwordx2 v[118:119], v52, s[24:27], s62 offen offset:128 nt
  buffer_load_dwordx2 v[114:115], v52, s[20:23], s62 offen offset:256 nt
  buffer_load_dwordx2 v[120:121], v52, s[24:27], s62 offen offset:256 nt
  v_pk_add_f32 v[56:57], v[56:57], v[134:135] neg_lo:[0,1] neg_hi:[0,1]
  v_pk_add_f32 v[58:59], v[58:59], v[136:137] neg_lo:[0,1] neg_hi:[0,1]
  v_cvt_pk_bf16_f32 v60, v56, v57
  v_cvt_pk_bf16_f32 v61, v58, v59
  v_mov_b32_dpp v88, v156 quad_perm:[0,0,0,0] row_mask:0xf bank_mask:0xf
  v_lshlrev_b32 v56, 16, v60
  v_and_b32 v57, s65, v60
  v_mov_b32_dpp v89, v158 quad_perm:[2,2,2,2] row_mask:0xf bank_mask:0xf
  v_lshlrev_b32 v58, 16, v61
  v_and_b32 v59, s65, v61
  v_add_f32_dpp v88, v157, v88 quad_perm:[1,1,1,1] row_mask:0xf bank_mask:0xf
  v_pk_mul_f32 v[56:57], v[56:57], v[122:123]
  v_pk_mul_f32 v[58:59], v[58:59], v[124:125]
  v_add_f32_dpp v89, v159, v89 quad_perm:[3,3,3,3] row_mask:0xf bank_mask:0xf
  v_cvt_pk_bf16_f32 v148, v56, v57
  v_cvt_pk_bf16_f32 v149, v58, v59
  v_add_f32 v160, v88, v89
  s_waitcnt vmcnt(12)
  buffer_load_dwordx4 v[16:19], v39, s[8:11], s60 offen offset:512 nt
  v_cvt_f32_i32 v56, v20
  v_cvt_f32_i32 v57, v21
  v_cvt_f32_i32 v58, v22
  v_cvt_f32_i32 v59, v23
  v_pk_add_f32 v[56:57], v[56:57], v[138:139] neg_lo:[0,1] neg_hi:[0,1]
  v_pk_add_f32 v[58:59], v[58:59], v[140:141] neg_lo:[0,1] neg_hi:[0,1]
  v_cvt_pk_bf16_f32 v60, v56, v57
  v_cvt_pk_bf16_f32 v61, v58, v59
  v_lshlrev_b32 v56, 16, v60
  v_and_b32 v57, s65, v60
  v_lshlrev_b32 v58, 16, v61
  v_and_b32 v59, s65, v61
  v_pk_mul_f32 v[56:57], v[56:57], v[126:127]
  v_pk_mul_f32 v[58:59], v[58:59], v[128:129]
  v_cvt_pk_bf16_f32 v150, v56, v57
  v_cvt_pk_bf16_f32 v151, v58, v59
  s_nop 1
  v_mfma_f32_16x16x32_bf16 v[156:159], v[148:151], v[104:107], 0
  s_waitcnt vmcnt(12)
  buffer_load_dwordx4 v[20:23], v40, s[8:11], s60 offen offset:0 nt
  v_cvt_f32_i32 v56, v24
  v_cvt_f32_i32 v57, v25
  v_cvt_f32_i32 v58, v26
  v_cvt_f32_i32 v59, v27
  v_pk_add_f32 v[56:57], v[56:57], v[142:143] neg_lo:[0,1] neg_hi:[0,1]
  v_pk_add_f32 v[58:59], v[58:59], v[144:145] neg_lo:[0,1] neg_hi:[0,1]
  v_cvt_pk_bf16_f32 v60, v56, v57
  v_cvt_pk_bf16_f32 v61, v58, v59
  v_lshlrev_b32 v56, 16, v60
  v_and_b32 v57, s65, v60
  v_lshlrev_b32 v58, 16, v61
  v_and_b32 v59, s65, v61
  v_pk_mul_f32 v[56:57], v[56:57], v[130:131]
  v_pk_mul_f32 v[58:59], v[58:59], v[132:133]
  v_cvt_pk_bf16_f32 v152, v56, v57
  v_cvt_pk_bf16_f32 v153, v58, v59
  s_nop 1
  v_mfma_f32_16x16x16_bf16 v[156:159], v[152:153], v[108:109], v[156:159]
  s_waitcnt vmcnt(12)
  buffer_load_dwordx4 v[24:27], v40, s[8:11], s60 offen offset:256 nt
  v_cvt_f32_i32 v56, v28
  v_cvt_f32_i32 v57, v29
  v_cvt_f32_i32 v58, v30
  v_cvt_f32_i32 v59, v31
  v_pk_add_f32 v[56:57], v[56:57], v[134:135] neg_lo:[0,1] neg_hi:[0,1]
  v_pk_add_f32 v[58:59], v[58:59], v[136:137] neg_lo:[0,1] neg_hi:[0,1]
  v_cvt_pk_bf16_f32 v60, v56, v57
  v_cvt_pk_bf16_f32 v61, v58, v59
  v_mov_b32_dpp v88, v156 quad_perm:[0,0,0,0] row_mask:0xf bank_mask:0xf
  v_lshlrev_b32 v56, 16, v60
  v_and_b32 v57, s65, v60
  v_mov_b32_dpp v89, v158 quad_perm:[2,2,2,2] row_mask:0xf bank_mask:0xf
  v_lshlrev_b32 v58, 16, v61
  v_and_b32 v59, s65, v61
  v_add_f32_dpp v88, v157, v88 quad_perm:[1,1,1,1] row_mask:0xf bank_mask:0xf
  v_pk_mul_f32 v[56:57], v[56:57], v[122:123]
  v_pk_mul_f32 v[58:59], v[58:59], v[124:125]
  v_add_f32_dpp v89, v159, v89 quad_perm:[3,3,3,3] row_mask:0xf bank_mask:0xf
  v_cvt_pk_bf16_f32 v148, v56, v57
  v_cvt_pk_bf16_f32 v149, v58, v59
  v_add_f32 v161, v88, v89
  s_waitcnt vmcnt(12)
  buffer_load_dwordx4 v[28:31], v40, s[8:11], s60 offen offset:512 nt
  v_cvt_f32_i32 v56, v32
  v_cvt_f32_i32 v57, v33
  v_cvt_f32_i32 v58, v34
  v_cvt_f32_i32 v59, v35
  v_pk_add_f32 v[56:57], v[56:57], v[138:139] neg_lo:[0,1] neg_hi:[0,1]
  v_pk_add_f32 v[58:59], v[58:59], v[140:141] neg_lo:[0,1] neg_hi:[0,1]
  v_cvt_pk_bf16_f32 v88, v160, v161
  v_cvt_pk_bf16_f32 v60, v56, v57
  v_cvt_pk_bf16_f32 v61, v58, v59
  v_lshlrev_b32 v160, 16, v88
  v_lshlrev_b32 v56, 16, v60
  v_and_b32 v57, s65, v60
  v_and_b32 v161, s65, v88
  v_lshlrev_b32 v58, 16, v61
  v_and_b32 v59, s65, v61
  v_pk_mul_f32 v[160:161], v[160:161], s[68:69]
  v_pk_mul_f32 v[56:57], v[56:57], v[126:127]
  v_pk_mul_f32 v[58:59], v[58:59], v[128:129]
  v_cvt_pk_bf16_f32 v68, v160, v161
  v_cvt_pk_bf16_f32 v150, v56, v57
  v_cvt_pk_bf16_f32 v151, v58, v59
  s_nop 1
  v_mfma_f32_16x16x32_bf16 v[156:159], v[148:151], v[104:107], 0
  s_waitcnt vmcnt(12)
  buffer_load_dwordx4 v[32:35], v41, s[8:11], s60 offen offset:0 nt
  v_cvt_f32_i32 v56, v4
  v_cvt_f32_i32 v57, v5
  v_cvt_f32_i32 v58, v6
  v_cvt_f32_i32 v59, v7
  v_pk_add_f32 v[56:57], v[56:57], v[142:143] neg_lo:[0,1] neg_hi:[0,1]
  v_pk_add_f32 v[58:59], v[58:59], v[144:145] neg_lo:[0,1] neg_hi:[0,1]
  v_cvt_pk_bf16_f32 v60, v56, v57
  v_cvt_pk_bf16_f32 v61, v58, v59
  v_lshlrev_b32 v56, 16, v60
  v_and_b32 v57, s65, v60
  v_lshlrev_b32 v58, 16, v61
  v_and_b32 v59, s65, v61
  v_pk_mul_f32 v[56:57], v[56:57], v[130:131]
  v_pk_mul_f32 v[58:59], v[58:59], v[132:133]
  v_cvt_pk_bf16_f32 v152, v56, v57
  v_cvt_pk_bf16_f32 v153, v58, v59
  s_nop 1
  v_mfma_f32_16x16x16_bf16 v[156:159], v[152:153], v[108:109], v[156:159]
  s_waitcnt vmcnt(12)
  buffer_load_dwordx4 v[4:7], v41, s[8:11], s60 offen offset:256 nt
  v_cvt_f32_i32 v56, v8
  v_cvt_f32_i32 v57, v9
  v_cvt_f32_i32 v58, v10
  v_cvt_f32_i32 v59, v11
  v_pk_add_f32 v[56:57], v[56:57], v[134:135] neg_lo:[0,1] neg_hi:[0,1]
  v_pk_add_f32 v[58:59], v[58:59], v[136:137] neg_lo:[0,1] neg_hi:[0,1]
  v_cvt_pk_bf16_f32 v60, v56, v57
  v_cvt_pk_bf16_f32 v61, v58, v59
  v_mov_b32_dpp v88, v156 quad_perm:[0,0,0,0] row_mask:0xf bank_mask:0xf
  v_lshlrev_b32 v56, 16, v60
  v_and_b32 v57, s65, v60
  v_mov_b32_dpp v89, v158 quad_perm:[2,2,2,2] row_mask:0xf bank_mask:0xf
  v_lshlrev_b32 v58, 16, v61
  v_and_b32 v59, s65, v61
  v_add_f32_dpp v88, v157, v88 quad_perm:[1,1,1,1] row_mask:0xf bank_mask:0xf
  v_pk_mul_f32 v[56:57], v[56:57], v[122:123]
  v_pk_mul_f32 v[58:59], v[58:59], v[124:125]
  v_add_f32_dpp v89, v159, v89 quad_perm:[3,3,3,3] row_mask:0xf bank_mask:0xf
  v_cvt_pk_bf16_f32 v148, v56, v57
  v_cvt_pk_bf16_f32 v149, v58, v59
  v_add_f32 v160, v88, v89
  s_waitcnt vmcnt(12)
  buffer_load_dwordx4 v[8:11], v41, s[8:11], s60 offen offset:512 nt
  v_cvt_f32_i32 v56, v12
  v_cvt_f32_i32 v57, v13
  v_cvt_f32_i32 v58, v14
  v_cvt_f32_i32 v59, v15
  v_pk_add_f32 v[56:57], v[56:57], v[138:139] neg_lo:[0,1] neg_hi:[0,1]
  v_pk_add_f32 v[58:59], v[58:59], v[140:141] neg_lo:[0,1] neg_hi:[0,1]
  v_cvt_pk_bf16_f32 v60, v56, v57
  v_cvt_pk_bf16_f32 v61, v58, v59
  v_lshlrev_b32 v56, 16, v60
  v_and_b32 v57, s65, v60
  v_lshlrev_b32 v58, 16, v61
  v_and_b32 v59, s65, v61
  v_pk_mul_f32 v[56:57], v[56:57], v[126:127]
  v_pk_mul_f32 v[58:59], v[58:59], v[128:129]
  v_cvt_pk_bf16_f32 v150, v56, v57
  v_cvt_pk_bf16_f32 v151, v58, v59
  s_nop 1
  v_mfma_f32_16x16x32_bf16 v[156:159], v[148:151], v[104:107], 0
  s_waitcnt vmcnt(6)
  buffer_load_dwordx4 v[12:15], v42, s[8:11], s60 offen offset:0 nt
  v_cvt_f32_i32 v56, v16
  v_cvt_f32_i32 v57, v17
  v_cvt_f32_i32 v58, v18
  v_cvt_f32_i32 v59, v19
  v_pk_add_f32 v[56:57], v[56:57], v[142:143] neg_lo:[0,1] neg_hi:[0,1]
  v_pk_add_f32 v[58:59], v[58:59], v[144:145] neg_lo:[0,1] neg_hi:[0,1]
  v_cvt_pk_bf16_f32 v60, v56, v57
  v_cvt_pk_bf16_f32 v61, v58, v59
  v_lshlrev_b32 v56, 16, v60
  v_and_b32 v57, s65, v60
  v_lshlrev_b32 v58, 16, v61
  v_and_b32 v59, s65, v61
  v_pk_mul_f32 v[56:57], v[56:57], v[130:131]
  v_pk_mul_f32 v[58:59], v[58:59], v[132:133]
  v_cvt_pk_bf16_f32 v152, v56, v57
  v_cvt_pk_bf16_f32 v153, v58, v59
  s_nop 1
  v_mfma_f32_16x16x16_bf16 v[156:159], v[152:153], v[108:109], v[156:159]
  s_waitcnt vmcnt(6)
  buffer_load_dwordx4 v[16:19], v42, s[8:11], s60 offen offset:256 nt
  v_cvt_f32_i32 v56, v20
  v_cvt_f32_i32 v57, v21
  v_cvt_f32_i32 v58, v22
  v_cvt_f32_i32 v59, v23
  v_pk_add_f32 v[56:57], v[56:57], v[134:135] neg_lo:[0,1] neg_hi:[0,1]
  v_pk_add_f32 v[58:59], v[58:59], v[136:137] neg_lo:[0,1] neg_hi:[0,1]
  v_cvt_pk_bf16_f32 v60, v56, v57
  v_cvt_pk_bf16_f32 v61, v58, v59
  v_mov_b32_dpp v88, v156 quad_perm:[0,0,0,0] row_mask:0xf bank_mask:0xf
  v_lshlrev_b32 v56, 16, v60
  v_and_b32 v57, s65, v60
  v_mov_b32_dpp v89, v158 quad_perm:[2,2,2,2] row_mask:0xf bank_mask:0xf
  v_lshlrev_b32 v58, 16, v61
  v_and_b32 v59, s65, v61
  v_add_f32_dpp v88, v157, v88 quad_perm:[1,1,1,1] row_mask:0xf bank_mask:0xf
  v_pk_mul_f32 v[56:57], v[56:57], v[122:123]
  v_pk_mul_f32 v[58:59], v[58:59], v[124:125]
  v_add_f32_dpp v89, v159, v89 quad_perm:[3,3,3,3] row_mask:0xf bank_mask:0xf
  v_cvt_pk_bf16_f32 v148, v56, v57
  v_cvt_pk_bf16_f32 v149, v58, v59
  v_add_f32 v161, v88, v89
  s_waitcnt vmcnt(6)
  buffer_load_dwordx4 v[20:23], v42, s[8:11], s60 offen offset:512 nt
  v_cvt_f32_i32 v56, v24
  v_cvt_f32_i32 v57, v25
  v_cvt_f32_i32 v58, v26
  v_cvt_f32_i32 v59, v27
  v_pk_add_f32 v[56:57], v[56:57], v[138:139] neg_lo:[0,1] neg_hi:[0,1]
  v_pk_add_f32 v[58:59], v[58:59], v[140:141] neg_lo:[0,1] neg_hi:[0,1]
  v_cvt_pk_bf16_f32 v88, v160, v161
  v_cvt_pk_bf16_f32 v60, v56, v57
  v_cvt_pk_bf16_f32 v61, v58, v59
  v_lshlrev_b32 v160, 16, v88
  v_lshlrev_b32 v56, 16, v60
  v_and_b32 v57, s65, v60
  v_and_b32 v161, s65, v88
  v_lshlrev_b32 v58, 16, v61
  v_and_b32 v59, s65, v61
  v_pk_mul_f32 v[160:161], v[160:161], s[68:69]
  v_pk_mul_f32 v[56:57], v[56:57], v[126:127]
  v_pk_mul_f32 v[58:59], v[58:59], v[128:129]
  v_cvt_pk_bf16_f32 v69, v160, v161
  v_cvt_pk_bf16_f32 v150, v56, v57
  v_cvt_pk_bf16_f32 v151, v58, v59
  s_nop 1
  v_mfma_f32_16x16x32_bf16 v[156:159], v[148:151], v[104:107], 0
  s_waitcnt vmcnt(6)
  buffer_load_dwordx4 v[24:27], v43, s[8:11], s60 offen offset:0 nt
  v_cvt_f32_i32 v56, v28
  v_cvt_f32_i32 v57, v29
  v_cvt_f32_i32 v58, v30
  v_cvt_f32_i32 v59, v31
  v_pk_add_f32 v[56:57], v[56:57], v[142:143] neg_lo:[0,1] neg_hi:[0,1]
  v_pk_add_f32 v[58:59], v[58:59], v[144:145] neg_lo:[0,1] neg_hi:[0,1]
  v_cvt_pk_bf16_f32 v60, v56, v57
  v_cvt_pk_bf16_f32 v61, v58, v59
  v_lshlrev_b32 v56, 16, v60
  v_and_b32 v57, s65, v60
  v_lshlrev_b32 v58, 16, v61
  v_and_b32 v59, s65, v61
  v_pk_mul_f32 v[56:57], v[56:57], v[130:131]
  v_pk_mul_f32 v[58:59], v[58:59], v[132:133]
  v_cvt_pk_bf16_f32 v152, v56, v57
  v_cvt_pk_bf16_f32 v153, v58, v59
  s_nop 1
  v_mfma_f32_16x16x16_bf16 v[156:159], v[152:153], v[108:109], v[156:159]
  s_waitcnt vmcnt(6)
  buffer_load_dwordx4 v[28:31], v43, s[8:11], s60 offen offset:256 nt
  v_cvt_f32_i32 v56, v32
  v_cvt_f32_i32 v57, v33
  v_cvt_f32_i32 v58, v34
  v_cvt_f32_i32 v59, v35
  v_pk_add_f32 v[56:57], v[56:57], v[134:135] neg_lo:[0,1] neg_hi:[0,1]
  v_pk_add_f32 v[58:59], v[58:59], v[136:137] neg_lo:[0,1] neg_hi:[0,1]
  v_cvt_pk_bf16_f32 v60, v56, v57
  v_cvt_pk_bf16_f32 v61, v58, v59
  v_mov_b32_dpp v88, v156 quad_perm:[0,0,0,0] row_mask:0xf bank_mask:0xf
  v_lshlrev_b32 v56, 16, v60
  v_and_b32 v57, s65, v60
  v_mov_b32_dpp v89, v158 quad_perm:[2,2,2,2] row_mask:0xf bank_mask:0xf
  v_lshlrev_b32 v58, 16, v61
  v_and_b32 v59, s65, v61
  v_add_f32_dpp v88, v157, v88 quad_perm:[1,1,1,1] row_mask:0xf bank_mask:0xf
  v_pk_mul_f32 v[56:57], v[56:57], v[122:123]
  v_pk_mul_f32 v[58:59], v[58:59], v[124:125]
  v_add_f32_dpp v89, v159, v89 quad_perm:[3,3,3,3] row_mask:0xf bank_mask:0xf
  v_cvt_pk_bf16_f32 v148, v56, v57
  v_cvt_pk_bf16_f32 v149, v58, v59
  v_add_f32 v160, v88, v89
  s_waitcnt vmcnt(6)
  buffer_load_dwordx4 v[32:35], v43, s[8:11], s60 offen offset:512 nt
  v_cvt_f32_i32 v56, v4
  v_cvt_f32_i32 v57, v5
  v_cvt_f32_i32 v58, v6
  v_cvt_f32_i32 v59, v7
  v_pk_add_f32 v[56:57], v[56:57], v[138:139] neg_lo:[0,1] neg_hi:[0,1]
  v_pk_add_f32 v[58:59], v[58:59], v[140:141] neg_lo:[0,1] neg_hi:[0,1]
  v_cvt_pk_bf16_f32 v60, v56, v57
  v_cvt_pk_bf16_f32 v61, v58, v59
  v_lshlrev_b32 v56, 16, v60
  v_and_b32 v57, s65, v60
  v_lshlrev_b32 v58, 16, v61
  v_and_b32 v59, s65, v61
  v_pk_mul_f32 v[56:57], v[56:57], v[126:127]
  v_pk_mul_f32 v[58:59], v[58:59], v[128:129]
  v_cvt_pk_bf16_f32 v150, v56, v57
  v_cvt_pk_bf16_f32 v151, v58, v59
  s_nop 1
  v_mfma_f32_16x16x32_bf16 v[156:159], v[148:151], v[104:107], 0
  s_add_u32 s61, s60, 98304
  s_cmp_lg_u32 s64, 1
  s_cbranch_scc1 L_k_keep
  s_mov_b32 s61, s67
  s_mov_b32 s16, s12
  s_mov_b32 s17, s13
  v_mov_b32 v36, v44
  v_mov_b32 v37, v45
  v_mov_b32 v38, v46
  v_mov_b32 v39, v47
  v_mov_b32 v40, v48
  v_mov_b32 v41, v49
  v_mov_b32 v42, v50
  v_mov_b32 v43, v51
L_k_keep:
  s_waitcnt vmcnt(6)
  buffer_load_dwordx4 v[4:7], v36, s[16:19], s61 offen offset:0 nt
  v_cvt_f32_i32 v56, v8
  v_cvt_f32_i32 v57, v9
  v_cvt_f32_i32 v58, v10
  v_cvt_f32_i32 v59, v11
  v_pk_add_f32 v[56:57], v[56:57], v[142:143] neg_lo:[0,1] neg_hi:[0,1]
  v_pk_add_f32 v[58:59], v[58:59], v[144:145] neg_lo:[0,1] neg_hi:[0,1]
  v_cvt_pk_bf16_f32 v60, v56, v57
  v_cvt_pk_bf16_f32 v61, v58, v59
  v_lshlrev_b32 v56, 16, v60
  v_and_b32 v57, s65, v60
  v_lshlrev_b32 v58, 16, v61
  v_and_b32 v59, s65, v61
  v_pk_mul_f32 v[56:57], v[56:57], v[130:131]
  v_pk_mul_f32 v[58:59], v[58:59], v[132:133]
  v_cvt_pk_bf16_f32 v152, v56, v57
  v_cvt_pk_bf16_f32 v153, v58, v59
  s_nop 1
  v_mfma_f32_16x16x16_bf16 v[156:159], v[152:153], v[108:109], v[156:159]
  s_waitcnt vmcnt(6)
  buffer_load_dwordx4 v[8:11], v36, s[16:19], s61 offen offset:256 nt
  v_cvt_f32_i32 v56, v12
  v_cvt_f32_i32 v57, v13
  v_cvt_f32_i32 v58, v14
  v_cvt_f32_i32 v59, v15
  v_pk_add_f32 v[56:57], v[56:57], v[134:135] neg_lo:[0,1] neg_hi:[0,1]
  v_pk_add_f32 v[58:59], v[58:59], v[136:137] neg_lo:[0,1] neg_hi:[0,1]
  v_cvt_pk_bf16_f32 v60, v56, v57
  v_cvt_pk_bf16_f32 v61, v58, v59
  v_mov_b32_dpp v88, v156 quad_perm:[0,0,0,0] row_mask:0xf bank_mask:0xf
  v_lshlrev_b32 v56, 16, v60
  v_and_b32 v57, s65, v60
  v_mov_b32_dpp v89, v158 quad_perm:[2,2,2,2] row_mask:0xf bank_mask:0xf
  v_lshlrev_b32 v58, 16, v61
  v_and_b32 v59, s65, v61
  v_add_f32_dpp v88, v157, v88 quad_perm:[1,1,1,1] row_mask:0xf bank_mask:0xf
  v_pk_mul_f32 v[56:57], v[56:57], v[122:123]
  v_pk_mul_f32 v[58:59], v[58:59], v[124:125]
  v_add_f32_dpp v89, v159, v89 quad_perm:[3,3,3,3] row_mask:0xf bank_mask:0xf
  v_cvt_pk_bf16_f32 v148, v56, v57
  v_cvt_pk_bf16_f32 v149, v58, v59
  v_add_f32 v161, v88, v89
  s_waitcnt vmcnt(6)
  buffer_load_dwordx4 v[12:15], v36, s[16:19], s61 offen offset:512 nt
  v_cvt_f32_i32 v56, v16
  v_cvt_f32_i32 v57, v17
  v_cvt_f32_i32 v58, v18
  v_cvt_f32_i32 v59, v19
  v_pk_add_f32 v[56:57], v[56:57], v[138:139] neg_lo:[0,1] neg_hi:[0,1]
  v_pk_add_f32 v[58:59], v[58:59], v[140:141] neg_lo:[0,1] neg_hi:[0,1]
  v_cvt_pk_bf16_f32 v88, v160, v161
  v_cvt_pk_bf16_f32 v60, v56, v57
  v_cvt_pk_bf16_f32 v61, v58, v59
  v_lshlrev_b32 v160, 16, v88
  v_lshlrev_b32 v56, 16, v60
  v_and_b32 v57, s65, v60
  v_and_b32 v161, s65, v88
  v_lshlrev_b32 v58, 16, v61
  v_and_b32 v59, s65, v61
  v_pk_mul_f32 v[160:161], v[160:161], s[68:69]
  v_pk_mul_f32 v[56:57], v[56:57], v[126:127]
  v_pk_mul_f32 v[58:59], v[58:59], v[128:129]
  v_cvt_pk_bf16_f32 v70, v160, v161
  v_cvt_pk_bf16_f32 v150, v56, v57
  v_cvt_pk_bf16_f32 v151, v58, v59
  s_nop 1
  v_mfma_f32_16x16x32_bf16 v[156:159], v[148:151], v[104:107], 0
  s_waitcnt vmcnt(6)
  buffer_load_dwordx4 v[16:19], v37, s[16:19], s61 offen offset:0 nt
  v_cvt_f32_i32 v56, v20
  v_cvt_f32_i32 v57, v21
  v_cvt_f32_i32 v58, v22
  v_cvt_f32_i32 v59, v23
  v_pk_add_f32 v[56:57], v[56:57], v[142:143] neg_lo:[0,1] neg_hi:[0,1]
  v_pk_add_f32 v[58:59], v[58:59], v[144:145] neg_lo:[0,1] neg_hi:[0,1]
  v_cvt_pk_bf16_f32 v60, v56, v57
  v_cvt_pk_bf16_f32 v61, v58, v59
  v_lshlrev_b32 v56, 16, v60
  v_and_b32 v57, s65, v60
  v_lshlrev_b32 v58, 16, v61
  v_and_b32 v59, s65, v61
  v_pk_mul_f32 v[56:57], v[56:57], v[130:131]
  v_pk_mul_f32 v[58:59], v[58:59], v[132:133]
  v_cvt_pk_bf16_f32 v152, v56, v57
  v_cvt_pk_bf16_f32 v153, v58, v59
  s_nop 1
  v_mfma_f32_16x16x16_bf16 v[156:159], v[152:153], v[108:109], v[156:159]
  s_waitcnt vmcnt(6)
  buffer_load_dwordx4 v[20:23], v37, s[16:19], s61 offen offset:256 nt
  v_cvt_f32_i32 v56, v24
  v_cvt_f32_i32 v57, v25
  v_cvt_f32_i32 v58, v26
  v_cvt_f32_i32 v59, v27
  v_pk_add_f32 v[56:57], v[56:57], v[134:135] neg_lo:[0,1] neg_hi:[0,1]
  v_pk_add_f32 v[58:59], v[58:59], v[136:137] neg_lo:[0,1] neg_hi:[0,1]
  v_cvt_pk_bf16_f32 v60, v56, v57
  v_cvt_pk_bf16_f32 v61, v58, v59
  v_mov_b32_dpp v88, v156 quad_perm:[0,0,0,0] row_mask:0xf bank_mask:0xf
  v_lshlrev_b32 v56, 16, v60
  v_and_b32 v57, s65, v60
  v_mov_b32_dpp v89, v158 quad_perm:[2,2,2,2] row_mask:0xf bank_mask:0xf
  v_lshlrev_b32 v58, 16, v61
  v_and_b32 v59, s65, v61
  v_add_f32_dpp v88, v157, v88 quad_perm:[1,1,1,1] row_mask:0xf bank_mask:0xf
  v_pk_mul_f32 v[56:57], v[56:57], v[122:123]
  v_pk_mul_f32 v[58:59], v[58:59], v[124:125]
  v_add_f32_dpp v89, v159, v89 quad_perm:[3,3,3,3] row_mask:0xf bank_mask:0xf
  v_cvt_pk_bf16_f32 v148, v56, v57
  v_cvt_pk_bf16_f32 v149, v58, v59
  v_add_f32 v160, v88, v89
  s_waitcnt vmcnt(6)
  buffer_load_dwordx4 v[24:27], v37, s[16:19], s61 offen offset:512 nt
  v_cvt_f32_i32 v56, v28
  v_cvt_f32_i32 v57, v29
  v_cvt_f32_i32 v58, v30
  v_cvt_f32_i32 v59, v31
  v_pk_add_f32 v[56:57], v[56:57], v[138:139] neg_lo:[0,1] neg_hi:[0,1]
  v_pk_add_f32 v[58:59], v[58:59], v[140:141] neg_lo:[0,1] neg_hi:[0,1]
  v_cvt_pk_bf16_f32 v60, v56, v57
  v_cvt_pk_bf16_f32 v61, v58, v59
  v_lshlrev_b32 v56, 16, v60
  v_and_b32 v57, s65, v60
  v_lshlrev_b32 v58, 16, v61
  v_and_b32 v59, s65, v61
  v_pk_mul_f32 v[56:57], v[56:57], v[126:127]
  v_pk_mul_f32 v[58:59], v[58:59], v[128:129]
  v_cvt_pk_bf16_f32 v150, v56, v57
  v_cvt_pk_bf16_f32 v151, v58, v59
  s_nop 1
  v_mfma_f32_16x16x32_bf16 v[156:159], v[148:151], v[104:107], 0
  s_waitcnt vmcnt(6)
  buffer_load_dwordx4 v[28:31], v38, s[16:19], s61 offen offset:0 nt
  v_cvt_f32_i32 v56, v32
  v_cvt_f32_i32 v57, v33
  v_cvt_f32_i32 v58, v34
  v_cvt_f32_i32 v59, v35
  v_pk_add_f32 v[56:57], v[56:57], v[142:143] neg_lo:[0,1] neg_hi:[0,1]
  v_pk_add_f32 v[58:59], v[58:59], v[144:145] neg_lo:[0,1] neg_hi:[0,1]
  v_cvt_pk_bf16_f32 v60, v56, v57
  v_cvt_pk_bf16_f32 v61, v58, v59
  v_lshlrev_b32 v56, 16, v60
  v_and_b32 v57, s65, v60
  v_lshlrev_b32 v58, 16, v61
  v_and_b32 v59, s65, v61
  v_pk_mul_f32 v[56:57], v[56:57], v[130:131]
  v_pk_mul_f32 v[58:59], v[58:59], v[132:133]
  v_cvt_pk_bf16_f32 v152, v56, v57
  v_cvt_pk_bf16_f32 v153, v58, v59
  s_nop 1
  v_mfma_f32_16x16x16_bf16 v[156:159], v[152:153], v[108:109], v[156:159]
  s_mov_b32 s60, s61
  s_sub_u32 s64, s64, 1
  s_nop 5
  v_mov_b32_dpp v88, v156 quad_perm:[0,0,0,0] row_mask:0xf bank_mask:0xf
  v_mov_b32_dpp v89, v158 quad_perm:[2,2,2,2] row_mask:0xf bank_mask:0xf
  s_nop 0
  v_add_f32_dpp v88, v157, v88 quad_perm:[1,1,1,1] row_mask:0xf bank_mask:0xf
  v_add_f32_dpp v89, v159, v89 quad_perm:[3,3,3,3] row_mask:0xf bank_mask:0xf
  v_add_f32 v161, v88, v89
  v_cvt_pk_bf16_f32 v88, v160, v161
  v_lshlrev_b32 v160, 16, v88
  v_and_b32 v161, s65, v88
  v_pk_mul_f32 v[160:161], v[160:161], s[68:69]
  v_cvt_pk_bf16_f32 v71, v160, v161
  ds_write_b128 v54, v[68:71]
  v_add_u32 v54, 256, v54
  s_cmp_lg_u32 s64, 0
  s_cbranch_scc1 L_k
  v_subrev_u32 v54, 8192, v54
  s_mov_b32 s64, 32
  s_waitcnt lgkmcnt(0)
  ds_read_b128 v[68:71], v54
L_v:
  s_waitcnt vmcnt(6)
  buffer_load_dwordx4 v[32:35], v38, s[12:15], s60 offen offset:256 nt
  v_mov_b32 v64, v62
  v_mov_b32 v65, v63
  v_cvt_f32_i32 v120, v4
  v_cvt_f32_i32 v121, v5
  v_cvt_f32_i32 v122, v6
  v_cvt_f32_i32 v123, v7
  v_mov_b32_dpp v66, v64 row_newbcast:0 row_mask:0xf bank_mask:0xf
  v_mov_b32_dpp v67, v65 row_newbcast:0 row_mask:0xf bank_mask:0xf
  v_pk_add_f32 v[120:121], v[120:121], v[66:67] op_sel_hi:[1,0] neg_lo:[0,1] neg_hi:[0,1]
  v_pk_add_f32 v[122:123], v[122:123], v[66:67] op_sel_hi:[1,0] neg_lo:[0,1] neg_hi:[0,1]
  s_waitcnt lgkmcnt(0)
  v_cvt_pk_bf16_f32 v60, v120, v121
  v_cvt_pk_bf16_f32 v61, v122, v123
  v_lshlrev_b32 v92, 16, v68
  v_lshlrev_b32 v120, 16, v60
  v_and_b32 v121, s65, v60
  v_and_b32 v93, s65, v68
  v_lshlrev_b32 v122, 16, v61
  v_and_b32 v123, s65, v61
  v_lshlrev_b32 v94, 16, v69
  v_pk_mul_f32 v[120:121], v[120:121], v[66:67] op_sel:[0,1]
  v_pk_mul_f32 v[122:123], v[122:123], v[66:67] op_sel:[0,1]
  v_and_b32 v95, s65, v69
  s_waitcnt vmcnt(6)
  buffer_load_dwordx4 v[4:7], v38, s[12:15], s60 offen offset:512 nt
  v_cvt_f32_i32 v124, v8
  v_cvt_f32_i32 v125, v9
  v_cvt_f32_i32 v126, v10
  v_cvt_f32_i32 v127, v11
  v_pk_add_f32 v[124:125], v[124:125], v[66:67] op_sel_hi:[1,0] neg_lo:[0,1] neg_hi:[0,1]
  v_pk_add_f32 v[126:127], v[126:127], v[66:67] op_sel_hi:[1,0] neg_lo:[0,1] neg_hi:[0,1]
  v_lshlrev_b32 v96, 16, v70
  v_cvt_pk_bf16_f32 v60, v124, v125
  v_cvt_pk_bf16_f32 v61, v126, v127
  v_and_b32 v97, s65, v70
  v_lshlrev_b32 v124, 16, v60
  v_and_b32 v125, s65, v60
  v_lshlrev_b32 v98, 16, v71
  v_lshlrev_b32 v126, 16, v61
  v_and_b32 v127, s65, v61
  v_and_b32 v99, s65, v71
  v_pk_mul_f32 v[124:125], v[124:125], v[66:67] op_sel:[0,1]
  v_pk_mul_f32 v[126:127], v[126:127], v[66:67] op_sel:[0,1]
  v_add_u32 v54, 256, v54
  s_waitcnt vmcnt(6)
  buffer_load_dwordx4 v[8:11], v39, s[12:15], s60 offen offset:0 nt
  v_cvt_f32_i32 v128, v12
  v_cvt_f32_i32 v129, v13
  v_cvt_f32_i32 v130, v14
  v_cvt_f32_i32 v131, v15
  v_pk_add_f32 v[128:129], v[128:129], v[66:67] op_sel_hi:[1,0] neg_lo:[0,1] neg_hi:[0,1]
  v_pk_add_f32 v[130:131], v[130:131], v[66:67] op_sel_hi:[1,0] neg_lo:[0,1] neg_hi:[0,1]
  v_max3_f32 v88, v92, v93, v94
  v_cvt_pk_bf16_f32 v60, v128, v129
  v_cvt_pk_bf16_f32 v61, v130, v131
  ds_read_b128 v[68:71], v54
  v_lshlrev_b32 v128, 16, v60
  v_and_b32 v129, s65, v60
  v_max3_f32 v89, v95, v96, v97
  v_lshlrev_b32 v130, 16, v61
  v_and_b32 v131, s65, v61
  v_max3_f32 v88, v88, v98, v99
  v_pk_mul_f32 v[128:129], v[128:129], v[66:67] op_sel:[0,1]
  v_pk_mul_f32 v[130:131], v[130:131], v[66:67] op_sel:[0,1]
  v_max3_f32 v88, v88, v89, v84
  s_waitcnt vmcnt(6)
  buffer_load_dwordx4 v[12:15], v39, s[12:15], s60 offen offset:256 nt
  v_cvt_f32_i32 v56, v16
  v_cvt_f32_i32 v57, v17
  v_cvt_f32_i32 v58, v18
  v_cvt_f32_i32 v59, v19
  s_add_u32 s63, s63, 256
  buffer_load_short_d16_hi v62, v53, s[32:35], s63 offen nt
  buffer_load_short_d16_hi v63, v53, s[28:31], s63 offen nt
  v_mov_b32_dpp v66, v64 row_newbcast:1 row_mask:0xf bank_mask:0xf
  v_mov_b32_dpp v67, v65 row_newbcast:1 row_mask:0xf bank_mask:0xf
  v_pk_add_f32 v[56:57], v[56:57], v[66:67] op_sel_hi:[1,0] neg_lo:[0,1] neg_hi:[0,1]
  v_pk_add_f32 v[58:59], v[58:59], v[66:67] op_sel_hi:[1,0] neg_lo:[0,1] neg_hi:[0,1]
  v_mov_b32 v89, v88
  v_cvt_pk_bf16_f32 v60, v56, v57
  v_cvt_pk_bf16_f32 v61, v58, v59
  v_permlane32_swap_b32 v88, v89
  v_lshlrev_b32 v56, 16, v60
  v_and_b32 v57, s65, v60
  v_max_f32 v88, v88, v89
  v_lshlrev_b32 v58, 16, v61
  v_and_b32 v59, s65, v61
  v_mov_b32 v89, v88
  v_pk_mul_f32 v[56:57], v[56:57], v[66:67] op_sel:[0,1]
  v_pk_mul_f32 v[58:59], v[58:59], v[66:67] op_sel:[0,1]
  v_permlane16_swap_b32 v88, v89
  v_cvt_pk_bf16_f32 v132, v120, v56
  v_cvt_pk_bf16_f32 v136, v121, v57
  v_cvt_pk_bf16_f32 v140, v122, v58
  v_cvt_pk_bf16_f32 v144, v123, v59
  s_waitcnt vmcnt(8)
  buffer_load_dwordx4 v[16:19], v39, s[12:15], s60 offen offset:512 nt
  v_cvt_f32_i32 v56, v20
  v_cvt_f32_i32 v57, v21
  v_cvt_f32_i32 v58, v22
  v_cvt_f32_i32 v59, v23
  v_pk_add_f32 v[56:57], v[56:57], v[66:67] op_sel_hi:[1,0] neg_lo:[0,1] neg_hi:[0,1]
  v_pk_add_f32 v[58:59], v[58:59], v[66:67] op_sel_hi:[1,0] neg_lo:[0,1] neg_hi:[0,1]
  v_max_f32 v84, v88, v89
  v_cvt_pk_bf16_f32 v60, v56, v57
  v_cvt_pk_bf16_f32 v61, v58, v59
  v_mul_f32 v88, s66, v84
  v_lshlrev_b32 v56, 16, v60
  v_and_b32 v57, s65, v60
  v_add_f32 v90, v88, v86
  v_lshlrev_b32 v58, 16, v61
  v_and_b32 v59, s65, v61
  v_sub_f32 v86, 0, v88
  v_pk_mul_f32 v[56:57], v[56:57], v[66:67] op_sel:[0,1]
  v_pk_mul_f32 v[58:59], v[58:59], v[66:67] op_sel:[0,1]
  v_exp_f32 v90, -v90
  v_cvt_pk_bf16_f32 v148, v124, v56
  v_cvt_pk_bf16_f32 v152, v125, v57
  v_cvt_pk_bf16_f32 v156, v126, v58
  v_cvt_pk_bf16_f32 v160, v127, v59
  s_waitcnt vmcnt(8)
  buffer_load_dwordx4 v[20:23], v40, s[12:15], s60 offen offset:0 nt
  v_cvt_f32_i32 v56, v24
  v_cvt_f32_i32 v57, v25
  v_cvt_f32_i32 v58, v26
  v_cvt_f32_i32 v59, v27
  v_pk_add_f32 v[56:57], v[56:57], v[66:67] op_sel_hi:[1,0] neg_lo:[0,1] neg_hi:[0,1]
  v_pk_add_f32 v[58:59], v[58:59], v[66:67] op_sel_hi:[1,0] neg_lo:[0,1] neg_hi:[0,1]
  ds_bpermute_b32 v91, v55, v90
  v_cvt_pk_bf16_f32 v60, v56, v57
  v_cvt_pk_bf16_f32 v61, v58, v59
  v_fma_f32 v92, v92, s66, v86
  v_lshlrev_b32 v56, 16, v60
  v_and_b32 v57, s65, v60
  v_exp_f32 v92, v92
  v_lshlrev_b32 v58, 16, v61
  v_and_b32 v59, s65, v61
  v_fma_f32 v93, v93, s66, v86
  v_pk_mul_f32 v[56:57], v[56:57], v[66:67] op_sel:[0,1]
  v_pk_mul_f32 v[58:59], v[58:59], v[66:67] op_sel:[0,1]
  v_exp_f32 v93, v93
  v_cvt_pk_bf16_f32 v164, v128, v56
  v_cvt_pk_bf16_f32 v168, v129, v57
  v_cvt_pk_bf16_f32 v172, v130, v58
  v_cvt_pk_bf16_f32 v176, v131, v59
  s_waitcnt vmcnt(8)
  buffer_load_dwordx4 v[24:27], v40, s[12:15], s60 offen offset:256 nt
  v_cvt_f32_i32 v120, v28
  v_cvt_f32_i32 v121, v29
  v_cvt_f32_i32 v122, v30
  v_cvt_f32_i32 v123, v31
  v_mov_b32_dpp v66, v64 row_newbcast:2 row_mask:0xf bank_mask:0xf
  v_mov_b32_dpp v67, v65 row_newbcast:2 row_mask:0xf bank_mask:0xf
  v_pk_add_f32 v[120:121], v[120:121], v[66:67] op_sel_hi:[1,0] neg_lo:[0,1] neg_hi:[0,1]
  v_pk_add_f32 v[122:123], v[122:123], v[66:67] op_sel_hi:[1,0] neg_lo:[0,1] neg_hi:[0,1]
  v_fma_f32 v94, v94, s66, v86
  v_cvt_pk_bf16_f32 v60, v120, v121
  v_cvt_pk_bf16_f32 v61, v122, v123
  v_exp_f32 v94, v94
  v_lshlrev_b32 v120, 16, v60
  v_and_b32 v121, s65, v60
  v_fma_f32 v95, v95, s66, v86
  v_lshlrev_b32 v122, 16, v61
  v_and_b32 v123, s65, v61
  v_exp_f32 v95, v95
  v_pk_mul_f32 v[120:121], v[120:121], v[66:67] op_sel:[0,1]
  v_pk_mul_f32 v[122:123], v[122:123], v[66:67] op_sel:[0,1]
  v_fma_f32 v96, v96, s66, v86
  s_waitcnt vmcnt(8)
  buffer_load_dwordx4 v[28:31], v40, s[12:15], s60 offen offset:512 nt
  v_cvt_f32_i32 v124, v32
  v_cvt_f32_i32 v125, v33
  v_cvt_f32_i32 v126, v34
  v_cvt_f32_i32 v127, v35
  v_pk_add_f32 v[124:125], v[124:125], v[66:67] op_sel_hi:[1,0] neg_lo:[0,1] neg_hi:[0,1]
  v_pk_add_f32 v[126:127], v[126:127], v[66:67] op_sel_hi:[1,0] neg_lo:[0,1] neg_hi:[0,1]
  v_exp_f32 v96, v96
  v_cvt_pk_bf16_f32 v60, v124, v125
  v_cvt_pk_bf16_f32 v61, v126, v127
  v_fma_f32 v97, v97, s66, v86
  v_lshlrev_b32 v124, 16, v60
  v_and_b32 v125, s65, v60
  v_exp_f32 v97, v97
  v_lshlrev_b32 v126, 16, v61
  v_and_b32 v127, s65, v61
  v_fma_f32 v98, v98, s66, v86
  v_pk_mul_f32 v[124:125], v[124:125], v[66:67] op_sel:[0,1]
  v_pk_mul_f32 v[126:127], v[126:127], v[66:67] op_sel:[0,1]
  v_exp_f32 v98, v98
  s_waitcnt vmcnt(8)
  buffer_load_dwordx4 v[32:35], v41, s[12:15], s60 offen offset:0 nt
  v_cvt_f32_i32 v128, v4
  v_cvt_f32_i32 v129, v5
  v_cvt_f32_i32 v130, v6
  v_cvt_f32_i32 v131, v7
  v_pk_add_f32 v[128:129], v[128:129], v[66:67] op_sel_hi:[1,0] neg_lo:[0,1] neg_hi:[0,1]
  v_pk_add_f32 v[130:131], v[130:131], v[66:67] op_sel_hi:[1,0] neg_lo:[0,1] neg_hi:[0,1]
  v_fma_f32 v99, v99, s66, v86
  v_cvt_pk_bf16_f32 v60, v128, v129
  v_cvt_pk_bf16_f32 v61, v130, v131
  v_exp_f32 v99, v99
  v_lshlrev_b32 v128, 16, v60
  v_and_b32 v129, s65, v60
  v_add_f32 v88, v92, v93
  v_lshlrev_b32 v130, 16, v61
  v_and_b32 v131, s65, v61
  v_add_f32 v89, v94, v95
  v_pk_mul_f32 v[128:129], v[128:129], v[66:67] op_sel:[0,1]
  v_pk_mul_f32 v[130:131], v[130:131], v[66:67] op_sel:[0,1]
  v_add_f32 v88, v88, v96
  s_waitcnt vmcnt(8)
  buffer_load_dwordx4 v[4:7], v41, s[12:15], s60 offen offset:256 nt
  v_cvt_f32_i32 v56, v8
  v_cvt_f32_i32 v57, v9
  v_cvt_f32_i32 v58, v10
  v_cvt_f32_i32 v59, v11
  v_mov_b32_dpp v66, v64 row_newbcast:3 row_mask:0xf bank_mask:0xf
  v_mov_b32_dpp v67, v65 row_newbcast:3 row_mask:0xf bank_mask:0xf
  v_pk_add_f32 v[56:57], v[56:57], v[66:67] op_sel_hi:[1,0] neg_lo:[0,1] neg_hi:[0,1]
  v_pk_add_f32 v[58:59], v[58:59], v[66:67] op_sel_hi:[1,0] neg_lo:[0,1] neg_hi:[0,1]
  v_add_f32 v89, v89, v97
  v_cvt_pk_bf16_f32 v60, v56, v57
  v_cvt_pk_bf16_f32 v61, v58, v59
  v_add_f32 v88, v88, v98
  v_lshlrev_b32 v56, 16, v60
  v_and_b32 v57, s65, v60
  v_add_f32 v89, v89, v99
  v_lshlrev_b32 v58, 16, v61
  v_and_b32 v59, s65, v61
  v_add_f32 v88, v88, v89
  v_pk_mul_f32 v[56:57], v[56:57], v[66:67] op_sel:[0,1]
  v_pk_mul_f32 v[58:59], v[58:59], v[66:67] op_sel:[0,1]
  v_fma_f32 v87, v87, v90, v88
  v_cvt_pk_bf16_f32 v133, v120, v56
  v_cvt_pk_bf16_f32 v137, v121, v57
  v_cvt_pk_bf16_f32 v141, v122, v58
  v_cvt_pk_bf16_f32 v145, v123, v59
  s_waitcnt vmcnt(8)
  buffer_load_dwordx4 v[8:11], v41, s[12:15], s60 offen offset:512 nt
  v_cvt_f32_i32 v56, v12
  v_cvt_f32_i32 v57, v13
  v_cvt_f32_i32 v58, v14
  v_cvt_f32_i32 v59, v15
  v_pk_add_f32 v[56:57], v[56:57], v[66:67] op_sel_hi:[1,0] neg_lo:[0,1] neg_hi:[0,1]
  v_pk_add_f32 v[58:59], v[58:59], v[66:67] op_sel_hi:[1,0] neg_lo:[0,1] neg_hi:[0,1]
  v_cvt_pk_bf16_f32 v100, v92, v93
  v_cvt_pk_bf16_f32 v60, v56, v57
  v_cvt_pk_bf16_f32 v61, v58, v59
  v_cvt_pk_bf16_f32 v101, v94, v95
  v_lshlrev_b32 v56, 16, v60
  v_and_b32 v57, s65, v60
  v_cvt_pk_bf16_f32 v102, v96, v97
  v_lshlrev_b32 v58, 16, v61
  v_and_b32 v59, s65, v61
  v_cvt_pk_bf16_f32 v103, v98, v99
  v_pk_mul_f32 v[56:57], v[56:57], v[66:67] op_sel:[0,1]
  v_pk_mul_f32 v[58:59], v[58:59], v[66:67] op_sel:[0,1]
  v_cndmask_b32 v104, 0, v100, s[72:73]
  v_cvt_pk_bf16_f32 v149, v124, v56
  v_cvt_pk_bf16_f32 v153, v125, v57
  v_cvt_pk_bf16_f32 v157, v126, v58
  v_cvt_pk_bf16_f32 v161, v127, v59
  s_waitcnt vmcnt(6)
  buffer_load_dwordx4 v[12:15], v42, s[12:15], s60 offen offset:0 nt
  v_cvt_f32_i32 v56, v16
  v_cvt_f32_i32 v57, v17
  v_cvt_f32_i32 v58, v18
  v_cvt_f32_i32 v59, v19
  v_pk_add_f32 v[56:57], v[56:57], v[66:67] op_sel_hi:[1,0] neg_lo:[0,1] neg_hi:[0,1]
  v_pk_add_f32 v[58:59], v[58:59], v[66:67] op_sel_hi:[1,0] neg_lo:[0,1] neg_hi:[0,1]
  v_cndmask_b32 v105, 0, v101, s[72:73]
  v_cvt_pk_bf16_f32 v60, v56, v57
  v_cvt_pk_bf16_f32 v61, v58, v59
  v_cndmask_b32 v106, 0, v102, s[72:73]
  v_lshlrev_b32 v56, 16, v60
  v_and_b32 v57, s65, v60
  v_cndmask_b32 v107, 0, v103, s[72:73]
  v_lshlrev_b32 v58, 16, v61
  v_and_b32 v59, s65, v61
  v_cndmask_b32 v108, 0, v100, s[74:75]
  v_pk_mul_f32 v[56:57], v[56:57], v[66:67] op_sel:[0,1]
  v_pk_mul_f32 v[58:59], v[58:59], v[66:67] op_sel:[0,1]
  v_cndmask_b32 v109, 0, v101, s[74:75]
  v_cvt_pk_bf16_f32 v165, v128, v56
  v_cvt_pk_bf16_f32 v169, v129, v57
  v_cvt_pk_bf16_f32 v173, v130, v58
  v_cvt_pk_bf16_f32 v177, v131, v59
  s_waitcnt vmcnt(6)
  buffer_load_dwordx4 v[16:19], v42, s[12:15], s60 offen offset:256 nt
  v_cvt_f32_i32 v120, v20
  v_cvt_f32_i32 v121, v21
  v_cvt_f32_i32 v122, v22
  v_cvt_f32_i32 v123, v23
  v_mov_b32_dpp v66, v64 row_newbcast:4 row_mask:0xf bank_mask:0xf
  v_mov_b32_dpp v67, v65 row_newbcast:4 row_mask:0xf bank_mask:0xf
  v_pk_add_f32 v[120:121], v[120:121], v[66:67] op_sel_hi:[1,0] neg_lo:[0,1] neg_hi:[0,1]
  v_pk_add_f32 v[122:123], v[122:123], v[66:67] op_sel_hi:[1,0] neg_lo:[0,1] neg_hi:[0,1]
  v_cndmask_b32 v110, 0, v102, s[74:75]
  v_cvt_pk_bf16_f32 v60, v120, v121
  v_cvt_pk_bf16_f32 v61, v122, v123
  v_cndmask_b32 v111, 0, v103, s[74:75]
  v_lshlrev_b32 v120, 16, v60
  v_and_b32 v121, s65, v60
  v_cndmask_b32 v112, 0, v100, s[76:77]
  v_lshlrev_b32 v122, 16, v61
  v_and_b32 v123, s65, v61
  v_cndmask_b32 v113, 0, v101, s[76:77]
  v_pk_mul_f32 v[120:121], v[120:121], v[66:67] op_sel:[0,1]
  v_pk_mul_f32 v[122:123], v[122:123], v[66:67] op_sel:[0,1]
  v_cndmask_b32 v114, 0, v102, s[76:77]
  s_waitcnt vmcnt(6)
  buffer_load_dwordx4 v[20:23], v42, s[12:15], s60 offen offset:512 nt
  v_cvt_f32_i32 v124, v24
  v_cvt_f32_i32 v125, v25
  v_cvt_f32_i32 v126, v26
  v_cvt_f32_i32 v127, v27
  v_pk_add_f32 v[124:125], v[124:125], v[66:67] op_sel_hi:[1,0] neg_lo:[0,1] neg_hi:[0,1]
  v_pk_add_f32 v[126:127], v[126:127], v[66:67] op_sel_hi:[1,0] neg_lo:[0,1] neg_hi:[0,1]
  v_cndmask_b32 v115, 0, v103, s[76:77]
  v_cvt_pk_bf16_f32 v60, v124, v125
  v_cvt_pk_bf16_f32 v61, v126, v127
  v_cndmask_b32 v116, 0, v100, s[78:79]
  v_lshlrev_b32 v124, 16, v60
  v_and_b32 v125, s65, v60
  v_cndmask_b32 v117, 0, v101, s[78:79]
  v_lshlrev_b32 v126, 16, v61
  v_and_b32 v127, s65, v61
  v_cndmask_b32 v118, 0, v102, s[78:79]
  v_pk_mul_f32 v[124:125], v[124:125], v[66:67] op_sel:[0,1]
  v_pk_mul_f32 v[126:127], v[126:127], v[66:67] op_sel:[0,1]
  v_cndmask_b32 v119, 0, v103, s[78:79]
  s_waitcnt vmcnt(6)
  buffer_load_dwordx4 v[24:27], v43, s[12:15], s60 offen offset:0 nt
  v_cvt_f32_i32 v128, v28
  v_cvt_f32_i32 v129, v29
  v_cvt_f32_i32 v130, v30
  v_cvt_f32_i32 v131, v31
  v_pk_add_f32 v[128:129], v[128:129], v[66:67] op_sel_hi:[1,0] neg_lo:[0,1] neg_hi:[0,1]
  v_pk_add_f32 v[130:131], v[130:131], v[66:67] op_sel_hi:[1,0] neg_lo:[0,1] neg_hi:[0,1]
  s_waitcnt lgkmcnt(0)
  v_cvt_pk_bf16_f32 v60, v128, v129
  v_cvt_pk_bf16_f32 v61, v130, v131
  v_mul_f32 v72, v91, v72
  v_lshlrev_b32 v128, 16, v60
  v_and_b32 v129, s65, v60
  v_mul_f32 v73, v91, v73
  v_lshlrev_b32 v130, 16, v61
  v_and_b32 v131, s65, v61
  v_mul_f32 v74, v91, v74
  v_pk_mul_f32 v[128:129], v[128:129], v[66:67] op_sel:[0,1]
  v_pk_mul_f32 v[130:131], v[130:131], v[66:67] op_sel:[0,1]
  v_mul_f32 v75, v91, v75
  s_waitcnt vmcnt(6)
  buffer_load_dwordx4 v[28:31], v43, s[12:15], s60 offen offset:256 nt
  v_cvt_f32_i32 v56, v32
  v_cvt_f32_i32 v57, v33
  v_cvt_f32_i32 v58, v34
  v_cvt_f32_i32 v59, v35
  v_mov_b32_dpp v66, v64 row_newbcast:5 row_mask:0xf bank_mask:0xf
  v_mov_b32_dpp v67, v65 row_newbcast:5 row_mask:0xf bank_mask:0xf
  v_pk_add_f32 v[56:57], v[56:57], v[66:67] op_sel_hi:[1,0] neg_lo:[0,1] neg_hi:[0,1]
  v_pk_add_f32 v[58:59], v[58:59], v[66:67] op_sel_hi:[1,0] neg_lo:[0,1] neg_hi:[0,1]
  v_mul_f32 v76, v91, v76
  v_cvt_pk_bf16_f32 v60, v56, v57
  v_cvt_pk_bf16_f32 v61, v58, v59
  v_mul_f32 v77, v91, v77
  v_lshlrev_b32 v56, 16, v60
  v_and_b32 v57, s65, v60
  v_mul_f32 v78, v91, v78
  v_lshlrev_b32 v58, 16, v61
  v_and_b32 v59, s65, v61
  v_mul_f32 v79, v91, v79
  v_pk_mul_f32 v[56:57], v[56:57], v[66:67] op_sel:[0,1]
  v_pk_mul_f32 v[58:59], v[58:59], v[66:67] op_sel:[0,1]
  v_mul_f32 v80, v91, v80
  v_cvt_pk_bf16_f32 v134, v120, v56
  v_cvt_pk_bf16_f32 v138, v121, v57
  v_cvt_pk_bf16_f32 v142, v122, v58
  v_cvt_pk_bf16_f32 v146, v123, v59
  s_waitcnt vmcnt(6)
  buffer_load_dwordx4 v[32:35], v43, s[12:15], s60 offen offset:512 nt
  v_cvt_f32_i32 v56, v4
  v_cvt_f32_i32 v57, v5
  v_cvt_f32_i32 v58, v6
  v_cvt_f32_i32 v59, v7
  v_pk_add_f32 v[56:57], v[56:57], v[66:67] op_sel_hi:[1,0] neg_lo:[0,1] neg_hi:[0,1]
  v_pk_add_f32 v[58:59], v[58:59], v[66:67] op_sel_hi:[1,0] neg_lo:[0,1] neg_hi:[0,1]
  v_mul_f32 v81, v91, v81
  v_cvt_pk_bf16_f32 v60, v56, v57
  v_cvt_pk_bf16_f32 v61, v58, v59
  v_mul_f32 v82, v91, v82
  v_lshlrev_b32 v56, 16, v60
  v_and_b32 v57, s65, v60
  v_mul_f32 v83, v91, v83
  v_lshlrev_b32 v58, 16, v61
  v_and_b32 v59, s65, v61
  v_pk_mul_f32 v[56:57], v[56:57], v[66:67] op_sel:[0,1]
  v_pk_mul_f32 v[58:59], v[58:59], v[66:67] op_sel:[0,1]
  v_cvt_pk_bf16_f32 v150, v124, v56
  v_cvt_pk_bf16_f32 v154, v125, v57
  v_cvt_pk_bf16_f32 v158, v126, v58
  v_cvt_pk_bf16_f32 v162, v127, v59
  s_add_u32 s61, s60, 98304
  s_cmp_lg_u32 s64, 1
  s_cselect_b32 s61, s61, 805306368
  s_waitcnt vmcnt(6)
  buffer_load_dwordx4 v[4:7], v36, s[12:15], s61 offen offset:0 nt
  v_cvt_f32_i32 v56, v8
  v_cvt_f32_i32 v57, v9
  v_cvt_f32_i32 v58, v10
  v_cvt_f32_i32 v59, v11
  v_pk_add_f32 v[56:57], v[56:57], v[66:67] op_sel_hi:[1,0] neg_lo:[0,1] neg_hi:[0,1]
  v_pk_add_f32 v[58:59], v[58:59], v[66:67] op_sel_hi:[1,0] neg_lo:[0,1] neg_hi:[0,1]
  v_cvt_pk_bf16_f32 v60, v56, v57
  v_cvt_pk_bf16_f32 v61, v58, v59
  v_lshlrev_b32 v56, 16, v60
  v_and_b32 v57, s65, v60
  v_lshlrev_b32 v58, 16, v61
  v_and_b32 v59, s65, v61
  v_pk_mul_f32 v[56:57], v[56:57], v[66:67] op_sel:[0,1]
  v_pk_mul_f32 v[58:59], v[58:59], v[66:67] op_sel:[0,1]
  v_cvt_pk_bf16_f32 v166, v128, v56
  v_cvt_pk_bf16_f32 v170, v129, v57
  v_cvt_pk_bf16_f32 v174, v130, v58
  v_cvt_pk_bf16_f32 v178, v131, v59
  s_waitcnt vmcnt(6)
  buffer_load_dwordx4 v[8:11], v36, s[12:15], s61 offen offset:256 nt
  v_cvt_f32_i32 v120, v12
  v_cvt_f32_i32 v121, v13
  v_cvt_f32_i32 v122, v14
  v_cvt_f32_i32 v123, v15
  v_mov_b32_dpp v66, v64 row_newbcast:6 row_mask:0xf bank_mask:0xf
  v_mov_b32_dpp v67, v65 row_newbcast:6 row_mask:0xf bank_mask:0xf
  v_pk_add_f32 v[120:121], v[120:121], v[66:67] op_sel_hi:[1,0] neg_lo:[0,1] neg_hi:[0,1]
  v_pk_add_f32 v[122:123], v[122:123], v[66:67] op_sel_hi:[1,0] neg_lo:[0,1] neg_hi:[0,1]
  v_cvt_pk_bf16_f32 v60, v120, v121
  v_cvt_pk_bf16_f32 v61, v122, v123
  v_lshlrev_b32 v120, 16, v60
  v_and_b32 v121, s65, v60
  v_lshlrev_b32 v122, 16, v61
  v_and_b32 v123, s65, v61
  v_pk_mul_f32 v[120:121], v[120:121], v[66:67] op_sel:[0,1]
  v_pk_mul_f32 v[122:123], v[122:123], v[66:67] op_sel:[0,1]
  s_waitcnt vmcnt(6)
  buffer_load_dwordx4 v[12:15], v36, s[12:15], s61 offen offset:512 nt
  v_cvt_f32_i32 v124, v16
  v_cvt_f32_i32 v125, v17
  v_cvt_f32_i32 v126, v18
  v_cvt_f32_i32 v127, v19
  v_pk_add_f32 v[124:125], v[124:125], v[66:67] op_sel_hi:[1,0] neg_lo:[0,1] neg_hi:[0,1]
  v_pk_add_f32 v[126:127], v[126:127], v[66:67] op_sel_hi:[1,0] neg_lo:[0,1] neg_hi:[0,1]
  v_cvt_pk_bf16_f32 v60, v124, v125
  v_cvt_pk_bf16_f32 v61, v126, v127
  v_lshlrev_b32 v124, 16, v60
  v_and_b32 v125, s65, v60
  v_lshlrev_b32 v126, 16, v61
  v_and_b32 v127, s65, v61
  v_pk_mul_f32 v[124:125], v[124:125], v[66:67] op_sel:[0,1]
  v_pk_mul_f32 v[126:127], v[126:127], v[66:67] op_sel:[0,1]
  s_waitcnt vmcnt(6)
  buffer_load_dwordx4 v[16:19], v37, s[12:15], s61 offen offset:0 nt
  v_cvt_f32_i32 v128, v20
  v_cvt_f32_i32 v129, v21
  v_cvt_f32_i32 v130, v22
  v_cvt_f32_i32 v131, v23
  v_pk_add_f32 v[128:129], v[128:129], v[66:67] op_sel_hi:[1,0] neg_lo:[0,1] neg_hi:[0,1]
  v_pk_add_f32 v[130:131], v[130:131], v[66:67] op_sel_hi:[1,0] neg_lo:[0,1] neg_hi:[0,1]
  v_cvt_pk_bf16_f32 v60, v128, v129
  v_cvt_pk_bf16_f32 v61, v130, v131
  v_lshlrev_b32 v128, 16, v60
  v_and_b32 v129, s65, v60
  v_lshlrev_b32 v130, 16, v61
  v_and_b32 v131, s65, v61
  v_pk_mul_f32 v[128:129], v[128:129], v[66:67] op_sel:[0,1]
  v_pk_mul_f32 v[130:131], v[130:131], v[66:67] op_sel:[0,1]
  s_waitcnt vmcnt(6)
  buffer_load_dwordx4 v[20:23], v37, s[12:15], s61 offen offset:256 nt
  v_cvt_f32_i32 v56, v24
  v_cvt_f32_i32 v57, v25
  v_cvt_f32_i32 v58, v26
  v_cvt_f32_i32 v59, v27
  v_mov_b32_dpp v66, v64 row_newbcast:7 row_mask:0xf bank_mask:0xf
  v_mov_b32_dpp v67, v65 row_newbcast:7 row_mask:0xf bank_mask:0xf
  v_pk_add_f32 v[56:57], v[56:57], v[66:67] op_sel_hi:[1,0] neg_lo:[0,1] neg_hi:[0,1]
  v_pk_add_f32 v[58:59], v[58:59], v[66:67] op_sel_hi:[1,0] neg_lo:[0,1] neg_hi:[0,1]
  v_cvt_pk_bf16_f32 v60, v56, v57
  v_cvt_pk_bf16_f32 v61, v58, v59
  v_lshlrev_b32 v56, 16, v60
  v_and_b32 v57, s65, v60
  v_lshlrev_b32 v58, 16, v61
  v_and_b32 v59, s65, v61
  v_pk_mul_f32 v[56:57], v[56:57], v[66:67] op_sel:[0,1]
  v_pk_mul_f32 v[58:59], v[58:59], v[66:67] op_sel:[0,1]
  v_cvt_pk_bf16_f32 v135, v120, v56
  v_cvt_pk_bf16_f32 v139, v121, v57
  v_cvt_pk_bf16_f32 v143, v122, v58
  v_cvt_pk_bf16_f32 v147, v123, v59
  v_mfma_f32_16x16x32_bf16 v[72:75], v[104:107], v[132:135], v[72:75]
  v_mfma_f32_16x16x32_bf16 v[72:75], v[108:111], v[136:139], v[72:75]
  v_mfma_f32_16x16x32_bf16 v[72:75], v[112:115], v[140:143], v[72:75]
  v_mfma_f32_16x16x32_bf16 v[72:75], v[116:119], v[144:147], v[72:75]
  s_waitcnt vmcnt(6)
  buffer_load_dwordx4 v[24:27], v37, s[12:15], s61 offen offset:512 nt
  v_cvt_f32_i32 v56, v28
  v_cvt_f32_i32 v57, v29
  v_cvt_f32_i32 v58, v30
  v_cvt_f32_i32 v59, v31
  v_pk_add_f32 v[56:57], v[56:57], v[66:67] op_sel_hi:[1,0] neg_lo:[0,1] neg_hi:[0,1]
  v_pk_add_f32 v[58:59], v[58:59], v[66:67] op_sel_hi:[1,0] neg_lo:[0,1] neg_hi:[0,1]
  v_cvt_pk_bf16_f32 v60, v56, v57
  v_cvt_pk_bf16_f32 v61, v58, v59
  v_lshlrev_b32 v56, 16, v60
  v_and_b32 v57, s65, v60
  v_lshlrev_b32 v58, 16, v61
  v_and_b32 v59, s65, v61
  v_pk_mul_f32 v[56:57], v[56:57], v[66:67] op_sel:[0,1]
  v_pk_mul_f32 v[58:59], v[58:59], v[66:67] op_sel:[0,1]
  v_cvt_pk_bf16_f32 v151, v124, v56
  v_cvt_pk_bf16_f32 v155, v125, v57
  v_cvt_pk_bf16_f32 v159, v126, v58
  v_cvt_pk_bf16_f32 v163, v127, v59
  v_mfma_f32_16x16x32_bf16 v[76:79], v[104:107], v[148:151], v[76:79]
  v_mfma_f32_16x16x32_bf16 v[76:79], v[108:111], v[152:155], v[76:79]
  v_mfma_f32_16x16x32_bf16 v[76:79], v[112:115], v[156:159], v[76:79]
  v_mfma_f32_16x16x32_bf16 v[76:79], v[116:119], v[160:163], v[76:79]
  s_waitcnt vmcnt(6)
  buffer_load_dwordx4 v[28:31], v38, s[12:15], s61 offen offset:0 nt
  v_cvt_f32_i32 v56, v32
  v_cvt_f32_i32 v57, v33
  v_cvt_f32_i32 v58, v34
  v_cvt_f32_i32 v59, v35
  v_pk_add_f32 v[56:57], v[56:57], v[66:67] op_sel_hi:[1,0] neg_lo:[0,1] neg_hi:[0,1]
  v_pk_add_f32 v[58:59], v[58:59], v[66:67] op_sel_hi:[1,0] neg_lo:[0,1] neg_hi:[0,1]
  v_cvt_pk_bf16_f32 v60, v56, v57
  v_cvt_pk_bf16_f32 v61, v58, v59
  v_lshlrev_b32 v56, 16, v60
  v_and_b32 v57, s65, v60
  v_lshlrev_b32 v58, 16, v61
  v_and_b32 v59, s65, v61
  v_pk_mul_f32 v[56:57], v[56:57], v[66:67] op_sel:[0,1]
  v_pk_mul_f32 v[58:59], v[58:59], v[66:67] op_sel:[0,1]
  v_cvt_pk_bf16_f32 v167, v128, v56
  v_cvt_pk_bf16_f32 v171, v129, v57
  v_cvt_pk_bf16_f32 v175, v130, v58
  v_cvt_pk_bf16_f32 v179, v131, v59
  v_mfma_f32_16x16x32_bf16 v[80:83], v[104:107], v[164:167], v[80:83]
  v_mfma_f32_16x16x32_bf16 v[80:83], v[108:111], v[168:171], v[80:83]
  v_mfma_f32_16x16x32_bf16 v[80:83], v[112:115], v[172:175], v[80:83]
  v_mfma_f32_16x16x32_bf16 v[80:83], v[116:119], v[176:179], v[80:83]
  s_mov_b32 s60, s61
  s_sub_u32 s64, s64, 1
  s_cmp_lg_u32 s64, 0
  s_cbranch_scc1 L_v
  v_mov_b32 v89, v87
  s_nop 1
  v_permlane32_swap_b32 v87, v89
  v_add_f32 v87, v87, v89
  v_mov_b32 v89, v87
  s_nop 1
  v_permlane16_swap_b32 v87, v89
  v_add_f32 v87, v87, v89
  v_bfe_u32 v88, v0, 2, 2
  v_lshlrev_b32 v88, 3, v88
  s_lshl_b32 s70, s3, 5
  v_add_u32 v88, s70, v88
  ds_write_b64 v88, v[86:87] offset:45056
  s_mul_i32 s70, s3, 3072
  v_lshl_add_u32 v88, v0, 4, s70
  ds_write_b128 v88, v[72:75] offset:32768
  ds_write_b128 v88, v[76:79] offset:33792
  ds_write_b128 v88, v[80:83] offset:34816
  s_waitcnt lgkmcnt(0)
  s_barrier
  s_cmp_ge_u32 s3, 3
  s_cbranch_scc1 L_fin
  v_lshrrev_b32 v88, 1, v55
  ds_read_b64 v[104:105], v88 offset:45056
  ds_read_b64 v[106:107], v88 offset:45088
  ds_read_b64 v[108:109], v88 offset:45120
  ds_read_b64 v[110:111], v88 offset:45152
  s_lshl_b32 s70, s3, 10
  v_lshl_add_u32 v88, v0, 4, s70
  ds_read_b128 v[112:115], v88 offset:32768
  ds_read_b128 v[116:119], v88 offset:35840
  ds_read_b128 v[120:123], v88 offset:38912
  ds_read_b128 v[124:127], v88 offset:41984
  s_waitcnt lgkmcnt(0)
  v_min_f32 v88, v104, v106
  v_min_f32 v88, v88, v108
  v_min_f32 v88, v88, v110
  v_sub_f32 v104, v88, v104
  v_sub_f32 v106, v88, v106
  v_sub_f32 v108, v88, v108
  v_sub_f32 v110, v88, v110
  v_exp_f32 v104, v104
  v_exp_f32 v106, v106
  v_exp_f32 v108, v108
  v_exp_f32 v110, v110
  v_mul_f32 v89, v104, v105
  v_fma_f32 v89, v106, v107, v89
  v_fma_f32 v89, v108, v109, v89
  v_fma_f32 v89, v110, v111, v89
  v_rcp_f32 v89, v89
  v_mul_f32 v56, v104, v112
  v_fma_f32 v56, v106, v116, v56
  v_fma_f32 v56, v108, v120, v56
  v_fma_f32 v56, v110, v124, v56
  v_mul_f32 v57, v104, v113
  v_fma_f32 v57, v106, v117, v57
  v_fma_f32 v57, v108, v121, v57
  v_fma_f32 v57, v110, v125, v57
  v_mul_f32 v58, v104, v114
  v_fma_f32 v58, v106, v118, v58
  v_fma_f32 v58, v108, v122, v58
  v_fma_f32 v58, v110, v126, v58
  v_mul_f32 v59, v104, v115
  v_fma_f32 v59, v106, v119, v59
  v_fma_f32 v59, v108, v123, v59
  v_fma_f32 v59, v110, v127, v59
  v_mul_f32 v56, v89, v56
  v_mul_f32 v57, v89, v57
  v_mul_f32 v58, v89, v58
  v_mul_f32 v59, v89, v59
  v_cvt_pk_bf16_f32 v56, v56, v57
  v_cvt_pk_bf16_f32 v57, v58, v59
  v_mul_u32_u24 v88, 24, v55
  v_and_b32 v89, 15, v0
  v_lshl_add_u32 v88, v89, 3, v88
  s_mul_i32 s70, s2, 1536
  s_lshl_b32 s71, s3, 7
  s_add_u32 s70, s70, s71
  buffer_store_dwordx2 v[56:57], v88, s[40:43], s70 offen
L_fin:
L_end:
  s_endpgm
.section .rodata,"a"
.p2align 6
.amdhsa_kernel standalone__kv_cache_quant_int4_int2_kv_with_per_channel_or_per_token_scales__sampling_kernel
  .amdhsa_next_free_vgpr 184
  .amdhsa_next_free_sgpr 96
  .amdhsa_accum_offset 184
  .amdhsa_group_segment_fixed_size 0
  .amdhsa_kernarg_size 80
  .amdhsa_user_sgpr_count 2
  .amdhsa_user_sgpr_kernarg_segment_ptr 1
  .amdhsa_system_sgpr_workgroup_id_x 1
  .amdhsa_float_denorm_mode_32 3
.end_amdhsa_kernel
```

```asm
; @launch kernel=standalone__kv_cache_quant_int4_int2_kv_with_per_channel_or_per_token_scales__sampling_kernel grid=(256,1,1) block=(256,1,1) lds=87040
; @launch kernel=merge_partials_kernel grid=(256,1,1) block=(64,1,1) lds=0
.amdgcn_target "amdgcn-amd-amdhsa--gfx950"
.text
.globl standalone__kv_cache_quant_int4_int2_kv_with_per_channel_or_per_token_scales__sampling_kernel
.p2align 8
.type standalone__kv_cache_quant_int4_int2_kv_with_per_channel_or_per_token_scales__sampling_kernel,@function
standalone__kv_cache_quant_int4_int2_kv_with_per_channel_or_per_token_scales__sampling_kernel:
  s_cmp_ge_u32 s2, 256
  s_cbranch_scc1 L_end
  s_load_dwordx16 s[44:59], s[0:1], 0
  s_load_dwordx2 s[84:85], s[0:1], 72
  v_lshrrev_b32 v1, 6, v0
  v_and_b32 v0, 63, v0
  v_readfirstlane_b32 s3, v1
  v_and_b32 v60, 3, v0
  v_bfe_u32 v61, v0, 2, 2
  v_lshrrev_b32 v62, 4, v0
  v_and_b32 v63, 15, v0
  v_lshlrev_b32 v92, 4, v60
  v_lshl_add_u32 v92, v62, 6, v92
  v_lshrrev_b32 v52, 1, v92
  v_mul_u32_u24 v93, 6144, v61
  v_add_u32 v36, v92, v93
  v_mul_u32_u24 v93, 6144, v62
  v_lshl_add_u32 v44, v63, 4, v93
  v_add_u32 v37, 768, v36
  v_add_u32 v45, 768, v44
  v_add_u32 v38, 1536, v36
  v_add_u32 v46, 1536, v44
  v_add_u32 v39, 2304, v36
  v_add_u32 v47, 2304, v44
  v_add_u32 v40, 3072, v36
  v_add_u32 v48, 3072, v44
  v_add_u32 v41, 3840, v36
  v_add_u32 v49, 3840, v44
  v_add_u32 v42, 4608, v36
  v_add_u32 v50, 4608, v44
  v_add_u32 v43, 5376, v36
  v_add_u32 v51, 5376, v44
  v_and_b32 v93, 7, v0
  v_mul_u32_u24 v93, 2, v93
  v_mul_u32_u24 v54, 16, v62
  v_add_u32 v54, v54, v93
  v_mul_u32_u24 v93, 384, v61
  v_add_u32 v53, v93, v52
  v_lshlrev_b32 v56, 4, v62
  v_lshrrev_b32 v55, 2, v0
  v_lshlrev_b32 v55, 4, v55
  s_mul_i32 s70, s3, 8192
  v_add_u32 v55, s70, v55
  s_mul_i32 s70, s3, 3072
  s_add_u32 s70, s70, 32768
  v_lshl_add_u32 v57, v0, 4, s70
  s_lshl_b32 s70, s3, 5
  s_add_u32 s70, s70, 45056
  v_lshl_add_u32 v58, v61, 3, s70
  v_mov_b32 v66, 0
  v_mov_b32 v67, 0
  s_mov_b32 s65, 0xffff0000
  s_mov_b32 s66, 0x3fb8aa3b
  s_mov_b32 s68, 0x3d93cd3a
  s_mov_b32 s69, 0x3d93cd3a
  s_mov_b32 s72, 0x11111111
  s_mov_b32 s73, 0x11111111
  s_mov_b32 s74, 0x22222222
  s_mov_b32 s75, 0x22222222
  s_mov_b32 s76, 0x44444444
  s_mov_b32 s77, 0x44444444
  s_mov_b32 s78, 0x88888888
  s_mov_b32 s79, 0x88888888
  s_mov_b32 s71, 0xaaaaaaab
  s_lshl_b32 s70, s2, 7
  s_add_u32 s70, s70, 1
  s_mul_hi_u32 s90, s70, s71
  s_lshr_b32 s90, s90, 1
  s_lshl_b32 s70, s2, 7
  s_add_u32 s70, s70, 129
  s_mul_hi_u32 s88, s70, s71
  s_lshr_b32 s88, s88, 1
  s_sub_u32 s88, s88, s90
  s_lshl_b32 s70, s2, 7
  s_add_u32 s70, s70, 32769
  s_mul_hi_u32 s91, s70, s71
  s_lshr_b32 s91, s91, 1
  s_lshl_b32 s70, s2, 7
  s_add_u32 s70, s70, 32897
  s_mul_hi_u32 s89, s70, s71
  s_lshr_b32 s89, s89, 1
  s_sub_u32 s89, s89, s91
  s_add_u32 s89, s89, s88
  s_lshl_b32 s70, s2, 7
  s_add_u32 s70, s70, 65537
  s_mul_hi_u32 s92, s70, s71
  s_lshr_b32 s92, s92, 1
  s_sub_u32 s91, s91, s88
  s_sub_u32 s92, s92, s89
  s_mov_b32 s64, s3
  s_add_u32 s95, s90, s3
  s_mul_i32 s60, s95, 24576
  s_mov_b32 s67, s60
  s_lshr_b32 s70, s95, 1
  s_mul_i32 s62, s70, 384
  s_lshl_b32 s63, s95, 6
  s_lshr_b32 s93, s95, 7
  s_mul_i32 s70, s93, 1536
  s_waitcnt lgkmcnt(0)
  s_mov_b32 s36, s44
  s_and_b32 s37, s45, 0xffff
  s_mov_b32 s38, 393216
  s_mov_b32 s39, 0x20000
  s_mov_b32 s8, s46
  s_and_b32 s9, s47, 0xffff
  s_mov_b32 s10, 805306368
  s_mov_b32 s11, 0x20000
  s_mov_b32 s16, s46
  s_and_b32 s17, s47, 0xffff
  s_mov_b32 s18, 805306368
  s_mov_b32 s19, 0x20000
  s_mov_b32 s12, s48
  s_and_b32 s13, s49, 0xffff
  s_mov_b32 s14, 805306368
  s_mov_b32 s15, 0x20000
  s_mov_b32 s20, s50
  s_and_b32 s21, s51, 0xffff
  s_mov_b32 s22, 6291456
  s_mov_b32 s23, 0x20000
  s_mov_b32 s24, s52
  s_and_b32 s25, s53, 0xffff
  s_mov_b32 s26, 6291456
  s_mov_b32 s27, 0x20000
  s_mov_b32 s28, s54
  s_and_b32 s29, s55, 0xffff
  s_mov_b32 s30, 2097152
  s_mov_b32 s31, 0x20000
  s_mov_b32 s32, s56
  s_and_b32 s33, s57, 0xffff
  s_mov_b32 s34, 2097152
  s_mov_b32 s35, 0x20000
  s_mov_b32 s40, s84
  s_and_b32 s41, s85, 0xffff
  s_mov_b32 s42, 3604480
  s_mov_b32 s43, 0x20000
  buffer_load_dwordx2 v[120:121], v52, s[20:23], s62 offen offset:0 nt
  buffer_load_dwordx2 v[126:127], v52, s[24:27], s62 offen offset:0 nt
  buffer_load_dwordx2 v[122:123], v52, s[20:23], s62 offen offset:128 nt
  buffer_load_dwordx2 v[128:129], v52, s[24:27], s62 offen offset:128 nt
  buffer_load_dwordx2 v[124:125], v52, s[20:23], s62 offen offset:256 nt
  buffer_load_dwordx2 v[130:131], v52, s[24:27], s62 offen offset:256 nt
  buffer_load_dwordx2 v[114:115], v53, s[36:39], s70 offen offset:0 nt
  buffer_load_dwordx2 v[116:117], v53, s[36:39], s70 offen offset:128 nt
  buffer_load_dwordx2 v[118:119], v53, s[36:39], s70 offen offset:256 nt
  buffer_load_short_d16_hi v66, v54, s[32:35], s63 offen nt
  buffer_load_short_d16_hi v67, v54, s[28:31], s63 offen nt
  buffer_load_dwordx4 v[4:7], v36, s[8:11], s60 offen offset:0 nt
  buffer_load_dwordx4 v[8:11], v36, s[8:11], s60 offen offset:256 nt
  buffer_load_dwordx4 v[12:15], v36, s[8:11], s60 offen offset:512 nt
  buffer_load_dwordx4 v[16:19], v37, s[8:11], s60 offen offset:0 nt
  buffer_load_dwordx4 v[20:23], v37, s[8:11], s60 offen offset:256 nt
  buffer_load_dwordx4 v[24:27], v37, s[8:11], s60 offen offset:512 nt
  v_mov_b32 v76, 0
  v_mov_b32 v77, 0
  v_mov_b32 v78, 0
  v_mov_b32 v79, 0
  v_mov_b32 v80, 0
  v_mov_b32 v81, 0
  v_mov_b32 v82, 0
  v_mov_b32 v83, 0
  v_mov_b32 v84, 0
  v_mov_b32 v85, 0
  v_mov_b32 v86, 0
  v_mov_b32 v87, 0
  v_mov_b32 v88, 0xff800000
  v_mov_b32 v90, 0x7f800000
  v_mov_b32 v91, 0
L_k:
  s_add_u32 s64, s64, 4
  s_cmp_ge_u32 s64, s88
  s_cselect_b32 s70, s91, s90
  s_cmp_ge_u32 s64, s89
  s_cselect_b32 s70, s92, s70
  s_add_u32 s95, s64, s70
  s_mul_i32 s61, s95, 24576
  s_lshr_b32 s94, s95, 7
  s_waitcnt vmcnt(5)
  buffer_load_dwordx4 v[28:31], v38, s[8:11], s60 offen offset:0 nt
  v_cvt_f32_i32 v60, v4
  v_cvt_f32_i32 v61, v5
  v_cvt_f32_i32 v62, v6
  v_cvt_f32_i32 v63, v7
  v_lshlrev_b32 v144, 16, v126
  v_and_b32 v145, s65, v126
  v_lshlrev_b32 v146, 16, v127
  v_and_b32 v147, s65, v127
  v_lshlrev_b32 v132, 16, v120
  v_and_b32 v133, s65, v120
  v_lshlrev_b32 v134, 16, v121
  v_and_b32 v135, s65, v121
  v_mov_b32 v108, v114
  v_mov_b32 v109, v115
  v_pk_add_f32 v[60:61], v[60:61], v[144:145] neg_lo:[0,1] neg_hi:[0,1]
  v_pk_add_f32 v[62:63], v[62:63], v[146:147] neg_lo:[0,1] neg_hi:[0,1]
  v_cvt_pk_bf16_f32 v64, v60, v61
  v_cvt_pk_bf16_f32 v65, v62, v63
  v_lshlrev_b32 v60, 16, v64
  v_and_b32 v61, s65, v64
  v_lshlrev_b32 v62, 16, v65
  v_and_b32 v63, s65, v65
  v_pk_mul_f32 v[60:61], v[60:61], v[132:133]
  v_pk_mul_f32 v[62:63], v[62:63], v[134:135]
  v_cvt_pk_bf16_f32 v156, v60, v61
  v_cvt_pk_bf16_f32 v157, v62, v63
  s_waitcnt vmcnt(5)
  buffer_load_dwordx4 v[32:35], v38, s[8:11], s60 offen offset:256 nt
  v_cvt_f32_i32 v60, v8
  v_cvt_f32_i32 v61, v9
  v_cvt_f32_i32 v62, v10
  v_cvt_f32_i32 v63, v11
  v_lshlrev_b32 v148, 16, v128
  v_and_b32 v149, s65, v128
  v_lshlrev_b32 v150, 16, v129
  v_and_b32 v151, s65, v129
  v_lshlrev_b32 v136, 16, v122
  v_and_b32 v137, s65, v122
  v_lshlrev_b32 v138, 16, v123
  v_and_b32 v139, s65, v123
  v_mov_b32 v110, v116
  v_mov_b32 v111, v117
  v_pk_add_f32 v[60:61], v[60:61], v[148:149] neg_lo:[0,1] neg_hi:[0,1]
  v_pk_add_f32 v[62:63], v[62:63], v[150:151] neg_lo:[0,1] neg_hi:[0,1]
  v_cvt_pk_bf16_f32 v64, v60, v61
  v_cvt_pk_bf16_f32 v65, v62, v63
  v_lshlrev_b32 v60, 16, v64
  v_and_b32 v61, s65, v64
  v_lshlrev_b32 v62, 16, v65
  v_and_b32 v63, s65, v65
  v_pk_mul_f32 v[60:61], v[60:61], v[136:137]
  v_pk_mul_f32 v[62:63], v[62:63], v[138:139]
  v_cvt_pk_bf16_f32 v158, v60, v61
  v_cvt_pk_bf16_f32 v159, v62, v63
  s_nop 1
  v_mfma_f32_16x16x32_bf16 v[164:167], v[156:159], v[108:111], 0
  s_waitcnt vmcnt(5)
  buffer_load_dwordx4 v[4:7], v38, s[8:11], s60 offen offset:512 nt
  v_cvt_f32_i32 v60, v12
  v_cvt_f32_i32 v61, v13
  v_cvt_f32_i32 v62, v14
  v_cvt_f32_i32 v63, v15
  v_lshlrev_b32 v152, 16, v130
  v_and_b32 v153, s65, v130
  v_lshlrev_b32 v154, 16, v131
  v_and_b32 v155, s65, v131
  v_lshlrev_b32 v140, 16, v124
  v_and_b32 v141, s65, v124
  v_lshlrev_b32 v142, 16, v125
  v_and_b32 v143, s65, v125
  v_mov_b32 v112, v118
  v_mov_b32 v113, v119
  v_pk_add_f32 v[60:61], v[60:61], v[152:153] neg_lo:[0,1] neg_hi:[0,1]
  v_pk_add_f32 v[62:63], v[62:63], v[154:155] neg_lo:[0,1] neg_hi:[0,1]
  v_cvt_pk_bf16_f32 v64, v60, v61
  v_cvt_pk_bf16_f32 v65, v62, v63
  v_lshlrev_b32 v60, 16, v64
  v_and_b32 v61, s65, v64
  v_lshlrev_b32 v62, 16, v65
  v_and_b32 v63, s65, v65
  v_pk_mul_f32 v[60:61], v[60:61], v[140:141]
  v_pk_mul_f32 v[62:63], v[62:63], v[142:143]
  v_cvt_pk_bf16_f32 v160, v60, v61
  v_cvt_pk_bf16_f32 v161, v62, v63
  s_nop 1
  v_mfma_f32_16x16x16_bf16 v[164:167], v[160:161], v[112:113], v[164:167]
  s_waitcnt vmcnt(5)
  buffer_load_dwordx4 v[8:11], v39, s[8:11], s60 offen offset:0 nt
  v_cvt_f32_i32 v60, v16
  v_cvt_f32_i32 v61, v17
  v_cvt_f32_i32 v62, v18
  v_cvt_f32_i32 v63, v19
  s_cmp_eq_u32 s94, s93
  s_cbranch_scc1 L_k_sameq
  s_mul_i32 s70, s94, 1536
  buffer_load_dwordx2 v[114:115], v53, s[36:39], s70 offen offset:0 nt
  buffer_load_dwordx2 v[116:117], v53, s[36:39], s70 offen offset:128 nt
  buffer_load_dwordx2 v[118:119], v53, s[36:39], s70 offen offset:256 nt
  s_mov_b32 s93, s94
L_k_sameq:
  s_lshr_b32 s70, s95, 1
  s_mul_i32 s62, s70, 384
  buffer_load_dwordx2 v[120:121], v52, s[20:23], s62 offen offset:0 nt
  buffer_load_dwordx2 v[126:127], v52, s[24:27], s62 offen offset:0 nt
  buffer_load_dwordx2 v[122:123], v52, s[20:23], s62 offen offset:128 nt
  buffer_load_dwordx2 v[128:129], v52, s[24:27], s62 offen offset:128 nt
  buffer_load_dwordx2 v[124:125], v52, s[20:23], s62 offen offset:256 nt
  buffer_load_dwordx2 v[130:131], v52, s[24:27], s62 offen offset:256 nt
  v_pk_add_f32 v[60:61], v[60:61], v[144:145] neg_lo:[0,1] neg_hi:[0,1]
  v_pk_add_f32 v[62:63], v[62:63], v[146:147] neg_lo:[0,1] neg_hi:[0,1]
  v_cvt_pk_bf16_f32 v64, v60, v61
  v_cvt_pk_bf16_f32 v65, v62, v63
  v_mov_b32_dpp v92, v164 quad_perm:[0,0,0,0] row_mask:0xf bank_mask:0xf
  v_lshlrev_b32 v60, 16, v64
  v_and_b32 v61, s65, v64
  v_mov_b32_dpp v93, v166 quad_perm:[2,2,2,2] row_mask:0xf bank_mask:0xf
  v_lshlrev_b32 v62, 16, v65
  v_and_b32 v63, s65, v65
  v_add_f32_dpp v92, v165, v92 quad_perm:[1,1,1,1] row_mask:0xf bank_mask:0xf
  v_pk_mul_f32 v[60:61], v[60:61], v[132:133]
  v_pk_mul_f32 v[62:63], v[62:63], v[134:135]
  v_add_f32_dpp v93, v167, v93 quad_perm:[3,3,3,3] row_mask:0xf bank_mask:0xf
  v_cvt_pk_bf16_f32 v156, v60, v61
  v_cvt_pk_bf16_f32 v157, v62, v63
  v_add_f32 v168, v92, v93
  s_waitcnt vmcnt(11)
  buffer_load_dwordx4 v[12:15], v39, s[8:11], s60 offen offset:256 nt
  v_cvt_f32_i32 v60, v20
  v_cvt_f32_i32 v61, v21
  v_cvt_f32_i32 v62, v22
  v_cvt_f32_i32 v63, v23
  v_pk_add_f32 v[60:61], v[60:61], v[148:149] neg_lo:[0,1] neg_hi:[0,1]
  v_pk_add_f32 v[62:63], v[62:63], v[150:151] neg_lo:[0,1] neg_hi:[0,1]
  v_cvt_pk_bf16_f32 v64, v60, v61
  v_cvt_pk_bf16_f32 v65, v62, v63
  v_lshlrev_b32 v60, 16, v64
  v_and_b32 v61, s65, v64
  v_lshlrev_b32 v62, 16, v65
  v_and_b32 v63, s65, v65
  v_pk_mul_f32 v[60:61], v[60:61], v[136:137]
  v_pk_mul_f32 v[62:63], v[62:63], v[138:139]
  v_cvt_pk_bf16_f32 v158, v60, v61
  v_cvt_pk_bf16_f32 v159, v62, v63
  s_nop 1
  v_mfma_f32_16x16x32_bf16 v[164:167], v[156:159], v[108:111], 0
  s_waitcnt vmcnt(11)
  buffer_load_dwordx4 v[16:19], v39, s[8:11], s60 offen offset:512 nt
  v_cvt_f32_i32 v60, v24
  v_cvt_f32_i32 v61, v25
  v_cvt_f32_i32 v62, v26
  v_cvt_f32_i32 v63, v27
  v_pk_add_f32 v[60:61], v[60:61], v[152:153] neg_lo:[0,1] neg_hi:[0,1]
  v_pk_add_f32 v[62:63], v[62:63], v[154:155] neg_lo:[0,1] neg_hi:[0,1]
  v_cvt_pk_bf16_f32 v64, v60, v61
  v_cvt_pk_bf16_f32 v65, v62, v63
  v_lshlrev_b32 v60, 16, v64
  v_and_b32 v61, s65, v64
  v_lshlrev_b32 v62, 16, v65
  v_and_b32 v63, s65, v65
  v_pk_mul_f32 v[60:61], v[60:61], v[140:141]
  v_pk_mul_f32 v[62:63], v[62:63], v[142:143]
  v_cvt_pk_bf16_f32 v160, v60, v61
  v_cvt_pk_bf16_f32 v161, v62, v63
  s_nop 1
  v_mfma_f32_16x16x16_bf16 v[164:167], v[160:161], v[112:113], v[164:167]
  s_waitcnt vmcnt(11)
  buffer_load_dwordx4 v[20:23], v40, s[8:11], s60 offen offset:0 nt
  v_cvt_f32_i32 v60, v28
  v_cvt_f32_i32 v61, v29
  v_cvt_f32_i32 v62, v30
  v_cvt_f32_i32 v63, v31
  v_pk_add_f32 v[60:61], v[60:61], v[144:145] neg_lo:[0,1] neg_hi:[0,1]
  v_pk_add_f32 v[62:63], v[62:63], v[146:147] neg_lo:[0,1] neg_hi:[0,1]
  v_cvt_pk_bf16_f32 v64, v60, v61
  v_cvt_pk_bf16_f32 v65, v62, v63
  v_mov_b32_dpp v92, v164 quad_perm:[0,0,0,0] row_mask:0xf bank_mask:0xf
  v_lshlrev_b32 v60, 16, v64
  v_and_b32 v61, s65, v64
  v_mov_b32_dpp v93, v166 quad_perm:[2,2,2,2] row_mask:0xf bank_mask:0xf
  v_lshlrev_b32 v62, 16, v65
  v_and_b32 v63, s65, v65
  v_add_f32_dpp v92, v165, v92 quad_perm:[1,1,1,1] row_mask:0xf bank_mask:0xf
  v_pk_mul_f32 v[60:61], v[60:61], v[132:133]
  v_pk_mul_f32 v[62:63], v[62:63], v[134:135]
  v_add_f32_dpp v93, v167, v93 quad_perm:[3,3,3,3] row_mask:0xf bank_mask:0xf
  v_cvt_pk_bf16_f32 v156, v60, v61
  v_cvt_pk_bf16_f32 v157, v62, v63
  v_add_f32 v169, v92, v93
  s_waitcnt vmcnt(11)
  buffer_load_dwordx4 v[24:27], v40, s[8:11], s60 offen offset:256 nt
  v_cvt_f32_i32 v60, v32
  v_cvt_f32_i32 v61, v33
  v_cvt_f32_i32 v62, v34
  v_cvt_f32_i32 v63, v35
  v_pk_add_f32 v[60:61], v[60:61], v[148:149] neg_lo:[0,1] neg_hi:[0,1]
  v_pk_add_f32 v[62:63], v[62:63], v[150:151] neg_lo:[0,1] neg_hi:[0,1]
  v_cvt_pk_bf16_f32 v92, v168, v169
  v_cvt_pk_bf16_f32 v64, v60, v61
  v_cvt_pk_bf16_f32 v65, v62, v63
  v_lshlrev_b32 v168, 16, v92
  v_lshlrev_b32 v60, 16, v64
  v_and_b32 v61, s65, v64
  v_and_b32 v169, s65, v92
  v_lshlrev_b32 v62, 16, v65
  v_and_b32 v63, s65, v65
  v_pk_mul_f32 v[168:169], v[168:169], s[68:69]
  v_pk_mul_f32 v[60:61], v[60:61], v[136:137]
  v_pk_mul_f32 v[62:63], v[62:63], v[138:139]
  v_cvt_pk_bf16_f32 v72, v168, v169
  v_cvt_pk_bf16_f32 v158, v60, v61
  v_cvt_pk_bf16_f32 v159, v62, v63
  s_nop 1
  v_mfma_f32_16x16x32_bf16 v[164:167], v[156:159], v[108:111], 0
  s_waitcnt vmcnt(11)
  buffer_load_dwordx4 v[28:31], v40, s[8:11], s60 offen offset:512 nt
  v_cvt_f32_i32 v60, v4
  v_cvt_f32_i32 v61, v5
  v_cvt_f32_i32 v62, v6
  v_cvt_f32_i32 v63, v7
  v_pk_add_f32 v[60:61], v[60:61], v[152:153] neg_lo:[0,1] neg_hi:[0,1]
  v_pk_add_f32 v[62:63], v[62:63], v[154:155] neg_lo:[0,1] neg_hi:[0,1]
  v_cvt_pk_bf16_f32 v64, v60, v61
  v_cvt_pk_bf16_f32 v65, v62, v63
  v_lshlrev_b32 v60, 16, v64
  v_and_b32 v61, s65, v64
  v_lshlrev_b32 v62, 16, v65
  v_and_b32 v63, s65, v65
  v_pk_mul_f32 v[60:61], v[60:61], v[140:141]
  v_pk_mul_f32 v[62:63], v[62:63], v[142:143]
  v_cvt_pk_bf16_f32 v160, v60, v61
  v_cvt_pk_bf16_f32 v161, v62, v63
  s_nop 1
  v_mfma_f32_16x16x16_bf16 v[164:167], v[160:161], v[112:113], v[164:167]
  s_waitcnt vmcnt(11)
  buffer_load_dwordx4 v[32:35], v41, s[8:11], s60 offen offset:0 nt
  v_cvt_f32_i32 v60, v8
  v_cvt_f32_i32 v61, v9
  v_cvt_f32_i32 v62, v10
  v_cvt_f32_i32 v63, v11
  v_pk_add_f32 v[60:61], v[60:61], v[144:145] neg_lo:[0,1] neg_hi:[0,1]
  v_pk_add_f32 v[62:63], v[62:63], v[146:147] neg_lo:[0,1] neg_hi:[0,1]
  v_cvt_pk_bf16_f32 v64, v60, v61
  v_cvt_pk_bf16_f32 v65, v62, v63
  v_mov_b32_dpp v92, v164 quad_perm:[0,0,0,0] row_mask:0xf bank_mask:0xf
  v_lshlrev_b32 v60, 16, v64
  v_and_b32 v61, s65, v64
  v_mov_b32_dpp v93, v166 quad_perm:[2,2,2,2] row_mask:0xf bank_mask:0xf
  v_lshlrev_b32 v62, 16, v65
  v_and_b32 v63, s65, v65
  v_add_f32_dpp v92, v165, v92 quad_perm:[1,1,1,1] row_mask:0xf bank_mask:0xf
  v_pk_mul_f32 v[60:61], v[60:61], v[132:133]
  v_pk_mul_f32 v[62:63], v[62:63], v[134:135]
  v_add_f32_dpp v93, v167, v93 quad_perm:[3,3,3,3] row_mask:0xf bank_mask:0xf
  v_cvt_pk_bf16_f32 v156, v60, v61
  v_cvt_pk_bf16_f32 v157, v62, v63
  v_add_f32 v168, v92, v93
  s_waitcnt vmcnt(5)
  buffer_load_dwordx4 v[4:7], v41, s[8:11], s60 offen offset:256 nt
  v_cvt_f32_i32 v60, v12
  v_cvt_f32_i32 v61, v13
  v_cvt_f32_i32 v62, v14
  v_cvt_f32_i32 v63, v15
  v_pk_add_f32 v[60:61], v[60:61], v[148:149] neg_lo:[0,1] neg_hi:[0,1]
  v_pk_add_f32 v[62:63], v[62:63], v[150:151] neg_lo:[0,1] neg_hi:[0,1]
  v_cvt_pk_bf16_f32 v64, v60, v61
  v_cvt_pk_bf16_f32 v65, v62, v63
  v_lshlrev_b32 v60, 16, v64
  v_and_b32 v61, s65, v64
  v_lshlrev_b32 v62, 16, v65
  v_and_b32 v63, s65, v65
  v_pk_mul_f32 v[60:61], v[60:61], v[136:137]
  v_pk_mul_f32 v[62:63], v[62:63], v[138:139]
  v_cvt_pk_bf16_f32 v158, v60, v61
  v_cvt_pk_bf16_f32 v159, v62, v63
  s_nop 1
  v_mfma_f32_16x16x32_bf16 v[164:167], v[156:159], v[108:111], 0
  s_waitcnt vmcnt(5)
  buffer_load_dwordx4 v[8:11], v41, s[8:11], s60 offen offset:512 nt
  v_cvt_f32_i32 v60, v16
  v_cvt_f32_i32 v61, v17
  v_cvt_f32_i32 v62, v18
  v_cvt_f32_i32 v63, v19
  v_pk_add_f32 v[60:61], v[60:61], v[152:153] neg_lo:[0,1] neg_hi:[0,1]
  v_pk_add_f32 v[62:63], v[62:63], v[154:155] neg_lo:[0,1] neg_hi:[0,1]
  v_cvt_pk_bf16_f32 v64, v60, v61
  v_cvt_pk_bf16_f32 v65, v62, v63
  v_lshlrev_b32 v60, 16, v64
  v_and_b32 v61, s65, v64
  v_lshlrev_b32 v62, 16, v65
  v_and_b32 v63, s65, v65
  v_pk_mul_f32 v[60:61], v[60:61], v[140:141]
  v_pk_mul_f32 v[62:63], v[62:63], v[142:143]
  v_cvt_pk_bf16_f32 v160, v60, v61
  v_cvt_pk_bf16_f32 v161, v62, v63
  s_nop 1
  v_mfma_f32_16x16x16_bf16 v[164:167], v[160:161], v[112:113], v[164:167]
  s_waitcnt vmcnt(5)
  buffer_load_dwordx4 v[12:15], v42, s[8:11], s60 offen offset:0 nt
  v_cvt_f32_i32 v60, v20
  v_cvt_f32_i32 v61, v21
  v_cvt_f32_i32 v62, v22
  v_cvt_f32_i32 v63, v23
  v_pk_add_f32 v[60:61], v[60:61], v[144:145] neg_lo:[0,1] neg_hi:[0,1]
  v_pk_add_f32 v[62:63], v[62:63], v[146:147] neg_lo:[0,1] neg_hi:[0,1]
  v_cvt_pk_bf16_f32 v64, v60, v61
  v_cvt_pk_bf16_f32 v65, v62, v63
  v_mov_b32_dpp v92, v164 quad_perm:[0,0,0,0] row_mask:0xf bank_mask:0xf
  v_lshlrev_b32 v60, 16, v64
  v_and_b32 v61, s65, v64
  v_mov_b32_dpp v93, v166 quad_perm:[2,2,2,2] row_mask:0xf bank_mask:0xf
  v_lshlrev_b32 v62, 16, v65
  v_and_b32 v63, s65, v65
  v_add_f32_dpp v92, v165, v92 quad_perm:[1,1,1,1] row_mask:0xf bank_mask:0xf
  v_pk_mul_f32 v[60:61], v[60:61], v[132:133]
  v_pk_mul_f32 v[62:63], v[62:63], v[134:135]
  v_add_f32_dpp v93, v167, v93 quad_perm:[3,3,3,3] row_mask:0xf bank_mask:0xf
  v_cvt_pk_bf16_f32 v156, v60, v61
  v_cvt_pk_bf16_f32 v157, v62, v63
  v_add_f32 v169, v92, v93
  s_waitcnt vmcnt(5)
  buffer_load_dwordx4 v[16:19], v42, s[8:11], s60 offen offset:256 nt
  v_cvt_f32_i32 v60, v24
  v_cvt_f32_i32 v61, v25
  v_cvt_f32_i32 v62, v26
  v_cvt_f32_i32 v63, v27
  v_pk_add_f32 v[60:61], v[60:61], v[148:149] neg_lo:[0,1] neg_hi:[0,1]
  v_pk_add_f32 v[62:63], v[62:63], v[150:151] neg_lo:[0,1] neg_hi:[0,1]
  v_cvt_pk_bf16_f32 v92, v168, v169
  v_cvt_pk_bf16_f32 v64, v60, v61
  v_cvt_pk_bf16_f32 v65, v62, v63
  v_lshlrev_b32 v168, 16, v92
  v_lshlrev_b32 v60, 16, v64
  v_and_b32 v61, s65, v64
  v_and_b32 v169, s65, v92
  v_lshlrev_b32 v62, 16, v65
  v_and_b32 v63, s65, v65
  v_pk_mul_f32 v[168:169], v[168:169], s[68:69]
  v_pk_mul_f32 v[60:61], v[60:61], v[136:137]
  v_pk_mul_f32 v[62:63], v[62:63], v[138:139]
  v_cvt_pk_bf16_f32 v73, v168, v169
  v_cvt_pk_bf16_f32 v158, v60, v61
  v_cvt_pk_bf16_f32 v159, v62, v63
  s_nop 1
  v_mfma_f32_16x16x32_bf16 v[164:167], v[156:159], v[108:111], 0
  s_waitcnt vmcnt(5)
  buffer_load_dwordx4 v[20:23], v42, s[8:11], s60 offen offset:512 nt
  v_cvt_f32_i32 v60, v28
  v_cvt_f32_i32 v61, v29
  v_cvt_f32_i32 v62, v30
  v_cvt_f32_i32 v63, v31
  v_pk_add_f32 v[60:61], v[60:61], v[152:153] neg_lo:[0,1] neg_hi:[0,1]
  v_pk_add_f32 v[62:63], v[62:63], v[154:155] neg_lo:[0,1] neg_hi:[0,1]
  v_cvt_pk_bf16_f32 v64, v60, v61
  v_cvt_pk_bf16_f32 v65, v62, v63
  v_lshlrev_b32 v60, 16, v64
  v_and_b32 v61, s65, v64
  v_lshlrev_b32 v62, 16, v65
  v_and_b32 v63, s65, v65
  v_pk_mul_f32 v[60:61], v[60:61], v[140:141]
  v_pk_mul_f32 v[62:63], v[62:63], v[142:143]
  v_cvt_pk_bf16_f32 v160, v60, v61
  v_cvt_pk_bf16_f32 v161, v62, v63
  s_nop 1
  v_mfma_f32_16x16x16_bf16 v[164:167], v[160:161], v[112:113], v[164:167]
  s_waitcnt vmcnt(5)
  buffer_load_dwordx4 v[24:27], v43, s[8:11], s60 offen offset:0 nt
  v_cvt_f32_i32 v60, v32
  v_cvt_f32_i32 v61, v33
  v_cvt_f32_i32 v62, v34
  v_cvt_f32_i32 v63, v35
  v_pk_add_f32 v[60:61], v[60:61], v[144:145] neg_lo:[0,1] neg_hi:[0,1]
  v_pk_add_f32 v[62:63], v[62:63], v[146:147] neg_lo:[0,1] neg_hi:[0,1]
  v_cvt_pk_bf16_f32 v64, v60, v61
  v_cvt_pk_bf16_f32 v65, v62, v63
  v_mov_b32_dpp v92, v164 quad_perm:[0,0,0,0] row_mask:0xf bank_mask:0xf
  v_lshlrev_b32 v60, 16, v64
  v_and_b32 v61, s65, v64
  v_mov_b32_dpp v93, v166 quad_perm:[2,2,2,2] row_mask:0xf bank_mask:0xf
  v_lshlrev_b32 v62, 16, v65
  v_and_b32 v63, s65, v65
  v_add_f32_dpp v92, v165, v92 quad_perm:[1,1,1,1] row_mask:0xf bank_mask:0xf
  v_pk_mul_f32 v[60:61], v[60:61], v[132:133]
  v_pk_mul_f32 v[62:63], v[62:63], v[134:135]
  v_add_f32_dpp v93, v167, v93 quad_perm:[3,3,3,3] row_mask:0xf bank_mask:0xf
  v_cvt_pk_bf16_f32 v156, v60, v61
  v_cvt_pk_bf16_f32 v157, v62, v63
  v_add_f32 v168, v92, v93
  s_waitcnt vmcnt(5)
  buffer_load_dwordx4 v[28:31], v43, s[8:11], s60 offen offset:256 nt
  v_cvt_f32_i32 v60, v4
  v_cvt_f32_i32 v61, v5
  v_cvt_f32_i32 v62, v6
  v_cvt_f32_i32 v63, v7
  v_pk_add_f32 v[60:61], v[60:61], v[148:149] neg_lo:[0,1] neg_hi:[0,1]
  v_pk_add_f32 v[62:63], v[62:63], v[150:151] neg_lo:[0,1] neg_hi:[0,1]
  v_cvt_pk_bf16_f32 v64, v60, v61
  v_cvt_pk_bf16_f32 v65, v62, v63
  v_lshlrev_b32 v60, 16, v64
  v_and_b32 v61, s65, v64
  v_lshlrev_b32 v62, 16, v65
  v_and_b32 v63, s65, v65
  v_pk_mul_f32 v[60:61], v[60:61], v[136:137]
  v_pk_mul_f32 v[62:63], v[62:63], v[138:139]
  v_cvt_pk_bf16_f32 v158, v60, v61
  v_cvt_pk_bf16_f32 v159, v62, v63
  s_nop 1
  v_mfma_f32_16x16x32_bf16 v[164:167], v[156:159], v[108:111], 0
  s_waitcnt vmcnt(5)
  buffer_load_dwordx4 v[32:35], v43, s[8:11], s60 offen offset:512 nt
  v_cvt_f32_i32 v60, v8
  v_cvt_f32_i32 v61, v9
  v_cvt_f32_i32 v62, v10
  v_cvt_f32_i32 v63, v11
  v_pk_add_f32 v[60:61], v[60:61], v[152:153] neg_lo:[0,1] neg_hi:[0,1]
  v_pk_add_f32 v[62:63], v[62:63], v[154:155] neg_lo:[0,1] neg_hi:[0,1]
  v_cvt_pk_bf16_f32 v64, v60, v61
  v_cvt_pk_bf16_f32 v65, v62, v63
  v_lshlrev_b32 v60, 16, v64
  v_and_b32 v61, s65, v64
  v_lshlrev_b32 v62, 16, v65
  v_and_b32 v63, s65, v65
  v_pk_mul_f32 v[60:61], v[60:61], v[140:141]
  v_pk_mul_f32 v[62:63], v[62:63], v[142:143]
  v_cvt_pk_bf16_f32 v160, v60, v61
  v_cvt_pk_bf16_f32 v161, v62, v63
  s_nop 1
  v_mfma_f32_16x16x16_bf16 v[164:167], v[160:161], v[112:113], v[164:167]
  s_cmp_lt_u32 s64, 128
  s_cbranch_scc1 L_k_keep
  s_mov_b32 s61, s67
  s_mov_b32 s16, s12
  s_mov_b32 s17, s13
  v_mov_b32 v36, v44
  v_mov_b32 v37, v45
  v_mov_b32 v38, v46
  v_mov_b32 v39, v47
  v_mov_b32 v40, v48
  v_mov_b32 v41, v49
  v_mov_b32 v42, v50
  v_mov_b32 v43, v51
L_k_keep:
  s_waitcnt vmcnt(5)
  buffer_load_dwordx4 v[4:7], v36, s[16:19], s61 offen offset:0 nt
  v_cvt_f32_i32 v60, v12
  v_cvt_f32_i32 v61, v13
  v_cvt_f32_i32 v62, v14
  v_cvt_f32_i32 v63, v15
  v_pk_add_f32 v[60:61], v[60:61], v[144:145] neg_lo:[0,1] neg_hi:[0,1]
  v_pk_add_f32 v[62:63], v[62:63], v[146:147] neg_lo:[0,1] neg_hi:[0,1]
  v_cvt_pk_bf16_f32 v64, v60, v61
  v_cvt_pk_bf16_f32 v65, v62, v63
  v_mov_b32_dpp v92, v164 quad_perm:[0,0,0,0] row_mask:0xf bank_mask:0xf
  v_lshlrev_b32 v60, 16, v64
  v_and_b32 v61, s65, v64
  v_mov_b32_dpp v93, v166 quad_perm:[2,2,2,2] row_mask:0xf bank_mask:0xf
  v_lshlrev_b32 v62, 16, v65
  v_and_b32 v63, s65, v65
  v_add_f32_dpp v92, v165, v92 quad_perm:[1,1,1,1] row_mask:0xf bank_mask:0xf
  v_pk_mul_f32 v[60:61], v[60:61], v[132:133]
  v_pk_mul_f32 v[62:63], v[62:63], v[134:135]
  v_add_f32_dpp v93, v167, v93 quad_perm:[3,3,3,3] row_mask:0xf bank_mask:0xf
  v_cvt_pk_bf16_f32 v156, v60, v61
  v_cvt_pk_bf16_f32 v157, v62, v63
  v_add_f32 v169, v92, v93
  s_waitcnt vmcnt(5)
  buffer_load_dwordx4 v[8:11], v36, s[16:19], s61 offen offset:256 nt
  v_cvt_f32_i32 v60, v16
  v_cvt_f32_i32 v61, v17
  v_cvt_f32_i32 v62, v18
  v_cvt_f32_i32 v63, v19
  v_pk_add_f32 v[60:61], v[60:61], v[148:149] neg_lo:[0,1] neg_hi:[0,1]
  v_pk_add_f32 v[62:63], v[62:63], v[150:151] neg_lo:[0,1] neg_hi:[0,1]
  v_cvt_pk_bf16_f32 v92, v168, v169
  v_cvt_pk_bf16_f32 v64, v60, v61
  v_cvt_pk_bf16_f32 v65, v62, v63
  v_lshlrev_b32 v168, 16, v92
  v_lshlrev_b32 v60, 16, v64
  v_and_b32 v61, s65, v64
  v_and_b32 v169, s65, v92
  v_lshlrev_b32 v62, 16, v65
  v_and_b32 v63, s65, v65
  v_pk_mul_f32 v[168:169], v[168:169], s[68:69]
  v_pk_mul_f32 v[60:61], v[60:61], v[136:137]
  v_pk_mul_f32 v[62:63], v[62:63], v[138:139]
  v_cvt_pk_bf16_f32 v74, v168, v169
  v_cvt_pk_bf16_f32 v158, v60, v61
  v_cvt_pk_bf16_f32 v159, v62, v63
  s_nop 1
  v_mfma_f32_16x16x32_bf16 v[164:167], v[156:159], v[108:111], 0
  s_waitcnt vmcnt(5)
  buffer_load_dwordx4 v[12:15], v36, s[16:19], s61 offen offset:512 nt
  v_cvt_f32_i32 v60, v20
  v_cvt_f32_i32 v61, v21
  v_cvt_f32_i32 v62, v22
  v_cvt_f32_i32 v63, v23
  v_pk_add_f32 v[60:61], v[60:61], v[152:153] neg_lo:[0,1] neg_hi:[0,1]
  v_pk_add_f32 v[62:63], v[62:63], v[154:155] neg_lo:[0,1] neg_hi:[0,1]
  v_cvt_pk_bf16_f32 v64, v60, v61
  v_cvt_pk_bf16_f32 v65, v62, v63
  v_lshlrev_b32 v60, 16, v64
  v_and_b32 v61, s65, v64
  v_lshlrev_b32 v62, 16, v65
  v_and_b32 v63, s65, v65
  v_pk_mul_f32 v[60:61], v[60:61], v[140:141]
  v_pk_mul_f32 v[62:63], v[62:63], v[142:143]
  v_cvt_pk_bf16_f32 v160, v60, v61
  v_cvt_pk_bf16_f32 v161, v62, v63
  s_nop 1
  v_mfma_f32_16x16x16_bf16 v[164:167], v[160:161], v[112:113], v[164:167]
  s_waitcnt vmcnt(5)
  buffer_load_dwordx4 v[16:19], v37, s[16:19], s61 offen offset:0 nt
  v_cvt_f32_i32 v60, v24
  v_cvt_f32_i32 v61, v25
  v_cvt_f32_i32 v62, v26
  v_cvt_f32_i32 v63, v27
  v_pk_add_f32 v[60:61], v[60:61], v[144:145] neg_lo:[0,1] neg_hi:[0,1]
  v_pk_add_f32 v[62:63], v[62:63], v[146:147] neg_lo:[0,1] neg_hi:[0,1]
  v_cvt_pk_bf16_f32 v64, v60, v61
  v_cvt_pk_bf16_f32 v65, v62, v63
  v_mov_b32_dpp v92, v164 quad_perm:[0,0,0,0] row_mask:0xf bank_mask:0xf
  v_lshlrev_b32 v60, 16, v64
  v_and_b32 v61, s65, v64
  v_mov_b32_dpp v93, v166 quad_perm:[2,2,2,2] row_mask:0xf bank_mask:0xf
  v_lshlrev_b32 v62, 16, v65
  v_and_b32 v63, s65, v65
  v_add_f32_dpp v92, v165, v92 quad_perm:[1,1,1,1] row_mask:0xf bank_mask:0xf
  v_pk_mul_f32 v[60:61], v[60:61], v[132:133]
  v_pk_mul_f32 v[62:63], v[62:63], v[134:135]
  v_add_f32_dpp v93, v167, v93 quad_perm:[3,3,3,3] row_mask:0xf bank_mask:0xf
  v_cvt_pk_bf16_f32 v156, v60, v61
  v_cvt_pk_bf16_f32 v157, v62, v63
  v_add_f32 v168, v92, v93
  s_waitcnt vmcnt(5)
  buffer_load_dwordx4 v[20:23], v37, s[16:19], s61 offen offset:256 nt
  v_cvt_f32_i32 v60, v28
  v_cvt_f32_i32 v61, v29
  v_cvt_f32_i32 v62, v30
  v_cvt_f32_i32 v63, v31
  v_pk_add_f32 v[60:61], v[60:61], v[148:149] neg_lo:[0,1] neg_hi:[0,1]
  v_pk_add_f32 v[62:63], v[62:63], v[150:151] neg_lo:[0,1] neg_hi:[0,1]
  v_cvt_pk_bf16_f32 v64, v60, v61
  v_cvt_pk_bf16_f32 v65, v62, v63
  v_lshlrev_b32 v60, 16, v64
  v_and_b32 v61, s65, v64
  v_lshlrev_b32 v62, 16, v65
  v_and_b32 v63, s65, v65
  v_pk_mul_f32 v[60:61], v[60:61], v[136:137]
  v_pk_mul_f32 v[62:63], v[62:63], v[138:139]
  v_cvt_pk_bf16_f32 v158, v60, v61
  v_cvt_pk_bf16_f32 v159, v62, v63
  s_nop 1
  v_mfma_f32_16x16x32_bf16 v[164:167], v[156:159], v[108:111], 0
  s_waitcnt vmcnt(5)
  buffer_load_dwordx4 v[24:27], v37, s[16:19], s61 offen offset:512 nt
  v_cvt_f32_i32 v60, v32
  v_cvt_f32_i32 v61, v33
  v_cvt_f32_i32 v62, v34
  v_cvt_f32_i32 v63, v35
  v_pk_add_f32 v[60:61], v[60:61], v[152:153] neg_lo:[0,1] neg_hi:[0,1]
  v_pk_add_f32 v[62:63], v[62:63], v[154:155] neg_lo:[0,1] neg_hi:[0,1]
  v_cvt_pk_bf16_f32 v64, v60, v61
  v_cvt_pk_bf16_f32 v65, v62, v63
  v_lshlrev_b32 v60, 16, v64
  v_and_b32 v61, s65, v64
  v_lshlrev_b32 v62, 16, v65
  v_and_b32 v63, s65, v65
  v_pk_mul_f32 v[60:61], v[60:61], v[140:141]
  v_pk_mul_f32 v[62:63], v[62:63], v[142:143]
  v_cvt_pk_bf16_f32 v160, v60, v61
  v_cvt_pk_bf16_f32 v161, v62, v63
  s_nop 1
  v_mfma_f32_16x16x16_bf16 v[164:167], v[160:161], v[112:113], v[164:167]
  s_mov_b32 s60, s61
  s_nop 6
  v_mov_b32_dpp v92, v164 quad_perm:[0,0,0,0] row_mask:0xf bank_mask:0xf
  v_mov_b32_dpp v93, v166 quad_perm:[2,2,2,2] row_mask:0xf bank_mask:0xf
  s_nop 0
  v_add_f32_dpp v92, v165, v92 quad_perm:[1,1,1,1] row_mask:0xf bank_mask:0xf
  v_add_f32_dpp v93, v167, v93 quad_perm:[3,3,3,3] row_mask:0xf bank_mask:0xf
  v_add_f32 v169, v92, v93
  v_cvt_pk_bf16_f32 v92, v168, v169
  v_lshlrev_b32 v168, 16, v92
  v_and_b32 v169, s65, v92
  v_pk_mul_f32 v[168:169], v[168:169], s[68:69]
  v_cvt_pk_bf16_f32 v75, v168, v169
  ds_write_b128 v55, v[72:75]
  v_add_u32 v55, 256, v55
  s_cmp_lt_u32 s64, 128
  s_cbranch_scc1 L_k
  v_subrev_u32 v55, 8192, v55
  s_mov_b32 s64, s3
  s_add_u32 s70, s90, s3
  s_lshr_b32 s93, s70, 7
  s_waitcnt lgkmcnt(0)
  ds_read_b128 v[72:75], v55
L_v:
  s_add_u32 s64, s64, 4
  s_cmp_ge_u32 s64, s88
  s_cselect_b32 s70, s91, s90
  s_cmp_ge_u32 s64, s89
  s_cselect_b32 s70, s92, s70
  s_add_u32 s95, s64, s70
  s_mul_i32 s61, s95, 24576
  s_lshr_b32 s94, s95, 7
  s_cmp_lt_u32 s64, 128
  s_cselect_b32 s61, s61, 805306368
  s_waitcnt vmcnt(5)
  buffer_load_dwordx4 v[28:31], v38, s[12:15], s60 offen offset:0 nt
  v_mov_b32 v68, v66
  v_mov_b32 v69, v67
  v_cvt_f32_i32 v124, v4
  v_cvt_f32_i32 v125, v5
  v_cvt_f32_i32 v126, v6
  v_cvt_f32_i32 v127, v7
  v_mov_b32_dpp v70, v68 row_newbcast:0 row_mask:0xf bank_mask:0xf
  v_mov_b32_dpp v71, v69 row_newbcast:0 row_mask:0xf bank_mask:0xf
  v_pk_add_f32 v[124:125], v[124:125], v[70:71] op_sel_hi:[1,0] neg_lo:[0,1] neg_hi:[0,1]
  v_pk_add_f32 v[126:127], v[126:127], v[70:71] op_sel_hi:[1,0] neg_lo:[0,1] neg_hi:[0,1]
  s_waitcnt lgkmcnt(0)
  v_cvt_pk_bf16_f32 v64, v124, v125
  v_cvt_pk_bf16_f32 v65, v126, v127
  v_lshlrev_b32 v96, 16, v72
  v_lshlrev_b32 v124, 16, v64
  v_and_b32 v125, s65, v64
  v_and_b32 v97, s65, v72
  v_lshlrev_b32 v126, 16, v65
  v_and_b32 v127, s65, v65
  v_lshlrev_b32 v98, 16, v73
  v_pk_mul_f32 v[124:125], v[124:125], v[70:71] op_sel:[0,1]
  v_pk_mul_f32 v[126:127], v[126:127], v[70:71] op_sel:[0,1]
  v_and_b32 v99, s65, v73
  s_waitcnt vmcnt(5)
  buffer_load_dwordx4 v[32:35], v38, s[12:15], s60 offen offset:256 nt
  v_cvt_f32_i32 v128, v8
  v_cvt_f32_i32 v129, v9
  v_cvt_f32_i32 v130, v10
  v_cvt_f32_i32 v131, v11
  v_pk_add_f32 v[128:129], v[128:129], v[70:71] op_sel_hi:[1,0] neg_lo:[0,1] neg_hi:[0,1]
  v_pk_add_f32 v[130:131], v[130:131], v[70:71] op_sel_hi:[1,0] neg_lo:[0,1] neg_hi:[0,1]
  v_lshlrev_b32 v100, 16, v74
  v_cvt_pk_bf16_f32 v64, v128, v129
  v_cvt_pk_bf16_f32 v65, v130, v131
  v_and_b32 v101, s65, v74
  v_lshlrev_b32 v128, 16, v64
  v_and_b32 v129, s65, v64
  v_lshlrev_b32 v102, 16, v75
  v_lshlrev_b32 v130, 16, v65
  v_and_b32 v131, s65, v65
  v_and_b32 v103, s65, v75
  v_pk_mul_f32 v[128:129], v[128:129], v[70:71] op_sel:[0,1]
  v_pk_mul_f32 v[130:131], v[130:131], v[70:71] op_sel:[0,1]
  v_add_u32 v55, 256, v55
  s_waitcnt vmcnt(5)
  buffer_load_dwordx4 v[4:7], v38, s[12:15], s60 offen offset:512 nt
  v_cvt_f32_i32 v132, v12
  v_cvt_f32_i32 v133, v13
  v_cvt_f32_i32 v134, v14
  v_cvt_f32_i32 v135, v15
  v_pk_add_f32 v[132:133], v[132:133], v[70:71] op_sel_hi:[1,0] neg_lo:[0,1] neg_hi:[0,1]
  v_pk_add_f32 v[134:135], v[134:135], v[70:71] op_sel_hi:[1,0] neg_lo:[0,1] neg_hi:[0,1]
  v_max3_f32 v92, v96, v97, v98
  v_cvt_pk_bf16_f32 v64, v132, v133
  v_cvt_pk_bf16_f32 v65, v134, v135
  ds_read_b128 v[72:75], v55
  v_lshlrev_b32 v132, 16, v64
  v_and_b32 v133, s65, v64
  v_max3_f32 v93, v99, v100, v101
  v_lshlrev_b32 v134, 16, v65
  v_and_b32 v135, s65, v65
  v_max3_f32 v92, v92, v102, v103
  v_pk_mul_f32 v[132:133], v[132:133], v[70:71] op_sel:[0,1]
  v_pk_mul_f32 v[134:135], v[134:135], v[70:71] op_sel:[0,1]
  v_max3_f32 v92, v92, v93, v88
  s_waitcnt vmcnt(5)
  buffer_load_dwordx4 v[8:11], v39, s[12:15], s60 offen offset:0 nt
  v_cvt_f32_i32 v60, v16
  v_cvt_f32_i32 v61, v17
  v_cvt_f32_i32 v62, v18
  v_cvt_f32_i32 v63, v19
  s_lshl_b32 s63, s95, 6
  buffer_load_short_d16_hi v66, v54, s[32:35], s63 offen nt
  buffer_load_short_d16_hi v67, v54, s[28:31], s63 offen nt
  v_mov_b32_dpp v70, v68 row_newbcast:1 row_mask:0xf bank_mask:0xf
  v_mov_b32_dpp v71, v69 row_newbcast:1 row_mask:0xf bank_mask:0xf
  v_pk_add_f32 v[60:61], v[60:61], v[70:71] op_sel_hi:[1,0] neg_lo:[0,1] neg_hi:[0,1]
  v_pk_add_f32 v[62:63], v[62:63], v[70:71] op_sel_hi:[1,0] neg_lo:[0,1] neg_hi:[0,1]
  v_mov_b32 v93, v92
  v_cvt_pk_bf16_f32 v64, v60, v61
  v_cvt_pk_bf16_f32 v65, v62, v63
  v_permlane32_swap_b32 v92, v93
  v_lshlrev_b32 v60, 16, v64
  v_and_b32 v61, s65, v64
  v_max_f32 v92, v92, v93
  v_lshlrev_b32 v62, 16, v65
  v_and_b32 v63, s65, v65
  v_mov_b32 v93, v92
  v_pk_mul_f32 v[60:61], v[60:61], v[70:71] op_sel:[0,1]
  v_pk_mul_f32 v[62:63], v[62:63], v[70:71] op_sel:[0,1]
  v_permlane16_swap_b32 v92, v93
  v_cvt_pk_bf16_f32 v136, v124, v60
  v_cvt_pk_bf16_f32 v140, v125, v61
  v_cvt_pk_bf16_f32 v144, v126, v62
  v_cvt_pk_bf16_f32 v148, v127, v63
  s_waitcnt vmcnt(7)
  buffer_load_dwordx4 v[12:15], v39, s[12:15], s60 offen offset:256 nt
  v_cvt_f32_i32 v60, v20
  v_cvt_f32_i32 v61, v21
  v_cvt_f32_i32 v62, v22
  v_cvt_f32_i32 v63, v23
  v_pk_add_f32 v[60:61], v[60:61], v[70:71] op_sel_hi:[1,0] neg_lo:[0,1] neg_hi:[0,1]
  v_pk_add_f32 v[62:63], v[62:63], v[70:71] op_sel_hi:[1,0] neg_lo:[0,1] neg_hi:[0,1]
  v_max_f32 v88, v92, v93
  v_cvt_pk_bf16_f32 v64, v60, v61
  v_cvt_pk_bf16_f32 v65, v62, v63
  v_mul_f32 v92, s66, v88
  v_lshlrev_b32 v60, 16, v64
  v_and_b32 v61, s65, v64
  v_add_f32 v94, v92, v90
  v_lshlrev_b32 v62, 16, v65
  v_and_b32 v63, s65, v65
  v_sub_f32 v90, 0, v92
  v_pk_mul_f32 v[60:61], v[60:61], v[70:71] op_sel:[0,1]
  v_pk_mul_f32 v[62:63], v[62:63], v[70:71] op_sel:[0,1]
  v_exp_f32 v94, -v94
  v_cvt_pk_bf16_f32 v152, v128, v60
  v_cvt_pk_bf16_f32 v156, v129, v61
  v_cvt_pk_bf16_f32 v160, v130, v62
  v_cvt_pk_bf16_f32 v164, v131, v63
  s_waitcnt vmcnt(7)
  buffer_load_dwordx4 v[16:19], v39, s[12:15], s60 offen offset:512 nt
  v_cvt_f32_i32 v60, v24
  v_cvt_f32_i32 v61, v25
  v_cvt_f32_i32 v62, v26
  v_cvt_f32_i32 v63, v27
  v_pk_add_f32 v[60:61], v[60:61], v[70:71] op_sel_hi:[1,0] neg_lo:[0,1] neg_hi:[0,1]
  v_pk_add_f32 v[62:63], v[62:63], v[70:71] op_sel_hi:[1,0] neg_lo:[0,1] neg_hi:[0,1]
  ds_bpermute_b32 v95, v56, v94
  v_cvt_pk_bf16_f32 v64, v60, v61
  v_cvt_pk_bf16_f32 v65, v62, v63
  v_fma_f32 v96, v96, s66, v90
  v_lshlrev_b32 v60, 16, v64
  v_and_b32 v61, s65, v64
  v_exp_f32 v96, v96
  v_lshlrev_b32 v62, 16, v65
  v_and_b32 v63, s65, v65
  v_fma_f32 v97, v97, s66, v90
  v_pk_mul_f32 v[60:61], v[60:61], v[70:71] op_sel:[0,1]
  v_pk_mul_f32 v[62:63], v[62:63], v[70:71] op_sel:[0,1]
  v_exp_f32 v97, v97
  v_cvt_pk_bf16_f32 v168, v132, v60
  v_cvt_pk_bf16_f32 v172, v133, v61
  v_cvt_pk_bf16_f32 v176, v134, v62
  v_cvt_pk_bf16_f32 v180, v135, v63
  s_waitcnt vmcnt(7)
  buffer_load_dwordx4 v[20:23], v40, s[12:15], s60 offen offset:0 nt
  v_cvt_f32_i32 v124, v28
  v_cvt_f32_i32 v125, v29
  v_cvt_f32_i32 v126, v30
  v_cvt_f32_i32 v127, v31
  v_mov_b32_dpp v70, v68 row_newbcast:2 row_mask:0xf bank_mask:0xf
  v_mov_b32_dpp v71, v69 row_newbcast:2 row_mask:0xf bank_mask:0xf
  v_pk_add_f32 v[124:125], v[124:125], v[70:71] op_sel_hi:[1,0] neg_lo:[0,1] neg_hi:[0,1]
  v_pk_add_f32 v[126:127], v[126:127], v[70:71] op_sel_hi:[1,0] neg_lo:[0,1] neg_hi:[0,1]
  v_fma_f32 v98, v98, s66, v90
  v_cvt_pk_bf16_f32 v64, v124, v125
  v_cvt_pk_bf16_f32 v65, v126, v127
  v_exp_f32 v98, v98
  v_lshlrev_b32 v124, 16, v64
  v_and_b32 v125, s65, v64
  v_fma_f32 v99, v99, s66, v90
  v_lshlrev_b32 v126, 16, v65
  v_and_b32 v127, s65, v65
  v_exp_f32 v99, v99
  v_pk_mul_f32 v[124:125], v[124:125], v[70:71] op_sel:[0,1]
  v_pk_mul_f32 v[126:127], v[126:127], v[70:71] op_sel:[0,1]
  v_fma_f32 v100, v100, s66, v90
  s_waitcnt vmcnt(7)
  buffer_load_dwordx4 v[24:27], v40, s[12:15], s60 offen offset:256 nt
  v_cvt_f32_i32 v128, v32
  v_cvt_f32_i32 v129, v33
  v_cvt_f32_i32 v130, v34
  v_cvt_f32_i32 v131, v35
  v_pk_add_f32 v[128:129], v[128:129], v[70:71] op_sel_hi:[1,0] neg_lo:[0,1] neg_hi:[0,1]
  v_pk_add_f32 v[130:131], v[130:131], v[70:71] op_sel_hi:[1,0] neg_lo:[0,1] neg_hi:[0,1]
  v_exp_f32 v100, v100
  v_cvt_pk_bf16_f32 v64, v128, v129
  v_cvt_pk_bf16_f32 v65, v130, v131
  v_fma_f32 v101, v101, s66, v90
  v_lshlrev_b32 v128, 16, v64
  v_and_b32 v129, s65, v64
  v_exp_f32 v101, v101
  v_lshlrev_b32 v130, 16, v65
  v_and_b32 v131, s65, v65
  v_fma_f32 v102, v102, s66, v90
  v_pk_mul_f32 v[128:129], v[128:129], v[70:71] op_sel:[0,1]
  v_pk_mul_f32 v[130:131], v[130:131], v[70:71] op_sel:[0,1]
  v_exp_f32 v102, v102
  s_waitcnt vmcnt(7)
  buffer_load_dwordx4 v[28:31], v40, s[12:15], s60 offen offset:512 nt
  v_cvt_f32_i32 v132, v4
  v_cvt_f32_i32 v133, v5
  v_cvt_f32_i32 v134, v6
  v_cvt_f32_i32 v135, v7
  v_pk_add_f32 v[132:133], v[132:133], v[70:71] op_sel_hi:[1,0] neg_lo:[0,1] neg_hi:[0,1]
  v_pk_add_f32 v[134:135], v[134:135], v[70:71] op_sel_hi:[1,0] neg_lo:[0,1] neg_hi:[0,1]
  v_fma_f32 v103, v103, s66, v90
  v_cvt_pk_bf16_f32 v64, v132, v133
  v_cvt_pk_bf16_f32 v65, v134, v135
  v_exp_f32 v103, v103
  v_lshlrev_b32 v132, 16, v64
  v_and_b32 v133, s65, v64
  v_add_f32 v92, v96, v97
  v_lshlrev_b32 v134, 16, v65
  v_and_b32 v135, s65, v65
  v_add_f32 v93, v98, v99
  v_pk_mul_f32 v[132:133], v[132:133], v[70:71] op_sel:[0,1]
  v_pk_mul_f32 v[134:135], v[134:135], v[70:71] op_sel:[0,1]
  v_add_f32 v92, v92, v100
  s_waitcnt vmcnt(7)
  buffer_load_dwordx4 v[32:35], v41, s[12:15], s60 offen offset:0 nt
  v_cvt_f32_i32 v60, v8
  v_cvt_f32_i32 v61, v9
  v_cvt_f32_i32 v62, v10
  v_cvt_f32_i32 v63, v11
  v_mov_b32_dpp v70, v68 row_newbcast:3 row_mask:0xf bank_mask:0xf
  v_mov_b32_dpp v71, v69 row_newbcast:3 row_mask:0xf bank_mask:0xf
  v_pk_add_f32 v[60:61], v[60:61], v[70:71] op_sel_hi:[1,0] neg_lo:[0,1] neg_hi:[0,1]
  v_pk_add_f32 v[62:63], v[62:63], v[70:71] op_sel_hi:[1,0] neg_lo:[0,1] neg_hi:[0,1]
  v_add_f32 v93, v93, v101
  v_cvt_pk_bf16_f32 v64, v60, v61
  v_cvt_pk_bf16_f32 v65, v62, v63
  v_add_f32 v92, v92, v102
  v_lshlrev_b32 v60, 16, v64
  v_and_b32 v61, s65, v64
  v_add_f32 v93, v93, v103
  v_lshlrev_b32 v62, 16, v65
  v_and_b32 v63, s65, v65
  v_add_f32 v92, v92, v93
  v_pk_mul_f32 v[60:61], v[60:61], v[70:71] op_sel:[0,1]
  v_pk_mul_f32 v[62:63], v[62:63], v[70:71] op_sel:[0,1]
  v_fma_f32 v91, v91, v94, v92
  v_cvt_pk_bf16_f32 v137, v124, v60
  v_cvt_pk_bf16_f32 v141, v125, v61
  v_cvt_pk_bf16_f32 v145, v126, v62
  v_cvt_pk_bf16_f32 v149, v127, v63
  s_waitcnt vmcnt(5)
  buffer_load_dwordx4 v[4:7], v41, s[12:15], s60 offen offset:256 nt
  v_cvt_f32_i32 v60, v12
  v_cvt_f32_i32 v61, v13
  v_cvt_f32_i32 v62, v14
  v_cvt_f32_i32 v63, v15
  v_pk_add_f32 v[60:61], v[60:61], v[70:71] op_sel_hi:[1,0] neg_lo:[0,1] neg_hi:[0,1]
  v_pk_add_f32 v[62:63], v[62:63], v[70:71] op_sel_hi:[1,0] neg_lo:[0,1] neg_hi:[0,1]
  v_cvt_pk_bf16_f32 v104, v96, v97
  v_cvt_pk_bf16_f32 v64, v60, v61
  v_cvt_pk_bf16_f32 v65, v62, v63
  v_cvt_pk_bf16_f32 v105, v98, v99
  v_lshlrev_b32 v60, 16, v64
  v_and_b32 v61, s65, v64
  v_cvt_pk_bf16_f32 v106, v100, v101
  v_lshlrev_b32 v62, 16, v65
  v_and_b32 v63, s65, v65
  v_cvt_pk_bf16_f32 v107, v102, v103
  v_pk_mul_f32 v[60:61], v[60:61], v[70:71] op_sel:[0,1]
  v_pk_mul_f32 v[62:63], v[62:63], v[70:71] op_sel:[0,1]
  v_cndmask_b32 v108, 0, v104, s[72:73]
  v_cvt_pk_bf16_f32 v153, v128, v60
  v_cvt_pk_bf16_f32 v157, v129, v61
  v_cvt_pk_bf16_f32 v161, v130, v62
  v_cvt_pk_bf16_f32 v165, v131, v63
  s_waitcnt vmcnt(5)
  buffer_load_dwordx4 v[8:11], v41, s[12:15], s60 offen offset:512 nt
  v_cvt_f32_i32 v60, v16
  v_cvt_f32_i32 v61, v17
  v_cvt_f32_i32 v62, v18
  v_cvt_f32_i32 v63, v19
  v_pk_add_f32 v[60:61], v[60:61], v[70:71] op_sel_hi:[1,0] neg_lo:[0,1] neg_hi:[0,1]
  v_pk_add_f32 v[62:63], v[62:63], v[70:71] op_sel_hi:[1,0] neg_lo:[0,1] neg_hi:[0,1]
  v_cndmask_b32 v109, 0, v105, s[72:73]
  v_cvt_pk_bf16_f32 v64, v60, v61
  v_cvt_pk_bf16_f32 v65, v62, v63
  v_cndmask_b32 v110, 0, v106, s[72:73]
  v_lshlrev_b32 v60, 16, v64
  v_and_b32 v61, s65, v64
  v_cndmask_b32 v111, 0, v107, s[72:73]
  v_lshlrev_b32 v62, 16, v65
  v_and_b32 v63, s65, v65
  v_cndmask_b32 v112, 0, v104, s[74:75]
  v_pk_mul_f32 v[60:61], v[60:61], v[70:71] op_sel:[0,1]
  v_pk_mul_f32 v[62:63], v[62:63], v[70:71] op_sel:[0,1]
  v_cndmask_b32 v113, 0, v105, s[74:75]
  v_cvt_pk_bf16_f32 v169, v132, v60
  v_cvt_pk_bf16_f32 v173, v133, v61
  v_cvt_pk_bf16_f32 v177, v134, v62
  v_cvt_pk_bf16_f32 v181, v135, v63
  s_waitcnt vmcnt(5)
  buffer_load_dwordx4 v[12:15], v42, s[12:15], s60 offen offset:0 nt
  v_cvt_f32_i32 v124, v20
  v_cvt_f32_i32 v125, v21
  v_cvt_f32_i32 v126, v22
  v_cvt_f32_i32 v127, v23
  v_mov_b32_dpp v70, v68 row_newbcast:4 row_mask:0xf bank_mask:0xf
  v_mov_b32_dpp v71, v69 row_newbcast:4 row_mask:0xf bank_mask:0xf
  v_pk_add_f32 v[124:125], v[124:125], v[70:71] op_sel_hi:[1,0] neg_lo:[0,1] neg_hi:[0,1]
  v_pk_add_f32 v[126:127], v[126:127], v[70:71] op_sel_hi:[1,0] neg_lo:[0,1] neg_hi:[0,1]
  v_cndmask_b32 v114, 0, v106, s[74:75]
  v_cvt_pk_bf16_f32 v64, v124, v125
  v_cvt_pk_bf16_f32 v65, v126, v127
  v_cndmask_b32 v115, 0, v107, s[74:75]
  v_lshlrev_b32 v124, 16, v64
  v_and_b32 v125, s65, v64
  v_cndmask_b32 v116, 0, v104, s[76:77]
  v_lshlrev_b32 v126, 16, v65
  v_and_b32 v127, s65, v65
  v_cndmask_b32 v117, 0, v105, s[76:77]
  v_pk_mul_f32 v[124:125], v[124:125], v[70:71] op_sel:[0,1]
  v_pk_mul_f32 v[126:127], v[126:127], v[70:71] op_sel:[0,1]
  v_cndmask_b32 v118, 0, v106, s[76:77]
  s_waitcnt vmcnt(5)
  buffer_load_dwordx4 v[16:19], v42, s[12:15], s60 offen offset:256 nt
  v_cvt_f32_i32 v128, v24
  v_cvt_f32_i32 v129, v25
  v_cvt_f32_i32 v130, v26
  v_cvt_f32_i32 v131, v27
  v_pk_add_f32 v[128:129], v[128:129], v[70:71] op_sel_hi:[1,0] neg_lo:[0,1] neg_hi:[0,1]
  v_pk_add_f32 v[130:131], v[130:131], v[70:71] op_sel_hi:[1,0] neg_lo:[0,1] neg_hi:[0,1]
  v_cndmask_b32 v119, 0, v107, s[76:77]
  v_cvt_pk_bf16_f32 v64, v128, v129
  v_cvt_pk_bf16_f32 v65, v130, v131
  v_cndmask_b32 v120, 0, v104, s[78:79]
  v_lshlrev_b32 v128, 16, v64
  v_and_b32 v129, s65, v64
  v_cndmask_b32 v121, 0, v105, s[78:79]
  v_lshlrev_b32 v130, 16, v65
  v_and_b32 v131, s65, v65
  v_cndmask_b32 v122, 0, v106, s[78:79]
  v_pk_mul_f32 v[128:129], v[128:129], v[70:71] op_sel:[0,1]
  v_pk_mul_f32 v[130:131], v[130:131], v[70:71] op_sel:[0,1]
  v_cndmask_b32 v123, 0, v107, s[78:79]
  s_waitcnt vmcnt(5)
  buffer_load_dwordx4 v[20:23], v42, s[12:15], s60 offen offset:512 nt
  v_cvt_f32_i32 v132, v28
  v_cvt_f32_i32 v133, v29
  v_cvt_f32_i32 v134, v30
  v_cvt_f32_i32 v135, v31
  v_pk_add_f32 v[132:133], v[132:133], v[70:71] op_sel_hi:[1,0] neg_lo:[0,1] neg_hi:[0,1]
  v_pk_add_f32 v[134:135], v[134:135], v[70:71] op_sel_hi:[1,0] neg_lo:[0,1] neg_hi:[0,1]
  s_waitcnt lgkmcnt(0)
  v_cvt_pk_bf16_f32 v64, v132, v133
  v_cvt_pk_bf16_f32 v65, v134, v135
  v_mul_f32 v76, v95, v76
  v_lshlrev_b32 v132, 16, v64
  v_and_b32 v133, s65, v64
  v_mul_f32 v77, v95, v77
  v_lshlrev_b32 v134, 16, v65
  v_and_b32 v135, s65, v65
  v_mul_f32 v78, v95, v78
  v_pk_mul_f32 v[132:133], v[132:133], v[70:71] op_sel:[0,1]
  v_pk_mul_f32 v[134:135], v[134:135], v[70:71] op_sel:[0,1]
  v_mul_f32 v79, v95, v79
  s_waitcnt vmcnt(5)
  buffer_load_dwordx4 v[24:27], v43, s[12:15], s60 offen offset:0 nt
  v_cvt_f32_i32 v60, v32
  v_cvt_f32_i32 v61, v33
  v_cvt_f32_i32 v62, v34
  v_cvt_f32_i32 v63, v35
  v_mov_b32_dpp v70, v68 row_newbcast:5 row_mask:0xf bank_mask:0xf
  v_mov_b32_dpp v71, v69 row_newbcast:5 row_mask:0xf bank_mask:0xf
  v_pk_add_f32 v[60:61], v[60:61], v[70:71] op_sel_hi:[1,0] neg_lo:[0,1] neg_hi:[0,1]
  v_pk_add_f32 v[62:63], v[62:63], v[70:71] op_sel_hi:[1,0] neg_lo:[0,1] neg_hi:[0,1]
  v_mul_f32 v80, v95, v80
  v_cvt_pk_bf16_f32 v64, v60, v61
  v_cvt_pk_bf16_f32 v65, v62, v63
  v_mul_f32 v81, v95, v81
  v_lshlrev_b32 v60, 16, v64
  v_and_b32 v61, s65, v64
  v_mul_f32 v82, v95, v82
  v_lshlrev_b32 v62, 16, v65
  v_and_b32 v63, s65, v65
  v_mul_f32 v83, v95, v83
  v_pk_mul_f32 v[60:61], v[60:61], v[70:71] op_sel:[0,1]
  v_pk_mul_f32 v[62:63], v[62:63], v[70:71] op_sel:[0,1]
  v_mul_f32 v84, v95, v84
  v_cvt_pk_bf16_f32 v138, v124, v60
  v_cvt_pk_bf16_f32 v142, v125, v61
  v_cvt_pk_bf16_f32 v146, v126, v62
  v_cvt_pk_bf16_f32 v150, v127, v63
  s_waitcnt vmcnt(5)
  buffer_load_dwordx4 v[28:31], v43, s[12:15], s60 offen offset:256 nt
  v_cvt_f32_i32 v60, v4
  v_cvt_f32_i32 v61, v5
  v_cvt_f32_i32 v62, v6
  v_cvt_f32_i32 v63, v7
  v_pk_add_f32 v[60:61], v[60:61], v[70:71] op_sel_hi:[1,0] neg_lo:[0,1] neg_hi:[0,1]
  v_pk_add_f32 v[62:63], v[62:63], v[70:71] op_sel_hi:[1,0] neg_lo:[0,1] neg_hi:[0,1]
  v_mul_f32 v85, v95, v85
  v_cvt_pk_bf16_f32 v64, v60, v61
  v_cvt_pk_bf16_f32 v65, v62, v63
  v_mul_f32 v86, v95, v86
  v_lshlrev_b32 v60, 16, v64
  v_and_b32 v61, s65, v64
  v_mul_f32 v87, v95, v87
  v_lshlrev_b32 v62, 16, v65
  v_and_b32 v63, s65, v65
  v_pk_mul_f32 v[60:61], v[60:61], v[70:71] op_sel:[0,1]
  v_pk_mul_f32 v[62:63], v[62:63], v[70:71] op_sel:[0,1]
  v_cvt_pk_bf16_f32 v154, v128, v60
  v_cvt_pk_bf16_f32 v158, v129, v61
  v_cvt_pk_bf16_f32 v162, v130, v62
  v_cvt_pk_bf16_f32 v166, v131, v63
  s_waitcnt vmcnt(5)
  buffer_load_dwordx4 v[32:35], v43, s[12:15], s60 offen offset:512 nt
  v_cvt_f32_i32 v60, v8
  v_cvt_f32_i32 v61, v9
  v_cvt_f32_i32 v62, v10
  v_cvt_f32_i32 v63, v11
  v_pk_add_f32 v[60:61], v[60:61], v[70:71] op_sel_hi:[1,0] neg_lo:[0,1] neg_hi:[0,1]
  v_pk_add_f32 v[62:63], v[62:63], v[70:71] op_sel_hi:[1,0] neg_lo:[0,1] neg_hi:[0,1]
  v_cvt_pk_bf16_f32 v64, v60, v61
  v_cvt_pk_bf16_f32 v65, v62, v63
  v_lshlrev_b32 v60, 16, v64
  v_and_b32 v61, s65, v64
  v_lshlrev_b32 v62, 16, v65
  v_and_b32 v63, s65, v65
  v_pk_mul_f32 v[60:61], v[60:61], v[70:71] op_sel:[0,1]
  v_pk_mul_f32 v[62:63], v[62:63], v[70:71] op_sel:[0,1]
  v_cvt_pk_bf16_f32 v170, v132, v60
  v_cvt_pk_bf16_f32 v174, v133, v61
  v_cvt_pk_bf16_f32 v178, v134, v62
  v_cvt_pk_bf16_f32 v182, v135, v63
  s_waitcnt vmcnt(5)
  buffer_load_dwordx4 v[4:7], v36, s[12:15], s61 offen offset:0 nt
  v_cvt_f32_i32 v124, v12
  v_cvt_f32_i32 v125, v13
  v_cvt_f32_i32 v126, v14
  v_cvt_f32_i32 v127, v15
  v_mov_b32_dpp v70, v68 row_newbcast:6 row_mask:0xf bank_mask:0xf
  v_mov_b32_dpp v71, v69 row_newbcast:6 row_mask:0xf bank_mask:0xf
  v_pk_add_f32 v[124:125], v[124:125], v[70:71] op_sel_hi:[1,0] neg_lo:[0,1] neg_hi:[0,1]
  v_pk_add_f32 v[126:127], v[126:127], v[70:71] op_sel_hi:[1,0] neg_lo:[0,1] neg_hi:[0,1]
  v_cvt_pk_bf16_f32 v64, v124, v125
  v_cvt_pk_bf16_f32 v65, v126, v127
  v_lshlrev_b32 v124, 16, v64
  v_and_b32 v125, s65, v64
  v_lshlrev_b32 v126, 16, v65
  v_and_b32 v127, s65, v65
  v_pk_mul_f32 v[124:125], v[124:125], v[70:71] op_sel:[0,1]
  v_pk_mul_f32 v[126:127], v[126:127], v[70:71] op_sel:[0,1]
  s_waitcnt vmcnt(5)
  buffer_load_dwordx4 v[8:11], v36, s[12:15], s61 offen offset:256 nt
  v_cvt_f32_i32 v128, v16
  v_cvt_f32_i32 v129, v17
  v_cvt_f32_i32 v130, v18
  v_cvt_f32_i32 v131, v19
  v_pk_add_f32 v[128:129], v[128:129], v[70:71] op_sel_hi:[1,0] neg_lo:[0,1] neg_hi:[0,1]
  v_pk_add_f32 v[130:131], v[130:131], v[70:71] op_sel_hi:[1,0] neg_lo:[0,1] neg_hi:[0,1]
  v_cvt_pk_bf16_f32 v64, v128, v129
  v_cvt_pk_bf16_f32 v65, v130, v131
  v_lshlrev_b32 v128, 16, v64
  v_and_b32 v129, s65, v64
  v_lshlrev_b32 v130, 16, v65
  v_and_b32 v131, s65, v65
  v_pk_mul_f32 v[128:129], v[128:129], v[70:71] op_sel:[0,1]
  v_pk_mul_f32 v[130:131], v[130:131], v[70:71] op_sel:[0,1]
  s_waitcnt vmcnt(5)
  buffer_load_dwordx4 v[12:15], v36, s[12:15], s61 offen offset:512 nt
  v_cvt_f32_i32 v132, v20
  v_cvt_f32_i32 v133, v21
  v_cvt_f32_i32 v134, v22
  v_cvt_f32_i32 v135, v23
  v_pk_add_f32 v[132:133], v[132:133], v[70:71] op_sel_hi:[1,0] neg_lo:[0,1] neg_hi:[0,1]
  v_pk_add_f32 v[134:135], v[134:135], v[70:71] op_sel_hi:[1,0] neg_lo:[0,1] neg_hi:[0,1]
  v_cvt_pk_bf16_f32 v64, v132, v133
  v_cvt_pk_bf16_f32 v65, v134, v135
  v_lshlrev_b32 v132, 16, v64
  v_and_b32 v133, s65, v64
  v_lshlrev_b32 v134, 16, v65
  v_and_b32 v135, s65, v65
  v_pk_mul_f32 v[132:133], v[132:133], v[70:71] op_sel:[0,1]
  v_pk_mul_f32 v[134:135], v[134:135], v[70:71] op_sel:[0,1]
  s_waitcnt vmcnt(5)
  buffer_load_dwordx4 v[16:19], v37, s[12:15], s61 offen offset:0 nt
  v_cvt_f32_i32 v60, v24
  v_cvt_f32_i32 v61, v25
  v_cvt_f32_i32 v62, v26
  v_cvt_f32_i32 v63, v27
  v_mov_b32_dpp v70, v68 row_newbcast:7 row_mask:0xf bank_mask:0xf
  v_mov_b32_dpp v71, v69 row_newbcast:7 row_mask:0xf bank_mask:0xf
  v_pk_add_f32 v[60:61], v[60:61], v[70:71] op_sel_hi:[1,0] neg_lo:[0,1] neg_hi:[0,1]
  v_pk_add_f32 v[62:63], v[62:63], v[70:71] op_sel_hi:[1,0] neg_lo:[0,1] neg_hi:[0,1]
  v_cvt_pk_bf16_f32 v64, v60, v61
  v_cvt_pk_bf16_f32 v65, v62, v63
  v_lshlrev_b32 v60, 16, v64
  v_and_b32 v61, s65, v64
  v_lshlrev_b32 v62, 16, v65
  v_and_b32 v63, s65, v65
  v_pk_mul_f32 v[60:61], v[60:61], v[70:71] op_sel:[0,1]
  v_pk_mul_f32 v[62:63], v[62:63], v[70:71] op_sel:[0,1]
  v_cvt_pk_bf16_f32 v139, v124, v60
  v_cvt_pk_bf16_f32 v143, v125, v61
  v_cvt_pk_bf16_f32 v147, v126, v62
  v_cvt_pk_bf16_f32 v151, v127, v63
  v_mfma_f32_16x16x32_bf16 v[76:79], v[108:111], v[136:139], v[76:79]
  v_mfma_f32_16x16x32_bf16 v[76:79], v[112:115], v[140:143], v[76:79]
  v_mfma_f32_16x16x32_bf16 v[76:79], v[116:119], v[144:147], v[76:79]
  v_mfma_f32_16x16x32_bf16 v[76:79], v[120:123], v[148:151], v[76:79]
  s_waitcnt vmcnt(5)
  buffer_load_dwordx4 v[20:23], v37, s[12:15], s61 offen offset:256 nt
  v_cvt_f32_i32 v60, v28
  v_cvt_f32_i32 v61, v29
  v_cvt_f32_i32 v62, v30
  v_cvt_f32_i32 v63, v31
  v_pk_add_f32 v[60:61], v[60:61], v[70:71] op_sel_hi:[1,0] neg_lo:[0,1] neg_hi:[0,1]
  v_pk_add_f32 v[62:63], v[62:63], v[70:71] op_sel_hi:[1,0] neg_lo:[0,1] neg_hi:[0,1]
  v_cvt_pk_bf16_f32 v64, v60, v61
  v_cvt_pk_bf16_f32 v65, v62, v63
  v_lshlrev_b32 v60, 16, v64
  v_and_b32 v61, s65, v64
  v_lshlrev_b32 v62, 16, v65
  v_and_b32 v63, s65, v65
  v_pk_mul_f32 v[60:61], v[60:61], v[70:71] op_sel:[0,1]
  v_pk_mul_f32 v[62:63], v[62:63], v[70:71] op_sel:[0,1]
  v_cvt_pk_bf16_f32 v155, v128, v60
  v_cvt_pk_bf16_f32 v159, v129, v61
  v_cvt_pk_bf16_f32 v163, v130, v62
  v_cvt_pk_bf16_f32 v167, v131, v63
  v_mfma_f32_16x16x32_bf16 v[80:83], v[108:111], v[152:155], v[80:83]
  v_mfma_f32_16x16x32_bf16 v[80:83], v[112:115], v[156:159], v[80:83]
  v_mfma_f32_16x16x32_bf16 v[80:83], v[116:119], v[160:163], v[80:83]
  v_mfma_f32_16x16x32_bf16 v[80:83], v[120:123], v[164:167], v[80:83]
  s_waitcnt vmcnt(5)
  buffer_load_dwordx4 v[24:27], v37, s[12:15], s61 offen offset:512 nt
  v_cvt_f32_i32 v60, v32
  v_cvt_f32_i32 v61, v33
  v_cvt_f32_i32 v62, v34
  v_cvt_f32_i32 v63, v35
  v_pk_add_f32 v[60:61], v[60:61], v[70:71] op_sel_hi:[1,0] neg_lo:[0,1] neg_hi:[0,1]
  v_pk_add_f32 v[62:63], v[62:63], v[70:71] op_sel_hi:[1,0] neg_lo:[0,1] neg_hi:[0,1]
  v_cvt_pk_bf16_f32 v64, v60, v61
  v_cvt_pk_bf16_f32 v65, v62, v63
  v_lshlrev_b32 v60, 16, v64
  v_and_b32 v61, s65, v64
  v_lshlrev_b32 v62, 16, v65
  v_and_b32 v63, s65, v65
  v_pk_mul_f32 v[60:61], v[60:61], v[70:71] op_sel:[0,1]
  v_pk_mul_f32 v[62:63], v[62:63], v[70:71] op_sel:[0,1]
  v_cvt_pk_bf16_f32 v171, v132, v60
  v_cvt_pk_bf16_f32 v175, v133, v61
  v_cvt_pk_bf16_f32 v179, v134, v62
  v_cvt_pk_bf16_f32 v183, v135, v63
  v_mfma_f32_16x16x32_bf16 v[84:87], v[108:111], v[168:171], v[84:87]
  v_mfma_f32_16x16x32_bf16 v[84:87], v[112:115], v[172:175], v[84:87]
  v_mfma_f32_16x16x32_bf16 v[84:87], v[116:119], v[176:179], v[84:87]
  v_mfma_f32_16x16x32_bf16 v[84:87], v[120:123], v[180:183], v[84:87]
  s_mov_b32 s60, s61
  s_cmp_ge_u32 s64, 128
  s_cbranch_scc1 L_v_done
  s_cmp_eq_u32 s94, s93
  s_cbranch_scc1 L_v
  s_mov_b32 s93, s94
  v_mov_b32 v93, v91
  s_nop 1
  v_permlane32_swap_b32 v91, v93
  v_add_f32 v91, v91, v93
  v_mov_b32 v93, v91
  s_nop 1
  v_permlane16_swap_b32 v91, v93
  v_add_f32 v91, v91, v93
  ds_write_b64 v58, v[90:91]
  ds_write_b128 v57, v[76:79] offset:0
  ds_write_b128 v57, v[80:83] offset:1024
  ds_write_b128 v57, v[84:87] offset:2048
  s_waitcnt lgkmcnt(0)
  v_add_u32 v57, 12416, v57
  v_add_u32 v58, 12416, v58
  v_mov_b32 v76, 0
  v_mov_b32 v77, 0
  v_mov_b32 v78, 0
  v_mov_b32 v79, 0
  v_mov_b32 v80, 0
  v_mov_b32 v81, 0
  v_mov_b32 v82, 0
  v_mov_b32 v83, 0
  v_mov_b32 v84, 0
  v_mov_b32 v85, 0
  v_mov_b32 v86, 0
  v_mov_b32 v87, 0
  v_mov_b32 v88, 0xff800000
  v_mov_b32 v90, 0x7f800000
  v_mov_b32 v91, 0
  s_branch L_v
L_v_done:
  v_mov_b32 v93, v91
  s_nop 1
  v_permlane32_swap_b32 v91, v93
  v_add_f32 v91, v91, v93
  v_mov_b32 v93, v91
  s_nop 1
  v_permlane16_swap_b32 v91, v93
  v_add_f32 v91, v91, v93
  ds_write_b64 v58, v[90:91]
  ds_write_b128 v57, v[76:79] offset:0
  ds_write_b128 v57, v[80:83] offset:1024
  ds_write_b128 v57, v[84:87] offset:2048
  s_waitcnt lgkmcnt(0)
  s_barrier
  s_cmp_ge_u32 s3, 3
  s_cbranch_scc1 L_fin
  s_mul_i32 s70, s3, 12416
  s_add_u32 s70, s70, 32768
  v_lshrrev_b32 v94, 1, v56
  v_add_u32 v92, s70, v94
  ds_read_b64 v[4:5], v92 offset:12288
  ds_read_b64 v[6:7], v92 offset:12320
  ds_read_b64 v[8:9], v92 offset:12352
  ds_read_b64 v[10:11], v92 offset:12384
  v_lshl_add_u32 v92, v0, 4, s70
  ds_read_b128 v[108:111], v92 offset:0
  ds_read_b128 v[112:115], v92 offset:1024
  ds_read_b128 v[116:119], v92 offset:2048
  ds_read_b128 v[120:123], v92 offset:3072
  ds_read_b128 v[124:127], v92 offset:4096
  ds_read_b128 v[128:131], v92 offset:5120
  ds_read_b128 v[132:135], v92 offset:6144
  ds_read_b128 v[136:139], v92 offset:7168
  ds_read_b128 v[140:143], v92 offset:8192
  ds_read_b128 v[144:147], v92 offset:9216
  ds_read_b128 v[148:151], v92 offset:10240
  ds_read_b128 v[152:155], v92 offset:11264
  s_lshl_b32 s70, s3, 8
  s_add_u32 s70, s70, s2
  s_mul_i32 s70, s70, 3328
  s_add_u32 s70, s70, 1048576
  v_lshlrev_b32 v95, 4, v0
  s_waitcnt lgkmcnt(0)
  v_min_f32 v92, v4, v6
  v_min_f32 v92, v92, v8
  v_min_f32 v92, v92, v10
  v_sub_f32 v4, v92, v4
  v_sub_f32 v6, v92, v6
  v_sub_f32 v8, v92, v8
  v_sub_f32 v10, v92, v10
  v_exp_f32 v4, v4
  v_exp_f32 v6, v6
  v_exp_f32 v8, v8
  v_exp_f32 v10, v10
  v_mul_f32 v93, v4, v5
  v_fma_f32 v93, v6, v7, v93
  v_fma_f32 v93, v8, v9, v93
  v_fma_f32 v93, v10, v11, v93
  v_mul_f32 v76, v4, v108
  v_fma_f32 v76, v6, v120, v76
  v_fma_f32 v76, v8, v132, v76
  v_fma_f32 v76, v10, v144, v76
  v_mul_f32 v77, v4, v109
  v_fma_f32 v77, v6, v121, v77
  v_fma_f32 v77, v8, v133, v77
  v_fma_f32 v77, v10, v145, v77
  v_mul_f32 v78, v4, v110
  v_fma_f32 v78, v6, v122, v78
  v_fma_f32 v78, v8, v134, v78
  v_fma_f32 v78, v10, v146, v78
  v_mul_f32 v79, v4, v111
  v_fma_f32 v79, v6, v123, v79
  v_fma_f32 v79, v8, v135, v79
  v_fma_f32 v79, v10, v147, v79
  v_mul_f32 v80, v4, v112
  v_fma_f32 v80, v6, v124, v80
  v_fma_f32 v80, v8, v136, v80
  v_fma_f32 v80, v10, v148, v80
  v_mul_f32 v81, v4, v113
  v_fma_f32 v81, v6, v125, v81
  v_fma_f32 v81, v8, v137, v81
  v_fma_f32 v81, v10, v149, v81
  v_mul_f32 v82, v4, v114
  v_fma_f32 v82, v6, v126, v82
  v_fma_f32 v82, v8, v138, v82
  v_fma_f32 v82, v10, v150, v82
  v_mul_f32 v83, v4, v115
  v_fma_f32 v83, v6, v127, v83
  v_fma_f32 v83, v8, v139, v83
  v_fma_f32 v83, v10, v151, v83
  v_mul_f32 v84, v4, v116
  v_fma_f32 v84, v6, v128, v84
  v_fma_f32 v84, v8, v140, v84
  v_fma_f32 v84, v10, v152, v84
  v_mul_f32 v85, v4, v117
  v_fma_f32 v85, v6, v129, v85
  v_fma_f32 v85, v8, v141, v85
  v_fma_f32 v85, v10, v153, v85
  v_mul_f32 v86, v4, v118
  v_fma_f32 v86, v6, v130, v86
  v_fma_f32 v86, v8, v142, v86
  v_fma_f32 v86, v10, v154, v86
  v_mul_f32 v87, v4, v119
  v_fma_f32 v87, v6, v131, v87
  v_fma_f32 v87, v8, v143, v87
  v_fma_f32 v87, v10, v155, v87
  buffer_store_dwordx4 v[76:79], v95, s[40:43], s70 offen offset:0
  buffer_store_dwordx4 v[80:83], v95, s[40:43], s70 offen offset:1024
  buffer_store_dwordx4 v[84:87], v95, s[40:43], s70 offen offset:2048
  buffer_store_dwordx2 v[92:93], v94, s[40:43], s70 offen offset:3072
L_fin:
L_end:
  s_endpgm
.globl merge_partials_kernel
.p2align 8
.type merge_partials_kernel,@function
merge_partials_kernel:
  s_cmp_ge_u32 s2, 256
  s_cbranch_scc1 L2_end
  s_load_dwordx2 s[4:5], s[0:1], 56
  s_load_dwordx2 s[8:9], s[0:1], 72
  v_lshlrev_b32 v1, 4, v0
  v_lshrrev_b32 v2, 4, v0
  v_lshlrev_b32 v3, 3, v2
  v_mul_u32_u24 v2, 384, v2
  v_and_b32 v4, 15, v0
  v_lshl_add_u32 v2, v4, 3, v2
  s_mul_i32 s12, s2, 9984
  s_add_u32 s12, s12, 1048576
  s_add_u32 s13, s12, 3328
  s_add_u32 s14, s13, 3328
  s_mul_i32 s15, s2, 1536
  s_mov_b32 s6, 393216
  s_mov_b32 s7, 0x20000
  s_mov_b32 s10, 3604480
  s_mov_b32 s11, 0x20000
  s_waitcnt lgkmcnt(0)
  s_and_b32 s5, s5, 0xffff
  s_and_b32 s9, s9, 0xffff
  buffer_load_dwordx2 v[8:9], v3, s[8:11], s12 offen offset:3072
  buffer_load_dwordx4 v[16:19], v1, s[8:11], s12 offen offset:0
  buffer_load_dwordx4 v[20:23], v1, s[8:11], s12 offen offset:1024
  buffer_load_dwordx4 v[24:27], v1, s[8:11], s12 offen offset:2048
  buffer_load_dwordx2 v[10:11], v3, s[8:11], s13 offen offset:3072
  buffer_load_dwordx4 v[28:31], v1, s[8:11], s13 offen offset:0
  buffer_load_dwordx4 v[32:35], v1, s[8:11], s13 offen offset:1024
  buffer_load_dwordx4 v[36:39], v1, s[8:11], s13 offen offset:2048
  buffer_load_dwordx2 v[12:13], v3, s[8:11], s14 offen offset:3072
  buffer_load_dwordx4 v[40:43], v1, s[8:11], s14 offen offset:0
  buffer_load_dwordx4 v[44:47], v1, s[8:11], s14 offen offset:1024
  buffer_load_dwordx4 v[48:51], v1, s[8:11], s14 offen offset:2048
  s_waitcnt vmcnt(0)
  v_min_f32 v6, v8, v10
  v_min_f32 v6, v6, v12
  v_sub_f32 v8, v6, v8
  v_sub_f32 v10, v6, v10
  v_sub_f32 v12, v6, v12
  v_exp_f32 v8, v8
  v_exp_f32 v10, v10
  v_exp_f32 v12, v12
  v_mul_f32 v7, v8, v9
  v_fma_f32 v7, v10, v11, v7
  v_fma_f32 v7, v12, v13, v7
  v_mul_f32 v52, v8, v16
  v_fma_f32 v52, v10, v28, v52
  v_fma_f32 v52, v12, v40, v52
  v_mul_f32 v53, v8, v17
  v_fma_f32 v53, v10, v29, v53
  v_fma_f32 v53, v12, v41, v53
  v_mul_f32 v54, v8, v18
  v_fma_f32 v54, v10, v30, v54
  v_fma_f32 v54, v12, v42, v54
  v_mul_f32 v55, v8, v19
  v_fma_f32 v55, v10, v31, v55
  v_fma_f32 v55, v12, v43, v55
  v_mul_f32 v56, v8, v20
  v_fma_f32 v56, v10, v32, v56
  v_fma_f32 v56, v12, v44, v56
  v_mul_f32 v57, v8, v21
  v_fma_f32 v57, v10, v33, v57
  v_fma_f32 v57, v12, v45, v57
  v_mul_f32 v58, v8, v22
  v_fma_f32 v58, v10, v34, v58
  v_fma_f32 v58, v12, v46, v58
  v_mul_f32 v59, v8, v23
  v_fma_f32 v59, v10, v35, v59
  v_fma_f32 v59, v12, v47, v59
  v_mul_f32 v60, v8, v24
  v_fma_f32 v60, v10, v36, v60
  v_fma_f32 v60, v12, v48, v60
  v_mul_f32 v61, v8, v25
  v_fma_f32 v61, v10, v37, v61
  v_fma_f32 v61, v12, v49, v61
  v_mul_f32 v62, v8, v26
  v_fma_f32 v62, v10, v38, v62
  v_fma_f32 v62, v12, v50, v62
  v_mul_f32 v63, v8, v27
  v_fma_f32 v63, v10, v39, v63
  v_fma_f32 v63, v12, v51, v63
  v_rcp_f32 v7, v7
  s_nop 0
  v_mul_f32 v52, v7, v52
  v_mul_f32 v53, v7, v53
  v_mul_f32 v54, v7, v54
  v_mul_f32 v55, v7, v55
  v_mul_f32 v56, v7, v56
  v_mul_f32 v57, v7, v57
  v_mul_f32 v58, v7, v58
  v_mul_f32 v59, v7, v59
  v_mul_f32 v60, v7, v60
  v_mul_f32 v61, v7, v61
  v_mul_f32 v62, v7, v62
  v_mul_f32 v63, v7, v63
  v_cvt_pk_bf16_f32 v52, v52, v53
  v_cvt_pk_bf16_f32 v53, v54, v55
  buffer_store_dwordx2 v[52:53], v2, s[4:7], s15 offen offset:0
  v_cvt_pk_bf16_f32 v56, v56, v57
  v_cvt_pk_bf16_f32 v57, v58, v59
  buffer_store_dwordx2 v[56:57], v2, s[4:7], s15 offen offset:128
  v_cvt_pk_bf16_f32 v60, v60, v61
  v_cvt_pk_bf16_f32 v61, v62, v63
  buffer_store_dwordx2 v[60:61], v2, s[4:7], s15 offen offset:256
L2_end:
  s_endpgm
.section .rodata,"a"
.p2align 6
.amdhsa_kernel standalone__kv_cache_quant_int4_int2_kv_with_per_channel_or_per_token_scales__sampling_kernel
  .amdhsa_next_free_vgpr 184
  .amdhsa_next_free_sgpr 96
  .amdhsa_accum_offset 184
  .amdhsa_group_segment_fixed_size 0
  .amdhsa_kernarg_size 80
  .amdhsa_user_sgpr_count 2
  .amdhsa_user_sgpr_kernarg_segment_ptr 1
  .amdhsa_system_sgpr_workgroup_id_x 1
  .amdhsa_float_denorm_mode_32 3
.end_amdhsa_kernel
.p2align 6
.amdhsa_kernel merge_partials_kernel
  .amdhsa_next_free_vgpr 64
  .amdhsa_next_free_sgpr 24
  .amdhsa_accum_offset 64
  .amdhsa_group_segment_fixed_size 0
  .amdhsa_kernarg_size 80
  .amdhsa_user_sgpr_count 2
  .amdhsa_user_sgpr_kernarg_segment_ptr 1
  .amdhsa_system_sgpr_workgroup_id_x 1
  .amdhsa_float_denorm_mode_32 3
.end_amdhsa_kernel
```

```asm
; @launch kernel=standalone__kv_cache_quant_int4_int2_kv_with_per_channel_or_per_token_scales__sampling_kernel grid=(256,1,1) block=(192,1,1) lds=87040
; @launch kernel=merge_partials_kernel grid=(256,1,1) block=(64,1,1) lds=0
.amdgcn_target "amdgcn-amd-amdhsa--gfx950"
.text
.globl standalone__kv_cache_quant_int4_int2_kv_with_per_channel_or_per_token_scales__sampling_kernel
.p2align 8
.type standalone__kv_cache_quant_int4_int2_kv_with_per_channel_or_per_token_scales__sampling_kernel,@function
standalone__kv_cache_quant_int4_int2_kv_with_per_channel_or_per_token_scales__sampling_kernel:
  s_cmp_ge_u32 s2, 256
  s_cbranch_scc1 L_end
  s_load_dwordx16 s[44:59], s[0:1], 0
  s_load_dwordx4 s[80:83], s[0:1], 64
  v_lshrrev_b32 v1, 6, v0
  v_and_b32 v0, 63, v0
  v_readfirstlane_b32 s3, v1
  s_bfe_u32 s4, s2, 0x10002
  s_lshr_b32 s5, s2, 3
  s_lshl_b32 s5, s5, 2
  s_and_b32 s70, s2, 3
  s_add_u32 s5, s5, s70
  s_lshl_b32 s5, s5, 5
  s_cmp_eq_u32 s3, 2
  s_cbranch_scc1 L_helper
  v_and_b32 v112, 3, v0
  v_bfe_u32 v113, v0, 2, 2
  v_lshrrev_b32 v114, 4, v0
  v_and_b32 v115, 15, v0
  v_lshlrev_b32 v148, 4, v112
  v_lshl_add_u32 v148, v114, 6, v148
  v_lshrrev_b32 v237, 1, v148
  v_and_b32 v235, 2, v113
  v_lshlrev_b32 v234, 5, v235
  v_add_u32 v234, 129, v234
  v_and_b32 v149, 1, v113
  v_lshl_add_u32 v235, v149, 2, v235
  v_mul_u32_u24 v149, 33024, v149
  v_add_u32 v236, v148, v149
  v_subrev_u32 v236, 33024, v236
  v_mul_u32_u24 v149, 384, v113
  v_add_u32 v239, v149, v237
  v_mov_b32 v108, 2147483632
  s_mov_b32 s90, 0xaaaaaaab
  s_mov_b32 s91, 0x492492
  s_movk_i32 s63, 768
  s_mov_b32 s64, s3
  s_mov_b32 s97, 16
  s_mov_b32 s99, 16
  s_mov_b32 s96, 0
  s_waitcnt lgkmcnt(0)
  s_mov_b32 s8, s46
  s_and_b32 s9, s47, 0xffff
  s_mov_b32 s10, 805306368
  s_mov_b32 s11, 0x20000
  s_mov_b32 s20, s50
  s_and_b32 s21, s51, 0xffff
  s_mov_b32 s22, 6291456
  s_mov_b32 s23, 0x20000
  s_mov_b32 s24, s52
  s_and_b32 s25, s53, 0xffff
  s_mov_b32 s26, 6291456
  s_mov_b32 s27, 0x20000
  s_mov_b32 s36, s44
  s_and_b32 s37, s45, 0xffff
  s_mov_b32 s38, 393216
  s_mov_b32 s39, 0x20000
  s_mov_b32 s16, s46
  s_and_b32 s17, s47, 0xffff
  s_mov_b32 s18, 805306368
  s_mov_b32 s19, 0x20000
  s_mov_b32 s12, s48
  s_and_b32 s13, s49, 0xffff
  s_mov_b32 s14, 805306368
  s_mov_b32 s15, 0x20000
  s_mov_b32 s28, s54
  s_and_b32 s29, s55, 0xffff
  s_mov_b32 s30, 2097152
  s_mov_b32 s31, 0x20000
  s_mov_b32 s32, s56
  s_and_b32 s33, s57, 0xffff
  s_mov_b32 s34, 2097152
  s_mov_b32 s35, 0x20000
  s_mov_b32 s40, s82
  s_and_b32 s41, s83, 0xffff
  s_mov_b32 s42, 25165824
  s_mov_b32 s43, 0x20000
  s_mov_b32 s56, 0x0f0f0f0f
  s_mov_b32 s57, 0x0f0f0f0f
  s_mov_b32 s58, 0xffff
  s_mov_b32 s59, 0xffff
  s_andn2_b32 s70, s64, 1
  s_or_b32 s70, s70, s4
  s_lshr_b32 s71, s64, 5
  s_lshr_b32 s85, s96, s71
  s_cmp_lt_u32 s64, s97
  s_cselect_b32 s70, s70, s64
  s_cselect_b32 s85, s64, s85
  s_and_b32 s85, s85, 1
  s_mul_i32 s71, s71, 4064
  s_add_u32 s70, s70, s71
  s_add_u32 s70, s70, s5
  s_mul_hi_u32 s84, s70, s90
  s_lshr_b32 s84, s84, 1
  s_mul_i32 s71, s84, 3
  s_sub_u32 s70, s70, s71
  s_lshl3_add_u32 s85, s70, s85
  s_mul_i32 s61, s84, 196608
  s_lshr_b32 s89, s84, 4
  s_lshl_b32 s70, s85, 5
  v_add_u32 v100, s70, v234
  v_mul_u32_u24 v100, 21846, v100
  v_lshrrev_b32 v100, 16, v100
  v_add_u32 v148, s85, v235
  v_lshrrev_b32 v149, v148, s91
  v_and_b32 v149, 1, v149
  v_cmp_eq_u32 s[54:55], 1, v149
  s_nop 1
  s_and_b64 s[52:53], s[54:55], s[56:57]
  s_andn2_b64 s[54:55], s[54:55], s[56:57]
  v_mul_u32_u24 v148, 43, v148
  v_lshrrev_b32 v148, 8, v148
  v_mul_u32_u24 v148, 384, v148
  v_add_u32 v238, v148, v237
  v_mad_u32_u24 v92, v100, s63, v236
  v_add_u32 v93, 768, v92
  v_add_u32 v94, 4608, v92
  v_add_u32 v95, 7680, v92
  v_cndmask_b32 v92, v92, v108, s[52:53]
  v_cndmask_b32 v95, v95, v108, s[54:55]
  s_mov_b32 s60, s61
  s_mov_b32 s88, s89
  s_mul_i32 s62, s84, 1536
  buffer_load_dwordx2 v[184:185], v238, s[20:23], s62 offen offset:0
  buffer_load_dwordx2 v[190:191], v238, s[24:27], s62 offen offset:0
  buffer_load_dwordx2 v[186:187], v238, s[20:23], s62 offen offset:128
  buffer_load_dwordx2 v[192:193], v238, s[24:27], s62 offen offset:128
  buffer_load_dwordx2 v[188:189], v238, s[20:23], s62 offen offset:256
  buffer_load_dwordx2 v[194:195], v238, s[24:27], s62 offen offset:256
  s_mul_i32 s70, s89, 1536
  buffer_load_dwordx2 v[178:179], v239, s[36:39], s70 offen offset:0
  buffer_load_dwordx2 v[180:181], v239, s[36:39], s70 offen offset:128
  buffer_load_dwordx2 v[182:183], v239, s[36:39], s70 offen offset:256
  buffer_load_dwordx4 v[4:7], v92, s[8:11], s60 offen offset:0 nt
  buffer_load_dwordx4 v[8:11], v92, s[8:11], s60 offen offset:256 nt
  buffer_load_dwordx4 v[12:15], v92, s[8:11], s60 offen offset:512 nt
  buffer_load_dwordx4 v[16:19], v93, s[8:11], s60 offen offset:0 nt
  buffer_load_dwordx4 v[20:23], v93, s[8:11], s60 offen offset:256 nt
  buffer_load_dwordx4 v[24:27], v93, s[8:11], s60 offen offset:512 nt
  buffer_load_dwordx4 v[28:31], v93, s[8:11], s60 offen offset:768 nt
  buffer_load_dwordx4 v[32:35], v93, s[8:11], s60 offen offset:1024 nt
  buffer_load_dwordx4 v[36:39], v93, s[8:11], s60 offen offset:1280 nt
  buffer_load_dwordx4 v[40:43], v93, s[8:11], s60 offen offset:1536 nt
  buffer_load_dwordx4 v[44:47], v93, s[8:11], s60 offen offset:1792 nt
  buffer_load_dwordx4 v[48:51], v93, s[8:11], s60 offen offset:2048 nt
  buffer_load_dwordx4 v[52:55], v93, s[8:11], s60 offen offset:2304 nt
  buffer_load_dwordx4 v[56:59], v93, s[8:11], s60 offen offset:2560 nt
  buffer_load_dwordx4 v[60:63], v93, s[8:11], s60 offen offset:2816 nt
  s_mov_b64 vcc, 0
  v_lshlrev_b32 v148, 4, v115
  v_and_b32 v97, 2, v114
  v_lshlrev_b32 v96, 5, v97
  v_add_u32 v96, 129, v96
  v_and_b32 v149, 1, v114
  v_lshl_add_u32 v97, v149, 2, v97
  v_mul_u32_u24 v149, 33024, v149
  v_add_u32 v98, v148, v149
  v_subrev_u32 v98, 33024, v98
  v_and_b32 v149, 1, v114
  v_mul_u32_u24 v149, 86, v149
  v_lshl_add_u32 v99, v115, 1, v149
  v_subrev_u32 v99, 86, v99
  v_lshlrev_b32 v104, 4, v114
  v_lshrrev_b32 v148, 2, v0
  s_mul_i32 s70, s3, 384
  v_lshl_add_u32 v102, v148, 4, s70
  v_lshl_add_u32 v103, v148, 3, s70
  s_mul_i32 s70, s3, 3072
  s_add_u32 s70, s70, 36864
  v_lshl_add_u32 v105, v0, 4, s70
  s_lshl_b32 s70, s3, 5
  s_add_u32 s70, s70, 43008
  v_lshl_add_u32 v106, v113, 3, s70
  s_lshl_b32 s70, s3, 2
  s_add_u32 s70, s70, 61712
  v_mov_b32 v107, s70
  v_mov_b32 v109, 61704
  v_mov_b32 v116, 0
  v_mov_b32 v117, 0
  v_mov_b32 v240, 0xff800000
  s_mov_b32 s65, 0xffff0000
  s_mov_b32 s66, 0x3fb8aa3b
  s_mov_b32 s68, 0x4893cd3a
  s_mov_b32 s92, 0x7f000000
  s_mov_b32 s94, 0x34800000
  s_mov_b32 s69, 0x4893cd3a
  s_mov_b32 s93, 0x7f000000
  s_mov_b32 s95, 0x34800000
  s_mov_b32 s72, 0x11111111
  s_mov_b32 s73, 0x11111111
  s_mov_b32 s44, 0
  s_mov_b32 s74, 0x22222222
  s_mov_b32 s75, 0x22222222
  s_mov_b32 s45, 0
  s_mov_b32 s76, 0x44444444
  s_mov_b32 s77, 0x44444444
  s_mov_b32 s46, 0
  s_mov_b32 s78, 0x88888888
  s_mov_b32 s79, 0x88888888
  s_mov_b32 s47, 0
  s_mov_b32 s100, 0
  v_mov_b32 v132, 0
  v_mov_b32 v133, 0
  v_mov_b32 v134, 0
  v_mov_b32 v135, 0
  v_mov_b32 v136, 0
  v_mov_b32 v137, 0
  v_mov_b32 v138, 0
  v_mov_b32 v139, 0
  v_mov_b32 v140, 0
  v_mov_b32 v141, 0
  v_mov_b32 v142, 0
  v_mov_b32 v143, 0
  v_mov_b32 v144, 0xff800000
  v_mov_b32 v146, 0x7f800000
  v_mov_b32 v147, 0
  s_barrier
L_k:
  v_add_u32 v148, s85, v97
  v_lshrrev_b32 v149, v148, s91
  v_and_b32 v149, 1, v149
  v_cmp_eq_u32 s[50:51], 1, v149
  s_nop 1
  s_and_b64 s[48:49], s[50:51], s[58:59]
  s_andn2_b64 s[50:51], s[50:51], s[58:59]
  s_add_u32 s64, s64, 2
  s_cmp_lt_u32 s64, s99
  s_cbranch_scc1 L_k_known0
L_k_spin0:
  v_mov_b32 v148, 61696
  ds_read_b32 v148, v148
  s_waitcnt lgkmcnt(0)
  v_readfirstlane_b32 s96, v148
  s_nop 1
  s_cmp_eq_u32 s96, 0
  s_cbranch_scc1 L_k_spin0
  s_mov_b32 s99, -1
  s_bitcmp1_b32 s96, 6
  s_cselect_b32 s97, 255, s97
L_k_known0:
  s_andn2_b32 s70, s64, 1
  s_or_b32 s70, s70, s4
  s_lshr_b32 s71, s64, 5
  s_lshr_b32 s85, s96, s71
  s_cmp_lt_u32 s64, s97
  s_cselect_b32 s70, s70, s64
  s_cselect_b32 s85, s64, s85
  s_and_b32 s85, s85, 1
  s_mul_i32 s71, s71, 4064
  s_add_u32 s70, s70, s71
  s_add_u32 s70, s70, s5
  s_mul_hi_u32 s84, s70, s90
  s_lshr_b32 s84, s84, 1
  s_mul_i32 s71, s84, 3
  s_sub_u32 s70, s70, s71
  s_lshl3_add_u32 s85, s70, s85
  s_mul_i32 s61, s84, 196608
  s_lshr_b32 s89, s84, 4
  s_lshl_b32 s70, s85, 5
  v_add_u32 v100, s70, v234
  v_mul_u32_u24 v100, 21846, v100
  v_lshrrev_b32 v100, 16, v100
  v_add_u32 v148, s85, v235
  v_lshrrev_b32 v149, v148, s91
  v_and_b32 v149, 1, v149
  v_cmp_eq_u32 s[54:55], 1, v149
  s_nop 1
  s_and_b64 s[52:53], s[54:55], s[56:57]
  s_andn2_b64 s[54:55], s[54:55], s[56:57]
  v_mul_u32_u24 v148, 43, v148
  v_lshrrev_b32 v148, 8, v148
  v_mul_u32_u24 v148, 384, v148
  v_add_u32 v238, v148, v237
  ds_read_b32 v110, v109
  s_waitcnt vmcnt(14)
  s_cbranch_vccnz L_kw0_0
  s_waitcnt vmcnt(10)
L_kw0_0:
  buffer_load_dwordx4 v[64:67], v93, s[8:11], s60 offen offset:3072 nt
  v_lshlrev_b32 v208, 16, v190
  v_and_b32 v209, s65, v190
  v_lshlrev_b32 v210, 16, v191
  v_and_b32 v211, s65, v191
  v_lshlrev_b32 v196, 16, v184
  v_and_b32 v197, s65, v184
  v_lshlrev_b32 v198, 16, v185
  v_and_b32 v199, s65, v185
  v_pk_mul_f32 v[208:209], v[208:209], s[94:95]
  v_mov_b32 v172, v178
  v_pk_mul_f32 v[210:211], v[210:211], s[94:95]
  v_mov_b32 v173, v179
  v_pk_fma_f32 v[112:113], v[4:5], s[92:93], v[208:209] neg_lo:[0,0,1] neg_hi:[0,0,1]
  v_pk_fma_f32 v[114:115], v[6:7], s[92:93], v[210:211] neg_lo:[0,0,1] neg_hi:[0,0,1]
  v_cvt_pk_bf16_f32 v112, 0, v112
  v_cvt_pk_bf16_f32 v113, 0, v113
  v_cvt_pk_bf16_f32 v114, 0, v114
  v_cvt_pk_bf16_f32 v115, 0, v115
  v_pk_mul_f32 v[112:113], v[112:113], v[196:197]
  v_pk_mul_f32 v[114:115], v[114:115], v[198:199]
  v_cvt_pk_bf16_f32 v220, v112, v113
  v_cvt_pk_bf16_f32 v221, v114, v115
  s_waitcnt lgkmcnt(0)
  s_sub_u32 s70, s64, 2
  v_cmp_lt_u32 vcc, s70, v110
  s_waitcnt vmcnt(14)
  s_cbranch_vccnz L_kw0_1
  s_waitcnt vmcnt(10)
L_kw0_1:
  buffer_load_dwordx4 v[68:71], v93, s[8:11], s60 offen offset:3328 nt
  v_lshlrev_b32 v212, 16, v192
  v_and_b32 v213, s65, v192
  v_lshlrev_b32 v214, 16, v193
  v_and_b32 v215, s65, v193
  v_lshlrev_b32 v200, 16, v186
  v_and_b32 v201, s65, v186
  v_lshlrev_b32 v202, 16, v187
  v_and_b32 v203, s65, v187
  v_pk_mul_f32 v[212:213], v[212:213], s[94:95]
  v_mov_b32 v174, v180
  v_pk_mul_f32 v[214:215], v[214:215], s[94:95]
  v_mov_b32 v175, v181
  v_pk_fma_f32 v[112:113], v[8:9], s[92:93], v[212:213] neg_lo:[0,0,1] neg_hi:[0,0,1]
  v_pk_fma_f32 v[114:115], v[10:11], s[92:93], v[214:215] neg_lo:[0,0,1] neg_hi:[0,0,1]
  v_cvt_pk_bf16_f32 v112, 0, v112
  v_cvt_pk_bf16_f32 v113, 0, v113
  v_cvt_pk_bf16_f32 v114, 0, v114
  v_cvt_pk_bf16_f32 v115, 0, v115
  v_pk_mul_f32 v[112:113], v[112:113], v[200:201]
  v_pk_mul_f32 v[114:115], v[114:115], v[202:203]
  v_cvt_pk_bf16_f32 v222, v112, v113
  v_cvt_pk_bf16_f32 v223, v114, v115
  s_waitcnt vmcnt(14)
  s_cbranch_vccnz L_kw0_2
  s_waitcnt vmcnt(10)
L_kw0_2:
  buffer_load_dwordx4 v[72:75], v93, s[8:11], s60 offen offset:3584 nt
  v_mfma_f32_16x16x32_bf16 v[228:231], v[220:223], v[172:175], 0
  v_lshlrev_b32 v216, 16, v194
  v_and_b32 v217, s65, v194
  v_lshlrev_b32 v218, 16, v195
  v_and_b32 v219, s65, v195
  v_lshlrev_b32 v204, 16, v188
  v_and_b32 v205, s65, v188
  v_lshlrev_b32 v206, 16, v189
  v_and_b32 v207, s65, v189
  v_pk_mul_f32 v[216:217], v[216:217], s[94:95]
  v_mov_b32 v176, v182
  v_pk_mul_f32 v[218:219], v[218:219], s[94:95]
  v_mov_b32 v177, v183
  v_pk_fma_f32 v[112:113], v[12:13], s[92:93], v[216:217] neg_lo:[0,0,1] neg_hi:[0,0,1]
  v_pk_fma_f32 v[114:115], v[14:15], s[92:93], v[218:219] neg_lo:[0,0,1] neg_hi:[0,0,1]
  v_cvt_pk_bf16_f32 v112, 0, v112
  v_cvt_pk_bf16_f32 v113, 0, v113
  v_cvt_pk_bf16_f32 v114, 0, v114
  v_cvt_pk_bf16_f32 v115, 0, v115
  v_pk_mul_f32 v[112:113], v[112:113], v[204:205]
  v_pk_mul_f32 v[114:115], v[114:115], v[206:207]
  v_cvt_pk_bf16_f32 v224, v112, v113
  v_cvt_pk_bf16_f32 v225, v114, v115
  s_waitcnt vmcnt(14)
  s_cbranch_vccnz L_kw0_3
  s_waitcnt vmcnt(10)
L_kw0_3:
  buffer_load_dwordx4 v[76:79], v94, s[8:11], s60 offen offset:0 nt
  v_mfma_f32_16x16x16_bf16 v[228:231], v[224:225], v[176:177], v[228:231]
  v_pk_fma_f32 v[112:113], v[16:17], s[92:93], v[208:209] neg_lo:[0,0,1] neg_hi:[0,0,1]
  v_pk_fma_f32 v[114:115], v[18:19], s[92:93], v[210:211] neg_lo:[0,0,1] neg_hi:[0,0,1]
  s_cmp_eq_u32 s89, s88
  s_cbranch_scc1 L_k_sameq0
  s_mul_i32 s70, s89, 1536
  buffer_load_dwordx2 v[178:179], v239, s[36:39], s70 offen offset:0
  buffer_load_dwordx2 v[180:181], v239, s[36:39], s70 offen offset:128
  buffer_load_dwordx2 v[182:183], v239, s[36:39], s70 offen offset:256
  s_mov_b32 s88, s89
L_k_sameq0:
  s_mul_i32 s62, s84, 1536
  buffer_load_dwordx2 v[184:185], v238, s[20:23], s62 offen offset:0
  buffer_load_dwordx2 v[190:191], v238, s[24:27], s62 offen offset:0
  buffer_load_dwordx2 v[186:187], v238, s[20:23], s62 offen offset:128
  buffer_load_dwordx2 v[192:193], v238, s[24:27], s62 offen offset:128
  buffer_load_dwordx2 v[188:189], v238, s[20:23], s62 offen offset:256
  buffer_load_dwordx2 v[194:195], v238, s[24:27], s62 offen offset:256
  v_cvt_pk_bf16_f32 v112, 0, v112
  v_cvt_pk_bf16_f32 v113, 0, v113
  v_cvt_pk_bf16_f32 v114, 0, v114
  v_cvt_pk_bf16_f32 v115, 0, v115
  v_pk_mul_f32 v[112:113], v[112:113], v[196:197]
  v_pk_mul_f32 v[114:115], v[114:115], v[198:199]
  v_cvt_pk_bf16_f32 v220, v112, v113
  v_cvt_pk_bf16_f32 v221, v114, v115
  s_waitcnt vmcnt(20)
  s_cbranch_vccnz L_kw0_4
  s_waitcnt vmcnt(16)
L_kw0_4:
  buffer_load_dwordx4 v[80:83], v94, s[8:11], s60 offen offset:256 nt
  v_pk_fma_f32 v[112:113], v[20:21], s[92:93], v[212:213] neg_lo:[0,0,1] neg_hi:[0,0,1]
  v_pk_fma_f32 v[114:115], v[22:23], s[92:93], v[214:215] neg_lo:[0,0,1] neg_hi:[0,0,1]
  v_mov_b32_dpp v148, v228 quad_perm:[0,0,0,0] row_mask:0xf bank_mask:0xf
  v_mov_b32_dpp v149, v230 quad_perm:[2,2,2,2] row_mask:0xf bank_mask:0xf
  v_cvt_pk_bf16_f32 v112, 0, v112
  v_cvt_pk_bf16_f32 v113, 0, v113
  v_add_f32_dpp v148, v229, v148 quad_perm:[1,1,1,1] row_mask:0xf bank_mask:0xf
  v_add_f32_dpp v149, v231, v149 quad_perm:[3,3,3,3] row_mask:0xf bank_mask:0xf
  v_cvt_pk_bf16_f32 v114, 0, v114
  v_cvt_pk_bf16_f32 v115, 0, v115
  v_add_f32 v232, v148, v149
  v_pk_mul_f32 v[112:113], v[112:113], v[200:201]
  v_pk_mul_f32 v[114:115], v[114:115], v[202:203]
  v_cvt_pk_bf16_f32 v222, v112, v113
  v_cvt_pk_bf16_f32 v223, v114, v115
  s_waitcnt vmcnt(20)
  s_cbranch_vccnz L_kw0_5
  s_waitcnt vmcnt(16)
L_kw0_5:
  buffer_load_dwordx4 v[84:87], v94, s[8:11], s60 offen offset:512 nt
  v_mfma_f32_16x16x32_bf16 v[228:231], v[220:223], v[172:175], 0
  v_pk_fma_f32 v[112:113], v[24:25], s[92:93], v[216:217] neg_lo:[0,0,1] neg_hi:[0,0,1]
  v_pk_fma_f32 v[114:115], v[26:27], s[92:93], v[218:219] neg_lo:[0,0,1] neg_hi:[0,0,1]
  v_cvt_pk_bf16_f32 v112, 0, v112
  v_cndmask_b32 v232, v232, v240, s[48:49]
  v_cvt_pk_bf16_f32 v113, 0, v113
  v_cvt_pk_bf16_f32 v114, 0, v114
  v_cvt_pk_bf16_f32 v115, 0, v115
  v_pk_mul_f32 v[112:113], v[112:113], v[204:205]
  v_pk_mul_f32 v[114:115], v[114:115], v[206:207]
  v_cvt_pk_bf16_f32 v224, v112, v113
  v_cvt_pk_bf16_f32 v225, v114, v115
  s_waitcnt vmcnt(20)
  s_cbranch_vccnz L_kw0_6
  s_waitcnt vmcnt(16)
L_kw0_6:
  buffer_load_dwordx4 v[88:91], v94, s[8:11], s60 offen offset:768 nt
  v_mfma_f32_16x16x16_bf16 v[228:231], v[224:225], v[176:177], v[228:231]
  v_pk_fma_f32 v[112:113], v[28:29], s[92:93], v[208:209] neg_lo:[0,0,1] neg_hi:[0,0,1]
  v_pk_fma_f32 v[114:115], v[30:31], s[92:93], v[210:211] neg_lo:[0,0,1] neg_hi:[0,0,1]
  v_cvt_pk_bf16_f32 v112, 0, v112
  v_cvt_pk_bf16_f32 v113, 0, v113
  v_cvt_pk_bf16_f32 v114, 0, v114
  v_cvt_pk_bf16_f32 v115, 0, v115
  v_pk_mul_f32 v[112:113], v[112:113], v[196:197]
  v_pk_mul_f32 v[114:115], v[114:115], v[198:199]
  v_cvt_pk_bf16_f32 v220, v112, v113
  v_cvt_pk_bf16_f32 v221, v114, v115
  s_waitcnt vmcnt(20)
  s_cbranch_vccnz L_kw0_7
  s_waitcnt vmcnt(16)
L_kw0_7:
  buffer_load_dwordx4 v[4:7], v94, s[8:11], s60 offen offset:1024 nt
  v_pk_fma_f32 v[112:113], v[32:33], s[92:93], v[212:213] neg_lo:[0,0,1] neg_hi:[0,0,1]
  v_pk_fma_f32 v[114:115], v[34:35], s[92:93], v[214:215] neg_lo:[0,0,1] neg_hi:[0,0,1]
  v_mov_b32_dpp v148, v228 quad_perm:[0,0,0,0] row_mask:0xf bank_mask:0xf
  v_mov_b32_dpp v149, v230 quad_perm:[2,2,2,2] row_mask:0xf bank_mask:0xf
  v_cvt_pk_bf16_f32 v112, 0, v112
  v_cvt_pk_bf16_f32 v113, 0, v113
  v_add_f32_dpp v148, v229, v148 quad_perm:[1,1,1,1] row_mask:0xf bank_mask:0xf
  v_add_f32_dpp v149, v231, v149 quad_perm:[3,3,3,3] row_mask:0xf bank_mask:0xf
  v_cvt_pk_bf16_f32 v114, 0, v114
  v_cvt_pk_bf16_f32 v115, 0, v115
  v_add_f32 v233, v148, v149
  v_pk_mul_f32 v[112:113], v[112:113], v[200:201]
  v_pk_mul_f32 v[114:115], v[114:115], v[202:203]
  v_cvt_pk_bf16_f32 v222, v112, v113
  v_cvt_pk_bf16_f32 v223, v114, v115
  s_waitcnt vmcnt(20)
  s_cbranch_vccnz L_kw0_8
  s_waitcnt vmcnt(16)
L_kw0_8:
  buffer_load_dwordx4 v[8:11], v94, s[8:11], s60 offen offset:1280 nt
  v_mfma_f32_16x16x32_bf16 v[228:231], v[220:223], v[172:175], 0
  v_pk_fma_f32 v[112:113], v[36:37], s[92:93], v[216:217] neg_lo:[0,0,1] neg_hi:[0,0,1]
  v_pk_fma_f32 v[114:115], v[38:39], s[92:93], v[218:219] neg_lo:[0,0,1] neg_hi:[0,0,1]
  v_cvt_pk_bf16_f32 v112, 0, v112
  v_cvt_pk_bf16_f32 v232, 0, v232
  v_cvt_pk_bf16_f32 v113, 0, v113
  v_cvt_pk_bf16_f32 v233, 0, v233
  v_cvt_pk_bf16_f32 v114, 0, v114
  v_pk_mul_f32 v[232:233], v[232:233], s[68:69]
  v_cvt_pk_bf16_f32 v115, 0, v115
  v_cvt_pk_bf16_f32 v124, v232, v233
  v_pk_mul_f32 v[112:113], v[112:113], v[204:205]
  v_pk_mul_f32 v[114:115], v[114:115], v[206:207]
  v_cvt_pk_bf16_f32 v224, v112, v113
  v_cvt_pk_bf16_f32 v225, v114, v115
  s_waitcnt vmcnt(20)
  s_cbranch_vccnz L_kw0_9
  s_waitcnt vmcnt(16)
L_kw0_9:
  buffer_load_dwordx4 v[12:15], v94, s[8:11], s60 offen offset:1536 nt
  v_mfma_f32_16x16x16_bf16 v[228:231], v[224:225], v[176:177], v[228:231]
  v_pk_fma_f32 v[112:113], v[40:41], s[92:93], v[208:209] neg_lo:[0,0,1] neg_hi:[0,0,1]
  v_pk_fma_f32 v[114:115], v[42:43], s[92:93], v[210:211] neg_lo:[0,0,1] neg_hi:[0,0,1]
  v_cvt_pk_bf16_f32 v112, 0, v112
  v_cvt_pk_bf16_f32 v113, 0, v113
  v_cvt_pk_bf16_f32 v114, 0, v114
  v_cvt_pk_bf16_f32 v115, 0, v115
  v_pk_mul_f32 v[112:113], v[112:113], v[196:197]
  v_pk_mul_f32 v[114:115], v[114:115], v[198:199]
  v_cvt_pk_bf16_f32 v220, v112, v113
  v_cvt_pk_bf16_f32 v221, v114, v115
  s_waitcnt vmcnt(20)
  s_cbranch_vccnz L_kw0_10
  s_waitcnt vmcnt(16)
L_kw0_10:
  buffer_load_dwordx4 v[16:19], v94, s[8:11], s60 offen offset:1792 nt
  v_pk_fma_f32 v[112:113], v[44:45], s[92:93], v[212:213] neg_lo:[0,0,1] neg_hi:[0,0,1]
  v_pk_fma_f32 v[114:115], v[46:47], s[92:93], v[214:215] neg_lo:[0,0,1] neg_hi:[0,0,1]
  v_mov_b32_dpp v148, v228 quad_perm:[0,0,0,0] row_mask:0xf bank_mask:0xf
  v_mov_b32_dpp v149, v230 quad_perm:[2,2,2,2] row_mask:0xf bank_mask:0xf
  v_cvt_pk_bf16_f32 v112, 0, v112
  v_cvt_pk_bf16_f32 v113, 0, v113
  v_add_f32_dpp v148, v229, v148 quad_perm:[1,1,1,1] row_mask:0xf bank_mask:0xf
  v_add_f32_dpp v149, v231, v149 quad_perm:[3,3,3,3] row_mask:0xf bank_mask:0xf
  v_cvt_pk_bf16_f32 v114, 0, v114
  v_cvt_pk_bf16_f32 v115, 0, v115
  v_add_f32 v232, v148, v149
  v_pk_mul_f32 v[112:113], v[112:113], v[200:201]
  v_pk_mul_f32 v[114:115], v[114:115], v[202:203]
  v_cvt_pk_bf16_f32 v222, v112, v113
  v_cvt_pk_bf16_f32 v223, v114, v115
  s_waitcnt vmcnt(20)
  s_cbranch_vccnz L_kw0_11
  s_waitcnt vmcnt(16)
L_kw0_11:
  buffer_load_dwordx4 v[20:23], v94, s[8:11], s60 offen offset:2048 nt
  v_mfma_f32_16x16x32_bf16 v[228:231], v[220:223], v[172:175], 0
  v_pk_fma_f32 v[112:113], v[48:49], s[92:93], v[216:217] neg_lo:[0,0,1] neg_hi:[0,0,1]
  v_pk_fma_f32 v[114:115], v[50:51], s[92:93], v[218:219] neg_lo:[0,0,1] neg_hi:[0,0,1]
  v_cvt_pk_bf16_f32 v112, 0, v112
  v_cvt_pk_bf16_f32 v113, 0, v113
  v_cvt_pk_bf16_f32 v114, 0, v114
  v_cvt_pk_bf16_f32 v115, 0, v115
  v_pk_mul_f32 v[112:113], v[112:113], v[204:205]
  v_pk_mul_f32 v[114:115], v[114:115], v[206:207]
  v_cvt_pk_bf16_f32 v224, v112, v113
  v_cvt_pk_bf16_f32 v225, v114, v115
  s_waitcnt vmcnt(20)
  s_cbranch_vccnz L_kw0_12
  s_waitcnt vmcnt(16)
L_kw0_12:
  buffer_load_dwordx4 v[24:27], v94, s[8:11], s60 offen offset:2304 nt
  v_mfma_f32_16x16x16_bf16 v[228:231], v[224:225], v[176:177], v[228:231]
  v_pk_fma_f32 v[112:113], v[52:53], s[92:93], v[208:209] neg_lo:[0,0,1] neg_hi:[0,0,1]
  v_pk_fma_f32 v[114:115], v[54:55], s[92:93], v[210:211] neg_lo:[0,0,1] neg_hi:[0,0,1]
  v_cvt_pk_bf16_f32 v112, 0, v112
  v_cvt_pk_bf16_f32 v113, 0, v113
  v_cvt_pk_bf16_f32 v114, 0, v114
  v_cvt_pk_bf16_f32 v115, 0, v115
  v_pk_mul_f32 v[112:113], v[112:113], v[196:197]
  v_pk_mul_f32 v[114:115], v[114:115], v[198:199]
  v_cvt_pk_bf16_f32 v220, v112, v113
  v_cvt_pk_bf16_f32 v221, v114, v115
  s_waitcnt vmcnt(20)
  s_cbranch_vccnz L_kw0_13
  s_waitcnt vmcnt(16)
L_kw0_13:
  buffer_load_dwordx4 v[28:31], v94, s[8:11], s60 offen offset:2560 nt
  v_pk_fma_f32 v[112:113], v[56:57], s[92:93], v[212:213] neg_lo:[0,0,1] neg_hi:[0,0,1]
  v_pk_fma_f32 v[114:115], v[58:59], s[92:93], v[214:215] neg_lo:[0,0,1] neg_hi:[0,0,1]
  v_mov_b32_dpp v148, v228 quad_perm:[0,0,0,0] row_mask:0xf bank_mask:0xf
  v_mov_b32_dpp v149, v230 quad_perm:[2,2,2,2] row_mask:0xf bank_mask:0xf
  v_cvt_pk_bf16_f32 v112, 0, v112
  v_cvt_pk_bf16_f32 v113, 0, v113
  v_add_f32_dpp v148, v229, v148 quad_perm:[1,1,1,1] row_mask:0xf bank_mask:0xf
  v_add_f32_dpp v149, v231, v149 quad_perm:[3,3,3,3] row_mask:0xf bank_mask:0xf
  v_cvt_pk_bf16_f32 v114, 0, v114
  v_cvt_pk_bf16_f32 v115, 0, v115
  v_add_f32 v233, v148, v149
  v_pk_mul_f32 v[112:113], v[112:113], v[200:201]
  v_pk_mul_f32 v[114:115], v[114:115], v[202:203]
  v_cvt_pk_bf16_f32 v222, v112, v113
  v_cvt_pk_bf16_f32 v223, v114, v115
  s_waitcnt vmcnt(20)
  s_cbranch_vccnz L_kw0_14
  s_waitcnt vmcnt(16)
L_kw0_14:
  buffer_load_dwordx4 v[32:35], v94, s[8:11], s60 offen offset:2816 nt
  v_mfma_f32_16x16x32_bf16 v[228:231], v[220:223], v[172:175], 0
  v_pk_fma_f32 v[112:113], v[60:61], s[92:93], v[216:217] neg_lo:[0,0,1] neg_hi:[0,0,1]
  v_pk_fma_f32 v[114:115], v[62:63], s[92:93], v[218:219] neg_lo:[0,0,1] neg_hi:[0,0,1]
  v_cvt_pk_bf16_f32 v112, 0, v112
  v_cvt_pk_bf16_f32 v232, 0, v232
  v_cvt_pk_bf16_f32 v113, 0, v113
  v_cvt_pk_bf16_f32 v233, 0, v233
  v_cvt_pk_bf16_f32 v114, 0, v114
  v_pk_mul_f32 v[232:233], v[232:233], s[68:69]
  v_cvt_pk_bf16_f32 v115, 0, v115
  v_cvt_pk_bf16_f32 v125, v232, v233
  v_pk_mul_f32 v[112:113], v[112:113], v[204:205]
  v_pk_mul_f32 v[114:115], v[114:115], v[206:207]
  v_cvt_pk_bf16_f32 v224, v112, v113
  v_cvt_pk_bf16_f32 v225, v114, v115
  s_waitcnt vmcnt(20)
  s_cbranch_vccnz L_kw0_15
  s_waitcnt vmcnt(10)
L_kw0_15:
  buffer_load_dwordx4 v[36:39], v95, s[8:11], s60 offen offset:0 nt
  v_mfma_f32_16x16x16_bf16 v[228:231], v[224:225], v[176:177], v[228:231]
  v_pk_fma_f32 v[112:113], v[64:65], s[92:93], v[208:209] neg_lo:[0,0,1] neg_hi:[0,0,1]
  v_pk_fma_f32 v[114:115], v[66:67], s[92:93], v[210:211] neg_lo:[0,0,1] neg_hi:[0,0,1]
  v_cvt_pk_bf16_f32 v112, 0, v112
  v_cvt_pk_bf16_f32 v113, 0, v113
  v_cvt_pk_bf16_f32 v114, 0, v114
  v_cvt_pk_bf16_f32 v115, 0, v115
  v_pk_mul_f32 v[112:113], v[112:113], v[196:197]
  v_pk_mul_f32 v[114:115], v[114:115], v[198:199]
  v_cvt_pk_bf16_f32 v220, v112, v113
  v_cvt_pk_bf16_f32 v221, v114, v115
  s_waitcnt vmcnt(20)
  s_cbranch_vccnz L_kw0_16
  s_waitcnt vmcnt(10)
L_kw0_16:
  buffer_load_dwordx4 v[40:43], v95, s[8:11], s60 offen offset:256 nt
  v_pk_fma_f32 v[112:113], v[68:69], s[92:93], v[212:213] neg_lo:[0,0,1] neg_hi:[0,0,1]
  v_pk_fma_f32 v[114:115], v[70:71], s[92:93], v[214:215] neg_lo:[0,0,1] neg_hi:[0,0,1]
  v_mov_b32_dpp v148, v228 quad_perm:[0,0,0,0] row_mask:0xf bank_mask:0xf
  v_mov_b32_dpp v149, v230 quad_perm:[2,2,2,2] row_mask:0xf bank_mask:0xf
  v_cvt_pk_bf16_f32 v112, 0, v112
  v_cvt_pk_bf16_f32 v113, 0, v113
  v_add_f32_dpp v148, v229, v148 quad_perm:[1,1,1,1] row_mask:0xf bank_mask:0xf
  v_add_f32_dpp v149, v231, v149 quad_perm:[3,3,3,3] row_mask:0xf bank_mask:0xf
  v_cvt_pk_bf16_f32 v114, 0, v114
  v_cvt_pk_bf16_f32 v115, 0, v115
  v_add_f32 v232, v148, v149
  v_pk_mul_f32 v[112:113], v[112:113], v[200:201]
  v_pk_mul_f32 v[114:115], v[114:115], v[202:203]
  v_cvt_pk_bf16_f32 v222, v112, v113
  v_cvt_pk_bf16_f32 v223, v114, v115
  s_waitcnt vmcnt(20)
  s_cbranch_vccnz L_kw0_17
  s_waitcnt vmcnt(10)
L_kw0_17:
  buffer_load_dwordx4 v[44:47], v95, s[8:11], s60 offen offset:512 nt
  v_mfma_f32_16x16x32_bf16 v[228:231], v[220:223], v[172:175], 0
  v_pk_fma_f32 v[112:113], v[72:73], s[92:93], v[216:217] neg_lo:[0,0,1] neg_hi:[0,0,1]
  v_pk_fma_f32 v[114:115], v[74:75], s[92:93], v[218:219] neg_lo:[0,0,1] neg_hi:[0,0,1]
  v_cvt_pk_bf16_f32 v112, 0, v112
  v_cvt_pk_bf16_f32 v113, 0, v113
  v_cvt_pk_bf16_f32 v114, 0, v114
  v_cvt_pk_bf16_f32 v115, 0, v115
  v_pk_mul_f32 v[112:113], v[112:113], v[204:205]
  v_pk_mul_f32 v[114:115], v[114:115], v[206:207]
  v_cvt_pk_bf16_f32 v224, v112, v113
  v_cvt_pk_bf16_f32 v225, v114, v115
  v_mad_u32_u24 v92, v100, s63, v236
  v_add_u32 v93, 768, v92
  v_add_u32 v94, 4608, v92
  v_add_u32 v95, 7680, v92
  v_cndmask_b32 v92, v92, v108, s[52:53]
  v_cndmask_b32 v95, v95, v108, s[54:55]
  s_waitcnt vmcnt(20)
  s_cbranch_vccnz L_kw0_18
  s_waitcnt vmcnt(10)
L_kw0_18:
  buffer_load_dwordx4 v[48:51], v92, s[16:19], s61 offen offset:0 nt
  v_mfma_f32_16x16x16_bf16 v[228:231], v[224:225], v[176:177], v[228:231]
  v_pk_fma_f32 v[112:113], v[76:77], s[92:93], v[208:209] neg_lo:[0,0,1] neg_hi:[0,0,1]
  v_pk_fma_f32 v[114:115], v[78:79], s[92:93], v[210:211] neg_lo:[0,0,1] neg_hi:[0,0,1]
  v_cvt_pk_bf16_f32 v112, 0, v112
  v_cvt_pk_bf16_f32 v113, 0, v113
  v_cvt_pk_bf16_f32 v114, 0, v114
  v_cvt_pk_bf16_f32 v115, 0, v115
  v_pk_mul_f32 v[112:113], v[112:113], v[196:197]
  v_pk_mul_f32 v[114:115], v[114:115], v[198:199]
  v_cvt_pk_bf16_f32 v220, v112, v113
  v_cvt_pk_bf16_f32 v221, v114, v115
  s_waitcnt vmcnt(14)
  s_cbranch_vccnz L_kw0_19
  s_waitcnt vmcnt(10)
L_kw0_19:
  buffer_load_dwordx4 v[52:55], v92, s[16:19], s61 offen offset:256 nt
  v_pk_fma_f32 v[112:113], v[80:81], s[92:93], v[212:213] neg_lo:[0,0,1] neg_hi:[0,0,1]
  v_pk_fma_f32 v[114:115], v[82:83], s[92:93], v[214:215] neg_lo:[0,0,1] neg_hi:[0,0,1]
  v_mov_b32_dpp v148, v228 quad_perm:[0,0,0,0] row_mask:0xf bank_mask:0xf
  v_mov_b32_dpp v149, v230 quad_perm:[2,2,2,2] row_mask:0xf bank_mask:0xf
  v_cvt_pk_bf16_f32 v112, 0, v112
  v_cvt_pk_bf16_f32 v113, 0, v113
  v_add_f32_dpp v148, v229, v148 quad_perm:[1,1,1,1] row_mask:0xf bank_mask:0xf
  v_add_f32_dpp v149, v231, v149 quad_perm:[3,3,3,3] row_mask:0xf bank_mask:0xf
  v_cvt_pk_bf16_f32 v114, 0, v114
  v_cvt_pk_bf16_f32 v115, 0, v115
  v_add_f32 v233, v148, v149
  v_pk_mul_f32 v[112:113], v[112:113], v[200:201]
  v_pk_mul_f32 v[114:115], v[114:115], v[202:203]
  v_cvt_pk_bf16_f32 v222, v112, v113
  v_cvt_pk_bf16_f32 v223, v114, v115
  s_waitcnt vmcnt(14)
  s_cbranch_vccnz L_kw0_20
  s_waitcnt vmcnt(10)
L_kw0_20:
  buffer_load_dwordx4 v[56:59], v92, s[16:19], s61 offen offset:512 nt
  v_mfma_f32_16x16x32_bf16 v[228:231], v[220:223], v[172:175], 0
  v_pk_fma_f32 v[112:113], v[84:85], s[92:93], v[216:217] neg_lo:[0,0,1] neg_hi:[0,0,1]
  v_pk_fma_f32 v[114:115], v[86:87], s[92:93], v[218:219] neg_lo:[0,0,1] neg_hi:[0,0,1]
  v_cvt_pk_bf16_f32 v112, 0, v112
  v_cvt_pk_bf16_f32 v232, 0, v232
  v_cvt_pk_bf16_f32 v113, 0, v113
  v_cvt_pk_bf16_f32 v233, 0, v233
  v_cvt_pk_bf16_f32 v114, 0, v114
  v_pk_mul_f32 v[232:233], v[232:233], s[68:69]
  v_cvt_pk_bf16_f32 v115, 0, v115
  v_cvt_pk_bf16_f32 v126, v232, v233
  v_pk_mul_f32 v[112:113], v[112:113], v[204:205]
  v_pk_mul_f32 v[114:115], v[114:115], v[206:207]
  v_cvt_pk_bf16_f32 v224, v112, v113
  v_cvt_pk_bf16_f32 v225, v114, v115
  s_waitcnt vmcnt(14)
  s_cbranch_vccnz L_kw0_21
  s_waitcnt vmcnt(10)
L_kw0_21:
  buffer_load_dwordx4 v[60:63], v93, s[16:19], s61 offen offset:0 nt
  v_mfma_f32_16x16x16_bf16 v[228:231], v[224:225], v[176:177], v[228:231]
  v_pk_fma_f32 v[112:113], v[88:89], s[92:93], v[208:209] neg_lo:[0,0,1] neg_hi:[0,0,1]
  v_pk_fma_f32 v[114:115], v[90:91], s[92:93], v[210:211] neg_lo:[0,0,1] neg_hi:[0,0,1]
  v_cvt_pk_bf16_f32 v112, 0, v112
  v_cvt_pk_bf16_f32 v113, 0, v113
  v_cvt_pk_bf16_f32 v114, 0, v114
  v_cvt_pk_bf16_f32 v115, 0, v115
  v_pk_mul_f32 v[112:113], v[112:113], v[196:197]
  v_pk_mul_f32 v[114:115], v[114:115], v[198:199]
  v_cvt_pk_bf16_f32 v220, v112, v113
  v_cvt_pk_bf16_f32 v221, v114, v115
  s_waitcnt vmcnt(14)
  s_cbranch_vccnz L_kw0_22
  s_waitcnt vmcnt(10)
L_kw0_22:
  buffer_load_dwordx4 v[64:67], v93, s[16:19], s61 offen offset:256 nt
  v_pk_fma_f32 v[112:113], v[4:5], s[92:93], v[212:213] neg_lo:[0,0,1] neg_hi:[0,0,1]
  v_pk_fma_f32 v[114:115], v[6:7], s[92:93], v[214:215] neg_lo:[0,0,1] neg_hi:[0,0,1]
  v_mov_b32_dpp v148, v228 quad_perm:[0,0,0,0] row_mask:0xf bank_mask:0xf
  v_mov_b32_dpp v149, v230 quad_perm:[2,2,2,2] row_mask:0xf bank_mask:0xf
  v_cvt_pk_bf16_f32 v112, 0, v112
  v_cvt_pk_bf16_f32 v113, 0, v113
  v_add_f32_dpp v148, v229, v148 quad_perm:[1,1,1,1] row_mask:0xf bank_mask:0xf
  v_add_f32_dpp v149, v231, v149 quad_perm:[3,3,3,3] row_mask:0xf bank_mask:0xf
  v_cvt_pk_bf16_f32 v114, 0, v114
  v_cvt_pk_bf16_f32 v115, 0, v115
  v_add_f32 v232, v148, v149
  v_pk_mul_f32 v[112:113], v[112:113], v[200:201]
  v_pk_mul_f32 v[114:115], v[114:115], v[202:203]
  v_cvt_pk_bf16_f32 v222, v112, v113
  v_cvt_pk_bf16_f32 v223, v114, v115
  s_waitcnt vmcnt(14)
  s_cbranch_vccnz L_kw0_23
  s_waitcnt vmcnt(10)
L_kw0_23:
  buffer_load_dwordx4 v[68:71], v93, s[16:19], s61 offen offset:512 nt
  v_mfma_f32_16x16x32_bf16 v[228:231], v[220:223], v[172:175], 0
  v_pk_fma_f32 v[112:113], v[8:9], s[92:93], v[216:217] neg_lo:[0,0,1] neg_hi:[0,0,1]
  v_pk_fma_f32 v[114:115], v[10:11], s[92:93], v[218:219] neg_lo:[0,0,1] neg_hi:[0,0,1]
  v_cvt_pk_bf16_f32 v112, 0, v112
  v_cvt_pk_bf16_f32 v113, 0, v113
  v_cvt_pk_bf16_f32 v114, 0, v114
  v_cvt_pk_bf16_f32 v115, 0, v115
  v_pk_mul_f32 v[112:113], v[112:113], v[204:205]
  v_pk_mul_f32 v[114:115], v[114:115], v[206:207]
  v_cvt_pk_bf16_f32 v224, v112, v113
  v_cvt_pk_bf16_f32 v225, v114, v115
  s_waitcnt vmcnt(14)
  s_cbranch_vccnz L_kw0_24
  s_waitcnt vmcnt(10)
L_kw0_24:
  buffer_load_dwordx4 v[72:75], v93, s[16:19], s61 offen offset:768 nt
  v_mfma_f32_16x16x16_bf16 v[228:231], v[224:225], v[176:177], v[228:231]
  v_pk_fma_f32 v[112:113], v[12:13], s[92:93], v[208:209] neg_lo:[0,0,1] neg_hi:[0,0,1]
  v_pk_fma_f32 v[114:115], v[14:15], s[92:93], v[210:211] neg_lo:[0,0,1] neg_hi:[0,0,1]
  v_cvt_pk_bf16_f32 v112, 0, v112
  v_cvt_pk_bf16_f32 v113, 0, v113
  v_cvt_pk_bf16_f32 v114, 0, v114
  v_cvt_pk_bf16_f32 v115, 0, v115
  v_pk_mul_f32 v[112:113], v[112:113], v[196:197]
  v_pk_mul_f32 v[114:115], v[114:115], v[198:199]
  v_cvt_pk_bf16_f32 v220, v112, v113
  v_cvt_pk_bf16_f32 v221, v114, v115
  s_waitcnt vmcnt(14)
  s_cbranch_vccnz L_kw0_25
  s_waitcnt vmcnt(10)
L_kw0_25:
  buffer_load_dwordx4 v[76:79], v93, s[16:19], s61 offen offset:1024 nt
  v_pk_fma_f32 v[112:113], v[16:17], s[92:93], v[212:213] neg_lo:[0,0,1] neg_hi:[0,0,1]
  v_pk_fma_f32 v[114:115], v[18:19], s[92:93], v[214:215] neg_lo:[0,0,1] neg_hi:[0,0,1]
  v_mov_b32_dpp v148, v228 quad_perm:[0,0,0,0] row_mask:0xf bank_mask:0xf
  v_mov_b32_dpp v149, v230 quad_perm:[2,2,2,2] row_mask:0xf bank_mask:0xf
  v_cvt_pk_bf16_f32 v112, 0, v112
  v_cvt_pk_bf16_f32 v113, 0, v113
  v_add_f32_dpp v148, v229, v148 quad_perm:[1,1,1,1] row_mask:0xf bank_mask:0xf
  v_add_f32_dpp v149, v231, v149 quad_perm:[3,3,3,3] row_mask:0xf bank_mask:0xf
  v_cvt_pk_bf16_f32 v114, 0, v114
  v_cvt_pk_bf16_f32 v115, 0, v115
  v_add_f32 v233, v148, v149
  v_pk_mul_f32 v[112:113], v[112:113], v[200:201]
  v_pk_mul_f32 v[114:115], v[114:115], v[202:203]
  v_cvt_pk_bf16_f32 v222, v112, v113
  v_cvt_pk_bf16_f32 v223, v114, v115
  s_waitcnt vmcnt(14)
  s_cbranch_vccnz L_kw0_26
  s_waitcnt vmcnt(10)
L_kw0_26:
  buffer_load_dwordx4 v[80:83], v93, s[16:19], s61 offen offset:1280 nt
  v_mfma_f32_16x16x32_bf16 v[228:231], v[220:223], v[172:175], 0
  v_pk_fma_f32 v[112:113], v[20:21], s[92:93], v[216:217] neg_lo:[0,0,1] neg_hi:[0,0,1]
  v_pk_fma_f32 v[114:115], v[22:23], s[92:93], v[218:219] neg_lo:[0,0,1] neg_hi:[0,0,1]
  v_cvt_pk_bf16_f32 v112, 0, v112
  v_cvt_pk_bf16_f32 v232, 0, v232
  v_cvt_pk_bf16_f32 v113, 0, v113
  v_cvt_pk_bf16_f32 v233, 0, v233
  v_cvt_pk_bf16_f32 v114, 0, v114
  v_pk_mul_f32 v[232:233], v[232:233], s[68:69]
  v_cvt_pk_bf16_f32 v115, 0, v115
  v_cvt_pk_bf16_f32 v127, v232, v233
  v_pk_mul_f32 v[112:113], v[112:113], v[204:205]
  v_pk_mul_f32 v[114:115], v[114:115], v[206:207]
  v_cvt_pk_bf16_f32 v224, v112, v113
  v_cvt_pk_bf16_f32 v225, v114, v115
  s_waitcnt vmcnt(14)
  s_cbranch_vccnz L_kw0_27
  s_waitcnt vmcnt(10)
L_kw0_27:
  buffer_load_dwordx4 v[84:87], v93, s[16:19], s61 offen offset:1536 nt
  v_mfma_f32_16x16x16_bf16 v[228:231], v[224:225], v[176:177], v[228:231]
  v_pk_fma_f32 v[112:113], v[24:25], s[92:93], v[208:209] neg_lo:[0,0,1] neg_hi:[0,0,1]
  v_pk_fma_f32 v[114:115], v[26:27], s[92:93], v[210:211] neg_lo:[0,0,1] neg_hi:[0,0,1]
  v_cvt_pk_bf16_f32 v112, 0, v112
  v_cvt_pk_bf16_f32 v113, 0, v113
  v_cvt_pk_bf16_f32 v114, 0, v114
  v_cvt_pk_bf16_f32 v115, 0, v115
  v_pk_mul_f32 v[112:113], v[112:113], v[196:197]
  v_pk_mul_f32 v[114:115], v[114:115], v[198:199]
  v_cvt_pk_bf16_f32 v220, v112, v113
  v_cvt_pk_bf16_f32 v221, v114, v115
  s_waitcnt vmcnt(14)
  s_cbranch_vccnz L_kw0_28
  s_waitcnt vmcnt(10)
L_kw0_28:
  buffer_load_dwordx4 v[88:91], v93, s[16:19], s61 offen offset:1792 nt
  v_pk_fma_f32 v[112:113], v[28:29], s[92:93], v[212:213] neg_lo:[0,0,1] neg_hi:[0,0,1]
  v_pk_fma_f32 v[114:115], v[30:31], s[92:93], v[214:215] neg_lo:[0,0,1] neg_hi:[0,0,1]
  v_mov_b32_dpp v148, v228 quad_perm:[0,0,0,0] row_mask:0xf bank_mask:0xf
  v_mov_b32_dpp v149, v230 quad_perm:[2,2,2,2] row_mask:0xf bank_mask:0xf
  v_cvt_pk_bf16_f32 v112, 0, v112
  v_cvt_pk_bf16_f32 v113, 0, v113
  v_add_f32_dpp v148, v229, v148 quad_perm:[1,1,1,1] row_mask:0xf bank_mask:0xf
  v_add_f32_dpp v149, v231, v149 quad_perm:[3,3,3,3] row_mask:0xf bank_mask:0xf
  v_cvt_pk_bf16_f32 v114, 0, v114
  v_cvt_pk_bf16_f32 v115, 0, v115
  v_add_f32 v232, v148, v149
  v_pk_mul_f32 v[112:113], v[112:113], v[200:201]
  v_pk_mul_f32 v[114:115], v[114:115], v[202:203]
  v_cvt_pk_bf16_f32 v222, v112, v113
  v_cvt_pk_bf16_f32 v223, v114, v115
  s_waitcnt vmcnt(14)
  s_cbranch_vccnz L_kw0_29
  s_waitcnt vmcnt(10)
L_kw0_29:
  buffer_load_dwordx4 v[4:7], v93, s[16:19], s61 offen offset:2048 nt
  v_mfma_f32_16x16x32_bf16 v[228:231], v[220:223], v[172:175], 0
  v_pk_fma_f32 v[112:113], v[32:33], s[92:93], v[216:217] neg_lo:[0,0,1] neg_hi:[0,0,1]
  v_pk_fma_f32 v[114:115], v[34:35], s[92:93], v[218:219] neg_lo:[0,0,1] neg_hi:[0,0,1]
  v_cvt_pk_bf16_f32 v112, 0, v112
  v_cvt_pk_bf16_f32 v113, 0, v113
  v_cvt_pk_bf16_f32 v114, 0, v114
  v_cvt_pk_bf16_f32 v115, 0, v115
  v_pk_mul_f32 v[112:113], v[112:113], v[204:205]
  v_pk_mul_f32 v[114:115], v[114:115], v[206:207]
  v_cvt_pk_bf16_f32 v224, v112, v113
  v_cvt_pk_bf16_f32 v225, v114, v115
  s_waitcnt vmcnt(14)
  s_cbranch_vccnz L_kw0_30
  s_waitcnt vmcnt(10)
L_kw0_30:
  buffer_load_dwordx4 v[8:11], v93, s[16:19], s61 offen offset:2304 nt
  v_mfma_f32_16x16x16_bf16 v[228:231], v[224:225], v[176:177], v[228:231]
  v_pk_fma_f32 v[112:113], v[36:37], s[92:93], v[208:209] neg_lo:[0,0,1] neg_hi:[0,0,1]
  v_pk_fma_f32 v[114:115], v[38:39], s[92:93], v[210:211] neg_lo:[0,0,1] neg_hi:[0,0,1]
  v_cvt_pk_bf16_f32 v112, 0, v112
  v_cvt_pk_bf16_f32 v113, 0, v113
  v_cvt_pk_bf16_f32 v114, 0, v114
  v_cvt_pk_bf16_f32 v115, 0, v115
  v_pk_mul_f32 v[112:113], v[112:113], v[196:197]
  v_pk_mul_f32 v[114:115], v[114:115], v[198:199]
  v_cvt_pk_bf16_f32 v220, v112, v113
  v_cvt_pk_bf16_f32 v221, v114, v115
  s_waitcnt vmcnt(14)
  s_cbranch_vccnz L_kw0_31
  s_waitcnt vmcnt(10)
L_kw0_31:
  buffer_load_dwordx4 v[12:15], v93, s[16:19], s61 offen offset:2560 nt
  v_pk_fma_f32 v[112:113], v[40:41], s[92:93], v[212:213] neg_lo:[0,0,1] neg_hi:[0,0,1]
  v_pk_fma_f32 v[114:115], v[42:43], s[92:93], v[214:215] neg_lo:[0,0,1] neg_hi:[0,0,1]
  v_mov_b32_dpp v148, v228 quad_perm:[0,0,0,0] row_mask:0xf bank_mask:0xf
  v_mov_b32_dpp v149, v230 quad_perm:[2,2,2,2] row_mask:0xf bank_mask:0xf
  v_cvt_pk_bf16_f32 v112, 0, v112
  v_cvt_pk_bf16_f32 v113, 0, v113
  v_add_f32_dpp v148, v229, v148 quad_perm:[1,1,1,1] row_mask:0xf bank_mask:0xf
  v_add_f32_dpp v149, v231, v149 quad_perm:[3,3,3,3] row_mask:0xf bank_mask:0xf
  v_cvt_pk_bf16_f32 v114, 0, v114
  v_cvt_pk_bf16_f32 v115, 0, v115
  v_add_f32 v233, v148, v149
  v_pk_mul_f32 v[112:113], v[112:113], v[200:201]
  v_pk_mul_f32 v[114:115], v[114:115], v[202:203]
  v_cvt_pk_bf16_f32 v222, v112, v113
  v_cvt_pk_bf16_f32 v223, v114, v115
  s_waitcnt vmcnt(14)
  s_cbranch_vccnz L_kw0_32
  s_waitcnt vmcnt(10)
L_kw0_32:
  buffer_load_dwordx4 v[16:19], v93, s[16:19], s61 offen offset:2816 nt
  v_mfma_f32_16x16x32_bf16 v[228:231], v[220:223], v[172:175], 0
  v_pk_fma_f32 v[112:113], v[44:45], s[92:93], v[216:217] neg_lo:[0,0,1] neg_hi:[0,0,1]
  v_pk_fma_f32 v[114:115], v[46:47], s[92:93], v[218:219] neg_lo:[0,0,1] neg_hi:[0,0,1]
  v_cvt_pk_bf16_f32 v112, 0, v112
  v_cvt_pk_bf16_f32 v232, 0, v232
  v_cvt_pk_bf16_f32 v113, 0, v113
  v_cvt_pk_bf16_f32 v233, 0, v233
  v_cvt_pk_bf16_f32 v114, 0, v114
  v_pk_mul_f32 v[232:233], v[232:233], s[68:69]
  v_cvt_pk_bf16_f32 v115, 0, v115
  v_cvt_pk_bf16_f32 v128, v232, v233
  v_pk_mul_f32 v[112:113], v[112:113], v[204:205]
  v_pk_mul_f32 v[114:115], v[114:115], v[206:207]
  v_cvt_pk_bf16_f32 v224, v112, v113
  v_cvt_pk_bf16_f32 v225, v114, v115
  s_mov_b32 s60, s61
  v_mov_b32 v150, s64
  v_mfma_f32_16x16x16_bf16 v[228:231], v[224:225], v[176:177], v[228:231]
  ds_write_b128 v102, v[124:127]
  v_add_u32 v102, 768, v102
  s_nop 5
  v_mov_b32_dpp v148, v228 quad_perm:[0,0,0,0] row_mask:0xf bank_mask:0xf
  v_mov_b32_dpp v149, v230 quad_perm:[2,2,2,2] row_mask:0xf bank_mask:0xf
  s_nop 0
  v_add_f32_dpp v148, v229, v148 quad_perm:[1,1,1,1] row_mask:0xf bank_mask:0xf
  v_add_f32_dpp v149, v231, v149 quad_perm:[3,3,3,3] row_mask:0xf bank_mask:0xf
  v_add_f32 v232, v148, v149
  v_cndmask_b32 v232, v232, v240, s[50:51]
  v_cvt_pk_bf16_f32 v232, 0, v232
  v_cvt_pk_bf16_f32 v233, 0, v233
  v_pk_mul_f32 v[232:233], v[232:233], s[68:69]
  v_cvt_pk_bf16_f32 v129, v232, v233
  ds_write_b64 v103, v[128:129] offset:256
  ds_write_b32 v107, v150
  v_add_u32 v103, 768, v103
  v_add_u32 v148, s85, v97
  v_lshrrev_b32 v149, v148, s91
  v_and_b32 v149, 1, v149
  v_cmp_eq_u32 s[50:51], 1, v149
  s_nop 1
  s_and_b64 s[48:49], s[50:51], s[58:59]
  s_andn2_b64 s[50:51], s[50:51], s[58:59]
  s_add_u32 s64, s64, 2
  s_cmp_lt_u32 s64, s99
  s_cbranch_scc1 L_k_known1
L_k_spin1:
  v_mov_b32 v148, 61696
  ds_read_b32 v148, v148
  s_waitcnt lgkmcnt(0)
  v_readfirstlane_b32 s96, v148
  s_nop 1
  s_cmp_eq_u32 s96, 0
  s_cbranch_scc1 L_k_spin1
  s_mov_b32 s99, -1
  s_bitcmp1_b32 s96, 6
  s_cselect_b32 s97, 255, s97
L_k_known1:
  s_andn2_b32 s70, s64, 1
  s_or_b32 s70, s70, s4
  s_lshr_b32 s71, s64, 5
  s_lshr_b32 s85, s96, s71
  s_cmp_lt_u32 s64, s97
  s_cselect_b32 s70, s70, s64
  s_cselect_b32 s85, s64, s85
  s_and_b32 s85, s85, 1
  s_mul_i32 s71, s71, 4064
  s_add_u32 s70, s70, s71
  s_add_u32 s70, s70, s5
  s_mul_hi_u32 s84, s70, s90
  s_lshr_b32 s84, s84, 1
  s_mul_i32 s71, s84, 3
  s_sub_u32 s70, s70, s71
  s_lshl3_add_u32 s85, s70, s85
  s_mul_i32 s61, s84, 196608
  s_lshr_b32 s89, s84, 4
  s_lshl_b32 s70, s85, 5
  v_add_u32 v100, s70, v234
  v_mul_u32_u24 v100, 21846, v100
  v_lshrrev_b32 v100, 16, v100
  v_add_u32 v148, s85, v235
  v_lshrrev_b32 v149, v148, s91
  v_and_b32 v149, 1, v149
  v_cmp_eq_u32 s[54:55], 1, v149
  s_nop 1
  s_and_b64 s[52:53], s[54:55], s[56:57]
  s_andn2_b64 s[54:55], s[54:55], s[56:57]
  v_mul_u32_u24 v148, 43, v148
  v_lshrrev_b32 v148, 8, v148
  v_mul_u32_u24 v148, 384, v148
  v_add_u32 v238, v148, v237
  ds_read_b32 v110, v109
  s_waitcnt vmcnt(14)
  s_cbranch_vccnz L_kw1_0
  s_waitcnt vmcnt(10)
L_kw1_0:
  buffer_load_dwordx4 v[20:23], v93, s[8:11], s60 offen offset:3072 nt
  v_lshlrev_b32 v208, 16, v190
  v_and_b32 v209, s65, v190
  v_lshlrev_b32 v210, 16, v191
  v_and_b32 v211, s65, v191
  v_lshlrev_b32 v196, 16, v184
  v_and_b32 v197, s65, v184
  v_lshlrev_b32 v198, 16, v185
  v_and_b32 v199, s65, v185
  v_pk_mul_f32 v[208:209], v[208:209], s[94:95]
  v_mov_b32 v172, v178
  v_pk_mul_f32 v[210:211], v[210:211], s[94:95]
  v_mov_b32 v173, v179
  v_pk_fma_f32 v[112:113], v[48:49], s[92:93], v[208:209] neg_lo:[0,0,1] neg_hi:[0,0,1]
  v_pk_fma_f32 v[114:115], v[50:51], s[92:93], v[210:211] neg_lo:[0,0,1] neg_hi:[0,0,1]
  v_cvt_pk_bf16_f32 v112, 0, v112
  v_cvt_pk_bf16_f32 v113, 0, v113
  v_cvt_pk_bf16_f32 v114, 0, v114
  v_cvt_pk_bf16_f32 v115, 0, v115
  v_pk_mul_f32 v[112:113], v[112:113], v[196:197]
  v_pk_mul_f32 v[114:115], v[114:115], v[198:199]
  v_cvt_pk_bf16_f32 v220, v112, v113
  v_cvt_pk_bf16_f32 v221, v114, v115
  s_waitcnt lgkmcnt(0)
  s_sub_u32 s70, s64, 2
  v_cmp_lt_u32 vcc, s70, v110
  s_waitcnt vmcnt(14)
  s_cbranch_vccnz L_kw1_1
  s_waitcnt vmcnt(10)
L_kw1_1:
  buffer_load_dwordx4 v[24:27], v93, s[8:11], s60 offen offset:3328 nt
  v_lshlrev_b32 v212, 16, v192
  v_and_b32 v213, s65, v192
  v_lshlrev_b32 v214, 16, v193
  v_and_b32 v215, s65, v193
  v_lshlrev_b32 v200, 16, v186
  v_and_b32 v201, s65, v186
  v_lshlrev_b32 v202, 16, v187
  v_and_b32 v203, s65, v187
  v_pk_mul_f32 v[212:213], v[212:213], s[94:95]
  v_mov_b32 v174, v180
  v_pk_mul_f32 v[214:215], v[214:215], s[94:95]
  v_mov_b32 v175, v181
  v_pk_fma_f32 v[112:113], v[52:53], s[92:93], v[212:213] neg_lo:[0,0,1] neg_hi:[0,0,1]
  v_pk_fma_f32 v[114:115], v[54:55], s[92:93], v[214:215] neg_lo:[0,0,1] neg_hi:[0,0,1]
  v_cvt_pk_bf16_f32 v112, 0, v112
  v_cvt_pk_bf16_f32 v113, 0, v113
  v_cvt_pk_bf16_f32 v114, 0, v114
  v_cvt_pk_bf16_f32 v115, 0, v115
  v_pk_mul_f32 v[112:113], v[112:113], v[200:201]
  v_pk_mul_f32 v[114:115], v[114:115], v[202:203]
  v_cvt_pk_bf16_f32 v222, v112, v113
  v_cvt_pk_bf16_f32 v223, v114, v115
  s_waitcnt vmcnt(14)
  s_cbranch_vccnz L_kw1_2
  s_waitcnt vmcnt(10)
L_kw1_2:
  buffer_load_dwordx4 v[28:31], v93, s[8:11], s60 offen offset:3584 nt
  v_mfma_f32_16x16x32_bf16 v[228:231], v[220:223], v[172:175], 0
  v_lshlrev_b32 v216, 16, v194
  v_and_b32 v217, s65, v194
  v_lshlrev_b32 v218, 16, v195
  v_and_b32 v219, s65, v195
  v_lshlrev_b32 v204, 16, v188
  v_and_b32 v205, s65, v188
  v_lshlrev_b32 v206, 16, v189
  v_and_b32 v207, s65, v189
  v_pk_mul_f32 v[216:217], v[216:217], s[94:95]
  v_mov_b32 v176, v182
  v_pk_mul_f32 v[218:219], v[218:219], s[94:95]
  v_mov_b32 v177, v183
  v_pk_fma_f32 v[112:113], v[56:57], s[92:93], v[216:217] neg_lo:[0,0,1] neg_hi:[0,0,1]
  v_pk_fma_f32 v[114:115], v[58:59], s[92:93], v[218:219] neg_lo:[0,0,1] neg_hi:[0,0,1]
  v_cvt_pk_bf16_f32 v112, 0, v112
  v_cvt_pk_bf16_f32 v113, 0, v113
  v_cvt_pk_bf16_f32 v114, 0, v114
  v_cvt_pk_bf16_f32 v115, 0, v115
  v_pk_mul_f32 v[112:113], v[112:113], v[204:205]
  v_pk_mul_f32 v[114:115], v[114:115], v[206:207]
  v_cvt_pk_bf16_f32 v224, v112, v113
  v_cvt_pk_bf16_f32 v225, v114, v115
  s_waitcnt vmcnt(14)
  s_cbranch_vccnz L_kw1_3
  s_waitcnt vmcnt(10)
L_kw1_3:
  buffer_load_dwordx4 v[32:35], v94, s[8:11], s60 offen offset:0 nt
  v_mfma_f32_16x16x16_bf16 v[228:231], v[224:225], v[176:177], v[228:231]
  v_pk_fma_f32 v[112:113], v[60:61], s[92:93], v[208:209] neg_lo:[0,0,1] neg_hi:[0,0,1]
  v_pk_fma_f32 v[114:115], v[62:63], s[92:93], v[210:211] neg_lo:[0,0,1] neg_hi:[0,0,1]
  s_cmp_eq_u32 s89, s88
  s_cbranch_scc1 L_k_sameq1
  s_mul_i32 s70, s89, 1536
  buffer_load_dwordx2 v[178:179], v239, s[36:39], s70 offen offset:0
  buffer_load_dwordx2 v[180:181], v239, s[36:39], s70 offen offset:128
  buffer_load_dwordx2 v[182:183], v239, s[36:39], s70 offen offset:256
  s_mov_b32 s88, s89
L_k_sameq1:
  s_mul_i32 s62, s84, 1536
  buffer_load_dwordx2 v[184:185], v238, s[20:23], s62 offen offset:0
  buffer_load_dwordx2 v[190:191], v238, s[24:27], s62 offen offset:0
  buffer_load_dwordx2 v[186:187], v238, s[20:23], s62 offen offset:128
  buffer_load_dwordx2 v[192:193], v238, s[24:27], s62 offen offset:128
  buffer_load_dwordx2 v[188:189], v238, s[20:23], s62 offen offset:256
  buffer_load_dwordx2 v[194:195], v238, s[24:27], s62 offen offset:256
  v_cvt_pk_bf16_f32 v112, 0, v112
  v_cvt_pk_bf16_f32 v113, 0, v113
  v_cvt_pk_bf16_f32 v114, 0, v114
  v_cvt_pk_bf16_f32 v115, 0, v115
  v_pk_mul_f32 v[112:113], v[112:113], v[196:197]
  v_pk_mul_f32 v[114:115], v[114:115], v[198:199]
  v_cvt_pk_bf16_f32 v220, v112, v113
  v_cvt_pk_bf16_f32 v221, v114, v115
  s_waitcnt vmcnt(20)
  s_cbranch_vccnz L_kw1_4
  s_waitcnt vmcnt(16)
L_kw1_4:
  buffer_load_dwordx4 v[36:39], v94, s[8:11], s60 offen offset:256 nt
  v_pk_fma_f32 v[112:113], v[64:65], s[92:93], v[212:213] neg_lo:[0,0,1] neg_hi:[0,0,1]
  v_pk_fma_f32 v[114:115], v[66:67], s[92:93], v[214:215] neg_lo:[0,0,1] neg_hi:[0,0,1]
  v_mov_b32_dpp v148, v228 quad_perm:[0,0,0,0] row_mask:0xf bank_mask:0xf
  v_mov_b32_dpp v149, v230 quad_perm:[2,2,2,2] row_mask:0xf bank_mask:0xf
  v_cvt_pk_bf16_f32 v112, 0, v112
  v_cvt_pk_bf16_f32 v113, 0, v113
  v_add_f32_dpp v148, v229, v148 quad_perm:[1,1,1,1] row_mask:0xf bank_mask:0xf
  v_add_f32_dpp v149, v231, v149 quad_perm:[3,3,3,3] row_mask:0xf bank_mask:0xf
  v_cvt_pk_bf16_f32 v114, 0, v114
  v_cvt_pk_bf16_f32 v115, 0, v115
  v_add_f32 v232, v148, v149
  v_pk_mul_f32 v[112:113], v[112:113], v[200:201]
  v_pk_mul_f32 v[114:115], v[114:115], v[202:203]
  v_cvt_pk_bf16_f32 v222, v112, v113
  v_cvt_pk_bf16_f32 v223, v114, v115
  s_waitcnt vmcnt(20)
  s_cbranch_vccnz L_kw1_5
  s_waitcnt vmcnt(16)
L_kw1_5:
  buffer_load_dwordx4 v[40:43], v94, s[8:11], s60 offen offset:512 nt
  v_mfma_f32_16x16x32_bf16 v[228:231], v[220:223], v[172:175], 0
  v_pk_fma_f32 v[112:113], v[68:69], s[92:93], v[216:217] neg_lo:[0,0,1] neg_hi:[0,0,1]
  v_pk_fma_f32 v[114:115], v[70:71], s[92:93], v[218:219] neg_lo:[0,0,1] neg_hi:[0,0,1]
  v_cvt_pk_bf16_f32 v112, 0, v112
  v_cndmask_b32 v232, v232, v240, s[48:49]
  v_cvt_pk_bf16_f32 v113, 0, v113
  v_cvt_pk_bf16_f32 v114, 0, v114
  v_cvt_pk_bf16_f32 v115, 0, v115
  v_pk_mul_f32 v[112:113], v[112:113], v[204:205]
  v_pk_mul_f32 v[114:115], v[114:115], v[206:207]
  v_cvt_pk_bf16_f32 v224, v112, v113
  v_cvt_pk_bf16_f32 v225, v114, v115
  s_waitcnt vmcnt(20)
  s_cbranch_vccnz L_kw1_6
  s_waitcnt vmcnt(16)
L_kw1_6:
  buffer_load_dwordx4 v[44:47], v94, s[8:11], s60 offen offset:768 nt
  v_mfma_f32_16x16x16_bf16 v[228:231], v[224:225], v[176:177], v[228:231]
  v_pk_fma_f32 v[112:113], v[72:73], s[92:93], v[208:209] neg_lo:[0,0,1] neg_hi:[0,0,1]
  v_pk_fma_f32 v[114:115], v[74:75], s[92:93], v[210:211] neg_lo:[0,0,1] neg_hi:[0,0,1]
  v_cvt_pk_bf16_f32 v112, 0, v112
  v_cvt_pk_bf16_f32 v113, 0, v113
  v_cvt_pk_bf16_f32 v114, 0, v114
  v_cvt_pk_bf16_f32 v115, 0, v115
  v_pk_mul_f32 v[112:113], v[112:113], v[196:197]
  v_pk_mul_f32 v[114:115], v[114:115], v[198:199]
  v_cvt_pk_bf16_f32 v220, v112, v113
  v_cvt_pk_bf16_f32 v221, v114, v115
  s_waitcnt vmcnt(20)
  s_cbranch_vccnz L_kw1_7
  s_waitcnt vmcnt(16)
L_kw1_7:
  buffer_load_dwordx4 v[48:51], v94, s[8:11], s60 offen offset:1024 nt
  v_pk_fma_f32 v[112:113], v[76:77], s[92:93], v[212:213] neg_lo:[0,0,1] neg_hi:[0,0,1]
  v_pk_fma_f32 v[114:115], v[78:79], s[92:93], v[214:215] neg_lo:[0,0,1] neg_hi:[0,0,1]
  v_mov_b32_dpp v148, v228 quad_perm:[0,0,0,0] row_mask:0xf bank_mask:0xf
  v_mov_b32_dpp v149, v230 quad_perm:[2,2,2,2] row_mask:0xf bank_mask:0xf
  v_cvt_pk_bf16_f32 v112, 0, v112
  v_cvt_pk_bf16_f32 v113, 0, v113
  v_add_f32_dpp v148, v229, v148 quad_perm:[1,1,1,1] row_mask:0xf bank_mask:0xf
  v_add_f32_dpp v149, v231, v149 quad_perm:[3,3,3,3] row_mask:0xf bank_mask:0xf
  v_cvt_pk_bf16_f32 v114, 0, v114
  v_cvt_pk_bf16_f32 v115, 0, v115
  v_add_f32 v233, v148, v149
  v_pk_mul_f32 v[112:113], v[112:113], v[200:201]
  v_pk_mul_f32 v[114:115], v[114:115], v[202:203]
  v_cvt_pk_bf16_f32 v222, v112, v113
  v_cvt_pk_bf16_f32 v223, v114, v115
  s_waitcnt vmcnt(20)
  s_cbranch_vccnz L_kw1_8
  s_waitcnt vmcnt(16)
L_kw1_8:
  buffer_load_dwordx4 v[52:55], v94, s[8:11], s60 offen offset:1280 nt
  v_mfma_f32_16x16x32_bf16 v[228:231], v[220:223], v[172:175], 0
  v_pk_fma_f32 v[112:113], v[80:81], s[92:93], v[216:217] neg_lo:[0,0,1] neg_hi:[0,0,1]
  v_pk_fma_f32 v[114:115], v[82:83], s[92:93], v[218:219] neg_lo:[0,0,1] neg_hi:[0,0,1]
  v_cvt_pk_bf16_f32 v112, 0, v112
  v_cvt_pk_bf16_f32 v232, 0, v232
  v_cvt_pk_bf16_f32 v113, 0, v113
  v_cvt_pk_bf16_f32 v233, 0, v233
  v_cvt_pk_bf16_f32 v114, 0, v114
  v_pk_mul_f32 v[232:233], v[232:233], s[68:69]
  v_cvt_pk_bf16_f32 v115, 0, v115
  v_cvt_pk_bf16_f32 v124, v232, v233
  v_pk_mul_f32 v[112:113], v[112:113], v[204:205]
  v_pk_mul_f32 v[114:115], v[114:115], v[206:207]
  v_cvt_pk_bf16_f32 v224, v112, v113
  v_cvt_pk_bf16_f32 v225, v114, v115
  s_waitcnt vmcnt(20)
  s_cbranch_vccnz L_kw1_9
  s_waitcnt vmcnt(16)
L_kw1_9:
  buffer_load_dwordx4 v[56:59], v94, s[8:11], s60 offen offset:1536 nt
  v_mfma_f32_16x16x16_bf16 v[228:231], v[224:225], v[176:177], v[228:231]
  v_pk_fma_f32 v[112:113], v[84:85], s[92:93], v[208:209] neg_lo:[0,0,1] neg_hi:[0,0,1]
  v_pk_fma_f32 v[114:115], v[86:87], s[92:93], v[210:211] neg_lo:[0,0,1] neg_hi:[0,0,1]
  v_cvt_pk_bf16_f32 v112, 0, v112
  v_cvt_pk_bf16_f32 v113, 0, v113
  v_cvt_pk_bf16_f32 v114, 0, v114
  v_cvt_pk_bf16_f32 v115, 0, v115
  v_pk_mul_f32 v[112:113], v[112:113], v[196:197]
  v_pk_mul_f32 v[114:115], v[114:115], v[198:199]
  v_cvt_pk_bf16_f32 v220, v112, v113
  v_cvt_pk_bf16_f32 v221, v114, v115
  s_waitcnt vmcnt(20)
  s_cbranch_vccnz L_kw1_10
  s_waitcnt vmcnt(16)
L_kw1_10:
  buffer_load_dwordx4 v[60:63], v94, s[8:11], s60 offen offset:1792 nt
  v_pk_fma_f32 v[112:113], v[88:89], s[92:93], v[212:213] neg_lo:[0,0,1] neg_hi:[0,0,1]
  v_pk_fma_f32 v[114:115], v[90:91], s[92:93], v[214:215] neg_lo:[0,0,1] neg_hi:[0,0,1]
  v_mov_b32_dpp v148, v228 quad_perm:[0,0,0,0] row_mask:0xf bank_mask:0xf
  v_mov_b32_dpp v149, v230 quad_perm:[2,2,2,2] row_mask:0xf bank_mask:0xf
  v_cvt_pk_bf16_f32 v112, 0, v112
  v_cvt_pk_bf16_f32 v113, 0, v113
  v_add_f32_dpp v148, v229, v148 quad_perm:[1,1,1,1] row_mask:0xf bank_mask:0xf
  v_add_f32_dpp v149, v231, v149 quad_perm:[3,3,3,3] row_mask:0xf bank_mask:0xf
  v_cvt_pk_bf16_f32 v114, 0, v114
  v_cvt_pk_bf16_f32 v115, 0, v115
  v_add_f32 v232, v148, v149
  v_pk_mul_f32 v[112:113], v[112:113], v[200:201]
  v_pk_mul_f32 v[114:115], v[114:115], v[202:203]
  v_cvt_pk_bf16_f32 v222, v112, v113
  v_cvt_pk_bf16_f32 v223, v114, v115
  s_waitcnt vmcnt(20)
  s_cbranch_vccnz L_kw1_11
  s_waitcnt vmcnt(16)
L_kw1_11:
  buffer_load_dwordx4 v[64:67], v94, s[8:11], s60 offen offset:2048 nt
  v_mfma_f32_16x16x32_bf16 v[228:231], v[220:223], v[172:175], 0
  v_pk_fma_f32 v[112:113], v[4:5], s[92:93], v[216:217] neg_lo:[0,0,1] neg_hi:[0,0,1]
  v_pk_fma_f32 v[114:115], v[6:7], s[92:93], v[218:219] neg_lo:[0,0,1] neg_hi:[0,0,1]
  v_cvt_pk_bf16_f32 v112, 0, v112
  v_cvt_pk_bf16_f32 v113, 0, v113
  v_cvt_pk_bf16_f32 v114, 0, v114
  v_cvt_pk_bf16_f32 v115, 0, v115
  v_pk_mul_f32 v[112:113], v[112:113], v[204:205]
  v_pk_mul_f32 v[114:115], v[114:115], v[206:207]
  v_cvt_pk_bf16_f32 v224, v112, v113
  v_cvt_pk_bf16_f32 v225, v114, v115
  s_waitcnt vmcnt(20)
  s_cbranch_vccnz L_kw1_12
  s_waitcnt vmcnt(16)
L_kw1_12:
  buffer_load_dwordx4 v[68:71], v94, s[8:11], s60 offen offset:2304 nt
  v_mfma_f32_16x16x16_bf16 v[228:231], v[224:225], v[176:177], v[228:231]
  v_pk_fma_f32 v[112:113], v[8:9], s[92:93], v[208:209] neg_lo:[0,0,1] neg_hi:[0,0,1]
  v_pk_fma_f32 v[114:115], v[10:11], s[92:93], v[210:211] neg_lo:[0,0,1] neg_hi:[0,0,1]
  v_cvt_pk_bf16_f32 v112, 0, v112
  v_cvt_pk_bf16_f32 v113, 0, v113
  v_cvt_pk_bf16_f32 v114, 0, v114
  v_cvt_pk_bf16_f32 v115, 0, v115
  v_pk_mul_f32 v[112:113], v[112:113], v[196:197]
  v_pk_mul_f32 v[114:115], v[114:115], v[198:199]
  v_cvt_pk_bf16_f32 v220, v112, v113
  v_cvt_pk_bf16_f32 v221, v114, v115
  s_waitcnt vmcnt(20)
  s_cbranch_vccnz L_kw1_13
  s_waitcnt vmcnt(16)
L_kw1_13:
  buffer_load_dwordx4 v[72:75], v94, s[8:11], s60 offen offset:2560 nt
  v_pk_fma_f32 v[112:113], v[12:13], s[92:93], v[212:213] neg_lo:[0,0,1] neg_hi:[0,0,1]
  v_pk_fma_f32 v[114:115], v[14:15], s[92:93], v[214:215] neg_lo:[0,0,1] neg_hi:[0,0,1]
  v_mov_b32_dpp v148, v228 quad_perm:[0,0,0,0] row_mask:0xf bank_mask:0xf
  v_mov_b32_dpp v149, v230 quad_perm:[2,2,2,2] row_mask:0xf bank_mask:0xf
  v_cvt_pk_bf16_f32 v112, 0, v112
  v_cvt_pk_bf16_f32 v113, 0, v113
  v_add_f32_dpp v148, v229, v148 quad_perm:[1,1,1,1] row_mask:0xf bank_mask:0xf
  v_add_f32_dpp v149, v231, v149 quad_perm:[3,3,3,3] row_mask:0xf bank_mask:0xf
  v_cvt_pk_bf16_f32 v114, 0, v114
  v_cvt_pk_bf16_f32 v115, 0, v115
  v_add_f32 v233, v148, v149
  v_pk_mul_f32 v[112:113], v[112:113], v[200:201]
  v_pk_mul_f32 v[114:115], v[114:115], v[202:203]
  v_cvt_pk_bf16_f32 v222, v112, v113
  v_cvt_pk_bf16_f32 v223, v114, v115
  s_waitcnt vmcnt(20)
  s_cbranch_vccnz L_kw1_14
  s_waitcnt vmcnt(16)
L_kw1_14:
  buffer_load_dwordx4 v[76:79], v94, s[8:11], s60 offen offset:2816 nt
  v_mfma_f32_16x16x32_bf16 v[228:231], v[220:223], v[172:175], 0
  v_pk_fma_f32 v[112:113], v[16:17], s[92:93], v[216:217] neg_lo:[0,0,1] neg_hi:[0,0,1]
  v_pk_fma_f32 v[114:115], v[18:19], s[92:93], v[218:219] neg_lo:[0,0,1] neg_hi:[0,0,1]
  v_cvt_pk_bf16_f32 v112, 0, v112
  v_cvt_pk_bf16_f32 v232, 0, v232
  v_cvt_pk_bf16_f32 v113, 0, v113
  v_cvt_pk_bf16_f32 v233, 0, v233
  v_cvt_pk_bf16_f32 v114, 0, v114
  v_pk_mul_f32 v[232:233], v[232:233], s[68:69]
  v_cvt_pk_bf16_f32 v115, 0, v115
  v_cvt_pk_bf16_f32 v125, v232, v233
  v_pk_mul_f32 v[112:113], v[112:113], v[204:205]
  v_pk_mul_f32 v[114:115], v[114:115], v[206:207]
  v_cvt_pk_bf16_f32 v224, v112, v113
  v_cvt_pk_bf16_f32 v225, v114, v115
  s_waitcnt vmcnt(20)
  s_cbranch_vccnz L_kw1_15
  s_waitcnt vmcnt(10)
L_kw1_15:
  buffer_load_dwordx4 v[80:83], v95, s[8:11], s60 offen offset:0 nt
  v_mfma_f32_16x16x16_bf16 v[228:231], v[224:225], v[176:177], v[228:231]
  v_pk_fma_f32 v[112:113], v[20:21], s[92:93], v[208:209] neg_lo:[0,0,1] neg_hi:[0,0,1]
  v_pk_fma_f32 v[114:115], v[22:23], s[92:93], v[210:211] neg_lo:[0,0,1] neg_hi:[0,0,1]
  v_cvt_pk_bf16_f32 v112, 0, v112
  v_cvt_pk_bf16_f32 v113, 0, v113
  v_cvt_pk_bf16_f32 v114, 0, v114
  v_cvt_pk_bf16_f32 v115, 0, v115
  v_pk_mul_f32 v[112:113], v[112:113], v[196:197]
  v_pk_mul_f32 v[114:115], v[114:115], v[198:199]
  v_cvt_pk_bf16_f32 v220, v112, v113
  v_cvt_pk_bf16_f32 v221, v114, v115
  s_waitcnt vmcnt(20)
  s_cbranch_vccnz L_kw1_16
  s_waitcnt vmcnt(10)
L_kw1_16:
  buffer_load_dwordx4 v[84:87], v95, s[8:11], s60 offen offset:256 nt
  v_pk_fma_f32 v[112:113], v[24:25], s[92:93], v[212:213] neg_lo:[0,0,1] neg_hi:[0,0,1]
  v_pk_fma_f32 v[114:115], v[26:27], s[92:93], v[214:215] neg_lo:[0,0,1] neg_hi:[0,0,1]
  v_mov_b32_dpp v148, v228 quad_perm:[0,0,0,0] row_mask:0xf bank_mask:0xf
  v_mov_b32_dpp v149, v230 quad_perm:[2,2,2,2] row_mask:0xf bank_mask:0xf
  v_cvt_pk_bf16_f32 v112, 0, v112
  v_cvt_pk_bf16_f32 v113, 0, v113
  v_add_f32_dpp v148, v229, v148 quad_perm:[1,1,1,1] row_mask:0xf bank_mask:0xf
  v_add_f32_dpp v149, v231, v149 quad_perm:[3,3,3,3] row_mask:0xf bank_mask:0xf
  v_cvt_pk_bf16_f32 v114, 0, v114
  v_cvt_pk_bf16_f32 v115, 0, v115
  v_add_f32 v232, v148, v149
  v_pk_mul_f32 v[112:113], v[112:113], v[200:201]
  v_pk_mul_f32 v[114:115], v[114:115], v[202:203]
  v_cvt_pk_bf16_f32 v222, v112, v113
  v_cvt_pk_bf16_f32 v223, v114, v115
  s_waitcnt vmcnt(20)
  s_cbranch_vccnz L_kw1_17
  s_waitcnt vmcnt(10)
L_kw1_17:
  buffer_load_dwordx4 v[88:91], v95, s[8:11], s60 offen offset:512 nt
  v_mfma_f32_16x16x32_bf16 v[228:231], v[220:223], v[172:175], 0
  v_pk_fma_f32 v[112:113], v[28:29], s[92:93], v[216:217] neg_lo:[0,0,1] neg_hi:[0,0,1]
  v_pk_fma_f32 v[114:115], v[30:31], s[92:93], v[218:219] neg_lo:[0,0,1] neg_hi:[0,0,1]
  v_cvt_pk_bf16_f32 v112, 0, v112
  v_cvt_pk_bf16_f32 v113, 0, v113
  v_cvt_pk_bf16_f32 v114, 0, v114
  v_cvt_pk_bf16_f32 v115, 0, v115
  v_pk_mul_f32 v[112:113], v[112:113], v[204:205]
  v_pk_mul_f32 v[114:115], v[114:115], v[206:207]
  v_cvt_pk_bf16_f32 v224, v112, v113
  v_cvt_pk_bf16_f32 v225, v114, v115
  s_cmp_lt_u32 s64, 96
  s_cbranch_scc1 L_k_keep1
  s_bitcmp1_b32 s96, 6
  s_cselect_b32 s97, 255, 0
  v_mov_b32 v152, v148
  v_mov_b32 v153, v149
  s_andn2_b32 s70, s3, 1
  s_or_b32 s70, s70, s4
  s_lshr_b32 s71, s3, 5
  s_lshr_b32 s85, s96, s71
  s_lshr_b32 s85, s85, 3
  s_cmp_lt_u32 s3, s97
  s_cselect_b32 s70, s70, s3
  s_cselect_b32 s85, s3, s85
  s_and_b32 s85, s85, 1
  s_mul_i32 s71, s71, 4064
  s_add_u32 s70, s70, s71
  s_add_u32 s70, s70, s5
  s_mul_hi_u32 s84, s70, s90
  s_lshr_b32 s84, s84, 1
  s_mul_i32 s71, s84, 3
  s_sub_u32 s70, s70, s71
  s_lshl3_add_u32 s85, s70, s85
  s_mul_i32 s61, s84, 196608
  s_lshr_b32 s89, s84, 4
  s_lshl_b32 s70, s85, 5
  v_add_u32 v100, s70, v96
  v_mul_u32_u24 v100, 21846, v100
  v_lshrrev_b32 v100, 16, v100
  v_add_u32 v148, s85, v97
  v_lshrrev_b32 v149, v148, s91
  v_and_b32 v149, 1, v149
  v_cmp_eq_u32 s[54:55], 1, v149
  s_nop 1
  s_and_b64 s[52:53], s[54:55], s[58:59]
  s_andn2_b64 s[54:55], s[54:55], s[58:59]
  v_mov_b32 v148, v152
  v_mov_b32 v149, v153
  s_mov_b32 s16, s12
  s_mov_b32 s17, s13
  s_lshl_b32 s62, s84, 9
  v_lshl_add_u32 v101, v100, 1, v99
  buffer_load_short_d16_hi v116, v101, s[32:35], s62 offen
  buffer_load_short_d16_hi v117, v101, s[28:31], s62 offen
  v_mov_b32 v236, v98
L_k_keep1:
  v_mad_u32_u24 v92, v100, s63, v236
  v_add_u32 v93, 768, v92
  v_add_u32 v94, 4608, v92
  v_add_u32 v95, 7680, v92
  v_cndmask_b32 v92, v92, v108, s[52:53]
  v_cndmask_b32 v95, v95, v108, s[54:55]
  s_waitcnt vmcnt(20)
  s_cbranch_vccnz L_kw1_18
  s_waitcnt vmcnt(10)
L_kw1_18:
  buffer_load_dwordx4 v[4:7], v92, s[16:19], s61 offen offset:0 nt
  v_mfma_f32_16x16x16_bf16 v[228:231], v[224:225], v[176:177], v[228:231]
  v_pk_fma_f32 v[112:113], v[32:33], s[92:93], v[208:209] neg_lo:[0,0,1] neg_hi:[0,0,1]
  v_pk_fma_f32 v[114:115], v[34:35], s[92:93], v[210:211] neg_lo:[0,0,1] neg_hi:[0,0,1]
  v_cvt_pk_bf16_f32 v112, 0, v112
  v_cvt_pk_bf16_f32 v113, 0, v113
  v_cvt_pk_bf16_f32 v114, 0, v114
  v_cvt_pk_bf16_f32 v115, 0, v115
  v_pk_mul_f32 v[112:113], v[112:113], v[196:197]
  v_pk_mul_f32 v[114:115], v[114:115], v[198:199]
  v_cvt_pk_bf16_f32 v220, v112, v113
  v_cvt_pk_bf16_f32 v221, v114, v115
  s_waitcnt vmcnt(14)
  s_cbranch_vccnz L_kw1_19
  s_waitcnt vmcnt(10)
L_kw1_19:
  buffer_load_dwordx4 v[8:11], v92, s[16:19], s61 offen offset:256 nt
  v_pk_fma_f32 v[112:113], v[36:37], s[92:93], v[212:213] neg_lo:[0,0,1] neg_hi:[0,0,1]
  v_pk_fma_f32 v[114:115], v[38:39], s[92:93], v[214:215] neg_lo:[0,0,1] neg_hi:[0,0,1]
  v_mov_b32_dpp v148, v228 quad_perm:[0,0,0,0] row_mask:0xf bank_mask:0xf
  v_mov_b32_dpp v149, v230 quad_perm:[2,2,2,2] row_mask:0xf bank_mask:0xf
  v_cvt_pk_bf16_f32 v112, 0, v112
  v_cvt_pk_bf16_f32 v113, 0, v113
  v_add_f32_dpp v148, v229, v148 quad_perm:[1,1,1,1] row_mask:0xf bank_mask:0xf
  v_add_f32_dpp v149, v231, v149 quad_perm:[3,3,3,3] row_mask:0xf bank_mask:0xf
  v_cvt_pk_bf16_f32 v114, 0, v114
  v_cvt_pk_bf16_f32 v115, 0, v115
  v_add_f32 v233, v148, v149
  v_pk_mul_f32 v[112:113], v[112:113], v[200:201]
  v_pk_mul_f32 v[114:115], v[114:115], v[202:203]
  v_cvt_pk_bf16_f32 v222, v112, v113
  v_cvt_pk_bf16_f32 v223, v114, v115
  s_waitcnt vmcnt(14)
  s_cbranch_vccnz L_kw1_20
  s_waitcnt vmcnt(10)
L_kw1_20:
  buffer_load_dwordx4 v[12:15], v92, s[16:19], s61 offen offset:512 nt
  v_mfma_f32_16x16x32_bf16 v[228:231], v[220:223], v[172:175], 0
  v_pk_fma_f32 v[112:113], v[40:41], s[92:93], v[216:217] neg_lo:[0,0,1] neg_hi:[0,0,1]
  v_pk_fma_f32 v[114:115], v[42:43], s[92:93], v[218:219] neg_lo:[0,0,1] neg_hi:[0,0,1]
  v_cvt_pk_bf16_f32 v112, 0, v112
  v_cvt_pk_bf16_f32 v232, 0, v232
  v_cvt_pk_bf16_f32 v113, 0, v113
  v_cvt_pk_bf16_f32 v233, 0, v233
  v_cvt_pk_bf16_f32 v114, 0, v114
  v_pk_mul_f32 v[232:233], v[232:233], s[68:69]
  v_cvt_pk_bf16_f32 v115, 0, v115
  v_cvt_pk_bf16_f32 v126, v232, v233
  v_pk_mul_f32 v[112:113], v[112:113], v[204:205]
  v_pk_mul_f32 v[114:115], v[114:115], v[206:207]
  v_cvt_pk_bf16_f32 v224, v112, v113
  v_cvt_pk_bf16_f32 v225, v114, v115
  s_waitcnt vmcnt(14)
  s_cbranch_vccnz L_kw1_21
  s_waitcnt vmcnt(10)
L_kw1_21:
  buffer_load_dwordx4 v[16:19], v93, s[16:19], s61 offen offset:0 nt
  v_mfma_f32_16x16x16_bf16 v[228:231], v[224:225], v[176:177], v[228:231]
  v_pk_fma_f32 v[112:113], v[44:45], s[92:93], v[208:209] neg_lo:[0,0,1] neg_hi:[0,0,1]
  v_pk_fma_f32 v[114:115], v[46:47], s[92:93], v[210:211] neg_lo:[0,0,1] neg_hi:[0,0,1]
  v_cvt_pk_bf16_f32 v112, 0, v112
  v_cvt_pk_bf16_f32 v113, 0, v113
  v_cvt_pk_bf16_f32 v114, 0, v114
  v_cvt_pk_bf16_f32 v115, 0, v115
  v_pk_mul_f32 v[112:113], v[112:113], v[196:197]
  v_pk_mul_f32 v[114:115], v[114:115], v[198:199]
  v_cvt_pk_bf16_f32 v220, v112, v113
  v_cvt_pk_bf16_f32 v221, v114, v115
  s_waitcnt vmcnt(14)
  s_cbranch_vccnz L_kw1_22
  s_waitcnt vmcnt(10)
L_kw1_22:
  buffer_load_dwordx4 v[20:23], v93, s[16:19], s61 offen offset:256 nt
  v_pk_fma_f32 v[112:113], v[48:49], s[92:93], v[212:213] neg_lo:[0,0,1] neg_hi:[0,0,1]
  v_pk_fma_f32 v[114:115], v[50:51], s[92:93], v[214:215] neg_lo:[0,0,1] neg_hi:[0,0,1]
  v_mov_b32_dpp v148, v228 quad_perm:[0,0,0,0] row_mask:0xf bank_mask:0xf
  v_mov_b32_dpp v149, v230 quad_perm:[2,2,2,2] row_mask:0xf bank_mask:0xf
  v_cvt_pk_bf16_f32 v112, 0, v112
  v_cvt_pk_bf16_f32 v113, 0, v113
  v_add_f32_dpp v148, v229, v148 quad_perm:[1,1,1,1] row_mask:0xf bank_mask:0xf
  v_add_f32_dpp v149, v231, v149 quad_perm:[3,3,3,3] row_mask:0xf bank_mask:0xf
  v_cvt_pk_bf16_f32 v114, 0, v114
  v_cvt_pk_bf16_f32 v115, 0, v115
  v_add_f32 v232, v148, v149
  v_pk_mul_f32 v[112:113], v[112:113], v[200:201]
  v_pk_mul_f32 v[114:115], v[114:115], v[202:203]
  v_cvt_pk_bf16_f32 v222, v112, v113
  v_cvt_pk_bf16_f32 v223, v114, v115
  s_waitcnt vmcnt(14)
  s_cbranch_vccnz L_kw1_23
  s_waitcnt vmcnt(10)
L_kw1_23:
  buffer_load_dwordx4 v[24:27], v93, s[16:19], s61 offen offset:512 nt
  v_mfma_f32_16x16x32_bf16 v[228:231], v[220:223], v[172:175], 0
  v_pk_fma_f32 v[112:113], v[52:53], s[92:93], v[216:217] neg_lo:[0,0,1] neg_hi:[0,0,1]
  v_pk_fma_f32 v[114:115], v[54:55], s[92:93], v[218:219] neg_lo:[0,0,1] neg_hi:[0,0,1]
  v_cvt_pk_bf16_f32 v112, 0, v112
  v_cvt_pk_bf16_f32 v113, 0, v113
  v_cvt_pk_bf16_f32 v114, 0, v114
  v_cvt_pk_bf16_f32 v115, 0, v115
  v_pk_mul_f32 v[112:113], v[112:113], v[204:205]
  v_pk_mul_f32 v[114:115], v[114:115], v[206:207]
  v_cvt_pk_bf16_f32 v224, v112, v113
  v_cvt_pk_bf16_f32 v225, v114, v115
  s_waitcnt vmcnt(14)
  s_cbranch_vccnz L_kw1_24
  s_waitcnt vmcnt(10)
L_kw1_24:
  buffer_load_dwordx4 v[28:31], v93, s[16:19], s61 offen offset:768 nt
  v_mfma_f32_16x16x16_bf16 v[228:231], v[224:225], v[176:177], v[228:231]
  v_pk_fma_f32 v[112:113], v[56:57], s[92:93], v[208:209] neg_lo:[0,0,1] neg_hi:[0,0,1]
  v_pk_fma_f32 v[114:115], v[58:59], s[92:93], v[210:211] neg_lo:[0,0,1] neg_hi:[0,0,1]
  v_cvt_pk_bf16_f32 v112, 0, v112
  v_cvt_pk_bf16_f32 v113, 0, v113
  v_cvt_pk_bf16_f32 v114, 0, v114
  v_cvt_pk_bf16_f32 v115, 0, v115
  v_pk_mul_f32 v[112:113], v[112:113], v[196:197]
  v_pk_mul_f32 v[114:115], v[114:115], v[198:199]
  v_cvt_pk_bf16_f32 v220, v112, v113
  v_cvt_pk_bf16_f32 v221, v114, v115
  s_waitcnt vmcnt(14)
  s_cbranch_vccnz L_kw1_25
  s_waitcnt vmcnt(10)
L_kw1_25:
  buffer_load_dwordx4 v[32:35], v93, s[16:19], s61 offen offset:1024 nt
  v_pk_fma_f32 v[112:113], v[60:61], s[92:93], v[212:213] neg_lo:[0,0,1] neg_hi:[0,0,1]
  v_pk_fma_f32 v[114:115], v[62:63], s[92:93], v[214:215] neg_lo:[0,0,1] neg_hi:[0,0,1]
  v_mov_b32_dpp v148, v228 quad_perm:[0,0,0,0] row_mask:0xf bank_mask:0xf
  v_mov_b32_dpp v149, v230 quad_perm:[2,2,2,2] row_mask:0xf bank_mask:0xf
  v_cvt_pk_bf16_f32 v112, 0, v112
  v_cvt_pk_bf16_f32 v113, 0, v113
  v_add_f32_dpp v148, v229, v148 quad_perm:[1,1,1,1] row_mask:0xf bank_mask:0xf
  v_add_f32_dpp v149, v231, v149 quad_perm:[3,3,3,3] row_mask:0xf bank_mask:0xf
  v_cvt_pk_bf16_f32 v114, 0, v114
  v_cvt_pk_bf16_f32 v115, 0, v115
  v_add_f32 v233, v148, v149
  v_pk_mul_f32 v[112:113], v[112:113], v[200:201]
  v_pk_mul_f32 v[114:115], v[114:115], v[202:203]
  v_cvt_pk_bf16_f32 v222, v112, v113
  v_cvt_pk_bf16_f32 v223, v114, v115
  s_waitcnt vmcnt(14)
  s_cbranch_vccnz L_kw1_26
  s_waitcnt vmcnt(10)
L_kw1_26:
  buffer_load_dwordx4 v[36:39], v93, s[16:19], s61 offen offset:1280 nt
  v_mfma_f32_16x16x32_bf16 v[228:231], v[220:223], v[172:175], 0
  v_pk_fma_f32 v[112:113], v[64:65], s[92:93], v[216:217] neg_lo:[0,0,1] neg_hi:[0,0,1]
  v_pk_fma_f32 v[114:115], v[66:67], s[92:93], v[218:219] neg_lo:[0,0,1] neg_hi:[0,0,1]
  v_cvt_pk_bf16_f32 v112, 0, v112
  v_cvt_pk_bf16_f32 v232, 0, v232
  v_cvt_pk_bf16_f32 v113, 0, v113
  v_cvt_pk_bf16_f32 v233, 0, v233
  v_cvt_pk_bf16_f32 v114, 0, v114
  v_pk_mul_f32 v[232:233], v[232:233], s[68:69]
  v_cvt_pk_bf16_f32 v115, 0, v115
  v_cvt_pk_bf16_f32 v127, v232, v233
  v_pk_mul_f32 v[112:113], v[112:113], v[204:205]
  v_pk_mul_f32 v[114:115], v[114:115], v[206:207]
  v_cvt_pk_bf16_f32 v224, v112, v113
  v_cvt_pk_bf16_f32 v225, v114, v115
  s_waitcnt vmcnt(14)
  s_cbranch_vccnz L_kw1_27
  s_waitcnt vmcnt(10)
L_kw1_27:
  buffer_load_dwordx4 v[40:43], v93, s[16:19], s61 offen offset:1536 nt
  v_mfma_f32_16x16x16_bf16 v[228:231], v[224:225], v[176:177], v[228:231]
  v_pk_fma_f32 v[112:113], v[68:69], s[92:93], v[208:209] neg_lo:[0,0,1] neg_hi:[0,0,1]
  v_pk_fma_f32 v[114:115], v[70:71], s[92:93], v[210:211] neg_lo:[0,0,1] neg_hi:[0,0,1]
  v_cvt_pk_bf16_f32 v112, 0, v112
  v_cvt_pk_bf16_f32 v113, 0, v113
  v_cvt_pk_bf16_f32 v114, 0, v114
  v_cvt_pk_bf16_f32 v115, 0, v115
  v_pk_mul_f32 v[112:113], v[112:113], v[196:197]
  v_pk_mul_f32 v[114:115], v[114:115], v[198:199]
  v_cvt_pk_bf16_f32 v220, v112, v113
  v_cvt_pk_bf16_f32 v221, v114, v115
  s_waitcnt vmcnt(14)
  s_cbranch_vccnz L_kw1_28
  s_waitcnt vmcnt(10)
L_kw1_28:
  buffer_load_dwordx4 v[44:47], v93, s[16:19], s61 offen offset:1792 nt
  v_pk_fma_f32 v[112:113], v[72:73], s[92:93], v[212:213] neg_lo:[0,0,1] neg_hi:[0,0,1]
  v_pk_fma_f32 v[114:115], v[74:75], s[92:93], v[214:215] neg_lo:[0,0,1] neg_hi:[0,0,1]
  v_mov_b32_dpp v148, v228 quad_perm:[0,0,0,0] row_mask:0xf bank_mask:0xf
  v_mov_b32_dpp v149, v230 quad_perm:[2,2,2,2] row_mask:0xf bank_mask:0xf
  v_cvt_pk_bf16_f32 v112, 0, v112
  v_cvt_pk_bf16_f32 v113, 0, v113
  v_add_f32_dpp v148, v229, v148 quad_perm:[1,1,1,1] row_mask:0xf bank_mask:0xf
  v_add_f32_dpp v149, v231, v149 quad_perm:[3,3,3,3] row_mask:0xf bank_mask:0xf
  v_cvt_pk_bf16_f32 v114, 0, v114
  v_cvt_pk_bf16_f32 v115, 0, v115
  v_add_f32 v232, v148, v149
  v_pk_mul_f32 v[112:113], v[112:113], v[200:201]
  v_pk_mul_f32 v[114:115], v[114:115], v[202:203]
  v_cvt_pk_bf16_f32 v222, v112, v113
  v_cvt_pk_bf16_f32 v223, v114, v115
  s_waitcnt vmcnt(14)
  s_cbranch_vccnz L_kw1_29
  s_waitcnt vmcnt(10)
L_kw1_29:
  buffer_load_dwordx4 v[48:51], v93, s[16:19], s61 offen offset:2048 nt
  v_mfma_f32_16x16x32_bf16 v[228:231], v[220:223], v[172:175], 0
  v_pk_fma_f32 v[112:113], v[76:77], s[92:93], v[216:217] neg_lo:[0,0,1] neg_hi:[0,0,1]
  v_pk_fma_f32 v[114:115], v[78:79], s[92:93], v[218:219] neg_lo:[0,0,1] neg_hi:[0,0,1]
  v_cvt_pk_bf16_f32 v112, 0, v112
  v_cvt_pk_bf16_f32 v113, 0, v113
  v_cvt_pk_bf16_f32 v114, 0, v114
  v_cvt_pk_bf16_f32 v115, 0, v115
  v_pk_mul_f32 v[112:113], v[112:113], v[204:205]
  v_pk_mul_f32 v[114:115], v[114:115], v[206:207]
  v_cvt_pk_bf16_f32 v224, v112, v113
  v_cvt_pk_bf16_f32 v225, v114, v115
  s_waitcnt vmcnt(14)
  s_cbranch_vccnz L_kw1_30
  s_waitcnt vmcnt(10)
L_kw1_30:
  buffer_load_dwordx4 v[52:55], v93, s[16:19], s61 offen offset:2304 nt
  v_mfma_f32_16x16x16_bf16 v[228:231], v[224:225], v[176:177], v[228:231]
  v_pk_fma_f32 v[112:113], v[80:81], s[92:93], v[208:209] neg_lo:[0,0,1] neg_hi:[0,0,1]
  v_pk_fma_f32 v[114:115], v[82:83], s[92:93], v[210:211] neg_lo:[0,0,1] neg_hi:[0,0,1]
  v_cvt_pk_bf16_f32 v112, 0, v112
  v_cvt_pk_bf16_f32 v113, 0, v113
  v_cvt_pk_bf16_f32 v114, 0, v114
  v_cvt_pk_bf16_f32 v115, 0, v115
  v_pk_mul_f32 v[112:113], v[112:113], v[196:197]
  v_pk_mul_f32 v[114:115], v[114:115], v[198:199]
  v_cvt_pk_bf16_f32 v220, v112, v113
  v_cvt_pk_bf16_f32 v221, v114, v115
  s_waitcnt vmcnt(14)
  s_cbranch_vccnz L_kw1_31
  s_waitcnt vmcnt(10)
L_kw1_31:
  buffer_load_dwordx4 v[56:59], v93, s[16:19], s61 offen offset:2560 nt
  v_pk_fma_f32 v[112:113], v[84:85], s[92:93], v[212:213] neg_lo:[0,0,1] neg_hi:[0,0,1]
  v_pk_fma_f32 v[114:115], v[86:87], s[92:93], v[214:215] neg_lo:[0,0,1] neg_hi:[0,0,1]
  v_mov_b32_dpp v148, v228 quad_perm:[0,0,0,0] row_mask:0xf bank_mask:0xf
  v_mov_b32_dpp v149, v230 quad_perm:[2,2,2,2] row_mask:0xf bank_mask:0xf
  v_cvt_pk_bf16_f32 v112, 0, v112
  v_cvt_pk_bf16_f32 v113, 0, v113
  v_add_f32_dpp v148, v229, v148 quad_perm:[1,1,1,1] row_mask:0xf bank_mask:0xf
  v_add_f32_dpp v149, v231, v149 quad_perm:[3,3,3,3] row_mask:0xf bank_mask:0xf
  v_cvt_pk_bf16_f32 v114, 0, v114
  v_cvt_pk_bf16_f32 v115, 0, v115
  v_add_f32 v233, v148, v149
  v_pk_mul_f32 v[112:113], v[112:113], v[200:201]
  v_pk_mul_f32 v[114:115], v[114:115], v[202:203]
  v_cvt_pk_bf16_f32 v222, v112, v113
  v_cvt_pk_bf16_f32 v223, v114, v115
  s_waitcnt vmcnt(14)
  s_cbranch_vccnz L_kw1_32
  s_waitcnt vmcnt(10)
L_kw1_32:
  buffer_load_dwordx4 v[60:63], v93, s[16:19], s61 offen offset:2816 nt
  v_mfma_f32_16x16x32_bf16 v[228:231], v[220:223], v[172:175], 0
  v_pk_fma_f32 v[112:113], v[88:89], s[92:93], v[216:217] neg_lo:[0,0,1] neg_hi:[0,0,1]
  v_pk_fma_f32 v[114:115], v[90:91], s[92:93], v[218:219] neg_lo:[0,0,1] neg_hi:[0,0,1]
  v_cvt_pk_bf16_f32 v112, 0, v112
  v_cvt_pk_bf16_f32 v232, 0, v232
  v_cvt_pk_bf16_f32 v113, 0, v113
  v_cvt_pk_bf16_f32 v233, 0, v233
  v_cvt_pk_bf16_f32 v114, 0, v114
  v_pk_mul_f32 v[232:233], v[232:233], s[68:69]
  v_cvt_pk_bf16_f32 v115, 0, v115
  v_cvt_pk_bf16_f32 v128, v232, v233
  v_pk_mul_f32 v[112:113], v[112:113], v[204:205]
  v_pk_mul_f32 v[114:115], v[114:115], v[206:207]
  v_cvt_pk_bf16_f32 v224, v112, v113
  v_cvt_pk_bf16_f32 v225, v114, v115
  s_mov_b32 s60, s61
  v_mov_b32 v150, s64
  v_mfma_f32_16x16x16_bf16 v[228:231], v[224:225], v[176:177], v[228:231]
  ds_write_b128 v102, v[124:127]
  v_add_u32 v102, 768, v102
  s_nop 5
  v_mov_b32_dpp v148, v228 quad_perm:[0,0,0,0] row_mask:0xf bank_mask:0xf
  v_mov_b32_dpp v149, v230 quad_perm:[2,2,2,2] row_mask:0xf bank_mask:0xf
  s_nop 0
  v_add_f32_dpp v148, v229, v148 quad_perm:[1,1,1,1] row_mask:0xf bank_mask:0xf
  v_add_f32_dpp v149, v231, v149 quad_perm:[3,3,3,3] row_mask:0xf bank_mask:0xf
  v_add_f32 v232, v148, v149
  v_cndmask_b32 v232, v232, v240, s[50:51]
  v_cvt_pk_bf16_f32 v232, 0, v232
  v_cvt_pk_bf16_f32 v233, 0, v233
  v_pk_mul_f32 v[232:233], v[232:233], s[68:69]
  v_cvt_pk_bf16_f32 v129, v232, v233
  ds_write_b64 v103, v[128:129] offset:256
  ds_write_b32 v107, v150
  v_add_u32 v103, 768, v103
  s_cmp_lt_u32 s64, 96
  s_cbranch_scc1 L_k
  v_subrev_u32 v102, 36864, v102
  v_subrev_u32 v103, 36864, v103
  s_mov_b32 s64, s3
  s_mov_b32 s88, s89
  s_mov_b32 s99, 0
  s_cmp_lt_u32 s64, s99
  s_cbranch_scc1 L_v0_ok
L_v0_spin:
  v_mov_b32 v148, 61700
  ds_read_b32 v148, v148
  s_waitcnt lgkmcnt(0)
  v_readfirstlane_b32 s99, v148
  s_nop 1
  s_cmp_lt_u32 s64, s99
  s_cbranch_scc0 L_v0_spin
L_v0_ok:
  ds_read_b128 v[124:127], v102
  ds_read_b64 v[128:129], v103 offset:256
L_v0:
  s_mov_b32 s86, s84
  s_mov_b32 s87, s85
  s_add_u32 s64, s64, 2
  s_cmp_lt_u32 s64, s99
  s_cbranch_scc1 L_v10_ok
L_v10_spin:
  v_mov_b32 v148, 61700
  ds_read_b32 v148, v148
  s_waitcnt lgkmcnt(0)
  v_readfirstlane_b32 s99, v148
  s_nop 1
  s_cmp_lt_u32 s64, s99
  s_cbranch_scc0 L_v10_spin
L_v10_ok:
  s_andn2_b32 s70, s64, 1
  s_or_b32 s70, s70, s4
  s_lshr_b32 s71, s64, 5
  s_lshr_b32 s85, s96, s71
  s_lshr_b32 s85, s85, 3
  s_cmp_lt_u32 s64, s97
  s_cselect_b32 s70, s70, s64
  s_cselect_b32 s85, s64, s85
  s_and_b32 s85, s85, 1
  s_mul_i32 s71, s71, 4064
  s_add_u32 s70, s70, s71
  s_add_u32 s70, s70, s5
  s_mul_hi_u32 s84, s70, s90
  s_lshr_b32 s84, s84, 1
  s_mul_i32 s71, s84, 3
  s_sub_u32 s70, s70, s71
  s_lshl3_add_u32 s85, s70, s85
  s_mul_i32 s61, s84, 196608
  s_lshr_b32 s89, s84, 4
  s_lshl_b32 s70, s85, 5
  v_add_u32 v100, s70, v96
  v_mul_u32_u24 v100, 21846, v100
  v_lshrrev_b32 v100, 16, v100
  v_add_u32 v148, s85, v97
  v_lshrrev_b32 v149, v148, s91
  v_and_b32 v149, 1, v149
  v_cmp_eq_u32 s[54:55], 1, v149
  s_nop 1
  s_and_b64 s[52:53], s[54:55], s[58:59]
  s_andn2_b64 s[54:55], s[54:55], s[58:59]
  s_cmp_lt_u32 s64, 96
  s_cselect_b32 s61, s61, 805306368
  s_add_u32 s70, s64, 94
  v_mov_b32 v150, s70
  ds_read_b32 v110, v109
  ds_write_b32 v107, v150
  s_waitcnt vmcnt(14)
  s_cbranch_vccnz L_vw0_0
  s_waitcnt vmcnt(10)
L_vw0_0:
  buffer_load_dwordx4 v[64:67], v93, s[12:15], s60 offen offset:3072 nt
  v_mul_f32 v118, s94, v116
  v_mul_f32 v119, 0x4a800000, v117
  s_nop 0
  v_mov_b32_dpp v120, v118 row_newbcast:0 row_mask:0xf bank_mask:0xf
  v_mov_b32_dpp v121, v119 row_newbcast:0 row_mask:0xf bank_mask:0xf
  v_pk_fma_f32 v[196:197], v[4:5], s[92:93], v[120:121] op_sel_hi:[1,1,0] neg_lo:[0,0,1] neg_hi:[0,0,1]
  v_pk_fma_f32 v[198:199], v[6:7], s[92:93], v[120:121] op_sel_hi:[1,1,0] neg_lo:[0,0,1] neg_hi:[0,0,1]
  v_cvt_pk_bf16_f32 v196, 0, v196
  s_waitcnt lgkmcnt(0)
  v_cvt_pk_bf16_f32 v197, 0, v197
  v_cmp_lt_u32 vcc, v150, v110
  v_cvt_pk_bf16_f32 v198, 0, v198
  v_lshlrev_b32 v152, 16, v124
  v_cvt_pk_bf16_f32 v199, 0, v199
  v_and_b32 v153, s65, v124
  v_pk_mul_f32 v[196:197], v[196:197], v[120:121] op_sel:[0,1]
  v_lshlrev_b32 v154, 16, v125
  v_pk_mul_f32 v[198:199], v[198:199], v[120:121] op_sel:[0,1]
  s_waitcnt vmcnt(14)
  s_cbranch_vccnz L_vw0_1
  s_waitcnt vmcnt(10)
L_vw0_1:
  buffer_load_dwordx4 v[68:71], v93, s[12:15], s60 offen offset:3328 nt
  v_pk_fma_f32 v[200:201], v[8:9], s[92:93], v[120:121] op_sel_hi:[1,1,0] neg_lo:[0,0,1] neg_hi:[0,0,1]
  v_pk_fma_f32 v[202:203], v[10:11], s[92:93], v[120:121] op_sel_hi:[1,1,0] neg_lo:[0,0,1] neg_hi:[0,0,1]
  v_cvt_pk_bf16_f32 v200, 0, v200
  v_and_b32 v155, s65, v125
  v_cvt_pk_bf16_f32 v201, 0, v201
  v_lshlrev_b32 v156, 16, v126
  v_cvt_pk_bf16_f32 v202, 0, v202
  v_and_b32 v157, s65, v126
  v_cvt_pk_bf16_f32 v203, 0, v203
  v_lshlrev_b32 v158, 16, v127
  v_pk_mul_f32 v[200:201], v[200:201], v[120:121] op_sel:[0,1]
  v_and_b32 v159, s65, v127
  v_pk_mul_f32 v[202:203], v[202:203], v[120:121] op_sel:[0,1]
  s_waitcnt vmcnt(14)
  s_cbranch_vccnz L_vw0_2
  s_waitcnt vmcnt(10)
L_vw0_2:
  buffer_load_dwordx4 v[72:75], v93, s[12:15], s60 offen offset:3584 nt
  v_pk_fma_f32 v[204:205], v[12:13], s[92:93], v[120:121] op_sel_hi:[1,1,0] neg_lo:[0,0,1] neg_hi:[0,0,1]
  v_pk_fma_f32 v[206:207], v[14:15], s[92:93], v[120:121] op_sel_hi:[1,1,0] neg_lo:[0,0,1] neg_hi:[0,0,1]
  v_cvt_pk_bf16_f32 v204, 0, v204
  v_lshlrev_b32 v160, 16, v128
  v_cvt_pk_bf16_f32 v205, 0, v205
  v_and_b32 v161, s65, v128
  v_cvt_pk_bf16_f32 v206, 0, v206
  v_lshlrev_b32 v162, 16, v129
  v_cvt_pk_bf16_f32 v207, 0, v207
  v_add_u32 v102, 768, v102
  v_pk_mul_f32 v[204:205], v[204:205], v[120:121] op_sel:[0,1]
  v_add_u32 v103, 768, v103
  v_pk_mul_f32 v[206:207], v[206:207], v[120:121] op_sel:[0,1]
  s_waitcnt vmcnt(14)
  s_cbranch_vccnz L_vw0_3
  s_waitcnt vmcnt(10)
L_vw0_3:
  buffer_load_dwordx4 v[76:79], v94, s[12:15], s60 offen offset:0 nt
  v_mov_b32_dpp v120, v118 row_newbcast:1 row_mask:0xf bank_mask:0xf
  v_mov_b32_dpp v121, v119 row_newbcast:1 row_mask:0xf bank_mask:0xf
  v_pk_fma_f32 v[112:113], v[16:17], s[92:93], v[120:121] op_sel_hi:[1,1,0] neg_lo:[0,0,1] neg_hi:[0,0,1]
  v_pk_fma_f32 v[114:115], v[18:19], s[92:93], v[120:121] op_sel_hi:[1,1,0] neg_lo:[0,0,1] neg_hi:[0,0,1]
  s_lshl_b32 s62, s84, 9
  v_lshl_add_u32 v101, v100, 1, v99
  buffer_load_short_d16_hi v116, v101, s[32:35], s62 offen
  buffer_load_short_d16_hi v117, v101, s[28:31], s62 offen
  v_cvt_pk_bf16_f32 v112, 0, v112
  v_max3_f32 v148, v152, v153, v154
  v_cvt_pk_bf16_f32 v113, 0, v113
  ds_read_b128 v[124:127], v102
  v_cvt_pk_bf16_f32 v114, 0, v114
  ds_read_b64 v[128:129], v103 offset:256
  v_cvt_pk_bf16_f32 v115, 0, v115
  v_max3_f32 v149, v155, v156, v157
  v_pk_mul_f32 v[112:113], v[112:113], v[120:121] op_sel:[0,1]
  v_max3_f32 v148, v148, v158, v159
  v_pk_mul_f32 v[114:115], v[114:115], v[120:121] op_sel:[0,1]
  v_cvt_pk_bf16_f32 v208, v196, v112
  v_cvt_pk_bf16_f32 v212, v197, v113
  v_cvt_pk_bf16_f32 v216, v198, v114
  v_cvt_pk_bf16_f32 v220, v199, v115
  s_waitcnt vmcnt(16)
  s_cbranch_vccnz L_vw0_4
  s_waitcnt vmcnt(12)
L_vw0_4:
  buffer_load_dwordx4 v[80:83], v94, s[12:15], s60 offen offset:256 nt
  v_pk_fma_f32 v[112:113], v[20:21], s[92:93], v[120:121] op_sel_hi:[1,1,0] neg_lo:[0,0,1] neg_hi:[0,0,1]
  v_pk_fma_f32 v[114:115], v[22:23], s[92:93], v[120:121] op_sel_hi:[1,1,0] neg_lo:[0,0,1] neg_hi:[0,0,1]
  v_cvt_pk_bf16_f32 v112, 0, v112
  v_max3_f32 v149, v149, v160, v161
  v_cvt_pk_bf16_f32 v113, 0, v113
  v_max3_f32 v148, v148, v162, v144
  v_cvt_pk_bf16_f32 v114, 0, v114
  v_max_f32 v148, v148, v149
  v_cvt_pk_bf16_f32 v115, 0, v115
  v_mov_b32 v149, v148
  v_pk_mul_f32 v[112:113], v[112:113], v[120:121] op_sel:[0,1]
  s_nop 0
  v_permlane32_swap_b32 v148, v149
  v_pk_mul_f32 v[114:115], v[114:115], v[120:121] op_sel:[0,1]
  v_cvt_pk_bf16_f32 v224, v200, v112
  v_cvt_pk_bf16_f32 v228, v201, v113
  v_cvt_pk_bf16_f32 v232, v202, v114
  v_cvt_pk_bf16_f32 v236, v203, v115
  s_waitcnt vmcnt(16)
  s_cbranch_vccnz L_vw0_5
  s_waitcnt vmcnt(12)
L_vw0_5:
  buffer_load_dwordx4 v[84:87], v94, s[12:15], s60 offen offset:512 nt
  v_pk_fma_f32 v[112:113], v[24:25], s[92:93], v[120:121] op_sel_hi:[1,1,0] neg_lo:[0,0,1] neg_hi:[0,0,1]
  v_pk_fma_f32 v[114:115], v[26:27], s[92:93], v[120:121] op_sel_hi:[1,1,0] neg_lo:[0,0,1] neg_hi:[0,0,1]
  v_cvt_pk_bf16_f32 v112, 0, v112
  v_max_f32 v148, v148, v149
  v_cvt_pk_bf16_f32 v113, 0, v113
  v_mov_b32 v149, v148
  v_cvt_pk_bf16_f32 v114, 0, v114
  s_nop 0
  v_permlane16_swap_b32 v148, v149
  v_cvt_pk_bf16_f32 v115, 0, v115
  v_max_f32 v144, v148, v149
  v_pk_mul_f32 v[112:113], v[112:113], v[120:121] op_sel:[0,1]
  v_mul_f32 v148, s66, v144
  v_pk_mul_f32 v[114:115], v[114:115], v[120:121] op_sel:[0,1]
  v_cvt_pk_bf16_f32 v240, v204, v112
  v_cvt_pk_bf16_f32 v244, v205, v113
  v_cvt_pk_bf16_f32 v248, v206, v114
  v_cvt_pk_bf16_f32 v252, v207, v115
  s_waitcnt vmcnt(16)
  s_cbranch_vccnz L_vw0_6
  s_waitcnt vmcnt(12)
L_vw0_6:
  buffer_load_dwordx4 v[88:91], v94, s[12:15], s60 offen offset:768 nt
  v_mov_b32_dpp v120, v118 row_newbcast:2 row_mask:0xf bank_mask:0xf
  v_mov_b32_dpp v121, v119 row_newbcast:2 row_mask:0xf bank_mask:0xf
  v_pk_fma_f32 v[196:197], v[28:29], s[92:93], v[120:121] op_sel_hi:[1,1,0] neg_lo:[0,0,1] neg_hi:[0,0,1]
  v_pk_fma_f32 v[198:199], v[30:31], s[92:93], v[120:121] op_sel_hi:[1,1,0] neg_lo:[0,0,1] neg_hi:[0,0,1]
  v_cvt_pk_bf16_f32 v196, 0, v196
  v_add_f32 v150, v148, v146
  v_cvt_pk_bf16_f32 v197, 0, v197
  v_sub_f32 v146, 0, v148
  v_cvt_pk_bf16_f32 v198, 0, v198
  v_exp_f32 v150, -v150
  v_cvt_pk_bf16_f32 v199, 0, v199
  ds_bpermute_b32 v151, v104, v150
  v_pk_mul_f32 v[196:197], v[196:197], v[120:121] op_sel:[0,1]
  v_fma_f32 v152, v152, s66, v146
  v_pk_mul_f32 v[198:199], v[198:199], v[120:121] op_sel:[0,1]
  s_waitcnt vmcnt(16)
  s_cbranch_vccnz L_vw0_7
  s_waitcnt vmcnt(12)
L_vw0_7:
  buffer_load_dwordx4 v[4:7], v94, s[12:15], s60 offen offset:1024 nt
  v_pk_fma_f32 v[200:201], v[32:33], s[92:93], v[120:121] op_sel_hi:[1,1,0] neg_lo:[0,0,1] neg_hi:[0,0,1]
  v_pk_fma_f32 v[202:203], v[34:35], s[92:93], v[120:121] op_sel_hi:[1,1,0] neg_lo:[0,0,1] neg_hi:[0,0,1]
  v_cvt_pk_bf16_f32 v200, 0, v200
  v_exp_f32 v152, v152
  v_cvt_pk_bf16_f32 v201, 0, v201
  v_fma_f32 v153, v153, s66, v146
  v_cvt_pk_bf16_f32 v202, 0, v202
  v_exp_f32 v153, v153
  v_cvt_pk_bf16_f32 v203, 0, v203
  v_fma_f32 v154, v154, s66, v146
  v_pk_mul_f32 v[200:201], v[200:201], v[120:121] op_sel:[0,1]
  v_exp_f32 v154, v154
  v_pk_mul_f32 v[202:203], v[202:203], v[120:121] op_sel:[0,1]
  s_waitcnt vmcnt(16)
  s_cbranch_vccnz L_vw0_8
  s_waitcnt vmcnt(12)
L_vw0_8:
  buffer_load_dwordx4 v[8:11], v94, s[12:15], s60 offen offset:1280 nt
  v_pk_fma_f32 v[204:205], v[36:37], s[92:93], v[120:121] op_sel_hi:[1,1,0] neg_lo:[0,0,1] neg_hi:[0,0,1]
  v_pk_fma_f32 v[206:207], v[38:39], s[92:93], v[120:121] op_sel_hi:[1,1,0] neg_lo:[0,0,1] neg_hi:[0,0,1]
  v_cvt_pk_bf16_f32 v204, 0, v204
  v_fma_f32 v155, v155, s66, v146
  v_cvt_pk_bf16_f32 v205, 0, v205
  v_exp_f32 v155, v155
  v_cvt_pk_bf16_f32 v206, 0, v206
  v_fma_f32 v156, v156, s66, v146
  v_cvt_pk_bf16_f32 v207, 0, v207
  v_exp_f32 v156, v156
  v_pk_mul_f32 v[204:205], v[204:205], v[120:121] op_sel:[0,1]
  v_fma_f32 v157, v157, s66, v146
  v_pk_mul_f32 v[206:207], v[206:207], v[120:121] op_sel:[0,1]
  s_waitcnt vmcnt(16)
  s_cbranch_vccnz L_vw0_9
  s_waitcnt vmcnt(12)
L_vw0_9:
  buffer_load_dwordx4 v[12:15], v94, s[12:15], s60 offen offset:1536 nt
  v_mov_b32_dpp v120, v118 row_newbcast:3 row_mask:0xf bank_mask:0xf
  v_mov_b32_dpp v121, v119 row_newbcast:3 row_mask:0xf bank_mask:0xf
  v_pk_fma_f32 v[112:113], v[40:41], s[92:93], v[120:121] op_sel_hi:[1,1,0] neg_lo:[0,0,1] neg_hi:[0,0,1]
  v_pk_fma_f32 v[114:115], v[42:43], s[92:93], v[120:121] op_sel_hi:[1,1,0] neg_lo:[0,0,1] neg_hi:[0,0,1]
  v_cvt_pk_bf16_f32 v112, 0, v112
  v_exp_f32 v157, v157
  v_cvt_pk_bf16_f32 v113, 0, v113
  v_fma_f32 v158, v158, s66, v146
  v_cvt_pk_bf16_f32 v114, 0, v114
  v_exp_f32 v158, v158
  v_cvt_pk_bf16_f32 v115, 0, v115
  v_fma_f32 v159, v159, s66, v146
  v_pk_mul_f32 v[112:113], v[112:113], v[120:121] op_sel:[0,1]
  v_exp_f32 v159, v159
  v_pk_mul_f32 v[114:115], v[114:115], v[120:121] op_sel:[0,1]
  v_cvt_pk_bf16_f32 v209, v196, v112
  v_cvt_pk_bf16_f32 v213, v197, v113
  v_cvt_pk_bf16_f32 v217, v198, v114
  v_cvt_pk_bf16_f32 v221, v199, v115
  s_waitcnt vmcnt(16)
  s_cbranch_vccnz L_vw0_10
  s_waitcnt vmcnt(12)
L_vw0_10:
  buffer_load_dwordx4 v[16:19], v94, s[12:15], s60 offen offset:1792 nt
  v_pk_fma_f32 v[112:113], v[44:45], s[92:93], v[120:121] op_sel_hi:[1,1,0] neg_lo:[0,0,1] neg_hi:[0,0,1]
  v_pk_fma_f32 v[114:115], v[46:47], s[92:93], v[120:121] op_sel_hi:[1,1,0] neg_lo:[0,0,1] neg_hi:[0,0,1]
  v_cvt_pk_bf16_f32 v112, 0, v112
  v_fma_f32 v160, v160, s66, v146
  v_cvt_pk_bf16_f32 v113, 0, v113
  v_exp_f32 v160, v160
  v_cvt_pk_bf16_f32 v114, 0, v114
  v_fma_f32 v161, v161, s66, v146
  v_cvt_pk_bf16_f32 v115, 0, v115
  v_exp_f32 v161, v161
  v_pk_mul_f32 v[112:113], v[112:113], v[120:121] op_sel:[0,1]
  v_fma_f32 v162, v162, s66, v146
  v_pk_mul_f32 v[114:115], v[114:115], v[120:121] op_sel:[0,1]
  v_cvt_pk_bf16_f32 v225, v200, v112
  v_cvt_pk_bf16_f32 v229, v201, v113
  v_cvt_pk_bf16_f32 v233, v202, v114
  v_cvt_pk_bf16_f32 v237, v203, v115
  s_waitcnt vmcnt(16)
  s_cbranch_vccnz L_vw0_11
  s_waitcnt vmcnt(12)
L_vw0_11:
  buffer_load_dwordx4 v[20:23], v94, s[12:15], s60 offen offset:2048 nt
  v_pk_fma_f32 v[112:113], v[48:49], s[92:93], v[120:121] op_sel_hi:[1,1,0] neg_lo:[0,0,1] neg_hi:[0,0,1]
  v_pk_fma_f32 v[114:115], v[50:51], s[92:93], v[120:121] op_sel_hi:[1,1,0] neg_lo:[0,0,1] neg_hi:[0,0,1]
  v_cvt_pk_bf16_f32 v112, 0, v112
  v_exp_f32 v162, v162
  v_cvt_pk_bf16_f32 v113, 0, v113
  v_add_f32 v148, v152, v153
  v_cvt_pk_bf16_f32 v114, 0, v114
  v_add_f32 v149, v154, v155
  v_cvt_pk_bf16_f32 v115, 0, v115
  v_add_f32 v148, v148, v156
  v_pk_mul_f32 v[112:113], v[112:113], v[120:121] op_sel:[0,1]
  v_add_f32 v149, v149, v157
  v_pk_mul_f32 v[114:115], v[114:115], v[120:121] op_sel:[0,1]
  v_cvt_pk_bf16_f32 v241, v204, v112
  v_cvt_pk_bf16_f32 v245, v205, v113
  v_cvt_pk_bf16_f32 v249, v206, v114
  v_cvt_pk_bf16_f32 v253, v207, v115
  s_waitcnt vmcnt(16)
  s_cbranch_vccnz L_vw0_12
  s_waitcnt vmcnt(12)
L_vw0_12:
  buffer_load_dwordx4 v[24:27], v94, s[12:15], s60 offen offset:2304 nt
  v_mov_b32_dpp v120, v118 row_newbcast:4 row_mask:0xf bank_mask:0xf
  v_mov_b32_dpp v121, v119 row_newbcast:4 row_mask:0xf bank_mask:0xf
  v_pk_fma_f32 v[196:197], v[52:53], s[92:93], v[120:121] op_sel_hi:[1,1,0] neg_lo:[0,0,1] neg_hi:[0,0,1]
  v_pk_fma_f32 v[198:199], v[54:55], s[92:93], v[120:121] op_sel_hi:[1,1,0] neg_lo:[0,0,1] neg_hi:[0,0,1]
  v_cvt_pk_bf16_f32 v196, 0, v196
  v_add_f32 v148, v148, v158
  v_cvt_pk_bf16_f32 v197, 0, v197
  v_add_f32 v149, v149, v159
  v_cvt_pk_bf16_f32 v198, 0, v198
  v_add_f32 v148, v148, v160
  v_cvt_pk_bf16_f32 v199, 0, v199
  v_add_f32 v149, v149, v161
  v_pk_mul_f32 v[196:197], v[196:197], v[120:121] op_sel:[0,1]
  v_add_f32 v148, v148, v162
  v_pk_mul_f32 v[198:199], v[198:199], v[120:121] op_sel:[0,1]
  s_waitcnt vmcnt(16)
  s_cbranch_vccnz L_vw0_13
  s_waitcnt vmcnt(12)
L_vw0_13:
  buffer_load_dwordx4 v[28:31], v94, s[12:15], s60 offen offset:2560 nt
  v_pk_fma_f32 v[200:201], v[56:57], s[92:93], v[120:121] op_sel_hi:[1,1,0] neg_lo:[0,0,1] neg_hi:[0,0,1]
  v_pk_fma_f32 v[202:203], v[58:59], s[92:93], v[120:121] op_sel_hi:[1,1,0] neg_lo:[0,0,1] neg_hi:[0,0,1]
  v_cvt_pk_bf16_f32 v200, 0, v200
  v_add_f32 v148, v148, v149
  v_cvt_pk_bf16_f32 v201, 0, v201
  v_fma_f32 v147, v147, v150, v148
  v_cvt_pk_bf16_f32 v202, 0, v202
  v_cvt_pk_bf16_f32 v163, v152, v153
  v_cvt_pk_bf16_f32 v203, 0, v203
  v_cvt_pk_bf16_f32 v164, v154, v155
  v_pk_mul_f32 v[200:201], v[200:201], v[120:121] op_sel:[0,1]
  v_cvt_pk_bf16_f32 v165, v156, v157
  v_pk_mul_f32 v[202:203], v[202:203], v[120:121] op_sel:[0,1]
  s_waitcnt vmcnt(16)
  s_cbranch_vccnz L_vw0_14
  s_waitcnt vmcnt(12)
L_vw0_14:
  buffer_load_dwordx4 v[32:35], v94, s[12:15], s60 offen offset:2816 nt
  v_pk_fma_f32 v[204:205], v[60:61], s[92:93], v[120:121] op_sel_hi:[1,1,0] neg_lo:[0,0,1] neg_hi:[0,0,1]
  v_pk_fma_f32 v[206:207], v[62:63], s[92:93], v[120:121] op_sel_hi:[1,1,0] neg_lo:[0,0,1] neg_hi:[0,0,1]
  v_cvt_pk_bf16_f32 v204, 0, v204
  v_cvt_pk_bf16_f32 v166, v158, v159
  v_cvt_pk_bf16_f32 v205, 0, v205
  v_cvt_pk_bf16_f32 v167, v160, v161
  v_cvt_pk_bf16_f32 v206, 0, v206
  v_cvt_pk_bf16_f32 v168, v162, 0
  v_cvt_pk_bf16_f32 v207, 0, v207
  v_cndmask_b32 v172, 0, v163, s[72:73]
  v_pk_mul_f32 v[204:205], v[204:205], v[120:121] op_sel:[0,1]
  v_cndmask_b32 v173, 0, v164, s[72:73]
  v_pk_mul_f32 v[206:207], v[206:207], v[120:121] op_sel:[0,1]
  s_waitcnt vmcnt(16)
  s_cbranch_vccnz L_vw0_15
  s_waitcnt vmcnt(10)
L_vw0_15:
  buffer_load_dwordx4 v[36:39], v95, s[12:15], s60 offen offset:0 nt
  v_mov_b32_dpp v120, v118 row_newbcast:5 row_mask:0xf bank_mask:0xf
  v_mov_b32_dpp v121, v119 row_newbcast:5 row_mask:0xf bank_mask:0xf
  v_pk_fma_f32 v[112:113], v[64:65], s[92:93], v[120:121] op_sel_hi:[1,1,0] neg_lo:[0,0,1] neg_hi:[0,0,1]
  v_pk_fma_f32 v[114:115], v[66:67], s[92:93], v[120:121] op_sel_hi:[1,1,0] neg_lo:[0,0,1] neg_hi:[0,0,1]
  v_cvt_pk_bf16_f32 v112, 0, v112
  v_cndmask_b32 v174, 0, v165, s[72:73]
  v_cvt_pk_bf16_f32 v113, 0, v113
  v_cndmask_b32 v175, 0, v166, s[72:73]
  v_cvt_pk_bf16_f32 v114, 0, v114
  v_cndmask_b32 v176, 0, v163, s[74:75]
  v_cvt_pk_bf16_f32 v115, 0, v115
  v_cndmask_b32 v177, 0, v164, s[74:75]
  v_pk_mul_f32 v[112:113], v[112:113], v[120:121] op_sel:[0,1]
  v_cndmask_b32 v178, 0, v165, s[74:75]
  v_pk_mul_f32 v[114:115], v[114:115], v[120:121] op_sel:[0,1]
  v_cvt_pk_bf16_f32 v210, v196, v112
  v_cvt_pk_bf16_f32 v214, v197, v113
  v_cvt_pk_bf16_f32 v218, v198, v114
  v_cvt_pk_bf16_f32 v222, v199, v115
  s_waitcnt vmcnt(16)
  s_cbranch_vccnz L_vw0_16
  s_waitcnt vmcnt(10)
L_vw0_16:
  buffer_load_dwordx4 v[40:43], v95, s[12:15], s60 offen offset:256 nt
  v_pk_fma_f32 v[112:113], v[68:69], s[92:93], v[120:121] op_sel_hi:[1,1,0] neg_lo:[0,0,1] neg_hi:[0,0,1]
  v_pk_fma_f32 v[114:115], v[70:71], s[92:93], v[120:121] op_sel_hi:[1,1,0] neg_lo:[0,0,1] neg_hi:[0,0,1]
  v_cvt_pk_bf16_f32 v112, 0, v112
  v_cndmask_b32 v179, 0, v166, s[74:75]
  v_cvt_pk_bf16_f32 v113, 0, v113
  v_cndmask_b32 v180, 0, v163, s[76:77]
  v_cvt_pk_bf16_f32 v114, 0, v114
  v_cndmask_b32 v181, 0, v164, s[76:77]
  v_cvt_pk_bf16_f32 v115, 0, v115
  v_cndmask_b32 v182, 0, v165, s[76:77]
  v_pk_mul_f32 v[112:113], v[112:113], v[120:121] op_sel:[0,1]
  v_cndmask_b32 v183, 0, v166, s[76:77]
  v_pk_mul_f32 v[114:115], v[114:115], v[120:121] op_sel:[0,1]
  v_cvt_pk_bf16_f32 v226, v200, v112
  v_cvt_pk_bf16_f32 v230, v201, v113
  v_cvt_pk_bf16_f32 v234, v202, v114
  v_cvt_pk_bf16_f32 v238, v203, v115
  s_waitcnt vmcnt(16)
  s_cbranch_vccnz L_vw0_17
  s_waitcnt vmcnt(10)
L_vw0_17:
  buffer_load_dwordx4 v[44:47], v95, s[12:15], s60 offen offset:512 nt
  v_pk_fma_f32 v[112:113], v[72:73], s[92:93], v[120:121] op_sel_hi:[1,1,0] neg_lo:[0,0,1] neg_hi:[0,0,1]
  v_pk_fma_f32 v[114:115], v[74:75], s[92:93], v[120:121] op_sel_hi:[1,1,0] neg_lo:[0,0,1] neg_hi:[0,0,1]
  v_cvt_pk_bf16_f32 v112, 0, v112
  v_cndmask_b32 v184, 0, v163, s[78:79]
  v_cvt_pk_bf16_f32 v113, 0, v113
  v_cndmask_b32 v185, 0, v164, s[78:79]
  v_cvt_pk_bf16_f32 v114, 0, v114
  v_cndmask_b32 v186, 0, v165, s[78:79]
  v_cvt_pk_bf16_f32 v115, 0, v115
  v_cndmask_b32 v187, 0, v166, s[78:79]
  v_pk_mul_f32 v[112:113], v[112:113], v[120:121] op_sel:[0,1]
  s_waitcnt lgkmcnt(0)
  v_pk_mul_f32 v[114:115], v[114:115], v[120:121] op_sel:[0,1]
  v_cvt_pk_bf16_f32 v242, v204, v112
  v_cvt_pk_bf16_f32 v246, v205, v113
  v_cvt_pk_bf16_f32 v250, v206, v114
  v_cvt_pk_bf16_f32 v254, v207, v115
  v_mad_u32_u24 v92, v100, s63, v98
  v_add_u32 v93, 768, v92
  v_add_u32 v94, 4608, v92
  v_add_u32 v95, 7680, v92
  v_cndmask_b32 v92, v92, v108, s[52:53]
  v_cndmask_b32 v95, v95, v108, s[54:55]
  s_waitcnt vmcnt(16)
  s_cbranch_vccnz L_vw0_18
  s_waitcnt vmcnt(10)
L_vw0_18:
  buffer_load_dwordx4 v[48:51], v92, s[12:15], s61 offen offset:0 nt
  v_mov_b32_dpp v120, v118 row_newbcast:6 row_mask:0xf bank_mask:0xf
  v_mov_b32_dpp v121, v119 row_newbcast:6 row_mask:0xf bank_mask:0xf
  v_pk_fma_f32 v[196:197], v[76:77], s[92:93], v[120:121] op_sel_hi:[1,1,0] neg_lo:[0,0,1] neg_hi:[0,0,1]
  v_pk_fma_f32 v[198:199], v[78:79], s[92:93], v[120:121] op_sel_hi:[1,1,0] neg_lo:[0,0,1] neg_hi:[0,0,1]
  v_cvt_pk_bf16_f32 v196, 0, v196
  v_mul_f32 v132, v151, v132
  v_cvt_pk_bf16_f32 v197, 0, v197
  v_mul_f32 v133, v151, v133
  v_cvt_pk_bf16_f32 v198, 0, v198
  v_mul_f32 v134, v151, v134
  v_cvt_pk_bf16_f32 v199, 0, v199
  v_mul_f32 v135, v151, v135
  v_pk_mul_f32 v[196:197], v[196:197], v[120:121] op_sel:[0,1]
  v_mul_f32 v136, v151, v136
  v_pk_mul_f32 v[198:199], v[198:199], v[120:121] op_sel:[0,1]
  s_waitcnt vmcnt(14)
  s_cbranch_vccnz L_vw0_19
  s_waitcnt vmcnt(10)
L_vw0_19:
  buffer_load_dwordx4 v[52:55], v92, s[12:15], s61 offen offset:256 nt
  v_pk_fma_f32 v[200:201], v[80:81], s[92:93], v[120:121] op_sel_hi:[1,1,0] neg_lo:[0,0,1] neg_hi:[0,0,1]
  v_pk_fma_f32 v[202:203], v[82:83], s[92:93], v[120:121] op_sel_hi:[1,1,0] neg_lo:[0,0,1] neg_hi:[0,0,1]
  v_cvt_pk_bf16_f32 v200, 0, v200
  v_mul_f32 v137, v151, v137
  v_cvt_pk_bf16_f32 v201, 0, v201
  v_mul_f32 v138, v151, v138
  v_cvt_pk_bf16_f32 v202, 0, v202
  v_mul_f32 v139, v151, v139
  v_cvt_pk_bf16_f32 v203, 0, v203
  v_mul_f32 v140, v151, v140
  v_pk_mul_f32 v[200:201], v[200:201], v[120:121] op_sel:[0,1]
  v_mul_f32 v141, v151, v141
  v_pk_mul_f32 v[202:203], v[202:203], v[120:121] op_sel:[0,1]
  s_waitcnt vmcnt(14)
  s_cbranch_vccnz L_vw0_20
  s_waitcnt vmcnt(10)
L_vw0_20:
  buffer_load_dwordx4 v[56:59], v92, s[12:15], s61 offen offset:512 nt
  v_pk_fma_f32 v[204:205], v[84:85], s[92:93], v[120:121] op_sel_hi:[1,1,0] neg_lo:[0,0,1] neg_hi:[0,0,1]
  v_pk_fma_f32 v[206:207], v[86:87], s[92:93], v[120:121] op_sel_hi:[1,1,0] neg_lo:[0,0,1] neg_hi:[0,0,1]
  v_cvt_pk_bf16_f32 v204, 0, v204
  v_mul_f32 v142, v151, v142
  v_cvt_pk_bf16_f32 v205, 0, v205
  v_mul_f32 v143, v151, v143
  v_cvt_pk_bf16_f32 v206, 0, v206
  v_cvt_pk_bf16_f32 v207, 0, v207
  v_pk_mul_f32 v[204:205], v[204:205], v[120:121] op_sel:[0,1]
  v_pk_mul_f32 v[206:207], v[206:207], v[120:121] op_sel:[0,1]
  s_waitcnt vmcnt(14)
  s_cbranch_vccnz L_vw0_21
  s_waitcnt vmcnt(10)
L_vw0_21:
  buffer_load_dwordx4 v[60:63], v93, s[12:15], s61 offen offset:0 nt
  v_mov_b32_dpp v120, v118 row_newbcast:7 row_mask:0xf bank_mask:0xf
  v_mov_b32_dpp v121, v119 row_newbcast:7 row_mask:0xf bank_mask:0xf
  v_pk_fma_f32 v[112:113], v[88:89], s[92:93], v[120:121] op_sel_hi:[1,1,0] neg_lo:[0,0,1] neg_hi:[0,0,1]
  v_pk_fma_f32 v[114:115], v[90:91], s[92:93], v[120:121] op_sel_hi:[1,1,0] neg_lo:[0,0,1] neg_hi:[0,0,1]
  v_cvt_pk_bf16_f32 v112, 0, v112
  v_cvt_pk_bf16_f32 v113, 0, v113
  v_cvt_pk_bf16_f32 v114, 0, v114
  v_cvt_pk_bf16_f32 v115, 0, v115
  v_pk_mul_f32 v[112:113], v[112:113], v[120:121] op_sel:[0,1]
  v_pk_mul_f32 v[114:115], v[114:115], v[120:121] op_sel:[0,1]
  v_cvt_pk_bf16_f32 v211, v196, v112
  v_cvt_pk_bf16_f32 v215, v197, v113
  v_cvt_pk_bf16_f32 v219, v198, v114
  v_cvt_pk_bf16_f32 v223, v199, v115
  v_mfma_f32_16x16x32_bf16 v[132:135], v[172:175], v[208:211], v[132:135]
  v_mfma_f32_16x16x32_bf16 v[132:135], v[176:179], v[212:215], v[132:135]
  v_mfma_f32_16x16x32_bf16 v[132:135], v[180:183], v[216:219], v[132:135]
  v_mfma_f32_16x16x32_bf16 v[132:135], v[184:187], v[220:223], v[132:135]
  s_waitcnt vmcnt(14)
  s_cbranch_vccnz L_vw0_22
  s_waitcnt vmcnt(10)
L_vw0_22:
  buffer_load_dwordx4 v[64:67], v93, s[12:15], s61 offen offset:256 nt
  v_pk_fma_f32 v[112:113], v[4:5], s[92:93], v[120:121] op_sel_hi:[1,1,0] neg_lo:[0,0,1] neg_hi:[0,0,1]
  v_pk_fma_f32 v[114:115], v[6:7], s[92:93], v[120:121] op_sel_hi:[1,1,0] neg_lo:[0,0,1] neg_hi:[0,0,1]
  v_cvt_pk_bf16_f32 v112, 0, v112
  v_cvt_pk_bf16_f32 v113, 0, v113
  v_cvt_pk_bf16_f32 v114, 0, v114
  v_cvt_pk_bf16_f32 v115, 0, v115
  v_pk_mul_f32 v[112:113], v[112:113], v[120:121] op_sel:[0,1]
  v_pk_mul_f32 v[114:115], v[114:115], v[120:121] op_sel:[0,1]
  v_cvt_pk_bf16_f32 v227, v200, v112
  v_cvt_pk_bf16_f32 v231, v201, v113
  v_cvt_pk_bf16_f32 v235, v202, v114
  v_cvt_pk_bf16_f32 v239, v203, v115
  v_mfma_f32_16x16x32_bf16 v[136:139], v[172:175], v[224:227], v[136:139]
  v_mfma_f32_16x16x32_bf16 v[136:139], v[176:179], v[228:231], v[136:139]
  v_mfma_f32_16x16x32_bf16 v[136:139], v[180:183], v[232:235], v[136:139]
  v_mfma_f32_16x16x32_bf16 v[136:139], v[184:187], v[236:239], v[136:139]
  s_waitcnt vmcnt(14)
  s_cbranch_vccnz L_vw0_23
  s_waitcnt vmcnt(10)
L_vw0_23:
  buffer_load_dwordx4 v[68:71], v93, s[12:15], s61 offen offset:512 nt
  v_pk_fma_f32 v[112:113], v[8:9], s[92:93], v[120:121] op_sel_hi:[1,1,0] neg_lo:[0,0,1] neg_hi:[0,0,1]
  v_pk_fma_f32 v[114:115], v[10:11], s[92:93], v[120:121] op_sel_hi:[1,1,0] neg_lo:[0,0,1] neg_hi:[0,0,1]
  v_cvt_pk_bf16_f32 v112, 0, v112
  v_cvt_pk_bf16_f32 v113, 0, v113
  v_cvt_pk_bf16_f32 v114, 0, v114
  v_cvt_pk_bf16_f32 v115, 0, v115
  v_pk_mul_f32 v[112:113], v[112:113], v[120:121] op_sel:[0,1]
  v_pk_mul_f32 v[114:115], v[114:115], v[120:121] op_sel:[0,1]
  v_cvt_pk_bf16_f32 v243, v204, v112
  v_cvt_pk_bf16_f32 v247, v205, v113
  v_cvt_pk_bf16_f32 v251, v206, v114
  v_cvt_pk_bf16_f32 v255, v207, v115
  v_mfma_f32_16x16x32_bf16 v[140:143], v[172:175], v[240:243], v[140:143]
  v_mfma_f32_16x16x32_bf16 v[140:143], v[176:179], v[244:247], v[140:143]
  v_mfma_f32_16x16x32_bf16 v[140:143], v[180:183], v[248:251], v[140:143]
  v_mfma_f32_16x16x32_bf16 v[140:143], v[184:187], v[252:255], v[140:143]
  s_waitcnt vmcnt(14)
  s_cbranch_vccnz L_vw0_24
  s_waitcnt vmcnt(10)
L_vw0_24:
  buffer_load_dwordx4 v[72:75], v93, s[12:15], s61 offen offset:768 nt
  v_mov_b32_dpp v120, v118 row_newbcast:8 row_mask:0xf bank_mask:0xf
  v_mov_b32_dpp v121, v119 row_newbcast:8 row_mask:0xf bank_mask:0xf
  v_pk_fma_f32 v[196:197], v[12:13], s[92:93], v[120:121] op_sel_hi:[1,1,0] neg_lo:[0,0,1] neg_hi:[0,0,1]
  v_pk_fma_f32 v[198:199], v[14:15], s[92:93], v[120:121] op_sel_hi:[1,1,0] neg_lo:[0,0,1] neg_hi:[0,0,1]
  v_cvt_pk_bf16_f32 v196, 0, v196
  v_cndmask_b32 v188, 0, v167, s[72:73]
  v_cvt_pk_bf16_f32 v197, 0, v197
  v_cndmask_b32 v189, 0, v168, s[72:73]
  v_cvt_pk_bf16_f32 v198, 0, v198
  v_cndmask_b32 v190, 0, v167, s[74:75]
  v_cvt_pk_bf16_f32 v199, 0, v199
  v_cndmask_b32 v191, 0, v168, s[74:75]
  v_pk_mul_f32 v[196:197], v[196:197], v[120:121] op_sel:[0,1]
  v_cndmask_b32 v192, 0, v167, s[76:77]
  v_pk_mul_f32 v[198:199], v[198:199], v[120:121] op_sel:[0,1]
  s_waitcnt vmcnt(14)
  s_cbranch_vccnz L_vw0_25
  s_waitcnt vmcnt(10)
L_vw0_25:
  buffer_load_dwordx4 v[76:79], v93, s[12:15], s61 offen offset:1024 nt
  v_pk_fma_f32 v[200:201], v[16:17], s[92:93], v[120:121] op_sel_hi:[1,1,0] neg_lo:[0,0,1] neg_hi:[0,0,1]
  v_pk_fma_f32 v[202:203], v[18:19], s[92:93], v[120:121] op_sel_hi:[1,1,0] neg_lo:[0,0,1] neg_hi:[0,0,1]
  v_cvt_pk_bf16_f32 v200, 0, v200
  v_cndmask_b32 v193, 0, v168, s[76:77]
  v_cvt_pk_bf16_f32 v201, 0, v201
  v_cndmask_b32 v194, 0, v167, s[78:79]
  v_cvt_pk_bf16_f32 v202, 0, v202
  v_cndmask_b32 v195, 0, v168, s[78:79]
  v_cvt_pk_bf16_f32 v203, 0, v203
  v_pk_mul_f32 v[200:201], v[200:201], v[120:121] op_sel:[0,1]
  v_pk_mul_f32 v[202:203], v[202:203], v[120:121] op_sel:[0,1]
  s_waitcnt vmcnt(14)
  s_cbranch_vccnz L_vw0_26
  s_waitcnt vmcnt(10)
L_vw0_26:
  buffer_load_dwordx4 v[80:83], v93, s[12:15], s61 offen offset:1280 nt
  v_pk_fma_f32 v[204:205], v[20:21], s[92:93], v[120:121] op_sel_hi:[1,1,0] neg_lo:[0,0,1] neg_hi:[0,0,1]
  v_pk_fma_f32 v[206:207], v[22:23], s[92:93], v[120:121] op_sel_hi:[1,1,0] neg_lo:[0,0,1] neg_hi:[0,0,1]
  v_cvt_pk_bf16_f32 v204, 0, v204
  v_cvt_pk_bf16_f32 v205, 0, v205
  v_cvt_pk_bf16_f32 v206, 0, v206
  v_cvt_pk_bf16_f32 v207, 0, v207
  v_pk_mul_f32 v[204:205], v[204:205], v[120:121] op_sel:[0,1]
  v_pk_mul_f32 v[206:207], v[206:207], v[120:121] op_sel:[0,1]
  s_waitcnt vmcnt(14)
  s_cbranch_vccnz L_vw0_27
  s_waitcnt vmcnt(10)
L_vw0_27:
  buffer_load_dwordx4 v[84:87], v93, s[12:15], s61 offen offset:1536 nt
  v_mov_b32_dpp v120, v118 row_newbcast:9 row_mask:0xf bank_mask:0xf
  v_mov_b32_dpp v121, v119 row_newbcast:9 row_mask:0xf bank_mask:0xf
  v_pk_fma_f32 v[112:113], v[24:25], s[92:93], v[120:121] op_sel_hi:[1,1,0] neg_lo:[0,0,1] neg_hi:[0,0,1]
  v_pk_fma_f32 v[114:115], v[26:27], s[92:93], v[120:121] op_sel_hi:[1,1,0] neg_lo:[0,0,1] neg_hi:[0,0,1]
  v_cvt_pk_bf16_f32 v112, 0, v112
  v_cvt_pk_bf16_f32 v113, 0, v113
  v_cvt_pk_bf16_f32 v114, 0, v114
  v_cvt_pk_bf16_f32 v115, 0, v115
  v_pk_mul_f32 v[112:113], v[112:113], v[120:121] op_sel:[0,1]
  v_pk_mul_f32 v[114:115], v[114:115], v[120:121] op_sel:[0,1]
  v_cvt_pk_bf16_f32 v208, v196, v112
  v_cvt_pk_bf16_f32 v212, v197, v113
  v_cvt_pk_bf16_f32 v216, v198, v114
  v_cvt_pk_bf16_f32 v220, v199, v115
  s_waitcnt vmcnt(14)
  s_cbranch_vccnz L_vw0_28
  s_waitcnt vmcnt(10)
L_vw0_28:
  buffer_load_dwordx4 v[88:91], v93, s[12:15], s61 offen offset:1792 nt
  v_pk_fma_f32 v[112:113], v[28:29], s[92:93], v[120:121] op_sel_hi:[1,1,0] neg_lo:[0,0,1] neg_hi:[0,0,1]
  v_pk_fma_f32 v[114:115], v[30:31], s[92:93], v[120:121] op_sel_hi:[1,1,0] neg_lo:[0,0,1] neg_hi:[0,0,1]
  v_cvt_pk_bf16_f32 v112, 0, v112
  v_cvt_pk_bf16_f32 v113, 0, v113
  v_cvt_pk_bf16_f32 v114, 0, v114
  v_cvt_pk_bf16_f32 v115, 0, v115
  v_pk_mul_f32 v[112:113], v[112:113], v[120:121] op_sel:[0,1]
  v_pk_mul_f32 v[114:115], v[114:115], v[120:121] op_sel:[0,1]
  v_cvt_pk_bf16_f32 v224, v200, v112
  v_cvt_pk_bf16_f32 v228, v201, v113
  v_cvt_pk_bf16_f32 v232, v202, v114
  v_cvt_pk_bf16_f32 v236, v203, v115
  s_waitcnt vmcnt(14)
  s_cbranch_vccnz L_vw0_29
  s_waitcnt vmcnt(10)
L_vw0_29:
  buffer_load_dwordx4 v[4:7], v93, s[12:15], s61 offen offset:2048 nt
  v_pk_fma_f32 v[112:113], v[32:33], s[92:93], v[120:121] op_sel_hi:[1,1,0] neg_lo:[0,0,1] neg_hi:[0,0,1]
  v_pk_fma_f32 v[114:115], v[34:35], s[92:93], v[120:121] op_sel_hi:[1,1,0] neg_lo:[0,0,1] neg_hi:[0,0,1]
  v_cvt_pk_bf16_f32 v112, 0, v112
  v_cvt_pk_bf16_f32 v113, 0, v113
  v_cvt_pk_bf16_f32 v114, 0, v114
  v_cvt_pk_bf16_f32 v115, 0, v115
  v_pk_mul_f32 v[112:113], v[112:113], v[120:121] op_sel:[0,1]
  v_pk_mul_f32 v[114:115], v[114:115], v[120:121] op_sel:[0,1]
  v_cvt_pk_bf16_f32 v240, v204, v112
  v_cvt_pk_bf16_f32 v244, v205, v113
  v_cvt_pk_bf16_f32 v248, v206, v114
  v_cvt_pk_bf16_f32 v252, v207, v115
  s_waitcnt vmcnt(14)
  s_cbranch_vccnz L_vw0_30
  s_waitcnt vmcnt(10)
L_vw0_30:
  buffer_load_dwordx4 v[8:11], v93, s[12:15], s61 offen offset:2304 nt
  v_mov_b32_dpp v120, v118 row_newbcast:10 row_mask:0xf bank_mask:0xf
  v_mov_b32_dpp v121, v119 row_newbcast:10 row_mask:0xf bank_mask:0xf
  v_pk_fma_f32 v[196:197], v[36:37], s[92:93], v[120:121] op_sel_hi:[1,1,0] neg_lo:[0,0,1] neg_hi:[0,0,1]
  v_pk_fma_f32 v[198:199], v[38:39], s[92:93], v[120:121] op_sel_hi:[1,1,0] neg_lo:[0,0,1] neg_hi:[0,0,1]
  v_cvt_pk_bf16_f32 v196, 0, v196
  v_cvt_pk_bf16_f32 v197, 0, v197
  v_cvt_pk_bf16_f32 v198, 0, v198
  v_cvt_pk_bf16_f32 v199, 0, v199
  v_pk_mul_f32 v[196:197], v[196:197], v[120:121] op_sel:[0,1]
  v_pk_mul_f32 v[198:199], v[198:199], v[120:121] op_sel:[0,1]
  v_cvt_pk_bf16_f32 v209, v196, 0
  v_cvt_pk_bf16_f32 v213, v197, 0
  v_cvt_pk_bf16_f32 v217, v198, 0
  v_cvt_pk_bf16_f32 v221, v199, 0
  v_mfma_f32_16x16x16_bf16 v[132:135], v[188:189], v[208:209], v[132:135]
  v_mfma_f32_16x16x16_bf16 v[132:135], v[190:191], v[212:213], v[132:135]
  v_mfma_f32_16x16x16_bf16 v[132:135], v[192:193], v[216:217], v[132:135]
  v_mfma_f32_16x16x16_bf16 v[132:135], v[194:195], v[220:221], v[132:135]
  s_waitcnt vmcnt(14)
  s_cbranch_vccnz L_vw0_31
  s_waitcnt vmcnt(10)
L_vw0_31:
  buffer_load_dwordx4 v[12:15], v93, s[12:15], s61 offen offset:2560 nt
  v_pk_fma_f32 v[200:201], v[40:41], s[92:93], v[120:121] op_sel_hi:[1,1,0] neg_lo:[0,0,1] neg_hi:[0,0,1]
  v_pk_fma_f32 v[202:203], v[42:43], s[92:93], v[120:121] op_sel_hi:[1,1,0] neg_lo:[0,0,1] neg_hi:[0,0,1]
  v_cvt_pk_bf16_f32 v200, 0, v200
  v_cvt_pk_bf16_f32 v201, 0, v201
  v_cvt_pk_bf16_f32 v202, 0, v202
  v_cvt_pk_bf16_f32 v203, 0, v203
  v_pk_mul_f32 v[200:201], v[200:201], v[120:121] op_sel:[0,1]
  v_pk_mul_f32 v[202:203], v[202:203], v[120:121] op_sel:[0,1]
  v_cvt_pk_bf16_f32 v225, v200, 0
  v_cvt_pk_bf16_f32 v229, v201, 0
  v_cvt_pk_bf16_f32 v233, v202, 0
  v_cvt_pk_bf16_f32 v237, v203, 0
  v_mfma_f32_16x16x16_bf16 v[136:139], v[188:189], v[224:225], v[136:139]
  v_mfma_f32_16x16x16_bf16 v[136:139], v[190:191], v[228:229], v[136:139]
  v_mfma_f32_16x16x16_bf16 v[136:139], v[192:193], v[232:233], v[136:139]
  v_mfma_f32_16x16x16_bf16 v[136:139], v[194:195], v[236:237], v[136:139]
  s_waitcnt vmcnt(14)
  s_cbranch_vccnz L_vw0_32
  s_waitcnt vmcnt(10)
L_vw0_32:
  buffer_load_dwordx4 v[16:19], v93, s[12:15], s61 offen offset:2816 nt
  v_pk_fma_f32 v[204:205], v[44:45], s[92:93], v[120:121] op_sel_hi:[1,1,0] neg_lo:[0,0,1] neg_hi:[0,0,1]
  v_pk_fma_f32 v[206:207], v[46:47], s[92:93], v[120:121] op_sel_hi:[1,1,0] neg_lo:[0,0,1] neg_hi:[0,0,1]
  v_cvt_pk_bf16_f32 v204, 0, v204
  v_cvt_pk_bf16_f32 v205, 0, v205
  v_cvt_pk_bf16_f32 v206, 0, v206
  v_cvt_pk_bf16_f32 v207, 0, v207
  v_pk_mul_f32 v[204:205], v[204:205], v[120:121] op_sel:[0,1]
  v_pk_mul_f32 v[206:207], v[206:207], v[120:121] op_sel:[0,1]
  v_cvt_pk_bf16_f32 v241, v204, 0
  v_cvt_pk_bf16_f32 v245, v205, 0
  v_cvt_pk_bf16_f32 v249, v206, 0
  v_cvt_pk_bf16_f32 v253, v207, 0
  v_mfma_f32_16x16x16_bf16 v[140:143], v[188:189], v[240:241], v[140:143]
  v_mfma_f32_16x16x16_bf16 v[140:143], v[190:191], v[244:245], v[140:143]
  v_mfma_f32_16x16x16_bf16 v[140:143], v[192:193], v[248:249], v[140:143]
  v_mfma_f32_16x16x16_bf16 v[140:143], v[194:195], v[252:253], v[140:143]
  s_mov_b32 s60, s61
  s_cmp_eq_u32 s89, s88
  s_cbranch_scc1 L_v1
  s_mov_b32 s88, s89
  v_mov_b32 v149, v147
  s_nop 1
  v_permlane32_swap_b32 v147, v149
  v_add_f32 v147, v147, v149
  v_mov_b32 v149, v147
  s_nop 1
  v_permlane16_swap_b32 v147, v149
  v_add_f32 v147, v147, v149
  ds_write_b64 v106, v[146:147]
  ds_write_b128 v105, v[132:135] offset:0
  ds_write_b128 v105, v[136:139] offset:1024
  ds_write_b128 v105, v[140:143] offset:2048
  s_and_b32 s70, s86, 15
  s_cmp_ge_u32 s70, 12
  s_cselect_b32 s70, 2, 0
  s_and_b32 s71, s87, 1
  s_bitcmp1_b32 s96, 6
  s_cselect_b32 s71, s4, s71
  s_add_u32 s70, s70, s71
  s_lshr_b32 s71, s86, 4
  s_lshl2_add_u32 s70, s71, s70
  s_add_u32 s71, s3, 0
  s_cmp_eq_u32 s100, s71
  s_cselect_b32 s44, s70, s44
  s_add_u32 s71, s3, 2
  s_cmp_eq_u32 s100, s71
  s_cselect_b32 s45, s70, s45
  s_add_u32 s100, s100, 1
  s_waitcnt lgkmcnt(0)
  v_add_u32 v105, 6208, v105
  v_add_u32 v106, 6208, v106
  v_mov_b32 v132, 0
  v_mov_b32 v133, 0
  v_mov_b32 v134, 0
  v_mov_b32 v135, 0
  v_mov_b32 v136, 0
  v_mov_b32 v137, 0
  v_mov_b32 v138, 0
  v_mov_b32 v139, 0
  v_mov_b32 v140, 0
  v_mov_b32 v141, 0
  v_mov_b32 v142, 0
  v_mov_b32 v143, 0
  v_mov_b32 v144, 0xff800000
  v_mov_b32 v146, 0x7f800000
  v_mov_b32 v147, 0
L_v1:
  s_mov_b32 s86, s84
  s_mov_b32 s87, s85
  s_add_u32 s64, s64, 2
  s_cmp_lt_u32 s64, s99
  s_cbranch_scc1 L_v11_ok
L_v11_spin:
  v_mov_b32 v148, 61700
  ds_read_b32 v148, v148
  s_waitcnt lgkmcnt(0)
  v_readfirstlane_b32 s99, v148
  s_nop 1
  s_cmp_lt_u32 s64, s99
  s_cbranch_scc0 L_v11_spin
L_v11_ok:
  s_andn2_b32 s70, s64, 1
  s_or_b32 s70, s70, s4
  s_lshr_b32 s71, s64, 5
  s_lshr_b32 s85, s96, s71
  s_lshr_b32 s85, s85, 3
  s_cmp_lt_u32 s64, s97
  s_cselect_b32 s70, s70, s64
  s_cselect_b32 s85, s64, s85
  s_and_b32 s85, s85, 1
  s_mul_i32 s71, s71, 4064
  s_add_u32 s70, s70, s71
  s_add_u32 s70, s70, s5
  s_mul_hi_u32 s84, s70, s90
  s_lshr_b32 s84, s84, 1
  s_mul_i32 s71, s84, 3
  s_sub_u32 s70, s70, s71
  s_lshl3_add_u32 s85, s70, s85
  s_mul_i32 s61, s84, 196608
  s_lshr_b32 s89, s84, 4
  s_lshl_b32 s70, s85, 5
  v_add_u32 v100, s70, v96
  v_mul_u32_u24 v100, 21846, v100
  v_lshrrev_b32 v100, 16, v100
  v_add_u32 v148, s85, v97
  v_lshrrev_b32 v149, v148, s91
  v_and_b32 v149, 1, v149
  v_cmp_eq_u32 s[54:55], 1, v149
  s_nop 1
  s_and_b64 s[52:53], s[54:55], s[58:59]
  s_andn2_b64 s[54:55], s[54:55], s[58:59]
  s_cmp_lt_u32 s64, 96
  s_cselect_b32 s61, s61, 805306368
  s_add_u32 s70, s64, 94
  v_mov_b32 v150, s70
  ds_read_b32 v110, v109
  ds_write_b32 v107, v150
  s_waitcnt vmcnt(14)
  s_cbranch_vccnz L_vw1_0
  s_waitcnt vmcnt(10)
L_vw1_0:
  buffer_load_dwordx4 v[20:23], v93, s[12:15], s60 offen offset:3072 nt
  v_mul_f32 v118, s94, v116
  v_mul_f32 v119, 0x4a800000, v117
  s_nop 0
  v_mov_b32_dpp v120, v118 row_newbcast:0 row_mask:0xf bank_mask:0xf
  v_mov_b32_dpp v121, v119 row_newbcast:0 row_mask:0xf bank_mask:0xf
  v_pk_fma_f32 v[196:197], v[48:49], s[92:93], v[120:121] op_sel_hi:[1,1,0] neg_lo:[0,0,1] neg_hi:[0,0,1]
  v_pk_fma_f32 v[198:199], v[50:51], s[92:93], v[120:121] op_sel_hi:[1,1,0] neg_lo:[0,0,1] neg_hi:[0,0,1]
  v_cvt_pk_bf16_f32 v196, 0, v196
  s_waitcnt lgkmcnt(0)
  v_cvt_pk_bf16_f32 v197, 0, v197
  v_cmp_lt_u32 vcc, v150, v110
  v_cvt_pk_bf16_f32 v198, 0, v198
  v_lshlrev_b32 v152, 16, v124
  v_cvt_pk_bf16_f32 v199, 0, v199
  v_and_b32 v153, s65, v124
  v_pk_mul_f32 v[196:197], v[196:197], v[120:121] op_sel:[0,1]
  v_lshlrev_b32 v154, 16, v125
  v_pk_mul_f32 v[198:199], v[198:199], v[120:121] op_sel:[0,1]
  s_waitcnt vmcnt(14)
  s_cbranch_vccnz L_vw1_1
  s_waitcnt vmcnt(10)
L_vw1_1:
  buffer_load_dwordx4 v[24:27], v93, s[12:15], s60 offen offset:3328 nt
  v_pk_fma_f32 v[200:201], v[52:53], s[92:93], v[120:121] op_sel_hi:[1,1,0] neg_lo:[0,0,1] neg_hi:[0,0,1]
  v_pk_fma_f32 v[202:203], v[54:55], s[92:93], v[120:121] op_sel_hi:[1,1,0] neg_lo:[0,0,1] neg_hi:[0,0,1]
  v_cvt_pk_bf16_f32 v200, 0, v200
  v_and_b32 v155, s65, v125
  v_cvt_pk_bf16_f32 v201, 0, v201
  v_lshlrev_b32 v156, 16, v126
  v_cvt_pk_bf16_f32 v202, 0, v202
  v_and_b32 v157, s65, v126
  v_cvt_pk_bf16_f32 v203, 0, v203
  v_lshlrev_b32 v158, 16, v127
  v_pk_mul_f32 v[200:201], v[200:201], v[120:121] op_sel:[0,1]
  v_and_b32 v159, s65, v127
  v_pk_mul_f32 v[202:203], v[202:203], v[120:121] op_sel:[0,1]
  s_waitcnt vmcnt(14)
  s_cbranch_vccnz L_vw1_2
  s_waitcnt vmcnt(10)
L_vw1_2:
  buffer_load_dwordx4 v[28:31], v93, s[12:15], s60 offen offset:3584 nt
  v_pk_fma_f32 v[204:205], v[56:57], s[92:93], v[120:121] op_sel_hi:[1,1,0] neg_lo:[0,0,1] neg_hi:[0,0,1]
  v_pk_fma_f32 v[206:207], v[58:59], s[92:93], v[120:121] op_sel_hi:[1,1,0] neg_lo:[0,0,1] neg_hi:[0,0,1]
  v_cvt_pk_bf16_f32 v204, 0, v204
  v_lshlrev_b32 v160, 16, v128
  v_cvt_pk_bf16_f32 v205, 0, v205
  v_and_b32 v161, s65, v128
  v_cvt_pk_bf16_f32 v206, 0, v206
  v_lshlrev_b32 v162, 16, v129
  v_cvt_pk_bf16_f32 v207, 0, v207
  v_add_u32 v102, 768, v102
  v_pk_mul_f32 v[204:205], v[204:205], v[120:121] op_sel:[0,1]
  v_add_u32 v103, 768, v103
  v_pk_mul_f32 v[206:207], v[206:207], v[120:121] op_sel:[0,1]
  s_waitcnt vmcnt(14)
  s_cbranch_vccnz L_vw1_3
  s_waitcnt vmcnt(10)
L_vw1_3:
  buffer_load_dwordx4 v[32:35], v94, s[12:15], s60 offen offset:0 nt
  v_mov_b32_dpp v120, v118 row_newbcast:1 row_mask:0xf bank_mask:0xf
  v_mov_b32_dpp v121, v119 row_newbcast:1 row_mask:0xf bank_mask:0xf
  v_pk_fma_f32 v[112:113], v[60:61], s[92:93], v[120:121] op_sel_hi:[1,1,0] neg_lo:[0,0,1] neg_hi:[0,0,1]
  v_pk_fma_f32 v[114:115], v[62:63], s[92:93], v[120:121] op_sel_hi:[1,1,0] neg_lo:[0,0,1] neg_hi:[0,0,1]
  s_lshl_b32 s62, s84, 9
  v_lshl_add_u32 v101, v100, 1, v99
  buffer_load_short_d16_hi v116, v101, s[32:35], s62 offen
  buffer_load_short_d16_hi v117, v101, s[28:31], s62 offen
  v_cvt_pk_bf16_f32 v112, 0, v112
  v_max3_f32 v148, v152, v153, v154
  v_cvt_pk_bf16_f32 v113, 0, v113
  ds_read_b128 v[124:127], v102
  v_cvt_pk_bf16_f32 v114, 0, v114
  ds_read_b64 v[128:129], v103 offset:256
  v_cvt_pk_bf16_f32 v115, 0, v115
  v_max3_f32 v149, v155, v156, v157
  v_pk_mul_f32 v[112:113], v[112:113], v[120:121] op_sel:[0,1]
  v_max3_f32 v148, v148, v158, v159
  v_pk_mul_f32 v[114:115], v[114:115], v[120:121] op_sel:[0,1]
  v_cvt_pk_bf16_f32 v208, v196, v112
  v_cvt_pk_bf16_f32 v212, v197, v113
  v_cvt_pk_bf16_f32 v216, v198, v114
  v_cvt_pk_bf16_f32 v220, v199, v115
  s_waitcnt vmcnt(16)
  s_cbranch_vccnz L_vw1_4
  s_waitcnt vmcnt(12)
L_vw1_4:
  buffer_load_dwordx4 v[36:39], v94, s[12:15], s60 offen offset:256 nt
  v_pk_fma_f32 v[112:113], v[64:65], s[92:93], v[120:121] op_sel_hi:[1,1,0] neg_lo:[0,0,1] neg_hi:[0,0,1]
  v_pk_fma_f32 v[114:115], v[66:67], s[92:93], v[120:121] op_sel_hi:[1,1,0] neg_lo:[0,0,1] neg_hi:[0,0,1]
  v_cvt_pk_bf16_f32 v112, 0, v112
  v_max3_f32 v149, v149, v160, v161
  v_cvt_pk_bf16_f32 v113, 0, v113
  v_max3_f32 v148, v148, v162, v144
  v_cvt_pk_bf16_f32 v114, 0, v114
  v_max_f32 v148, v148, v149
  v_cvt_pk_bf16_f32 v115, 0, v115
  v_mov_b32 v149, v148
  v_pk_mul_f32 v[112:113], v[112:113], v[120:121] op_sel:[0,1]
  s_nop 0
  v_permlane32_swap_b32 v148, v149
  v_pk_mul_f32 v[114:115], v[114:115], v[120:121] op_sel:[0,1]
  v_cvt_pk_bf16_f32 v224, v200, v112
  v_cvt_pk_bf16_f32 v228, v201, v113
  v_cvt_pk_bf16_f32 v232, v202, v114
  v_cvt_pk_bf16_f32 v236, v203, v115
  s_waitcnt vmcnt(16)
  s_cbranch_vccnz L_vw1_5
  s_waitcnt vmcnt(12)
L_vw1_5:
  buffer_load_dwordx4 v[40:43], v94, s[12:15], s60 offen offset:512 nt
  v_pk_fma_f32 v[112:113], v[68:69], s[92:93], v[120:121] op_sel_hi:[1,1,0] neg_lo:[0,0,1] neg_hi:[0,0,1]
  v_pk_fma_f32 v[114:115], v[70:71], s[92:93], v[120:121] op_sel_hi:[1,1,0] neg_lo:[0,0,1] neg_hi:[0,0,1]
  v_cvt_pk_bf16_f32 v112, 0, v112
  v_max_f32 v148, v148, v149
  v_cvt_pk_bf16_f32 v113, 0, v113
  v_mov_b32 v149, v148
  v_cvt_pk_bf16_f32 v114, 0, v114
  s_nop 0
  v_permlane16_swap_b32 v148, v149
  v_cvt_pk_bf16_f32 v115, 0, v115
  v_max_f32 v144, v148, v149
  v_pk_mul_f32 v[112:113], v[112:113], v[120:121] op_sel:[0,1]
  v_mul_f32 v148, s66, v144
  v_pk_mul_f32 v[114:115], v[114:115], v[120:121] op_sel:[0,1]
  v_cvt_pk_bf16_f32 v240, v204, v112
  v_cvt_pk_bf16_f32 v244, v205, v113
  v_cvt_pk_bf16_f32 v248, v206, v114
  v_cvt_pk_bf16_f32 v252, v207, v115
  s_waitcnt vmcnt(16)
  s_cbranch_vccnz L_vw1_6
  s_waitcnt vmcnt(12)
L_vw1_6:
  buffer_load_dwordx4 v[44:47], v94, s[12:15], s60 offen offset:768 nt
  v_mov_b32_dpp v120, v118 row_newbcast:2 row_mask:0xf bank_mask:0xf
  v_mov_b32_dpp v121, v119 row_newbcast:2 row_mask:0xf bank_mask:0xf
  v_pk_fma_f32 v[196:197], v[72:73], s[92:93], v[120:121] op_sel_hi:[1,1,0] neg_lo:[0,0,1] neg_hi:[0,0,1]
  v_pk_fma_f32 v[198:199], v[74:75], s[92:93], v[120:121] op_sel_hi:[1,1,0] neg_lo:[0,0,1] neg_hi:[0,0,1]
  v_cvt_pk_bf16_f32 v196, 0, v196
  v_add_f32 v150, v148, v146
  v_cvt_pk_bf16_f32 v197, 0, v197
  v_sub_f32 v146, 0, v148
  v_cvt_pk_bf16_f32 v198, 0, v198
  v_exp_f32 v150, -v150
  v_cvt_pk_bf16_f32 v199, 0, v199
  ds_bpermute_b32 v151, v104, v150
  v_pk_mul_f32 v[196:197], v[196:197], v[120:121] op_sel:[0,1]
  v_fma_f32 v152, v152, s66, v146
  v_pk_mul_f32 v[198:199], v[198:199], v[120:121] op_sel:[0,1]
  s_waitcnt vmcnt(16)
  s_cbranch_vccnz L_vw1_7
  s_waitcnt vmcnt(12)
L_vw1_7:
  buffer_load_dwordx4 v[48:51], v94, s[12:15], s60 offen offset:1024 nt
  v_pk_fma_f32 v[200:201], v[76:77], s[92:93], v[120:121] op_sel_hi:[1,1,0] neg_lo:[0,0,1] neg_hi:[0,0,1]
  v_pk_fma_f32 v[202:203], v[78:79], s[92:93], v[120:121] op_sel_hi:[1,1,0] neg_lo:[0,0,1] neg_hi:[0,0,1]
  v_cvt_pk_bf16_f32 v200, 0, v200
  v_exp_f32 v152, v152
  v_cvt_pk_bf16_f32 v201, 0, v201
  v_fma_f32 v153, v153, s66, v146
  v_cvt_pk_bf16_f32 v202, 0, v202
  v_exp_f32 v153, v153
  v_cvt_pk_bf16_f32 v203, 0, v203
  v_fma_f32 v154, v154, s66, v146
  v_pk_mul_f32 v[200:201], v[200:201], v[120:121] op_sel:[0,1]
  v_exp_f32 v154, v154
  v_pk_mul_f32 v[202:203], v[202:203], v[120:121] op_sel:[0,1]
  s_waitcnt vmcnt(16)
  s_cbranch_vccnz L_vw1_8
  s_waitcnt vmcnt(12)
L_vw1_8:
  buffer_load_dwordx4 v[52:55], v94, s[12:15], s60 offen offset:1280 nt
  v_pk_fma_f32 v[204:205], v[80:81], s[92:93], v[120:121] op_sel_hi:[1,1,0] neg_lo:[0,0,1] neg_hi:[0,0,1]
  v_pk_fma_f32 v[206:207], v[82:83], s[92:93], v[120:121] op_sel_hi:[1,1,0] neg_lo:[0,0,1] neg_hi:[0,0,1]
  v_cvt_pk_bf16_f32 v204, 0, v204
  v_fma_f32 v155, v155, s66, v146
  v_cvt_pk_bf16_f32 v205, 0, v205
  v_exp_f32 v155, v155
  v_cvt_pk_bf16_f32 v206, 0, v206
  v_fma_f32 v156, v156, s66, v146
  v_cvt_pk_bf16_f32 v207, 0, v207
  v_exp_f32 v156, v156
  v_pk_mul_f32 v[204:205], v[204:205], v[120:121] op_sel:[0,1]
  v_fma_f32 v157, v157, s66, v146
  v_pk_mul_f32 v[206:207], v[206:207], v[120:121] op_sel:[0,1]
  s_waitcnt vmcnt(16)
  s_cbranch_vccnz L_vw1_9
  s_waitcnt vmcnt(12)
L_vw1_9:
  buffer_load_dwordx4 v[56:59], v94, s[12:15], s60 offen offset:1536 nt
  v_mov_b32_dpp v120, v118 row_newbcast:3 row_mask:0xf bank_mask:0xf
  v_mov_b32_dpp v121, v119 row_newbcast:3 row_mask:0xf bank_mask:0xf
  v_pk_fma_f32 v[112:113], v[84:85], s[92:93], v[120:121] op_sel_hi:[1,1,0] neg_lo:[0,0,1] neg_hi:[0,0,1]
  v_pk_fma_f32 v[114:115], v[86:87], s[92:93], v[120:121] op_sel_hi:[1,1,0] neg_lo:[0,0,1] neg_hi:[0,0,1]
  v_cvt_pk_bf16_f32 v112, 0, v112
  v_exp_f32 v157, v157
  v_cvt_pk_bf16_f32 v113, 0, v113
  v_fma_f32 v158, v158, s66, v146
  v_cvt_pk_bf16_f32 v114, 0, v114
  v_exp_f32 v158, v158
  v_cvt_pk_bf16_f32 v115, 0, v115
  v_fma_f32 v159, v159, s66, v146
  v_pk_mul_f32 v[112:113], v[112:113], v[120:121] op_sel:[0,1]
  v_exp_f32 v159, v159
  v_pk_mul_f32 v[114:115], v[114:115], v[120:121] op_sel:[0,1]
  v_cvt_pk_bf16_f32 v209, v196, v112
  v_cvt_pk_bf16_f32 v213, v197, v113
  v_cvt_pk_bf16_f32 v217, v198, v114
  v_cvt_pk_bf16_f32 v221, v199, v115
  s_waitcnt vmcnt(16)
  s_cbranch_vccnz L_vw1_10
  s_waitcnt vmcnt(12)
L_vw1_10:
  buffer_load_dwordx4 v[60:63], v94, s[12:15], s60 offen offset:1792 nt
  v_pk_fma_f32 v[112:113], v[88:89], s[92:93], v[120:121] op_sel_hi:[1,1,0] neg_lo:[0,0,1] neg_hi:[0,0,1]
  v_pk_fma_f32 v[114:115], v[90:91], s[92:93], v[120:121] op_sel_hi:[1,1,0] neg_lo:[0,0,1] neg_hi:[0,0,1]
  v_cvt_pk_bf16_f32 v112, 0, v112
  v_fma_f32 v160, v160, s66, v146
  v_cvt_pk_bf16_f32 v113, 0, v113
  v_exp_f32 v160, v160
  v_cvt_pk_bf16_f32 v114, 0, v114
  v_fma_f32 v161, v161, s66, v146
  v_cvt_pk_bf16_f32 v115, 0, v115
  v_exp_f32 v161, v161
  v_pk_mul_f32 v[112:113], v[112:113], v[120:121] op_sel:[0,1]
  v_fma_f32 v162, v162, s66, v146
  v_pk_mul_f32 v[114:115], v[114:115], v[120:121] op_sel:[0,1]
  v_cvt_pk_bf16_f32 v225, v200, v112
  v_cvt_pk_bf16_f32 v229, v201, v113
  v_cvt_pk_bf16_f32 v233, v202, v114
  v_cvt_pk_bf16_f32 v237, v203, v115
  s_waitcnt vmcnt(16)
  s_cbranch_vccnz L_vw1_11
  s_waitcnt vmcnt(12)
L_vw1_11:
  buffer_load_dwordx4 v[64:67], v94, s[12:15], s60 offen offset:2048 nt
  v_pk_fma_f32 v[112:113], v[4:5], s[92:93], v[120:121] op_sel_hi:[1,1,0] neg_lo:[0,0,1] neg_hi:[0,0,1]
  v_pk_fma_f32 v[114:115], v[6:7], s[92:93], v[120:121] op_sel_hi:[1,1,0] neg_lo:[0,0,1] neg_hi:[0,0,1]
  v_cvt_pk_bf16_f32 v112, 0, v112
  v_exp_f32 v162, v162
  v_cvt_pk_bf16_f32 v113, 0, v113
  v_add_f32 v148, v152, v153
  v_cvt_pk_bf16_f32 v114, 0, v114
  v_add_f32 v149, v154, v155
  v_cvt_pk_bf16_f32 v115, 0, v115
  v_add_f32 v148, v148, v156
  v_pk_mul_f32 v[112:113], v[112:113], v[120:121] op_sel:[0,1]
  v_add_f32 v149, v149, v157
  v_pk_mul_f32 v[114:115], v[114:115], v[120:121] op_sel:[0,1]
  v_cvt_pk_bf16_f32 v241, v204, v112
  v_cvt_pk_bf16_f32 v245, v205, v113
  v_cvt_pk_bf16_f32 v249, v206, v114
  v_cvt_pk_bf16_f32 v253, v207, v115
  s_waitcnt vmcnt(16)
  s_cbranch_vccnz L_vw1_12
  s_waitcnt vmcnt(12)
L_vw1_12:
  buffer_load_dwordx4 v[68:71], v94, s[12:15], s60 offen offset:2304 nt
  v_mov_b32_dpp v120, v118 row_newbcast:4 row_mask:0xf bank_mask:0xf
  v_mov_b32_dpp v121, v119 row_newbcast:4 row_mask:0xf bank_mask:0xf
  v_pk_fma_f32 v[196:197], v[8:9], s[92:93], v[120:121] op_sel_hi:[1,1,0] neg_lo:[0,0,1] neg_hi:[0,0,1]
  v_pk_fma_f32 v[198:199], v[10:11], s[92:93], v[120:121] op_sel_hi:[1,1,0] neg_lo:[0,0,1] neg_hi:[0,0,1]
  v_cvt_pk_bf16_f32 v196, 0, v196
  v_add_f32 v148, v148, v158
  v_cvt_pk_bf16_f32 v197, 0, v197
  v_add_f32 v149, v149, v159
  v_cvt_pk_bf16_f32 v198, 0, v198
  v_add_f32 v148, v148, v160
  v_cvt_pk_bf16_f32 v199, 0, v199
  v_add_f32 v149, v149, v161
  v_pk_mul_f32 v[196:197], v[196:197], v[120:121] op_sel:[0,1]
  v_add_f32 v148, v148, v162
  v_pk_mul_f32 v[198:199], v[198:199], v[120:121] op_sel:[0,1]
  s_waitcnt vmcnt(16)
  s_cbranch_vccnz L_vw1_13
  s_waitcnt vmcnt(12)
L_vw1_13:
  buffer_load_dwordx4 v[72:75], v94, s[12:15], s60 offen offset:2560 nt
  v_pk_fma_f32 v[200:201], v[12:13], s[92:93], v[120:121] op_sel_hi:[1,1,0] neg_lo:[0,0,1] neg_hi:[0,0,1]
  v_pk_fma_f32 v[202:203], v[14:15], s[92:93], v[120:121] op_sel_hi:[1,1,0] neg_lo:[0,0,1] neg_hi:[0,0,1]
  v_cvt_pk_bf16_f32 v200, 0, v200
  v_add_f32 v148, v148, v149
  v_cvt_pk_bf16_f32 v201, 0, v201
  v_fma_f32 v147, v147, v150, v148
  v_cvt_pk_bf16_f32 v202, 0, v202
  v_cvt_pk_bf16_f32 v163, v152, v153
  v_cvt_pk_bf16_f32 v203, 0, v203
  v_cvt_pk_bf16_f32 v164, v154, v155
  v_pk_mul_f32 v[200:201], v[200:201], v[120:121] op_sel:[0,1]
  v_cvt_pk_bf16_f32 v165, v156, v157
  v_pk_mul_f32 v[202:203], v[202:203], v[120:121] op_sel:[0,1]
  s_waitcnt vmcnt(16)
  s_cbranch_vccnz L_vw1_14
  s_waitcnt vmcnt(12)
L_vw1_14:
  buffer_load_dwordx4 v[76:79], v94, s[12:15], s60 offen offset:2816 nt
  v_pk_fma_f32 v[204:205], v[16:17], s[92:93], v[120:121] op_sel_hi:[1,1,0] neg_lo:[0,0,1] neg_hi:[0,0,1]
  v_pk_fma_f32 v[206:207], v[18:19], s[92:93], v[120:121] op_sel_hi:[1,1,0] neg_lo:[0,0,1] neg_hi:[0,0,1]
  v_cvt_pk_bf16_f32 v204, 0, v204
  v_cvt_pk_bf16_f32 v166, v158, v159
  v_cvt_pk_bf16_f32 v205, 0, v205
  v_cvt_pk_bf16_f32 v167, v160, v161
  v_cvt_pk_bf16_f32 v206, 0, v206
  v_cvt_pk_bf16_f32 v168, v162, 0
  v_cvt_pk_bf16_f32 v207, 0, v207
  v_cndmask_b32 v172, 0, v163, s[72:73]
  v_pk_mul_f32 v[204:205], v[204:205], v[120:121] op_sel:[0,1]
  v_cndmask_b32 v173, 0, v164, s[72:73]
  v_pk_mul_f32 v[206:207], v[206:207], v[120:121] op_sel:[0,1]
  s_waitcnt vmcnt(16)
  s_cbranch_vccnz L_vw1_15
  s_waitcnt vmcnt(10)
L_vw1_15:
  buffer_load_dwordx4 v[80:83], v95, s[12:15], s60 offen offset:0 nt
  v_mov_b32_dpp v120, v118 row_newbcast:5 row_mask:0xf bank_mask:0xf
  v_mov_b32_dpp v121, v119 row_newbcast:5 row_mask:0xf bank_mask:0xf
  v_pk_fma_f32 v[112:113], v[20:21], s[92:93], v[120:121] op_sel_hi:[1,1,0] neg_lo:[0,0,1] neg_hi:[0,0,1]
  v_pk_fma_f32 v[114:115], v[22:23], s[92:93], v[120:121] op_sel_hi:[1,1,0] neg_lo:[0,0,1] neg_hi:[0,0,1]
  v_cvt_pk_bf16_f32 v112, 0, v112
  v_cndmask_b32 v174, 0, v165, s[72:73]
  v_cvt_pk_bf16_f32 v113, 0, v113
  v_cndmask_b32 v175, 0, v166, s[72:73]
  v_cvt_pk_bf16_f32 v114, 0, v114
  v_cndmask_b32 v176, 0, v163, s[74:75]
  v_cvt_pk_bf16_f32 v115, 0, v115
  v_cndmask_b32 v177, 0, v164, s[74:75]
  v_pk_mul_f32 v[112:113], v[112:113], v[120:121] op_sel:[0,1]
  v_cndmask_b32 v178, 0, v165, s[74:75]
  v_pk_mul_f32 v[114:115], v[114:115], v[120:121] op_sel:[0,1]
  v_cvt_pk_bf16_f32 v210, v196, v112
  v_cvt_pk_bf16_f32 v214, v197, v113
  v_cvt_pk_bf16_f32 v218, v198, v114
  v_cvt_pk_bf16_f32 v222, v199, v115
  s_waitcnt vmcnt(16)
  s_cbranch_vccnz L_vw1_16
  s_waitcnt vmcnt(10)
L_vw1_16:
  buffer_load_dwordx4 v[84:87], v95, s[12:15], s60 offen offset:256 nt
  v_pk_fma_f32 v[112:113], v[24:25], s[92:93], v[120:121] op_sel_hi:[1,1,0] neg_lo:[0,0,1] neg_hi:[0,0,1]
  v_pk_fma_f32 v[114:115], v[26:27], s[92:93], v[120:121] op_sel_hi:[1,1,0] neg_lo:[0,0,1] neg_hi:[0,0,1]
  v_cvt_pk_bf16_f32 v112, 0, v112
  v_cndmask_b32 v179, 0, v166, s[74:75]
  v_cvt_pk_bf16_f32 v113, 0, v113
  v_cndmask_b32 v180, 0, v163, s[76:77]
  v_cvt_pk_bf16_f32 v114, 0, v114
  v_cndmask_b32 v181, 0, v164, s[76:77]
  v_cvt_pk_bf16_f32 v115, 0, v115
  v_cndmask_b32 v182, 0, v165, s[76:77]
  v_pk_mul_f32 v[112:113], v[112:113], v[120:121] op_sel:[0,1]
  v_cndmask_b32 v183, 0, v166, s[76:77]
  v_pk_mul_f32 v[114:115], v[114:115], v[120:121] op_sel:[0,1]
  v_cvt_pk_bf16_f32 v226, v200, v112
  v_cvt_pk_bf16_f32 v230, v201, v113
  v_cvt_pk_bf16_f32 v234, v202, v114
  v_cvt_pk_bf16_f32 v238, v203, v115
  s_waitcnt vmcnt(16)
  s_cbranch_vccnz L_vw1_17
  s_waitcnt vmcnt(10)
L_vw1_17:
  buffer_load_dwordx4 v[88:91], v95, s[12:15], s60 offen offset:512 nt
  v_pk_fma_f32 v[112:113], v[28:29], s[92:93], v[120:121] op_sel_hi:[1,1,0] neg_lo:[0,0,1] neg_hi:[0,0,1]
  v_pk_fma_f32 v[114:115], v[30:31], s[92:93], v[120:121] op_sel_hi:[1,1,0] neg_lo:[0,0,1] neg_hi:[0,0,1]
  v_cvt_pk_bf16_f32 v112, 0, v112
  v_cndmask_b32 v184, 0, v163, s[78:79]
  v_cvt_pk_bf16_f32 v113, 0, v113
  v_cndmask_b32 v185, 0, v164, s[78:79]
  v_cvt_pk_bf16_f32 v114, 0, v114
  v_cndmask_b32 v186, 0, v165, s[78:79]
  v_cvt_pk_bf16_f32 v115, 0, v115
  v_cndmask_b32 v187, 0, v166, s[78:79]
  v_pk_mul_f32 v[112:113], v[112:113], v[120:121] op_sel:[0,1]
  s_waitcnt lgkmcnt(0)
  v_pk_mul_f32 v[114:115], v[114:115], v[120:121] op_sel:[0,1]
  v_cvt_pk_bf16_f32 v242, v204, v112
  v_cvt_pk_bf16_f32 v246, v205, v113
  v_cvt_pk_bf16_f32 v250, v206, v114
  v_cvt_pk_bf16_f32 v254, v207, v115
  v_mad_u32_u24 v92, v100, s63, v98
  v_add_u32 v93, 768, v92
  v_add_u32 v94, 4608, v92
  v_add_u32 v95, 7680, v92
  v_cndmask_b32 v92, v92, v108, s[52:53]
  v_cndmask_b32 v95, v95, v108, s[54:55]
  s_waitcnt vmcnt(16)
  s_cbranch_vccnz L_vw1_18
  s_waitcnt vmcnt(10)
L_vw1_18:
  buffer_load_dwordx4 v[4:7], v92, s[12:15], s61 offen offset:0 nt
  v_mov_b32_dpp v120, v118 row_newbcast:6 row_mask:0xf bank_mask:0xf
  v_mov_b32_dpp v121, v119 row_newbcast:6 row_mask:0xf bank_mask:0xf
  v_pk_fma_f32 v[196:197], v[32:33], s[92:93], v[120:121] op_sel_hi:[1,1,0] neg_lo:[0,0,1] neg_hi:[0,0,1]
  v_pk_fma_f32 v[198:199], v[34:35], s[92:93], v[120:121] op_sel_hi:[1,1,0] neg_lo:[0,0,1] neg_hi:[0,0,1]
  v_cvt_pk_bf16_f32 v196, 0, v196
  v_mul_f32 v132, v151, v132
  v_cvt_pk_bf16_f32 v197, 0, v197
  v_mul_f32 v133, v151, v133
  v_cvt_pk_bf16_f32 v198, 0, v198
  v_mul_f32 v134, v151, v134
  v_cvt_pk_bf16_f32 v199, 0, v199
  v_mul_f32 v135, v151, v135
  v_pk_mul_f32 v[196:197], v[196:197], v[120:121] op_sel:[0,1]
  v_mul_f32 v136, v151, v136
  v_pk_mul_f32 v[198:199], v[198:199], v[120:121] op_sel:[0,1]
  s_waitcnt vmcnt(14)
  s_cbranch_vccnz L_vw1_19
  s_waitcnt vmcnt(10)
L_vw1_19:
  buffer_load_dwordx4 v[8:11], v92, s[12:15], s61 offen offset:256 nt
  v_pk_fma_f32 v[200:201], v[36:37], s[92:93], v[120:121] op_sel_hi:[1,1,0] neg_lo:[0,0,1] neg_hi:[0,0,1]
  v_pk_fma_f32 v[202:203], v[38:39], s[92:93], v[120:121] op_sel_hi:[1,1,0] neg_lo:[0,0,1] neg_hi:[0,0,1]
  v_cvt_pk_bf16_f32 v200, 0, v200
  v_mul_f32 v137, v151, v137
  v_cvt_pk_bf16_f32 v201, 0, v201
  v_mul_f32 v138, v151, v138
  v_cvt_pk_bf16_f32 v202, 0, v202
  v_mul_f32 v139, v151, v139
  v_cvt_pk_bf16_f32 v203, 0, v203
  v_mul_f32 v140, v151, v140
  v_pk_mul_f32 v[200:201], v[200:201], v[120:121] op_sel:[0,1]
  v_mul_f32 v141, v151, v141
  v_pk_mul_f32 v[202:203], v[202:203], v[120:121] op_sel:[0,1]
  s_waitcnt vmcnt(14)
  s_cbranch_vccnz L_vw1_20
  s_waitcnt vmcnt(10)
L_vw1_20:
  buffer_load_dwordx4 v[12:15], v92, s[12:15], s61 offen offset:512 nt
  v_pk_fma_f32 v[204:205], v[40:41], s[92:93], v[120:121] op_sel_hi:[1,1,0] neg_lo:[0,0,1] neg_hi:[0,0,1]
  v_pk_fma_f32 v[206:207], v[42:43], s[92:93], v[120:121] op_sel_hi:[1,1,0] neg_lo:[0,0,1] neg_hi:[0,0,1]
  v_cvt_pk_bf16_f32 v204, 0, v204
  v_mul_f32 v142, v151, v142
  v_cvt_pk_bf16_f32 v205, 0, v205
  v_mul_f32 v143, v151, v143
  v_cvt_pk_bf16_f32 v206, 0, v206
  v_cvt_pk_bf16_f32 v207, 0, v207
  v_pk_mul_f32 v[204:205], v[204:205], v[120:121] op_sel:[0,1]
  v_pk_mul_f32 v[206:207], v[206:207], v[120:121] op_sel:[0,1]
  s_waitcnt vmcnt(14)
  s_cbranch_vccnz L_vw1_21
  s_waitcnt vmcnt(10)
L_vw1_21:
  buffer_load_dwordx4 v[16:19], v93, s[12:15], s61 offen offset:0 nt
  v_mov_b32_dpp v120, v118 row_newbcast:7 row_mask:0xf bank_mask:0xf
  v_mov_b32_dpp v121, v119 row_newbcast:7 row_mask:0xf bank_mask:0xf
  v_pk_fma_f32 v[112:113], v[44:45], s[92:93], v[120:121] op_sel_hi:[1,1,0] neg_lo:[0,0,1] neg_hi:[0,0,1]
  v_pk_fma_f32 v[114:115], v[46:47], s[92:93], v[120:121] op_sel_hi:[1,1,0] neg_lo:[0,0,1] neg_hi:[0,0,1]
  v_cvt_pk_bf16_f32 v112, 0, v112
  v_cvt_pk_bf16_f32 v113, 0, v113
  v_cvt_pk_bf16_f32 v114, 0, v114
  v_cvt_pk_bf16_f32 v115, 0, v115
  v_pk_mul_f32 v[112:113], v[112:113], v[120:121] op_sel:[0,1]
  v_pk_mul_f32 v[114:115], v[114:115], v[120:121] op_sel:[0,1]
  v_cvt_pk_bf16_f32 v211, v196, v112
  v_cvt_pk_bf16_f32 v215, v197, v113
  v_cvt_pk_bf16_f32 v219, v198, v114
  v_cvt_pk_bf16_f32 v223, v199, v115
  v_mfma_f32_16x16x32_bf16 v[132:135], v[172:175], v[208:211], v[132:135]
  v_mfma_f32_16x16x32_bf16 v[132:135], v[176:179], v[212:215], v[132:135]
  v_mfma_f32_16x16x32_bf16 v[132:135], v[180:183], v[216:219], v[132:135]
  v_mfma_f32_16x16x32_bf16 v[132:135], v[184:187], v[220:223], v[132:135]
  s_waitcnt vmcnt(14)
  s_cbranch_vccnz L_vw1_22
  s_waitcnt vmcnt(10)
L_vw1_22:
  buffer_load_dwordx4 v[20:23], v93, s[12:15], s61 offen offset:256 nt
  v_pk_fma_f32 v[112:113], v[48:49], s[92:93], v[120:121] op_sel_hi:[1,1,0] neg_lo:[0,0,1] neg_hi:[0,0,1]
  v_pk_fma_f32 v[114:115], v[50:51], s[92:93], v[120:121] op_sel_hi:[1,1,0] neg_lo:[0,0,1] neg_hi:[0,0,1]
  v_cvt_pk_bf16_f32 v112, 0, v112
  v_cvt_pk_bf16_f32 v113, 0, v113
  v_cvt_pk_bf16_f32 v114, 0, v114
  v_cvt_pk_bf16_f32 v115, 0, v115
  v_pk_mul_f32 v[112:113], v[112:113], v[120:121] op_sel:[0,1]
  v_pk_mul_f32 v[114:115], v[114:115], v[120:121] op_sel:[0,1]
  v_cvt_pk_bf16_f32 v227, v200, v112
  v_cvt_pk_bf16_f32 v231, v201, v113
  v_cvt_pk_bf16_f32 v235, v202, v114
  v_cvt_pk_bf16_f32 v239, v203, v115
  v_mfma_f32_16x16x32_bf16 v[136:139], v[172:175], v[224:227], v[136:139]
  v_mfma_f32_16x16x32_bf16 v[136:139], v[176:179], v[228:231], v[136:139]
  v_mfma_f32_16x16x32_bf16 v[136:139], v[180:183], v[232:235], v[136:139]
  v_mfma_f32_16x16x32_bf16 v[136:139], v[184:187], v[236:239], v[136:139]
  s_waitcnt vmcnt(14)
  s_cbranch_vccnz L_vw1_23
  s_waitcnt vmcnt(10)
L_vw1_23:
  buffer_load_dwordx4 v[24:27], v93, s[12:15], s61 offen offset:512 nt
  v_pk_fma_f32 v[112:113], v[52:53], s[92:93], v[120:121] op_sel_hi:[1,1,0] neg_lo:[0,0,1] neg_hi:[0,0,1]
  v_pk_fma_f32 v[114:115], v[54:55], s[92:93], v[120:121] op_sel_hi:[1,1,0] neg_lo:[0,0,1] neg_hi:[0,0,1]
  v_cvt_pk_bf16_f32 v112, 0, v112
  v_cvt_pk_bf16_f32 v113, 0, v113
  v_cvt_pk_bf16_f32 v114, 0, v114
  v_cvt_pk_bf16_f32 v115, 0, v115
  v_pk_mul_f32 v[112:113], v[112:113], v[120:121] op_sel:[0,1]
  v_pk_mul_f32 v[114:115], v[114:115], v[120:121] op_sel:[0,1]
  v_cvt_pk_bf16_f32 v243, v204, v112
  v_cvt_pk_bf16_f32 v247, v205, v113
  v_cvt_pk_bf16_f32 v251, v206, v114
  v_cvt_pk_bf16_f32 v255, v207, v115
  v_mfma_f32_16x16x32_bf16 v[140:143], v[172:175], v[240:243], v[140:143]
  v_mfma_f32_16x16x32_bf16 v[140:143], v[176:179], v[244:247], v[140:143]
  v_mfma_f32_16x16x32_bf16 v[140:143], v[180:183], v[248:251], v[140:143]
  v_mfma_f32_16x16x32_bf16 v[140:143], v[184:187], v[252:255], v[140:143]
  s_waitcnt vmcnt(14)
  s_cbranch_vccnz L_vw1_24
  s_waitcnt vmcnt(10)
L_vw1_24:
  buffer_load_dwordx4 v[28:31], v93, s[12:15], s61 offen offset:768 nt
  v_mov_b32_dpp v120, v118 row_newbcast:8 row_mask:0xf bank_mask:0xf
  v_mov_b32_dpp v121, v119 row_newbcast:8 row_mask:0xf bank_mask:0xf
  v_pk_fma_f32 v[196:197], v[56:57], s[92:93], v[120:121] op_sel_hi:[1,1,0] neg_lo:[0,0,1] neg_hi:[0,0,1]
  v_pk_fma_f32 v[198:199], v[58:59], s[92:93], v[120:121] op_sel_hi:[1,1,0] neg_lo:[0,0,1] neg_hi:[0,0,1]
  v_cvt_pk_bf16_f32 v196, 0, v196
  v_cndmask_b32 v188, 0, v167, s[72:73]
  v_cvt_pk_bf16_f32 v197, 0, v197
  v_cndmask_b32 v189, 0, v168, s[72:73]
  v_cvt_pk_bf16_f32 v198, 0, v198
  v_cndmask_b32 v190, 0, v167, s[74:75]
  v_cvt_pk_bf16_f32 v199, 0, v199
  v_cndmask_b32 v191, 0, v168, s[74:75]
  v_pk_mul_f32 v[196:197], v[196:197], v[120:121] op_sel:[0,1]
  v_cndmask_b32 v192, 0, v167, s[76:77]
  v_pk_mul_f32 v[198:199], v[198:199], v[120:121] op_sel:[0,1]
  s_waitcnt vmcnt(14)
  s_cbranch_vccnz L_vw1_25
  s_waitcnt vmcnt(10)
L_vw1_25:
  buffer_load_dwordx4 v[32:35], v93, s[12:15], s61 offen offset:1024 nt
  v_pk_fma_f32 v[200:201], v[60:61], s[92:93], v[120:121] op_sel_hi:[1,1,0] neg_lo:[0,0,1] neg_hi:[0,0,1]
  v_pk_fma_f32 v[202:203], v[62:63], s[92:93], v[120:121] op_sel_hi:[1,1,0] neg_lo:[0,0,1] neg_hi:[0,0,1]
  v_cvt_pk_bf16_f32 v200, 0, v200
  v_cndmask_b32 v193, 0, v168, s[76:77]
  v_cvt_pk_bf16_f32 v201, 0, v201
  v_cndmask_b32 v194, 0, v167, s[78:79]
  v_cvt_pk_bf16_f32 v202, 0, v202
  v_cndmask_b32 v195, 0, v168, s[78:79]
  v_cvt_pk_bf16_f32 v203, 0, v203
  v_pk_mul_f32 v[200:201], v[200:201], v[120:121] op_sel:[0,1]
  v_pk_mul_f32 v[202:203], v[202:203], v[120:121] op_sel:[0,1]
  s_waitcnt vmcnt(14)
  s_cbranch_vccnz L_vw1_26
  s_waitcnt vmcnt(10)
L_vw1_26:
  buffer_load_dwordx4 v[36:39], v93, s[12:15], s61 offen offset:1280 nt
  v_pk_fma_f32 v[204:205], v[64:65], s[92:93], v[120:121] op_sel_hi:[1,1,0] neg_lo:[0,0,1] neg_hi:[0,0,1]
  v_pk_fma_f32 v[206:207], v[66:67], s[92:93], v[120:121] op_sel_hi:[1,1,0] neg_lo:[0,0,1] neg_hi:[0,0,1]
  v_cvt_pk_bf16_f32 v204, 0, v204
  v_cvt_pk_bf16_f32 v205, 0, v205
  v_cvt_pk_bf16_f32 v206, 0, v206
  v_cvt_pk_bf16_f32 v207, 0, v207
  v_pk_mul_f32 v[204:205], v[204:205], v[120:121] op_sel:[0,1]
  v_pk_mul_f32 v[206:207], v[206:207], v[120:121] op_sel:[0,1]
  s_waitcnt vmcnt(14)
  s_cbranch_vccnz L_vw1_27
  s_waitcnt vmcnt(10)
L_vw1_27:
  buffer_load_dwordx4 v[40:43], v93, s[12:15], s61 offen offset:1536 nt
  v_mov_b32_dpp v120, v118 row_newbcast:9 row_mask:0xf bank_mask:0xf
  v_mov_b32_dpp v121, v119 row_newbcast:9 row_mask:0xf bank_mask:0xf
  v_pk_fma_f32 v[112:113], v[68:69], s[92:93], v[120:121] op_sel_hi:[1,1,0] neg_lo:[0,0,1] neg_hi:[0,0,1]
  v_pk_fma_f32 v[114:115], v[70:71], s[92:93], v[120:121] op_sel_hi:[1,1,0] neg_lo:[0,0,1] neg_hi:[0,0,1]
  v_cvt_pk_bf16_f32 v112, 0, v112
  v_cvt_pk_bf16_f32 v113, 0, v113
  v_cvt_pk_bf16_f32 v114, 0, v114
  v_cvt_pk_bf16_f32 v115, 0, v115
  v_pk_mul_f32 v[112:113], v[112:113], v[120:121] op_sel:[0,1]
  v_pk_mul_f32 v[114:115], v[114:115], v[120:121] op_sel:[0,1]
  v_cvt_pk_bf16_f32 v208, v196, v112
  v_cvt_pk_bf16_f32 v212, v197, v113
  v_cvt_pk_bf16_f32 v216, v198, v114
  v_cvt_pk_bf16_f32 v220, v199, v115
  s_waitcnt vmcnt(14)
  s_cbranch_vccnz L_vw1_28
  s_waitcnt vmcnt(10)
L_vw1_28:
  buffer_load_dwordx4 v[44:47], v93, s[12:15], s61 offen offset:1792 nt
  v_pk_fma_f32 v[112:113], v[72:73], s[92:93], v[120:121] op_sel_hi:[1,1,0] neg_lo:[0,0,1] neg_hi:[0,0,1]
  v_pk_fma_f32 v[114:115], v[74:75], s[92:93], v[120:121] op_sel_hi:[1,1,0] neg_lo:[0,0,1] neg_hi:[0,0,1]
  v_cvt_pk_bf16_f32 v112, 0, v112
  v_cvt_pk_bf16_f32 v113, 0, v113
  v_cvt_pk_bf16_f32 v114, 0, v114
  v_cvt_pk_bf16_f32 v115, 0, v115
  v_pk_mul_f32 v[112:113], v[112:113], v[120:121] op_sel:[0,1]
  v_pk_mul_f32 v[114:115], v[114:115], v[120:121] op_sel:[0,1]
  v_cvt_pk_bf16_f32 v224, v200, v112
  v_cvt_pk_bf16_f32 v228, v201, v113
  v_cvt_pk_bf16_f32 v232, v202, v114
  v_cvt_pk_bf16_f32 v236, v203, v115
  s_waitcnt vmcnt(14)
  s_cbranch_vccnz L_vw1_29
  s_waitcnt vmcnt(10)
L_vw1_29:
  buffer_load_dwordx4 v[48:51], v93, s[12:15], s61 offen offset:2048 nt
  v_pk_fma_f32 v[112:113], v[76:77], s[92:93], v[120:121] op_sel_hi:[1,1,0] neg_lo:[0,0,1] neg_hi:[0,0,1]
  v_pk_fma_f32 v[114:115], v[78:79], s[92:93], v[120:121] op_sel_hi:[1,1,0] neg_lo:[0,0,1] neg_hi:[0,0,1]
  v_cvt_pk_bf16_f32 v112, 0, v112
  v_cvt_pk_bf16_f32 v113, 0, v113
  v_cvt_pk_bf16_f32 v114, 0, v114
  v_cvt_pk_bf16_f32 v115, 0, v115
  v_pk_mul_f32 v[112:113], v[112:113], v[120:121] op_sel:[0,1]
  v_pk_mul_f32 v[114:115], v[114:115], v[120:121] op_sel:[0,1]
  v_cvt_pk_bf16_f32 v240, v204, v112
  v_cvt_pk_bf16_f32 v244, v205, v113
  v_cvt_pk_bf16_f32 v248, v206, v114
  v_cvt_pk_bf16_f32 v252, v207, v115
  s_waitcnt vmcnt(14)
  s_cbranch_vccnz L_vw1_30
  s_waitcnt vmcnt(10)
L_vw1_30:
  buffer_load_dwordx4 v[52:55], v93, s[12:15], s61 offen offset:2304 nt
  v_mov_b32_dpp v120, v118 row_newbcast:10 row_mask:0xf bank_mask:0xf
  v_mov_b32_dpp v121, v119 row_newbcast:10 row_mask:0xf bank_mask:0xf
  v_pk_fma_f32 v[196:197], v[80:81], s[92:93], v[120:121] op_sel_hi:[1,1,0] neg_lo:[0,0,1] neg_hi:[0,0,1]
  v_pk_fma_f32 v[198:199], v[82:83], s[92:93], v[120:121] op_sel_hi:[1,1,0] neg_lo:[0,0,1] neg_hi:[0,0,1]
  v_cvt_pk_bf16_f32 v196, 0, v196
  v_cvt_pk_bf16_f32 v197, 0, v197
  v_cvt_pk_bf16_f32 v198, 0, v198
  v_cvt_pk_bf16_f32 v199, 0, v199
  v_pk_mul_f32 v[196:197], v[196:197], v[120:121] op_sel:[0,1]
  v_pk_mul_f32 v[198:199], v[198:199], v[120:121] op_sel:[0,1]
  v_cvt_pk_bf16_f32 v209, v196, 0
  v_cvt_pk_bf16_f32 v213, v197, 0
  v_cvt_pk_bf16_f32 v217, v198, 0
  v_cvt_pk_bf16_f32 v221, v199, 0
  v_mfma_f32_16x16x16_bf16 v[132:135], v[188:189], v[208:209], v[132:135]
  v_mfma_f32_16x16x16_bf16 v[132:135], v[190:191], v[212:213], v[132:135]
  v_mfma_f32_16x16x16_bf16 v[132:135], v[192:193], v[216:217], v[132:135]
  v_mfma_f32_16x16x16_bf16 v[132:135], v[194:195], v[220:221], v[132:135]
  s_waitcnt vmcnt(14)
  s_cbranch_vccnz L_vw1_31
  s_waitcnt vmcnt(10)
L_vw1_31:
  buffer_load_dwordx4 v[56:59], v93, s[12:15], s61 offen offset:2560 nt
  v_pk_fma_f32 v[200:201], v[84:85], s[92:93], v[120:121] op_sel_hi:[1,1,0] neg_lo:[0,0,1] neg_hi:[0,0,1]
  v_pk_fma_f32 v[202:203], v[86:87], s[92:93], v[120:121] op_sel_hi:[1,1,0] neg_lo:[0,0,1] neg_hi:[0,0,1]
  v_cvt_pk_bf16_f32 v200, 0, v200
  v_cvt_pk_bf16_f32 v201, 0, v201
  v_cvt_pk_bf16_f32 v202, 0, v202
  v_cvt_pk_bf16_f32 v203, 0, v203
  v_pk_mul_f32 v[200:201], v[200:201], v[120:121] op_sel:[0,1]
  v_pk_mul_f32 v[202:203], v[202:203], v[120:121] op_sel:[0,1]
  v_cvt_pk_bf16_f32 v225, v200, 0
  v_cvt_pk_bf16_f32 v229, v201, 0
  v_cvt_pk_bf16_f32 v233, v202, 0
  v_cvt_pk_bf16_f32 v237, v203, 0
  v_mfma_f32_16x16x16_bf16 v[136:139], v[188:189], v[224:225], v[136:139]
  v_mfma_f32_16x16x16_bf16 v[136:139], v[190:191], v[228:229], v[136:139]
  v_mfma_f32_16x16x16_bf16 v[136:139], v[192:193], v[232:233], v[136:139]
  v_mfma_f32_16x16x16_bf16 v[136:139], v[194:195], v[236:237], v[136:139]
  s_waitcnt vmcnt(14)
  s_cbranch_vccnz L_vw1_32
  s_waitcnt vmcnt(10)
L_vw1_32:
  buffer_load_dwordx4 v[60:63], v93, s[12:15], s61 offen offset:2816 nt
  v_pk_fma_f32 v[204:205], v[88:89], s[92:93], v[120:121] op_sel_hi:[1,1,0] neg_lo:[0,0,1] neg_hi:[0,0,1]
  v_pk_fma_f32 v[206:207], v[90:91], s[92:93], v[120:121] op_sel_hi:[1,1,0] neg_lo:[0,0,1] neg_hi:[0,0,1]
  v_cvt_pk_bf16_f32 v204, 0, v204
  v_cvt_pk_bf16_f32 v205, 0, v205
  v_cvt_pk_bf16_f32 v206, 0, v206
  v_cvt_pk_bf16_f32 v207, 0, v207
  v_pk_mul_f32 v[204:205], v[204:205], v[120:121] op_sel:[0,1]
  v_pk_mul_f32 v[206:207], v[206:207], v[120:121] op_sel:[0,1]
  v_cvt_pk_bf16_f32 v241, v204, 0
  v_cvt_pk_bf16_f32 v245, v205, 0
  v_cvt_pk_bf16_f32 v249, v206, 0
  v_cvt_pk_bf16_f32 v253, v207, 0
  v_mfma_f32_16x16x16_bf16 v[140:143], v[188:189], v[240:241], v[140:143]
  v_mfma_f32_16x16x16_bf16 v[140:143], v[190:191], v[244:245], v[140:143]
  v_mfma_f32_16x16x16_bf16 v[140:143], v[192:193], v[248:249], v[140:143]
  v_mfma_f32_16x16x16_bf16 v[140:143], v[194:195], v[252:253], v[140:143]
  s_mov_b32 s60, s61
  s_cmp_ge_u32 s64, 96
  s_cbranch_scc1 L_v_done
  s_cmp_eq_u32 s89, s88
  s_cbranch_scc1 L_v0
  s_mov_b32 s88, s89
  v_mov_b32 v149, v147
  s_nop 1
  v_permlane32_swap_b32 v147, v149
  v_add_f32 v147, v147, v149
  v_mov_b32 v149, v147
  s_nop 1
  v_permlane16_swap_b32 v147, v149
  v_add_f32 v147, v147, v149
  ds_write_b64 v106, v[146:147]
  ds_write_b128 v105, v[132:135] offset:0
  ds_write_b128 v105, v[136:139] offset:1024
  ds_write_b128 v105, v[140:143] offset:2048
  s_and_b32 s70, s86, 15
  s_cmp_ge_u32 s70, 12
  s_cselect_b32 s70, 2, 0
  s_and_b32 s71, s87, 1
  s_bitcmp1_b32 s96, 6
  s_cselect_b32 s71, s4, s71
  s_add_u32 s70, s70, s71
  s_lshr_b32 s71, s86, 4
  s_lshl2_add_u32 s70, s71, s70
  s_add_u32 s71, s3, 0
  s_cmp_eq_u32 s100, s71
  s_cselect_b32 s44, s70, s44
  s_add_u32 s71, s3, 2
  s_cmp_eq_u32 s100, s71
  s_cselect_b32 s45, s70, s45
  s_add_u32 s100, s100, 1
  s_waitcnt lgkmcnt(0)
  v_add_u32 v105, 6208, v105
  v_add_u32 v106, 6208, v106
  v_mov_b32 v132, 0
  v_mov_b32 v133, 0
  v_mov_b32 v134, 0
  v_mov_b32 v135, 0
  v_mov_b32 v136, 0
  v_mov_b32 v137, 0
  v_mov_b32 v138, 0
  v_mov_b32 v139, 0
  v_mov_b32 v140, 0
  v_mov_b32 v141, 0
  v_mov_b32 v142, 0
  v_mov_b32 v143, 0
  v_mov_b32 v144, 0xff800000
  v_mov_b32 v146, 0x7f800000
  v_mov_b32 v147, 0
  s_branch L_v0
L_v_done:
  v_mov_b32 v149, v147
  s_nop 1
  v_permlane32_swap_b32 v147, v149
  v_add_f32 v147, v147, v149
  v_mov_b32 v149, v147
  s_nop 1
  v_permlane16_swap_b32 v147, v149
  v_add_f32 v147, v147, v149
  ds_write_b64 v106, v[146:147]
  ds_write_b128 v105, v[132:135] offset:0
  ds_write_b128 v105, v[136:139] offset:1024
  ds_write_b128 v105, v[140:143] offset:2048
  s_and_b32 s70, s86, 15
  s_cmp_ge_u32 s70, 12
  s_cselect_b32 s70, 2, 0
  s_and_b32 s71, s87, 1
  s_bitcmp1_b32 s96, 6
  s_cselect_b32 s71, s4, s71
  s_add_u32 s70, s70, s71
  s_lshr_b32 s71, s86, 4
  s_lshl2_add_u32 s70, s71, s70
  s_add_u32 s71, s3, 0
  s_cmp_eq_u32 s100, s71
  s_cselect_b32 s44, s70, s44
  s_add_u32 s71, s3, 2
  s_cmp_eq_u32 s100, s71
  s_cselect_b32 s45, s70, s45
  s_add_u32 s100, s100, 1
  s_waitcnt lgkmcnt(0)
  s_waitcnt vmcnt(0)
  s_barrier
  v_lshrrev_b32 v150, 1, v104
  v_lshlrev_b32 v151, 4, v0
  s_mul_i32 s70, s3, 6208
  s_add_u32 s70, s70, 36864
  v_add_u32 v148, s70, v150
  ds_read_b64 v[4:5], v148 offset:6144
  ds_read_b64 v[6:7], v148 offset:6176
  v_add_u32 v148, s70, v151
  ds_read_b128 v[172:175], v148 offset:0
  ds_read_b128 v[176:179], v148 offset:1024
  ds_read_b128 v[180:183], v148 offset:2048
  ds_read_b128 v[184:187], v148 offset:3072
  ds_read_b128 v[188:191], v148 offset:4096
  ds_read_b128 v[192:195], v148 offset:5120
  s_mul_i32 s70, s3, 6208
  s_add_u32 s70, s70, 49280
  v_add_u32 v148, s70, v150
  ds_read_b64 v[8:9], v148 offset:6144
  ds_read_b64 v[10:11], v148 offset:6176
  v_add_u32 v148, s70, v151
  ds_read_b128 v[196:199], v148 offset:0
  ds_read_b128 v[200:203], v148 offset:1024
  ds_read_b128 v[204:207], v148 offset:2048
  ds_read_b128 v[208:211], v148 offset:3072
  ds_read_b128 v[212:215], v148 offset:4096
  ds_read_b128 v[216:219], v148 offset:5120
  s_waitcnt lgkmcnt(0)
  s_mul_i32 s70, s44, 3328
  s_add_u32 s70, s70, 1048576
  v_min_f32 v148, v4, v6
  v_sub_f32 v4, v148, v4
  v_sub_f32 v6, v148, v6
  v_exp_f32 v4, v4
  v_exp_f32 v6, v6
  v_mul_f32 v149, v4, v5
  v_fma_f32 v149, v6, v7, v149
  v_mul_f32 v132, v4, v172
  v_fma_f32 v132, v6, v184, v132
  v_mul_f32 v133, v4, v173
  v_fma_f32 v133, v6, v185, v133
  v_mul_f32 v134, v4, v174
  v_fma_f32 v134, v6, v186, v134
  v_mul_f32 v135, v4, v175
  v_fma_f32 v135, v6, v187, v135
  v_mul_f32 v136, v4, v176
  v_fma_f32 v136, v6, v188, v136
  v_mul_f32 v137, v4, v177
  v_fma_f32 v137, v6, v189, v137
  v_mul_f32 v138, v4, v178
  v_fma_f32 v138, v6, v190, v138
  v_mul_f32 v139, v4, v179
  v_fma_f32 v139, v6, v191, v139
  v_mul_f32 v140, v4, v180
  v_fma_f32 v140, v6, v192, v140
  v_mul_f32 v141, v4, v181
  v_fma_f32 v141, v6, v193, v141
  v_mul_f32 v142, v4, v182
  v_fma_f32 v142, v6, v194, v142
  v_mul_f32 v143, v4, v183
  v_fma_f32 v143, v6, v195, v143
  buffer_store_dwordx4 v[132:135], v151, s[40:43], s70 offen offset:0 sc1
  buffer_store_dwordx4 v[136:139], v151, s[40:43], s70 offen offset:1024 sc1
  buffer_store_dwordx4 v[140:143], v151, s[40:43], s70 offen offset:2048 sc1
  buffer_store_dwordx2 v[148:149], v150, s[40:43], s70 offen offset:3072 sc1
  s_mul_i32 s70, s45, 3328
  s_add_u32 s70, s70, 1048576
  v_min_f32 v120, v8, v10
  v_sub_f32 v8, v120, v8
  v_sub_f32 v10, v120, v10
  v_exp_f32 v8, v8
  v_exp_f32 v10, v10
  v_mul_f32 v121, v8, v9
  v_fma_f32 v121, v10, v11, v121
  v_mul_f32 v16, v8, v196
  v_fma_f32 v16, v10, v208, v16
  v_mul_f32 v17, v8, v197
  v_fma_f32 v17, v10, v209, v17
  v_mul_f32 v18, v8, v198
  v_fma_f32 v18, v10, v210, v18
  v_mul_f32 v19, v8, v199
  v_fma_f32 v19, v10, v211, v19
  v_mul_f32 v20, v8, v200
  v_fma_f32 v20, v10, v212, v20
  v_mul_f32 v21, v8, v201
  v_fma_f32 v21, v10, v213, v21
  v_mul_f32 v22, v8, v202
  v_fma_f32 v22, v10, v214, v22
  v_mul_f32 v23, v8, v203
  v_fma_f32 v23, v10, v215, v23
  v_mul_f32 v24, v8, v204
  v_fma_f32 v24, v10, v216, v24
  v_mul_f32 v25, v8, v205
  v_fma_f32 v25, v10, v217, v25
  v_mul_f32 v26, v8, v206
  v_fma_f32 v26, v10, v218, v26
  v_mul_f32 v27, v8, v207
  v_fma_f32 v27, v10, v219, v27
  buffer_store_dwordx4 v[16:19], v151, s[40:43], s70 offen offset:0 sc1
  buffer_store_dwordx4 v[20:23], v151, s[40:43], s70 offen offset:1024 sc1
  buffer_store_dwordx4 v[24:27], v151, s[40:43], s70 offen offset:2048 sc1
  buffer_store_dwordx2 v[120:121], v150, s[40:43], s70 offen offset:3072 sc1
L_fin:
L_end:
  s_endpgm
L_helper:
  v_lshlrev_b32 v1, 2, v0
  v_add_u32 v1, 61696, v1
  v_mov_b32 v2, 0
  s_mov_b64 exec, 0xff
  ds_write_b32 v1, v2
  s_mov_b64 exec, -1
  s_waitcnt lgkmcnt(0)
  s_mov_b32 s8, s46
  s_and_b32 s9, s47, 0xffff
  s_mov_b32 s10, 805306368
  s_mov_b32 s11, 0x20000
  s_mov_b32 s20, s50
  s_and_b32 s21, s51, 0xffff
  s_mov_b32 s22, 6291456
  s_mov_b32 s23, 0x20000
  s_mov_b32 s24, s52
  s_and_b32 s25, s53, 0xffff
  s_mov_b32 s26, 6291456
  s_mov_b32 s27, 0x20000
  s_mov_b32 s36, s44
  s_and_b32 s37, s45, 0xffff
  s_mov_b32 s38, 393216
  s_mov_b32 s39, 0x20000
  s_mov_b32 s16, s46
  s_and_b32 s17, s47, 0xffff
  s_mov_b32 s18, 805306368
  s_mov_b32 s19, 0x20000
  s_mov_b32 s12, s48
  s_and_b32 s13, s49, 0xffff
  s_mov_b32 s14, 805306368
  s_mov_b32 s15, 0x20000
  s_mov_b32 s28, s54
  s_and_b32 s29, s55, 0xffff
  s_mov_b32 s30, 2097152
  s_mov_b32 s31, 0x20000
  s_mov_b32 s32, s56
  s_and_b32 s33, s57, 0xffff
  s_mov_b32 s34, 2097152
  s_mov_b32 s35, 0x20000
  s_mov_b32 s40, s82
  s_and_b32 s41, s83, 0xffff
  s_mov_b32 s42, 25165824
  s_mov_b32 s43, 0x20000
  s_barrier
  s_memrealtime s[72:73]
  s_mov_b32 s66, 0
  s_lshr_b32 s70, s2, 4
  s_and_b32 s70, s70, 8
  s_and_b32 s71, s2, 7
  s_add_u32 s70, s70, s71
  s_lshl_b32 s70, s70, 3
  v_mov_b32 v104, s70
  v_and_b32 v105, 15, v0
  v_lshlrev_b32 v105, 3, v105
  s_bitcmp1_b32 s2, 3
  s_cselect_b32 s16, s12, s8
  s_cselect_b32 s17, s13, s9
  s_cselect_b32 s52, 24, 0
  s_lshl_b32 s44, s5, 16
  s_lshl_b32 s70, s4, 16
  s_add_u32 s44, s44, s70
  s_add_u32 s44, s44, 0x1c0000
  s_bfe_u32 s70, s2, 0x40004
  s_mul_i32 s70, s70, 0x4a80
  s_and_b32 s70, s70, 0x5f80
  s_add_u32 s44, s44, s70
  s_mov_b32 s48, 0
  s_mov_b32 s49, 0x1000000
  s_mov_b32 s50, 0
L_h_page:
  s_add_u32 s70, s44, 0x8000
  s_buffer_load_dword s58, s[16:19], s70
  s_mov_b32 s45, -1
  s_mov_b32 s46, -1
  s_waitcnt lgkmcnt(0)
  s_xor_b32 s70, s44, 0
  s_memtime s[54:55]
  s_waitcnt lgkmcnt(0)
  s_buffer_load_dword s58, s[16:19], s70
  s_waitcnt lgkmcnt(0)
  s_memtime s[56:57]
  s_waitcnt lgkmcnt(0)
  s_sub_u32 s56, s56, s54
  s_min_u32 s45, s45, s56
  s_xor_b32 s70, s44, 8192
  s_memtime s[54:55]
  s_waitcnt lgkmcnt(0)
  s_buffer_load_dword s58, s[16:19], s70
  s_waitcnt lgkmcnt(0)
  s_memtime s[56:57]
  s_waitcnt lgkmcnt(0)
  s_sub_u32 s56, s56, s54
  s_min_u32 s46, s46, s56
  s_xor_b32 s70, s44, 17280
  s_memtime s[54:55]
  s_waitcnt lgkmcnt(0)
  s_buffer_load_dword s58, s[16:19], s70
  s_waitcnt lgkmcnt(0)
  s_memtime s[56:57]
  s_waitcnt lgkmcnt(0)
  s_sub_u32 s56, s56, s54
  s_min_u32 s45, s45, s56
  s_xor_b32 s70, s44, 25472
  s_memtime s[54:55]
  s_waitcnt lgkmcnt(0)
  s_buffer_load_dword s58, s[16:19], s70
  s_waitcnt lgkmcnt(0)
  s_memtime s[56:57]
  s_waitcnt lgkmcnt(0)
  s_sub_u32 s56, s56, s54
  s_min_u32 s46, s46, s56
  s_cmp_lt_u32 s46, s45
  s_cselect_b32 s54, 1, 0
  s_xor_b32 s54, s54, s4
  s_mov_b32 s55, 0
  s_lshl_b64 s[54:55], s[54:55], s52
  s_or_b64 s[48:49], s[48:49], s[54:55]
  s_add_u32 s52, s52, 8
  s_add_u32 s44, s44, 0x10000000
  s_add_u32 s50, s50, 1
  s_cmp_lt_u32 s50, 3
  s_cbranch_scc1 L_h_page
  s_and_b32 s70, s2, 3
  s_lshl_b32 s62, s70, 6
  s_cmp_ge_u32 s2, 4
  s_cbranch_scc1 L_h_nonce
  s_lshl_b64 s[54:55], s[72:73], 2
  s_add_u32 s70, s62, 8
  s_atomic_add_x2 s[54:55], s[80:81], s70 glc
  s_waitcnt lgkmcnt(0)
L_h_nonce:
  s_atomic_add_x2 s[48:49], s[80:81], s62
  s_waitcnt lgkmcnt(0)
  v_mov_b32 v1, 61712
L_h_progv:
  s_sleep 8
  ds_read_b128 v[8:11], v1
  s_waitcnt lgkmcnt(0)
  v_min_u32 v8, v8, v9
  s_nop 0
  v_readfirstlane_b32 s54, v8
  s_nop 1
  s_cmp_lt_u32 s54, 12
  s_cbranch_scc1 L_h_progv
  s_load_dwordx2 s[48:49], s[80:81], s62
  s_mov_b32 s59, 0
L_h_votes:
  s_waitcnt lgkmcnt(0)
  s_lshr_b32 s70, s49, 24
  s_cmp_eq_u32 s70, 64
  s_cbranch_scc1 L_h_votes_done
  s_add_u32 s59, s59, 1
  s_cmp_gt_u32 s59, 2000
  s_cbranch_scc1 L_h_votes_done
  s_sleep 64
  s_mov_b64 s[48:49], 0
  s_atomic_or_x2 s[48:49], s[80:81], s62 glc
  s_branch L_h_votes
L_h_votes_done:
  s_mov_b32 s96, 0x80
  s_bfe_u32 s54, s48, 0x80000
  s_cmp_gt_u32 s54, 16
  s_cselect_b32 s56, 1, 0
  s_or_b32 s96, s96, s56
  s_sub_u32 s54, s54, 13
  s_cmp_lt_u32 s54, 7
  s_cselect_b32 s56, 64, 0
  s_or_b32 s96, s96, s56
  s_bfe_u32 s54, s48, 0x80008
  s_cmp_gt_u32 s54, 16
  s_cselect_b32 s56, 2, 0
  s_or_b32 s96, s96, s56
  s_sub_u32 s54, s54, 13
  s_cmp_lt_u32 s54, 7
  s_cselect_b32 s56, 64, 0
  s_or_b32 s96, s96, s56
  s_bfe_u32 s54, s48, 0x80010
  s_cmp_gt_u32 s54, 16
  s_cselect_b32 s56, 4, 0
  s_or_b32 s96, s96, s56
  s_sub_u32 s54, s54, 13
  s_cmp_lt_u32 s54, 7
  s_cselect_b32 s56, 64, 0
  s_or_b32 s96, s96, s56
  s_bfe_u32 s54, s48, 0x80018
  s_cmp_gt_u32 s54, 16
  s_cselect_b32 s56, 8, 0
  s_or_b32 s96, s96, s56
  s_sub_u32 s54, s54, 13
  s_cmp_lt_u32 s54, 7
  s_cselect_b32 s56, 64, 0
  s_or_b32 s96, s96, s56
  s_bfe_u32 s54, s49, 0x80000
  s_cmp_gt_u32 s54, 16
  s_cselect_b32 s56, 16, 0
  s_or_b32 s96, s96, s56
  s_sub_u32 s54, s54, 13
  s_cmp_lt_u32 s54, 7
  s_cselect_b32 s56, 64, 0
  s_or_b32 s96, s96, s56
  s_bfe_u32 s54, s49, 0x80008
  s_cmp_gt_u32 s54, 16
  s_cselect_b32 s56, 32, 0
  s_or_b32 s96, s96, s56
  s_sub_u32 s54, s54, 13
  s_cmp_lt_u32 s54, 7
  s_cselect_b32 s56, 64, 0
  s_or_b32 s96, s96, s56
  s_mul_i32 s54, s4, 63
  s_xor_b32 s96, s96, s54
  v_mov_b32 v1, 61696
  v_mov_b32 v8, s96
  ds_write_b32 v1, v8
  v_lshlrev_b32 v3, 4, v0
  s_mul_i32 s54, s2, 24576
  s_waitcnt vmcnt(7)
  buffer_load_dwordx4 v[8:11], v3, s[20:23], s54 offen offset:0
  s_waitcnt vmcnt(7)
  buffer_load_dwordx4 v[8:11], v3, s[20:23], s54 offen offset:1024
  s_waitcnt vmcnt(7)
  buffer_load_dwordx4 v[8:11], v3, s[20:23], s54 offen offset:2048
  s_waitcnt vmcnt(7)
  buffer_load_dwordx4 v[8:11], v3, s[20:23], s54 offen offset:3072
  s_add_u32 s54, s54, 4096
  s_waitcnt vmcnt(7)
  buffer_load_dwordx4 v[8:11], v3, s[20:23], s54 offen offset:0
  s_waitcnt vmcnt(7)
  buffer_load_dwordx4 v[8:11], v3, s[20:23], s54 offen offset:1024
  s_waitcnt vmcnt(7)
  buffer_load_dwordx4 v[8:11], v3, s[20:23], s54 offen offset:2048
  s_waitcnt vmcnt(7)
  buffer_load_dwordx4 v[8:11], v3, s[20:23], s54 offen offset:3072
  s_add_u32 s54, s54, 4096
  s_waitcnt vmcnt(7)
  buffer_load_dwordx4 v[8:11], v3, s[20:23], s54 offen offset:0
  s_waitcnt vmcnt(7)
  buffer_load_dwordx4 v[8:11], v3, s[20:23], s54 offen offset:1024
  s_waitcnt vmcnt(7)
  buffer_load_dwordx4 v[8:11], v3, s[20:23], s54 offen offset:2048
  s_waitcnt vmcnt(7)
  buffer_load_dwordx4 v[8:11], v3, s[20:23], s54 offen offset:3072
  s_add_u32 s54, s54, 4096
  s_waitcnt vmcnt(7)
  buffer_load_dwordx4 v[8:11], v3, s[20:23], s54 offen offset:0
  s_waitcnt vmcnt(7)
  buffer_load_dwordx4 v[8:11], v3, s[20:23], s54 offen offset:1024
  s_waitcnt vmcnt(7)
  buffer_load_dwordx4 v[8:11], v3, s[20:23], s54 offen offset:2048
  s_waitcnt vmcnt(7)
  buffer_load_dwordx4 v[8:11], v3, s[20:23], s54 offen offset:3072
  s_add_u32 s54, s54, 4096
  s_waitcnt vmcnt(7)
  buffer_load_dwordx4 v[8:11], v3, s[20:23], s54 offen offset:0
  s_waitcnt vmcnt(7)
  buffer_load_dwordx4 v[8:11], v3, s[20:23], s54 offen offset:1024
  s_waitcnt vmcnt(7)
  buffer_load_dwordx4 v[8:11], v3, s[20:23], s54 offen offset:2048
  s_waitcnt vmcnt(7)
  buffer_load_dwordx4 v[8:11], v3, s[20:23], s54 offen offset:3072
  s_add_u32 s54, s54, 4096
  s_waitcnt vmcnt(7)
  buffer_load_dwordx4 v[8:11], v3, s[20:23], s54 offen offset:0
  s_waitcnt vmcnt(7)
  buffer_load_dwordx4 v[8:11], v3, s[20:23], s54 offen offset:1024
  s_waitcnt vmcnt(7)
  buffer_load_dwordx4 v[8:11], v3, s[20:23], s54 offen offset:2048
  s_waitcnt vmcnt(7)
  buffer_load_dwordx4 v[8:11], v3, s[20:23], s54 offen offset:3072
  s_mul_i32 s54, s2, 24576
  s_waitcnt vmcnt(7)
  buffer_load_dwordx4 v[8:11], v3, s[24:27], s54 offen offset:0
  s_waitcnt vmcnt(7)
  buffer_load_dwordx4 v[8:11], v3, s[24:27], s54 offen offset:1024
  s_waitcnt vmcnt(7)
  buffer_load_dwordx4 v[8:11], v3, s[24:27], s54 offen offset:2048
  s_waitcnt vmcnt(7)
  buffer_load_dwordx4 v[8:11], v3, s[24:27], s54 offen offset:3072
  s_add_u32 s54, s54, 4096
  s_waitcnt vmcnt(7)
  buffer_load_dwordx4 v[8:11], v3, s[24:27], s54 offen offset:0
  s_waitcnt vmcnt(7)
  buffer_load_dwordx4 v[8:11], v3, s[24:27], s54 offen offset:1024
  s_waitcnt vmcnt(7)
  buffer_load_dwordx4 v[8:11], v3, s[24:27], s54 offen offset:2048
  s_waitcnt vmcnt(7)
  buffer_load_dwordx4 v[8:11], v3, s[24:27], s54 offen offset:3072
  s_add_u32 s54, s54, 4096
  s_waitcnt vmcnt(7)
  buffer_load_dwordx4 v[8:11], v3, s[24:27], s54 offen offset:0
  s_waitcnt vmcnt(7)
  buffer_load_dwordx4 v[8:11], v3, s[24:27], s54 offen offset:1024
  s_waitcnt vmcnt(7)
  buffer_load_dwordx4 v[8:11], v3, s[24:27], s54 offen offset:2048
  s_waitcnt vmcnt(7)
  buffer_load_dwordx4 v[8:11], v3, s[24:27], s54 offen offset:3072
  s_add_u32 s54, s54, 4096
  s_waitcnt vmcnt(7)
  buffer_load_dwordx4 v[8:11], v3, s[24:27], s54 offen offset:0
  s_waitcnt vmcnt(7)
  buffer_load_dwordx4 v[8:11], v3, s[24:27], s54 offen offset:1024
  s_waitcnt vmcnt(7)
  buffer_load_dwordx4 v[8:11], v3, s[24:27], s54 offen offset:2048
  s_waitcnt vmcnt(7)
  buffer_load_dwordx4 v[8:11], v3, s[24:27], s54 offen offset:3072
  s_add_u32 s54, s54, 4096
  s_waitcnt vmcnt(7)
  buffer_load_dwordx4 v[8:11], v3, s[24:27], s54 offen offset:0
  s_waitcnt vmcnt(7)
  buffer_load_dwordx4 v[8:11], v3, s[24:27], s54 offen offset:1024
  s_waitcnt vmcnt(7)
  buffer_load_dwordx4 v[8:11], v3, s[24:27], s54 offen offset:2048
  s_waitcnt vmcnt(7)
  buffer_load_dwordx4 v[8:11], v3, s[24:27], s54 offen offset:3072
  s_add_u32 s54, s54, 4096
  s_waitcnt vmcnt(7)
  buffer_load_dwordx4 v[8:11], v3, s[24:27], s54 offen offset:0
  s_waitcnt vmcnt(7)
  buffer_load_dwordx4 v[8:11], v3, s[24:27], s54 offen offset:1024
  s_waitcnt vmcnt(7)
  buffer_load_dwordx4 v[8:11], v3, s[24:27], s54 offen offset:2048
  s_waitcnt vmcnt(7)
  buffer_load_dwordx4 v[8:11], v3, s[24:27], s54 offen offset:3072
  s_mul_i32 s54, s2, 8192
  s_waitcnt vmcnt(7)
  buffer_load_dwordx4 v[8:11], v3, s[28:31], s54 offen offset:0
  s_waitcnt vmcnt(7)
  buffer_load_dwordx4 v[8:11], v3, s[28:31], s54 offen offset:1024
  s_waitcnt vmcnt(7)
  buffer_load_dwordx4 v[8:11], v3, s[28:31], s54 offen offset:2048
  s_waitcnt vmcnt(7)
  buffer_load_dwordx4 v[8:11], v3, s[28:31], s54 offen offset:3072
  s_add_u32 s54, s54, 4096
  s_waitcnt vmcnt(7)
  buffer_load_dwordx4 v[8:11], v3, s[28:31], s54 offen offset:0
  s_waitcnt vmcnt(7)
  buffer_load_dwordx4 v[8:11], v3, s[28:31], s54 offen offset:1024
  s_waitcnt vmcnt(7)
  buffer_load_dwordx4 v[8:11], v3, s[28:31], s54 offen offset:2048
  s_waitcnt vmcnt(7)
  buffer_load_dwordx4 v[8:11], v3, s[28:31], s54 offen offset:3072
  s_mul_i32 s54, s2, 8192
  s_waitcnt vmcnt(7)
  buffer_load_dwordx4 v[8:11], v3, s[32:35], s54 offen offset:0
  s_waitcnt vmcnt(7)
  buffer_load_dwordx4 v[8:11], v3, s[32:35], s54 offen offset:1024
  s_waitcnt vmcnt(7)
  buffer_load_dwordx4 v[8:11], v3, s[32:35], s54 offen offset:2048
  s_waitcnt vmcnt(7)
  buffer_load_dwordx4 v[8:11], v3, s[32:35], s54 offen offset:3072
  s_add_u32 s54, s54, 4096
  s_waitcnt vmcnt(7)
  buffer_load_dwordx4 v[8:11], v3, s[32:35], s54 offen offset:0
  s_waitcnt vmcnt(7)
  buffer_load_dwordx4 v[8:11], v3, s[32:35], s54 offen offset:1024
  s_waitcnt vmcnt(7)
  buffer_load_dwordx4 v[8:11], v3, s[32:35], s54 offen offset:2048
  s_waitcnt vmcnt(7)
  buffer_load_dwordx4 v[8:11], v3, s[32:35], s54 offen offset:3072
  s_waitcnt vmcnt(0)
  v_mov_b32 v1, 61712
L_h_progc0_0:
  s_sleep 8
  ds_read_b128 v[8:11], v1
  s_waitcnt lgkmcnt(0)
  v_min_u32 v8, v8, v9
  s_nop 0
  v_readfirstlane_b32 s54, v8
  s_nop 1
  s_cmp_lt_u32 s54, 28
  s_cbranch_scc1 L_h_progc0_0
  s_memrealtime s[54:55]
  s_waitcnt lgkmcnt(0)
  s_sub_u32 s65, s54, s72
  s_and_b32 s70, s2, 0x78
  s_cbranch_scc1 L_h_np0
  v_mov_b32 v8, s54
  v_mov_b32 v9, s55
  s_mov_b32 s70, 6291456
  s_mov_b64 exec, 1
  buffer_store_dwordx2 v[8:9], v104, s[40:43], s70 offen sc1
  s_mov_b64 exec, -1
L_h_np0:
  v_mov_b32 v1, 61712
L_h_progc0_1:
  s_sleep 8
  ds_read_b128 v[8:11], v1
  s_waitcnt lgkmcnt(0)
  v_min_u32 v8, v8, v9
  s_nop 0
  v_readfirstlane_b32 s54, v8
  s_nop 1
  s_cmp_lt_u32 s54, 36
  s_cbranch_scc1 L_h_progc0_1
  s_mov_b32 s70, 6291456
  buffer_load_dwordx2 v[8:9], v105, s[40:43], s70 offen
  v_mov_b32 v10, s73
  s_waitcnt vmcnt(0)
  v_subrev_co_u32 v8, vcc, s72, v8
  s_nop 1
  v_subb_co_u32 v9, vcc, v9, v10, vcc
  v_lshrrev_b32 v10, 24, v8
  v_or_b32 v9, v9, v10
  v_cmp_eq_u32 vcc, 0, v9
  s_nop 1
  v_cndmask_b32 v8, 0, v8, vcc
  s_and_b32 s56, vcc_lo, 0xffff
  s_bcnt1_i32_b32 s56, s56
  v_add_u32_dpp v8, v8, v8 row_ror:8 row_mask:0xf bank_mask:0xf
  s_nop 1
  v_add_u32_dpp v8, v8, v8 row_ror:4 row_mask:0xf bank_mask:0xf
  s_nop 1
  v_add_u32_dpp v8, v8, v8 row_ror:2 row_mask:0xf bank_mask:0xf
  s_nop 1
  v_add_u32_dpp v8, v8, v8 row_ror:1 row_mask:0xf bank_mask:0xf
  s_nop 0
  v_readfirstlane_b32 s54, v8
  s_sub_u32 s70, s65, 0
  s_mul_i32 s70, s70, s56
  s_sub_i32 s54, s70, s54
  s_max_i32 s54, s54, 0
  s_max_u32 s56, s56, 1
  s_mul_i32 s56, s56, 22
  v_cvt_f32_u32 v8, s56
  v_cvt_f32_u32 v9, s54
  v_rcp_f32 v8, v8
  s_nop 0
  v_fma_f32 v8, v8, v9, 0.5
  v_cvt_u32_f32 v8, v8
  v_min_u32 v8, 64, v8
  s_nop 0
  v_readfirstlane_b32 s54, v8
  s_nop 1
  s_mul_i32 s54, s54, 2
  s_sub_i32 s70, s66, 28
  s_max_i32 s70, s70, 0
  s_min_i32 s70, s70, 10
  s_sub_i32 s54, s54, s70
  s_cmp_gt_i32 s54, 0
  s_cselect_b32 s70, 38, 0
  s_cselect_b32 s54, s54, 0
  s_add_u32 s66, s70, s54
  v_mov_b32 v8, s66
  v_mov_b32 v1, 61704
  ds_write_b32 v1, v8
  v_mov_b32 v1, 61712
L_h_progc1_0:
  s_sleep 8
  ds_read_b128 v[8:11], v1
  s_waitcnt lgkmcnt(0)
  v_min_u32 v8, v8, v9
  s_nop 0
  v_readfirstlane_b32 s54, v8
  s_nop 1
  s_cmp_lt_u32 s54, 44
  s_cbranch_scc1 L_h_progc1_0
  s_memrealtime s[54:55]
  s_waitcnt lgkmcnt(0)
  s_sub_u32 s65, s54, s72
  s_and_b32 s70, s2, 0x78
  s_cbranch_scc1 L_h_np1
  v_mov_b32 v8, s54
  v_mov_b32 v9, s55
  s_mov_b32 s70, 6291712
  s_mov_b64 exec, 1
  buffer_store_dwordx2 v[8:9], v104, s[40:43], s70 offen sc1
  s_mov_b64 exec, -1
L_h_np1:
  v_mov_b32 v1, 61712
L_h_progc1_1:
  s_sleep 8
  ds_read_b128 v[8:11], v1
  s_waitcnt lgkmcnt(0)
  v_min_u32 v8, v8, v9
  s_nop 0
  v_readfirstlane_b32 s54, v8
  s_nop 1
  s_cmp_lt_u32 s54, 52
  s_cbranch_scc1 L_h_progc1_1
  s_mov_b32 s70, 6291712
  buffer_load_dwordx2 v[8:9], v105, s[40:43], s70 offen
  v_mov_b32 v10, s73
  s_waitcnt vmcnt(0)
  v_subrev_co_u32 v8, vcc, s72, v8
  s_nop 1
  v_subb_co_u32 v9, vcc, v9, v10, vcc
  v_lshrrev_b32 v10, 24, v8
  v_or_b32 v9, v9, v10
  v_cmp_eq_u32 vcc, 0, v9
  s_nop 1
  v_cndmask_b32 v8, 0, v8, vcc
  s_and_b32 s56, vcc_lo, 0xffff
  s_bcnt1_i32_b32 s56, s56
  v_add_u32_dpp v8, v8, v8 row_ror:8 row_mask:0xf bank_mask:0xf
  s_nop 1
  v_add_u32_dpp v8, v8, v8 row_ror:4 row_mask:0xf bank_mask:0xf
  s_nop 1
  v_add_u32_dpp v8, v8, v8 row_ror:2 row_mask:0xf bank_mask:0xf
  s_nop 1
  v_add_u32_dpp v8, v8, v8 row_ror:1 row_mask:0xf bank_mask:0xf
  s_nop 0
  v_readfirstlane_b32 s54, v8
  s_sub_u32 s70, s65, 0
  s_mul_i32 s70, s70, s56
  s_sub_i32 s54, s70, s54
  s_max_i32 s54, s54, 0
  s_max_u32 s56, s56, 1
  s_mul_i32 s56, s56, 22
  v_cvt_f32_u32 v8, s56
  v_cvt_f32_u32 v9, s54
  v_rcp_f32 v8, v8
  s_nop 0
  v_fma_f32 v8, v8, v9, 0.5
  v_cvt_u32_f32 v8, v8
  v_min_u32 v8, 64, v8
  s_nop 0
  v_readfirstlane_b32 s54, v8
  s_nop 1
  s_mul_i32 s54, s54, 2
  s_sub_i32 s70, s66, 44
  s_max_i32 s70, s70, 0
  s_min_i32 s70, s70, 10
  s_sub_i32 s54, s54, s70
  s_cmp_gt_i32 s54, 0
  s_cselect_b32 s70, 54, 0
  s_cselect_b32 s54, s54, 0
  s_add_u32 s66, s70, s54
  v_mov_b32 v8, s66
  v_mov_b32 v1, 61704
  ds_write_b32 v1, v8
  s_bitcmp1_b32 s96, 6
  s_cbranch_scc1 L_h_skipa
  s_add_u32 s70, s62, 8
  s_load_dwordx2 s[74:75], s[80:81], s70
  s_waitcnt lgkmcnt(0)
  s_cmp_lg_u64 s[74:75], 0
  s_cbranch_scc1 L_h_gotnonce
  s_atomic_or_x2 s[74:75], s[80:81], s70 glc
  s_waitcnt lgkmcnt(0)
L_h_gotnonce:
  s_lshl_b32 s62, s2, 8
  s_add_u32 s62, s62, 7340032
  s_xor_b32 s63, s62, 1024
  s_lshr_b32 s58, s96, 3
  s_xor_b32 s58, s58, s96
  s_lshr_b32 s70, s5, 4
  s_lshr_b32 s44, s70, 5
  s_lshl_b32 s44, s44, 21
  s_add_u32 s44, s44, 8388608
  s_and_b32 s64, s70, 31
  s_add_u32 s70, s64, s4
  s_lshl_b32 s70, s70, 10
  s_add_u32 s60, s44, s70
  s_xor_b32 s61, s60, 1024
  v_mov_b32 v1, 61712
L_h_proga:
  s_sleep 32
  ds_read_b128 v[8:11], v1
  s_waitcnt lgkmcnt(0)
  v_min_u32 v8, v8, v9
  s_nop 0
  v_readfirstlane_b32 s54, v8
  s_nop 1
  s_cmp_lt_u32 s54, 64
  s_cbranch_scc1 L_h_proga
  ds_read_b128 v[8:11], v3 offset:0
  ds_read_b128 v[12:15], v3 offset:1024
  ds_read_b128 v[16:19], v3 offset:2048
  ds_read_b128 v[20:23], v3 offset:3072
  ds_read_b128 v[24:27], v3 offset:4096
  ds_read_b128 v[28:31], v3 offset:5120
  s_waitcnt lgkmcnt(0)
  s_xor_b32 s70, s60, 0
  buffer_store_dwordx4 v[8:11], v3, s[40:43], s70 offen sc1
  s_xor_b32 s70, s60, 32768
  buffer_store_dwordx4 v[12:15], v3, s[40:43], s70 offen sc1
  s_xor_b32 s70, s60, 65536
  buffer_store_dwordx4 v[16:19], v3, s[40:43], s70 offen sc1
  s_xor_b32 s70, s60, 98304
  buffer_store_dwordx4 v[20:23], v3, s[40:43], s70 offen sc1
  s_xor_b32 s70, s60, 132096
  buffer_store_dwordx4 v[24:27], v3, s[40:43], s70 offen sc1
  s_xor_b32 s70, s60, 164864
  buffer_store_dwordx4 v[28:31], v3, s[40:43], s70 offen sc1
  s_bitcmp0_b32 s58, 0
  s_cbranch_scc1 L_h_e0
  ds_read_b128 v[32:35], v3 offset:6144
  ds_read_b128 v[36:39], v3 offset:7168
  ds_read_b128 v[40:43], v3 offset:8192
  ds_read_b128 v[44:47], v3 offset:9216
  ds_read_b128 v[48:51], v3 offset:10240
  ds_read_b128 v[52:55], v3 offset:11264
  s_waitcnt lgkmcnt(0)
  s_xor_b32 s70, s60, 197632
  buffer_store_dwordx4 v[32:35], v3, s[40:43], s70 offen sc1
  s_xor_b32 s70, s60, 230400
  buffer_store_dwordx4 v[36:39], v3, s[40:43], s70 offen sc1
  s_xor_b32 s70, s60, 264192
  buffer_store_dwordx4 v[40:43], v3, s[40:43], s70 offen sc1
  s_xor_b32 s70, s60, 296960
  buffer_store_dwordx4 v[44:47], v3, s[40:43], s70 offen sc1
  s_xor_b32 s70, s60, 329728
  buffer_store_dwordx4 v[48:51], v3, s[40:43], s70 offen sc1
  s_xor_b32 s70, s60, 362496
  buffer_store_dwordx4 v[52:55], v3, s[40:43], s70 offen sc1
L_h_e0:
  s_bitcmp0_b32 s58, 1
  s_cbranch_scc1 L_h_e1
  ds_read_b128 v[56:59], v3 offset:12288
  ds_read_b128 v[60:63], v3 offset:13312
  ds_read_b128 v[64:67], v3 offset:14336
  ds_read_b128 v[68:71], v3 offset:15360
  ds_read_b128 v[72:75], v3 offset:16384
  ds_read_b128 v[76:79], v3 offset:17408
  ds_read_b128 v[80:83], v3 offset:18432
  ds_read_b128 v[84:87], v3 offset:19456
  ds_read_b128 v[88:91], v3 offset:20480
  ds_read_b128 v[92:95], v3 offset:21504
  ds_read_b128 v[96:99], v3 offset:22528
  ds_read_b128 v[100:103], v3 offset:23552
  s_waitcnt lgkmcnt(0)
  s_xor_b32 s70, s60, 396288
  buffer_store_dwordx4 v[56:59], v3, s[40:43], s70 offen sc1
  s_xor_b32 s70, s60, 429056
  buffer_store_dwordx4 v[60:63], v3, s[40:43], s70 offen sc1
  s_xor_b32 s70, s60, 461824
  buffer_store_dwordx4 v[64:67], v3, s[40:43], s70 offen sc1
  s_xor_b32 s70, s60, 494592
  buffer_store_dwordx4 v[68:71], v3, s[40:43], s70 offen sc1
  s_xor_b32 s70, s60, 541696
  buffer_store_dwordx4 v[72:75], v3, s[40:43], s70 offen sc1
  s_xor_b32 s70, s60, 574464
  buffer_store_dwordx4 v[76:79], v3, s[40:43], s70 offen sc1
  s_xor_b32 s70, s60, 607232
  buffer_store_dwordx4 v[80:83], v3, s[40:43], s70 offen sc1
  s_xor_b32 s70, s60, 640000
  buffer_store_dwordx4 v[84:87], v3, s[40:43], s70 offen sc1
  s_xor_b32 s70, s60, 671744
  buffer_store_dwordx4 v[88:91], v3, s[40:43], s70 offen sc1
  s_xor_b32 s70, s60, 704512
  buffer_store_dwordx4 v[92:95], v3, s[40:43], s70 offen sc1
  s_xor_b32 s70, s60, 737280
  buffer_store_dwordx4 v[96:99], v3, s[40:43], s70 offen sc1
  s_xor_b32 s70, s60, 770048
  buffer_store_dwordx4 v[100:103], v3, s[40:43], s70 offen sc1
L_h_e1:
  s_add_u32 s54, s74, 1
  v_mov_b32 v5, 0
  s_waitcnt vmcnt(0)
  v_mov_b32 v8, s54
  v_mov_b32 v9, s75
  s_mov_b64 exec, 1
  buffer_store_dwordx2 v[8:9], v5, s[40:43], s62 offen sc1
  s_mov_b32 s59, 0
L_h_flaga:
  buffer_load_dwordx2 v[10:11], v5, s[40:43], s63 offen sc1
  s_waitcnt vmcnt(0)
  v_readfirstlane_b32 s56, v10
  v_readfirstlane_b32 s57, v11
  s_nop 0
  s_sub_u32 s56, s56, s54
  s_xor_b32 s57, s57, s75
  s_lshr_b32 s56, s56, 1
  s_or_b32 s56, s56, s57
  s_cbranch_scc0 L_h_flaga_done
  s_add_u32 s59, s59, 1
  s_cmp_gt_u32 s59, 2000
  s_cbranch_scc1 L_h_flaga_done
  s_sleep 32
  s_branch L_h_flaga
L_h_flaga_done:
  s_mov_b64 exec, -1
  s_bfe_u32 s54, s96, 0x10003
  s_mul_i32 s54, s54, 384
  v_lshrrev_b32 v4, 3, v0
  v_add_u32 v5, 0, v4
  v_mul_u32_u24 v5, 21846, v5
  v_bfe_u32 v5, v5, 16, 1
  v_mul_u32_u24 v6, 384, v5
  v_sub_u32 v6, v3, v6
  v_add_u32 v6, s54, v6
  v_add_u32 v6, 0, v6
  v_add_u32 v5, s64, v5
  v_lshrrev_b32 v2, 12, v6
  v_xor_b32 v5, v5, v2
  v_lshrrev_b32 v2, 10, v6
  v_lshl_add_u32 v5, v2, 5, v5
  v_and_b32 v6, 1023, v6
  v_lshl_add_u32 v5, v5, 10, v6
  buffer_load_dwordx4 v[8:11], v5, s[40:43], s44 offen sc1
  v_add_u32 v5, 8, v4
  v_mul_u32_u24 v5, 21846, v5
  v_bfe_u32 v5, v5, 16, 1
  v_mul_u32_u24 v6, 384, v5
  v_sub_u32 v6, v3, v6
  v_add_u32 v6, s54, v6
  v_add_u32 v6, 1024, v6
  v_add_u32 v5, s64, v5
  v_lshrrev_b32 v2, 12, v6
  v_xor_b32 v5, v5, v2
  v_lshrrev_b32 v2, 10, v6
  v_lshl_add_u32 v5, v2, 5, v5
  v_and_b32 v6, 1023, v6
  v_lshl_add_u32 v5, v5, 10, v6
  buffer_load_dwordx4 v[12:15], v5, s[40:43], s44 offen sc1
  v_add_u32 v5, 16, v4
  v_mul_u32_u24 v5, 21846, v5
  v_bfe_u32 v5, v5, 16, 1
  v_mul_u32_u24 v6, 384, v5
  v_sub_u32 v6, v3, v6
  v_add_u32 v6, s54, v6
  v_add_u32 v6, 2048, v6
  v_add_u32 v5, s64, v5
  v_lshrrev_b32 v2, 12, v6
  v_xor_b32 v5, v5, v2
  v_lshrrev_b32 v2, 10, v6
  v_lshl_add_u32 v5, v2, 5, v5
  v_and_b32 v6, 1023, v6
  v_lshl_add_u32 v5, v5, 10, v6
  buffer_load_dwordx4 v[16:19], v5, s[40:43], s44 offen sc1
  v_add_u32 v5, 24, v4
  v_mul_u32_u24 v5, 21846, v5
  v_bfe_u32 v5, v5, 16, 1
  v_mul_u32_u24 v6, 384, v5
  v_sub_u32 v6, v3, v6
  v_add_u32 v6, s54, v6
  v_add_u32 v6, 3072, v6
  v_add_u32 v5, s64, v5
  v_lshrrev_b32 v2, 12, v6
  v_xor_b32 v5, v5, v2
  v_lshrrev_b32 v2, 10, v6
  v_lshl_add_u32 v5, v2, 5, v5
  v_and_b32 v6, 1023, v6
  v_lshl_add_u32 v5, v5, 10, v6
  buffer_load_dwordx4 v[20:23], v5, s[40:43], s44 offen sc1
  v_add_u32 v5, 32, v4
  v_mul_u32_u24 v5, 21846, v5
  v_bfe_u32 v5, v5, 16, 1
  v_mul_u32_u24 v6, 384, v5
  v_sub_u32 v6, v3, v6
  v_add_u32 v6, s54, v6
  v_add_u32 v6, 4096, v6
  v_add_u32 v5, s64, v5
  v_lshrrev_b32 v2, 12, v6
  v_xor_b32 v5, v5, v2
  v_lshrrev_b32 v2, 10, v6
  v_lshl_add_u32 v5, v2, 5, v5
  v_and_b32 v6, 1023, v6
  v_lshl_add_u32 v5, v5, 10, v6
  buffer_load_dwordx4 v[24:27], v5, s[40:43], s44 offen sc1
  v_add_u32 v5, 40, v4
  v_mul_u32_u24 v5, 21846, v5
  v_bfe_u32 v5, v5, 16, 1
  v_mul_u32_u24 v6, 384, v5
  v_sub_u32 v6, v3, v6
  v_add_u32 v6, s54, v6
  v_add_u32 v6, 5120, v6
  v_add_u32 v5, s64, v5
  v_lshrrev_b32 v2, 12, v6
  v_xor_b32 v5, v5, v2
  v_lshrrev_b32 v2, 10, v6
  v_lshl_add_u32 v5, v2, 5, v5
  v_and_b32 v6, 1023, v6
  v_lshl_add_u32 v5, v5, 10, v6
  buffer_load_dwordx4 v[28:31], v5, s[40:43], s44 offen sc1
  s_waitcnt vmcnt(0)
  ds_write_b128 v3, v[8:11] offset:0
  ds_write_b128 v3, v[12:15] offset:1024
  ds_write_b128 v3, v[16:19] offset:2048
  ds_write_b128 v3, v[20:23] offset:3072
  ds_write_b128 v3, v[24:27] offset:4096
  ds_write_b128 v3, v[28:31] offset:5120
  s_bitcmp0_b32 s58, 0
  s_cbranch_scc1 L_h_i0
  s_xor_b32 s70, s61, 197632
  buffer_load_dwordx4 v[32:35], v3, s[40:43], s70 offen sc1
  s_xor_b32 s70, s61, 230400
  buffer_load_dwordx4 v[36:39], v3, s[40:43], s70 offen sc1
  s_xor_b32 s70, s61, 264192
  buffer_load_dwordx4 v[40:43], v3, s[40:43], s70 offen sc1
  s_xor_b32 s70, s61, 296960
  buffer_load_dwordx4 v[44:47], v3, s[40:43], s70 offen sc1
  s_xor_b32 s70, s61, 329728
  buffer_load_dwordx4 v[48:51], v3, s[40:43], s70 offen sc1
  s_xor_b32 s70, s61, 362496
  buffer_load_dwordx4 v[52:55], v3, s[40:43], s70 offen sc1
  s_waitcnt vmcnt(0)
  ds_write_b128 v3, v[32:35] offset:6144
  ds_write_b128 v3, v[36:39] offset:7168
  ds_write_b128 v3, v[40:43] offset:8192
  ds_write_b128 v3, v[44:47] offset:9216
  ds_write_b128 v3, v[48:51] offset:10240
  ds_write_b128 v3, v[52:55] offset:11264
L_h_i0:
  s_bitcmp0_b32 s58, 1
  s_cbranch_scc1 L_h_i1
  s_xor_b32 s70, s61, 396288
  buffer_load_dwordx4 v[56:59], v3, s[40:43], s70 offen sc1
  s_xor_b32 s70, s61, 429056
  buffer_load_dwordx4 v[60:63], v3, s[40:43], s70 offen sc1
  s_xor_b32 s70, s61, 461824
  buffer_load_dwordx4 v[64:67], v3, s[40:43], s70 offen sc1
  s_xor_b32 s70, s61, 494592
  buffer_load_dwordx4 v[68:71], v3, s[40:43], s70 offen sc1
  s_xor_b32 s70, s61, 541696
  buffer_load_dwordx4 v[72:75], v3, s[40:43], s70 offen sc1
  s_xor_b32 s70, s61, 574464
  buffer_load_dwordx4 v[76:79], v3, s[40:43], s70 offen sc1
  s_xor_b32 s70, s61, 607232
  buffer_load_dwordx4 v[80:83], v3, s[40:43], s70 offen sc1
  s_xor_b32 s70, s61, 640000
  buffer_load_dwordx4 v[84:87], v3, s[40:43], s70 offen sc1
  s_xor_b32 s70, s61, 671744
  buffer_load_dwordx4 v[88:91], v3, s[40:43], s70 offen sc1
  s_xor_b32 s70, s61, 704512
  buffer_load_dwordx4 v[92:95], v3, s[40:43], s70 offen sc1
  s_xor_b32 s70, s61, 737280
  buffer_load_dwordx4 v[96:99], v3, s[40:43], s70 offen sc1
  s_xor_b32 s70, s61, 770048
  buffer_load_dwordx4 v[100:103], v3, s[40:43], s70 offen sc1
  s_waitcnt vmcnt(0)
  ds_write_b128 v3, v[56:59] offset:12288
  ds_write_b128 v3, v[60:63] offset:13312
  ds_write_b128 v3, v[64:67] offset:14336
  ds_write_b128 v3, v[68:71] offset:15360
  ds_write_b128 v3, v[72:75] offset:16384
  ds_write_b128 v3, v[76:79] offset:17408
  ds_write_b128 v3, v[80:83] offset:18432
  ds_write_b128 v3, v[84:87] offset:19456
  ds_write_b128 v3, v[88:91] offset:20480
  ds_write_b128 v3, v[92:95] offset:21504
  ds_write_b128 v3, v[96:99] offset:22528
  ds_write_b128 v3, v[100:103] offset:23552
L_h_i1:
L_h_skipa:
  s_lshr_b32 s70, s96, 4
  s_andn2_b32 s58, s58, s70
  s_bitcmp0_b32 s58, 2
  s_cselect_b32 s70, 255, 64
  v_mov_b32 v1, 61700
  v_mov_b32 v5, s70
  ds_write_b32 v1, v5
  v_mov_b32 v1, 61712
L_h_progc2_0:
  s_sleep 8
  ds_read_b128 v[8:11], v1
  s_waitcnt lgkmcnt(0)
  v_min_u32 v8, v8, v9
  s_nop 0
  v_readfirstlane_b32 s54, v8
  s_nop 1
  s_cmp_lt_u32 s54, 76
  s_cbranch_scc1 L_h_progc2_0
  s_memrealtime s[54:55]
  s_waitcnt lgkmcnt(0)
  s_sub_u32 s65, s54, s72
  s_and_b32 s70, s2, 0x78
  s_cbranch_scc1 L_h_np2
  v_mov_b32 v8, s54
  v_mov_b32 v9, s55
  s_mov_b32 s70, 6291968
  s_mov_b64 exec, 1
  buffer_store_dwordx2 v[8:9], v104, s[40:43], s70 offen sc1
  s_mov_b64 exec, -1
L_h_np2:
  v_mov_b32 v1, 61712
L_h_progc2_1:
  s_sleep 8
  ds_read_b128 v[8:11], v1
  s_waitcnt lgkmcnt(0)
  v_min_u32 v8, v8, v9
  s_nop 0
  v_readfirstlane_b32 s54, v8
  s_nop 1
  s_cmp_lt_u32 s54, 84
  s_cbranch_scc1 L_h_progc2_1
  s_mov_b32 s70, 6291968
  buffer_load_dwordx2 v[8:9], v105, s[40:43], s70 offen
  v_mov_b32 v10, s73
  s_waitcnt vmcnt(0)
  v_subrev_co_u32 v8, vcc, s72, v8
  s_nop 1
  v_subb_co_u32 v9, vcc, v9, v10, vcc
  v_lshrrev_b32 v10, 24, v8
  v_or_b32 v9, v9, v10
  v_cmp_eq_u32 vcc, 0, v9
  s_nop 1
  v_cndmask_b32 v8, 0, v8, vcc
  s_and_b32 s56, vcc_lo, 0xffff
  s_bcnt1_i32_b32 s56, s56
  v_add_u32_dpp v8, v8, v8 row_ror:8 row_mask:0xf bank_mask:0xf
  s_nop 1
  v_add_u32_dpp v8, v8, v8 row_ror:4 row_mask:0xf bank_mask:0xf
  s_nop 1
  v_add_u32_dpp v8, v8, v8 row_ror:2 row_mask:0xf bank_mask:0xf
  s_nop 1
  v_add_u32_dpp v8, v8, v8 row_ror:1 row_mask:0xf bank_mask:0xf
  s_nop 0
  v_readfirstlane_b32 s54, v8
  s_sub_u32 s70, s65, 0
  s_mul_i32 s70, s70, s56
  s_sub_i32 s54, s70, s54
  s_max_i32 s54, s54, 0
  s_max_u32 s56, s56, 1
  s_mul_i32 s56, s56, 22
  v_cvt_f32_u32 v8, s56
  v_cvt_f32_u32 v9, s54
  v_rcp_f32 v8, v8
  s_nop 0
  v_fma_f32 v8, v8, v9, 0.5
  v_cvt_u32_f32 v8, v8
  v_min_u32 v8, 64, v8
  s_nop 0
  v_readfirstlane_b32 s54, v8
  s_nop 1
  s_mul_i32 s54, s54, 2
  s_sub_i32 s70, s66, 76
  s_max_i32 s70, s70, 0
  s_min_i32 s70, s70, 10
  s_sub_i32 s54, s54, s70
  s_cmp_gt_i32 s54, 0
  s_cselect_b32 s70, 86, 0
  s_cselect_b32 s54, s54, 0
  s_add_u32 s66, s70, s54
  v_mov_b32 v8, s66
  v_mov_b32 v1, 61704
  ds_write_b32 v1, v8
  s_bitcmp0_b32 s58, 2
  s_cbranch_scc1 L_h_all
  v_mov_b32 v1, 61712
L_h_progb:
  s_sleep 32
  ds_read_b128 v[8:11], v1
  s_waitcnt lgkmcnt(0)
  v_min_u32 v8, v8, v9
  s_nop 0
  v_readfirstlane_b32 s54, v8
  s_nop 1
  s_cmp_lt_u32 s54, 96
  s_cbranch_scc1 L_h_progb
  ds_read_b128 v[8:11], v3 offset:24576
  ds_read_b128 v[12:15], v3 offset:25600
  ds_read_b128 v[16:19], v3 offset:26624
  ds_read_b128 v[20:23], v3 offset:27648
  ds_read_b128 v[24:27], v3 offset:28672
  ds_read_b128 v[28:31], v3 offset:29696
  ds_read_b128 v[32:35], v3 offset:30720
  ds_read_b128 v[36:39], v3 offset:31744
  ds_read_b128 v[40:43], v3 offset:32768
  ds_read_b128 v[44:47], v3 offset:33792
  ds_read_b128 v[48:51], v3 offset:34816
  ds_read_b128 v[52:55], v3 offset:35840
  s_waitcnt lgkmcnt(0)
  s_xor_b32 s70, s60, 805888
  buffer_store_dwordx4 v[8:11], v3, s[40:43], s70 offen sc1
  s_xor_b32 s70, s60, 838656
  buffer_store_dwordx4 v[12:15], v3, s[40:43], s70 offen sc1
  s_xor_b32 s70, s60, 871424
  buffer_store_dwordx4 v[16:19], v3, s[40:43], s70 offen sc1
  s_xor_b32 s70, s60, 904192
  buffer_store_dwordx4 v[20:23], v3, s[40:43], s70 offen sc1
  s_xor_b32 s70, s60, 935936
  buffer_store_dwordx4 v[24:27], v3, s[40:43], s70 offen sc1
  s_xor_b32 s70, s60, 968704
  buffer_store_dwordx4 v[28:31], v3, s[40:43], s70 offen sc1
  s_xor_b32 s70, s60, 1001472
  buffer_store_dwordx4 v[32:35], v3, s[40:43], s70 offen sc1
  s_xor_b32 s70, s60, 1034240
  buffer_store_dwordx4 v[36:39], v3, s[40:43], s70 offen sc1
  s_xor_b32 s70, s60, 1052672
  buffer_store_dwordx4 v[40:43], v3, s[40:43], s70 offen sc1
  s_xor_b32 s70, s60, 1085440
  buffer_store_dwordx4 v[44:47], v3, s[40:43], s70 offen sc1
  s_xor_b32 s70, s60, 1118208
  buffer_store_dwordx4 v[48:51], v3, s[40:43], s70 offen sc1
  s_xor_b32 s70, s60, 1150976
  buffer_store_dwordx4 v[52:55], v3, s[40:43], s70 offen sc1
  s_add_u32 s54, s74, 2
  v_mov_b32 v5, 0
  s_waitcnt vmcnt(0)
  v_mov_b32 v8, s54
  v_mov_b32 v9, s75
  s_mov_b64 exec, 1
  buffer_store_dwordx2 v[8:9], v5, s[40:43], s62 offen sc1
  s_mov_b32 s59, 0
L_h_flagb:
  buffer_load_dwordx2 v[10:11], v5, s[40:43], s63 offen sc1
  s_waitcnt vmcnt(0)
  v_readfirstlane_b32 s56, v10
  v_readfirstlane_b32 s57, v11
  s_nop 0
  s_sub_u32 s56, s56, s54
  s_xor_b32 s57, s57, s75
  s_lshr_b32 s56, s56, 1
  s_or_b32 s56, s56, s57
  s_cbranch_scc0 L_h_flagb_done
  s_add_u32 s59, s59, 1
  s_cmp_gt_u32 s59, 2000
  s_cbranch_scc1 L_h_flagb_done
  s_sleep 32
  s_branch L_h_flagb
L_h_flagb_done:
  s_mov_b64 exec, -1
  s_xor_b32 s70, s61, 805888
  buffer_load_dwordx4 v[8:11], v3, s[40:43], s70 offen sc1
  s_xor_b32 s70, s61, 838656
  buffer_load_dwordx4 v[12:15], v3, s[40:43], s70 offen sc1
  s_xor_b32 s70, s61, 871424
  buffer_load_dwordx4 v[16:19], v3, s[40:43], s70 offen sc1
  s_xor_b32 s70, s61, 904192
  buffer_load_dwordx4 v[20:23], v3, s[40:43], s70 offen sc1
  s_xor_b32 s70, s61, 935936
  buffer_load_dwordx4 v[24:27], v3, s[40:43], s70 offen sc1
  s_xor_b32 s70, s61, 968704
  buffer_load_dwordx4 v[28:31], v3, s[40:43], s70 offen sc1
  s_xor_b32 s70, s61, 1001472
  buffer_load_dwordx4 v[32:35], v3, s[40:43], s70 offen sc1
  s_xor_b32 s70, s61, 1034240
  buffer_load_dwordx4 v[36:39], v3, s[40:43], s70 offen sc1
  s_xor_b32 s70, s61, 1052672
  buffer_load_dwordx4 v[40:43], v3, s[40:43], s70 offen sc1
  s_xor_b32 s70, s61, 1085440
  buffer_load_dwordx4 v[44:47], v3, s[40:43], s70 offen sc1
  s_xor_b32 s70, s61, 1118208
  buffer_load_dwordx4 v[48:51], v3, s[40:43], s70 offen sc1
  s_xor_b32 s70, s61, 1150976
  buffer_load_dwordx4 v[52:55], v3, s[40:43], s70 offen sc1
  s_waitcnt vmcnt(0)
  ds_write_b128 v3, v[8:11] offset:24576
  ds_write_b128 v3, v[12:15] offset:25600
  ds_write_b128 v3, v[16:19] offset:26624
  ds_write_b128 v3, v[20:23] offset:27648
  ds_write_b128 v3, v[24:27] offset:28672
  ds_write_b128 v3, v[28:31] offset:29696
  ds_write_b128 v3, v[32:35] offset:30720
  ds_write_b128 v3, v[36:39] offset:31744
  ds_write_b128 v3, v[40:43] offset:32768
  ds_write_b128 v3, v[44:47] offset:33792
  ds_write_b128 v3, v[48:51] offset:34816
  ds_write_b128 v3, v[52:55] offset:35840
  v_mov_b32 v1, 61700
  v_mov_b32 v5, 255
  ds_write_b32 v1, v5
L_h_all:
  v_mov_b32 v1, 61712
L_h_progc3_0:
  s_sleep 8
  ds_read_b128 v[8:11], v1
  s_waitcnt lgkmcnt(0)
  v_min_u32 v8, v8, v9
  s_nop 0
  v_readfirstlane_b32 s54, v8
  s_nop 1
  s_cmp_lt_u32 s54, 108
  s_cbranch_scc1 L_h_progc3_0
  s_memrealtime s[54:55]
  s_waitcnt lgkmcnt(0)
  s_sub_u32 s65, s54, s72
  s_and_b32 s70, s2, 0x78
  s_cbranch_scc1 L_h_np3
  v_mov_b32 v8, s54
  v_mov_b32 v9, s55
  s_mov_b32 s70, 6292224
  s_mov_b64 exec, 1
  buffer_store_dwordx2 v[8:9], v104, s[40:43], s70 offen sc1
  s_mov_b64 exec, -1
L_h_np3:
  v_mov_b32 v1, 61712
L_h_progc3_1:
  s_sleep 8
  ds_read_b128 v[8:11], v1
  s_waitcnt lgkmcnt(0)
  v_min_u32 v8, v8, v9
  s_nop 0
  v_readfirstlane_b32 s54, v8
  s_nop 1
  s_cmp_lt_u32 s54, 116
  s_cbranch_scc1 L_h_progc3_1
  s_mov_b32 s70, 6292224
  buffer_load_dwordx2 v[8:9], v105, s[40:43], s70 offen
  v_mov_b32 v10, s73
  s_waitcnt vmcnt(0)
  v_subrev_co_u32 v8, vcc, s72, v8
  s_nop 1
  v_subb_co_u32 v9, vcc, v9, v10, vcc
  v_lshrrev_b32 v10, 24, v8
  v_or_b32 v9, v9, v10
  v_cmp_eq_u32 vcc, 0, v9
  s_nop 1
  v_cndmask_b32 v8, 0, v8, vcc
  s_and_b32 s56, vcc_lo, 0xffff
  s_bcnt1_i32_b32 s56, s56
  v_add_u32_dpp v8, v8, v8 row_ror:8 row_mask:0xf bank_mask:0xf
  s_nop 1
  v_add_u32_dpp v8, v8, v8 row_ror:4 row_mask:0xf bank_mask:0xf
  s_nop 1
  v_add_u32_dpp v8, v8, v8 row_ror:2 row_mask:0xf bank_mask:0xf
  s_nop 1
  v_add_u32_dpp v8, v8, v8 row_ror:1 row_mask:0xf bank_mask:0xf
  s_nop 0
  v_readfirstlane_b32 s54, v8
  s_sub_u32 s70, s65, 0
  s_mul_i32 s70, s70, s56
  s_sub_i32 s54, s70, s54
  s_max_i32 s54, s54, 0
  s_max_u32 s56, s56, 1
  s_mul_i32 s56, s56, 22
  v_cvt_f32_u32 v8, s56
  v_cvt_f32_u32 v9, s54
  v_rcp_f32 v8, v8
  s_nop 0
  v_fma_f32 v8, v8, v9, 0.5
  v_cvt_u32_f32 v8, v8
  v_min_u32 v8, 64, v8
  s_nop 0
  v_readfirstlane_b32 s54, v8
  s_nop 1
  s_mul_i32 s54, s54, 2
  s_sub_i32 s70, s66, 108
  s_max_i32 s70, s70, 0
  s_min_i32 s70, s70, 10
  s_sub_i32 s54, s54, s70
  s_cmp_gt_i32 s54, 0
  s_cselect_b32 s70, 118, 0
  s_cselect_b32 s54, s54, 0
  s_add_u32 s66, s70, s54
  v_mov_b32 v8, s66
  v_mov_b32 v1, 61704
  ds_write_b32 v1, v8
  v_mov_b32 v1, 61712
L_h_progc4_0:
  s_sleep 8
  ds_read_b128 v[8:11], v1
  s_waitcnt lgkmcnt(0)
  v_min_u32 v8, v8, v9
  s_nop 0
  v_readfirstlane_b32 s54, v8
  s_nop 1
  s_cmp_lt_u32 s54, 124
  s_cbranch_scc1 L_h_progc4_0
  s_memrealtime s[54:55]
  s_waitcnt lgkmcnt(0)
  s_sub_u32 s65, s54, s72
  s_and_b32 s70, s2, 0x78
  s_cbranch_scc1 L_h_np4
  v_mov_b32 v8, s54
  v_mov_b32 v9, s55
  s_mov_b32 s70, 6292480
  s_mov_b64 exec, 1
  buffer_store_dwordx2 v[8:9], v104, s[40:43], s70 offen sc1
  s_mov_b64 exec, -1
L_h_np4:
  v_mov_b32 v1, 61712
L_h_progc4_1:
  s_sleep 8
  ds_read_b128 v[8:11], v1
  s_waitcnt lgkmcnt(0)
  v_min_u32 v8, v8, v9
  s_nop 0
  v_readfirstlane_b32 s54, v8
  s_nop 1
  s_cmp_lt_u32 s54, 132
  s_cbranch_scc1 L_h_progc4_1
  s_mov_b32 s70, 6292480
  buffer_load_dwordx2 v[8:9], v105, s[40:43], s70 offen
  v_mov_b32 v10, s73
  s_waitcnt vmcnt(0)
  v_subrev_co_u32 v8, vcc, s72, v8
  s_nop 1
  v_subb_co_u32 v9, vcc, v9, v10, vcc
  v_lshrrev_b32 v10, 24, v8
  v_or_b32 v9, v9, v10
  v_cmp_eq_u32 vcc, 0, v9
  s_nop 1
  v_cndmask_b32 v8, 0, v8, vcc
  s_and_b32 s56, vcc_lo, 0xffff
  s_bcnt1_i32_b32 s56, s56
  v_add_u32_dpp v8, v8, v8 row_ror:8 row_mask:0xf bank_mask:0xf
  s_nop 1
  v_add_u32_dpp v8, v8, v8 row_ror:4 row_mask:0xf bank_mask:0xf
  s_nop 1
  v_add_u32_dpp v8, v8, v8 row_ror:2 row_mask:0xf bank_mask:0xf
  s_nop 1
  v_add_u32_dpp v8, v8, v8 row_ror:1 row_mask:0xf bank_mask:0xf
  s_nop 0
  v_readfirstlane_b32 s54, v8
  s_sub_u32 s70, s65, 0
  s_mul_i32 s70, s70, s56
  s_sub_i32 s54, s70, s54
  s_max_i32 s54, s54, 0
  s_max_u32 s56, s56, 1
  s_mul_i32 s56, s56, 22
  v_cvt_f32_u32 v8, s56
  v_cvt_f32_u32 v9, s54
  v_rcp_f32 v8, v8
  s_nop 0
  v_fma_f32 v8, v8, v9, 0.5
  v_cvt_u32_f32 v8, v8
  v_min_u32 v8, 64, v8
  s_nop 0
  v_readfirstlane_b32 s54, v8
  s_nop 1
  s_mul_i32 s54, s54, 2
  s_sub_i32 s70, s66, 124
  s_max_i32 s70, s70, 0
  s_min_i32 s70, s70, 10
  s_sub_i32 s54, s54, s70
  s_cmp_gt_i32 s54, 0
  s_cselect_b32 s70, 134, 0
  s_cselect_b32 s54, s54, 0
  s_add_u32 s66, s70, s54
  v_mov_b32 v8, s66
  v_mov_b32 v1, 61704
  ds_write_b32 v1, v8
  v_mov_b32 v1, 61712
L_h_progc5_0:
  s_sleep 8
  ds_read_b128 v[8:11], v1
  s_waitcnt lgkmcnt(0)
  v_min_u32 v8, v8, v9
  s_nop 0
  v_readfirstlane_b32 s54, v8
  s_nop 1
  s_cmp_lt_u32 s54, 140
  s_cbranch_scc1 L_h_progc5_0
  s_memrealtime s[54:55]
  s_waitcnt lgkmcnt(0)
  s_sub_u32 s65, s54, s72
  s_and_b32 s70, s2, 0x78
  s_cbranch_scc1 L_h_np5
  v_mov_b32 v8, s54
  v_mov_b32 v9, s55
  s_mov_b32 s70, 6292736
  s_mov_b64 exec, 1
  buffer_store_dwordx2 v[8:9], v104, s[40:43], s70 offen sc1
  s_mov_b64 exec, -1
L_h_np5:
  v_mov_b32 v1, 61712
L_h_progc5_1:
  s_sleep 8
  ds_read_b128 v[8:11], v1
  s_waitcnt lgkmcnt(0)
  v_min_u32 v8, v8, v9
  s_nop 0
  v_readfirstlane_b32 s54, v8
  s_nop 1
  s_cmp_lt_u32 s54, 148
  s_cbranch_scc1 L_h_progc5_1
  s_mov_b32 s70, 6292736
  buffer_load_dwordx2 v[8:9], v105, s[40:43], s70 offen
  v_mov_b32 v10, s73
  s_waitcnt vmcnt(0)
  v_subrev_co_u32 v8, vcc, s72, v8
  s_nop 1
  v_subb_co_u32 v9, vcc, v9, v10, vcc
  v_lshrrev_b32 v10, 24, v8
  v_or_b32 v9, v9, v10
  v_cmp_eq_u32 vcc, 0, v9
  s_nop 1
  v_cndmask_b32 v8, 0, v8, vcc
  s_and_b32 s56, vcc_lo, 0xffff
  s_bcnt1_i32_b32 s56, s56
  v_add_u32_dpp v8, v8, v8 row_ror:8 row_mask:0xf bank_mask:0xf
  s_nop 1
  v_add_u32_dpp v8, v8, v8 row_ror:4 row_mask:0xf bank_mask:0xf
  s_nop 1
  v_add_u32_dpp v8, v8, v8 row_ror:2 row_mask:0xf bank_mask:0xf
  s_nop 1
  v_add_u32_dpp v8, v8, v8 row_ror:1 row_mask:0xf bank_mask:0xf
  s_nop 0
  v_readfirstlane_b32 s54, v8
  s_sub_u32 s70, s65, 0
  s_mul_i32 s70, s70, s56
  s_sub_i32 s54, s70, s54
  s_max_i32 s54, s54, 0
  s_max_u32 s56, s56, 1
  s_mul_i32 s56, s56, 22
  v_cvt_f32_u32 v8, s56
  v_cvt_f32_u32 v9, s54
  v_rcp_f32 v8, v8
  s_nop 0
  v_fma_f32 v8, v8, v9, 0.5
  v_cvt_u32_f32 v8, v8
  v_min_u32 v8, 64, v8
  s_nop 0
  v_readfirstlane_b32 s54, v8
  s_nop 1
  s_mul_i32 s54, s54, 2
  s_sub_i32 s70, s66, 140
  s_max_i32 s70, s70, 0
  s_min_i32 s70, s70, 10
  s_sub_i32 s54, s54, s70
  s_cmp_gt_i32 s54, 0
  s_cselect_b32 s70, 150, 0
  s_cselect_b32 s54, s54, 0
  s_add_u32 s66, s70, s54
  v_mov_b32 v8, s66
  v_mov_b32 v1, 61704
  ds_write_b32 v1, v8
  v_mov_b32 v1, 61712
L_h_progc6_0:
  s_sleep 8
  ds_read_b128 v[8:11], v1
  s_waitcnt lgkmcnt(0)
  v_min_u32 v8, v8, v9
  s_nop 0
  v_readfirstlane_b32 s54, v8
  s_nop 1
  s_cmp_lt_u32 s54, 156
  s_cbranch_scc1 L_h_progc6_0
  s_memrealtime s[54:55]
  s_waitcnt lgkmcnt(0)
  s_sub_u32 s65, s54, s72
  s_and_b32 s70, s2, 0x78
  s_cbranch_scc1 L_h_np6
  v_mov_b32 v8, s54
  v_mov_b32 v9, s55
  s_mov_b32 s70, 6292992
  s_mov_b64 exec, 1
  buffer_store_dwordx2 v[8:9], v104, s[40:43], s70 offen sc1
  s_mov_b64 exec, -1
L_h_np6:
  v_mov_b32 v1, 61712
L_h_progc6_1:
  s_sleep 8
  ds_read_b128 v[8:11], v1
  s_waitcnt lgkmcnt(0)
  v_min_u32 v8, v8, v9
  s_nop 0
  v_readfirstlane_b32 s54, v8
  s_nop 1
  s_cmp_lt_u32 s54, 164
  s_cbranch_scc1 L_h_progc6_1
  s_mov_b32 s70, 6292992
  buffer_load_dwordx2 v[8:9], v105, s[40:43], s70 offen
  v_mov_b32 v10, s73
  s_waitcnt vmcnt(0)
  v_subrev_co_u32 v8, vcc, s72, v8
  s_nop 1
  v_subb_co_u32 v9, vcc, v9, v10, vcc
  v_lshrrev_b32 v10, 24, v8
  v_or_b32 v9, v9, v10
  v_cmp_eq_u32 vcc, 0, v9
  s_nop 1
  v_cndmask_b32 v8, 0, v8, vcc
  s_and_b32 s56, vcc_lo, 0xffff
  s_bcnt1_i32_b32 s56, s56
  v_add_u32_dpp v8, v8, v8 row_ror:8 row_mask:0xf bank_mask:0xf
  s_nop 1
  v_add_u32_dpp v8, v8, v8 row_ror:4 row_mask:0xf bank_mask:0xf
  s_nop 1
  v_add_u32_dpp v8, v8, v8 row_ror:2 row_mask:0xf bank_mask:0xf
  s_nop 1
  v_add_u32_dpp v8, v8, v8 row_ror:1 row_mask:0xf bank_mask:0xf
  s_nop 0
  v_readfirstlane_b32 s54, v8
  s_sub_u32 s70, s65, 0
  s_mul_i32 s70, s70, s56
  s_sub_i32 s54, s70, s54
  s_max_i32 s54, s54, 0
  s_max_u32 s56, s56, 1
  s_mul_i32 s56, s56, 22
  v_cvt_f32_u32 v8, s56
  v_cvt_f32_u32 v9, s54
  v_rcp_f32 v8, v8
  s_nop 0
  v_fma_f32 v8, v8, v9, 0.5
  v_cvt_u32_f32 v8, v8
  v_min_u32 v8, 64, v8
  s_nop 0
  v_readfirstlane_b32 s54, v8
  s_nop 1
  s_mul_i32 s54, s54, 2
  s_sub_i32 s70, s66, 156
  s_max_i32 s70, s70, 0
  s_min_i32 s70, s70, 10
  s_sub_i32 s54, s54, s70
  s_cmp_gt_i32 s54, 0
  s_cselect_b32 s70, 166, 0
  s_cselect_b32 s54, s54, 0
  s_add_u32 s66, s70, s54
  v_mov_b32 v8, s66
  v_mov_b32 v1, 61704
  ds_write_b32 v1, v8
  v_mov_b32 v1, 61712
L_h_progc7_0:
  s_sleep 8
  ds_read_b128 v[8:11], v1
  s_waitcnt lgkmcnt(0)
  v_min_u32 v8, v8, v9
  s_nop 0
  v_readfirstlane_b32 s54, v8
  s_nop 1
  s_cmp_lt_u32 s54, 168
  s_cbranch_scc1 L_h_progc7_0
  s_memrealtime s[54:55]
  s_waitcnt lgkmcnt(0)
  s_sub_u32 s65, s54, s72
  s_and_b32 s70, s2, 0x78
  s_cbranch_scc1 L_h_np7
  v_mov_b32 v8, s54
  v_mov_b32 v9, s55
  s_mov_b32 s70, 6293248
  s_mov_b64 exec, 1
  buffer_store_dwordx2 v[8:9], v104, s[40:43], s70 offen sc1
  s_mov_b64 exec, -1
L_h_np7:
  v_mov_b32 v1, 61712
L_h_progc7_1:
  s_sleep 8
  ds_read_b128 v[8:11], v1
  s_waitcnt lgkmcnt(0)
  v_min_u32 v8, v8, v9
  s_nop 0
  v_readfirstlane_b32 s54, v8
  s_nop 1
  s_cmp_lt_u32 s54, 176
  s_cbranch_scc1 L_h_progc7_1
  s_mov_b32 s70, 6293248
  buffer_load_dwordx2 v[8:9], v105, s[40:43], s70 offen
  v_mov_b32 v10, s73
  s_waitcnt vmcnt(0)
  v_subrev_co_u32 v8, vcc, s72, v8
  s_nop 1
  v_subb_co_u32 v9, vcc, v9, v10, vcc
  v_lshrrev_b32 v10, 24, v8
  v_or_b32 v9, v9, v10
  v_cmp_eq_u32 vcc, 0, v9
  s_nop 1
  v_cndmask_b32 v8, 0, v8, vcc
  s_and_b32 s56, vcc_lo, 0xffff
  s_bcnt1_i32_b32 s56, s56
  v_add_u32_dpp v8, v8, v8 row_ror:8 row_mask:0xf bank_mask:0xf
  s_nop 1
  v_add_u32_dpp v8, v8, v8 row_ror:4 row_mask:0xf bank_mask:0xf
  s_nop 1
  v_add_u32_dpp v8, v8, v8 row_ror:2 row_mask:0xf bank_mask:0xf
  s_nop 1
  v_add_u32_dpp v8, v8, v8 row_ror:1 row_mask:0xf bank_mask:0xf
  s_nop 0
  v_readfirstlane_b32 s54, v8
  s_sub_u32 s70, s65, 0
  s_mul_i32 s70, s70, s56
  s_sub_i32 s54, s70, s54
  s_max_i32 s54, s54, 0
  s_max_u32 s56, s56, 1
  s_mul_i32 s56, s56, 22
  v_cvt_f32_u32 v8, s56
  v_cvt_f32_u32 v9, s54
  v_rcp_f32 v8, v8
  s_nop 0
  v_fma_f32 v8, v8, v9, 0.5
  v_cvt_u32_f32 v8, v8
  v_min_u32 v8, 64, v8
  s_nop 0
  v_readfirstlane_b32 s54, v8
  s_nop 1
  s_mul_i32 s54, s54, 2
  s_sub_i32 s70, s66, 168
  s_max_i32 s70, s70, 0
  s_min_i32 s70, s70, 10
  s_sub_i32 s54, s54, s70
  s_cmp_gt_i32 s54, 0
  s_cselect_b32 s70, 178, 0
  s_cselect_b32 s54, s54, 0
  s_add_u32 s66, s70, s54
  v_mov_b32 v8, s66
  v_mov_b32 v1, 61704
  ds_write_b32 v1, v8
  s_waitcnt lgkmcnt(0)
  s_endpgm
.globl merge_partials_kernel
.p2align 8
.type merge_partials_kernel,@function
merge_partials_kernel:
  s_cmp_ge_u32 s2, 256
  s_cbranch_scc1 L2_end
  s_load_dwordx2 s[4:5], s[0:1], 56
  s_load_dwordx2 s[8:9], s[0:1], 72
  v_lshlrev_b32 v1, 4, v0
  v_lshrrev_b32 v2, 4, v0
  v_lshlrev_b32 v3, 3, v2
  v_mul_u32_u24 v2, 384, v2
  v_and_b32 v4, 15, v0
  v_lshl_add_u32 v2, v4, 3, v2
  s_mul_i32 s12, s2, 13312
  s_add_u32 s12, s12, 1048576
  s_add_u32 s13, s12, 3328
  s_add_u32 s14, s13, 3328
  s_add_u32 s15, s14, 3328
  s_mul_i32 s16, s2, 1536
  s_mov_b32 s6, 393216
  s_mov_b32 s7, 0x20000
  s_mov_b32 s10, 4456448
  s_mov_b32 s11, 0x20000
  s_waitcnt lgkmcnt(0)
  s_and_b32 s5, s5, 0xffff
  s_and_b32 s9, s9, 0xffff
  buffer_load_dwordx2 v[8:9], v3, s[8:11], s12 offen offset:3072
  buffer_load_dwordx4 v[16:19], v1, s[8:11], s12 offen offset:0
  buffer_load_dwordx4 v[20:23], v1, s[8:11], s12 offen offset:1024
  buffer_load_dwordx4 v[24:27], v1, s[8:11], s12 offen offset:2048
  buffer_load_dwordx2 v[10:11], v3, s[8:11], s13 offen offset:3072
  buffer_load_dwordx4 v[28:31], v1, s[8:11], s13 offen offset:0
  buffer_load_dwordx4 v[32:35], v1, s[8:11], s13 offen offset:1024
  buffer_load_dwordx4 v[36:39], v1, s[8:11], s13 offen offset:2048
  buffer_load_dwordx2 v[12:13], v3, s[8:11], s14 offen offset:3072
  buffer_load_dwordx4 v[40:43], v1, s[8:11], s14 offen offset:0
  buffer_load_dwordx4 v[44:47], v1, s[8:11], s14 offen offset:1024
  buffer_load_dwordx4 v[48:51], v1, s[8:11], s14 offen offset:2048
  buffer_load_dwordx2 v[14:15], v3, s[8:11], s15 offen offset:3072
  buffer_load_dwordx4 v[52:55], v1, s[8:11], s15 offen offset:0
  buffer_load_dwordx4 v[56:59], v1, s[8:11], s15 offen offset:1024
  buffer_load_dwordx4 v[60:63], v1, s[8:11], s15 offen offset:2048
  s_waitcnt vmcnt(0)
  v_min_f32 v6, v8, v10
  v_min_f32 v6, v6, v12
  v_min_f32 v6, v6, v14
  v_sub_f32 v8, v6, v8
  v_sub_f32 v10, v6, v10
  v_sub_f32 v12, v6, v12
  v_sub_f32 v14, v6, v14
  v_exp_f32 v8, v8
  v_exp_f32 v10, v10
  v_exp_f32 v12, v12
  v_exp_f32 v14, v14
  v_mul_f32 v7, v8, v9
  v_fma_f32 v7, v10, v11, v7
  v_fma_f32 v7, v12, v13, v7
  v_fma_f32 v7, v14, v15, v7
  v_mul_f32 v64, v8, v16
  v_fma_f32 v64, v10, v28, v64
  v_fma_f32 v64, v12, v40, v64
  v_fma_f32 v64, v14, v52, v64
  v_mul_f32 v65, v8, v17
  v_fma_f32 v65, v10, v29, v65
  v_fma_f32 v65, v12, v41, v65
  v_fma_f32 v65, v14, v53, v65
  v_mul_f32 v66, v8, v18
  v_fma_f32 v66, v10, v30, v66
  v_fma_f32 v66, v12, v42, v66
  v_fma_f32 v66, v14, v54, v66
  v_mul_f32 v67, v8, v19
  v_fma_f32 v67, v10, v31, v67
  v_fma_f32 v67, v12, v43, v67
  v_fma_f32 v67, v14, v55, v67
  v_mul_f32 v68, v8, v20
  v_fma_f32 v68, v10, v32, v68
  v_fma_f32 v68, v12, v44, v68
  v_fma_f32 v68, v14, v56, v68
  v_mul_f32 v69, v8, v21
  v_fma_f32 v69, v10, v33, v69
  v_fma_f32 v69, v12, v45, v69
  v_fma_f32 v69, v14, v57, v69
  v_mul_f32 v70, v8, v22
  v_fma_f32 v70, v10, v34, v70
  v_fma_f32 v70, v12, v46, v70
  v_fma_f32 v70, v14, v58, v70
  v_mul_f32 v71, v8, v23
  v_fma_f32 v71, v10, v35, v71
  v_fma_f32 v71, v12, v47, v71
  v_fma_f32 v71, v14, v59, v71
  v_mul_f32 v72, v8, v24
  v_fma_f32 v72, v10, v36, v72
  v_fma_f32 v72, v12, v48, v72
  v_fma_f32 v72, v14, v60, v72
  v_mul_f32 v73, v8, v25
  v_fma_f32 v73, v10, v37, v73
  v_fma_f32 v73, v12, v49, v73
  v_fma_f32 v73, v14, v61, v73
  v_mul_f32 v74, v8, v26
  v_fma_f32 v74, v10, v38, v74
  v_fma_f32 v74, v12, v50, v74
  v_fma_f32 v74, v14, v62, v74
  v_mul_f32 v75, v8, v27
  v_fma_f32 v75, v10, v39, v75
  v_fma_f32 v75, v12, v51, v75
  v_fma_f32 v75, v14, v63, v75
  v_rcp_f32 v7, v7
  s_nop 0
  v_mul_f32 v64, v7, v64
  v_mul_f32 v65, v7, v65
  v_mul_f32 v66, v7, v66
  v_mul_f32 v67, v7, v67
  v_mul_f32 v68, v7, v68
  v_mul_f32 v69, v7, v69
  v_mul_f32 v70, v7, v70
  v_mul_f32 v71, v7, v71
  v_mul_f32 v72, v7, v72
  v_mul_f32 v73, v7, v73
  v_mul_f32 v74, v7, v74
  v_mul_f32 v75, v7, v75
  v_cvt_pk_bf16_f32 v64, v64, v65
  v_cvt_pk_bf16_f32 v65, v66, v67
  buffer_store_dwordx2 v[64:65], v2, s[4:7], s16 offen offset:0
  v_cvt_pk_bf16_f32 v68, v68, v69
  v_cvt_pk_bf16_f32 v69, v70, v71
  buffer_store_dwordx2 v[68:69], v2, s[4:7], s16 offen offset:128
  v_cvt_pk_bf16_f32 v72, v72, v73
  v_cvt_pk_bf16_f32 v73, v74, v75
  buffer_store_dwordx2 v[72:73], v2, s[4:7], s16 offen offset:256
L2_end:
  s_endpgm
.section .rodata,"a"
.p2align 6
.amdhsa_kernel standalone__kv_cache_quant_int4_int2_kv_with_per_channel_or_per_token_scales__sampling_kernel
  .amdhsa_next_free_vgpr 256
  .amdhsa_next_free_sgpr 102
  .amdhsa_accum_offset 256
  .amdhsa_group_segment_fixed_size 0
  .amdhsa_kernarg_size 80
  .amdhsa_user_sgpr_count 2
  .amdhsa_user_sgpr_kernarg_segment_ptr 1
  .amdhsa_system_sgpr_workgroup_id_x 1
  .amdhsa_float_denorm_mode_32 3
.end_amdhsa_kernel
.p2align 6
.amdhsa_kernel merge_partials_kernel
  .amdhsa_next_free_vgpr 80
  .amdhsa_next_free_sgpr 24
  .amdhsa_accum_offset 80
  .amdhsa_group_segment_fixed_size 0
  .amdhsa_kernarg_size 80
  .amdhsa_user_sgpr_count 2
  .amdhsa_user_sgpr_kernarg_segment_ptr 1
  .amdhsa_system_sgpr_workgroup_id_x 1
  .amdhsa_float_denorm_mode_32 3
.end_amdhsa_kernel
```

```asm
; @launch grid=(256,1,1) block=(192,1,1) lds=87040
.amdgcn_target "amdgcn-amd-amdhsa--gfx950"
.text
.globl standalone__kv_cache_quant_int4_int2_kv_with_per_channel_or_per_token_scales__sampling_kernel
.p2align 8
.type standalone__kv_cache_quant_int4_int2_kv_with_per_channel_or_per_token_scales__sampling_kernel,@function
standalone__kv_cache_quant_int4_int2_kv_with_per_channel_or_per_token_scales__sampling_kernel:
  s_cmp_ge_u32 s2, 256
  s_cbranch_scc1 L_end
  s_load_dwordx16 s[44:59], s[0:1], 0
  s_load_dwordx4 s[80:83], s[0:1], 64
  v_lshrrev_b32 v1, 6, v0
  v_and_b32 v0, 63, v0
  v_readfirstlane_b32 s3, v1
  s_bfe_u32 s4, s2, 0x10002
  s_lshr_b32 s5, s2, 3
  s_lshl_b32 s5, s5, 2
  s_and_b32 s70, s2, 3
  s_add_u32 s5, s5, s70
  s_lshl_b32 s5, s5, 5
  s_cmp_eq_u32 s3, 2
  s_cbranch_scc1 L_helper
  v_and_b32 v112, 3, v0
  v_bfe_u32 v113, v0, 2, 2
  v_lshrrev_b32 v114, 4, v0
  v_and_b32 v115, 15, v0
  v_lshlrev_b32 v148, 4, v112
  v_lshl_add_u32 v148, v114, 6, v148
  v_lshrrev_b32 v237, 1, v148
  v_and_b32 v235, 2, v113
  v_lshlrev_b32 v234, 5, v235
  v_add_u32 v234, 129, v234
  v_and_b32 v149, 1, v113
  v_lshl_add_u32 v235, v149, 2, v235
  v_mul_u32_u24 v149, 33024, v149
  v_add_u32 v236, v148, v149
  v_subrev_u32 v236, 33024, v236
  v_mul_u32_u24 v149, 384, v113
  v_add_u32 v239, v149, v237
  v_mov_b32 v108, 2147483632
  s_mov_b32 s90, 0xaaaaaaab
  s_mov_b32 s91, 0x492492
  s_movk_i32 s63, 768
  s_mov_b32 s64, s3
  s_mov_b32 s97, 16
  s_mov_b32 s99, 16
  s_mov_b32 s96, 0
  s_waitcnt lgkmcnt(0)
  s_mov_b32 s8, s46
  s_and_b32 s9, s47, 0xffff
  s_mov_b32 s10, 805306368
  s_mov_b32 s11, 0x20000
  s_mov_b32 s20, s50
  s_and_b32 s21, s51, 0xffff
  s_mov_b32 s22, 6291456
  s_mov_b32 s23, 0x20000
  s_mov_b32 s24, s52
  s_and_b32 s25, s53, 0xffff
  s_mov_b32 s26, 6291456
  s_mov_b32 s27, 0x20000
  s_mov_b32 s36, s44
  s_and_b32 s37, s45, 0xffff
  s_mov_b32 s38, 393216
  s_mov_b32 s39, 0x20000
  s_mov_b32 s16, s46
  s_and_b32 s17, s47, 0xffff
  s_mov_b32 s18, 805306368
  s_mov_b32 s19, 0x20000
  s_mov_b32 s12, s48
  s_and_b32 s13, s49, 0xffff
  s_mov_b32 s14, 805306368
  s_mov_b32 s15, 0x20000
  s_mov_b32 s28, s54
  s_and_b32 s29, s55, 0xffff
  s_mov_b32 s30, 2097152
  s_mov_b32 s31, 0x20000
  s_mov_b32 s32, s56
  s_and_b32 s33, s57, 0xffff
  s_mov_b32 s34, 2097152
  s_mov_b32 s35, 0x20000
  s_mov_b32 s40, s82
  s_and_b32 s41, s83, 0xffff
  s_mov_b32 s42, 25165824
  s_mov_b32 s43, 0x20000
  s_mov_b32 s56, 0x0f0f0f0f
  s_mov_b32 s57, 0x0f0f0f0f
  s_mov_b32 s58, 0xffff
  s_mov_b32 s59, 0xffff
  s_andn2_b32 s70, s64, 1
  s_or_b32 s70, s70, s4
  s_lshr_b32 s71, s64, 5
  s_lshr_b32 s85, s96, s71
  s_cmp_lt_u32 s64, s97
  s_cselect_b32 s70, s70, s64
  s_cselect_b32 s85, s64, s85
  s_and_b32 s85, s85, 1
  s_mul_i32 s71, s71, 4064
  s_add_u32 s70, s70, s71
  s_add_u32 s70, s70, s5
  s_mul_hi_u32 s84, s70, s90
  s_lshr_b32 s84, s84, 1
  s_mul_i32 s71, s84, 3
  s_sub_u32 s70, s70, s71
  s_lshl3_add_u32 s85, s70, s85
  s_mul_i32 s61, s84, 196608
  s_lshr_b32 s89, s84, 4
  s_lshl_b32 s70, s85, 5
  v_add_u32 v100, s70, v234
  v_mul_u32_u24 v100, 21846, v100
  v_lshrrev_b32 v100, 16, v100
  v_add_u32 v148, s85, v235
  v_lshrrev_b32 v149, v148, s91
  v_and_b32 v149, 1, v149
  v_cmp_eq_u32 s[54:55], 1, v149
  s_nop 1
  s_and_b64 s[52:53], s[54:55], s[56:57]
  s_andn2_b64 s[54:55], s[54:55], s[56:57]
  v_mul_u32_u24 v148, 43, v148
  v_lshrrev_b32 v148, 8, v148
  v_mul_u32_u24 v148, 384, v148
  v_add_u32 v238, v148, v237
  v_mad_u32_u24 v92, v100, s63, v236
  v_add_u32 v93, 768, v92
  v_add_u32 v94, 4608, v92
  v_add_u32 v95, 7680, v92
  v_cndmask_b32 v92, v92, v108, s[52:53]
  v_cndmask_b32 v95, v95, v108, s[54:55]
  s_mov_b32 s60, s61
  s_mov_b32 s88, s89
  s_mul_i32 s62, s84, 1536
  buffer_load_dwordx2 v[184:185], v238, s[20:23], s62 offen offset:0
  buffer_load_dwordx2 v[190:191], v238, s[24:27], s62 offen offset:0
  buffer_load_dwordx2 v[186:187], v238, s[20:23], s62 offen offset:128
  buffer_load_dwordx2 v[192:193], v238, s[24:27], s62 offen offset:128
  buffer_load_dwordx2 v[188:189], v238, s[20:23], s62 offen offset:256
  buffer_load_dwordx2 v[194:195], v238, s[24:27], s62 offen offset:256
  s_mul_i32 s70, s89, 1536
  buffer_load_dwordx2 v[178:179], v239, s[36:39], s70 offen offset:0
  buffer_load_dwordx2 v[180:181], v239, s[36:39], s70 offen offset:128
  buffer_load_dwordx2 v[182:183], v239, s[36:39], s70 offen offset:256
  buffer_load_dwordx4 v[4:7], v92, s[8:11], s60 offen offset:0 nt
  buffer_load_dwordx4 v[8:11], v92, s[8:11], s60 offen offset:256 nt
  buffer_load_dwordx4 v[12:15], v92, s[8:11], s60 offen offset:512 nt
  buffer_load_dwordx4 v[16:19], v93, s[8:11], s60 offen offset:0 nt
  buffer_load_dwordx4 v[20:23], v93, s[8:11], s60 offen offset:256 nt
  buffer_load_dwordx4 v[24:27], v93, s[8:11], s60 offen offset:512 nt
  buffer_load_dwordx4 v[28:31], v93, s[8:11], s60 offen offset:768 nt
  buffer_load_dwordx4 v[32:35], v93, s[8:11], s60 offen offset:1024 nt
  buffer_load_dwordx4 v[36:39], v93, s[8:11], s60 offen offset:1280 nt
  buffer_load_dwordx4 v[40:43], v93, s[8:11], s60 offen offset:1536 nt
  buffer_load_dwordx4 v[44:47], v93, s[8:11], s60 offen offset:1792 nt
  buffer_load_dwordx4 v[48:51], v93, s[8:11], s60 offen offset:2048 nt
  buffer_load_dwordx4 v[52:55], v93, s[8:11], s60 offen offset:2304 nt
  buffer_load_dwordx4 v[56:59], v93, s[8:11], s60 offen offset:2560 nt
  buffer_load_dwordx4 v[60:63], v93, s[8:11], s60 offen offset:2816 nt
  s_mov_b64 vcc, 0
  v_lshlrev_b32 v148, 4, v115
  v_and_b32 v97, 2, v114
  v_lshlrev_b32 v96, 5, v97
  v_add_u32 v96, 129, v96
  v_and_b32 v149, 1, v114
  v_lshl_add_u32 v97, v149, 2, v97
  v_mul_u32_u24 v149, 33024, v149
  v_add_u32 v98, v148, v149
  v_subrev_u32 v98, 33024, v98
  v_and_b32 v149, 1, v114
  v_mul_u32_u24 v149, 86, v149
  v_lshl_add_u32 v99, v115, 1, v149
  v_subrev_u32 v99, 86, v99
  v_lshlrev_b32 v104, 4, v114
  v_lshrrev_b32 v148, 2, v0
  s_mul_i32 s70, s3, 384
  v_lshl_add_u32 v102, v148, 4, s70
  v_lshl_add_u32 v103, v148, 3, s70
  s_mul_i32 s70, s3, 3072
  s_add_u32 s70, s70, 36864
  v_lshl_add_u32 v105, v0, 4, s70
  s_lshl_b32 s70, s3, 5
  s_add_u32 s70, s70, 43008
  v_lshl_add_u32 v106, v113, 3, s70
  s_lshl_b32 s70, s3, 2
  s_add_u32 s70, s70, 61712
  v_mov_b32 v107, s70
  v_mov_b32 v109, 61704
  v_mov_b32 v116, 0
  v_mov_b32 v117, 0
  v_mov_b32 v240, 0xff800000
  s_mov_b32 s65, 0xffff0000
  s_mov_b32 s66, 0x3fb8aa3b
  s_mov_b32 s68, 0x4893cd3a
  s_mov_b32 s92, 0x7f000000
  s_mov_b32 s94, 0x34800000
  s_mov_b32 s69, 0x4893cd3a
  s_mov_b32 s93, 0x7f000000
  s_mov_b32 s95, 0x34800000
  s_mov_b32 s72, 0x11111111
  s_mov_b32 s73, 0x11111111
  s_mov_b32 s44, 0
  s_mov_b32 s74, 0x22222222
  s_mov_b32 s75, 0x22222222
  s_mov_b32 s45, 0
  s_mov_b32 s76, 0x44444444
  s_mov_b32 s77, 0x44444444
  s_mov_b32 s46, 0
  s_mov_b32 s78, 0x88888888
  s_mov_b32 s79, 0x88888888
  s_mov_b32 s47, 0
  s_mov_b32 s100, 0
  v_mov_b32 v132, 0
  v_mov_b32 v133, 0
  v_mov_b32 v134, 0
  v_mov_b32 v135, 0
  v_mov_b32 v136, 0
  v_mov_b32 v137, 0
  v_mov_b32 v138, 0
  v_mov_b32 v139, 0
  v_mov_b32 v140, 0
  v_mov_b32 v141, 0
  v_mov_b32 v142, 0
  v_mov_b32 v143, 0
  v_mov_b32 v144, 0xff800000
  v_mov_b32 v146, 0x7f800000
  v_mov_b32 v147, 0
  s_barrier
L_k:
  v_add_u32 v148, s85, v97
  v_lshrrev_b32 v149, v148, s91
  v_and_b32 v149, 1, v149
  v_cmp_eq_u32 s[50:51], 1, v149
  s_nop 1
  s_and_b64 s[48:49], s[50:51], s[58:59]
  s_andn2_b64 s[50:51], s[50:51], s[58:59]
  s_add_u32 s64, s64, 2
  s_cmp_lt_u32 s64, s99
  s_cbranch_scc1 L_k_known0
L_k_spin0:
  v_mov_b32 v148, 61696
  ds_read_b32 v148, v148
  s_waitcnt lgkmcnt(0)
  v_readfirstlane_b32 s96, v148
  s_nop 1
  s_cmp_eq_u32 s96, 0
  s_cbranch_scc1 L_k_spin0
  s_mov_b32 s99, -1
  s_bitcmp1_b32 s96, 6
  s_cselect_b32 s97, 255, s97
L_k_known0:
  s_andn2_b32 s70, s64, 1
  s_or_b32 s70, s70, s4
  s_lshr_b32 s71, s64, 5
  s_lshr_b32 s85, s96, s71
  s_cmp_lt_u32 s64, s97
  s_cselect_b32 s70, s70, s64
  s_cselect_b32 s85, s64, s85
  s_and_b32 s85, s85, 1
  s_mul_i32 s71, s71, 4064
  s_add_u32 s70, s70, s71
  s_add_u32 s70, s70, s5
  s_mul_hi_u32 s84, s70, s90
  s_lshr_b32 s84, s84, 1
  s_mul_i32 s71, s84, 3
  s_sub_u32 s70, s70, s71
  s_lshl3_add_u32 s85, s70, s85
  s_mul_i32 s61, s84, 196608
  s_lshr_b32 s89, s84, 4
  s_lshl_b32 s70, s85, 5
  v_add_u32 v100, s70, v234
  v_mul_u32_u24 v100, 21846, v100
  v_lshrrev_b32 v100, 16, v100
  v_add_u32 v148, s85, v235
  v_lshrrev_b32 v149, v148, s91
  v_and_b32 v149, 1, v149
  v_cmp_eq_u32 s[54:55], 1, v149
  s_nop 1
  s_and_b64 s[52:53], s[54:55], s[56:57]
  s_andn2_b64 s[54:55], s[54:55], s[56:57]
  v_mul_u32_u24 v148, 43, v148
  v_lshrrev_b32 v148, 8, v148
  v_mul_u32_u24 v148, 384, v148
  v_add_u32 v238, v148, v237
  ds_read_b32 v110, v109
  s_waitcnt vmcnt(14)
  s_cbranch_vccnz L_kw0_0
  s_waitcnt vmcnt(10)
L_kw0_0:
  buffer_load_dwordx4 v[64:67], v93, s[8:11], s60 offen offset:3072 nt
  v_lshlrev_b32 v208, 16, v190
  v_and_b32 v209, s65, v190
  v_lshlrev_b32 v210, 16, v191
  v_and_b32 v211, s65, v191
  v_lshlrev_b32 v196, 16, v184
  v_and_b32 v197, s65, v184
  v_lshlrev_b32 v198, 16, v185
  v_and_b32 v199, s65, v185
  v_pk_mul_f32 v[208:209], v[208:209], s[94:95]
  v_mov_b32 v172, v178
  v_pk_mul_f32 v[210:211], v[210:211], s[94:95]
  v_mov_b32 v173, v179
  v_pk_fma_f32 v[112:113], v[4:5], s[92:93], v[208:209] neg_lo:[0,0,1] neg_hi:[0,0,1]
  v_pk_fma_f32 v[114:115], v[6:7], s[92:93], v[210:211] neg_lo:[0,0,1] neg_hi:[0,0,1]
  v_cvt_pk_bf16_f32 v112, 0, v112
  v_cvt_pk_bf16_f32 v113, 0, v113
  v_cvt_pk_bf16_f32 v114, 0, v114
  v_cvt_pk_bf16_f32 v115, 0, v115
  v_pk_mul_f32 v[112:113], v[112:113], v[196:197]
  v_pk_mul_f32 v[114:115], v[114:115], v[198:199]
  v_cvt_pk_bf16_f32 v220, v112, v113
  v_cvt_pk_bf16_f32 v221, v114, v115
  s_waitcnt lgkmcnt(0)
  s_sub_u32 s70, s64, 2
  v_cmp_lt_u32 vcc, s70, v110
  s_waitcnt vmcnt(14)
  s_cbranch_vccnz L_kw0_1
  s_waitcnt vmcnt(10)
L_kw0_1:
  buffer_load_dwordx4 v[68:71], v93, s[8:11], s60 offen offset:3328 nt
  v_lshlrev_b32 v212, 16, v192
  v_and_b32 v213, s65, v192
  v_lshlrev_b32 v214, 16, v193
  v_and_b32 v215, s65, v193
  v_lshlrev_b32 v200, 16, v186
  v_and_b32 v201, s65, v186
  v_lshlrev_b32 v202, 16, v187
  v_and_b32 v203, s65, v187
  v_pk_mul_f32 v[212:213], v[212:213], s[94:95]
  v_mov_b32 v174, v180
  v_pk_mul_f32 v[214:215], v[214:215], s[94:95]
  v_mov_b32 v175, v181
  v_pk_fma_f32 v[112:113], v[8:9], s[92:93], v[212:213] neg_lo:[0,0,1] neg_hi:[0,0,1]
  v_pk_fma_f32 v[114:115], v[10:11], s[92:93], v[214:215] neg_lo:[0,0,1] neg_hi:[0,0,1]
  v_cvt_pk_bf16_f32 v112, 0, v112
  v_cvt_pk_bf16_f32 v113, 0, v113
  v_cvt_pk_bf16_f32 v114, 0, v114
  v_cvt_pk_bf16_f32 v115, 0, v115
  v_pk_mul_f32 v[112:113], v[112:113], v[200:201]
  v_pk_mul_f32 v[114:115], v[114:115], v[202:203]
  v_cvt_pk_bf16_f32 v222, v112, v113
  v_cvt_pk_bf16_f32 v223, v114, v115
  s_waitcnt vmcnt(14)
  s_cbranch_vccnz L_kw0_2
  s_waitcnt vmcnt(10)
L_kw0_2:
  buffer_load_dwordx4 v[72:75], v93, s[8:11], s60 offen offset:3584 nt
  v_mfma_f32_16x16x32_bf16 v[228:231], v[220:223], v[172:175], 0
  v_lshlrev_b32 v216, 16, v194
  v_and_b32 v217, s65, v194
  v_lshlrev_b32 v218, 16, v195
  v_and_b32 v219, s65, v195
  v_lshlrev_b32 v204, 16, v188
  v_and_b32 v205, s65, v188
  v_lshlrev_b32 v206, 16, v189
  v_and_b32 v207, s65, v189
  v_pk_mul_f32 v[216:217], v[216:217], s[94:95]
  v_mov_b32 v176, v182
  v_pk_mul_f32 v[218:219], v[218:219], s[94:95]
  v_mov_b32 v177, v183
  v_pk_fma_f32 v[112:113], v[12:13], s[92:93], v[216:217] neg_lo:[0,0,1] neg_hi:[0,0,1]
  v_pk_fma_f32 v[114:115], v[14:15], s[92:93], v[218:219] neg_lo:[0,0,1] neg_hi:[0,0,1]
  v_cvt_pk_bf16_f32 v112, 0, v112
  v_cvt_pk_bf16_f32 v113, 0, v113
  v_cvt_pk_bf16_f32 v114, 0, v114
  v_cvt_pk_bf16_f32 v115, 0, v115
  v_pk_mul_f32 v[112:113], v[112:113], v[204:205]
  v_pk_mul_f32 v[114:115], v[114:115], v[206:207]
  v_cvt_pk_bf16_f32 v224, v112, v113
  v_cvt_pk_bf16_f32 v225, v114, v115
  s_waitcnt vmcnt(14)
  s_cbranch_vccnz L_kw0_3
  s_waitcnt vmcnt(10)
L_kw0_3:
  buffer_load_dwordx4 v[76:79], v94, s[8:11], s60 offen offset:0 nt
  v_mfma_f32_16x16x16_bf16 v[228:231], v[224:225], v[176:177], v[228:231]
  v_pk_fma_f32 v[112:113], v[16:17], s[92:93], v[208:209] neg_lo:[0,0,1] neg_hi:[0,0,1]
  v_pk_fma_f32 v[114:115], v[18:19], s[92:93], v[210:211] neg_lo:[0,0,1] neg_hi:[0,0,1]
  s_cmp_eq_u32 s89, s88
  s_cbranch_scc1 L_k_sameq0
  s_mul_i32 s70, s89, 1536
  buffer_load_dwordx2 v[178:179], v239, s[36:39], s70 offen offset:0
  buffer_load_dwordx2 v[180:181], v239, s[36:39], s70 offen offset:128
  buffer_load_dwordx2 v[182:183], v239, s[36:39], s70 offen offset:256
  s_mov_b32 s88, s89
L_k_sameq0:
  s_mul_i32 s62, s84, 1536
  buffer_load_dwordx2 v[184:185], v238, s[20:23], s62 offen offset:0
  buffer_load_dwordx2 v[190:191], v238, s[24:27], s62 offen offset:0
  buffer_load_dwordx2 v[186:187], v238, s[20:23], s62 offen offset:128
  buffer_load_dwordx2 v[192:193], v238, s[24:27], s62 offen offset:128
  buffer_load_dwordx2 v[188:189], v238, s[20:23], s62 offen offset:256
  buffer_load_dwordx2 v[194:195], v238, s[24:27], s62 offen offset:256
  v_cvt_pk_bf16_f32 v112, 0, v112
  v_cvt_pk_bf16_f32 v113, 0, v113
  v_cvt_pk_bf16_f32 v114, 0, v114
  v_cvt_pk_bf16_f32 v115, 0, v115
  v_pk_mul_f32 v[112:113], v[112:113], v[196:197]
  v_pk_mul_f32 v[114:115], v[114:115], v[198:199]
  v_cvt_pk_bf16_f32 v220, v112, v113
  v_cvt_pk_bf16_f32 v221, v114, v115
  s_waitcnt vmcnt(20)
  s_cbranch_vccnz L_kw0_4
  s_waitcnt vmcnt(16)
L_kw0_4:
  buffer_load_dwordx4 v[80:83], v94, s[8:11], s60 offen offset:256 nt
  v_pk_fma_f32 v[112:113], v[20:21], s[92:93], v[212:213] neg_lo:[0,0,1] neg_hi:[0,0,1]
  v_pk_fma_f32 v[114:115], v[22:23], s[92:93], v[214:215] neg_lo:[0,0,1] neg_hi:[0,0,1]
  v_mov_b32_dpp v148, v228 quad_perm:[0,0,0,0] row_mask:0xf bank_mask:0xf
  v_mov_b32_dpp v149, v230 quad_perm:[2,2,2,2] row_mask:0xf bank_mask:0xf
  v_cvt_pk_bf16_f32 v112, 0, v112
  v_cvt_pk_bf16_f32 v113, 0, v113
  v_add_f32_dpp v148, v229, v148 quad_perm:[1,1,1,1] row_mask:0xf bank_mask:0xf
  v_add_f32_dpp v149, v231, v149 quad_perm:[3,3,3,3] row_mask:0xf bank_mask:0xf
  v_cvt_pk_bf16_f32 v114, 0, v114
  v_cvt_pk_bf16_f32 v115, 0, v115
  v_add_f32 v232, v148, v149
  v_pk_mul_f32 v[112:113], v[112:113], v[200:201]
  v_pk_mul_f32 v[114:115], v[114:115], v[202:203]
  v_cvt_pk_bf16_f32 v222, v112, v113
  v_cvt_pk_bf16_f32 v223, v114, v115
  s_waitcnt vmcnt(20)
  s_cbranch_vccnz L_kw0_5
  s_waitcnt vmcnt(16)
L_kw0_5:
  buffer_load_dwordx4 v[84:87], v94, s[8:11], s60 offen offset:512 nt
  v_mfma_f32_16x16x32_bf16 v[228:231], v[220:223], v[172:175], 0
  v_pk_fma_f32 v[112:113], v[24:25], s[92:93], v[216:217] neg_lo:[0,0,1] neg_hi:[0,0,1]
  v_pk_fma_f32 v[114:115], v[26:27], s[92:93], v[218:219] neg_lo:[0,0,1] neg_hi:[0,0,1]
  v_cvt_pk_bf16_f32 v112, 0, v112
  v_cndmask_b32 v232, v232, v240, s[48:49]
  v_cvt_pk_bf16_f32 v113, 0, v113
  v_cvt_pk_bf16_f32 v114, 0, v114
  v_cvt_pk_bf16_f32 v115, 0, v115
  v_pk_mul_f32 v[112:113], v[112:113], v[204:205]
  v_pk_mul_f32 v[114:115], v[114:115], v[206:207]
  v_cvt_pk_bf16_f32 v224, v112, v113
  v_cvt_pk_bf16_f32 v225, v114, v115
  s_waitcnt vmcnt(20)
  s_cbranch_vccnz L_kw0_6
  s_waitcnt vmcnt(16)
L_kw0_6:
  buffer_load_dwordx4 v[88:91], v94, s[8:11], s60 offen offset:768 nt
  v_mfma_f32_16x16x16_bf16 v[228:231], v[224:225], v[176:177], v[228:231]
  v_pk_fma_f32 v[112:113], v[28:29], s[92:93], v[208:209] neg_lo:[0,0,1] neg_hi:[0,0,1]
  v_pk_fma_f32 v[114:115], v[30:31], s[92:93], v[210:211] neg_lo:[0,0,1] neg_hi:[0,0,1]
  v_cvt_pk_bf16_f32 v112, 0, v112
  v_cvt_pk_bf16_f32 v113, 0, v113
  v_cvt_pk_bf16_f32 v114, 0, v114
  v_cvt_pk_bf16_f32 v115, 0, v115
  v_pk_mul_f32 v[112:113], v[112:113], v[196:197]
  v_pk_mul_f32 v[114:115], v[114:115], v[198:199]
  v_cvt_pk_bf16_f32 v220, v112, v113
  v_cvt_pk_bf16_f32 v221, v114, v115
  s_waitcnt vmcnt(20)
  s_cbranch_vccnz L_kw0_7
  s_waitcnt vmcnt(16)
L_kw0_7:
  buffer_load_dwordx4 v[4:7], v94, s[8:11], s60 offen offset:1024 nt
  v_pk_fma_f32 v[112:113], v[32:33], s[92:93], v[212:213] neg_lo:[0,0,1] neg_hi:[0,0,1]
  v_pk_fma_f32 v[114:115], v[34:35], s[92:93], v[214:215] neg_lo:[0,0,1] neg_hi:[0,0,1]
  v_mov_b32_dpp v148, v228 quad_perm:[0,0,0,0] row_mask:0xf bank_mask:0xf
  v_mov_b32_dpp v149, v230 quad_perm:[2,2,2,2] row_mask:0xf bank_mask:0xf
  v_cvt_pk_bf16_f32 v112, 0, v112
  v_cvt_pk_bf16_f32 v113, 0, v113
  v_add_f32_dpp v148, v229, v148 quad_perm:[1,1,1,1] row_mask:0xf bank_mask:0xf
  v_add_f32_dpp v149, v231, v149 quad_perm:[3,3,3,3] row_mask:0xf bank_mask:0xf
  v_cvt_pk_bf16_f32 v114, 0, v114
  v_cvt_pk_bf16_f32 v115, 0, v115
  v_add_f32 v233, v148, v149
  v_pk_mul_f32 v[112:113], v[112:113], v[200:201]
  v_pk_mul_f32 v[114:115], v[114:115], v[202:203]
  v_cvt_pk_bf16_f32 v222, v112, v113
  v_cvt_pk_bf16_f32 v223, v114, v115
  s_waitcnt vmcnt(20)
  s_cbranch_vccnz L_kw0_8
  s_waitcnt vmcnt(16)
L_kw0_8:
  buffer_load_dwordx4 v[8:11], v94, s[8:11], s60 offen offset:1280 nt
  v_mfma_f32_16x16x32_bf16 v[228:231], v[220:223], v[172:175], 0
  v_pk_fma_f32 v[112:113], v[36:37], s[92:93], v[216:217] neg_lo:[0,0,1] neg_hi:[0,0,1]
  v_pk_fma_f32 v[114:115], v[38:39], s[92:93], v[218:219] neg_lo:[0,0,1] neg_hi:[0,0,1]
  v_cvt_pk_bf16_f32 v112, 0, v112
  v_cvt_pk_bf16_f32 v232, 0, v232
  v_cvt_pk_bf16_f32 v113, 0, v113
  v_cvt_pk_bf16_f32 v233, 0, v233
  v_cvt_pk_bf16_f32 v114, 0, v114
  v_pk_mul_f32 v[232:233], v[232:233], s[68:69]
  v_cvt_pk_bf16_f32 v115, 0, v115
  v_cvt_pk_bf16_f32 v124, v232, v233
  v_pk_mul_f32 v[112:113], v[112:113], v[204:205]
  v_pk_mul_f32 v[114:115], v[114:115], v[206:207]
  v_cvt_pk_bf16_f32 v224, v112, v113
  v_cvt_pk_bf16_f32 v225, v114, v115
  s_waitcnt vmcnt(20)
  s_cbranch_vccnz L_kw0_9
  s_waitcnt vmcnt(16)
L_kw0_9:
  buffer_load_dwordx4 v[12:15], v94, s[8:11], s60 offen offset:1536 nt
  v_mfma_f32_16x16x16_bf16 v[228:231], v[224:225], v[176:177], v[228:231]
  v_pk_fma_f32 v[112:113], v[40:41], s[92:93], v[208:209] neg_lo:[0,0,1] neg_hi:[0,0,1]
  v_pk_fma_f32 v[114:115], v[42:43], s[92:93], v[210:211] neg_lo:[0,0,1] neg_hi:[0,0,1]
  v_cvt_pk_bf16_f32 v112, 0, v112
  v_cvt_pk_bf16_f32 v113, 0, v113
  v_cvt_pk_bf16_f32 v114, 0, v114
  v_cvt_pk_bf16_f32 v115, 0, v115
  v_pk_mul_f32 v[112:113], v[112:113], v[196:197]
  v_pk_mul_f32 v[114:115], v[114:115], v[198:199]
  v_cvt_pk_bf16_f32 v220, v112, v113
  v_cvt_pk_bf16_f32 v221, v114, v115
  s_waitcnt vmcnt(20)
  s_cbranch_vccnz L_kw0_10
  s_waitcnt vmcnt(16)
L_kw0_10:
  buffer_load_dwordx4 v[16:19], v94, s[8:11], s60 offen offset:1792 nt
  v_pk_fma_f32 v[112:113], v[44:45], s[92:93], v[212:213] neg_lo:[0,0,1] neg_hi:[0,0,1]
  v_pk_fma_f32 v[114:115], v[46:47], s[92:93], v[214:215] neg_lo:[0,0,1] neg_hi:[0,0,1]
  v_mov_b32_dpp v148, v228 quad_perm:[0,0,0,0] row_mask:0xf bank_mask:0xf
  v_mov_b32_dpp v149, v230 quad_perm:[2,2,2,2] row_mask:0xf bank_mask:0xf
  v_cvt_pk_bf16_f32 v112, 0, v112
  v_cvt_pk_bf16_f32 v113, 0, v113
  v_add_f32_dpp v148, v229, v148 quad_perm:[1,1,1,1] row_mask:0xf bank_mask:0xf
  v_add_f32_dpp v149, v231, v149 quad_perm:[3,3,3,3] row_mask:0xf bank_mask:0xf
  v_cvt_pk_bf16_f32 v114, 0, v114
  v_cvt_pk_bf16_f32 v115, 0, v115
  v_add_f32 v232, v148, v149
  v_pk_mul_f32 v[112:113], v[112:113], v[200:201]
  v_pk_mul_f32 v[114:115], v[114:115], v[202:203]
  v_cvt_pk_bf16_f32 v222, v112, v113
  v_cvt_pk_bf16_f32 v223, v114, v115
  s_waitcnt vmcnt(20)
  s_cbranch_vccnz L_kw0_11
  s_waitcnt vmcnt(16)
L_kw0_11:
  buffer_load_dwordx4 v[20:23], v94, s[8:11], s60 offen offset:2048 nt
  v_mfma_f32_16x16x32_bf16 v[228:231], v[220:223], v[172:175], 0
  v_pk_fma_f32 v[112:113], v[48:49], s[92:93], v[216:217] neg_lo:[0,0,1] neg_hi:[0,0,1]
  v_pk_fma_f32 v[114:115], v[50:51], s[92:93], v[218:219] neg_lo:[0,0,1] neg_hi:[0,0,1]
  v_cvt_pk_bf16_f32 v112, 0, v112
  v_cvt_pk_bf16_f32 v113, 0, v113
  v_cvt_pk_bf16_f32 v114, 0, v114
  v_cvt_pk_bf16_f32 v115, 0, v115
  v_pk_mul_f32 v[112:113], v[112:113], v[204:205]
  v_pk_mul_f32 v[114:115], v[114:115], v[206:207]
  v_cvt_pk_bf16_f32 v224, v112, v113
  v_cvt_pk_bf16_f32 v225, v114, v115
  s_waitcnt vmcnt(20)
  s_cbranch_vccnz L_kw0_12
  s_waitcnt vmcnt(16)
L_kw0_12:
  buffer_load_dwordx4 v[24:27], v94, s[8:11], s60 offen offset:2304 nt
  v_mfma_f32_16x16x16_bf16 v[228:231], v[224:225], v[176:177], v[228:231]
  v_pk_fma_f32 v[112:113], v[52:53], s[92:93], v[208:209] neg_lo:[0,0,1] neg_hi:[0,0,1]
  v_pk_fma_f32 v[114:115], v[54:55], s[92:93], v[210:211] neg_lo:[0,0,1] neg_hi:[0,0,1]
  v_cvt_pk_bf16_f32 v112, 0, v112
  v_cvt_pk_bf16_f32 v113, 0, v113
  v_cvt_pk_bf16_f32 v114, 0, v114
  v_cvt_pk_bf16_f32 v115, 0, v115
  v_pk_mul_f32 v[112:113], v[112:113], v[196:197]
  v_pk_mul_f32 v[114:115], v[114:115], v[198:199]
  v_cvt_pk_bf16_f32 v220, v112, v113
  v_cvt_pk_bf16_f32 v221, v114, v115
  s_waitcnt vmcnt(20)
  s_cbranch_vccnz L_kw0_13
  s_waitcnt vmcnt(16)
L_kw0_13:
  buffer_load_dwordx4 v[28:31], v94, s[8:11], s60 offen offset:2560 nt
  v_pk_fma_f32 v[112:113], v[56:57], s[92:93], v[212:213] neg_lo:[0,0,1] neg_hi:[0,0,1]
  v_pk_fma_f32 v[114:115], v[58:59], s[92:93], v[214:215] neg_lo:[0,0,1] neg_hi:[0,0,1]
  v_mov_b32_dpp v148, v228 quad_perm:[0,0,0,0] row_mask:0xf bank_mask:0xf
  v_mov_b32_dpp v149, v230 quad_perm:[2,2,2,2] row_mask:0xf bank_mask:0xf
  v_cvt_pk_bf16_f32 v112, 0, v112
  v_cvt_pk_bf16_f32 v113, 0, v113
  v_add_f32_dpp v148, v229, v148 quad_perm:[1,1,1,1] row_mask:0xf bank_mask:0xf
  v_add_f32_dpp v149, v231, v149 quad_perm:[3,3,3,3] row_mask:0xf bank_mask:0xf
  v_cvt_pk_bf16_f32 v114, 0, v114
  v_cvt_pk_bf16_f32 v115, 0, v115
  v_add_f32 v233, v148, v149
  v_pk_mul_f32 v[112:113], v[112:113], v[200:201]
  v_pk_mul_f32 v[114:115], v[114:115], v[202:203]
  v_cvt_pk_bf16_f32 v222, v112, v113
  v_cvt_pk_bf16_f32 v223, v114, v115
  s_waitcnt vmcnt(20)
  s_cbranch_vccnz L_kw0_14
  s_waitcnt vmcnt(16)
L_kw0_14:
  buffer_load_dwordx4 v[32:35], v94, s[8:11], s60 offen offset:2816 nt
  v_mfma_f32_16x16x32_bf16 v[228:231], v[220:223], v[172:175], 0
  v_pk_fma_f32 v[112:113], v[60:61], s[92:93], v[216:217] neg_lo:[0,0,1] neg_hi:[0,0,1]
  v_pk_fma_f32 v[114:115], v[62:63], s[92:93], v[218:219] neg_lo:[0,0,1] neg_hi:[0,0,1]
  v_cvt_pk_bf16_f32 v112, 0, v112
  v_cvt_pk_bf16_f32 v232, 0, v232
  v_cvt_pk_bf16_f32 v113, 0, v113
  v_cvt_pk_bf16_f32 v233, 0, v233
  v_cvt_pk_bf16_f32 v114, 0, v114
  v_pk_mul_f32 v[232:233], v[232:233], s[68:69]
  v_cvt_pk_bf16_f32 v115, 0, v115
  v_cvt_pk_bf16_f32 v125, v232, v233
  v_pk_mul_f32 v[112:113], v[112:113], v[204:205]
  v_pk_mul_f32 v[114:115], v[114:115], v[206:207]
  v_cvt_pk_bf16_f32 v224, v112, v113
  v_cvt_pk_bf16_f32 v225, v114, v115
  s_waitcnt vmcnt(20)
  s_cbranch_vccnz L_kw0_15
  s_waitcnt vmcnt(10)
L_kw0_15:
  buffer_load_dwordx4 v[36:39], v95, s[8:11], s60 offen offset:0 nt
  v_mfma_f32_16x16x16_bf16 v[228:231], v[224:225], v[176:177], v[228:231]
  v_pk_fma_f32 v[112:113], v[64:65], s[92:93], v[208:209] neg_lo:[0,0,1] neg_hi:[0,0,1]
  v_pk_fma_f32 v[114:115], v[66:67], s[92:93], v[210:211] neg_lo:[0,0,1] neg_hi:[0,0,1]
  v_cvt_pk_bf16_f32 v112, 0, v112
  v_cvt_pk_bf16_f32 v113, 0, v113
  v_cvt_pk_bf16_f32 v114, 0, v114
  v_cvt_pk_bf16_f32 v115, 0, v115
  v_pk_mul_f32 v[112:113], v[112:113], v[196:197]
  v_pk_mul_f32 v[114:115], v[114:115], v[198:199]
  v_cvt_pk_bf16_f32 v220, v112, v113
  v_cvt_pk_bf16_f32 v221, v114, v115
  s_waitcnt vmcnt(20)
  s_cbranch_vccnz L_kw0_16
  s_waitcnt vmcnt(10)
L_kw0_16:
  buffer_load_dwordx4 v[40:43], v95, s[8:11], s60 offen offset:256 nt
  v_pk_fma_f32 v[112:113], v[68:69], s[92:93], v[212:213] neg_lo:[0,0,1] neg_hi:[0,0,1]
  v_pk_fma_f32 v[114:115], v[70:71], s[92:93], v[214:215] neg_lo:[0,0,1] neg_hi:[0,0,1]
  v_mov_b32_dpp v148, v228 quad_perm:[0,0,0,0] row_mask:0xf bank_mask:0xf
  v_mov_b32_dpp v149, v230 quad_perm:[2,2,2,2] row_mask:0xf bank_mask:0xf
  v_cvt_pk_bf16_f32 v112, 0, v112
  v_cvt_pk_bf16_f32 v113, 0, v113
  v_add_f32_dpp v148, v229, v148 quad_perm:[1,1,1,1] row_mask:0xf bank_mask:0xf
  v_add_f32_dpp v149, v231, v149 quad_perm:[3,3,3,3] row_mask:0xf bank_mask:0xf
  v_cvt_pk_bf16_f32 v114, 0, v114
  v_cvt_pk_bf16_f32 v115, 0, v115
  v_add_f32 v232, v148, v149
  v_pk_mul_f32 v[112:113], v[112:113], v[200:201]
  v_pk_mul_f32 v[114:115], v[114:115], v[202:203]
  v_cvt_pk_bf16_f32 v222, v112, v113
  v_cvt_pk_bf16_f32 v223, v114, v115
  s_waitcnt vmcnt(20)
  s_cbranch_vccnz L_kw0_17
  s_waitcnt vmcnt(10)
L_kw0_17:
  buffer_load_dwordx4 v[44:47], v95, s[8:11], s60 offen offset:512 nt
  v_mfma_f32_16x16x32_bf16 v[228:231], v[220:223], v[172:175], 0
  v_pk_fma_f32 v[112:113], v[72:73], s[92:93], v[216:217] neg_lo:[0,0,1] neg_hi:[0,0,1]
  v_pk_fma_f32 v[114:115], v[74:75], s[92:93], v[218:219] neg_lo:[0,0,1] neg_hi:[0,0,1]
  v_cvt_pk_bf16_f32 v112, 0, v112
  v_cvt_pk_bf16_f32 v113, 0, v113
  v_cvt_pk_bf16_f32 v114, 0, v114
  v_cvt_pk_bf16_f32 v115, 0, v115
  v_pk_mul_f32 v[112:113], v[112:113], v[204:205]
  v_pk_mul_f32 v[114:115], v[114:115], v[206:207]
  v_cvt_pk_bf16_f32 v224, v112, v113
  v_cvt_pk_bf16_f32 v225, v114, v115
  v_mad_u32_u24 v92, v100, s63, v236
  v_add_u32 v93, 768, v92
  v_add_u32 v94, 4608, v92
  v_add_u32 v95, 7680, v92
  v_cndmask_b32 v92, v92, v108, s[52:53]
  v_cndmask_b32 v95, v95, v108, s[54:55]
  s_waitcnt vmcnt(20)
  s_cbranch_vccnz L_kw0_18
  s_waitcnt vmcnt(10)
L_kw0_18:
  buffer_load_dwordx4 v[48:51], v92, s[16:19], s61 offen offset:0 nt
  v_mfma_f32_16x16x16_bf16 v[228:231], v[224:225], v[176:177], v[228:231]
  v_pk_fma_f32 v[112:113], v[76:77], s[92:93], v[208:209] neg_lo:[0,0,1] neg_hi:[0,0,1]
  v_pk_fma_f32 v[114:115], v[78:79], s[92:93], v[210:211] neg_lo:[0,0,1] neg_hi:[0,0,1]
  v_cvt_pk_bf16_f32 v112, 0, v112
  v_cvt_pk_bf16_f32 v113, 0, v113
  v_cvt_pk_bf16_f32 v114, 0, v114
  v_cvt_pk_bf16_f32 v115, 0, v115
  v_pk_mul_f32 v[112:113], v[112:113], v[196:197]
  v_pk_mul_f32 v[114:115], v[114:115], v[198:199]
  v_cvt_pk_bf16_f32 v220, v112, v113
  v_cvt_pk_bf16_f32 v221, v114, v115
  s_waitcnt vmcnt(14)
  s_cbranch_vccnz L_kw0_19
  s_waitcnt vmcnt(10)
L_kw0_19:
  buffer_load_dwordx4 v[52:55], v92, s[16:19], s61 offen offset:256 nt
  v_pk_fma_f32 v[112:113], v[80:81], s[92:93], v[212:213] neg_lo:[0,0,1] neg_hi:[0,0,1]
  v_pk_fma_f32 v[114:115], v[82:83], s[92:93], v[214:215] neg_lo:[0,0,1] neg_hi:[0,0,1]
  v_mov_b32_dpp v148, v228 quad_perm:[0,0,0,0] row_mask:0xf bank_mask:0xf
  v_mov_b32_dpp v149, v230 quad_perm:[2,2,2,2] row_mask:0xf bank_mask:0xf
  v_cvt_pk_bf16_f32 v112, 0, v112
  v_cvt_pk_bf16_f32 v113, 0, v113
  v_add_f32_dpp v148, v229, v148 quad_perm:[1,1,1,1] row_mask:0xf bank_mask:0xf
  v_add_f32_dpp v149, v231, v149 quad_perm:[3,3,3,3] row_mask:0xf bank_mask:0xf
  v_cvt_pk_bf16_f32 v114, 0, v114
  v_cvt_pk_bf16_f32 v115, 0, v115
  v_add_f32 v233, v148, v149
  v_pk_mul_f32 v[112:113], v[112:113], v[200:201]
  v_pk_mul_f32 v[114:115], v[114:115], v[202:203]
  v_cvt_pk_bf16_f32 v222, v112, v113
  v_cvt_pk_bf16_f32 v223, v114, v115
  s_waitcnt vmcnt(14)
  s_cbranch_vccnz L_kw0_20
  s_waitcnt vmcnt(10)
L_kw0_20:
  buffer_load_dwordx4 v[56:59], v92, s[16:19], s61 offen offset:512 nt
  v_mfma_f32_16x16x32_bf16 v[228:231], v[220:223], v[172:175], 0
  v_pk_fma_f32 v[112:113], v[84:85], s[92:93], v[216:217] neg_lo:[0,0,1] neg_hi:[0,0,1]
  v_pk_fma_f32 v[114:115], v[86:87], s[92:93], v[218:219] neg_lo:[0,0,1] neg_hi:[0,0,1]
  v_cvt_pk_bf16_f32 v112, 0, v112
  v_cvt_pk_bf16_f32 v232, 0, v232
  v_cvt_pk_bf16_f32 v113, 0, v113
  v_cvt_pk_bf16_f32 v233, 0, v233
  v_cvt_pk_bf16_f32 v114, 0, v114
  v_pk_mul_f32 v[232:233], v[232:233], s[68:69]
  v_cvt_pk_bf16_f32 v115, 0, v115
  v_cvt_pk_bf16_f32 v126, v232, v233
  v_pk_mul_f32 v[112:113], v[112:113], v[204:205]
  v_pk_mul_f32 v[114:115], v[114:115], v[206:207]
  v_cvt_pk_bf16_f32 v224, v112, v113
  v_cvt_pk_bf16_f32 v225, v114, v115
  s_waitcnt vmcnt(14)
  s_cbranch_vccnz L_kw0_21
  s_waitcnt vmcnt(10)
L_kw0_21:
  buffer_load_dwordx4 v[60:63], v93, s[16:19], s61 offen offset:0 nt
  v_mfma_f32_16x16x16_bf16 v[228:231], v[224:225], v[176:177], v[228:231]
  v_pk_fma_f32 v[112:113], v[88:89], s[92:93], v[208:209] neg_lo:[0,0,1] neg_hi:[0,0,1]
  v_pk_fma_f32 v[114:115], v[90:91], s[92:93], v[210:211] neg_lo:[0,0,1] neg_hi:[0,0,1]
  v_cvt_pk_bf16_f32 v112, 0, v112
  v_cvt_pk_bf16_f32 v113, 0, v113
  v_cvt_pk_bf16_f32 v114, 0, v114
  v_cvt_pk_bf16_f32 v115, 0, v115
  v_pk_mul_f32 v[112:113], v[112:113], v[196:197]
  v_pk_mul_f32 v[114:115], v[114:115], v[198:199]
  v_cvt_pk_bf16_f32 v220, v112, v113
  v_cvt_pk_bf16_f32 v221, v114, v115
  s_waitcnt vmcnt(14)
  s_cbranch_vccnz L_kw0_22
  s_waitcnt vmcnt(10)
L_kw0_22:
  buffer_load_dwordx4 v[64:67], v93, s[16:19], s61 offen offset:256 nt
  v_pk_fma_f32 v[112:113], v[4:5], s[92:93], v[212:213] neg_lo:[0,0,1] neg_hi:[0,0,1]
  v_pk_fma_f32 v[114:115], v[6:7], s[92:93], v[214:215] neg_lo:[0,0,1] neg_hi:[0,0,1]
  v_mov_b32_dpp v148, v228 quad_perm:[0,0,0,0] row_mask:0xf bank_mask:0xf
  v_mov_b32_dpp v149, v230 quad_perm:[2,2,2,2] row_mask:0xf bank_mask:0xf
  v_cvt_pk_bf16_f32 v112, 0, v112
  v_cvt_pk_bf16_f32 v113, 0, v113
  v_add_f32_dpp v148, v229, v148 quad_perm:[1,1,1,1] row_mask:0xf bank_mask:0xf
  v_add_f32_dpp v149, v231, v149 quad_perm:[3,3,3,3] row_mask:0xf bank_mask:0xf
  v_cvt_pk_bf16_f32 v114, 0, v114
  v_cvt_pk_bf16_f32 v115, 0, v115
  v_add_f32 v232, v148, v149
  v_pk_mul_f32 v[112:113], v[112:113], v[200:201]
  v_pk_mul_f32 v[114:115], v[114:115], v[202:203]
  v_cvt_pk_bf16_f32 v222, v112, v113
  v_cvt_pk_bf16_f32 v223, v114, v115
  s_waitcnt vmcnt(14)
  s_cbranch_vccnz L_kw0_23
  s_waitcnt vmcnt(10)
L_kw0_23:
  buffer_load_dwordx4 v[68:71], v93, s[16:19], s61 offen offset:512 nt
  v_mfma_f32_16x16x32_bf16 v[228:231], v[220:223], v[172:175], 0
  v_pk_fma_f32 v[112:113], v[8:9], s[92:93], v[216:217] neg_lo:[0,0,1] neg_hi:[0,0,1]
  v_pk_fma_f32 v[114:115], v[10:11], s[92:93], v[218:219] neg_lo:[0,0,1] neg_hi:[0,0,1]
  v_cvt_pk_bf16_f32 v112, 0, v112
  v_cvt_pk_bf16_f32 v113, 0, v113
  v_cvt_pk_bf16_f32 v114, 0, v114
  v_cvt_pk_bf16_f32 v115, 0, v115
  v_pk_mul_f32 v[112:113], v[112:113], v[204:205]
  v_pk_mul_f32 v[114:115], v[114:115], v[206:207]
  v_cvt_pk_bf16_f32 v224, v112, v113
  v_cvt_pk_bf16_f32 v225, v114, v115
  s_waitcnt vmcnt(14)
  s_cbranch_vccnz L_kw0_24
  s_waitcnt vmcnt(10)
L_kw0_24:
  buffer_load_dwordx4 v[72:75], v93, s[16:19], s61 offen offset:768 nt
  v_mfma_f32_16x16x16_bf16 v[228:231], v[224:225], v[176:177], v[228:231]
  v_pk_fma_f32 v[112:113], v[12:13], s[92:93], v[208:209] neg_lo:[0,0,1] neg_hi:[0,0,1]
  v_pk_fma_f32 v[114:115], v[14:15], s[92:93], v[210:211] neg_lo:[0,0,1] neg_hi:[0,0,1]
  v_cvt_pk_bf16_f32 v112, 0, v112
  v_cvt_pk_bf16_f32 v113, 0, v113
  v_cvt_pk_bf16_f32 v114, 0, v114
  v_cvt_pk_bf16_f32 v115, 0, v115
  v_pk_mul_f32 v[112:113], v[112:113], v[196:197]
  v_pk_mul_f32 v[114:115], v[114:115], v[198:199]
  v_cvt_pk_bf16_f32 v220, v112, v113
  v_cvt_pk_bf16_f32 v221, v114, v115
  s_waitcnt vmcnt(14)
  s_cbranch_vccnz L_kw0_25
  s_waitcnt vmcnt(10)
L_kw0_25:
  buffer_load_dwordx4 v[76:79], v93, s[16:19], s61 offen offset:1024 nt
  v_pk_fma_f32 v[112:113], v[16:17], s[92:93], v[212:213] neg_lo:[0,0,1] neg_hi:[0,0,1]
  v_pk_fma_f32 v[114:115], v[18:19], s[92:93], v[214:215] neg_lo:[0,0,1] neg_hi:[0,0,1]
  v_mov_b32_dpp v148, v228 quad_perm:[0,0,0,0] row_mask:0xf bank_mask:0xf
  v_mov_b32_dpp v149, v230 quad_perm:[2,2,2,2] row_mask:0xf bank_mask:0xf
  v_cvt_pk_bf16_f32 v112, 0, v112
  v_cvt_pk_bf16_f32 v113, 0, v113
  v_add_f32_dpp v148, v229, v148 quad_perm:[1,1,1,1] row_mask:0xf bank_mask:0xf
  v_add_f32_dpp v149, v231, v149 quad_perm:[3,3,3,3] row_mask:0xf bank_mask:0xf
  v_cvt_pk_bf16_f32 v114, 0, v114
  v_cvt_pk_bf16_f32 v115, 0, v115
  v_add_f32 v233, v148, v149
  v_pk_mul_f32 v[112:113], v[112:113], v[200:201]
  v_pk_mul_f32 v[114:115], v[114:115], v[202:203]
  v_cvt_pk_bf16_f32 v222, v112, v113
  v_cvt_pk_bf16_f32 v223, v114, v115
  s_waitcnt vmcnt(14)
  s_cbranch_vccnz L_kw0_26
  s_waitcnt vmcnt(10)
L_kw0_26:
  buffer_load_dwordx4 v[80:83], v93, s[16:19], s61 offen offset:1280 nt
  v_mfma_f32_16x16x32_bf16 v[228:231], v[220:223], v[172:175], 0
  v_pk_fma_f32 v[112:113], v[20:21], s[92:93], v[216:217] neg_lo:[0,0,1] neg_hi:[0,0,1]
  v_pk_fma_f32 v[114:115], v[22:23], s[92:93], v[218:219] neg_lo:[0,0,1] neg_hi:[0,0,1]
  v_cvt_pk_bf16_f32 v112, 0, v112
  v_cvt_pk_bf16_f32 v232, 0, v232
  v_cvt_pk_bf16_f32 v113, 0, v113
  v_cvt_pk_bf16_f32 v233, 0, v233
  v_cvt_pk_bf16_f32 v114, 0, v114
  v_pk_mul_f32 v[232:233], v[232:233], s[68:69]
  v_cvt_pk_bf16_f32 v115, 0, v115
  v_cvt_pk_bf16_f32 v127, v232, v233
  v_pk_mul_f32 v[112:113], v[112:113], v[204:205]
  v_pk_mul_f32 v[114:115], v[114:115], v[206:207]
  v_cvt_pk_bf16_f32 v224, v112, v113
  v_cvt_pk_bf16_f32 v225, v114, v115
  s_waitcnt vmcnt(14)
  s_cbranch_vccnz L_kw0_27
  s_waitcnt vmcnt(10)
L_kw0_27:
  buffer_load_dwordx4 v[84:87], v93, s[16:19], s61 offen offset:1536 nt
  v_mfma_f32_16x16x16_bf16 v[228:231], v[224:225], v[176:177], v[228:231]
  v_pk_fma_f32 v[112:113], v[24:25], s[92:93], v[208:209] neg_lo:[0,0,1] neg_hi:[0,0,1]
  v_pk_fma_f32 v[114:115], v[26:27], s[92:93], v[210:211] neg_lo:[0,0,1] neg_hi:[0,0,1]
  v_cvt_pk_bf16_f32 v112, 0, v112
  v_cvt_pk_bf16_f32 v113, 0, v113
  v_cvt_pk_bf16_f32 v114, 0, v114
  v_cvt_pk_bf16_f32 v115, 0, v115
  v_pk_mul_f32 v[112:113], v[112:113], v[196:197]
  v_pk_mul_f32 v[114:115], v[114:115], v[198:199]
  v_cvt_pk_bf16_f32 v220, v112, v113
  v_cvt_pk_bf16_f32 v221, v114, v115
  s_waitcnt vmcnt(14)
  s_cbranch_vccnz L_kw0_28
  s_waitcnt vmcnt(10)
L_kw0_28:
  buffer_load_dwordx4 v[88:91], v93, s[16:19], s61 offen offset:1792 nt
  v_pk_fma_f32 v[112:113], v[28:29], s[92:93], v[212:213] neg_lo:[0,0,1] neg_hi:[0,0,1]
  v_pk_fma_f32 v[114:115], v[30:31], s[92:93], v[214:215] neg_lo:[0,0,1] neg_hi:[0,0,1]
  v_mov_b32_dpp v148, v228 quad_perm:[0,0,0,0] row_mask:0xf bank_mask:0xf
  v_mov_b32_dpp v149, v230 quad_perm:[2,2,2,2] row_mask:0xf bank_mask:0xf
  v_cvt_pk_bf16_f32 v112, 0, v112
  v_cvt_pk_bf16_f32 v113, 0, v113
  v_add_f32_dpp v148, v229, v148 quad_perm:[1,1,1,1] row_mask:0xf bank_mask:0xf
  v_add_f32_dpp v149, v231, v149 quad_perm:[3,3,3,3] row_mask:0xf bank_mask:0xf
  v_cvt_pk_bf16_f32 v114, 0, v114
  v_cvt_pk_bf16_f32 v115, 0, v115
  v_add_f32 v232, v148, v149
  v_pk_mul_f32 v[112:113], v[112:113], v[200:201]
  v_pk_mul_f32 v[114:115], v[114:115], v[202:203]
  v_cvt_pk_bf16_f32 v222, v112, v113
  v_cvt_pk_bf16_f32 v223, v114, v115
  s_waitcnt vmcnt(14)
  s_cbranch_vccnz L_kw0_29
  s_waitcnt vmcnt(10)
L_kw0_29:
  buffer_load_dwordx4 v[4:7], v93, s[16:19], s61 offen offset:2048 nt
  v_mfma_f32_16x16x32_bf16 v[228:231], v[220:223], v[172:175], 0
  v_pk_fma_f32 v[112:113], v[32:33], s[92:93], v[216:217] neg_lo:[0,0,1] neg_hi:[0,0,1]
  v_pk_fma_f32 v[114:115], v[34:35], s[92:93], v[218:219] neg_lo:[0,0,1] neg_hi:[0,0,1]
  v_cvt_pk_bf16_f32 v112, 0, v112
  v_cvt_pk_bf16_f32 v113, 0, v113
  v_cvt_pk_bf16_f32 v114, 0, v114
  v_cvt_pk_bf16_f32 v115, 0, v115
  v_pk_mul_f32 v[112:113], v[112:113], v[204:205]
  v_pk_mul_f32 v[114:115], v[114:115], v[206:207]
  v_cvt_pk_bf16_f32 v224, v112, v113
  v_cvt_pk_bf16_f32 v225, v114, v115
  s_waitcnt vmcnt(14)
  s_cbranch_vccnz L_kw0_30
  s_waitcnt vmcnt(10)
L_kw0_30:
  buffer_load_dwordx4 v[8:11], v93, s[16:19], s61 offen offset:2304 nt
  v_mfma_f32_16x16x16_bf16 v[228:231], v[224:225], v[176:177], v[228:231]
  v_pk_fma_f32 v[112:113], v[36:37], s[92:93], v[208:209] neg_lo:[0,0,1] neg_hi:[0,0,1]
  v_pk_fma_f32 v[114:115], v[38:39], s[92:93], v[210:211] neg_lo:[0,0,1] neg_hi:[0,0,1]
  v_cvt_pk_bf16_f32 v112, 0, v112
  v_cvt_pk_bf16_f32 v113, 0, v113
  v_cvt_pk_bf16_f32 v114, 0, v114
  v_cvt_pk_bf16_f32 v115, 0, v115
  v_pk_mul_f32 v[112:113], v[112:113], v[196:197]
  v_pk_mul_f32 v[114:115], v[114:115], v[198:199]
  v_cvt_pk_bf16_f32 v220, v112, v113
  v_cvt_pk_bf16_f32 v221, v114, v115
  s_waitcnt vmcnt(14)
  s_cbranch_vccnz L_kw0_31
  s_waitcnt vmcnt(10)
L_kw0_31:
  buffer_load_dwordx4 v[12:15], v93, s[16:19], s61 offen offset:2560 nt
  v_pk_fma_f32 v[112:113], v[40:41], s[92:93], v[212:213] neg_lo:[0,0,1] neg_hi:[0,0,1]
  v_pk_fma_f32 v[114:115], v[42:43], s[92:93], v[214:215] neg_lo:[0,0,1] neg_hi:[0,0,1]
  v_mov_b32_dpp v148, v228 quad_perm:[0,0,0,0] row_mask:0xf bank_mask:0xf
  v_mov_b32_dpp v149, v230 quad_perm:[2,2,2,2] row_mask:0xf bank_mask:0xf
  v_cvt_pk_bf16_f32 v112, 0, v112
  v_cvt_pk_bf16_f32 v113, 0, v113
  v_add_f32_dpp v148, v229, v148 quad_perm:[1,1,1,1] row_mask:0xf bank_mask:0xf
  v_add_f32_dpp v149, v231, v149 quad_perm:[3,3,3,3] row_mask:0xf bank_mask:0xf
  v_cvt_pk_bf16_f32 v114, 0, v114
  v_cvt_pk_bf16_f32 v115, 0, v115
  v_add_f32 v233, v148, v149
  v_pk_mul_f32 v[112:113], v[112:113], v[200:201]
  v_pk_mul_f32 v[114:115], v[114:115], v[202:203]
  v_cvt_pk_bf16_f32 v222, v112, v113
  v_cvt_pk_bf16_f32 v223, v114, v115
  s_waitcnt vmcnt(14)
  s_cbranch_vccnz L_kw0_32
  s_waitcnt vmcnt(10)
L_kw0_32:
  buffer_load_dwordx4 v[16:19], v93, s[16:19], s61 offen offset:2816 nt
  v_mfma_f32_16x16x32_bf16 v[228:231], v[220:223], v[172:175], 0
  v_pk_fma_f32 v[112:113], v[44:45], s[92:93], v[216:217] neg_lo:[0,0,1] neg_hi:[0,0,1]
  v_pk_fma_f32 v[114:115], v[46:47], s[92:93], v[218:219] neg_lo:[0,0,1] neg_hi:[0,0,1]
  v_cvt_pk_bf16_f32 v112, 0, v112
  v_cvt_pk_bf16_f32 v232, 0, v232
  v_cvt_pk_bf16_f32 v113, 0, v113
  v_cvt_pk_bf16_f32 v233, 0, v233
  v_cvt_pk_bf16_f32 v114, 0, v114
  v_pk_mul_f32 v[232:233], v[232:233], s[68:69]
  v_cvt_pk_bf16_f32 v115, 0, v115
  v_cvt_pk_bf16_f32 v128, v232, v233
  v_pk_mul_f32 v[112:113], v[112:113], v[204:205]
  v_pk_mul_f32 v[114:115], v[114:115], v[206:207]
  v_cvt_pk_bf16_f32 v224, v112, v113
  v_cvt_pk_bf16_f32 v225, v114, v115
  s_mov_b32 s60, s61
  v_mov_b32 v150, s64
  v_mfma_f32_16x16x16_bf16 v[228:231], v[224:225], v[176:177], v[228:231]
  ds_write_b128 v102, v[124:127]
  v_add_u32 v102, 768, v102
  s_nop 5
  v_mov_b32_dpp v148, v228 quad_perm:[0,0,0,0] row_mask:0xf bank_mask:0xf
  v_mov_b32_dpp v149, v230 quad_perm:[2,2,2,2] row_mask:0xf bank_mask:0xf
  s_nop 0
  v_add_f32_dpp v148, v229, v148 quad_perm:[1,1,1,1] row_mask:0xf bank_mask:0xf
  v_add_f32_dpp v149, v231, v149 quad_perm:[3,3,3,3] row_mask:0xf bank_mask:0xf
  v_add_f32 v232, v148, v149
  v_cndmask_b32 v232, v232, v240, s[50:51]
  v_cvt_pk_bf16_f32 v232, 0, v232
  v_cvt_pk_bf16_f32 v233, 0, v233
  v_pk_mul_f32 v[232:233], v[232:233], s[68:69]
  v_cvt_pk_bf16_f32 v129, v232, v233
  ds_write_b64 v103, v[128:129] offset:256
  ds_write_b32 v107, v150
  v_add_u32 v103, 768, v103
  v_add_u32 v148, s85, v97
  v_lshrrev_b32 v149, v148, s91
  v_and_b32 v149, 1, v149
  v_cmp_eq_u32 s[50:51], 1, v149
  s_nop 1
  s_and_b64 s[48:49], s[50:51], s[58:59]
  s_andn2_b64 s[50:51], s[50:51], s[58:59]
  s_add_u32 s64, s64, 2
  s_cmp_lt_u32 s64, s99
  s_cbranch_scc1 L_k_known1
L_k_spin1:
  v_mov_b32 v148, 61696
  ds_read_b32 v148, v148
  s_waitcnt lgkmcnt(0)
  v_readfirstlane_b32 s96, v148
  s_nop 1
  s_cmp_eq_u32 s96, 0
  s_cbranch_scc1 L_k_spin1
  s_mov_b32 s99, -1
  s_bitcmp1_b32 s96, 6
  s_cselect_b32 s97, 255, s97
L_k_known1:
  s_andn2_b32 s70, s64, 1
  s_or_b32 s70, s70, s4
  s_lshr_b32 s71, s64, 5
  s_lshr_b32 s85, s96, s71
  s_cmp_lt_u32 s64, s97
  s_cselect_b32 s70, s70, s64
  s_cselect_b32 s85, s64, s85
  s_and_b32 s85, s85, 1
  s_mul_i32 s71, s71, 4064
  s_add_u32 s70, s70, s71
  s_add_u32 s70, s70, s5
  s_mul_hi_u32 s84, s70, s90
  s_lshr_b32 s84, s84, 1
  s_mul_i32 s71, s84, 3
  s_sub_u32 s70, s70, s71
  s_lshl3_add_u32 s85, s70, s85
  s_mul_i32 s61, s84, 196608
  s_lshr_b32 s89, s84, 4
  s_lshl_b32 s70, s85, 5
  v_add_u32 v100, s70, v234
  v_mul_u32_u24 v100, 21846, v100
  v_lshrrev_b32 v100, 16, v100
  v_add_u32 v148, s85, v235
  v_lshrrev_b32 v149, v148, s91
  v_and_b32 v149, 1, v149
  v_cmp_eq_u32 s[54:55], 1, v149
  s_nop 1
  s_and_b64 s[52:53], s[54:55], s[56:57]
  s_andn2_b64 s[54:55], s[54:55], s[56:57]
  v_mul_u32_u24 v148, 43, v148
  v_lshrrev_b32 v148, 8, v148
  v_mul_u32_u24 v148, 384, v148
  v_add_u32 v238, v148, v237
  ds_read_b32 v110, v109
  s_waitcnt vmcnt(14)
  s_cbranch_vccnz L_kw1_0
  s_waitcnt vmcnt(10)
L_kw1_0:
  buffer_load_dwordx4 v[20:23], v93, s[8:11], s60 offen offset:3072 nt
  v_lshlrev_b32 v208, 16, v190
  v_and_b32 v209, s65, v190
  v_lshlrev_b32 v210, 16, v191
  v_and_b32 v211, s65, v191
  v_lshlrev_b32 v196, 16, v184
  v_and_b32 v197, s65, v184
  v_lshlrev_b32 v198, 16, v185
  v_and_b32 v199, s65, v185
  v_pk_mul_f32 v[208:209], v[208:209], s[94:95]
  v_mov_b32 v172, v178
  v_pk_mul_f32 v[210:211], v[210:211], s[94:95]
  v_mov_b32 v173, v179
  v_pk_fma_f32 v[112:113], v[48:49], s[92:93], v[208:209] neg_lo:[0,0,1] neg_hi:[0,0,1]
  v_pk_fma_f32 v[114:115], v[50:51], s[92:93], v[210:211] neg_lo:[0,0,1] neg_hi:[0,0,1]
  v_cvt_pk_bf16_f32 v112, 0, v112
  v_cvt_pk_bf16_f32 v113, 0, v113
  v_cvt_pk_bf16_f32 v114, 0, v114
  v_cvt_pk_bf16_f32 v115, 0, v115
  v_pk_mul_f32 v[112:113], v[112:113], v[196:197]
  v_pk_mul_f32 v[114:115], v[114:115], v[198:199]
  v_cvt_pk_bf16_f32 v220, v112, v113
  v_cvt_pk_bf16_f32 v221, v114, v115
  s_waitcnt lgkmcnt(0)
  s_sub_u32 s70, s64, 2
  v_cmp_lt_u32 vcc, s70, v110
  s_waitcnt vmcnt(14)
  s_cbranch_vccnz L_kw1_1
  s_waitcnt vmcnt(10)
L_kw1_1:
  buffer_load_dwordx4 v[24:27], v93, s[8:11], s60 offen offset:3328 nt
  v_lshlrev_b32 v212, 16, v192
  v_and_b32 v213, s65, v192
  v_lshlrev_b32 v214, 16, v193
  v_and_b32 v215, s65, v193
  v_lshlrev_b32 v200, 16, v186
  v_and_b32 v201, s65, v186
  v_lshlrev_b32 v202, 16, v187
  v_and_b32 v203, s65, v187
  v_pk_mul_f32 v[212:213], v[212:213], s[94:95]
  v_mov_b32 v174, v180
  v_pk_mul_f32 v[214:215], v[214:215], s[94:95]
  v_mov_b32 v175, v181
  v_pk_fma_f32 v[112:113], v[52:53], s[92:93], v[212:213] neg_lo:[0,0,1] neg_hi:[0,0,1]
  v_pk_fma_f32 v[114:115], v[54:55], s[92:93], v[214:215] neg_lo:[0,0,1] neg_hi:[0,0,1]
  v_cvt_pk_bf16_f32 v112, 0, v112
  v_cvt_pk_bf16_f32 v113, 0, v113
  v_cvt_pk_bf16_f32 v114, 0, v114
  v_cvt_pk_bf16_f32 v115, 0, v115
  v_pk_mul_f32 v[112:113], v[112:113], v[200:201]
  v_pk_mul_f32 v[114:115], v[114:115], v[202:203]
  v_cvt_pk_bf16_f32 v222, v112, v113
  v_cvt_pk_bf16_f32 v223, v114, v115
  s_waitcnt vmcnt(14)
  s_cbranch_vccnz L_kw1_2
  s_waitcnt vmcnt(10)
L_kw1_2:
  buffer_load_dwordx4 v[28:31], v93, s[8:11], s60 offen offset:3584 nt
  v_mfma_f32_16x16x32_bf16 v[228:231], v[220:223], v[172:175], 0
  v_lshlrev_b32 v216, 16, v194
  v_and_b32 v217, s65, v194
  v_lshlrev_b32 v218, 16, v195
  v_and_b32 v219, s65, v195
  v_lshlrev_b32 v204, 16, v188
  v_and_b32 v205, s65, v188
  v_lshlrev_b32 v206, 16, v189
  v_and_b32 v207, s65, v189
  v_pk_mul_f32 v[216:217], v[216:217], s[94:95]
  v_mov_b32 v176, v182
  v_pk_mul_f32 v[218:219], v[218:219], s[94:95]
  v_mov_b32 v177, v183
  v_pk_fma_f32 v[112:113], v[56:57], s[92:93], v[216:217] neg_lo:[0,0,1] neg_hi:[0,0,1]
  v_pk_fma_f32 v[114:115], v[58:59], s[92:93], v[218:219] neg_lo:[0,0,1] neg_hi:[0,0,1]
  v_cvt_pk_bf16_f32 v112, 0, v112
  v_cvt_pk_bf16_f32 v113, 0, v113
  v_cvt_pk_bf16_f32 v114, 0, v114
  v_cvt_pk_bf16_f32 v115, 0, v115
  v_pk_mul_f32 v[112:113], v[112:113], v[204:205]
  v_pk_mul_f32 v[114:115], v[114:115], v[206:207]
  v_cvt_pk_bf16_f32 v224, v112, v113
  v_cvt_pk_bf16_f32 v225, v114, v115
  s_waitcnt vmcnt(14)
  s_cbranch_vccnz L_kw1_3
  s_waitcnt vmcnt(10)
L_kw1_3:
  buffer_load_dwordx4 v[32:35], v94, s[8:11], s60 offen offset:0 nt
  v_mfma_f32_16x16x16_bf16 v[228:231], v[224:225], v[176:177], v[228:231]
  v_pk_fma_f32 v[112:113], v[60:61], s[92:93], v[208:209] neg_lo:[0,0,1] neg_hi:[0,0,1]
  v_pk_fma_f32 v[114:115], v[62:63], s[92:93], v[210:211] neg_lo:[0,0,1] neg_hi:[0,0,1]
  s_cmp_eq_u32 s89, s88
  s_cbranch_scc1 L_k_sameq1
  s_mul_i32 s70, s89, 1536
  buffer_load_dwordx2 v[178:179], v239, s[36:39], s70 offen offset:0
  buffer_load_dwordx2 v[180:181], v239, s[36:39], s70 offen offset:128
  buffer_load_dwordx2 v[182:183], v239, s[36:39], s70 offen offset:256
  s_mov_b32 s88, s89
L_k_sameq1:
  s_mul_i32 s62, s84, 1536
  buffer_load_dwordx2 v[184:185], v238, s[20:23], s62 offen offset:0
  buffer_load_dwordx2 v[190:191], v238, s[24:27], s62 offen offset:0
  buffer_load_dwordx2 v[186:187], v238, s[20:23], s62 offen offset:128
  buffer_load_dwordx2 v[192:193], v238, s[24:27], s62 offen offset:128
  buffer_load_dwordx2 v[188:189], v238, s[20:23], s62 offen offset:256
  buffer_load_dwordx2 v[194:195], v238, s[24:27], s62 offen offset:256
  v_cvt_pk_bf16_f32 v112, 0, v112
  v_cvt_pk_bf16_f32 v113, 0, v113
  v_cvt_pk_bf16_f32 v114, 0, v114
  v_cvt_pk_bf16_f32 v115, 0, v115
  v_pk_mul_f32 v[112:113], v[112:113], v[196:197]
  v_pk_mul_f32 v[114:115], v[114:115], v[198:199]
  v_cvt_pk_bf16_f32 v220, v112, v113
  v_cvt_pk_bf16_f32 v221, v114, v115
  s_waitcnt vmcnt(20)
  s_cbranch_vccnz L_kw1_4
  s_waitcnt vmcnt(16)
L_kw1_4:
  buffer_load_dwordx4 v[36:39], v94, s[8:11], s60 offen offset:256 nt
  v_pk_fma_f32 v[112:113], v[64:65], s[92:93], v[212:213] neg_lo:[0,0,1] neg_hi:[0,0,1]
  v_pk_fma_f32 v[114:115], v[66:67], s[92:93], v[214:215] neg_lo:[0,0,1] neg_hi:[0,0,1]
  v_mov_b32_dpp v148, v228 quad_perm:[0,0,0,0] row_mask:0xf bank_mask:0xf
  v_mov_b32_dpp v149, v230 quad_perm:[2,2,2,2] row_mask:0xf bank_mask:0xf
  v_cvt_pk_bf16_f32 v112, 0, v112
  v_cvt_pk_bf16_f32 v113, 0, v113
  v_add_f32_dpp v148, v229, v148 quad_perm:[1,1,1,1] row_mask:0xf bank_mask:0xf
  v_add_f32_dpp v149, v231, v149 quad_perm:[3,3,3,3] row_mask:0xf bank_mask:0xf
  v_cvt_pk_bf16_f32 v114, 0, v114
  v_cvt_pk_bf16_f32 v115, 0, v115
  v_add_f32 v232, v148, v149
  v_pk_mul_f32 v[112:113], v[112:113], v[200:201]
  v_pk_mul_f32 v[114:115], v[114:115], v[202:203]
  v_cvt_pk_bf16_f32 v222, v112, v113
  v_cvt_pk_bf16_f32 v223, v114, v115
  s_waitcnt vmcnt(20)
  s_cbranch_vccnz L_kw1_5
  s_waitcnt vmcnt(16)
L_kw1_5:
  buffer_load_dwordx4 v[40:43], v94, s[8:11], s60 offen offset:512 nt
  v_mfma_f32_16x16x32_bf16 v[228:231], v[220:223], v[172:175], 0
  v_pk_fma_f32 v[112:113], v[68:69], s[92:93], v[216:217] neg_lo:[0,0,1] neg_hi:[0,0,1]
  v_pk_fma_f32 v[114:115], v[70:71], s[92:93], v[218:219] neg_lo:[0,0,1] neg_hi:[0,0,1]
  v_cvt_pk_bf16_f32 v112, 0, v112
  v_cndmask_b32 v232, v232, v240, s[48:49]
  v_cvt_pk_bf16_f32 v113, 0, v113
  v_cvt_pk_bf16_f32 v114, 0, v114
  v_cvt_pk_bf16_f32 v115, 0, v115
  v_pk_mul_f32 v[112:113], v[112:113], v[204:205]
  v_pk_mul_f32 v[114:115], v[114:115], v[206:207]
  v_cvt_pk_bf16_f32 v224, v112, v113
  v_cvt_pk_bf16_f32 v225, v114, v115
  s_waitcnt vmcnt(20)
  s_cbranch_vccnz L_kw1_6
  s_waitcnt vmcnt(16)
L_kw1_6:
  buffer_load_dwordx4 v[44:47], v94, s[8:11], s60 offen offset:768 nt
  v_mfma_f32_16x16x16_bf16 v[228:231], v[224:225], v[176:177], v[228:231]
  v_pk_fma_f32 v[112:113], v[72:73], s[92:93], v[208:209] neg_lo:[0,0,1] neg_hi:[0,0,1]
  v_pk_fma_f32 v[114:115], v[74:75], s[92:93], v[210:211] neg_lo:[0,0,1] neg_hi:[0,0,1]
  v_cvt_pk_bf16_f32 v112, 0, v112
  v_cvt_pk_bf16_f32 v113, 0, v113
  v_cvt_pk_bf16_f32 v114, 0, v114
  v_cvt_pk_bf16_f32 v115, 0, v115
  v_pk_mul_f32 v[112:113], v[112:113], v[196:197]
  v_pk_mul_f32 v[114:115], v[114:115], v[198:199]
  v_cvt_pk_bf16_f32 v220, v112, v113
  v_cvt_pk_bf16_f32 v221, v114, v115
  s_waitcnt vmcnt(20)
  s_cbranch_vccnz L_kw1_7
  s_waitcnt vmcnt(16)
L_kw1_7:
  buffer_load_dwordx4 v[48:51], v94, s[8:11], s60 offen offset:1024 nt
  v_pk_fma_f32 v[112:113], v[76:77], s[92:93], v[212:213] neg_lo:[0,0,1] neg_hi:[0,0,1]
  v_pk_fma_f32 v[114:115], v[78:79], s[92:93], v[214:215] neg_lo:[0,0,1] neg_hi:[0,0,1]
  v_mov_b32_dpp v148, v228 quad_perm:[0,0,0,0] row_mask:0xf bank_mask:0xf
  v_mov_b32_dpp v149, v230 quad_perm:[2,2,2,2] row_mask:0xf bank_mask:0xf
  v_cvt_pk_bf16_f32 v112, 0, v112
  v_cvt_pk_bf16_f32 v113, 0, v113
  v_add_f32_dpp v148, v229, v148 quad_perm:[1,1,1,1] row_mask:0xf bank_mask:0xf
  v_add_f32_dpp v149, v231, v149 quad_perm:[3,3,3,3] row_mask:0xf bank_mask:0xf
  v_cvt_pk_bf16_f32 v114, 0, v114
  v_cvt_pk_bf16_f32 v115, 0, v115
  v_add_f32 v233, v148, v149
  v_pk_mul_f32 v[112:113], v[112:113], v[200:201]
  v_pk_mul_f32 v[114:115], v[114:115], v[202:203]
  v_cvt_pk_bf16_f32 v222, v112, v113
  v_cvt_pk_bf16_f32 v223, v114, v115
  s_waitcnt vmcnt(20)
  s_cbranch_vccnz L_kw1_8
  s_waitcnt vmcnt(16)
L_kw1_8:
  buffer_load_dwordx4 v[52:55], v94, s[8:11], s60 offen offset:1280 nt
  v_mfma_f32_16x16x32_bf16 v[228:231], v[220:223], v[172:175], 0
  v_pk_fma_f32 v[112:113], v[80:81], s[92:93], v[216:217] neg_lo:[0,0,1] neg_hi:[0,0,1]
  v_pk_fma_f32 v[114:115], v[82:83], s[92:93], v[218:219] neg_lo:[0,0,1] neg_hi:[0,0,1]
  v_cvt_pk_bf16_f32 v112, 0, v112
  v_cvt_pk_bf16_f32 v232, 0, v232
  v_cvt_pk_bf16_f32 v113, 0, v113
  v_cvt_pk_bf16_f32 v233, 0, v233
  v_cvt_pk_bf16_f32 v114, 0, v114
  v_pk_mul_f32 v[232:233], v[232:233], s[68:69]
  v_cvt_pk_bf16_f32 v115, 0, v115
  v_cvt_pk_bf16_f32 v124, v232, v233
  v_pk_mul_f32 v[112:113], v[112:113], v[204:205]
  v_pk_mul_f32 v[114:115], v[114:115], v[206:207]
  v_cvt_pk_bf16_f32 v224, v112, v113
  v_cvt_pk_bf16_f32 v225, v114, v115
  s_waitcnt vmcnt(20)
  s_cbranch_vccnz L_kw1_9
  s_waitcnt vmcnt(16)
L_kw1_9:
  buffer_load_dwordx4 v[56:59], v94, s[8:11], s60 offen offset:1536 nt
  v_mfma_f32_16x16x16_bf16 v[228:231], v[224:225], v[176:177], v[228:231]
  v_pk_fma_f32 v[112:113], v[84:85], s[92:93], v[208:209] neg_lo:[0,0,1] neg_hi:[0,0,1]
  v_pk_fma_f32 v[114:115], v[86:87], s[92:93], v[210:211] neg_lo:[0,0,1] neg_hi:[0,0,1]
  v_cvt_pk_bf16_f32 v112, 0, v112
  v_cvt_pk_bf16_f32 v113, 0, v113
  v_cvt_pk_bf16_f32 v114, 0, v114
  v_cvt_pk_bf16_f32 v115, 0, v115
  v_pk_mul_f32 v[112:113], v[112:113], v[196:197]
  v_pk_mul_f32 v[114:115], v[114:115], v[198:199]
  v_cvt_pk_bf16_f32 v220, v112, v113
  v_cvt_pk_bf16_f32 v221, v114, v115
  s_waitcnt vmcnt(20)
  s_cbranch_vccnz L_kw1_10
  s_waitcnt vmcnt(16)
L_kw1_10:
  buffer_load_dwordx4 v[60:63], v94, s[8:11], s60 offen offset:1792 nt
  v_pk_fma_f32 v[112:113], v[88:89], s[92:93], v[212:213] neg_lo:[0,0,1] neg_hi:[0,0,1]
  v_pk_fma_f32 v[114:115], v[90:91], s[92:93], v[214:215] neg_lo:[0,0,1] neg_hi:[0,0,1]
  v_mov_b32_dpp v148, v228 quad_perm:[0,0,0,0] row_mask:0xf bank_mask:0xf
  v_mov_b32_dpp v149, v230 quad_perm:[2,2,2,2] row_mask:0xf bank_mask:0xf
  v_cvt_pk_bf16_f32 v112, 0, v112
  v_cvt_pk_bf16_f32 v113, 0, v113
  v_add_f32_dpp v148, v229, v148 quad_perm:[1,1,1,1] row_mask:0xf bank_mask:0xf
  v_add_f32_dpp v149, v231, v149 quad_perm:[3,3,3,3] row_mask:0xf bank_mask:0xf
  v_cvt_pk_bf16_f32 v114, 0, v114
  v_cvt_pk_bf16_f32 v115, 0, v115
  v_add_f32 v232, v148, v149
  v_pk_mul_f32 v[112:113], v[112:113], v[200:201]
  v_pk_mul_f32 v[114:115], v[114:115], v[202:203]
  v_cvt_pk_bf16_f32 v222, v112, v113
  v_cvt_pk_bf16_f32 v223, v114, v115
  s_waitcnt vmcnt(20)
  s_cbranch_vccnz L_kw1_11
  s_waitcnt vmcnt(16)
L_kw1_11:
  buffer_load_dwordx4 v[64:67], v94, s[8:11], s60 offen offset:2048 nt
  v_mfma_f32_16x16x32_bf16 v[228:231], v[220:223], v[172:175], 0
  v_pk_fma_f32 v[112:113], v[4:5], s[92:93], v[216:217] neg_lo:[0,0,1] neg_hi:[0,0,1]
  v_pk_fma_f32 v[114:115], v[6:7], s[92:93], v[218:219] neg_lo:[0,0,1] neg_hi:[0,0,1]
  v_cvt_pk_bf16_f32 v112, 0, v112
  v_cvt_pk_bf16_f32 v113, 0, v113
  v_cvt_pk_bf16_f32 v114, 0, v114
  v_cvt_pk_bf16_f32 v115, 0, v115
  v_pk_mul_f32 v[112:113], v[112:113], v[204:205]
  v_pk_mul_f32 v[114:115], v[114:115], v[206:207]
  v_cvt_pk_bf16_f32 v224, v112, v113
  v_cvt_pk_bf16_f32 v225, v114, v115
  s_waitcnt vmcnt(20)
  s_cbranch_vccnz L_kw1_12
  s_waitcnt vmcnt(16)
L_kw1_12:
  buffer_load_dwordx4 v[68:71], v94, s[8:11], s60 offen offset:2304 nt
  v_mfma_f32_16x16x16_bf16 v[228:231], v[224:225], v[176:177], v[228:231]
  v_pk_fma_f32 v[112:113], v[8:9], s[92:93], v[208:209] neg_lo:[0,0,1] neg_hi:[0,0,1]
  v_pk_fma_f32 v[114:115], v[10:11], s[92:93], v[210:211] neg_lo:[0,0,1] neg_hi:[0,0,1]
  v_cvt_pk_bf16_f32 v112, 0, v112
  v_cvt_pk_bf16_f32 v113, 0, v113
  v_cvt_pk_bf16_f32 v114, 0, v114
  v_cvt_pk_bf16_f32 v115, 0, v115
  v_pk_mul_f32 v[112:113], v[112:113], v[196:197]
  v_pk_mul_f32 v[114:115], v[114:115], v[198:199]
  v_cvt_pk_bf16_f32 v220, v112, v113
  v_cvt_pk_bf16_f32 v221, v114, v115
  s_waitcnt vmcnt(20)
  s_cbranch_vccnz L_kw1_13
  s_waitcnt vmcnt(16)
L_kw1_13:
  buffer_load_dwordx4 v[72:75], v94, s[8:11], s60 offen offset:2560 nt
  v_pk_fma_f32 v[112:113], v[12:13], s[92:93], v[212:213] neg_lo:[0,0,1] neg_hi:[0,0,1]
  v_pk_fma_f32 v[114:115], v[14:15], s[92:93], v[214:215] neg_lo:[0,0,1] neg_hi:[0,0,1]
  v_mov_b32_dpp v148, v228 quad_perm:[0,0,0,0] row_mask:0xf bank_mask:0xf
  v_mov_b32_dpp v149, v230 quad_perm:[2,2,2,2] row_mask:0xf bank_mask:0xf
  v_cvt_pk_bf16_f32 v112, 0, v112
  v_cvt_pk_bf16_f32 v113, 0, v113
  v_add_f32_dpp v148, v229, v148 quad_perm:[1,1,1,1] row_mask:0xf bank_mask:0xf
  v_add_f32_dpp v149, v231, v149 quad_perm:[3,3,3,3] row_mask:0xf bank_mask:0xf
  v_cvt_pk_bf16_f32 v114, 0, v114
  v_cvt_pk_bf16_f32 v115, 0, v115
  v_add_f32 v233, v148, v149
  v_pk_mul_f32 v[112:113], v[112:113], v[200:201]
  v_pk_mul_f32 v[114:115], v[114:115], v[202:203]
  v_cvt_pk_bf16_f32 v222, v112, v113
  v_cvt_pk_bf16_f32 v223, v114, v115
  s_waitcnt vmcnt(20)
  s_cbranch_vccnz L_kw1_14
  s_waitcnt vmcnt(16)
L_kw1_14:
  buffer_load_dwordx4 v[76:79], v94, s[8:11], s60 offen offset:2816 nt
  v_mfma_f32_16x16x32_bf16 v[228:231], v[220:223], v[172:175], 0
  v_pk_fma_f32 v[112:113], v[16:17], s[92:93], v[216:217] neg_lo:[0,0,1] neg_hi:[0,0,1]
  v_pk_fma_f32 v[114:115], v[18:19], s[92:93], v[218:219] neg_lo:[0,0,1] neg_hi:[0,0,1]
  v_cvt_pk_bf16_f32 v112, 0, v112
  v_cvt_pk_bf16_f32 v232, 0, v232
  v_cvt_pk_bf16_f32 v113, 0, v113
  v_cvt_pk_bf16_f32 v233, 0, v233
  v_cvt_pk_bf16_f32 v114, 0, v114
  v_pk_mul_f32 v[232:233], v[232:233], s[68:69]
  v_cvt_pk_bf16_f32 v115, 0, v115
  v_cvt_pk_bf16_f32 v125, v232, v233
  v_pk_mul_f32 v[112:113], v[112:113], v[204:205]
  v_pk_mul_f32 v[114:115], v[114:115], v[206:207]
  v_cvt_pk_bf16_f32 v224, v112, v113
  v_cvt_pk_bf16_f32 v225, v114, v115
  s_waitcnt vmcnt(20)
  s_cbranch_vccnz L_kw1_15
  s_waitcnt vmcnt(10)
L_kw1_15:
  buffer_load_dwordx4 v[80:83], v95, s[8:11], s60 offen offset:0 nt
  v_mfma_f32_16x16x16_bf16 v[228:231], v[224:225], v[176:177], v[228:231]
  v_pk_fma_f32 v[112:113], v[20:21], s[92:93], v[208:209] neg_lo:[0,0,1] neg_hi:[0,0,1]
  v_pk_fma_f32 v[114:115], v[22:23], s[92:93], v[210:211] neg_lo:[0,0,1] neg_hi:[0,0,1]
  v_cvt_pk_bf16_f32 v112, 0, v112
  v_cvt_pk_bf16_f32 v113, 0, v113
  v_cvt_pk_bf16_f32 v114, 0, v114
  v_cvt_pk_bf16_f32 v115, 0, v115
  v_pk_mul_f32 v[112:113], v[112:113], v[196:197]
  v_pk_mul_f32 v[114:115], v[114:115], v[198:199]
  v_cvt_pk_bf16_f32 v220, v112, v113
  v_cvt_pk_bf16_f32 v221, v114, v115
  s_waitcnt vmcnt(20)
  s_cbranch_vccnz L_kw1_16
  s_waitcnt vmcnt(10)
L_kw1_16:
  buffer_load_dwordx4 v[84:87], v95, s[8:11], s60 offen offset:256 nt
  v_pk_fma_f32 v[112:113], v[24:25], s[92:93], v[212:213] neg_lo:[0,0,1] neg_hi:[0,0,1]
  v_pk_fma_f32 v[114:115], v[26:27], s[92:93], v[214:215] neg_lo:[0,0,1] neg_hi:[0,0,1]
  v_mov_b32_dpp v148, v228 quad_perm:[0,0,0,0] row_mask:0xf bank_mask:0xf
  v_mov_b32_dpp v149, v230 quad_perm:[2,2,2,2] row_mask:0xf bank_mask:0xf
  v_cvt_pk_bf16_f32 v112, 0, v112
  v_cvt_pk_bf16_f32 v113, 0, v113
  v_add_f32_dpp v148, v229, v148 quad_perm:[1,1,1,1] row_mask:0xf bank_mask:0xf
  v_add_f32_dpp v149, v231, v149 quad_perm:[3,3,3,3] row_mask:0xf bank_mask:0xf
  v_cvt_pk_bf16_f32 v114, 0, v114
  v_cvt_pk_bf16_f32 v115, 0, v115
  v_add_f32 v232, v148, v149
  v_pk_mul_f32 v[112:113], v[112:113], v[200:201]
  v_pk_mul_f32 v[114:115], v[114:115], v[202:203]
  v_cvt_pk_bf16_f32 v222, v112, v113
  v_cvt_pk_bf16_f32 v223, v114, v115
  s_waitcnt vmcnt(20)
  s_cbranch_vccnz L_kw1_17
  s_waitcnt vmcnt(10)
L_kw1_17:
  buffer_load_dwordx4 v[88:91], v95, s[8:11], s60 offen offset:512 nt
  v_mfma_f32_16x16x32_bf16 v[228:231], v[220:223], v[172:175], 0
  v_pk_fma_f32 v[112:113], v[28:29], s[92:93], v[216:217] neg_lo:[0,0,1] neg_hi:[0,0,1]
  v_pk_fma_f32 v[114:115], v[30:31], s[92:93], v[218:219] neg_lo:[0,0,1] neg_hi:[0,0,1]
  v_cvt_pk_bf16_f32 v112, 0, v112
  v_cvt_pk_bf16_f32 v113, 0, v113
  v_cvt_pk_bf16_f32 v114, 0, v114
  v_cvt_pk_bf16_f32 v115, 0, v115
  v_pk_mul_f32 v[112:113], v[112:113], v[204:205]
  v_pk_mul_f32 v[114:115], v[114:115], v[206:207]
  v_cvt_pk_bf16_f32 v224, v112, v113
  v_cvt_pk_bf16_f32 v225, v114, v115
  s_cmp_lt_u32 s64, 96
  s_cbranch_scc1 L_k_keep1
  s_bitcmp1_b32 s96, 6
  s_cselect_b32 s97, 255, 0
  v_mov_b32 v152, v148
  v_mov_b32 v153, v149
  s_andn2_b32 s70, s3, 1
  s_or_b32 s70, s70, s4
  s_lshr_b32 s71, s3, 5
  s_lshr_b32 s85, s96, s71
  s_lshr_b32 s85, s85, 3
  s_cmp_lt_u32 s3, s97
  s_cselect_b32 s70, s70, s3
  s_cselect_b32 s85, s3, s85
  s_and_b32 s85, s85, 1
  s_mul_i32 s71, s71, 4064
  s_add_u32 s70, s70, s71
  s_add_u32 s70, s70, s5
  s_mul_hi_u32 s84, s70, s90
  s_lshr_b32 s84, s84, 1
  s_mul_i32 s71, s84, 3
  s_sub_u32 s70, s70, s71
  s_lshl3_add_u32 s85, s70, s85
  s_mul_i32 s61, s84, 196608
  s_lshr_b32 s89, s84, 4
  s_lshl_b32 s70, s85, 5
  v_add_u32 v100, s70, v96
  v_mul_u32_u24 v100, 21846, v100
  v_lshrrev_b32 v100, 16, v100
  v_add_u32 v148, s85, v97
  v_lshrrev_b32 v149, v148, s91
  v_and_b32 v149, 1, v149
  v_cmp_eq_u32 s[54:55], 1, v149
  s_nop 1
  s_and_b64 s[52:53], s[54:55], s[58:59]
  s_andn2_b64 s[54:55], s[54:55], s[58:59]
  v_mov_b32 v148, v152
  v_mov_b32 v149, v153
  s_mov_b32 s16, s12
  s_mov_b32 s17, s13
  s_lshl_b32 s62, s84, 9
  v_lshl_add_u32 v101, v100, 1, v99
  buffer_load_short_d16_hi v116, v101, s[32:35], s62 offen
  buffer_load_short_d16_hi v117, v101, s[28:31], s62 offen
  v_mov_b32 v236, v98
L_k_keep1:
  v_mad_u32_u24 v92, v100, s63, v236
  v_add_u32 v93, 768, v92
  v_add_u32 v94, 4608, v92
  v_add_u32 v95, 7680, v92
  v_cndmask_b32 v92, v92, v108, s[52:53]
  v_cndmask_b32 v95, v95, v108, s[54:55]
  s_waitcnt vmcnt(20)
  s_cbranch_vccnz L_kw1_18
  s_waitcnt vmcnt(10)
L_kw1_18:
  buffer_load_dwordx4 v[4:7], v92, s[16:19], s61 offen offset:0 nt
  v_mfma_f32_16x16x16_bf16 v[228:231], v[224:225], v[176:177], v[228:231]
  v_pk_fma_f32 v[112:113], v[32:33], s[92:93], v[208:209] neg_lo:[0,0,1] neg_hi:[0,0,1]
  v_pk_fma_f32 v[114:115], v[34:35], s[92:93], v[210:211] neg_lo:[0,0,1] neg_hi:[0,0,1]
  v_cvt_pk_bf16_f32 v112, 0, v112
  v_cvt_pk_bf16_f32 v113, 0, v113
  v_cvt_pk_bf16_f32 v114, 0, v114
  v_cvt_pk_bf16_f32 v115, 0, v115
  v_pk_mul_f32 v[112:113], v[112:113], v[196:197]
  v_pk_mul_f32 v[114:115], v[114:115], v[198:199]
  v_cvt_pk_bf16_f32 v220, v112, v113
  v_cvt_pk_bf16_f32 v221, v114, v115
  s_waitcnt vmcnt(14)
  s_cbranch_vccnz L_kw1_19
  s_waitcnt vmcnt(10)
L_kw1_19:
  buffer_load_dwordx4 v[8:11], v92, s[16:19], s61 offen offset:256 nt
  v_pk_fma_f32 v[112:113], v[36:37], s[92:93], v[212:213] neg_lo:[0,0,1] neg_hi:[0,0,1]
  v_pk_fma_f32 v[114:115], v[38:39], s[92:93], v[214:215] neg_lo:[0,0,1] neg_hi:[0,0,1]
  v_mov_b32_dpp v148, v228 quad_perm:[0,0,0,0] row_mask:0xf bank_mask:0xf
  v_mov_b32_dpp v149, v230 quad_perm:[2,2,2,2] row_mask:0xf bank_mask:0xf
  v_cvt_pk_bf16_f32 v112, 0, v112
  v_cvt_pk_bf16_f32 v113, 0, v113
  v_add_f32_dpp v148, v229, v148 quad_perm:[1,1,1,1] row_mask:0xf bank_mask:0xf
  v_add_f32_dpp v149, v231, v149 quad_perm:[3,3,3,3] row_mask:0xf bank_mask:0xf
  v_cvt_pk_bf16_f32 v114, 0, v114
  v_cvt_pk_bf16_f32 v115, 0, v115
  v_add_f32 v233, v148, v149
  v_pk_mul_f32 v[112:113], v[112:113], v[200:201]
  v_pk_mul_f32 v[114:115], v[114:115], v[202:203]
  v_cvt_pk_bf16_f32 v222, v112, v113
  v_cvt_pk_bf16_f32 v223, v114, v115
  s_waitcnt vmcnt(14)
  s_cbranch_vccnz L_kw1_20
  s_waitcnt vmcnt(10)
L_kw1_20:
  buffer_load_dwordx4 v[12:15], v92, s[16:19], s61 offen offset:512 nt
  v_mfma_f32_16x16x32_bf16 v[228:231], v[220:223], v[172:175], 0
  v_pk_fma_f32 v[112:113], v[40:41], s[92:93], v[216:217] neg_lo:[0,0,1] neg_hi:[0,0,1]
  v_pk_fma_f32 v[114:115], v[42:43], s[92:93], v[218:219] neg_lo:[0,0,1] neg_hi:[0,0,1]
  v_cvt_pk_bf16_f32 v112, 0, v112
  v_cvt_pk_bf16_f32 v232, 0, v232
  v_cvt_pk_bf16_f32 v113, 0, v113
  v_cvt_pk_bf16_f32 v233, 0, v233
  v_cvt_pk_bf16_f32 v114, 0, v114
  v_pk_mul_f32 v[232:233], v[232:233], s[68:69]
  v_cvt_pk_bf16_f32 v115, 0, v115
  v_cvt_pk_bf16_f32 v126, v232, v233
  v_pk_mul_f32 v[112:113], v[112:113], v[204:205]
  v_pk_mul_f32 v[114:115], v[114:115], v[206:207]
  v_cvt_pk_bf16_f32 v224, v112, v113
  v_cvt_pk_bf16_f32 v225, v114, v115
  s_waitcnt vmcnt(14)
  s_cbranch_vccnz L_kw1_21
  s_waitcnt vmcnt(10)
L_kw1_21:
  buffer_load_dwordx4 v[16:19], v93, s[16:19], s61 offen offset:0 nt
  v_mfma_f32_16x16x16_bf16 v[228:231], v[224:225], v[176:177], v[228:231]
  v_pk_fma_f32 v[112:113], v[44:45], s[92:93], v[208:209] neg_lo:[0,0,1] neg_hi:[0,0,1]
  v_pk_fma_f32 v[114:115], v[46:47], s[92:93], v[210:211] neg_lo:[0,0,1] neg_hi:[0,0,1]
  v_cvt_pk_bf16_f32 v112, 0, v112
  v_cvt_pk_bf16_f32 v113, 0, v113
  v_cvt_pk_bf16_f32 v114, 0, v114
  v_cvt_pk_bf16_f32 v115, 0, v115
  v_pk_mul_f32 v[112:113], v[112:113], v[196:197]
  v_pk_mul_f32 v[114:115], v[114:115], v[198:199]
  v_cvt_pk_bf16_f32 v220, v112, v113
  v_cvt_pk_bf16_f32 v221, v114, v115
  s_waitcnt vmcnt(14)
  s_cbranch_vccnz L_kw1_22
  s_waitcnt vmcnt(10)
L_kw1_22:
  buffer_load_dwordx4 v[20:23], v93, s[16:19], s61 offen offset:256 nt
  v_pk_fma_f32 v[112:113], v[48:49], s[92:93], v[212:213] neg_lo:[0,0,1] neg_hi:[0,0,1]
  v_pk_fma_f32 v[114:115], v[50:51], s[92:93], v[214:215] neg_lo:[0,0,1] neg_hi:[0,0,1]
  v_mov_b32_dpp v148, v228 quad_perm:[0,0,0,0] row_mask:0xf bank_mask:0xf
  v_mov_b32_dpp v149, v230 quad_perm:[2,2,2,2] row_mask:0xf bank_mask:0xf
  v_cvt_pk_bf16_f32 v112, 0, v112
  v_cvt_pk_bf16_f32 v113, 0, v113
  v_add_f32_dpp v148, v229, v148 quad_perm:[1,1,1,1] row_mask:0xf bank_mask:0xf
  v_add_f32_dpp v149, v231, v149 quad_perm:[3,3,3,3] row_mask:0xf bank_mask:0xf
  v_cvt_pk_bf16_f32 v114, 0, v114
  v_cvt_pk_bf16_f32 v115, 0, v115
  v_add_f32 v232, v148, v149
  v_pk_mul_f32 v[112:113], v[112:113], v[200:201]
  v_pk_mul_f32 v[114:115], v[114:115], v[202:203]
  v_cvt_pk_bf16_f32 v222, v112, v113
  v_cvt_pk_bf16_f32 v223, v114, v115
  s_waitcnt vmcnt(14)
  s_cbranch_vccnz L_kw1_23
  s_waitcnt vmcnt(10)
L_kw1_23:
  buffer_load_dwordx4 v[24:27], v93, s[16:19], s61 offen offset:512 nt
  v_mfma_f32_16x16x32_bf16 v[228:231], v[220:223], v[172:175], 0
  v_pk_fma_f32 v[112:113], v[52:53], s[92:93], v[216:217] neg_lo:[0,0,1] neg_hi:[0,0,1]
  v_pk_fma_f32 v[114:115], v[54:55], s[92:93], v[218:219] neg_lo:[0,0,1] neg_hi:[0,0,1]
  v_cvt_pk_bf16_f32 v112, 0, v112
  v_cvt_pk_bf16_f32 v113, 0, v113
  v_cvt_pk_bf16_f32 v114, 0, v114
  v_cvt_pk_bf16_f32 v115, 0, v115
  v_pk_mul_f32 v[112:113], v[112:113], v[204:205]
  v_pk_mul_f32 v[114:115], v[114:115], v[206:207]
  v_cvt_pk_bf16_f32 v224, v112, v113
  v_cvt_pk_bf16_f32 v225, v114, v115
  s_waitcnt vmcnt(14)
  s_cbranch_vccnz L_kw1_24
  s_waitcnt vmcnt(10)
L_kw1_24:
  buffer_load_dwordx4 v[28:31], v93, s[16:19], s61 offen offset:768 nt
  v_mfma_f32_16x16x16_bf16 v[228:231], v[224:225], v[176:177], v[228:231]
  v_pk_fma_f32 v[112:113], v[56:57], s[92:93], v[208:209] neg_lo:[0,0,1] neg_hi:[0,0,1]
  v_pk_fma_f32 v[114:115], v[58:59], s[92:93], v[210:211] neg_lo:[0,0,1] neg_hi:[0,0,1]
  v_cvt_pk_bf16_f32 v112, 0, v112
  v_cvt_pk_bf16_f32 v113, 0, v113
  v_cvt_pk_bf16_f32 v114, 0, v114
  v_cvt_pk_bf16_f32 v115, 0, v115
  v_pk_mul_f32 v[112:113], v[112:113], v[196:197]
  v_pk_mul_f32 v[114:115], v[114:115], v[198:199]
  v_cvt_pk_bf16_f32 v220, v112, v113
  v_cvt_pk_bf16_f32 v221, v114, v115
  s_waitcnt vmcnt(14)
  s_cbranch_vccnz L_kw1_25
  s_waitcnt vmcnt(10)
L_kw1_25:
  buffer_load_dwordx4 v[32:35], v93, s[16:19], s61 offen offset:1024 nt
  v_pk_fma_f32 v[112:113], v[60:61], s[92:93], v[212:213] neg_lo:[0,0,1] neg_hi:[0,0,1]
  v_pk_fma_f32 v[114:115], v[62:63], s[92:93], v[214:215] neg_lo:[0,0,1] neg_hi:[0,0,1]
  v_mov_b32_dpp v148, v228 quad_perm:[0,0,0,0] row_mask:0xf bank_mask:0xf
  v_mov_b32_dpp v149, v230 quad_perm:[2,2,2,2] row_mask:0xf bank_mask:0xf
  v_cvt_pk_bf16_f32 v112, 0, v112
  v_cvt_pk_bf16_f32 v113, 0, v113
  v_add_f32_dpp v148, v229, v148 quad_perm:[1,1,1,1] row_mask:0xf bank_mask:0xf
  v_add_f32_dpp v149, v231, v149 quad_perm:[3,3,3,3] row_mask:0xf bank_mask:0xf
  v_cvt_pk_bf16_f32 v114, 0, v114
  v_cvt_pk_bf16_f32 v115, 0, v115
  v_add_f32 v233, v148, v149
  v_pk_mul_f32 v[112:113], v[112:113], v[200:201]
  v_pk_mul_f32 v[114:115], v[114:115], v[202:203]
  v_cvt_pk_bf16_f32 v222, v112, v113
  v_cvt_pk_bf16_f32 v223, v114, v115
  s_waitcnt vmcnt(14)
  s_cbranch_vccnz L_kw1_26
  s_waitcnt vmcnt(10)
L_kw1_26:
  buffer_load_dwordx4 v[36:39], v93, s[16:19], s61 offen offset:1280 nt
  v_mfma_f32_16x16x32_bf16 v[228:231], v[220:223], v[172:175], 0
  v_pk_fma_f32 v[112:113], v[64:65], s[92:93], v[216:217] neg_lo:[0,0,1] neg_hi:[0,0,1]
  v_pk_fma_f32 v[114:115], v[66:67], s[92:93], v[218:219] neg_lo:[0,0,1] neg_hi:[0,0,1]
  v_cvt_pk_bf16_f32 v112, 0, v112
  v_cvt_pk_bf16_f32 v232, 0, v232
  v_cvt_pk_bf16_f32 v113, 0, v113
  v_cvt_pk_bf16_f32 v233, 0, v233
  v_cvt_pk_bf16_f32 v114, 0, v114
  v_pk_mul_f32 v[232:233], v[232:233], s[68:69]
  v_cvt_pk_bf16_f32 v115, 0, v115
  v_cvt_pk_bf16_f32 v127, v232, v233
  v_pk_mul_f32 v[112:113], v[112:113], v[204:205]
  v_pk_mul_f32 v[114:115], v[114:115], v[206:207]
  v_cvt_pk_bf16_f32 v224, v112, v113
  v_cvt_pk_bf16_f32 v225, v114, v115
  s_waitcnt vmcnt(14)
  s_cbranch_vccnz L_kw1_27
  s_waitcnt vmcnt(10)
L_kw1_27:
  buffer_load_dwordx4 v[40:43], v93, s[16:19], s61 offen offset:1536 nt
  v_mfma_f32_16x16x16_bf16 v[228:231], v[224:225], v[176:177], v[228:231]
  v_pk_fma_f32 v[112:113], v[68:69], s[92:93], v[208:209] neg_lo:[0,0,1] neg_hi:[0,0,1]
  v_pk_fma_f32 v[114:115], v[70:71], s[92:93], v[210:211] neg_lo:[0,0,1] neg_hi:[0,0,1]
  v_cvt_pk_bf16_f32 v112, 0, v112
  v_cvt_pk_bf16_f32 v113, 0, v113
  v_cvt_pk_bf16_f32 v114, 0, v114
  v_cvt_pk_bf16_f32 v115, 0, v115
  v_pk_mul_f32 v[112:113], v[112:113], v[196:197]
  v_pk_mul_f32 v[114:115], v[114:115], v[198:199]
  v_cvt_pk_bf16_f32 v220, v112, v113
  v_cvt_pk_bf16_f32 v221, v114, v115
  s_waitcnt vmcnt(14)
  s_cbranch_vccnz L_kw1_28
  s_waitcnt vmcnt(10)
L_kw1_28:
  buffer_load_dwordx4 v[44:47], v93, s[16:19], s61 offen offset:1792 nt
  v_pk_fma_f32 v[112:113], v[72:73], s[92:93], v[212:213] neg_lo:[0,0,1] neg_hi:[0,0,1]
  v_pk_fma_f32 v[114:115], v[74:75], s[92:93], v[214:215] neg_lo:[0,0,1] neg_hi:[0,0,1]
  v_mov_b32_dpp v148, v228 quad_perm:[0,0,0,0] row_mask:0xf bank_mask:0xf
  v_mov_b32_dpp v149, v230 quad_perm:[2,2,2,2] row_mask:0xf bank_mask:0xf
  v_cvt_pk_bf16_f32 v112, 0, v112
  v_cvt_pk_bf16_f32 v113, 0, v113
  v_add_f32_dpp v148, v229, v148 quad_perm:[1,1,1,1] row_mask:0xf bank_mask:0xf
  v_add_f32_dpp v149, v231, v149 quad_perm:[3,3,3,3] row_mask:0xf bank_mask:0xf
  v_cvt_pk_bf16_f32 v114, 0, v114
  v_cvt_pk_bf16_f32 v115, 0, v115
  v_add_f32 v232, v148, v149
  v_pk_mul_f32 v[112:113], v[112:113], v[200:201]
  v_pk_mul_f32 v[114:115], v[114:115], v[202:203]
  v_cvt_pk_bf16_f32 v222, v112, v113
  v_cvt_pk_bf16_f32 v223, v114, v115
  s_waitcnt vmcnt(14)
  s_cbranch_vccnz L_kw1_29
  s_waitcnt vmcnt(10)
L_kw1_29:
  buffer_load_dwordx4 v[48:51], v93, s[16:19], s61 offen offset:2048 nt
  v_mfma_f32_16x16x32_bf16 v[228:231], v[220:223], v[172:175], 0
  v_pk_fma_f32 v[112:113], v[76:77], s[92:93], v[216:217] neg_lo:[0,0,1] neg_hi:[0,0,1]
  v_pk_fma_f32 v[114:115], v[78:79], s[92:93], v[218:219] neg_lo:[0,0,1] neg_hi:[0,0,1]
  v_cvt_pk_bf16_f32 v112, 0, v112
  v_cvt_pk_bf16_f32 v113, 0, v113
  v_cvt_pk_bf16_f32 v114, 0, v114
  v_cvt_pk_bf16_f32 v115, 0, v115
  v_pk_mul_f32 v[112:113], v[112:113], v[204:205]
  v_pk_mul_f32 v[114:115], v[114:115], v[206:207]
  v_cvt_pk_bf16_f32 v224, v112, v113
  v_cvt_pk_bf16_f32 v225, v114, v115
  s_waitcnt vmcnt(14)
  s_cbranch_vccnz L_kw1_30
  s_waitcnt vmcnt(10)
L_kw1_30:
  buffer_load_dwordx4 v[52:55], v93, s[16:19], s61 offen offset:2304 nt
  v_mfma_f32_16x16x16_bf16 v[228:231], v[224:225], v[176:177], v[228:231]
  v_pk_fma_f32 v[112:113], v[80:81], s[92:93], v[208:209] neg_lo:[0,0,1] neg_hi:[0,0,1]
  v_pk_fma_f32 v[114:115], v[82:83], s[92:93], v[210:211] neg_lo:[0,0,1] neg_hi:[0,0,1]
  v_cvt_pk_bf16_f32 v112, 0, v112
  v_cvt_pk_bf16_f32 v113, 0, v113
  v_cvt_pk_bf16_f32 v114, 0, v114
  v_cvt_pk_bf16_f32 v115, 0, v115
  v_pk_mul_f32 v[112:113], v[112:113], v[196:197]
  v_pk_mul_f32 v[114:115], v[114:115], v[198:199]
  v_cvt_pk_bf16_f32 v220, v112, v113
  v_cvt_pk_bf16_f32 v221, v114, v115
  s_waitcnt vmcnt(14)
  s_cbranch_vccnz L_kw1_31
  s_waitcnt vmcnt(10)
L_kw1_31:
  buffer_load_dwordx4 v[56:59], v93, s[16:19], s61 offen offset:2560 nt
  v_pk_fma_f32 v[112:113], v[84:85], s[92:93], v[212:213] neg_lo:[0,0,1] neg_hi:[0,0,1]
  v_pk_fma_f32 v[114:115], v[86:87], s[92:93], v[214:215] neg_lo:[0,0,1] neg_hi:[0,0,1]
  v_mov_b32_dpp v148, v228 quad_perm:[0,0,0,0] row_mask:0xf bank_mask:0xf
  v_mov_b32_dpp v149, v230 quad_perm:[2,2,2,2] row_mask:0xf bank_mask:0xf
  v_cvt_pk_bf16_f32 v112, 0, v112
  v_cvt_pk_bf16_f32 v113, 0, v113
  v_add_f32_dpp v148, v229, v148 quad_perm:[1,1,1,1] row_mask:0xf bank_mask:0xf
  v_add_f32_dpp v149, v231, v149 quad_perm:[3,3,3,3] row_mask:0xf bank_mask:0xf
  v_cvt_pk_bf16_f32 v114, 0, v114
  v_cvt_pk_bf16_f32 v115, 0, v115
  v_add_f32 v233, v148, v149
  v_pk_mul_f32 v[112:113], v[112:113], v[200:201]
  v_pk_mul_f32 v[114:115], v[114:115], v[202:203]
  v_cvt_pk_bf16_f32 v222, v112, v113
  v_cvt_pk_bf16_f32 v223, v114, v115
  s_waitcnt vmcnt(14)
  s_cbranch_vccnz L_kw1_32
  s_waitcnt vmcnt(10)
L_kw1_32:
  buffer_load_dwordx4 v[60:63], v93, s[16:19], s61 offen offset:2816 nt
  v_mfma_f32_16x16x32_bf16 v[228:231], v[220:223], v[172:175], 0
  v_pk_fma_f32 v[112:113], v[88:89], s[92:93], v[216:217] neg_lo:[0,0,1] neg_hi:[0,0,1]
  v_pk_fma_f32 v[114:115], v[90:91], s[92:93], v[218:219] neg_lo:[0,0,1] neg_hi:[0,0,1]
  v_cvt_pk_bf16_f32 v112, 0, v112
  v_cvt_pk_bf16_f32 v232, 0, v232
  v_cvt_pk_bf16_f32 v113, 0, v113
  v_cvt_pk_bf16_f32 v233, 0, v233
  v_cvt_pk_bf16_f32 v114, 0, v114
  v_pk_mul_f32 v[232:233], v[232:233], s[68:69]
  v_cvt_pk_bf16_f32 v115, 0, v115
  v_cvt_pk_bf16_f32 v128, v232, v233
  v_pk_mul_f32 v[112:113], v[112:113], v[204:205]
  v_pk_mul_f32 v[114:115], v[114:115], v[206:207]
  v_cvt_pk_bf16_f32 v224, v112, v113
  v_cvt_pk_bf16_f32 v225, v114, v115
  s_mov_b32 s60, s61
  v_mov_b32 v150, s64
  v_mfma_f32_16x16x16_bf16 v[228:231], v[224:225], v[176:177], v[228:231]
  ds_write_b128 v102, v[124:127]
  v_add_u32 v102, 768, v102
  s_nop 5
  v_mov_b32_dpp v148, v228 quad_perm:[0,0,0,0] row_mask:0xf bank_mask:0xf
  v_mov_b32_dpp v149, v230 quad_perm:[2,2,2,2] row_mask:0xf bank_mask:0xf
  s_nop 0
  v_add_f32_dpp v148, v229, v148 quad_perm:[1,1,1,1] row_mask:0xf bank_mask:0xf
  v_add_f32_dpp v149, v231, v149 quad_perm:[3,3,3,3] row_mask:0xf bank_mask:0xf
  v_add_f32 v232, v148, v149
  v_cndmask_b32 v232, v232, v240, s[50:51]
  v_cvt_pk_bf16_f32 v232, 0, v232
  v_cvt_pk_bf16_f32 v233, 0, v233
  v_pk_mul_f32 v[232:233], v[232:233], s[68:69]
  v_cvt_pk_bf16_f32 v129, v232, v233
  ds_write_b64 v103, v[128:129] offset:256
  ds_write_b32 v107, v150
  v_add_u32 v103, 768, v103
  s_cmp_lt_u32 s64, 96
  s_cbranch_scc1 L_k
  v_subrev_u32 v102, 36864, v102
  v_subrev_u32 v103, 36864, v103
  s_mov_b32 s64, s3
  s_mov_b32 s88, s89
  s_mov_b32 s99, 0
  s_load_dwordx2 s[44:45], s[0:1], 56
  s_waitcnt lgkmcnt(0)
  s_mov_b32 s36, s44
  s_and_b32 s37, s45, 0xffff
  s_cmp_lt_u32 s64, s99
  s_cbranch_scc1 L_v0_ok
L_v0_spin:
  v_mov_b32 v148, 61700
  ds_read_b32 v148, v148
  s_waitcnt lgkmcnt(0)
  v_readfirstlane_b32 s99, v148
  s_nop 1
  s_cmp_lt_u32 s64, s99
  s_cbranch_scc0 L_v0_spin
L_v0_ok:
  ds_read_b128 v[124:127], v102
  ds_read_b64 v[128:129], v103 offset:256
L_v0:
  s_mov_b32 s86, s84
  s_mov_b32 s87, s85
  s_add_u32 s64, s64, 2
  s_cmp_lt_u32 s64, s99
  s_cbranch_scc1 L_v10_ok
L_v10_spin:
  v_mov_b32 v148, 61700
  ds_read_b32 v148, v148
  s_waitcnt lgkmcnt(0)
  v_readfirstlane_b32 s99, v148
  s_nop 1
  s_cmp_lt_u32 s64, s99
  s_cbranch_scc0 L_v10_spin
L_v10_ok:
  s_andn2_b32 s70, s64, 1
  s_or_b32 s70, s70, s4
  s_lshr_b32 s71, s64, 5
  s_lshr_b32 s85, s96, s71
  s_lshr_b32 s85, s85, 3
  s_cmp_lt_u32 s64, s97
  s_cselect_b32 s70, s70, s64
  s_cselect_b32 s85, s64, s85
  s_and_b32 s85, s85, 1
  s_mul_i32 s71, s71, 4064
  s_add_u32 s70, s70, s71
  s_add_u32 s70, s70, s5
  s_mul_hi_u32 s84, s70, s90
  s_lshr_b32 s84, s84, 1
  s_mul_i32 s71, s84, 3
  s_sub_u32 s70, s70, s71
  s_lshl3_add_u32 s85, s70, s85
  s_mul_i32 s61, s84, 196608
  s_lshr_b32 s89, s84, 4
  s_lshl_b32 s70, s85, 5
  v_add_u32 v100, s70, v96
  v_mul_u32_u24 v100, 21846, v100
  v_lshrrev_b32 v100, 16, v100
  v_add_u32 v148, s85, v97
  v_lshrrev_b32 v149, v148, s91
  v_and_b32 v149, 1, v149
  v_cmp_eq_u32 s[54:55], 1, v149
  s_nop 1
  s_and_b64 s[52:53], s[54:55], s[58:59]
  s_andn2_b64 s[54:55], s[54:55], s[58:59]
  s_cmp_lt_u32 s64, 96
  s_cselect_b32 s61, s61, 805306368
  s_add_u32 s70, s64, 94
  v_mov_b32 v150, s70
  ds_read_b32 v110, v109
  ds_write_b32 v107, v150
  s_waitcnt vmcnt(14)
  s_cbranch_vccnz L_vw0_0
  s_waitcnt vmcnt(10)
L_vw0_0:
  buffer_load_dwordx4 v[64:67], v93, s[12:15], s60 offen offset:3072 nt
  v_mul_f32 v118, s94, v116
  v_mul_f32 v119, 0x4a800000, v117
  s_nop 0
  v_mov_b32_dpp v120, v118 row_newbcast:0 row_mask:0xf bank_mask:0xf
  v_mov_b32_dpp v121, v119 row_newbcast:0 row_mask:0xf bank_mask:0xf
  v_pk_fma_f32 v[196:197], v[4:5], s[92:93], v[120:121] op_sel_hi:[1,1,0] neg_lo:[0,0,1] neg_hi:[0,0,1]
  v_pk_fma_f32 v[198:199], v[6:7], s[92:93], v[120:121] op_sel_hi:[1,1,0] neg_lo:[0,0,1] neg_hi:[0,0,1]
  v_cvt_pk_bf16_f32 v196, 0, v196
  s_waitcnt lgkmcnt(0)
  v_cvt_pk_bf16_f32 v197, 0, v197
  v_cmp_lt_u32 vcc, v150, v110
  v_cvt_pk_bf16_f32 v198, 0, v198
  v_lshlrev_b32 v152, 16, v124
  v_cvt_pk_bf16_f32 v199, 0, v199
  v_and_b32 v153, s65, v124
  v_pk_mul_f32 v[196:197], v[196:197], v[120:121] op_sel:[0,1]
  v_lshlrev_b32 v154, 16, v125
  v_pk_mul_f32 v[198:199], v[198:199], v[120:121] op_sel:[0,1]
  s_waitcnt vmcnt(14)
  s_cbranch_vccnz L_vw0_1
  s_waitcnt vmcnt(10)
L_vw0_1:
  buffer_load_dwordx4 v[68:71], v93, s[12:15], s60 offen offset:3328 nt
  v_pk_fma_f32 v[200:201], v[8:9], s[92:93], v[120:121] op_sel_hi:[1,1,0] neg_lo:[0,0,1] neg_hi:[0,0,1]
  v_pk_fma_f32 v[202:203], v[10:11], s[92:93], v[120:121] op_sel_hi:[1,1,0] neg_lo:[0,0,1] neg_hi:[0,0,1]
  v_cvt_pk_bf16_f32 v200, 0, v200
  v_and_b32 v155, s65, v125
  v_cvt_pk_bf16_f32 v201, 0, v201
  v_lshlrev_b32 v156, 16, v126
  v_cvt_pk_bf16_f32 v202, 0, v202
  v_and_b32 v157, s65, v126
  v_cvt_pk_bf16_f32 v203, 0, v203
  v_lshlrev_b32 v158, 16, v127
  v_pk_mul_f32 v[200:201], v[200:201], v[120:121] op_sel:[0,1]
  v_and_b32 v159, s65, v127
  v_pk_mul_f32 v[202:203], v[202:203], v[120:121] op_sel:[0,1]
  s_waitcnt vmcnt(14)
  s_cbranch_vccnz L_vw0_2
  s_waitcnt vmcnt(10)
L_vw0_2:
  buffer_load_dwordx4 v[72:75], v93, s[12:15], s60 offen offset:3584 nt
  v_pk_fma_f32 v[204:205], v[12:13], s[92:93], v[120:121] op_sel_hi:[1,1,0] neg_lo:[0,0,1] neg_hi:[0,0,1]
  v_pk_fma_f32 v[206:207], v[14:15], s[92:93], v[120:121] op_sel_hi:[1,1,0] neg_lo:[0,0,1] neg_hi:[0,0,1]
  v_cvt_pk_bf16_f32 v204, 0, v204
  v_lshlrev_b32 v160, 16, v128
  v_cvt_pk_bf16_f32 v205, 0, v205
  v_and_b32 v161, s65, v128
  v_cvt_pk_bf16_f32 v206, 0, v206
  v_lshlrev_b32 v162, 16, v129
  v_cvt_pk_bf16_f32 v207, 0, v207
  v_add_u32 v102, 768, v102
  v_pk_mul_f32 v[204:205], v[204:205], v[120:121] op_sel:[0,1]
  v_add_u32 v103, 768, v103
  v_pk_mul_f32 v[206:207], v[206:207], v[120:121] op_sel:[0,1]
  s_waitcnt vmcnt(14)
  s_cbranch_vccnz L_vw0_3
  s_waitcnt vmcnt(10)
L_vw0_3:
  buffer_load_dwordx4 v[76:79], v94, s[12:15], s60 offen offset:0 nt
  v_mov_b32_dpp v120, v118 row_newbcast:1 row_mask:0xf bank_mask:0xf
  v_mov_b32_dpp v121, v119 row_newbcast:1 row_mask:0xf bank_mask:0xf
  v_pk_fma_f32 v[112:113], v[16:17], s[92:93], v[120:121] op_sel_hi:[1,1,0] neg_lo:[0,0,1] neg_hi:[0,0,1]
  v_pk_fma_f32 v[114:115], v[18:19], s[92:93], v[120:121] op_sel_hi:[1,1,0] neg_lo:[0,0,1] neg_hi:[0,0,1]
  s_lshl_b32 s62, s84, 9
  v_lshl_add_u32 v101, v100, 1, v99
  buffer_load_short_d16_hi v116, v101, s[32:35], s62 offen
  buffer_load_short_d16_hi v117, v101, s[28:31], s62 offen
  v_cvt_pk_bf16_f32 v112, 0, v112
  v_max3_f32 v148, v152, v153, v154
  v_cvt_pk_bf16_f32 v113, 0, v113
  ds_read_b128 v[124:127], v102
  v_cvt_pk_bf16_f32 v114, 0, v114
  ds_read_b64 v[128:129], v103 offset:256
  v_cvt_pk_bf16_f32 v115, 0, v115
  v_max3_f32 v149, v155, v156, v157
  v_pk_mul_f32 v[112:113], v[112:113], v[120:121] op_sel:[0,1]
  v_max3_f32 v148, v148, v158, v159
  v_pk_mul_f32 v[114:115], v[114:115], v[120:121] op_sel:[0,1]
  v_cvt_pk_bf16_f32 v208, v196, v112
  v_cvt_pk_bf16_f32 v212, v197, v113
  v_cvt_pk_bf16_f32 v216, v198, v114
  v_cvt_pk_bf16_f32 v220, v199, v115
  s_waitcnt vmcnt(16)
  s_cbranch_vccnz L_vw0_4
  s_waitcnt vmcnt(12)
L_vw0_4:
  buffer_load_dwordx4 v[80:83], v94, s[12:15], s60 offen offset:256 nt
  v_pk_fma_f32 v[112:113], v[20:21], s[92:93], v[120:121] op_sel_hi:[1,1,0] neg_lo:[0,0,1] neg_hi:[0,0,1]
  v_pk_fma_f32 v[114:115], v[22:23], s[92:93], v[120:121] op_sel_hi:[1,1,0] neg_lo:[0,0,1] neg_hi:[0,0,1]
  v_cvt_pk_bf16_f32 v112, 0, v112
  v_max3_f32 v149, v149, v160, v161
  v_cvt_pk_bf16_f32 v113, 0, v113
  v_max3_f32 v148, v148, v162, v144
  v_cvt_pk_bf16_f32 v114, 0, v114
  v_max_f32 v148, v148, v149
  v_cvt_pk_bf16_f32 v115, 0, v115
  v_mov_b32 v149, v148
  v_pk_mul_f32 v[112:113], v[112:113], v[120:121] op_sel:[0,1]
  s_nop 0
  v_permlane32_swap_b32 v148, v149
  v_pk_mul_f32 v[114:115], v[114:115], v[120:121] op_sel:[0,1]
  v_cvt_pk_bf16_f32 v224, v200, v112
  v_cvt_pk_bf16_f32 v228, v201, v113
  v_cvt_pk_bf16_f32 v232, v202, v114
  v_cvt_pk_bf16_f32 v236, v203, v115
  s_waitcnt vmcnt(16)
  s_cbranch_vccnz L_vw0_5
  s_waitcnt vmcnt(12)
L_vw0_5:
  buffer_load_dwordx4 v[84:87], v94, s[12:15], s60 offen offset:512 nt
  v_pk_fma_f32 v[112:113], v[24:25], s[92:93], v[120:121] op_sel_hi:[1,1,0] neg_lo:[0,0,1] neg_hi:[0,0,1]
  v_pk_fma_f32 v[114:115], v[26:27], s[92:93], v[120:121] op_sel_hi:[1,1,0] neg_lo:[0,0,1] neg_hi:[0,0,1]
  v_cvt_pk_bf16_f32 v112, 0, v112
  v_max_f32 v148, v148, v149
  v_cvt_pk_bf16_f32 v113, 0, v113
  v_mov_b32 v149, v148
  v_cvt_pk_bf16_f32 v114, 0, v114
  s_nop 0
  v_permlane16_swap_b32 v148, v149
  v_cvt_pk_bf16_f32 v115, 0, v115
  v_max_f32 v144, v148, v149
  v_pk_mul_f32 v[112:113], v[112:113], v[120:121] op_sel:[0,1]
  v_mul_f32 v148, s66, v144
  v_pk_mul_f32 v[114:115], v[114:115], v[120:121] op_sel:[0,1]
  v_cvt_pk_bf16_f32 v240, v204, v112
  v_cvt_pk_bf16_f32 v244, v205, v113
  v_cvt_pk_bf16_f32 v248, v206, v114
  v_cvt_pk_bf16_f32 v252, v207, v115
  s_waitcnt vmcnt(16)
  s_cbranch_vccnz L_vw0_6
  s_waitcnt vmcnt(12)
L_vw0_6:
  buffer_load_dwordx4 v[88:91], v94, s[12:15], s60 offen offset:768 nt
  v_mov_b32_dpp v120, v118 row_newbcast:2 row_mask:0xf bank_mask:0xf
  v_mov_b32_dpp v121, v119 row_newbcast:2 row_mask:0xf bank_mask:0xf
  v_pk_fma_f32 v[196:197], v[28:29], s[92:93], v[120:121] op_sel_hi:[1,1,0] neg_lo:[0,0,1] neg_hi:[0,0,1]
  v_pk_fma_f32 v[198:199], v[30:31], s[92:93], v[120:121] op_sel_hi:[1,1,0] neg_lo:[0,0,1] neg_hi:[0,0,1]
  v_cvt_pk_bf16_f32 v196, 0, v196
  v_add_f32 v150, v148, v146
  v_cvt_pk_bf16_f32 v197, 0, v197
  v_sub_f32 v146, 0, v148
  v_cvt_pk_bf16_f32 v198, 0, v198
  v_exp_f32 v150, -v150
  v_cvt_pk_bf16_f32 v199, 0, v199
  ds_bpermute_b32 v151, v104, v150
  v_pk_mul_f32 v[196:197], v[196:197], v[120:121] op_sel:[0,1]
  v_fma_f32 v152, v152, s66, v146
  v_pk_mul_f32 v[198:199], v[198:199], v[120:121] op_sel:[0,1]
  s_waitcnt vmcnt(16)
  s_cbranch_vccnz L_vw0_7
  s_waitcnt vmcnt(12)
L_vw0_7:
  buffer_load_dwordx4 v[4:7], v94, s[12:15], s60 offen offset:1024 nt
  v_pk_fma_f32 v[200:201], v[32:33], s[92:93], v[120:121] op_sel_hi:[1,1,0] neg_lo:[0,0,1] neg_hi:[0,0,1]
  v_pk_fma_f32 v[202:203], v[34:35], s[92:93], v[120:121] op_sel_hi:[1,1,0] neg_lo:[0,0,1] neg_hi:[0,0,1]
  v_cvt_pk_bf16_f32 v200, 0, v200
  v_exp_f32 v152, v152
  v_cvt_pk_bf16_f32 v201, 0, v201
  v_fma_f32 v153, v153, s66, v146
  v_cvt_pk_bf16_f32 v202, 0, v202
  v_exp_f32 v153, v153
  v_cvt_pk_bf16_f32 v203, 0, v203
  v_fma_f32 v154, v154, s66, v146
  v_pk_mul_f32 v[200:201], v[200:201], v[120:121] op_sel:[0,1]
  v_exp_f32 v154, v154
  v_pk_mul_f32 v[202:203], v[202:203], v[120:121] op_sel:[0,1]
  s_waitcnt vmcnt(16)
  s_cbranch_vccnz L_vw0_8
  s_waitcnt vmcnt(12)
L_vw0_8:
  buffer_load_dwordx4 v[8:11], v94, s[12:15], s60 offen offset:1280 nt
  v_pk_fma_f32 v[204:205], v[36:37], s[92:93], v[120:121] op_sel_hi:[1,1,0] neg_lo:[0,0,1] neg_hi:[0,0,1]
  v_pk_fma_f32 v[206:207], v[38:39], s[92:93], v[120:121] op_sel_hi:[1,1,0] neg_lo:[0,0,1] neg_hi:[0,0,1]
  v_cvt_pk_bf16_f32 v204, 0, v204
  v_fma_f32 v155, v155, s66, v146
  v_cvt_pk_bf16_f32 v205, 0, v205
  v_exp_f32 v155, v155
  v_cvt_pk_bf16_f32 v206, 0, v206
  v_fma_f32 v156, v156, s66, v146
  v_cvt_pk_bf16_f32 v207, 0, v207
  v_exp_f32 v156, v156
  v_pk_mul_f32 v[204:205], v[204:205], v[120:121] op_sel:[0,1]
  v_fma_f32 v157, v157, s66, v146
  v_pk_mul_f32 v[206:207], v[206:207], v[120:121] op_sel:[0,1]
  s_waitcnt vmcnt(16)
  s_cbranch_vccnz L_vw0_9
  s_waitcnt vmcnt(12)
L_vw0_9:
  buffer_load_dwordx4 v[12:15], v94, s[12:15], s60 offen offset:1536 nt
  v_mov_b32_dpp v120, v118 row_newbcast:3 row_mask:0xf bank_mask:0xf
  v_mov_b32_dpp v121, v119 row_newbcast:3 row_mask:0xf bank_mask:0xf
  v_pk_fma_f32 v[112:113], v[40:41], s[92:93], v[120:121] op_sel_hi:[1,1,0] neg_lo:[0,0,1] neg_hi:[0,0,1]
  v_pk_fma_f32 v[114:115], v[42:43], s[92:93], v[120:121] op_sel_hi:[1,1,0] neg_lo:[0,0,1] neg_hi:[0,0,1]
  v_cvt_pk_bf16_f32 v112, 0, v112
  v_exp_f32 v157, v157
  v_cvt_pk_bf16_f32 v113, 0, v113
  v_fma_f32 v158, v158, s66, v146
  v_cvt_pk_bf16_f32 v114, 0, v114
  v_exp_f32 v158, v158
  v_cvt_pk_bf16_f32 v115, 0, v115
  v_fma_f32 v159, v159, s66, v146
  v_pk_mul_f32 v[112:113], v[112:113], v[120:121] op_sel:[0,1]
  v_exp_f32 v159, v159
  v_pk_mul_f32 v[114:115], v[114:115], v[120:121] op_sel:[0,1]
  v_cvt_pk_bf16_f32 v209, v196, v112
  v_cvt_pk_bf16_f32 v213, v197, v113
  v_cvt_pk_bf16_f32 v217, v198, v114
  v_cvt_pk_bf16_f32 v221, v199, v115
  s_waitcnt vmcnt(16)
  s_cbranch_vccnz L_vw0_10
  s_waitcnt vmcnt(12)
L_vw0_10:
  buffer_load_dwordx4 v[16:19], v94, s[12:15], s60 offen offset:1792 nt
  v_pk_fma_f32 v[112:113], v[44:45], s[92:93], v[120:121] op_sel_hi:[1,1,0] neg_lo:[0,0,1] neg_hi:[0,0,1]
  v_pk_fma_f32 v[114:115], v[46:47], s[92:93], v[120:121] op_sel_hi:[1,1,0] neg_lo:[0,0,1] neg_hi:[0,0,1]
  v_cvt_pk_bf16_f32 v112, 0, v112
  v_fma_f32 v160, v160, s66, v146
  v_cvt_pk_bf16_f32 v113, 0, v113
  v_exp_f32 v160, v160
  v_cvt_pk_bf16_f32 v114, 0, v114
  v_fma_f32 v161, v161, s66, v146
  v_cvt_pk_bf16_f32 v115, 0, v115
  v_exp_f32 v161, v161
  v_pk_mul_f32 v[112:113], v[112:113], v[120:121] op_sel:[0,1]
  v_fma_f32 v162, v162, s66, v146
  v_pk_mul_f32 v[114:115], v[114:115], v[120:121] op_sel:[0,1]
  v_cvt_pk_bf16_f32 v225, v200, v112
  v_cvt_pk_bf16_f32 v229, v201, v113
  v_cvt_pk_bf16_f32 v233, v202, v114
  v_cvt_pk_bf16_f32 v237, v203, v115
  s_waitcnt vmcnt(16)
  s_cbranch_vccnz L_vw0_11
  s_waitcnt vmcnt(12)
L_vw0_11:
  buffer_load_dwordx4 v[20:23], v94, s[12:15], s60 offen offset:2048 nt
  v_pk_fma_f32 v[112:113], v[48:49], s[92:93], v[120:121] op_sel_hi:[1,1,0] neg_lo:[0,0,1] neg_hi:[0,0,1]
  v_pk_fma_f32 v[114:115], v[50:51], s[92:93], v[120:121] op_sel_hi:[1,1,0] neg_lo:[0,0,1] neg_hi:[0,0,1]
  v_cvt_pk_bf16_f32 v112, 0, v112
  v_exp_f32 v162, v162
  v_cvt_pk_bf16_f32 v113, 0, v113
  v_add_f32 v148, v152, v153
  v_cvt_pk_bf16_f32 v114, 0, v114
  v_add_f32 v149, v154, v155
  v_cvt_pk_bf16_f32 v115, 0, v115
  v_add_f32 v148, v148, v156
  v_pk_mul_f32 v[112:113], v[112:113], v[120:121] op_sel:[0,1]
  v_add_f32 v149, v149, v157
  v_pk_mul_f32 v[114:115], v[114:115], v[120:121] op_sel:[0,1]
  v_cvt_pk_bf16_f32 v241, v204, v112
  v_cvt_pk_bf16_f32 v245, v205, v113
  v_cvt_pk_bf16_f32 v249, v206, v114
  v_cvt_pk_bf16_f32 v253, v207, v115
  s_waitcnt vmcnt(16)
  s_cbranch_vccnz L_vw0_12
  s_waitcnt vmcnt(12)
L_vw0_12:
  buffer_load_dwordx4 v[24:27], v94, s[12:15], s60 offen offset:2304 nt
  v_mov_b32_dpp v120, v118 row_newbcast:4 row_mask:0xf bank_mask:0xf
  v_mov_b32_dpp v121, v119 row_newbcast:4 row_mask:0xf bank_mask:0xf
  v_pk_fma_f32 v[196:197], v[52:53], s[92:93], v[120:121] op_sel_hi:[1,1,0] neg_lo:[0,0,1] neg_hi:[0,0,1]
  v_pk_fma_f32 v[198:199], v[54:55], s[92:93], v[120:121] op_sel_hi:[1,1,0] neg_lo:[0,0,1] neg_hi:[0,0,1]
  v_cvt_pk_bf16_f32 v196, 0, v196
  v_add_f32 v148, v148, v158
  v_cvt_pk_bf16_f32 v197, 0, v197
  v_add_f32 v149, v149, v159
  v_cvt_pk_bf16_f32 v198, 0, v198
  v_add_f32 v148, v148, v160
  v_cvt_pk_bf16_f32 v199, 0, v199
  v_add_f32 v149, v149, v161
  v_pk_mul_f32 v[196:197], v[196:197], v[120:121] op_sel:[0,1]
  v_add_f32 v148, v148, v162
  v_pk_mul_f32 v[198:199], v[198:199], v[120:121] op_sel:[0,1]
  s_waitcnt vmcnt(16)
  s_cbranch_vccnz L_vw0_13
  s_waitcnt vmcnt(12)
L_vw0_13:
  buffer_load_dwordx4 v[28:31], v94, s[12:15], s60 offen offset:2560 nt
  v_pk_fma_f32 v[200:201], v[56:57], s[92:93], v[120:121] op_sel_hi:[1,1,0] neg_lo:[0,0,1] neg_hi:[0,0,1]
  v_pk_fma_f32 v[202:203], v[58:59], s[92:93], v[120:121] op_sel_hi:[1,1,0] neg_lo:[0,0,1] neg_hi:[0,0,1]
  v_cvt_pk_bf16_f32 v200, 0, v200
  v_add_f32 v148, v148, v149
  v_cvt_pk_bf16_f32 v201, 0, v201
  v_fma_f32 v147, v147, v150, v148
  v_cvt_pk_bf16_f32 v202, 0, v202
  v_cvt_pk_bf16_f32 v163, v152, v153
  v_cvt_pk_bf16_f32 v203, 0, v203
  v_cvt_pk_bf16_f32 v164, v154, v155
  v_pk_mul_f32 v[200:201], v[200:201], v[120:121] op_sel:[0,1]
  v_cvt_pk_bf16_f32 v165, v156, v157
  v_pk_mul_f32 v[202:203], v[202:203], v[120:121] op_sel:[0,1]
  s_waitcnt vmcnt(16)
  s_cbranch_vccnz L_vw0_14
  s_waitcnt vmcnt(12)
L_vw0_14:
  buffer_load_dwordx4 v[32:35], v94, s[12:15], s60 offen offset:2816 nt
  v_pk_fma_f32 v[204:205], v[60:61], s[92:93], v[120:121] op_sel_hi:[1,1,0] neg_lo:[0,0,1] neg_hi:[0,0,1]
  v_pk_fma_f32 v[206:207], v[62:63], s[92:93], v[120:121] op_sel_hi:[1,1,0] neg_lo:[0,0,1] neg_hi:[0,0,1]
  v_cvt_pk_bf16_f32 v204, 0, v204
  v_cvt_pk_bf16_f32 v166, v158, v159
  v_cvt_pk_bf16_f32 v205, 0, v205
  v_cvt_pk_bf16_f32 v167, v160, v161
  v_cvt_pk_bf16_f32 v206, 0, v206
  v_cvt_pk_bf16_f32 v168, v162, 0
  v_cvt_pk_bf16_f32 v207, 0, v207
  v_cndmask_b32 v172, 0, v163, s[72:73]
  v_pk_mul_f32 v[204:205], v[204:205], v[120:121] op_sel:[0,1]
  v_cndmask_b32 v173, 0, v164, s[72:73]
  v_pk_mul_f32 v[206:207], v[206:207], v[120:121] op_sel:[0,1]
  s_waitcnt vmcnt(16)
  s_cbranch_vccnz L_vw0_15
  s_waitcnt vmcnt(10)
L_vw0_15:
  buffer_load_dwordx4 v[36:39], v95, s[12:15], s60 offen offset:0 nt
  v_mov_b32_dpp v120, v118 row_newbcast:5 row_mask:0xf bank_mask:0xf
  v_mov_b32_dpp v121, v119 row_newbcast:5 row_mask:0xf bank_mask:0xf
  v_pk_fma_f32 v[112:113], v[64:65], s[92:93], v[120:121] op_sel_hi:[1,1,0] neg_lo:[0,0,1] neg_hi:[0,0,1]
  v_pk_fma_f32 v[114:115], v[66:67], s[92:93], v[120:121] op_sel_hi:[1,1,0] neg_lo:[0,0,1] neg_hi:[0,0,1]
  v_cvt_pk_bf16_f32 v112, 0, v112
  v_cndmask_b32 v174, 0, v165, s[72:73]
  v_cvt_pk_bf16_f32 v113, 0, v113
  v_cndmask_b32 v175, 0, v166, s[72:73]
  v_cvt_pk_bf16_f32 v114, 0, v114
  v_cndmask_b32 v176, 0, v163, s[74:75]
  v_cvt_pk_bf16_f32 v115, 0, v115
  v_cndmask_b32 v177, 0, v164, s[74:75]
  v_pk_mul_f32 v[112:113], v[112:113], v[120:121] op_sel:[0,1]
  v_cndmask_b32 v178, 0, v165, s[74:75]
  v_pk_mul_f32 v[114:115], v[114:115], v[120:121] op_sel:[0,1]
  v_cvt_pk_bf16_f32 v210, v196, v112
  v_cvt_pk_bf16_f32 v214, v197, v113
  v_cvt_pk_bf16_f32 v218, v198, v114
  v_cvt_pk_bf16_f32 v222, v199, v115
  s_waitcnt vmcnt(16)
  s_cbranch_vccnz L_vw0_16
  s_waitcnt vmcnt(10)
L_vw0_16:
  buffer_load_dwordx4 v[40:43], v95, s[12:15], s60 offen offset:256 nt
  v_pk_fma_f32 v[112:113], v[68:69], s[92:93], v[120:121] op_sel_hi:[1,1,0] neg_lo:[0,0,1] neg_hi:[0,0,1]
  v_pk_fma_f32 v[114:115], v[70:71], s[92:93], v[120:121] op_sel_hi:[1,1,0] neg_lo:[0,0,1] neg_hi:[0,0,1]
  v_cvt_pk_bf16_f32 v112, 0, v112
  v_cndmask_b32 v179, 0, v166, s[74:75]
  v_cvt_pk_bf16_f32 v113, 0, v113
  v_cndmask_b32 v180, 0, v163, s[76:77]
  v_cvt_pk_bf16_f32 v114, 0, v114
  v_cndmask_b32 v181, 0, v164, s[76:77]
  v_cvt_pk_bf16_f32 v115, 0, v115
  v_cndmask_b32 v182, 0, v165, s[76:77]
  v_pk_mul_f32 v[112:113], v[112:113], v[120:121] op_sel:[0,1]
  v_cndmask_b32 v183, 0, v166, s[76:77]
  v_pk_mul_f32 v[114:115], v[114:115], v[120:121] op_sel:[0,1]
  v_cvt_pk_bf16_f32 v226, v200, v112
  v_cvt_pk_bf16_f32 v230, v201, v113
  v_cvt_pk_bf16_f32 v234, v202, v114
  v_cvt_pk_bf16_f32 v238, v203, v115
  s_waitcnt vmcnt(16)
  s_cbranch_vccnz L_vw0_17
  s_waitcnt vmcnt(10)
L_vw0_17:
  buffer_load_dwordx4 v[44:47], v95, s[12:15], s60 offen offset:512 nt
  v_pk_fma_f32 v[112:113], v[72:73], s[92:93], v[120:121] op_sel_hi:[1,1,0] neg_lo:[0,0,1] neg_hi:[0,0,1]
  v_pk_fma_f32 v[114:115], v[74:75], s[92:93], v[120:121] op_sel_hi:[1,1,0] neg_lo:[0,0,1] neg_hi:[0,0,1]
  v_cvt_pk_bf16_f32 v112, 0, v112
  v_cndmask_b32 v184, 0, v163, s[78:79]
  v_cvt_pk_bf16_f32 v113, 0, v113
  v_cndmask_b32 v185, 0, v164, s[78:79]
  v_cvt_pk_bf16_f32 v114, 0, v114
  v_cndmask_b32 v186, 0, v165, s[78:79]
  v_cvt_pk_bf16_f32 v115, 0, v115
  v_cndmask_b32 v187, 0, v166, s[78:79]
  v_pk_mul_f32 v[112:113], v[112:113], v[120:121] op_sel:[0,1]
  s_waitcnt lgkmcnt(0)
  v_pk_mul_f32 v[114:115], v[114:115], v[120:121] op_sel:[0,1]
  v_cvt_pk_bf16_f32 v242, v204, v112
  v_cvt_pk_bf16_f32 v246, v205, v113
  v_cvt_pk_bf16_f32 v250, v206, v114
  v_cvt_pk_bf16_f32 v254, v207, v115
  v_mad_u32_u24 v92, v100, s63, v98
  v_add_u32 v93, 768, v92
  v_add_u32 v94, 4608, v92
  v_add_u32 v95, 7680, v92
  v_cndmask_b32 v92, v92, v108, s[52:53]
  v_cndmask_b32 v95, v95, v108, s[54:55]
  s_waitcnt vmcnt(16)
  s_cbranch_vccnz L_vw0_18
  s_waitcnt vmcnt(10)
L_vw0_18:
  buffer_load_dwordx4 v[48:51], v92, s[12:15], s61 offen offset:0 nt
  v_mov_b32_dpp v120, v118 row_newbcast:6 row_mask:0xf bank_mask:0xf
  v_mov_b32_dpp v121, v119 row_newbcast:6 row_mask:0xf bank_mask:0xf
  v_pk_fma_f32 v[196:197], v[76:77], s[92:93], v[120:121] op_sel_hi:[1,1,0] neg_lo:[0,0,1] neg_hi:[0,0,1]
  v_pk_fma_f32 v[198:199], v[78:79], s[92:93], v[120:121] op_sel_hi:[1,1,0] neg_lo:[0,0,1] neg_hi:[0,0,1]
  v_cvt_pk_bf16_f32 v196, 0, v196
  v_mul_f32 v132, v151, v132
  v_cvt_pk_bf16_f32 v197, 0, v197
  v_mul_f32 v133, v151, v133
  v_cvt_pk_bf16_f32 v198, 0, v198
  v_mul_f32 v134, v151, v134
  v_cvt_pk_bf16_f32 v199, 0, v199
  v_mul_f32 v135, v151, v135
  v_pk_mul_f32 v[196:197], v[196:197], v[120:121] op_sel:[0,1]
  v_mul_f32 v136, v151, v136
  v_pk_mul_f32 v[198:199], v[198:199], v[120:121] op_sel:[0,1]
  s_waitcnt vmcnt(14)
  s_cbranch_vccnz L_vw0_19
  s_waitcnt vmcnt(10)
L_vw0_19:
  buffer_load_dwordx4 v[52:55], v92, s[12:15], s61 offen offset:256 nt
  v_pk_fma_f32 v[200:201], v[80:81], s[92:93], v[120:121] op_sel_hi:[1,1,0] neg_lo:[0,0,1] neg_hi:[0,0,1]
  v_pk_fma_f32 v[202:203], v[82:83], s[92:93], v[120:121] op_sel_hi:[1,1,0] neg_lo:[0,0,1] neg_hi:[0,0,1]
  v_cvt_pk_bf16_f32 v200, 0, v200
  v_mul_f32 v137, v151, v137
  v_cvt_pk_bf16_f32 v201, 0, v201
  v_mul_f32 v138, v151, v138
  v_cvt_pk_bf16_f32 v202, 0, v202
  v_mul_f32 v139, v151, v139
  v_cvt_pk_bf16_f32 v203, 0, v203
  v_mul_f32 v140, v151, v140
  v_pk_mul_f32 v[200:201], v[200:201], v[120:121] op_sel:[0,1]
  v_mul_f32 v141, v151, v141
  v_pk_mul_f32 v[202:203], v[202:203], v[120:121] op_sel:[0,1]
  s_waitcnt vmcnt(14)
  s_cbranch_vccnz L_vw0_20
  s_waitcnt vmcnt(10)
L_vw0_20:
  buffer_load_dwordx4 v[56:59], v92, s[12:15], s61 offen offset:512 nt
  v_pk_fma_f32 v[204:205], v[84:85], s[92:93], v[120:121] op_sel_hi:[1,1,0] neg_lo:[0,0,1] neg_hi:[0,0,1]
  v_pk_fma_f32 v[206:207], v[86:87], s[92:93], v[120:121] op_sel_hi:[1,1,0] neg_lo:[0,0,1] neg_hi:[0,0,1]
  v_cvt_pk_bf16_f32 v204, 0, v204
  v_mul_f32 v142, v151, v142
  v_cvt_pk_bf16_f32 v205, 0, v205
  v_mul_f32 v143, v151, v143
  v_cvt_pk_bf16_f32 v206, 0, v206
  v_cvt_pk_bf16_f32 v207, 0, v207
  v_pk_mul_f32 v[204:205], v[204:205], v[120:121] op_sel:[0,1]
  v_pk_mul_f32 v[206:207], v[206:207], v[120:121] op_sel:[0,1]
  s_waitcnt vmcnt(14)
  s_cbranch_vccnz L_vw0_21
  s_waitcnt vmcnt(10)
L_vw0_21:
  buffer_load_dwordx4 v[60:63], v93, s[12:15], s61 offen offset:0 nt
  v_mov_b32_dpp v120, v118 row_newbcast:7 row_mask:0xf bank_mask:0xf
  v_mov_b32_dpp v121, v119 row_newbcast:7 row_mask:0xf bank_mask:0xf
  v_pk_fma_f32 v[112:113], v[88:89], s[92:93], v[120:121] op_sel_hi:[1,1,0] neg_lo:[0,0,1] neg_hi:[0,0,1]
  v_pk_fma_f32 v[114:115], v[90:91], s[92:93], v[120:121] op_sel_hi:[1,1,0] neg_lo:[0,0,1] neg_hi:[0,0,1]
  v_cvt_pk_bf16_f32 v112, 0, v112
  v_cvt_pk_bf16_f32 v113, 0, v113
  v_cvt_pk_bf16_f32 v114, 0, v114
  v_cvt_pk_bf16_f32 v115, 0, v115
  v_pk_mul_f32 v[112:113], v[112:113], v[120:121] op_sel:[0,1]
  v_pk_mul_f32 v[114:115], v[114:115], v[120:121] op_sel:[0,1]
  v_cvt_pk_bf16_f32 v211, v196, v112
  v_cvt_pk_bf16_f32 v215, v197, v113
  v_cvt_pk_bf16_f32 v219, v198, v114
  v_cvt_pk_bf16_f32 v223, v199, v115
  v_mfma_f32_16x16x32_bf16 v[132:135], v[172:175], v[208:211], v[132:135]
  v_mfma_f32_16x16x32_bf16 v[132:135], v[176:179], v[212:215], v[132:135]
  v_mfma_f32_16x16x32_bf16 v[132:135], v[180:183], v[216:219], v[132:135]
  v_mfma_f32_16x16x32_bf16 v[132:135], v[184:187], v[220:223], v[132:135]
  s_waitcnt vmcnt(14)
  s_cbranch_vccnz L_vw0_22
  s_waitcnt vmcnt(10)
L_vw0_22:
  buffer_load_dwordx4 v[64:67], v93, s[12:15], s61 offen offset:256 nt
  v_pk_fma_f32 v[112:113], v[4:5], s[92:93], v[120:121] op_sel_hi:[1,1,0] neg_lo:[0,0,1] neg_hi:[0,0,1]
  v_pk_fma_f32 v[114:115], v[6:7], s[92:93], v[120:121] op_sel_hi:[1,1,0] neg_lo:[0,0,1] neg_hi:[0,0,1]
  v_cvt_pk_bf16_f32 v112, 0, v112
  v_cvt_pk_bf16_f32 v113, 0, v113
  v_cvt_pk_bf16_f32 v114, 0, v114
  v_cvt_pk_bf16_f32 v115, 0, v115
  v_pk_mul_f32 v[112:113], v[112:113], v[120:121] op_sel:[0,1]
  v_pk_mul_f32 v[114:115], v[114:115], v[120:121] op_sel:[0,1]
  v_cvt_pk_bf16_f32 v227, v200, v112
  v_cvt_pk_bf16_f32 v231, v201, v113
  v_cvt_pk_bf16_f32 v235, v202, v114
  v_cvt_pk_bf16_f32 v239, v203, v115
  v_mfma_f32_16x16x32_bf16 v[136:139], v[172:175], v[224:227], v[136:139]
  v_mfma_f32_16x16x32_bf16 v[136:139], v[176:179], v[228:231], v[136:139]
  v_mfma_f32_16x16x32_bf16 v[136:139], v[180:183], v[232:235], v[136:139]
  v_mfma_f32_16x16x32_bf16 v[136:139], v[184:187], v[236:239], v[136:139]
  s_waitcnt vmcnt(14)
  s_cbranch_vccnz L_vw0_23
  s_waitcnt vmcnt(10)
L_vw0_23:
  buffer_load_dwordx4 v[68:71], v93, s[12:15], s61 offen offset:512 nt
  v_pk_fma_f32 v[112:113], v[8:9], s[92:93], v[120:121] op_sel_hi:[1,1,0] neg_lo:[0,0,1] neg_hi:[0,0,1]
  v_pk_fma_f32 v[114:115], v[10:11], s[92:93], v[120:121] op_sel_hi:[1,1,0] neg_lo:[0,0,1] neg_hi:[0,0,1]
  v_cvt_pk_bf16_f32 v112, 0, v112
  v_cvt_pk_bf16_f32 v113, 0, v113
  v_cvt_pk_bf16_f32 v114, 0, v114
  v_cvt_pk_bf16_f32 v115, 0, v115
  v_pk_mul_f32 v[112:113], v[112:113], v[120:121] op_sel:[0,1]
  v_pk_mul_f32 v[114:115], v[114:115], v[120:121] op_sel:[0,1]
  v_cvt_pk_bf16_f32 v243, v204, v112
  v_cvt_pk_bf16_f32 v247, v205, v113
  v_cvt_pk_bf16_f32 v251, v206, v114
  v_cvt_pk_bf16_f32 v255, v207, v115
  v_mfma_f32_16x16x32_bf16 v[140:143], v[172:175], v[240:243], v[140:143]
  v_mfma_f32_16x16x32_bf16 v[140:143], v[176:179], v[244:247], v[140:143]
  v_mfma_f32_16x16x32_bf16 v[140:143], v[180:183], v[248:251], v[140:143]
  v_mfma_f32_16x16x32_bf16 v[140:143], v[184:187], v[252:255], v[140:143]
  s_waitcnt vmcnt(14)
  s_cbranch_vccnz L_vw0_24
  s_waitcnt vmcnt(10)
L_vw0_24:
  buffer_load_dwordx4 v[72:75], v93, s[12:15], s61 offen offset:768 nt
  v_mov_b32_dpp v120, v118 row_newbcast:8 row_mask:0xf bank_mask:0xf
  v_mov_b32_dpp v121, v119 row_newbcast:8 row_mask:0xf bank_mask:0xf
  v_pk_fma_f32 v[196:197], v[12:13], s[92:93], v[120:121] op_sel_hi:[1,1,0] neg_lo:[0,0,1] neg_hi:[0,0,1]
  v_pk_fma_f32 v[198:199], v[14:15], s[92:93], v[120:121] op_sel_hi:[1,1,0] neg_lo:[0,0,1] neg_hi:[0,0,1]
  v_cvt_pk_bf16_f32 v196, 0, v196
  v_cndmask_b32 v188, 0, v167, s[72:73]
  v_cvt_pk_bf16_f32 v197, 0, v197
  v_cndmask_b32 v189, 0, v168, s[72:73]
  v_cvt_pk_bf16_f32 v198, 0, v198
  v_cndmask_b32 v190, 0, v167, s[74:75]
  v_cvt_pk_bf16_f32 v199, 0, v199
  v_cndmask_b32 v191, 0, v168, s[74:75]
  v_pk_mul_f32 v[196:197], v[196:197], v[120:121] op_sel:[0,1]
  v_cndmask_b32 v192, 0, v167, s[76:77]
  v_pk_mul_f32 v[198:199], v[198:199], v[120:121] op_sel:[0,1]
  s_waitcnt vmcnt(14)
  s_cbranch_vccnz L_vw0_25
  s_waitcnt vmcnt(10)
L_vw0_25:
  buffer_load_dwordx4 v[76:79], v93, s[12:15], s61 offen offset:1024 nt
  v_pk_fma_f32 v[200:201], v[16:17], s[92:93], v[120:121] op_sel_hi:[1,1,0] neg_lo:[0,0,1] neg_hi:[0,0,1]
  v_pk_fma_f32 v[202:203], v[18:19], s[92:93], v[120:121] op_sel_hi:[1,1,0] neg_lo:[0,0,1] neg_hi:[0,0,1]
  v_cvt_pk_bf16_f32 v200, 0, v200
  v_cndmask_b32 v193, 0, v168, s[76:77]
  v_cvt_pk_bf16_f32 v201, 0, v201
  v_cndmask_b32 v194, 0, v167, s[78:79]
  v_cvt_pk_bf16_f32 v202, 0, v202
  v_cndmask_b32 v195, 0, v168, s[78:79]
  v_cvt_pk_bf16_f32 v203, 0, v203
  v_pk_mul_f32 v[200:201], v[200:201], v[120:121] op_sel:[0,1]
  v_pk_mul_f32 v[202:203], v[202:203], v[120:121] op_sel:[0,1]
  s_waitcnt vmcnt(14)
  s_cbranch_vccnz L_vw0_26
  s_waitcnt vmcnt(10)
L_vw0_26:
  buffer_load_dwordx4 v[80:83], v93, s[12:15], s61 offen offset:1280 nt
  v_pk_fma_f32 v[204:205], v[20:21], s[92:93], v[120:121] op_sel_hi:[1,1,0] neg_lo:[0,0,1] neg_hi:[0,0,1]
  v_pk_fma_f32 v[206:207], v[22:23], s[92:93], v[120:121] op_sel_hi:[1,1,0] neg_lo:[0,0,1] neg_hi:[0,0,1]
  v_cvt_pk_bf16_f32 v204, 0, v204
  v_cvt_pk_bf16_f32 v205, 0, v205
  v_cvt_pk_bf16_f32 v206, 0, v206
  v_cvt_pk_bf16_f32 v207, 0, v207
  v_pk_mul_f32 v[204:205], v[204:205], v[120:121] op_sel:[0,1]
  v_pk_mul_f32 v[206:207], v[206:207], v[120:121] op_sel:[0,1]
  s_waitcnt vmcnt(14)
  s_cbranch_vccnz L_vw0_27
  s_waitcnt vmcnt(10)
L_vw0_27:
  buffer_load_dwordx4 v[84:87], v93, s[12:15], s61 offen offset:1536 nt
  v_mov_b32_dpp v120, v118 row_newbcast:9 row_mask:0xf bank_mask:0xf
  v_mov_b32_dpp v121, v119 row_newbcast:9 row_mask:0xf bank_mask:0xf
  v_pk_fma_f32 v[112:113], v[24:25], s[92:93], v[120:121] op_sel_hi:[1,1,0] neg_lo:[0,0,1] neg_hi:[0,0,1]
  v_pk_fma_f32 v[114:115], v[26:27], s[92:93], v[120:121] op_sel_hi:[1,1,0] neg_lo:[0,0,1] neg_hi:[0,0,1]
  v_cvt_pk_bf16_f32 v112, 0, v112
  v_cvt_pk_bf16_f32 v113, 0, v113
  v_cvt_pk_bf16_f32 v114, 0, v114
  v_cvt_pk_bf16_f32 v115, 0, v115
  v_pk_mul_f32 v[112:113], v[112:113], v[120:121] op_sel:[0,1]
  v_pk_mul_f32 v[114:115], v[114:115], v[120:121] op_sel:[0,1]
  v_cvt_pk_bf16_f32 v208, v196, v112
  v_cvt_pk_bf16_f32 v212, v197, v113
  v_cvt_pk_bf16_f32 v216, v198, v114
  v_cvt_pk_bf16_f32 v220, v199, v115
  s_waitcnt vmcnt(14)
  s_cbranch_vccnz L_vw0_28
  s_waitcnt vmcnt(10)
L_vw0_28:
  buffer_load_dwordx4 v[88:91], v93, s[12:15], s61 offen offset:1792 nt
  v_pk_fma_f32 v[112:113], v[28:29], s[92:93], v[120:121] op_sel_hi:[1,1,0] neg_lo:[0,0,1] neg_hi:[0,0,1]
  v_pk_fma_f32 v[114:115], v[30:31], s[92:93], v[120:121] op_sel_hi:[1,1,0] neg_lo:[0,0,1] neg_hi:[0,0,1]
  v_cvt_pk_bf16_f32 v112, 0, v112
  v_cvt_pk_bf16_f32 v113, 0, v113
  v_cvt_pk_bf16_f32 v114, 0, v114
  v_cvt_pk_bf16_f32 v115, 0, v115
  v_pk_mul_f32 v[112:113], v[112:113], v[120:121] op_sel:[0,1]
  v_pk_mul_f32 v[114:115], v[114:115], v[120:121] op_sel:[0,1]
  v_cvt_pk_bf16_f32 v224, v200, v112
  v_cvt_pk_bf16_f32 v228, v201, v113
  v_cvt_pk_bf16_f32 v232, v202, v114
  v_cvt_pk_bf16_f32 v236, v203, v115
  s_waitcnt vmcnt(14)
  s_cbranch_vccnz L_vw0_29
  s_waitcnt vmcnt(10)
L_vw0_29:
  buffer_load_dwordx4 v[4:7], v93, s[12:15], s61 offen offset:2048 nt
  v_pk_fma_f32 v[112:113], v[32:33], s[92:93], v[120:121] op_sel_hi:[1,1,0] neg_lo:[0,0,1] neg_hi:[0,0,1]
  v_pk_fma_f32 v[114:115], v[34:35], s[92:93], v[120:121] op_sel_hi:[1,1,0] neg_lo:[0,0,1] neg_hi:[0,0,1]
  v_cvt_pk_bf16_f32 v112, 0, v112
  v_cvt_pk_bf16_f32 v113, 0, v113
  v_cvt_pk_bf16_f32 v114, 0, v114
  v_cvt_pk_bf16_f32 v115, 0, v115
  v_pk_mul_f32 v[112:113], v[112:113], v[120:121] op_sel:[0,1]
  v_pk_mul_f32 v[114:115], v[114:115], v[120:121] op_sel:[0,1]
  v_cvt_pk_bf16_f32 v240, v204, v112
  v_cvt_pk_bf16_f32 v244, v205, v113
  v_cvt_pk_bf16_f32 v248, v206, v114
  v_cvt_pk_bf16_f32 v252, v207, v115
  s_waitcnt vmcnt(14)
  s_cbranch_vccnz L_vw0_30
  s_waitcnt vmcnt(10)
L_vw0_30:
  buffer_load_dwordx4 v[8:11], v93, s[12:15], s61 offen offset:2304 nt
  v_mov_b32_dpp v120, v118 row_newbcast:10 row_mask:0xf bank_mask:0xf
  v_mov_b32_dpp v121, v119 row_newbcast:10 row_mask:0xf bank_mask:0xf
  v_pk_fma_f32 v[196:197], v[36:37], s[92:93], v[120:121] op_sel_hi:[1,1,0] neg_lo:[0,0,1] neg_hi:[0,0,1]
  v_pk_fma_f32 v[198:199], v[38:39], s[92:93], v[120:121] op_sel_hi:[1,1,0] neg_lo:[0,0,1] neg_hi:[0,0,1]
  v_cvt_pk_bf16_f32 v196, 0, v196
  v_cvt_pk_bf16_f32 v197, 0, v197
  v_cvt_pk_bf16_f32 v198, 0, v198
  v_cvt_pk_bf16_f32 v199, 0, v199
  v_pk_mul_f32 v[196:197], v[196:197], v[120:121] op_sel:[0,1]
  v_pk_mul_f32 v[198:199], v[198:199], v[120:121] op_sel:[0,1]
  v_cvt_pk_bf16_f32 v209, v196, 0
  v_cvt_pk_bf16_f32 v213, v197, 0
  v_cvt_pk_bf16_f32 v217, v198, 0
  v_cvt_pk_bf16_f32 v221, v199, 0
  v_mfma_f32_16x16x16_bf16 v[132:135], v[188:189], v[208:209], v[132:135]
  v_mfma_f32_16x16x16_bf16 v[132:135], v[190:191], v[212:213], v[132:135]
  v_mfma_f32_16x16x16_bf16 v[132:135], v[192:193], v[216:217], v[132:135]
  v_mfma_f32_16x16x16_bf16 v[132:135], v[194:195], v[220:221], v[132:135]
  s_waitcnt vmcnt(14)
  s_cbranch_vccnz L_vw0_31
  s_waitcnt vmcnt(10)
L_vw0_31:
  buffer_load_dwordx4 v[12:15], v93, s[12:15], s61 offen offset:2560 nt
  v_pk_fma_f32 v[200:201], v[40:41], s[92:93], v[120:121] op_sel_hi:[1,1,0] neg_lo:[0,0,1] neg_hi:[0,0,1]
  v_pk_fma_f32 v[202:203], v[42:43], s[92:93], v[120:121] op_sel_hi:[1,1,0] neg_lo:[0,0,1] neg_hi:[0,0,1]
  v_cvt_pk_bf16_f32 v200, 0, v200
  v_cvt_pk_bf16_f32 v201, 0, v201
  v_cvt_pk_bf16_f32 v202, 0, v202
  v_cvt_pk_bf16_f32 v203, 0, v203
  v_pk_mul_f32 v[200:201], v[200:201], v[120:121] op_sel:[0,1]
  v_pk_mul_f32 v[202:203], v[202:203], v[120:121] op_sel:[0,1]
  v_cvt_pk_bf16_f32 v225, v200, 0
  v_cvt_pk_bf16_f32 v229, v201, 0
  v_cvt_pk_bf16_f32 v233, v202, 0
  v_cvt_pk_bf16_f32 v237, v203, 0
  v_mfma_f32_16x16x16_bf16 v[136:139], v[188:189], v[224:225], v[136:139]
  v_mfma_f32_16x16x16_bf16 v[136:139], v[190:191], v[228:229], v[136:139]
  v_mfma_f32_16x16x16_bf16 v[136:139], v[192:193], v[232:233], v[136:139]
  v_mfma_f32_16x16x16_bf16 v[136:139], v[194:195], v[236:237], v[136:139]
  s_waitcnt vmcnt(14)
  s_cbranch_vccnz L_vw0_32
  s_waitcnt vmcnt(10)
L_vw0_32:
  buffer_load_dwordx4 v[16:19], v93, s[12:15], s61 offen offset:2816 nt
  v_pk_fma_f32 v[204:205], v[44:45], s[92:93], v[120:121] op_sel_hi:[1,1,0] neg_lo:[0,0,1] neg_hi:[0,0,1]
  v_pk_fma_f32 v[206:207], v[46:47], s[92:93], v[120:121] op_sel_hi:[1,1,0] neg_lo:[0,0,1] neg_hi:[0,0,1]
  v_cvt_pk_bf16_f32 v204, 0, v204
  v_cvt_pk_bf16_f32 v205, 0, v205
  v_cvt_pk_bf16_f32 v206, 0, v206
  v_cvt_pk_bf16_f32 v207, 0, v207
  v_pk_mul_f32 v[204:205], v[204:205], v[120:121] op_sel:[0,1]
  v_pk_mul_f32 v[206:207], v[206:207], v[120:121] op_sel:[0,1]
  v_cvt_pk_bf16_f32 v241, v204, 0
  v_cvt_pk_bf16_f32 v245, v205, 0
  v_cvt_pk_bf16_f32 v249, v206, 0
  v_cvt_pk_bf16_f32 v253, v207, 0
  v_mfma_f32_16x16x16_bf16 v[140:143], v[188:189], v[240:241], v[140:143]
  v_mfma_f32_16x16x16_bf16 v[140:143], v[190:191], v[244:245], v[140:143]
  v_mfma_f32_16x16x16_bf16 v[140:143], v[192:193], v[248:249], v[140:143]
  v_mfma_f32_16x16x16_bf16 v[140:143], v[194:195], v[252:253], v[140:143]
  s_mov_b32 s60, s61
  s_cmp_eq_u32 s89, s88
  s_cbranch_scc1 L_v1
  s_mov_b32 s88, s89
  v_mov_b32 v149, v147
  s_nop 1
  v_permlane32_swap_b32 v147, v149
  v_add_f32 v147, v147, v149
  v_mov_b32 v149, v147
  s_nop 1
  v_permlane16_swap_b32 v147, v149
  v_add_f32 v147, v147, v149
  ds_write_b64 v106, v[146:147]
  ds_write_b128 v105, v[132:135] offset:0
  ds_write_b128 v105, v[136:139] offset:1024
  ds_write_b128 v105, v[140:143] offset:2048
  s_and_b32 s70, s86, 15
  s_cmp_ge_u32 s70, 12
  s_cselect_b32 s70, 2, 0
  s_and_b32 s71, s87, 1
  s_bitcmp1_b32 s96, 6
  s_cselect_b32 s71, s4, s71
  s_add_u32 s70, s70, s71
  s_lshr_b32 s71, s86, 4
  s_lshl2_add_u32 s70, s71, s70
  s_add_u32 s71, s3, 0
  s_cmp_eq_u32 s100, s71
  s_cselect_b32 s44, s70, s44
  s_add_u32 s71, s3, 2
  s_cmp_eq_u32 s100, s71
  s_cselect_b32 s45, s70, s45
  s_add_u32 s100, s100, 1
  s_waitcnt lgkmcnt(0)
  v_add_u32 v105, 6208, v105
  v_add_u32 v106, 6208, v106
  v_mov_b32 v132, 0
  v_mov_b32 v133, 0
  v_mov_b32 v134, 0
  v_mov_b32 v135, 0
  v_mov_b32 v136, 0
  v_mov_b32 v137, 0
  v_mov_b32 v138, 0
  v_mov_b32 v139, 0
  v_mov_b32 v140, 0
  v_mov_b32 v141, 0
  v_mov_b32 v142, 0
  v_mov_b32 v143, 0
  v_mov_b32 v144, 0xff800000
  v_mov_b32 v146, 0x7f800000
  v_mov_b32 v147, 0
L_v1:
  s_mov_b32 s86, s84
  s_mov_b32 s87, s85
  s_add_u32 s64, s64, 2
  s_cmp_lt_u32 s64, s99
  s_cbranch_scc1 L_v11_ok
L_v11_spin:
  v_mov_b32 v148, 61700
  ds_read_b32 v148, v148
  s_waitcnt lgkmcnt(0)
  v_readfirstlane_b32 s99, v148
  s_nop 1
  s_cmp_lt_u32 s64, s99
  s_cbranch_scc0 L_v11_spin
L_v11_ok:
  s_andn2_b32 s70, s64, 1
  s_or_b32 s70, s70, s4
  s_lshr_b32 s71, s64, 5
  s_lshr_b32 s85, s96, s71
  s_lshr_b32 s85, s85, 3
  s_cmp_lt_u32 s64, s97
  s_cselect_b32 s70, s70, s64
  s_cselect_b32 s85, s64, s85
  s_and_b32 s85, s85, 1
  s_mul_i32 s71, s71, 4064
  s_add_u32 s70, s70, s71
  s_add_u32 s70, s70, s5
  s_mul_hi_u32 s84, s70, s90
  s_lshr_b32 s84, s84, 1
  s_mul_i32 s71, s84, 3
  s_sub_u32 s70, s70, s71
  s_lshl3_add_u32 s85, s70, s85
  s_mul_i32 s61, s84, 196608
  s_lshr_b32 s89, s84, 4
  s_lshl_b32 s70, s85, 5
  v_add_u32 v100, s70, v96
  v_mul_u32_u24 v100, 21846, v100
  v_lshrrev_b32 v100, 16, v100
  v_add_u32 v148, s85, v97
  v_lshrrev_b32 v149, v148, s91
  v_and_b32 v149, 1, v149
  v_cmp_eq_u32 s[54:55], 1, v149
  s_nop 1
  s_and_b64 s[52:53], s[54:55], s[58:59]
  s_andn2_b64 s[54:55], s[54:55], s[58:59]
  s_cmp_lt_u32 s64, 96
  s_cselect_b32 s61, s61, 805306368
  s_add_u32 s70, s64, 94
  v_mov_b32 v150, s70
  ds_read_b32 v110, v109
  ds_write_b32 v107, v150
  s_waitcnt vmcnt(14)
  s_cbranch_vccnz L_vw1_0
  s_waitcnt vmcnt(10)
L_vw1_0:
  buffer_load_dwordx4 v[20:23], v93, s[12:15], s60 offen offset:3072 nt
  v_mul_f32 v118, s94, v116
  v_mul_f32 v119, 0x4a800000, v117
  s_nop 0
  v_mov_b32_dpp v120, v118 row_newbcast:0 row_mask:0xf bank_mask:0xf
  v_mov_b32_dpp v121, v119 row_newbcast:0 row_mask:0xf bank_mask:0xf
  v_pk_fma_f32 v[196:197], v[48:49], s[92:93], v[120:121] op_sel_hi:[1,1,0] neg_lo:[0,0,1] neg_hi:[0,0,1]
  v_pk_fma_f32 v[198:199], v[50:51], s[92:93], v[120:121] op_sel_hi:[1,1,0] neg_lo:[0,0,1] neg_hi:[0,0,1]
  v_cvt_pk_bf16_f32 v196, 0, v196
  s_waitcnt lgkmcnt(0)
  v_cvt_pk_bf16_f32 v197, 0, v197
  v_cmp_lt_u32 vcc, v150, v110
  v_cvt_pk_bf16_f32 v198, 0, v198
  v_lshlrev_b32 v152, 16, v124
  v_cvt_pk_bf16_f32 v199, 0, v199
  v_and_b32 v153, s65, v124
  v_pk_mul_f32 v[196:197], v[196:197], v[120:121] op_sel:[0,1]
  v_lshlrev_b32 v154, 16, v125
  v_pk_mul_f32 v[198:199], v[198:199], v[120:121] op_sel:[0,1]
  s_waitcnt vmcnt(14)
  s_cbranch_vccnz L_vw1_1
  s_waitcnt vmcnt(10)
L_vw1_1:
  buffer_load_dwordx4 v[24:27], v93, s[12:15], s60 offen offset:3328 nt
  v_pk_fma_f32 v[200:201], v[52:53], s[92:93], v[120:121] op_sel_hi:[1,1,0] neg_lo:[0,0,1] neg_hi:[0,0,1]
  v_pk_fma_f32 v[202:203], v[54:55], s[92:93], v[120:121] op_sel_hi:[1,1,0] neg_lo:[0,0,1] neg_hi:[0,0,1]
  v_cvt_pk_bf16_f32 v200, 0, v200
  v_and_b32 v155, s65, v125
  v_cvt_pk_bf16_f32 v201, 0, v201
  v_lshlrev_b32 v156, 16, v126
  v_cvt_pk_bf16_f32 v202, 0, v202
  v_and_b32 v157, s65, v126
  v_cvt_pk_bf16_f32 v203, 0, v203
  v_lshlrev_b32 v158, 16, v127
  v_pk_mul_f32 v[200:201], v[200:201], v[120:121] op_sel:[0,1]
  v_and_b32 v159, s65, v127
  v_pk_mul_f32 v[202:203], v[202:203], v[120:121] op_sel:[0,1]
  s_waitcnt vmcnt(14)
  s_cbranch_vccnz L_vw1_2
  s_waitcnt vmcnt(10)
L_vw1_2:
  buffer_load_dwordx4 v[28:31], v93, s[12:15], s60 offen offset:3584 nt
  v_pk_fma_f32 v[204:205], v[56:57], s[92:93], v[120:121] op_sel_hi:[1,1,0] neg_lo:[0,0,1] neg_hi:[0,0,1]
  v_pk_fma_f32 v[206:207], v[58:59], s[92:93], v[120:121] op_sel_hi:[1,1,0] neg_lo:[0,0,1] neg_hi:[0,0,1]
  v_cvt_pk_bf16_f32 v204, 0, v204
  v_lshlrev_b32 v160, 16, v128
  v_cvt_pk_bf16_f32 v205, 0, v205
  v_and_b32 v161, s65, v128
  v_cvt_pk_bf16_f32 v206, 0, v206
  v_lshlrev_b32 v162, 16, v129
  v_cvt_pk_bf16_f32 v207, 0, v207
  v_add_u32 v102, 768, v102
  v_pk_mul_f32 v[204:205], v[204:205], v[120:121] op_sel:[0,1]
  v_add_u32 v103, 768, v103
  v_pk_mul_f32 v[206:207], v[206:207], v[120:121] op_sel:[0,1]
  s_waitcnt vmcnt(14)
  s_cbranch_vccnz L_vw1_3
  s_waitcnt vmcnt(10)
L_vw1_3:
  buffer_load_dwordx4 v[32:35], v94, s[12:15], s60 offen offset:0 nt
  v_mov_b32_dpp v120, v118 row_newbcast:1 row_mask:0xf bank_mask:0xf
  v_mov_b32_dpp v121, v119 row_newbcast:1 row_mask:0xf bank_mask:0xf
  v_pk_fma_f32 v[112:113], v[60:61], s[92:93], v[120:121] op_sel_hi:[1,1,0] neg_lo:[0,0,1] neg_hi:[0,0,1]
  v_pk_fma_f32 v[114:115], v[62:63], s[92:93], v[120:121] op_sel_hi:[1,1,0] neg_lo:[0,0,1] neg_hi:[0,0,1]
  s_lshl_b32 s62, s84, 9
  v_lshl_add_u32 v101, v100, 1, v99
  buffer_load_short_d16_hi v116, v101, s[32:35], s62 offen
  buffer_load_short_d16_hi v117, v101, s[28:31], s62 offen
  v_cvt_pk_bf16_f32 v112, 0, v112
  v_max3_f32 v148, v152, v153, v154
  v_cvt_pk_bf16_f32 v113, 0, v113
  ds_read_b128 v[124:127], v102
  v_cvt_pk_bf16_f32 v114, 0, v114
  ds_read_b64 v[128:129], v103 offset:256
  v_cvt_pk_bf16_f32 v115, 0, v115
  v_max3_f32 v149, v155, v156, v157
  v_pk_mul_f32 v[112:113], v[112:113], v[120:121] op_sel:[0,1]
  v_max3_f32 v148, v148, v158, v159
  v_pk_mul_f32 v[114:115], v[114:115], v[120:121] op_sel:[0,1]
  v_cvt_pk_bf16_f32 v208, v196, v112
  v_cvt_pk_bf16_f32 v212, v197, v113
  v_cvt_pk_bf16_f32 v216, v198, v114
  v_cvt_pk_bf16_f32 v220, v199, v115
  s_waitcnt vmcnt(16)
  s_cbranch_vccnz L_vw1_4
  s_waitcnt vmcnt(12)
L_vw1_4:
  buffer_load_dwordx4 v[36:39], v94, s[12:15], s60 offen offset:256 nt
  v_pk_fma_f32 v[112:113], v[64:65], s[92:93], v[120:121] op_sel_hi:[1,1,0] neg_lo:[0,0,1] neg_hi:[0,0,1]
  v_pk_fma_f32 v[114:115], v[66:67], s[92:93], v[120:121] op_sel_hi:[1,1,0] neg_lo:[0,0,1] neg_hi:[0,0,1]
  v_cvt_pk_bf16_f32 v112, 0, v112
  v_max3_f32 v149, v149, v160, v161
  v_cvt_pk_bf16_f32 v113, 0, v113
  v_max3_f32 v148, v148, v162, v144
  v_cvt_pk_bf16_f32 v114, 0, v114
  v_max_f32 v148, v148, v149
  v_cvt_pk_bf16_f32 v115, 0, v115
  v_mov_b32 v149, v148
  v_pk_mul_f32 v[112:113], v[112:113], v[120:121] op_sel:[0,1]
  s_nop 0
  v_permlane32_swap_b32 v148, v149
  v_pk_mul_f32 v[114:115], v[114:115], v[120:121] op_sel:[0,1]
  v_cvt_pk_bf16_f32 v224, v200, v112
  v_cvt_pk_bf16_f32 v228, v201, v113
  v_cvt_pk_bf16_f32 v232, v202, v114
  v_cvt_pk_bf16_f32 v236, v203, v115
  s_waitcnt vmcnt(16)
  s_cbranch_vccnz L_vw1_5
  s_waitcnt vmcnt(12)
L_vw1_5:
  buffer_load_dwordx4 v[40:43], v94, s[12:15], s60 offen offset:512 nt
  v_pk_fma_f32 v[112:113], v[68:69], s[92:93], v[120:121] op_sel_hi:[1,1,0] neg_lo:[0,0,1] neg_hi:[0,0,1]
  v_pk_fma_f32 v[114:115], v[70:71], s[92:93], v[120:121] op_sel_hi:[1,1,0] neg_lo:[0,0,1] neg_hi:[0,0,1]
  v_cvt_pk_bf16_f32 v112, 0, v112
  v_max_f32 v148, v148, v149
  v_cvt_pk_bf16_f32 v113, 0, v113
  v_mov_b32 v149, v148
  v_cvt_pk_bf16_f32 v114, 0, v114
  s_nop 0
  v_permlane16_swap_b32 v148, v149
  v_cvt_pk_bf16_f32 v115, 0, v115
  v_max_f32 v144, v148, v149
  v_pk_mul_f32 v[112:113], v[112:113], v[120:121] op_sel:[0,1]
  v_mul_f32 v148, s66, v144
  v_pk_mul_f32 v[114:115], v[114:115], v[120:121] op_sel:[0,1]
  v_cvt_pk_bf16_f32 v240, v204, v112
  v_cvt_pk_bf16_f32 v244, v205, v113
  v_cvt_pk_bf16_f32 v248, v206, v114
  v_cvt_pk_bf16_f32 v252, v207, v115
  s_waitcnt vmcnt(16)
  s_cbranch_vccnz L_vw1_6
  s_waitcnt vmcnt(12)
L_vw1_6:
  buffer_load_dwordx4 v[44:47], v94, s[12:15], s60 offen offset:768 nt
  v_mov_b32_dpp v120, v118 row_newbcast:2 row_mask:0xf bank_mask:0xf
  v_mov_b32_dpp v121, v119 row_newbcast:2 row_mask:0xf bank_mask:0xf
  v_pk_fma_f32 v[196:197], v[72:73], s[92:93], v[120:121] op_sel_hi:[1,1,0] neg_lo:[0,0,1] neg_hi:[0,0,1]
  v_pk_fma_f32 v[198:199], v[74:75], s[92:93], v[120:121] op_sel_hi:[1,1,0] neg_lo:[0,0,1] neg_hi:[0,0,1]
  v_cvt_pk_bf16_f32 v196, 0, v196
  v_add_f32 v150, v148, v146
  v_cvt_pk_bf16_f32 v197, 0, v197
  v_sub_f32 v146, 0, v148
  v_cvt_pk_bf16_f32 v198, 0, v198
  v_exp_f32 v150, -v150
  v_cvt_pk_bf16_f32 v199, 0, v199
  ds_bpermute_b32 v151, v104, v150
  v_pk_mul_f32 v[196:197], v[196:197], v[120:121] op_sel:[0,1]
  v_fma_f32 v152, v152, s66, v146
  v_pk_mul_f32 v[198:199], v[198:199], v[120:121] op_sel:[0,1]
  s_waitcnt vmcnt(16)
  s_cbranch_vccnz L_vw1_7
  s_waitcnt vmcnt(12)
L_vw1_7:
  buffer_load_dwordx4 v[48:51], v94, s[12:15], s60 offen offset:1024 nt
  v_pk_fma_f32 v[200:201], v[76:77], s[92:93], v[120:121] op_sel_hi:[1,1,0] neg_lo:[0,0,1] neg_hi:[0,0,1]
  v_pk_fma_f32 v[202:203], v[78:79], s[92:93], v[120:121] op_sel_hi:[1,1,0] neg_lo:[0,0,1] neg_hi:[0,0,1]
  v_cvt_pk_bf16_f32 v200, 0, v200
  v_exp_f32 v152, v152
  v_cvt_pk_bf16_f32 v201, 0, v201
  v_fma_f32 v153, v153, s66, v146
  v_cvt_pk_bf16_f32 v202, 0, v202
  v_exp_f32 v153, v153
  v_cvt_pk_bf16_f32 v203, 0, v203
  v_fma_f32 v154, v154, s66, v146
  v_pk_mul_f32 v[200:201], v[200:201], v[120:121] op_sel:[0,1]
  v_exp_f32 v154, v154
  v_pk_mul_f32 v[202:203], v[202:203], v[120:121] op_sel:[0,1]
  s_waitcnt vmcnt(16)
  s_cbranch_vccnz L_vw1_8
  s_waitcnt vmcnt(12)
L_vw1_8:
  buffer_load_dwordx4 v[52:55], v94, s[12:15], s60 offen offset:1280 nt
  v_pk_fma_f32 v[204:205], v[80:81], s[92:93], v[120:121] op_sel_hi:[1,1,0] neg_lo:[0,0,1] neg_hi:[0,0,1]
  v_pk_fma_f32 v[206:207], v[82:83], s[92:93], v[120:121] op_sel_hi:[1,1,0] neg_lo:[0,0,1] neg_hi:[0,0,1]
  v_cvt_pk_bf16_f32 v204, 0, v204
  v_fma_f32 v155, v155, s66, v146
  v_cvt_pk_bf16_f32 v205, 0, v205
  v_exp_f32 v155, v155
  v_cvt_pk_bf16_f32 v206, 0, v206
  v_fma_f32 v156, v156, s66, v146
  v_cvt_pk_bf16_f32 v207, 0, v207
  v_exp_f32 v156, v156
  v_pk_mul_f32 v[204:205], v[204:205], v[120:121] op_sel:[0,1]
  v_fma_f32 v157, v157, s66, v146
  v_pk_mul_f32 v[206:207], v[206:207], v[120:121] op_sel:[0,1]
  s_waitcnt vmcnt(16)
  s_cbranch_vccnz L_vw1_9
  s_waitcnt vmcnt(12)
L_vw1_9:
  buffer_load_dwordx4 v[56:59], v94, s[12:15], s60 offen offset:1536 nt
  v_mov_b32_dpp v120, v118 row_newbcast:3 row_mask:0xf bank_mask:0xf
  v_mov_b32_dpp v121, v119 row_newbcast:3 row_mask:0xf bank_mask:0xf
  v_pk_fma_f32 v[112:113], v[84:85], s[92:93], v[120:121] op_sel_hi:[1,1,0] neg_lo:[0,0,1] neg_hi:[0,0,1]
  v_pk_fma_f32 v[114:115], v[86:87], s[92:93], v[120:121] op_sel_hi:[1,1,0] neg_lo:[0,0,1] neg_hi:[0,0,1]
  v_cvt_pk_bf16_f32 v112, 0, v112
  v_exp_f32 v157, v157
  v_cvt_pk_bf16_f32 v113, 0, v113
  v_fma_f32 v158, v158, s66, v146
  v_cvt_pk_bf16_f32 v114, 0, v114
  v_exp_f32 v158, v158
  v_cvt_pk_bf16_f32 v115, 0, v115
  v_fma_f32 v159, v159, s66, v146
  v_pk_mul_f32 v[112:113], v[112:113], v[120:121] op_sel:[0,1]
  v_exp_f32 v159, v159
  v_pk_mul_f32 v[114:115], v[114:115], v[120:121] op_sel:[0,1]
  v_cvt_pk_bf16_f32 v209, v196, v112
  v_cvt_pk_bf16_f32 v213, v197, v113
  v_cvt_pk_bf16_f32 v217, v198, v114
  v_cvt_pk_bf16_f32 v221, v199, v115
  s_waitcnt vmcnt(16)
  s_cbranch_vccnz L_vw1_10
  s_waitcnt vmcnt(12)
L_vw1_10:
  buffer_load_dwordx4 v[60:63], v94, s[12:15], s60 offen offset:1792 nt
  v_pk_fma_f32 v[112:113], v[88:89], s[92:93], v[120:121] op_sel_hi:[1,1,0] neg_lo:[0,0,1] neg_hi:[0,0,1]
  v_pk_fma_f32 v[114:115], v[90:91], s[92:93], v[120:121] op_sel_hi:[1,1,0] neg_lo:[0,0,1] neg_hi:[0,0,1]
  v_cvt_pk_bf16_f32 v112, 0, v112
  v_fma_f32 v160, v160, s66, v146
  v_cvt_pk_bf16_f32 v113, 0, v113
  v_exp_f32 v160, v160
  v_cvt_pk_bf16_f32 v114, 0, v114
  v_fma_f32 v161, v161, s66, v146
  v_cvt_pk_bf16_f32 v115, 0, v115
  v_exp_f32 v161, v161
  v_pk_mul_f32 v[112:113], v[112:113], v[120:121] op_sel:[0,1]
  v_fma_f32 v162, v162, s66, v146
  v_pk_mul_f32 v[114:115], v[114:115], v[120:121] op_sel:[0,1]
  v_cvt_pk_bf16_f32 v225, v200, v112
  v_cvt_pk_bf16_f32 v229, v201, v113
  v_cvt_pk_bf16_f32 v233, v202, v114
  v_cvt_pk_bf16_f32 v237, v203, v115
  s_waitcnt vmcnt(16)
  s_cbranch_vccnz L_vw1_11
  s_waitcnt vmcnt(12)
L_vw1_11:
  buffer_load_dwordx4 v[64:67], v94, s[12:15], s60 offen offset:2048 nt
  v_pk_fma_f32 v[112:113], v[4:5], s[92:93], v[120:121] op_sel_hi:[1,1,0] neg_lo:[0,0,1] neg_hi:[0,0,1]
  v_pk_fma_f32 v[114:115], v[6:7], s[92:93], v[120:121] op_sel_hi:[1,1,0] neg_lo:[0,0,1] neg_hi:[0,0,1]
  v_cvt_pk_bf16_f32 v112, 0, v112
  v_exp_f32 v162, v162
  v_cvt_pk_bf16_f32 v113, 0, v113
  v_add_f32 v148, v152, v153
  v_cvt_pk_bf16_f32 v114, 0, v114
  v_add_f32 v149, v154, v155
  v_cvt_pk_bf16_f32 v115, 0, v115
  v_add_f32 v148, v148, v156
  v_pk_mul_f32 v[112:113], v[112:113], v[120:121] op_sel:[0,1]
  v_add_f32 v149, v149, v157
  v_pk_mul_f32 v[114:115], v[114:115], v[120:121] op_sel:[0,1]
  v_cvt_pk_bf16_f32 v241, v204, v112
  v_cvt_pk_bf16_f32 v245, v205, v113
  v_cvt_pk_bf16_f32 v249, v206, v114
  v_cvt_pk_bf16_f32 v253, v207, v115
  s_waitcnt vmcnt(16)
  s_cbranch_vccnz L_vw1_12
  s_waitcnt vmcnt(12)
L_vw1_12:
  buffer_load_dwordx4 v[68:71], v94, s[12:15], s60 offen offset:2304 nt
  v_mov_b32_dpp v120, v118 row_newbcast:4 row_mask:0xf bank_mask:0xf
  v_mov_b32_dpp v121, v119 row_newbcast:4 row_mask:0xf bank_mask:0xf
  v_pk_fma_f32 v[196:197], v[8:9], s[92:93], v[120:121] op_sel_hi:[1,1,0] neg_lo:[0,0,1] neg_hi:[0,0,1]
  v_pk_fma_f32 v[198:199], v[10:11], s[92:93], v[120:121] op_sel_hi:[1,1,0] neg_lo:[0,0,1] neg_hi:[0,0,1]
  v_cvt_pk_bf16_f32 v196, 0, v196
  v_add_f32 v148, v148, v158
  v_cvt_pk_bf16_f32 v197, 0, v197
  v_add_f32 v149, v149, v159
  v_cvt_pk_bf16_f32 v198, 0, v198
  v_add_f32 v148, v148, v160
  v_cvt_pk_bf16_f32 v199, 0, v199
  v_add_f32 v149, v149, v161
  v_pk_mul_f32 v[196:197], v[196:197], v[120:121] op_sel:[0,1]
  v_add_f32 v148, v148, v162
  v_pk_mul_f32 v[198:199], v[198:199], v[120:121] op_sel:[0,1]
  s_waitcnt vmcnt(16)
  s_cbranch_vccnz L_vw1_13
  s_waitcnt vmcnt(12)
L_vw1_13:
  buffer_load_dwordx4 v[72:75], v94, s[12:15], s60 offen offset:2560 nt
  v_pk_fma_f32 v[200:201], v[12:13], s[92:93], v[120:121] op_sel_hi:[1,1,0] neg_lo:[0,0,1] neg_hi:[0,0,1]
  v_pk_fma_f32 v[202:203], v[14:15], s[92:93], v[120:121] op_sel_hi:[1,1,0] neg_lo:[0,0,1] neg_hi:[0,0,1]
  v_cvt_pk_bf16_f32 v200, 0, v200
  v_add_f32 v148, v148, v149
  v_cvt_pk_bf16_f32 v201, 0, v201
  v_fma_f32 v147, v147, v150, v148
  v_cvt_pk_bf16_f32 v202, 0, v202
  v_cvt_pk_bf16_f32 v163, v152, v153
  v_cvt_pk_bf16_f32 v203, 0, v203
  v_cvt_pk_bf16_f32 v164, v154, v155
  v_pk_mul_f32 v[200:201], v[200:201], v[120:121] op_sel:[0,1]
  v_cvt_pk_bf16_f32 v165, v156, v157
  v_pk_mul_f32 v[202:203], v[202:203], v[120:121] op_sel:[0,1]
  s_waitcnt vmcnt(16)
  s_cbranch_vccnz L_vw1_14
  s_waitcnt vmcnt(12)
L_vw1_14:
  buffer_load_dwordx4 v[76:79], v94, s[12:15], s60 offen offset:2816 nt
  v_pk_fma_f32 v[204:205], v[16:17], s[92:93], v[120:121] op_sel_hi:[1,1,0] neg_lo:[0,0,1] neg_hi:[0,0,1]
  v_pk_fma_f32 v[206:207], v[18:19], s[92:93], v[120:121] op_sel_hi:[1,1,0] neg_lo:[0,0,1] neg_hi:[0,0,1]
  v_cvt_pk_bf16_f32 v204, 0, v204
  v_cvt_pk_bf16_f32 v166, v158, v159
  v_cvt_pk_bf16_f32 v205, 0, v205
  v_cvt_pk_bf16_f32 v167, v160, v161
  v_cvt_pk_bf16_f32 v206, 0, v206
  v_cvt_pk_bf16_f32 v168, v162, 0
  v_cvt_pk_bf16_f32 v207, 0, v207
  v_cndmask_b32 v172, 0, v163, s[72:73]
  v_pk_mul_f32 v[204:205], v[204:205], v[120:121] op_sel:[0,1]
  v_cndmask_b32 v173, 0, v164, s[72:73]
  v_pk_mul_f32 v[206:207], v[206:207], v[120:121] op_sel:[0,1]
  s_waitcnt vmcnt(16)
  s_cbranch_vccnz L_vw1_15
  s_waitcnt vmcnt(10)
L_vw1_15:
  buffer_load_dwordx4 v[80:83], v95, s[12:15], s60 offen offset:0 nt
  v_mov_b32_dpp v120, v118 row_newbcast:5 row_mask:0xf bank_mask:0xf
  v_mov_b32_dpp v121, v119 row_newbcast:5 row_mask:0xf bank_mask:0xf
  v_pk_fma_f32 v[112:113], v[20:21], s[92:93], v[120:121] op_sel_hi:[1,1,0] neg_lo:[0,0,1] neg_hi:[0,0,1]
  v_pk_fma_f32 v[114:115], v[22:23], s[92:93], v[120:121] op_sel_hi:[1,1,0] neg_lo:[0,0,1] neg_hi:[0,0,1]
  v_cvt_pk_bf16_f32 v112, 0, v112
  v_cndmask_b32 v174, 0, v165, s[72:73]
  v_cvt_pk_bf16_f32 v113, 0, v113
  v_cndmask_b32 v175, 0, v166, s[72:73]
  v_cvt_pk_bf16_f32 v114, 0, v114
  v_cndmask_b32 v176, 0, v163, s[74:75]
  v_cvt_pk_bf16_f32 v115, 0, v115
  v_cndmask_b32 v177, 0, v164, s[74:75]
  v_pk_mul_f32 v[112:113], v[112:113], v[120:121] op_sel:[0,1]
  v_cndmask_b32 v178, 0, v165, s[74:75]
  v_pk_mul_f32 v[114:115], v[114:115], v[120:121] op_sel:[0,1]
  v_cvt_pk_bf16_f32 v210, v196, v112
  v_cvt_pk_bf16_f32 v214, v197, v113
  v_cvt_pk_bf16_f32 v218, v198, v114
  v_cvt_pk_bf16_f32 v222, v199, v115
  s_waitcnt vmcnt(16)
  s_cbranch_vccnz L_vw1_16
  s_waitcnt vmcnt(10)
L_vw1_16:
  buffer_load_dwordx4 v[84:87], v95, s[12:15], s60 offen offset:256 nt
  v_pk_fma_f32 v[112:113], v[24:25], s[92:93], v[120:121] op_sel_hi:[1,1,0] neg_lo:[0,0,1] neg_hi:[0,0,1]
  v_pk_fma_f32 v[114:115], v[26:27], s[92:93], v[120:121] op_sel_hi:[1,1,0] neg_lo:[0,0,1] neg_hi:[0,0,1]
  v_cvt_pk_bf16_f32 v112, 0, v112
  v_cndmask_b32 v179, 0, v166, s[74:75]
  v_cvt_pk_bf16_f32 v113, 0, v113
  v_cndmask_b32 v180, 0, v163, s[76:77]
  v_cvt_pk_bf16_f32 v114, 0, v114
  v_cndmask_b32 v181, 0, v164, s[76:77]
  v_cvt_pk_bf16_f32 v115, 0, v115
  v_cndmask_b32 v182, 0, v165, s[76:77]
  v_pk_mul_f32 v[112:113], v[112:113], v[120:121] op_sel:[0,1]
  v_cndmask_b32 v183, 0, v166, s[76:77]
  v_pk_mul_f32 v[114:115], v[114:115], v[120:121] op_sel:[0,1]
  v_cvt_pk_bf16_f32 v226, v200, v112
  v_cvt_pk_bf16_f32 v230, v201, v113
  v_cvt_pk_bf16_f32 v234, v202, v114
  v_cvt_pk_bf16_f32 v238, v203, v115
  s_waitcnt vmcnt(16)
  s_cbranch_vccnz L_vw1_17
  s_waitcnt vmcnt(10)
L_vw1_17:
  buffer_load_dwordx4 v[88:91], v95, s[12:15], s60 offen offset:512 nt
  v_pk_fma_f32 v[112:113], v[28:29], s[92:93], v[120:121] op_sel_hi:[1,1,0] neg_lo:[0,0,1] neg_hi:[0,0,1]
  v_pk_fma_f32 v[114:115], v[30:31], s[92:93], v[120:121] op_sel_hi:[1,1,0] neg_lo:[0,0,1] neg_hi:[0,0,1]
  v_cvt_pk_bf16_f32 v112, 0, v112
  v_cndmask_b32 v184, 0, v163, s[78:79]
  v_cvt_pk_bf16_f32 v113, 0, v113
  v_cndmask_b32 v185, 0, v164, s[78:79]
  v_cvt_pk_bf16_f32 v114, 0, v114
  v_cndmask_b32 v186, 0, v165, s[78:79]
  v_cvt_pk_bf16_f32 v115, 0, v115
  v_cndmask_b32 v187, 0, v166, s[78:79]
  v_pk_mul_f32 v[112:113], v[112:113], v[120:121] op_sel:[0,1]
  s_waitcnt lgkmcnt(0)
  v_pk_mul_f32 v[114:115], v[114:115], v[120:121] op_sel:[0,1]
  v_cvt_pk_bf16_f32 v242, v204, v112
  v_cvt_pk_bf16_f32 v246, v205, v113
  v_cvt_pk_bf16_f32 v250, v206, v114
  v_cvt_pk_bf16_f32 v254, v207, v115
  v_mad_u32_u24 v92, v100, s63, v98
  v_add_u32 v93, 768, v92
  v_add_u32 v94, 4608, v92
  v_add_u32 v95, 7680, v92
  v_cndmask_b32 v92, v92, v108, s[52:53]
  v_cndmask_b32 v95, v95, v108, s[54:55]
  s_waitcnt vmcnt(16)
  s_cbranch_vccnz L_vw1_18
  s_waitcnt vmcnt(10)
L_vw1_18:
  buffer_load_dwordx4 v[4:7], v92, s[12:15], s61 offen offset:0 nt
  v_mov_b32_dpp v120, v118 row_newbcast:6 row_mask:0xf bank_mask:0xf
  v_mov_b32_dpp v121, v119 row_newbcast:6 row_mask:0xf bank_mask:0xf
  v_pk_fma_f32 v[196:197], v[32:33], s[92:93], v[120:121] op_sel_hi:[1,1,0] neg_lo:[0,0,1] neg_hi:[0,0,1]
  v_pk_fma_f32 v[198:199], v[34:35], s[92:93], v[120:121] op_sel_hi:[1,1,0] neg_lo:[0,0,1] neg_hi:[0,0,1]
  v_cvt_pk_bf16_f32 v196, 0, v196
  v_mul_f32 v132, v151, v132
  v_cvt_pk_bf16_f32 v197, 0, v197
  v_mul_f32 v133, v151, v133
  v_cvt_pk_bf16_f32 v198, 0, v198
  v_mul_f32 v134, v151, v134
  v_cvt_pk_bf16_f32 v199, 0, v199
  v_mul_f32 v135, v151, v135
  v_pk_mul_f32 v[196:197], v[196:197], v[120:121] op_sel:[0,1]
  v_mul_f32 v136, v151, v136
  v_pk_mul_f32 v[198:199], v[198:199], v[120:121] op_sel:[0,1]
  s_waitcnt vmcnt(14)
  s_cbranch_vccnz L_vw1_19
  s_waitcnt vmcnt(10)
L_vw1_19:
  buffer_load_dwordx4 v[8:11], v92, s[12:15], s61 offen offset:256 nt
  v_pk_fma_f32 v[200:201], v[36:37], s[92:93], v[120:121] op_sel_hi:[1,1,0] neg_lo:[0,0,1] neg_hi:[0,0,1]
  v_pk_fma_f32 v[202:203], v[38:39], s[92:93], v[120:121] op_sel_hi:[1,1,0] neg_lo:[0,0,1] neg_hi:[0,0,1]
  v_cvt_pk_bf16_f32 v200, 0, v200
  v_mul_f32 v137, v151, v137
  v_cvt_pk_bf16_f32 v201, 0, v201
  v_mul_f32 v138, v151, v138
  v_cvt_pk_bf16_f32 v202, 0, v202
  v_mul_f32 v139, v151, v139
  v_cvt_pk_bf16_f32 v203, 0, v203
  v_mul_f32 v140, v151, v140
  v_pk_mul_f32 v[200:201], v[200:201], v[120:121] op_sel:[0,1]
  v_mul_f32 v141, v151, v141
  v_pk_mul_f32 v[202:203], v[202:203], v[120:121] op_sel:[0,1]
  s_waitcnt vmcnt(14)
  s_cbranch_vccnz L_vw1_20
  s_waitcnt vmcnt(10)
L_vw1_20:
  buffer_load_dwordx4 v[12:15], v92, s[12:15], s61 offen offset:512 nt
  v_pk_fma_f32 v[204:205], v[40:41], s[92:93], v[120:121] op_sel_hi:[1,1,0] neg_lo:[0,0,1] neg_hi:[0,0,1]
  v_pk_fma_f32 v[206:207], v[42:43], s[92:93], v[120:121] op_sel_hi:[1,1,0] neg_lo:[0,0,1] neg_hi:[0,0,1]
  v_cvt_pk_bf16_f32 v204, 0, v204
  v_mul_f32 v142, v151, v142
  v_cvt_pk_bf16_f32 v205, 0, v205
  v_mul_f32 v143, v151, v143
  v_cvt_pk_bf16_f32 v206, 0, v206
  v_cvt_pk_bf16_f32 v207, 0, v207
  v_pk_mul_f32 v[204:205], v[204:205], v[120:121] op_sel:[0,1]
  v_pk_mul_f32 v[206:207], v[206:207], v[120:121] op_sel:[0,1]
  s_waitcnt vmcnt(14)
  s_cbranch_vccnz L_vw1_21
  s_waitcnt vmcnt(10)
L_vw1_21:
  buffer_load_dwordx4 v[16:19], v93, s[12:15], s61 offen offset:0 nt
  v_mov_b32_dpp v120, v118 row_newbcast:7 row_mask:0xf bank_mask:0xf
  v_mov_b32_dpp v121, v119 row_newbcast:7 row_mask:0xf bank_mask:0xf
  v_pk_fma_f32 v[112:113], v[44:45], s[92:93], v[120:121] op_sel_hi:[1,1,0] neg_lo:[0,0,1] neg_hi:[0,0,1]
  v_pk_fma_f32 v[114:115], v[46:47], s[92:93], v[120:121] op_sel_hi:[1,1,0] neg_lo:[0,0,1] neg_hi:[0,0,1]
  v_cvt_pk_bf16_f32 v112, 0, v112
  v_cvt_pk_bf16_f32 v113, 0, v113
  v_cvt_pk_bf16_f32 v114, 0, v114
  v_cvt_pk_bf16_f32 v115, 0, v115
  v_pk_mul_f32 v[112:113], v[112:113], v[120:121] op_sel:[0,1]
  v_pk_mul_f32 v[114:115], v[114:115], v[120:121] op_sel:[0,1]
  v_cvt_pk_bf16_f32 v211, v196, v112
  v_cvt_pk_bf16_f32 v215, v197, v113
  v_cvt_pk_bf16_f32 v219, v198, v114
  v_cvt_pk_bf16_f32 v223, v199, v115
  v_mfma_f32_16x16x32_bf16 v[132:135], v[172:175], v[208:211], v[132:135]
  v_mfma_f32_16x16x32_bf16 v[132:135], v[176:179], v[212:215], v[132:135]
  v_mfma_f32_16x16x32_bf16 v[132:135], v[180:183], v[216:219], v[132:135]
  v_mfma_f32_16x16x32_bf16 v[132:135], v[184:187], v[220:223], v[132:135]
  s_waitcnt vmcnt(14)
  s_cbranch_vccnz L_vw1_22
  s_waitcnt vmcnt(10)
L_vw1_22:
  buffer_load_dwordx4 v[20:23], v93, s[12:15], s61 offen offset:256 nt
  v_pk_fma_f32 v[112:113], v[48:49], s[92:93], v[120:121] op_sel_hi:[1,1,0] neg_lo:[0,0,1] neg_hi:[0,0,1]
  v_pk_fma_f32 v[114:115], v[50:51], s[92:93], v[120:121] op_sel_hi:[1,1,0] neg_lo:[0,0,1] neg_hi:[0,0,1]
  v_cvt_pk_bf16_f32 v112, 0, v112
  v_cvt_pk_bf16_f32 v113, 0, v113
  v_cvt_pk_bf16_f32 v114, 0, v114
  v_cvt_pk_bf16_f32 v115, 0, v115
  v_pk_mul_f32 v[112:113], v[112:113], v[120:121] op_sel:[0,1]
  v_pk_mul_f32 v[114:115], v[114:115], v[120:121] op_sel:[0,1]
  v_cvt_pk_bf16_f32 v227, v200, v112
  v_cvt_pk_bf16_f32 v231, v201, v113
  v_cvt_pk_bf16_f32 v235, v202, v114
  v_cvt_pk_bf16_f32 v239, v203, v115
  v_mfma_f32_16x16x32_bf16 v[136:139], v[172:175], v[224:227], v[136:139]
  v_mfma_f32_16x16x32_bf16 v[136:139], v[176:179], v[228:231], v[136:139]
  v_mfma_f32_16x16x32_bf16 v[136:139], v[180:183], v[232:235], v[136:139]
  v_mfma_f32_16x16x32_bf16 v[136:139], v[184:187], v[236:239], v[136:139]
  s_waitcnt vmcnt(14)
  s_cbranch_vccnz L_vw1_23
  s_waitcnt vmcnt(10)
L_vw1_23:
  buffer_load_dwordx4 v[24:27], v93, s[12:15], s61 offen offset:512 nt
  v_pk_fma_f32 v[112:113], v[52:53], s[92:93], v[120:121] op_sel_hi:[1,1,0] neg_lo:[0,0,1] neg_hi:[0,0,1]
  v_pk_fma_f32 v[114:115], v[54:55], s[92:93], v[120:121] op_sel_hi:[1,1,0] neg_lo:[0,0,1] neg_hi:[0,0,1]
  v_cvt_pk_bf16_f32 v112, 0, v112
  v_cvt_pk_bf16_f32 v113, 0, v113
  v_cvt_pk_bf16_f32 v114, 0, v114
  v_cvt_pk_bf16_f32 v115, 0, v115
  v_pk_mul_f32 v[112:113], v[112:113], v[120:121] op_sel:[0,1]
  v_pk_mul_f32 v[114:115], v[114:115], v[120:121] op_sel:[0,1]
  v_cvt_pk_bf16_f32 v243, v204, v112
  v_cvt_pk_bf16_f32 v247, v205, v113
  v_cvt_pk_bf16_f32 v251, v206, v114
  v_cvt_pk_bf16_f32 v255, v207, v115
  v_mfma_f32_16x16x32_bf16 v[140:143], v[172:175], v[240:243], v[140:143]
  v_mfma_f32_16x16x32_bf16 v[140:143], v[176:179], v[244:247], v[140:143]
  v_mfma_f32_16x16x32_bf16 v[140:143], v[180:183], v[248:251], v[140:143]
  v_mfma_f32_16x16x32_bf16 v[140:143], v[184:187], v[252:255], v[140:143]
  s_waitcnt vmcnt(14)
  s_cbranch_vccnz L_vw1_24
  s_waitcnt vmcnt(10)
L_vw1_24:
  buffer_load_dwordx4 v[28:31], v93, s[12:15], s61 offen offset:768 nt
  v_mov_b32_dpp v120, v118 row_newbcast:8 row_mask:0xf bank_mask:0xf
  v_mov_b32_dpp v121, v119 row_newbcast:8 row_mask:0xf bank_mask:0xf
  v_pk_fma_f32 v[196:197], v[56:57], s[92:93], v[120:121] op_sel_hi:[1,1,0] neg_lo:[0,0,1] neg_hi:[0,0,1]
  v_pk_fma_f32 v[198:199], v[58:59], s[92:93], v[120:121] op_sel_hi:[1,1,0] neg_lo:[0,0,1] neg_hi:[0,0,1]
  v_cvt_pk_bf16_f32 v196, 0, v196
  v_cndmask_b32 v188, 0, v167, s[72:73]
  v_cvt_pk_bf16_f32 v197, 0, v197
  v_cndmask_b32 v189, 0, v168, s[72:73]
  v_cvt_pk_bf16_f32 v198, 0, v198
  v_cndmask_b32 v190, 0, v167, s[74:75]
  v_cvt_pk_bf16_f32 v199, 0, v199
  v_cndmask_b32 v191, 0, v168, s[74:75]
  v_pk_mul_f32 v[196:197], v[196:197], v[120:121] op_sel:[0,1]
  v_cndmask_b32 v192, 0, v167, s[76:77]
  v_pk_mul_f32 v[198:199], v[198:199], v[120:121] op_sel:[0,1]
  s_waitcnt vmcnt(14)
  s_cbranch_vccnz L_vw1_25
  s_waitcnt vmcnt(10)
L_vw1_25:
  buffer_load_dwordx4 v[32:35], v93, s[12:15], s61 offen offset:1024 nt
  v_pk_fma_f32 v[200:201], v[60:61], s[92:93], v[120:121] op_sel_hi:[1,1,0] neg_lo:[0,0,1] neg_hi:[0,0,1]
  v_pk_fma_f32 v[202:203], v[62:63], s[92:93], v[120:121] op_sel_hi:[1,1,0] neg_lo:[0,0,1] neg_hi:[0,0,1]
  v_cvt_pk_bf16_f32 v200, 0, v200
  v_cndmask_b32 v193, 0, v168, s[76:77]
  v_cvt_pk_bf16_f32 v201, 0, v201
  v_cndmask_b32 v194, 0, v167, s[78:79]
  v_cvt_pk_bf16_f32 v202, 0, v202
  v_cndmask_b32 v195, 0, v168, s[78:79]
  v_cvt_pk_bf16_f32 v203, 0, v203
  v_pk_mul_f32 v[200:201], v[200:201], v[120:121] op_sel:[0,1]
  v_pk_mul_f32 v[202:203], v[202:203], v[120:121] op_sel:[0,1]
  s_waitcnt vmcnt(14)
  s_cbranch_vccnz L_vw1_26
  s_waitcnt vmcnt(10)
L_vw1_26:
  buffer_load_dwordx4 v[36:39], v93, s[12:15], s61 offen offset:1280 nt
  v_pk_fma_f32 v[204:205], v[64:65], s[92:93], v[120:121] op_sel_hi:[1,1,0] neg_lo:[0,0,1] neg_hi:[0,0,1]
  v_pk_fma_f32 v[206:207], v[66:67], s[92:93], v[120:121] op_sel_hi:[1,1,0] neg_lo:[0,0,1] neg_hi:[0,0,1]
  v_cvt_pk_bf16_f32 v204, 0, v204
  v_cvt_pk_bf16_f32 v205, 0, v205
  v_cvt_pk_bf16_f32 v206, 0, v206
  v_cvt_pk_bf16_f32 v207, 0, v207
  v_pk_mul_f32 v[204:205], v[204:205], v[120:121] op_sel:[0,1]
  v_pk_mul_f32 v[206:207], v[206:207], v[120:121] op_sel:[0,1]
  s_waitcnt vmcnt(14)
  s_cbranch_vccnz L_vw1_27
  s_waitcnt vmcnt(10)
L_vw1_27:
  buffer_load_dwordx4 v[40:43], v93, s[12:15], s61 offen offset:1536 nt
  v_mov_b32_dpp v120, v118 row_newbcast:9 row_mask:0xf bank_mask:0xf
  v_mov_b32_dpp v121, v119 row_newbcast:9 row_mask:0xf bank_mask:0xf
  v_pk_fma_f32 v[112:113], v[68:69], s[92:93], v[120:121] op_sel_hi:[1,1,0] neg_lo:[0,0,1] neg_hi:[0,0,1]
  v_pk_fma_f32 v[114:115], v[70:71], s[92:93], v[120:121] op_sel_hi:[1,1,0] neg_lo:[0,0,1] neg_hi:[0,0,1]
  v_cvt_pk_bf16_f32 v112, 0, v112
  v_cvt_pk_bf16_f32 v113, 0, v113
  v_cvt_pk_bf16_f32 v114, 0, v114
  v_cvt_pk_bf16_f32 v115, 0, v115
  v_pk_mul_f32 v[112:113], v[112:113], v[120:121] op_sel:[0,1]
  v_pk_mul_f32 v[114:115], v[114:115], v[120:121] op_sel:[0,1]
  v_cvt_pk_bf16_f32 v208, v196, v112
  v_cvt_pk_bf16_f32 v212, v197, v113
  v_cvt_pk_bf16_f32 v216, v198, v114
  v_cvt_pk_bf16_f32 v220, v199, v115
  s_waitcnt vmcnt(14)
  s_cbranch_vccnz L_vw1_28
  s_waitcnt vmcnt(10)
L_vw1_28:
  buffer_load_dwordx4 v[44:47], v93, s[12:15], s61 offen offset:1792 nt
  v_pk_fma_f32 v[112:113], v[72:73], s[92:93], v[120:121] op_sel_hi:[1,1,0] neg_lo:[0,0,1] neg_hi:[0,0,1]
  v_pk_fma_f32 v[114:115], v[74:75], s[92:93], v[120:121] op_sel_hi:[1,1,0] neg_lo:[0,0,1] neg_hi:[0,0,1]
  v_cvt_pk_bf16_f32 v112, 0, v112
  v_cvt_pk_bf16_f32 v113, 0, v113
  v_cvt_pk_bf16_f32 v114, 0, v114
  v_cvt_pk_bf16_f32 v115, 0, v115
  v_pk_mul_f32 v[112:113], v[112:113], v[120:121] op_sel:[0,1]
  v_pk_mul_f32 v[114:115], v[114:115], v[120:121] op_sel:[0,1]
  v_cvt_pk_bf16_f32 v224, v200, v112
  v_cvt_pk_bf16_f32 v228, v201, v113
  v_cvt_pk_bf16_f32 v232, v202, v114
  v_cvt_pk_bf16_f32 v236, v203, v115
  s_waitcnt vmcnt(14)
  s_cbranch_vccnz L_vw1_29
  s_waitcnt vmcnt(10)
L_vw1_29:
  buffer_load_dwordx4 v[48:51], v93, s[12:15], s61 offen offset:2048 nt
  v_pk_fma_f32 v[112:113], v[76:77], s[92:93], v[120:121] op_sel_hi:[1,1,0] neg_lo:[0,0,1] neg_hi:[0,0,1]
  v_pk_fma_f32 v[114:115], v[78:79], s[92:93], v[120:121] op_sel_hi:[1,1,0] neg_lo:[0,0,1] neg_hi:[0,0,1]
  v_cvt_pk_bf16_f32 v112, 0, v112
  v_cvt_pk_bf16_f32 v113, 0, v113
  v_cvt_pk_bf16_f32 v114, 0, v114
  v_cvt_pk_bf16_f32 v115, 0, v115
  v_pk_mul_f32 v[112:113], v[112:113], v[120:121] op_sel:[0,1]
  v_pk_mul_f32 v[114:115], v[114:115], v[120:121] op_sel:[0,1]
  v_cvt_pk_bf16_f32 v240, v204, v112
  v_cvt_pk_bf16_f32 v244, v205, v113
  v_cvt_pk_bf16_f32 v248, v206, v114
  v_cvt_pk_bf16_f32 v252, v207, v115
  s_waitcnt vmcnt(14)
  s_cbranch_vccnz L_vw1_30
  s_waitcnt vmcnt(10)
L_vw1_30:
  buffer_load_dwordx4 v[52:55], v93, s[12:15], s61 offen offset:2304 nt
  v_mov_b32_dpp v120, v118 row_newbcast:10 row_mask:0xf bank_mask:0xf
  v_mov_b32_dpp v121, v119 row_newbcast:10 row_mask:0xf bank_mask:0xf
  v_pk_fma_f32 v[196:197], v[80:81], s[92:93], v[120:121] op_sel_hi:[1,1,0] neg_lo:[0,0,1] neg_hi:[0,0,1]
  v_pk_fma_f32 v[198:199], v[82:83], s[92:93], v[120:121] op_sel_hi:[1,1,0] neg_lo:[0,0,1] neg_hi:[0,0,1]
  v_cvt_pk_bf16_f32 v196, 0, v196
  v_cvt_pk_bf16_f32 v197, 0, v197
  v_cvt_pk_bf16_f32 v198, 0, v198
  v_cvt_pk_bf16_f32 v199, 0, v199
  v_pk_mul_f32 v[196:197], v[196:197], v[120:121] op_sel:[0,1]
  v_pk_mul_f32 v[198:199], v[198:199], v[120:121] op_sel:[0,1]
  v_cvt_pk_bf16_f32 v209, v196, 0
  v_cvt_pk_bf16_f32 v213, v197, 0
  v_cvt_pk_bf16_f32 v217, v198, 0
  v_cvt_pk_bf16_f32 v221, v199, 0
  v_mfma_f32_16x16x16_bf16 v[132:135], v[188:189], v[208:209], v[132:135]
  v_mfma_f32_16x16x16_bf16 v[132:135], v[190:191], v[212:213], v[132:135]
  v_mfma_f32_16x16x16_bf16 v[132:135], v[192:193], v[216:217], v[132:135]
  v_mfma_f32_16x16x16_bf16 v[132:135], v[194:195], v[220:221], v[132:135]
  s_waitcnt vmcnt(14)
  s_cbranch_vccnz L_vw1_31
  s_waitcnt vmcnt(10)
L_vw1_31:
  buffer_load_dwordx4 v[56:59], v93, s[12:15], s61 offen offset:2560 nt
  v_pk_fma_f32 v[200:201], v[84:85], s[92:93], v[120:121] op_sel_hi:[1,1,0] neg_lo:[0,0,1] neg_hi:[0,0,1]
  v_pk_fma_f32 v[202:203], v[86:87], s[92:93], v[120:121] op_sel_hi:[1,1,0] neg_lo:[0,0,1] neg_hi:[0,0,1]
  v_cvt_pk_bf16_f32 v200, 0, v200
  v_cvt_pk_bf16_f32 v201, 0, v201
  v_cvt_pk_bf16_f32 v202, 0, v202
  v_cvt_pk_bf16_f32 v203, 0, v203
  v_pk_mul_f32 v[200:201], v[200:201], v[120:121] op_sel:[0,1]
  v_pk_mul_f32 v[202:203], v[202:203], v[120:121] op_sel:[0,1]
  v_cvt_pk_bf16_f32 v225, v200, 0
  v_cvt_pk_bf16_f32 v229, v201, 0
  v_cvt_pk_bf16_f32 v233, v202, 0
  v_cvt_pk_bf16_f32 v237, v203, 0
  v_mfma_f32_16x16x16_bf16 v[136:139], v[188:189], v[224:225], v[136:139]
  v_mfma_f32_16x16x16_bf16 v[136:139], v[190:191], v[228:229], v[136:139]
  v_mfma_f32_16x16x16_bf16 v[136:139], v[192:193], v[232:233], v[136:139]
  v_mfma_f32_16x16x16_bf16 v[136:139], v[194:195], v[236:237], v[136:139]
  s_waitcnt vmcnt(14)
  s_cbranch_vccnz L_vw1_32
  s_waitcnt vmcnt(10)
L_vw1_32:
  buffer_load_dwordx4 v[60:63], v93, s[12:15], s61 offen offset:2816 nt
  v_pk_fma_f32 v[204:205], v[88:89], s[92:93], v[120:121] op_sel_hi:[1,1,0] neg_lo:[0,0,1] neg_hi:[0,0,1]
  v_pk_fma_f32 v[206:207], v[90:91], s[92:93], v[120:121] op_sel_hi:[1,1,0] neg_lo:[0,0,1] neg_hi:[0,0,1]
  v_cvt_pk_bf16_f32 v204, 0, v204
  v_cvt_pk_bf16_f32 v205, 0, v205
  v_cvt_pk_bf16_f32 v206, 0, v206
  v_cvt_pk_bf16_f32 v207, 0, v207
  v_pk_mul_f32 v[204:205], v[204:205], v[120:121] op_sel:[0,1]
  v_pk_mul_f32 v[206:207], v[206:207], v[120:121] op_sel:[0,1]
  v_cvt_pk_bf16_f32 v241, v204, 0
  v_cvt_pk_bf16_f32 v245, v205, 0
  v_cvt_pk_bf16_f32 v249, v206, 0
  v_cvt_pk_bf16_f32 v253, v207, 0
  v_mfma_f32_16x16x16_bf16 v[140:143], v[188:189], v[240:241], v[140:143]
  v_mfma_f32_16x16x16_bf16 v[140:143], v[190:191], v[244:245], v[140:143]
  v_mfma_f32_16x16x16_bf16 v[140:143], v[192:193], v[248:249], v[140:143]
  v_mfma_f32_16x16x16_bf16 v[140:143], v[194:195], v[252:253], v[140:143]
  s_mov_b32 s60, s61
  s_cmp_ge_u32 s64, 96
  s_cbranch_scc1 L_v_done
  s_cmp_eq_u32 s89, s88
  s_cbranch_scc1 L_v0
  s_mov_b32 s88, s89
  v_mov_b32 v149, v147
  s_nop 1
  v_permlane32_swap_b32 v147, v149
  v_add_f32 v147, v147, v149
  v_mov_b32 v149, v147
  s_nop 1
  v_permlane16_swap_b32 v147, v149
  v_add_f32 v147, v147, v149
  ds_write_b64 v106, v[146:147]
  ds_write_b128 v105, v[132:135] offset:0
  ds_write_b128 v105, v[136:139] offset:1024
  ds_write_b128 v105, v[140:143] offset:2048
  s_and_b32 s70, s86, 15
  s_cmp_ge_u32 s70, 12
  s_cselect_b32 s70, 2, 0
  s_and_b32 s71, s87, 1
  s_bitcmp1_b32 s96, 6
  s_cselect_b32 s71, s4, s71
  s_add_u32 s70, s70, s71
  s_lshr_b32 s71, s86, 4
  s_lshl2_add_u32 s70, s71, s70
  s_add_u32 s71, s3, 0
  s_cmp_eq_u32 s100, s71
  s_cselect_b32 s44, s70, s44
  s_add_u32 s71, s3, 2
  s_cmp_eq_u32 s100, s71
  s_cselect_b32 s45, s70, s45
  s_add_u32 s100, s100, 1
  s_waitcnt lgkmcnt(0)
  v_add_u32 v105, 6208, v105
  v_add_u32 v106, 6208, v106
  v_mov_b32 v132, 0
  v_mov_b32 v133, 0
  v_mov_b32 v134, 0
  v_mov_b32 v135, 0
  v_mov_b32 v136, 0
  v_mov_b32 v137, 0
  v_mov_b32 v138, 0
  v_mov_b32 v139, 0
  v_mov_b32 v140, 0
  v_mov_b32 v141, 0
  v_mov_b32 v142, 0
  v_mov_b32 v143, 0
  v_mov_b32 v144, 0xff800000
  v_mov_b32 v146, 0x7f800000
  v_mov_b32 v147, 0
  s_branch L_v0
L_v_done:
  v_mov_b32 v149, v147
  s_nop 1
  v_permlane32_swap_b32 v147, v149
  v_add_f32 v147, v147, v149
  v_mov_b32 v149, v147
  s_nop 1
  v_permlane16_swap_b32 v147, v149
  v_add_f32 v147, v147, v149
  ds_write_b64 v106, v[146:147]
  ds_write_b128 v105, v[132:135] offset:0
  ds_write_b128 v105, v[136:139] offset:1024
  ds_write_b128 v105, v[140:143] offset:2048
  s_and_b32 s70, s86, 15
  s_cmp_ge_u32 s70, 12
  s_cselect_b32 s70, 2, 0
  s_and_b32 s71, s87, 1
  s_bitcmp1_b32 s96, 6
  s_cselect_b32 s71, s4, s71
  s_add_u32 s70, s70, s71
  s_lshr_b32 s71, s86, 4
  s_lshl2_add_u32 s70, s71, s70
  s_add_u32 s71, s3, 0
  s_cmp_eq_u32 s100, s71
  s_cselect_b32 s44, s70, s44
  s_add_u32 s71, s3, 2
  s_cmp_eq_u32 s100, s71
  s_cselect_b32 s45, s70, s45
  s_add_u32 s100, s100, 1
  s_waitcnt lgkmcnt(0)
  s_waitcnt vmcnt(0)
  s_barrier
  v_lshrrev_b32 v150, 1, v104
  v_lshlrev_b32 v151, 4, v0
  s_mul_i32 s70, s3, 6208
  s_add_u32 s70, s70, 36864
  v_add_u32 v148, s70, v150
  ds_read_b64 v[4:5], v148 offset:6144
  ds_read_b64 v[6:7], v148 offset:6176
  v_add_u32 v148, s70, v151
  ds_read_b128 v[172:175], v148 offset:0
  ds_read_b128 v[176:179], v148 offset:1024
  ds_read_b128 v[180:183], v148 offset:2048
  ds_read_b128 v[184:187], v148 offset:3072
  ds_read_b128 v[188:191], v148 offset:4096
  ds_read_b128 v[192:195], v148 offset:5120
  s_mul_i32 s70, s3, 6208
  s_add_u32 s70, s70, 49280
  v_add_u32 v148, s70, v150
  ds_read_b64 v[8:9], v148 offset:6144
  ds_read_b64 v[10:11], v148 offset:6176
  v_add_u32 v148, s70, v151
  ds_read_b128 v[196:199], v148 offset:0
  ds_read_b128 v[200:203], v148 offset:1024
  ds_read_b128 v[204:207], v148 offset:2048
  ds_read_b128 v[208:211], v148 offset:3072
  ds_read_b128 v[212:215], v148 offset:4096
  ds_read_b128 v[216:219], v148 offset:5120
  v_mov_b32 v148, 61708
  ds_read_b32 v144, v148
  s_mov_b32 s100, -1
  s_add_u32 s97, s4, 1
  s_waitcnt lgkmcnt(0)
  v_min_f32 v28, v4, v6
  v_sub_f32 v4, v28, v4
  v_sub_f32 v6, v28, v6
  v_exp_f32 v4, v4
  v_exp_f32 v6, v6
  v_mul_f32 v29, v4, v5
  v_fma_f32 v29, v6, v7, v29
  v_mul_f32 v12, v4, v172
  v_fma_f32 v12, v6, v184, v12
  v_mul_f32 v13, v4, v173
  v_fma_f32 v13, v6, v185, v13
  v_mul_f32 v14, v4, v174
  v_fma_f32 v14, v6, v186, v14
  v_mul_f32 v16, v4, v175
  v_fma_f32 v16, v6, v187, v16
  v_mul_f32 v17, v4, v176
  v_fma_f32 v17, v6, v188, v17
  v_mul_f32 v18, v4, v177
  v_fma_f32 v18, v6, v189, v18
  v_mul_f32 v20, v4, v178
  v_fma_f32 v20, v6, v190, v20
  v_mul_f32 v21, v4, v179
  v_fma_f32 v21, v6, v191, v21
  v_mul_f32 v22, v4, v180
  v_fma_f32 v22, v6, v192, v22
  v_mul_f32 v24, v4, v181
  v_fma_f32 v24, v6, v193, v24
  v_mul_f32 v25, v4, v182
  v_fma_f32 v25, v6, v194, v25
  v_mul_f32 v26, v4, v183
  v_fma_f32 v26, v6, v195, v26
  s_bfe_u32 s70, s44, 0x20001
  s_cmp_eq_u32 s70, s97
  s_cbranch_scc1 L_own0
  v_mov_b32 v15, v144
  v_mov_b32 v19, v144
  v_mov_b32 v23, v144
  v_mov_b32 v27, v144
  v_mov_b32 v31, v144
  s_mul_i32 s70, s44, 5120
  s_add_u32 s70, s70, 1048576
  s_add_u32 s71, s70, 4096
  buffer_store_dwordx4 v[12:15], v151, s[40:43], s70 offen offset:0 sc1
  buffer_store_dwordx4 v[16:19], v151, s[40:43], s70 offen offset:1024 sc1
  buffer_store_dwordx4 v[20:23], v151, s[40:43], s70 offen offset:2048 sc1
  buffer_store_dwordx4 v[24:27], v151, s[40:43], s70 offen offset:3072 sc1
  buffer_store_dwordx4 v[28:31], v151, s[40:43], s71 offen offset:0 sc1
  s_branch L_pub0
L_own0:
  v_mov_b32 v52, v12
  v_mov_b32 v53, v13
  v_mov_b32 v54, v14
  v_mov_b32 v56, v16
  v_mov_b32 v57, v17
  v_mov_b32 v58, v18
  v_mov_b32 v60, v20
  v_mov_b32 v61, v21
  v_mov_b32 v62, v22
  v_mov_b32 v64, v24
  v_mov_b32 v65, v25
  v_mov_b32 v66, v26
  v_mov_b32 v68, v28
  v_mov_b32 v69, v29
  s_mov_b32 s100, s44
L_pub0:
  v_min_f32 v48, v8, v10
  v_sub_f32 v8, v48, v8
  v_sub_f32 v10, v48, v10
  v_exp_f32 v8, v8
  v_exp_f32 v10, v10
  v_mul_f32 v49, v8, v9
  v_fma_f32 v49, v10, v11, v49
  v_mul_f32 v32, v8, v196
  v_fma_f32 v32, v10, v208, v32
  v_mul_f32 v33, v8, v197
  v_fma_f32 v33, v10, v209, v33
  v_mul_f32 v34, v8, v198
  v_fma_f32 v34, v10, v210, v34
  v_mul_f32 v36, v8, v199
  v_fma_f32 v36, v10, v211, v36
  v_mul_f32 v37, v8, v200
  v_fma_f32 v37, v10, v212, v37
  v_mul_f32 v38, v8, v201
  v_fma_f32 v38, v10, v213, v38
  v_mul_f32 v40, v8, v202
  v_fma_f32 v40, v10, v214, v40
  v_mul_f32 v41, v8, v203
  v_fma_f32 v41, v10, v215, v41
  v_mul_f32 v42, v8, v204
  v_fma_f32 v42, v10, v216, v42
  v_mul_f32 v44, v8, v205
  v_fma_f32 v44, v10, v217, v44
  v_mul_f32 v45, v8, v206
  v_fma_f32 v45, v10, v218, v45
  v_mul_f32 v46, v8, v207
  v_fma_f32 v46, v10, v219, v46
  s_bfe_u32 s70, s45, 0x20001
  s_cmp_eq_u32 s70, s97
  s_cbranch_scc1 L_own1
  v_mov_b32 v35, v144
  v_mov_b32 v39, v144
  v_mov_b32 v43, v144
  v_mov_b32 v47, v144
  v_mov_b32 v51, v144
  s_mul_i32 s70, s45, 5120
  s_add_u32 s70, s70, 1048576
  s_add_u32 s71, s70, 4096
  buffer_store_dwordx4 v[32:35], v151, s[40:43], s70 offen offset:0 sc1
  buffer_store_dwordx4 v[36:39], v151, s[40:43], s70 offen offset:1024 sc1
  buffer_store_dwordx4 v[40:43], v151, s[40:43], s70 offen offset:2048 sc1
  buffer_store_dwordx4 v[44:47], v151, s[40:43], s70 offen offset:3072 sc1
  buffer_store_dwordx4 v[48:51], v151, s[40:43], s71 offen offset:0 sc1
  s_branch L_pub1
L_own1:
  v_mov_b32 v52, v32
  v_mov_b32 v53, v33
  v_mov_b32 v54, v34
  v_mov_b32 v56, v36
  v_mov_b32 v57, v37
  v_mov_b32 v58, v38
  v_mov_b32 v60, v40
  v_mov_b32 v61, v41
  v_mov_b32 v62, v42
  v_mov_b32 v64, v44
  v_mov_b32 v65, v45
  v_mov_b32 v66, v46
  v_mov_b32 v68, v48
  v_mov_b32 v69, v49
  s_mov_b32 s100, s45
L_pub1:
  s_cmp_eq_u32 s100, -1
  s_cbranch_scc1 L_fin
  s_xor_b32 s84, s100, 1
  s_andn2_b32 s86, s100, 1
  s_xor_b32 s86, s86, 2
  s_add_u32 s88, s86, 1
  s_mul_i32 s84, s84, 5120
  s_add_u32 s84, s84, 1048576
  s_add_u32 s85, s84, 4096
  s_mul_i32 s86, s86, 5120
  s_add_u32 s86, s86, 1048576
  s_add_u32 s87, s86, 4096
  s_mul_i32 s88, s88, 5120
  s_add_u32 s88, s88, 1048576
  s_add_u32 s89, s88, 4096
  v_mov_b32 v149, s85
  v_writelane_b32 v149, s87, 1
  v_writelane_b32 v149, s89, 2
  s_mov_b32 s64, 0
L_gather:
  buffer_load_dwordx4 v[172:175], v151, s[40:43], s84 offen offset:0 sc1
  buffer_load_dwordx4 v[176:179], v151, s[40:43], s84 offen offset:1024 sc1
  buffer_load_dwordx4 v[180:183], v151, s[40:43], s84 offen offset:2048 sc1
  buffer_load_dwordx4 v[184:187], v151, s[40:43], s84 offen offset:3072 sc1
  buffer_load_dwordx4 v[188:191], v151, s[40:43], s85 offen offset:0 sc1
  buffer_load_dwordx4 v[192:195], v151, s[40:43], s86 offen offset:0 sc1
  buffer_load_dwordx4 v[196:199], v151, s[40:43], s86 offen offset:1024 sc1
  buffer_load_dwordx4 v[200:203], v151, s[40:43], s86 offen offset:2048 sc1
  buffer_load_dwordx4 v[204:207], v151, s[40:43], s86 offen offset:3072 sc1
  buffer_load_dwordx4 v[208:211], v151, s[40:43], s87 offen offset:0 sc1
  buffer_load_dwordx4 v[212:215], v151, s[40:43], s88 offen offset:0 sc1
  buffer_load_dwordx4 v[216:219], v151, s[40:43], s88 offen offset:1024 sc1
  buffer_load_dwordx4 v[220:223], v151, s[40:43], s88 offen offset:2048 sc1
  buffer_load_dwordx4 v[224:227], v151, s[40:43], s88 offen offset:3072 sc1
  buffer_load_dwordx4 v[228:231], v151, s[40:43], s89 offen offset:0 sc1
  s_waitcnt vmcnt(0)
  v_xor_b32 v148, v144, v175
  v_xor_b32 v179, v144, v179
  v_xor_b32 v183, v144, v183
  v_xor_b32 v187, v144, v187
  v_xor_b32 v191, v144, v191
  v_xor_b32 v195, v144, v195
  v_xor_b32 v199, v144, v199
  v_xor_b32 v203, v144, v203
  v_xor_b32 v207, v144, v207
  v_xor_b32 v211, v144, v211
  v_xor_b32 v215, v144, v215
  v_xor_b32 v219, v144, v219
  v_xor_b32 v223, v144, v223
  v_xor_b32 v227, v144, v227
  v_xor_b32 v231, v144, v231
  v_or3_b32 v148, v148, v179, v183
  v_or3_b32 v148, v148, v187, v191
  v_or3_b32 v148, v148, v195, v199
  v_or3_b32 v148, v148, v203, v207
  v_or3_b32 v148, v148, v211, v215
  v_or3_b32 v148, v148, v219, v223
  v_or3_b32 v148, v148, v227, v231
  v_cmp_ne_u32 s[70:71], 0, v148
  s_nop 1
  s_cmp_eq_u64 s[70:71], 0
  s_cbranch_scc1 L_gathered
  s_mov_b64 exec, 7
L_poll:
  s_add_u32 s64, s64, 1
  s_cmp_gt_u32 s64, 20000
  s_cbranch_scc1 L_end
  buffer_load_dword v148, v149, s[40:43], 0 offen offset:1020 sc1
  s_waitcnt vmcnt(0)
  v_cmp_ne_u32 s[70:71], v144, v148
  s_nop 1
  s_cmp_lg_u64 s[70:71], 0
  s_cbranch_scc1 L_poll
  s_mov_b64 exec, -1
  s_branch L_gather
L_gathered:
  v_min_f32 v148, v68, v188
  v_min3_f32 v148, v148, v208, v228
  v_sub_f32 v68, v148, v68
  v_sub_f32 v188, v148, v188
  v_sub_f32 v208, v148, v208
  v_sub_f32 v228, v148, v228
  v_exp_f32 v68, v68
  v_exp_f32 v188, v188
  v_exp_f32 v208, v208
  v_exp_f32 v228, v228
  v_mul_f32 v69, v68, v69
  v_mul_f32 v189, v188, v189
  v_mul_f32 v209, v208, v209
  v_mul_f32 v229, v228, v229
  v_add_f32 v69, v69, v189
  v_add_f32 v209, v209, v229
  v_add_f32 v69, v69, v209
  v_rcp_f32 v149, v69
  v_mul_f32 v52, v68, v52
  v_mul_f32 v172, v188, v172
  v_mul_f32 v192, v208, v192
  v_mul_f32 v212, v228, v212
  v_add_f32 v52, v52, v172
  v_add_f32 v192, v192, v212
  v_add_f32 v52, v52, v192
  v_mul_f32 v53, v68, v53
  v_mul_f32 v173, v188, v173
  v_mul_f32 v193, v208, v193
  v_mul_f32 v213, v228, v213
  v_add_f32 v53, v53, v173
  v_add_f32 v193, v193, v213
  v_add_f32 v53, v53, v193
  v_mul_f32 v54, v68, v54
  v_mul_f32 v174, v188, v174
  v_mul_f32 v194, v208, v194
  v_mul_f32 v214, v228, v214
  v_add_f32 v54, v54, v174
  v_add_f32 v194, v194, v214
  v_add_f32 v54, v54, v194
  v_mul_f32 v56, v68, v56
  v_mul_f32 v176, v188, v176
  v_mul_f32 v196, v208, v196
  v_mul_f32 v216, v228, v216
  v_add_f32 v56, v56, v176
  v_add_f32 v196, v196, v216
  v_add_f32 v56, v56, v196
  v_mul_f32 v57, v68, v57
  v_mul_f32 v177, v188, v177
  v_mul_f32 v197, v208, v197
  v_mul_f32 v217, v228, v217
  v_add_f32 v57, v57, v177
  v_add_f32 v197, v197, v217
  v_add_f32 v57, v57, v197
  v_mul_f32 v58, v68, v58
  v_mul_f32 v178, v188, v178
  v_mul_f32 v198, v208, v198
  v_mul_f32 v218, v228, v218
  v_add_f32 v58, v58, v178
  v_add_f32 v198, v198, v218
  v_add_f32 v58, v58, v198
  v_mul_f32 v60, v68, v60
  v_mul_f32 v180, v188, v180
  v_mul_f32 v200, v208, v200
  v_mul_f32 v220, v228, v220
  v_add_f32 v60, v60, v180
  v_add_f32 v200, v200, v220
  v_add_f32 v60, v60, v200
  v_mul_f32 v61, v68, v61
  v_mul_f32 v181, v188, v181
  v_mul_f32 v201, v208, v201
  v_mul_f32 v221, v228, v221
  v_add_f32 v61, v61, v181
  v_add_f32 v201, v201, v221
  v_add_f32 v61, v61, v201
  v_mul_f32 v62, v68, v62
  v_mul_f32 v182, v188, v182
  v_mul_f32 v202, v208, v202
  v_mul_f32 v222, v228, v222
  v_add_f32 v62, v62, v182
  v_add_f32 v202, v202, v222
  v_add_f32 v62, v62, v202
  v_mul_f32 v64, v68, v64
  v_mul_f32 v184, v188, v184
  v_mul_f32 v204, v208, v204
  v_mul_f32 v224, v228, v224
  v_add_f32 v64, v64, v184
  v_add_f32 v204, v204, v224
  v_add_f32 v64, v64, v204
  v_mul_f32 v65, v68, v65
  v_mul_f32 v185, v188, v185
  v_mul_f32 v205, v208, v205
  v_mul_f32 v225, v228, v225
  v_add_f32 v65, v65, v185
  v_add_f32 v205, v205, v225
  v_add_f32 v65, v65, v205
  v_mul_f32 v66, v68, v66
  v_mul_f32 v186, v188, v186
  v_mul_f32 v206, v208, v206
  v_mul_f32 v226, v228, v226
  v_add_f32 v66, v66, v186
  v_add_f32 v206, v206, v226
  v_add_f32 v66, v66, v206
  v_mul_f32 v52, v149, v52
  v_mul_f32 v53, v149, v53
  v_mul_f32 v54, v149, v54
  v_mul_f32 v56, v149, v56
  v_mul_f32 v57, v149, v57
  v_mul_f32 v58, v149, v58
  v_mul_f32 v60, v149, v60
  v_mul_f32 v61, v149, v61
  v_mul_f32 v62, v149, v62
  v_mul_f32 v64, v149, v64
  v_mul_f32 v65, v149, v65
  v_mul_f32 v66, v149, v66
  v_mul_u32_u24 v148, 24, v104
  v_and_b32 v149, 15, v0
  v_lshl_add_u32 v148, v149, 3, v148
  s_lshr_b32 s70, s100, 2
  s_mul_i32 s70, s70, 1536
  v_cvt_pk_bf16_f32 v132, v52, v53
  v_cvt_pk_bf16_f32 v133, v54, v56
  buffer_store_dwordx2 v[132:133], v148, s[36:39], s70 offen offset:0
  v_cvt_pk_bf16_f32 v134, v57, v58
  v_cvt_pk_bf16_f32 v135, v60, v61
  buffer_store_dwordx2 v[134:135], v148, s[36:39], s70 offen offset:128
  v_cvt_pk_bf16_f32 v136, v62, v64
  v_cvt_pk_bf16_f32 v137, v65, v66
  buffer_store_dwordx2 v[136:137], v148, s[36:39], s70 offen offset:256
L_fin:
L_end:
  s_endpgm
L_helper:
  v_lshlrev_b32 v1, 2, v0
  v_add_u32 v1, 61696, v1
  v_mov_b32 v2, 0
  s_mov_b64 exec, 0xff
  ds_write_b32 v1, v2
  s_mov_b64 exec, -1
  s_waitcnt lgkmcnt(0)
  s_mov_b32 s8, s46
  s_and_b32 s9, s47, 0xffff
  s_mov_b32 s10, 805306368
  s_mov_b32 s11, 0x20000
  s_mov_b32 s20, s50
  s_and_b32 s21, s51, 0xffff
  s_mov_b32 s22, 6291456
  s_mov_b32 s23, 0x20000
  s_mov_b32 s24, s52
  s_and_b32 s25, s53, 0xffff
  s_mov_b32 s26, 6291456
  s_mov_b32 s27, 0x20000
  s_mov_b32 s36, s44
  s_and_b32 s37, s45, 0xffff
  s_mov_b32 s38, 393216
  s_mov_b32 s39, 0x20000
  s_mov_b32 s16, s46
  s_and_b32 s17, s47, 0xffff
  s_mov_b32 s18, 805306368
  s_mov_b32 s19, 0x20000
  s_mov_b32 s12, s48
  s_and_b32 s13, s49, 0xffff
  s_mov_b32 s14, 805306368
  s_mov_b32 s15, 0x20000
  s_mov_b32 s28, s54
  s_and_b32 s29, s55, 0xffff
  s_mov_b32 s30, 2097152
  s_mov_b32 s31, 0x20000
  s_mov_b32 s32, s56
  s_and_b32 s33, s57, 0xffff
  s_mov_b32 s34, 2097152
  s_mov_b32 s35, 0x20000
  s_mov_b32 s40, s82
  s_and_b32 s41, s83, 0xffff
  s_mov_b32 s42, 25165824
  s_mov_b32 s43, 0x20000
  s_barrier
  s_memrealtime s[72:73]
  s_mov_b32 s66, 0
  s_lshr_b32 s70, s2, 4
  s_and_b32 s70, s70, 8
  s_and_b32 s71, s2, 7
  s_add_u32 s70, s70, s71
  s_lshl_b32 s70, s70, 3
  v_mov_b32 v104, s70
  v_and_b32 v105, 15, v0
  v_lshlrev_b32 v105, 3, v105
  s_bitcmp1_b32 s2, 3
  s_cselect_b32 s16, s12, s8
  s_cselect_b32 s17, s13, s9
  s_cselect_b32 s52, 24, 0
  s_lshl_b32 s44, s5, 16
  s_lshl_b32 s70, s4, 16
  s_add_u32 s44, s44, s70
  s_add_u32 s44, s44, 0x1c0000
  s_bfe_u32 s70, s2, 0x40004
  s_mul_i32 s70, s70, 0x4a80
  s_and_b32 s70, s70, 0x5f80
  s_add_u32 s44, s44, s70
  s_mov_b32 s48, 0
  s_mov_b32 s49, 0x1000000
  s_mov_b32 s50, 0
L_h_page:
  s_add_u32 s70, s44, 0x8000
  s_buffer_load_dword s58, s[16:19], s70
  s_mov_b32 s45, -1
  s_mov_b32 s46, -1
  s_waitcnt lgkmcnt(0)
  s_xor_b32 s70, s44, 0
  s_memtime s[54:55]
  s_waitcnt lgkmcnt(0)
  s_buffer_load_dword s58, s[16:19], s70
  s_waitcnt lgkmcnt(0)
  s_memtime s[56:57]
  s_waitcnt lgkmcnt(0)
  s_sub_u32 s56, s56, s54
  s_min_u32 s45, s45, s56
  s_xor_b32 s70, s44, 8192
  s_memtime s[54:55]
  s_waitcnt lgkmcnt(0)
  s_buffer_load_dword s58, s[16:19], s70
  s_waitcnt lgkmcnt(0)
  s_memtime s[56:57]
  s_waitcnt lgkmcnt(0)
  s_sub_u32 s56, s56, s54
  s_min_u32 s46, s46, s56
  s_xor_b32 s70, s44, 17280
  s_memtime s[54:55]
  s_waitcnt lgkmcnt(0)
  s_buffer_load_dword s58, s[16:19], s70
  s_waitcnt lgkmcnt(0)
  s_memtime s[56:57]
  s_waitcnt lgkmcnt(0)
  s_sub_u32 s56, s56, s54
  s_min_u32 s45, s45, s56
  s_xor_b32 s70, s44, 25472
  s_memtime s[54:55]
  s_waitcnt lgkmcnt(0)
  s_buffer_load_dword s58, s[16:19], s70
  s_waitcnt lgkmcnt(0)
  s_memtime s[56:57]
  s_waitcnt lgkmcnt(0)
  s_sub_u32 s56, s56, s54
  s_min_u32 s46, s46, s56
  s_cmp_lt_u32 s46, s45
  s_cselect_b32 s54, 1, 0
  s_xor_b32 s54, s54, s4
  s_mov_b32 s55, 0
  s_lshl_b64 s[54:55], s[54:55], s52
  s_or_b64 s[48:49], s[48:49], s[54:55]
  s_add_u32 s52, s52, 8
  s_add_u32 s44, s44, 0x10000000
  s_add_u32 s50, s50, 1
  s_cmp_lt_u32 s50, 3
  s_cbranch_scc1 L_h_page
  s_and_b32 s70, s2, 3
  s_lshl_b32 s62, s70, 6
  s_cmp_lg_u32 s2, 0
  s_cbranch_scc1 L_h_nonce
  s_lshl_b64 s[54:55], s[72:73], 2
  s_atomic_add_x2 s[54:55], s[80:81], 8 glc
  s_waitcnt lgkmcnt(0)
L_h_nonce:
  s_atomic_add_x2 s[48:49], s[80:81], s62
  s_waitcnt lgkmcnt(0)
  v_mov_b32 v1, 61712
L_h_progv:
  s_sleep 8
  ds_read_b128 v[8:11], v1
  s_waitcnt lgkmcnt(0)
  v_min_u32 v8, v8, v9
  s_nop 0
  v_readfirstlane_b32 s54, v8
  s_nop 1
  s_cmp_lt_u32 s54, 12
  s_cbranch_scc1 L_h_progv
  s_load_dwordx2 s[48:49], s[80:81], s62
  s_mov_b32 s59, 0
L_h_votes:
  s_waitcnt lgkmcnt(0)
  s_lshr_b32 s70, s49, 24
  s_cmp_eq_u32 s70, 64
  s_cbranch_scc1 L_h_votes_done
  s_add_u32 s59, s59, 1
  s_cmp_gt_u32 s59, 2000
  s_cbranch_scc1 L_h_votes_done
  s_sleep 64
  s_mov_b64 s[48:49], 0
  s_atomic_or_x2 s[48:49], s[80:81], s62 glc
  s_branch L_h_votes
L_h_votes_done:
  s_mov_b32 s96, 0x80
  s_bfe_u32 s54, s48, 0x80000
  s_cmp_gt_u32 s54, 16
  s_cselect_b32 s56, 1, 0
  s_or_b32 s96, s96, s56
  s_sub_u32 s54, s54, 13
  s_cmp_lt_u32 s54, 7
  s_cselect_b32 s56, 64, 0
  s_or_b32 s96, s96, s56
  s_bfe_u32 s54, s48, 0x80008
  s_cmp_gt_u32 s54, 16
  s_cselect_b32 s56, 2, 0
  s_or_b32 s96, s96, s56
  s_sub_u32 s54, s54, 13
  s_cmp_lt_u32 s54, 7
  s_cselect_b32 s56, 64, 0
  s_or_b32 s96, s96, s56
  s_bfe_u32 s54, s48, 0x80010
  s_cmp_gt_u32 s54, 16
  s_cselect_b32 s56, 4, 0
  s_or_b32 s96, s96, s56
  s_sub_u32 s54, s54, 13
  s_cmp_lt_u32 s54, 7
  s_cselect_b32 s56, 64, 0
  s_or_b32 s96, s96, s56
  s_bfe_u32 s54, s48, 0x80018
  s_cmp_gt_u32 s54, 16
  s_cselect_b32 s56, 8, 0
  s_or_b32 s96, s96, s56
  s_sub_u32 s54, s54, 13
  s_cmp_lt_u32 s54, 7
  s_cselect_b32 s56, 64, 0
  s_or_b32 s96, s96, s56
  s_bfe_u32 s54, s49, 0x80000
  s_cmp_gt_u32 s54, 16
  s_cselect_b32 s56, 16, 0
  s_or_b32 s96, s96, s56
  s_sub_u32 s54, s54, 13
  s_cmp_lt_u32 s54, 7
  s_cselect_b32 s56, 64, 0
  s_or_b32 s96, s96, s56
  s_bfe_u32 s54, s49, 0x80008
  s_cmp_gt_u32 s54, 16
  s_cselect_b32 s56, 32, 0
  s_or_b32 s96, s96, s56
  s_sub_u32 s54, s54, 13
  s_cmp_lt_u32 s54, 7
  s_cselect_b32 s56, 64, 0
  s_or_b32 s96, s96, s56
  s_mul_i32 s54, s4, 63
  s_xor_b32 s96, s96, s54
  v_mov_b32 v1, 61696
  v_mov_b32 v8, s96
  ds_write_b32 v1, v8
  v_lshlrev_b32 v3, 4, v0
  s_mul_i32 s54, s2, 24576
  s_waitcnt vmcnt(7)
  buffer_load_dwordx4 v[8:11], v3, s[20:23], s54 offen offset:0
  s_waitcnt vmcnt(7)
  buffer_load_dwordx4 v[8:11], v3, s[20:23], s54 offen offset:1024
  s_waitcnt vmcnt(7)
  buffer_load_dwordx4 v[8:11], v3, s[20:23], s54 offen offset:2048
  s_waitcnt vmcnt(7)
  buffer_load_dwordx4 v[8:11], v3, s[20:23], s54 offen offset:3072
  s_add_u32 s54, s54, 4096
  s_waitcnt vmcnt(7)
  buffer_load_dwordx4 v[8:11], v3, s[20:23], s54 offen offset:0
  s_waitcnt vmcnt(7)
  buffer_load_dwordx4 v[8:11], v3, s[20:23], s54 offen offset:1024
  s_waitcnt vmcnt(7)
  buffer_load_dwordx4 v[8:11], v3, s[20:23], s54 offen offset:2048
  s_waitcnt vmcnt(7)
  buffer_load_dwordx4 v[8:11], v3, s[20:23], s54 offen offset:3072
  s_add_u32 s54, s54, 4096
  s_waitcnt vmcnt(7)
  buffer_load_dwordx4 v[8:11], v3, s[20:23], s54 offen offset:0
  s_waitcnt vmcnt(7)
  buffer_load_dwordx4 v[8:11], v3, s[20:23], s54 offen offset:1024
  s_waitcnt vmcnt(7)
  buffer_load_dwordx4 v[8:11], v3, s[20:23], s54 offen offset:2048
  s_waitcnt vmcnt(7)
  buffer_load_dwordx4 v[8:11], v3, s[20:23], s54 offen offset:3072
  s_add_u32 s54, s54, 4096
  s_waitcnt vmcnt(7)
  buffer_load_dwordx4 v[8:11], v3, s[20:23], s54 offen offset:0
  s_waitcnt vmcnt(7)
  buffer_load_dwordx4 v[8:11], v3, s[20:23], s54 offen offset:1024
  s_waitcnt vmcnt(7)
  buffer_load_dwordx4 v[8:11], v3, s[20:23], s54 offen offset:2048
  s_waitcnt vmcnt(7)
  buffer_load_dwordx4 v[8:11], v3, s[20:23], s54 offen offset:3072
  s_add_u32 s54, s54, 4096
  s_waitcnt vmcnt(7)
  buffer_load_dwordx4 v[8:11], v3, s[20:23], s54 offen offset:0
  s_waitcnt vmcnt(7)
  buffer_load_dwordx4 v[8:11], v3, s[20:23], s54 offen offset:1024
  s_waitcnt vmcnt(7)
  buffer_load_dwordx4 v[8:11], v3, s[20:23], s54 offen offset:2048
  s_waitcnt vmcnt(7)
  buffer_load_dwordx4 v[8:11], v3, s[20:23], s54 offen offset:3072
  s_add_u32 s54, s54, 4096
  s_waitcnt vmcnt(7)
  buffer_load_dwordx4 v[8:11], v3, s[20:23], s54 offen offset:0
  s_waitcnt vmcnt(7)
  buffer_load_dwordx4 v[8:11], v3, s[20:23], s54 offen offset:1024
  s_waitcnt vmcnt(7)
  buffer_load_dwordx4 v[8:11], v3, s[20:23], s54 offen offset:2048
  s_waitcnt vmcnt(7)
  buffer_load_dwordx4 v[8:11], v3, s[20:23], s54 offen offset:3072
  s_mul_i32 s54, s2, 24576
  s_waitcnt vmcnt(7)
  buffer_load_dwordx4 v[8:11], v3, s[24:27], s54 offen offset:0
  s_waitcnt vmcnt(7)
  buffer_load_dwordx4 v[8:11], v3, s[24:27], s54 offen offset:1024
  s_waitcnt vmcnt(7)
  buffer_load_dwordx4 v[8:11], v3, s[24:27], s54 offen offset:2048
  s_waitcnt vmcnt(7)
  buffer_load_dwordx4 v[8:11], v3, s[24:27], s54 offen offset:3072
  s_add_u32 s54, s54, 4096
  s_waitcnt vmcnt(7)
  buffer_load_dwordx4 v[8:11], v3, s[24:27], s54 offen offset:0
  s_waitcnt vmcnt(7)
  buffer_load_dwordx4 v[8:11], v3, s[24:27], s54 offen offset:1024
  s_waitcnt vmcnt(7)
  buffer_load_dwordx4 v[8:11], v3, s[24:27], s54 offen offset:2048
  s_waitcnt vmcnt(7)
  buffer_load_dwordx4 v[8:11], v3, s[24:27], s54 offen offset:3072
  s_add_u32 s54, s54, 4096
  s_waitcnt vmcnt(7)
  buffer_load_dwordx4 v[8:11], v3, s[24:27], s54 offen offset:0
  s_waitcnt vmcnt(7)
  buffer_load_dwordx4 v[8:11], v3, s[24:27], s54 offen offset:1024
  s_waitcnt vmcnt(7)
  buffer_load_dwordx4 v[8:11], v3, s[24:27], s54 offen offset:2048
  s_waitcnt vmcnt(7)
  buffer_load_dwordx4 v[8:11], v3, s[24:27], s54 offen offset:3072
  s_add_u32 s54, s54, 4096
  s_waitcnt vmcnt(7)
  buffer_load_dwordx4 v[8:11], v3, s[24:27], s54 offen offset:0
  s_waitcnt vmcnt(7)
  buffer_load_dwordx4 v[8:11], v3, s[24:27], s54 offen offset:1024
  s_waitcnt vmcnt(7)
  buffer_load_dwordx4 v[8:11], v3, s[24:27], s54 offen offset:2048
  s_waitcnt vmcnt(7)
  buffer_load_dwordx4 v[8:11], v3, s[24:27], s54 offen offset:3072
  s_add_u32 s54, s54, 4096
  s_waitcnt vmcnt(7)
  buffer_load_dwordx4 v[8:11], v3, s[24:27], s54 offen offset:0
  s_waitcnt vmcnt(7)
  buffer_load_dwordx4 v[8:11], v3, s[24:27], s54 offen offset:1024
  s_waitcnt vmcnt(7)
  buffer_load_dwordx4 v[8:11], v3, s[24:27], s54 offen offset:2048
  s_waitcnt vmcnt(7)
  buffer_load_dwordx4 v[8:11], v3, s[24:27], s54 offen offset:3072
  s_add_u32 s54, s54, 4096
  s_waitcnt vmcnt(7)
  buffer_load_dwordx4 v[8:11], v3, s[24:27], s54 offen offset:0
  s_waitcnt vmcnt(7)
  buffer_load_dwordx4 v[8:11], v3, s[24:27], s54 offen offset:1024
  s_waitcnt vmcnt(7)
  buffer_load_dwordx4 v[8:11], v3, s[24:27], s54 offen offset:2048
  s_waitcnt vmcnt(7)
  buffer_load_dwordx4 v[8:11], v3, s[24:27], s54 offen offset:3072
  s_mul_i32 s54, s2, 8192
  s_waitcnt vmcnt(7)
  buffer_load_dwordx4 v[8:11], v3, s[28:31], s54 offen offset:0
  s_waitcnt vmcnt(7)
  buffer_load_dwordx4 v[8:11], v3, s[28:31], s54 offen offset:1024
  s_waitcnt vmcnt(7)
  buffer_load_dwordx4 v[8:11], v3, s[28:31], s54 offen offset:2048
  s_waitcnt vmcnt(7)
  buffer_load_dwordx4 v[8:11], v3, s[28:31], s54 offen offset:3072
  s_add_u32 s54, s54, 4096
  s_waitcnt vmcnt(7)
  buffer_load_dwordx4 v[8:11], v3, s[28:31], s54 offen offset:0
  s_waitcnt vmcnt(7)
  buffer_load_dwordx4 v[8:11], v3, s[28:31], s54 offen offset:1024
  s_waitcnt vmcnt(7)
  buffer_load_dwordx4 v[8:11], v3, s[28:31], s54 offen offset:2048
  s_waitcnt vmcnt(7)
  buffer_load_dwordx4 v[8:11], v3, s[28:31], s54 offen offset:3072
  s_mul_i32 s54, s2, 8192
  s_waitcnt vmcnt(7)
  buffer_load_dwordx4 v[8:11], v3, s[32:35], s54 offen offset:0
  s_waitcnt vmcnt(7)
  buffer_load_dwordx4 v[8:11], v3, s[32:35], s54 offen offset:1024
  s_waitcnt vmcnt(7)
  buffer_load_dwordx4 v[8:11], v3, s[32:35], s54 offen offset:2048
  s_waitcnt vmcnt(7)
  buffer_load_dwordx4 v[8:11], v3, s[32:35], s54 offen offset:3072
  s_add_u32 s54, s54, 4096
  s_waitcnt vmcnt(7)
  buffer_load_dwordx4 v[8:11], v3, s[32:35], s54 offen offset:0
  s_waitcnt vmcnt(7)
  buffer_load_dwordx4 v[8:11], v3, s[32:35], s54 offen offset:1024
  s_waitcnt vmcnt(7)
  buffer_load_dwordx4 v[8:11], v3, s[32:35], s54 offen offset:2048
  s_waitcnt vmcnt(7)
  buffer_load_dwordx4 v[8:11], v3, s[32:35], s54 offen offset:3072
  s_waitcnt vmcnt(0)
  s_load_dwordx2 s[74:75], s[80:81], 8
L_h_getnonce:
  s_waitcnt lgkmcnt(0)
  s_cmp_lg_u64 s[74:75], 0
  s_cbranch_scc1 L_h_gotnonce
  s_sleep 32
  s_atomic_or_x2 s[74:75], s[80:81], 8 glc
  s_branch L_h_getnonce
L_h_gotnonce:
  s_lshr_b64 s[54:55], s[74:75], 2
  v_mov_b32 v1, 61708
  v_mov_b32 v8, s54
  ds_write_b32 v1, v8
  v_mov_b32 v1, 61712
L_h_progc0_0:
  s_sleep 8
  ds_read_b128 v[8:11], v1
  s_waitcnt lgkmcnt(0)
  v_min_u32 v8, v8, v9
  s_nop 0
  v_readfirstlane_b32 s54, v8
  s_nop 1
  s_cmp_lt_u32 s54, 28
  s_cbranch_scc1 L_h_progc0_0
  s_memrealtime s[54:55]
  s_waitcnt lgkmcnt(0)
  s_sub_u32 s65, s54, s72
  s_and_b32 s70, s2, 0x78
  s_cbranch_scc1 L_h_np0
  v_mov_b32 v8, s54
  v_mov_b32 v9, s55
  s_mov_b32 s70, 7340032
  s_mov_b64 exec, 1
  buffer_store_dwordx2 v[8:9], v104, s[40:43], s70 offen sc1
  s_mov_b64 exec, -1
L_h_np0:
  v_mov_b32 v1, 61712
L_h_progc0_1:
  s_sleep 8
  ds_read_b128 v[8:11], v1
  s_waitcnt lgkmcnt(0)
  v_min_u32 v8, v8, v9
  s_nop 0
  v_readfirstlane_b32 s54, v8
  s_nop 1
  s_cmp_lt_u32 s54, 36
  s_cbranch_scc1 L_h_progc0_1
  s_mov_b32 s70, 7340032
  buffer_load_dwordx2 v[8:9], v105, s[40:43], s70 offen
  v_mov_b32 v10, s73
  s_waitcnt vmcnt(0)
  v_subrev_co_u32 v8, vcc, s72, v8
  s_nop 1
  v_subb_co_u32 v9, vcc, v9, v10, vcc
  v_lshrrev_b32 v10, 24, v8
  v_or_b32 v9, v9, v10
  v_cmp_eq_u32 vcc, 0, v9
  s_nop 1
  v_cndmask_b32 v8, 0, v8, vcc
  s_and_b32 s56, vcc_lo, 0xffff
  s_bcnt1_i32_b32 s56, s56
  v_add_u32_dpp v8, v8, v8 row_ror:8 row_mask:0xf bank_mask:0xf
  s_nop 1
  v_add_u32_dpp v8, v8, v8 row_ror:4 row_mask:0xf bank_mask:0xf
  s_nop 1
  v_add_u32_dpp v8, v8, v8 row_ror:2 row_mask:0xf bank_mask:0xf
  s_nop 1
  v_add_u32_dpp v8, v8, v8 row_ror:1 row_mask:0xf bank_mask:0xf
  s_nop 0
  v_readfirstlane_b32 s54, v8
  s_sub_u32 s70, s65, 0
  s_mul_i32 s70, s70, s56
  s_sub_i32 s54, s70, s54
  s_max_i32 s54, s54, 0
  s_max_u32 s56, s56, 1
  s_mul_i32 s56, s56, 22
  v_cvt_f32_u32 v8, s56
  v_cvt_f32_u32 v9, s54
  v_rcp_f32 v8, v8
  s_nop 0
  v_fma_f32 v8, v8, v9, 0.5
  v_cvt_u32_f32 v8, v8
  v_min_u32 v8, 64, v8
  s_nop 0
  v_readfirstlane_b32 s54, v8
  s_nop 1
  s_mul_i32 s54, s54, 2
  s_sub_i32 s70, s66, 28
  s_max_i32 s70, s70, 0
  s_min_i32 s70, s70, 10
  s_sub_i32 s54, s54, s70
  s_cmp_gt_i32 s54, 0
  s_cselect_b32 s70, 38, 0
  s_cselect_b32 s54, s54, 0
  s_add_u32 s66, s70, s54
  v_mov_b32 v8, s66
  v_mov_b32 v1, 61704
  ds_write_b32 v1, v8
  v_mov_b32 v1, 61712
L_h_progc1_0:
  s_sleep 8
  ds_read_b128 v[8:11], v1
  s_waitcnt lgkmcnt(0)
  v_min_u32 v8, v8, v9
  s_nop 0
  v_readfirstlane_b32 s54, v8
  s_nop 1
  s_cmp_lt_u32 s54, 44
  s_cbranch_scc1 L_h_progc1_0
  s_memrealtime s[54:55]
  s_waitcnt lgkmcnt(0)
  s_sub_u32 s65, s54, s72
  s_and_b32 s70, s2, 0x78
  s_cbranch_scc1 L_h_np1
  v_mov_b32 v8, s54
  v_mov_b32 v9, s55
  s_mov_b32 s70, 7340288
  s_mov_b64 exec, 1
  buffer_store_dwordx2 v[8:9], v104, s[40:43], s70 offen sc1
  s_mov_b64 exec, -1
L_h_np1:
  v_mov_b32 v1, 61712
L_h_progc1_1:
  s_sleep 8
  ds_read_b128 v[8:11], v1
  s_waitcnt lgkmcnt(0)
  v_min_u32 v8, v8, v9
  s_nop 0
  v_readfirstlane_b32 s54, v8
  s_nop 1
  s_cmp_lt_u32 s54, 52
  s_cbranch_scc1 L_h_progc1_1
  s_mov_b32 s70, 7340288
  buffer_load_dwordx2 v[8:9], v105, s[40:43], s70 offen
  v_mov_b32 v10, s73
  s_waitcnt vmcnt(0)
  v_subrev_co_u32 v8, vcc, s72, v8
  s_nop 1
  v_subb_co_u32 v9, vcc, v9, v10, vcc
  v_lshrrev_b32 v10, 24, v8
  v_or_b32 v9, v9, v10
  v_cmp_eq_u32 vcc, 0, v9
  s_nop 1
  v_cndmask_b32 v8, 0, v8, vcc
  s_and_b32 s56, vcc_lo, 0xffff
  s_bcnt1_i32_b32 s56, s56
  v_add_u32_dpp v8, v8, v8 row_ror:8 row_mask:0xf bank_mask:0xf
  s_nop 1
  v_add_u32_dpp v8, v8, v8 row_ror:4 row_mask:0xf bank_mask:0xf
  s_nop 1
  v_add_u32_dpp v8, v8, v8 row_ror:2 row_mask:0xf bank_mask:0xf
  s_nop 1
  v_add_u32_dpp v8, v8, v8 row_ror:1 row_mask:0xf bank_mask:0xf
  s_nop 0
  v_readfirstlane_b32 s54, v8
  s_sub_u32 s70, s65, 0
  s_mul_i32 s70, s70, s56
  s_sub_i32 s54, s70, s54
  s_max_i32 s54, s54, 0
  s_max_u32 s56, s56, 1
  s_mul_i32 s56, s56, 22
  v_cvt_f32_u32 v8, s56
  v_cvt_f32_u32 v9, s54
  v_rcp_f32 v8, v8
  s_nop 0
  v_fma_f32 v8, v8, v9, 0.5
  v_cvt_u32_f32 v8, v8
  v_min_u32 v8, 64, v8
  s_nop 0
  v_readfirstlane_b32 s54, v8
  s_nop 1
  s_mul_i32 s54, s54, 2
  s_sub_i32 s70, s66, 44
  s_max_i32 s70, s70, 0
  s_min_i32 s70, s70, 10
  s_sub_i32 s54, s54, s70
  s_cmp_gt_i32 s54, 0
  s_cselect_b32 s70, 54, 0
  s_cselect_b32 s54, s54, 0
  s_add_u32 s66, s70, s54
  v_mov_b32 v8, s66
  v_mov_b32 v1, 61704
  ds_write_b32 v1, v8
  s_bitcmp1_b32 s96, 6
  s_cbranch_scc1 L_h_skipa
  s_lshl_b32 s62, s2, 8
  s_add_u32 s62, s62, 7405568
  s_xor_b32 s63, s62, 1024
  s_lshr_b32 s58, s96, 3
  s_xor_b32 s58, s58, s96
  s_lshr_b32 s70, s5, 4
  s_lshr_b32 s44, s70, 5
  s_lshl_b32 s44, s44, 21
  s_add_u32 s44, s44, 8388608
  s_and_b32 s64, s70, 31
  s_add_u32 s70, s64, s4
  s_lshl_b32 s70, s70, 10
  s_add_u32 s60, s44, s70
  s_xor_b32 s61, s60, 1024
  v_mov_b32 v1, 61712
L_h_proga:
  s_sleep 32
  ds_read_b128 v[8:11], v1
  s_waitcnt lgkmcnt(0)
  v_min_u32 v8, v8, v9
  s_nop 0
  v_readfirstlane_b32 s54, v8
  s_nop 1
  s_cmp_lt_u32 s54, 64
  s_cbranch_scc1 L_h_proga
  ds_read_b128 v[8:11], v3 offset:0
  ds_read_b128 v[12:15], v3 offset:1024
  ds_read_b128 v[16:19], v3 offset:2048
  ds_read_b128 v[20:23], v3 offset:3072
  ds_read_b128 v[24:27], v3 offset:4096
  ds_read_b128 v[28:31], v3 offset:5120
  s_waitcnt lgkmcnt(0)
  s_xor_b32 s70, s60, 0
  buffer_store_dwordx4 v[8:11], v3, s[40:43], s70 offen sc1
  s_xor_b32 s70, s60, 32768
  buffer_store_dwordx4 v[12:15], v3, s[40:43], s70 offen sc1
  s_xor_b32 s70, s60, 65536
  buffer_store_dwordx4 v[16:19], v3, s[40:43], s70 offen sc1
  s_xor_b32 s70, s60, 98304
  buffer_store_dwordx4 v[20:23], v3, s[40:43], s70 offen sc1
  s_xor_b32 s70, s60, 132096
  buffer_store_dwordx4 v[24:27], v3, s[40:43], s70 offen sc1
  s_xor_b32 s70, s60, 164864
  buffer_store_dwordx4 v[28:31], v3, s[40:43], s70 offen sc1
  s_bitcmp0_b32 s58, 0
  s_cbranch_scc1 L_h_e0
  ds_read_b128 v[32:35], v3 offset:6144
  ds_read_b128 v[36:39], v3 offset:7168
  ds_read_b128 v[40:43], v3 offset:8192
  ds_read_b128 v[44:47], v3 offset:9216
  ds_read_b128 v[48:51], v3 offset:10240
  ds_read_b128 v[52:55], v3 offset:11264
  s_waitcnt lgkmcnt(0)
  s_xor_b32 s70, s60, 197632
  buffer_store_dwordx4 v[32:35], v3, s[40:43], s70 offen sc1
  s_xor_b32 s70, s60, 230400
  buffer_store_dwordx4 v[36:39], v3, s[40:43], s70 offen sc1
  s_xor_b32 s70, s60, 264192
  buffer_store_dwordx4 v[40:43], v3, s[40:43], s70 offen sc1
  s_xor_b32 s70, s60, 296960
  buffer_store_dwordx4 v[44:47], v3, s[40:43], s70 offen sc1
  s_xor_b32 s70, s60, 329728
  buffer_store_dwordx4 v[48:51], v3, s[40:43], s70 offen sc1
  s_xor_b32 s70, s60, 362496
  buffer_store_dwordx4 v[52:55], v3, s[40:43], s70 offen sc1
L_h_e0:
  s_bitcmp0_b32 s58, 1
  s_cbranch_scc1 L_h_e1
  ds_read_b128 v[56:59], v3 offset:12288
  ds_read_b128 v[60:63], v3 offset:13312
  ds_read_b128 v[64:67], v3 offset:14336
  ds_read_b128 v[68:71], v3 offset:15360
  ds_read_b128 v[72:75], v3 offset:16384
  ds_read_b128 v[76:79], v3 offset:17408
  ds_read_b128 v[80:83], v3 offset:18432
  ds_read_b128 v[84:87], v3 offset:19456
  ds_read_b128 v[88:91], v3 offset:20480
  ds_read_b128 v[92:95], v3 offset:21504
  ds_read_b128 v[96:99], v3 offset:22528
  ds_read_b128 v[100:103], v3 offset:23552
  s_waitcnt lgkmcnt(0)
  s_xor_b32 s70, s60, 396288
  buffer_store_dwordx4 v[56:59], v3, s[40:43], s70 offen sc1
  s_xor_b32 s70, s60, 429056
  buffer_store_dwordx4 v[60:63], v3, s[40:43], s70 offen sc1
  s_xor_b32 s70, s60, 461824
  buffer_store_dwordx4 v[64:67], v3, s[40:43], s70 offen sc1
  s_xor_b32 s70, s60, 494592
  buffer_store_dwordx4 v[68:71], v3, s[40:43], s70 offen sc1
  s_xor_b32 s70, s60, 541696
  buffer_store_dwordx4 v[72:75], v3, s[40:43], s70 offen sc1
  s_xor_b32 s70, s60, 574464
  buffer_store_dwordx4 v[76:79], v3, s[40:43], s70 offen sc1
  s_xor_b32 s70, s60, 607232
  buffer_store_dwordx4 v[80:83], v3, s[40:43], s70 offen sc1
  s_xor_b32 s70, s60, 640000
  buffer_store_dwordx4 v[84:87], v3, s[40:43], s70 offen sc1
  s_xor_b32 s70, s60, 671744
  buffer_store_dwordx4 v[88:91], v3, s[40:43], s70 offen sc1
  s_xor_b32 s70, s60, 704512
  buffer_store_dwordx4 v[92:95], v3, s[40:43], s70 offen sc1
  s_xor_b32 s70, s60, 737280
  buffer_store_dwordx4 v[96:99], v3, s[40:43], s70 offen sc1
  s_xor_b32 s70, s60, 770048
  buffer_store_dwordx4 v[100:103], v3, s[40:43], s70 offen sc1
L_h_e1:
  s_add_u32 s54, s74, 1
  v_mov_b32 v5, 0
  s_waitcnt vmcnt(0)
  v_mov_b32 v8, s54
  v_mov_b32 v9, s75
  s_mov_b64 exec, 1
  buffer_store_dwordx2 v[8:9], v5, s[40:43], s62 offen sc1
  s_mov_b32 s59, 0
L_h_flaga:
  buffer_load_dwordx2 v[10:11], v5, s[40:43], s63 offen sc1
  s_waitcnt vmcnt(0)
  v_readfirstlane_b32 s56, v10
  v_readfirstlane_b32 s57, v11
  s_nop 0
  s_sub_u32 s56, s56, s54
  s_xor_b32 s57, s57, s75
  s_lshr_b32 s56, s56, 1
  s_or_b32 s56, s56, s57
  s_cbranch_scc0 L_h_flaga_done
  s_add_u32 s59, s59, 1
  s_cmp_gt_u32 s59, 2000
  s_cbranch_scc1 L_h_flaga_done
  s_sleep 32
  s_branch L_h_flaga
L_h_flaga_done:
  s_mov_b64 exec, -1
  s_bfe_u32 s54, s96, 0x10003
  s_mul_i32 s54, s54, 384
  v_lshrrev_b32 v4, 3, v0
  v_add_u32 v5, 0, v4
  v_mul_u32_u24 v5, 21846, v5
  v_bfe_u32 v5, v5, 16, 1
  v_mul_u32_u24 v6, 384, v5
  v_sub_u32 v6, v3, v6
  v_add_u32 v6, s54, v6
  v_add_u32 v6, 0, v6
  v_add_u32 v5, s64, v5
  v_lshrrev_b32 v2, 12, v6
  v_xor_b32 v5, v5, v2
  v_lshrrev_b32 v2, 10, v6
  v_lshl_add_u32 v5, v2, 5, v5
  v_and_b32 v6, 1023, v6
  v_lshl_add_u32 v5, v5, 10, v6
  buffer_load_dwordx4 v[8:11], v5, s[40:43], s44 offen sc1
  v_add_u32 v5, 8, v4
  v_mul_u32_u24 v5, 21846, v5
  v_bfe_u32 v5, v5, 16, 1
  v_mul_u32_u24 v6, 384, v5
  v_sub_u32 v6, v3, v6
  v_add_u32 v6, s54, v6
  v_add_u32 v6, 1024, v6
  v_add_u32 v5, s64, v5
  v_lshrrev_b32 v2, 12, v6
  v_xor_b32 v5, v5, v2
  v_lshrrev_b32 v2, 10, v6
  v_lshl_add_u32 v5, v2, 5, v5
  v_and_b32 v6, 1023, v6
  v_lshl_add_u32 v5, v5, 10, v6
  buffer_load_dwordx4 v[12:15], v5, s[40:43], s44 offen sc1
  v_add_u32 v5, 16, v4
  v_mul_u32_u24 v5, 21846, v5
  v_bfe_u32 v5, v5, 16, 1
  v_mul_u32_u24 v6, 384, v5
  v_sub_u32 v6, v3, v6
  v_add_u32 v6, s54, v6
  v_add_u32 v6, 2048, v6
  v_add_u32 v5, s64, v5
  v_lshrrev_b32 v2, 12, v6
  v_xor_b32 v5, v5, v2
  v_lshrrev_b32 v2, 10, v6
  v_lshl_add_u32 v5, v2, 5, v5
  v_and_b32 v6, 1023, v6
  v_lshl_add_u32 v5, v5, 10, v6
  buffer_load_dwordx4 v[16:19], v5, s[40:43], s44 offen sc1
  v_add_u32 v5, 24, v4
  v_mul_u32_u24 v5, 21846, v5
  v_bfe_u32 v5, v5, 16, 1
  v_mul_u32_u24 v6, 384, v5
  v_sub_u32 v6, v3, v6
  v_add_u32 v6, s54, v6
  v_add_u32 v6, 3072, v6
  v_add_u32 v5, s64, v5
  v_lshrrev_b32 v2, 12, v6
  v_xor_b32 v5, v5, v2
  v_lshrrev_b32 v2, 10, v6
  v_lshl_add_u32 v5, v2, 5, v5
  v_and_b32 v6, 1023, v6
  v_lshl_add_u32 v5, v5, 10, v6
  buffer_load_dwordx4 v[20:23], v5, s[40:43], s44 offen sc1
  v_add_u32 v5, 32, v4
  v_mul_u32_u24 v5, 21846, v5
  v_bfe_u32 v5, v5, 16, 1
  v_mul_u32_u24 v6, 384, v5
  v_sub_u32 v6, v3, v6
  v_add_u32 v6, s54, v6
  v_add_u32 v6, 4096, v6
  v_add_u32 v5, s64, v5
  v_lshrrev_b32 v2, 12, v6
  v_xor_b32 v5, v5, v2
  v_lshrrev_b32 v2, 10, v6
  v_lshl_add_u32 v5, v2, 5, v5
  v_and_b32 v6, 1023, v6
  v_lshl_add_u32 v5, v5, 10, v6
  buffer_load_dwordx4 v[24:27], v5, s[40:43], s44 offen sc1
  v_add_u32 v5, 40, v4
  v_mul_u32_u24 v5, 21846, v5
  v_bfe_u32 v5, v5, 16, 1
  v_mul_u32_u24 v6, 384, v5
  v_sub_u32 v6, v3, v6
  v_add_u32 v6, s54, v6
  v_add_u32 v6, 5120, v6
  v_add_u32 v5, s64, v5
  v_lshrrev_b32 v2, 12, v6
  v_xor_b32 v5, v5, v2
  v_lshrrev_b32 v2, 10, v6
  v_lshl_add_u32 v5, v2, 5, v5
  v_and_b32 v6, 1023, v6
  v_lshl_add_u32 v5, v5, 10, v6
  buffer_load_dwordx4 v[28:31], v5, s[40:43], s44 offen sc1
  s_waitcnt vmcnt(0)
  ds_write_b128 v3, v[8:11] offset:0
  ds_write_b128 v3, v[12:15] offset:1024
  ds_write_b128 v3, v[16:19] offset:2048
  ds_write_b128 v3, v[20:23] offset:3072
  ds_write_b128 v3, v[24:27] offset:4096
  ds_write_b128 v3, v[28:31] offset:5120
  s_bitcmp0_b32 s58, 0
  s_cbranch_scc1 L_h_i0
  s_xor_b32 s70, s61, 197632
  buffer_load_dwordx4 v[32:35], v3, s[40:43], s70 offen sc1
  s_xor_b32 s70, s61, 230400
  buffer_load_dwordx4 v[36:39], v3, s[40:43], s70 offen sc1
  s_xor_b32 s70, s61, 264192
  buffer_load_dwordx4 v[40:43], v3, s[40:43], s70 offen sc1
  s_xor_b32 s70, s61, 296960
  buffer_load_dwordx4 v[44:47], v3, s[40:43], s70 offen sc1
  s_xor_b32 s70, s61, 329728
  buffer_load_dwordx4 v[48:51], v3, s[40:43], s70 offen sc1
  s_xor_b32 s70, s61, 362496
  buffer_load_dwordx4 v[52:55], v3, s[40:43], s70 offen sc1
  s_waitcnt vmcnt(0)
  ds_write_b128 v3, v[32:35] offset:6144
  ds_write_b128 v3, v[36:39] offset:7168
  ds_write_b128 v3, v[40:43] offset:8192
  ds_write_b128 v3, v[44:47] offset:9216
  ds_write_b128 v3, v[48:51] offset:10240
  ds_write_b128 v3, v[52:55] offset:11264
L_h_i0:
  s_bitcmp0_b32 s58, 1
  s_cbranch_scc1 L_h_i1
  s_xor_b32 s70, s61, 396288
  buffer_load_dwordx4 v[56:59], v3, s[40:43], s70 offen sc1
  s_xor_b32 s70, s61, 429056
  buffer_load_dwordx4 v[60:63], v3, s[40:43], s70 offen sc1
  s_xor_b32 s70, s61, 461824
  buffer_load_dwordx4 v[64:67], v3, s[40:43], s70 offen sc1
  s_xor_b32 s70, s61, 494592
  buffer_load_dwordx4 v[68:71], v3, s[40:43], s70 offen sc1
  s_xor_b32 s70, s61, 541696
  buffer_load_dwordx4 v[72:75], v3, s[40:43], s70 offen sc1
  s_xor_b32 s70, s61, 574464
  buffer_load_dwordx4 v[76:79], v3, s[40:43], s70 offen sc1
  s_xor_b32 s70, s61, 607232
  buffer_load_dwordx4 v[80:83], v3, s[40:43], s70 offen sc1
  s_xor_b32 s70, s61, 640000
  buffer_load_dwordx4 v[84:87], v3, s[40:43], s70 offen sc1
  s_xor_b32 s70, s61, 671744
  buffer_load_dwordx4 v[88:91], v3, s[40:43], s70 offen sc1
  s_xor_b32 s70, s61, 704512
  buffer_load_dwordx4 v[92:95], v3, s[40:43], s70 offen sc1
  s_xor_b32 s70, s61, 737280
  buffer_load_dwordx4 v[96:99], v3, s[40:43], s70 offen sc1
  s_xor_b32 s70, s61, 770048
  buffer_load_dwordx4 v[100:103], v3, s[40:43], s70 offen sc1
  s_waitcnt vmcnt(0)
  ds_write_b128 v3, v[56:59] offset:12288
  ds_write_b128 v3, v[60:63] offset:13312
  ds_write_b128 v3, v[64:67] offset:14336
  ds_write_b128 v3, v[68:71] offset:15360
  ds_write_b128 v3, v[72:75] offset:16384
  ds_write_b128 v3, v[76:79] offset:17408
  ds_write_b128 v3, v[80:83] offset:18432
  ds_write_b128 v3, v[84:87] offset:19456
  ds_write_b128 v3, v[88:91] offset:20480
  ds_write_b128 v3, v[92:95] offset:21504
  ds_write_b128 v3, v[96:99] offset:22528
  ds_write_b128 v3, v[100:103] offset:23552
L_h_i1:
L_h_skipa:
  s_lshr_b32 s70, s96, 4
  s_andn2_b32 s58, s58, s70
  s_bitcmp0_b32 s58, 2
  s_cselect_b32 s70, 255, 64
  v_mov_b32 v1, 61700
  v_mov_b32 v5, s70
  ds_write_b32 v1, v5
  v_mov_b32 v1, 61712
L_h_progc2_0:
  s_sleep 8
  ds_read_b128 v[8:11], v1
  s_waitcnt lgkmcnt(0)
  v_min_u32 v8, v8, v9
  s_nop 0
  v_readfirstlane_b32 s54, v8
  s_nop 1
  s_cmp_lt_u32 s54, 76
  s_cbranch_scc1 L_h_progc2_0
  s_memrealtime s[54:55]
  s_waitcnt lgkmcnt(0)
  s_sub_u32 s65, s54, s72
  s_and_b32 s70, s2, 0x78
  s_cbranch_scc1 L_h_np2
  v_mov_b32 v8, s54
  v_mov_b32 v9, s55
  s_mov_b32 s70, 7340544
  s_mov_b64 exec, 1
  buffer_store_dwordx2 v[8:9], v104, s[40:43], s70 offen sc1
  s_mov_b64 exec, -1
L_h_np2:
  v_mov_b32 v1, 61712
L_h_progc2_1:
  s_sleep 8
  ds_read_b128 v[8:11], v1
  s_waitcnt lgkmcnt(0)
  v_min_u32 v8, v8, v9
  s_nop 0
  v_readfirstlane_b32 s54, v8
  s_nop 1
  s_cmp_lt_u32 s54, 84
  s_cbranch_scc1 L_h_progc2_1
  s_mov_b32 s70, 7340544
  buffer_load_dwordx2 v[8:9], v105, s[40:43], s70 offen
  v_mov_b32 v10, s73
  s_waitcnt vmcnt(0)
  v_subrev_co_u32 v8, vcc, s72, v8
  s_nop 1
  v_subb_co_u32 v9, vcc, v9, v10, vcc
  v_lshrrev_b32 v10, 24, v8
  v_or_b32 v9, v9, v10
  v_cmp_eq_u32 vcc, 0, v9
  s_nop 1
  v_cndmask_b32 v8, 0, v8, vcc
  s_and_b32 s56, vcc_lo, 0xffff
  s_bcnt1_i32_b32 s56, s56
  v_add_u32_dpp v8, v8, v8 row_ror:8 row_mask:0xf bank_mask:0xf
  s_nop 1
  v_add_u32_dpp v8, v8, v8 row_ror:4 row_mask:0xf bank_mask:0xf
  s_nop 1
  v_add_u32_dpp v8, v8, v8 row_ror:2 row_mask:0xf bank_mask:0xf
  s_nop 1
  v_add_u32_dpp v8, v8, v8 row_ror:1 row_mask:0xf bank_mask:0xf
  s_nop 0
  v_readfirstlane_b32 s54, v8
  s_sub_u32 s70, s65, 0
  s_mul_i32 s70, s70, s56
  s_sub_i32 s54, s70, s54
  s_max_i32 s54, s54, 0
  s_max_u32 s56, s56, 1
  s_mul_i32 s56, s56, 22
  v_cvt_f32_u32 v8, s56
  v_cvt_f32_u32 v9, s54
  v_rcp_f32 v8, v8
  s_nop 0
  v_fma_f32 v8, v8, v9, 0.5
  v_cvt_u32_f32 v8, v8
  v_min_u32 v8, 64, v8
  s_nop 0
  v_readfirstlane_b32 s54, v8
  s_nop 1
  s_mul_i32 s54, s54, 2
  s_sub_i32 s70, s66, 76
  s_max_i32 s70, s70, 0
  s_min_i32 s70, s70, 10
  s_sub_i32 s54, s54, s70
  s_cmp_gt_i32 s54, 0
  s_cselect_b32 s70, 86, 0
  s_cselect_b32 s54, s54, 0
  s_add_u32 s66, s70, s54
  v_mov_b32 v8, s66
  v_mov_b32 v1, 61704
  ds_write_b32 v1, v8
  s_bitcmp0_b32 s58, 2
  s_cbranch_scc1 L_h_all
  v_mov_b32 v1, 61712
L_h_progb:
  s_sleep 32
  ds_read_b128 v[8:11], v1
  s_waitcnt lgkmcnt(0)
  v_min_u32 v8, v8, v9
  s_nop 0
  v_readfirstlane_b32 s54, v8
  s_nop 1
  s_cmp_lt_u32 s54, 96
  s_cbranch_scc1 L_h_progb
  ds_read_b128 v[8:11], v3 offset:24576
  ds_read_b128 v[12:15], v3 offset:25600
  ds_read_b128 v[16:19], v3 offset:26624
  ds_read_b128 v[20:23], v3 offset:27648
  ds_read_b128 v[24:27], v3 offset:28672
  ds_read_b128 v[28:31], v3 offset:29696
  ds_read_b128 v[32:35], v3 offset:30720
  ds_read_b128 v[36:39], v3 offset:31744
  ds_read_b128 v[40:43], v3 offset:32768
  ds_read_b128 v[44:47], v3 offset:33792
  ds_read_b128 v[48:51], v3 offset:34816
  ds_read_b128 v[52:55], v3 offset:35840
  s_waitcnt lgkmcnt(0)
  s_xor_b32 s70, s60, 805888
  buffer_store_dwordx4 v[8:11], v3, s[40:43], s70 offen sc1
  s_xor_b32 s70, s60, 838656
  buffer_store_dwordx4 v[12:15], v3, s[40:43], s70 offen sc1
  s_xor_b32 s70, s60, 871424
  buffer_store_dwordx4 v[16:19], v3, s[40:43], s70 offen sc1
  s_xor_b32 s70, s60, 904192
  buffer_store_dwordx4 v[20:23], v3, s[40:43], s70 offen sc1
  s_xor_b32 s70, s60, 935936
  buffer_store_dwordx4 v[24:27], v3, s[40:43], s70 offen sc1
  s_xor_b32 s70, s60, 968704
  buffer_store_dwordx4 v[28:31], v3, s[40:43], s70 offen sc1
  s_xor_b32 s70, s60, 1001472
  buffer_store_dwordx4 v[32:35], v3, s[40:43], s70 offen sc1
  s_xor_b32 s70, s60, 1034240
  buffer_store_dwordx4 v[36:39], v3, s[40:43], s70 offen sc1
  s_xor_b32 s70, s60, 1052672
  buffer_store_dwordx4 v[40:43], v3, s[40:43], s70 offen sc1
  s_xor_b32 s70, s60, 1085440
  buffer_store_dwordx4 v[44:47], v3, s[40:43], s70 offen sc1
  s_xor_b32 s70, s60, 1118208
  buffer_store_dwordx4 v[48:51], v3, s[40:43], s70 offen sc1
  s_xor_b32 s70, s60, 1150976
  buffer_store_dwordx4 v[52:55], v3, s[40:43], s70 offen sc1
  s_add_u32 s54, s74, 2
  v_mov_b32 v5, 0
  s_waitcnt vmcnt(0)
  v_mov_b32 v8, s54
  v_mov_b32 v9, s75
  s_mov_b64 exec, 1
  buffer_store_dwordx2 v[8:9], v5, s[40:43], s62 offen sc1
  s_mov_b32 s59, 0
L_h_flagb:
  buffer_load_dwordx2 v[10:11], v5, s[40:43], s63 offen sc1
  s_waitcnt vmcnt(0)
  v_readfirstlane_b32 s56, v10
  v_readfirstlane_b32 s57, v11
  s_nop 0
  s_sub_u32 s56, s56, s54
  s_xor_b32 s57, s57, s75
  s_lshr_b32 s56, s56, 1
  s_or_b32 s56, s56, s57
  s_cbranch_scc0 L_h_flagb_done
  s_add_u32 s59, s59, 1
  s_cmp_gt_u32 s59, 2000
  s_cbranch_scc1 L_h_flagb_done
  s_sleep 32
  s_branch L_h_flagb
L_h_flagb_done:
  s_mov_b64 exec, -1
  s_xor_b32 s70, s61, 805888
  buffer_load_dwordx4 v[8:11], v3, s[40:43], s70 offen sc1
  s_xor_b32 s70, s61, 838656
  buffer_load_dwordx4 v[12:15], v3, s[40:43], s70 offen sc1
  s_xor_b32 s70, s61, 871424
  buffer_load_dwordx4 v[16:19], v3, s[40:43], s70 offen sc1
  s_xor_b32 s70, s61, 904192
  buffer_load_dwordx4 v[20:23], v3, s[40:43], s70 offen sc1
  s_xor_b32 s70, s61, 935936
  buffer_load_dwordx4 v[24:27], v3, s[40:43], s70 offen sc1
  s_xor_b32 s70, s61, 968704
  buffer_load_dwordx4 v[28:31], v3, s[40:43], s70 offen sc1
  s_xor_b32 s70, s61, 1001472
  buffer_load_dwordx4 v[32:35], v3, s[40:43], s70 offen sc1
  s_xor_b32 s70, s61, 1034240
  buffer_load_dwordx4 v[36:39], v3, s[40:43], s70 offen sc1
  s_xor_b32 s70, s61, 1052672
  buffer_load_dwordx4 v[40:43], v3, s[40:43], s70 offen sc1
  s_xor_b32 s70, s61, 1085440
  buffer_load_dwordx4 v[44:47], v3, s[40:43], s70 offen sc1
  s_xor_b32 s70, s61, 1118208
  buffer_load_dwordx4 v[48:51], v3, s[40:43], s70 offen sc1
  s_xor_b32 s70, s61, 1150976
  buffer_load_dwordx4 v[52:55], v3, s[40:43], s70 offen sc1
  s_waitcnt vmcnt(0)
  ds_write_b128 v3, v[8:11] offset:24576
  ds_write_b128 v3, v[12:15] offset:25600
  ds_write_b128 v3, v[16:19] offset:26624
  ds_write_b128 v3, v[20:23] offset:27648
  ds_write_b128 v3, v[24:27] offset:28672
  ds_write_b128 v3, v[28:31] offset:29696
  ds_write_b128 v3, v[32:35] offset:30720
  ds_write_b128 v3, v[36:39] offset:31744
  ds_write_b128 v3, v[40:43] offset:32768
  ds_write_b128 v3, v[44:47] offset:33792
  ds_write_b128 v3, v[48:51] offset:34816
  ds_write_b128 v3, v[52:55] offset:35840
  v_mov_b32 v1, 61700
  v_mov_b32 v5, 255
  ds_write_b32 v1, v5
L_h_all:
  v_mov_b32 v1, 61712
L_h_progc3_0:
  s_sleep 8
  ds_read_b128 v[8:11], v1
  s_waitcnt lgkmcnt(0)
  v_min_u32 v8, v8, v9
  s_nop 0
  v_readfirstlane_b32 s54, v8
  s_nop 1
  s_cmp_lt_u32 s54, 108
  s_cbranch_scc1 L_h_progc3_0
  s_memrealtime s[54:55]
  s_waitcnt lgkmcnt(0)
  s_sub_u32 s65, s54, s72
  s_and_b32 s70, s2, 0x78
  s_cbranch_scc1 L_h_np3
  v_mov_b32 v8, s54
  v_mov_b32 v9, s55
  s_mov_b32 s70, 7340800
  s_mov_b64 exec, 1
  buffer_store_dwordx2 v[8:9], v104, s[40:43], s70 offen sc1
  s_mov_b64 exec, -1
L_h_np3:
  v_mov_b32 v1, 61712
L_h_progc3_1:
  s_sleep 8
  ds_read_b128 v[8:11], v1
  s_waitcnt lgkmcnt(0)
  v_min_u32 v8, v8, v9
  s_nop 0
  v_readfirstlane_b32 s54, v8
  s_nop 1
  s_cmp_lt_u32 s54, 116
  s_cbranch_scc1 L_h_progc3_1
  s_mov_b32 s70, 7340800
  buffer_load_dwordx2 v[8:9], v105, s[40:43], s70 offen
  v_mov_b32 v10, s73
  s_waitcnt vmcnt(0)
  v_subrev_co_u32 v8, vcc, s72, v8
  s_nop 1
  v_subb_co_u32 v9, vcc, v9, v10, vcc
  v_lshrrev_b32 v10, 24, v8
  v_or_b32 v9, v9, v10
  v_cmp_eq_u32 vcc, 0, v9
  s_nop 1
  v_cndmask_b32 v8, 0, v8, vcc
  s_and_b32 s56, vcc_lo, 0xffff
  s_bcnt1_i32_b32 s56, s56
  v_add_u32_dpp v8, v8, v8 row_ror:8 row_mask:0xf bank_mask:0xf
  s_nop 1
  v_add_u32_dpp v8, v8, v8 row_ror:4 row_mask:0xf bank_mask:0xf
  s_nop 1
  v_add_u32_dpp v8, v8, v8 row_ror:2 row_mask:0xf bank_mask:0xf
  s_nop 1
  v_add_u32_dpp v8, v8, v8 row_ror:1 row_mask:0xf bank_mask:0xf
  s_nop 0
  v_readfirstlane_b32 s54, v8
  s_sub_u32 s70, s65, 0
  s_mul_i32 s70, s70, s56
  s_sub_i32 s54, s70, s54
  s_max_i32 s54, s54, 0
  s_max_u32 s56, s56, 1
  s_mul_i32 s56, s56, 22
  v_cvt_f32_u32 v8, s56
  v_cvt_f32_u32 v9, s54
  v_rcp_f32 v8, v8
  s_nop 0
  v_fma_f32 v8, v8, v9, 0.5
  v_cvt_u32_f32 v8, v8
  v_min_u32 v8, 64, v8
  s_nop 0
  v_readfirstlane_b32 s54, v8
  s_nop 1
  s_mul_i32 s54, s54, 2
  s_sub_i32 s70, s66, 108
  s_max_i32 s70, s70, 0
  s_min_i32 s70, s70, 10
  s_sub_i32 s54, s54, s70
  s_cmp_gt_i32 s54, 0
  s_cselect_b32 s70, 118, 0
  s_cselect_b32 s54, s54, 0
  s_add_u32 s66, s70, s54
  v_mov_b32 v8, s66
  v_mov_b32 v1, 61704
  ds_write_b32 v1, v8
  v_mov_b32 v1, 61712
L_h_progc4_0:
  s_sleep 8
  ds_read_b128 v[8:11], v1
  s_waitcnt lgkmcnt(0)
  v_min_u32 v8, v8, v9
  s_nop 0
  v_readfirstlane_b32 s54, v8
  s_nop 1
  s_cmp_lt_u32 s54, 124
  s_cbranch_scc1 L_h_progc4_0
  s_memrealtime s[54:55]
  s_waitcnt lgkmcnt(0)
  s_sub_u32 s65, s54, s72
  s_and_b32 s70, s2, 0x78
  s_cbranch_scc1 L_h_np4
  v_mov_b32 v8, s54
  v_mov_b32 v9, s55
  s_mov_b32 s70, 7341056
  s_mov_b64 exec, 1
  buffer_store_dwordx2 v[8:9], v104, s[40:43], s70 offen sc1
  s_mov_b64 exec, -1
L_h_np4:
  v_mov_b32 v1, 61712
L_h_progc4_1:
  s_sleep 8
  ds_read_b128 v[8:11], v1
  s_waitcnt lgkmcnt(0)
  v_min_u32 v8, v8, v9
  s_nop 0
  v_readfirstlane_b32 s54, v8
  s_nop 1
  s_cmp_lt_u32 s54, 132
  s_cbranch_scc1 L_h_progc4_1
  s_mov_b32 s70, 7341056
  buffer_load_dwordx2 v[8:9], v105, s[40:43], s70 offen
  v_mov_b32 v10, s73
  s_waitcnt vmcnt(0)
  v_subrev_co_u32 v8, vcc, s72, v8
  s_nop 1
  v_subb_co_u32 v9, vcc, v9, v10, vcc
  v_lshrrev_b32 v10, 24, v8
  v_or_b32 v9, v9, v10
  v_cmp_eq_u32 vcc, 0, v9
  s_nop 1
  v_cndmask_b32 v8, 0, v8, vcc
  s_and_b32 s56, vcc_lo, 0xffff
  s_bcnt1_i32_b32 s56, s56
  v_add_u32_dpp v8, v8, v8 row_ror:8 row_mask:0xf bank_mask:0xf
  s_nop 1
  v_add_u32_dpp v8, v8, v8 row_ror:4 row_mask:0xf bank_mask:0xf
  s_nop 1
  v_add_u32_dpp v8, v8, v8 row_ror:2 row_mask:0xf bank_mask:0xf
  s_nop 1
  v_add_u32_dpp v8, v8, v8 row_ror:1 row_mask:0xf bank_mask:0xf
  s_nop 0
  v_readfirstlane_b32 s54, v8
  s_sub_u32 s70, s65, 0
  s_mul_i32 s70, s70, s56
  s_sub_i32 s54, s70, s54
  s_max_i32 s54, s54, 0
  s_max_u32 s56, s56, 1
  s_mul_i32 s56, s56, 22
  v_cvt_f32_u32 v8, s56
  v_cvt_f32_u32 v9, s54
  v_rcp_f32 v8, v8
  s_nop 0
  v_fma_f32 v8, v8, v9, 0.5
  v_cvt_u32_f32 v8, v8
  v_min_u32 v8, 64, v8
  s_nop 0
  v_readfirstlane_b32 s54, v8
  s_nop 1
  s_mul_i32 s54, s54, 2
  s_sub_i32 s70, s66, 124
  s_max_i32 s70, s70, 0
  s_min_i32 s70, s70, 10
  s_sub_i32 s54, s54, s70
  s_cmp_gt_i32 s54, 0
  s_cselect_b32 s70, 134, 0
  s_cselect_b32 s54, s54, 0
  s_add_u32 s66, s70, s54
  v_mov_b32 v8, s66
  v_mov_b32 v1, 61704
  ds_write_b32 v1, v8
  v_mov_b32 v1, 61712
L_h_progc5_0:
  s_sleep 8
  ds_read_b128 v[8:11], v1
  s_waitcnt lgkmcnt(0)
  v_min_u32 v8, v8, v9
  s_nop 0
  v_readfirstlane_b32 s54, v8
  s_nop 1
  s_cmp_lt_u32 s54, 140
  s_cbranch_scc1 L_h_progc5_0
  s_memrealtime s[54:55]
  s_waitcnt lgkmcnt(0)
  s_sub_u32 s65, s54, s72
  s_and_b32 s70, s2, 0x78
  s_cbranch_scc1 L_h_np5
  v_mov_b32 v8, s54
  v_mov_b32 v9, s55
  s_mov_b32 s70, 7341312
  s_mov_b64 exec, 1
  buffer_store_dwordx2 v[8:9], v104, s[40:43], s70 offen sc1
  s_mov_b64 exec, -1
L_h_np5:
  v_mov_b32 v1, 61712
L_h_progc5_1:
  s_sleep 8
  ds_read_b128 v[8:11], v1
  s_waitcnt lgkmcnt(0)
  v_min_u32 v8, v8, v9
  s_nop 0
  v_readfirstlane_b32 s54, v8
  s_nop 1
  s_cmp_lt_u32 s54, 148
  s_cbranch_scc1 L_h_progc5_1
  s_mov_b32 s70, 7341312
  buffer_load_dwordx2 v[8:9], v105, s[40:43], s70 offen
  v_mov_b32 v10, s73
  s_waitcnt vmcnt(0)
  v_subrev_co_u32 v8, vcc, s72, v8
  s_nop 1
  v_subb_co_u32 v9, vcc, v9, v10, vcc
  v_lshrrev_b32 v10, 24, v8
  v_or_b32 v9, v9, v10
  v_cmp_eq_u32 vcc, 0, v9
  s_nop 1
  v_cndmask_b32 v8, 0, v8, vcc
  s_and_b32 s56, vcc_lo, 0xffff
  s_bcnt1_i32_b32 s56, s56
  v_add_u32_dpp v8, v8, v8 row_ror:8 row_mask:0xf bank_mask:0xf
  s_nop 1
  v_add_u32_dpp v8, v8, v8 row_ror:4 row_mask:0xf bank_mask:0xf
  s_nop 1
  v_add_u32_dpp v8, v8, v8 row_ror:2 row_mask:0xf bank_mask:0xf
  s_nop 1
  v_add_u32_dpp v8, v8, v8 row_ror:1 row_mask:0xf bank_mask:0xf
  s_nop 0
  v_readfirstlane_b32 s54, v8
  s_sub_u32 s70, s65, 0
  s_mul_i32 s70, s70, s56
  s_sub_i32 s54, s70, s54
  s_max_i32 s54, s54, 0
  s_max_u32 s56, s56, 1
  s_mul_i32 s56, s56, 22
  v_cvt_f32_u32 v8, s56
  v_cvt_f32_u32 v9, s54
  v_rcp_f32 v8, v8
  s_nop 0
  v_fma_f32 v8, v8, v9, 0.5
  v_cvt_u32_f32 v8, v8
  v_min_u32 v8, 64, v8
  s_nop 0
  v_readfirstlane_b32 s54, v8
  s_nop 1
  s_mul_i32 s54, s54, 2
  s_sub_i32 s70, s66, 140
  s_max_i32 s70, s70, 0
  s_min_i32 s70, s70, 10
  s_sub_i32 s54, s54, s70
  s_cmp_gt_i32 s54, 0
  s_cselect_b32 s70, 150, 0
  s_cselect_b32 s54, s54, 0
  s_add_u32 s66, s70, s54
  v_mov_b32 v8, s66
  v_mov_b32 v1, 61704
  ds_write_b32 v1, v8
  v_mov_b32 v1, 61712
L_h_progc6_0:
  s_sleep 8
  ds_read_b128 v[8:11], v1
  s_waitcnt lgkmcnt(0)
  v_min_u32 v8, v8, v9
  s_nop 0
  v_readfirstlane_b32 s54, v8
  s_nop 1
  s_cmp_lt_u32 s54, 156
  s_cbranch_scc1 L_h_progc6_0
  s_memrealtime s[54:55]
  s_waitcnt lgkmcnt(0)
  s_sub_u32 s65, s54, s72
  s_and_b32 s70, s2, 0x78
  s_cbranch_scc1 L_h_np6
  v_mov_b32 v8, s54
  v_mov_b32 v9, s55
  s_mov_b32 s70, 7341568
  s_mov_b64 exec, 1
  buffer_store_dwordx2 v[8:9], v104, s[40:43], s70 offen sc1
  s_mov_b64 exec, -1
L_h_np6:
  v_mov_b32 v1, 61712
L_h_progc6_1:
  s_sleep 8
  ds_read_b128 v[8:11], v1
  s_waitcnt lgkmcnt(0)
  v_min_u32 v8, v8, v9
  s_nop 0
  v_readfirstlane_b32 s54, v8
  s_nop 1
  s_cmp_lt_u32 s54, 164
  s_cbranch_scc1 L_h_progc6_1
  s_mov_b32 s70, 7341568
  buffer_load_dwordx2 v[8:9], v105, s[40:43], s70 offen
  v_mov_b32 v10, s73
  s_waitcnt vmcnt(0)
  v_subrev_co_u32 v8, vcc, s72, v8
  s_nop 1
  v_subb_co_u32 v9, vcc, v9, v10, vcc
  v_lshrrev_b32 v10, 24, v8
  v_or_b32 v9, v9, v10
  v_cmp_eq_u32 vcc, 0, v9
  s_nop 1
  v_cndmask_b32 v8, 0, v8, vcc
  s_and_b32 s56, vcc_lo, 0xffff
  s_bcnt1_i32_b32 s56, s56
  v_add_u32_dpp v8, v8, v8 row_ror:8 row_mask:0xf bank_mask:0xf
  s_nop 1
  v_add_u32_dpp v8, v8, v8 row_ror:4 row_mask:0xf bank_mask:0xf
  s_nop 1
  v_add_u32_dpp v8, v8, v8 row_ror:2 row_mask:0xf bank_mask:0xf
  s_nop 1
  v_add_u32_dpp v8, v8, v8 row_ror:1 row_mask:0xf bank_mask:0xf
  s_nop 0
  v_readfirstlane_b32 s54, v8
  s_sub_u32 s70, s65, 0
  s_mul_i32 s70, s70, s56
  s_sub_i32 s54, s70, s54
  s_max_i32 s54, s54, 0
  s_max_u32 s56, s56, 1
  s_mul_i32 s56, s56, 22
  v_cvt_f32_u32 v8, s56
  v_cvt_f32_u32 v9, s54
  v_rcp_f32 v8, v8
  s_nop 0
  v_fma_f32 v8, v8, v9, 0.5
  v_cvt_u32_f32 v8, v8
  v_min_u32 v8, 64, v8
  s_nop 0
  v_readfirstlane_b32 s54, v8
  s_nop 1
  s_mul_i32 s54, s54, 2
  s_sub_i32 s70, s66, 156
  s_max_i32 s70, s70, 0
  s_min_i32 s70, s70, 10
  s_sub_i32 s54, s54, s70
  s_cmp_gt_i32 s54, 0
  s_cselect_b32 s70, 166, 0
  s_cselect_b32 s54, s54, 0
  s_add_u32 s66, s70, s54
  v_mov_b32 v8, s66
  v_mov_b32 v1, 61704
  ds_write_b32 v1, v8
  v_mov_b32 v1, 61712
L_h_progc7_0:
  s_sleep 8
  ds_read_b128 v[8:11], v1
  s_waitcnt lgkmcnt(0)
  v_min_u32 v8, v8, v9
  s_nop 0
  v_readfirstlane_b32 s54, v8
  s_nop 1
  s_cmp_lt_u32 s54, 168
  s_cbranch_scc1 L_h_progc7_0
  s_memrealtime s[54:55]
  s_waitcnt lgkmcnt(0)
  s_sub_u32 s65, s54, s72
  s_and_b32 s70, s2, 0x78
  s_cbranch_scc1 L_h_np7
  v_mov_b32 v8, s54
  v_mov_b32 v9, s55
  s_mov_b32 s70, 7341824
  s_mov_b64 exec, 1
  buffer_store_dwordx2 v[8:9], v104, s[40:43], s70 offen sc1
  s_mov_b64 exec, -1
L_h_np7:
  v_mov_b32 v1, 61712
L_h_progc7_1:
  s_sleep 8
  ds_read_b128 v[8:11], v1
  s_waitcnt lgkmcnt(0)
  v_min_u32 v8, v8, v9
  s_nop 0
  v_readfirstlane_b32 s54, v8
  s_nop 1
  s_cmp_lt_u32 s54, 176
  s_cbranch_scc1 L_h_progc7_1
  s_mov_b32 s70, 7341824
  buffer_load_dwordx2 v[8:9], v105, s[40:43], s70 offen
  v_mov_b32 v10, s73
  s_waitcnt vmcnt(0)
  v_subrev_co_u32 v8, vcc, s72, v8
  s_nop 1
  v_subb_co_u32 v9, vcc, v9, v10, vcc
  v_lshrrev_b32 v10, 24, v8
  v_or_b32 v9, v9, v10
  v_cmp_eq_u32 vcc, 0, v9
  s_nop 1
  v_cndmask_b32 v8, 0, v8, vcc
  s_and_b32 s56, vcc_lo, 0xffff
  s_bcnt1_i32_b32 s56, s56
  v_add_u32_dpp v8, v8, v8 row_ror:8 row_mask:0xf bank_mask:0xf
  s_nop 1
  v_add_u32_dpp v8, v8, v8 row_ror:4 row_mask:0xf bank_mask:0xf
  s_nop 1
  v_add_u32_dpp v8, v8, v8 row_ror:2 row_mask:0xf bank_mask:0xf
  s_nop 1
  v_add_u32_dpp v8, v8, v8 row_ror:1 row_mask:0xf bank_mask:0xf
  s_nop 0
  v_readfirstlane_b32 s54, v8
  s_sub_u32 s70, s65, 0
  s_mul_i32 s70, s70, s56
  s_sub_i32 s54, s70, s54
  s_max_i32 s54, s54, 0
  s_max_u32 s56, s56, 1
  s_mul_i32 s56, s56, 22
  v_cvt_f32_u32 v8, s56
  v_cvt_f32_u32 v9, s54
  v_rcp_f32 v8, v8
  s_nop 0
  v_fma_f32 v8, v8, v9, 0.5
  v_cvt_u32_f32 v8, v8
  v_min_u32 v8, 64, v8
  s_nop 0
  v_readfirstlane_b32 s54, v8
  s_nop 1
  s_mul_i32 s54, s54, 2
  s_sub_i32 s70, s66, 168
  s_max_i32 s70, s70, 0
  s_min_i32 s70, s70, 10
  s_sub_i32 s54, s54, s70
  s_cmp_gt_i32 s54, 0
  s_cselect_b32 s70, 178, 0
  s_cselect_b32 s54, s54, 0
  s_add_u32 s66, s70, s54
  v_mov_b32 v8, s66
  v_mov_b32 v1, 61704
  ds_write_b32 v1, v8
  s_waitcnt lgkmcnt(0)
  s_endpgm
.section .rodata,"a"
.p2align 6
.amdhsa_kernel standalone__kv_cache_quant_int4_int2_kv_with_per_channel_or_per_token_scales__sampling_kernel
  .amdhsa_next_free_vgpr 256
  .amdhsa_next_free_sgpr 102
  .amdhsa_accum_offset 256
  .amdhsa_group_segment_fixed_size 0
  .amdhsa_kernarg_size 80
  .amdhsa_user_sgpr_count 2
  .amdhsa_user_sgpr_kernarg_segment_ptr 1
  .amdhsa_system_sgpr_workgroup_id_x 1
  .amdhsa_float_denorm_mode_32 3
.end_amdhsa_kernel
```

```asm
; @launch grid=(256,1,1) block=(192,1,1) lds=62464
.amdgcn_target "amdgcn-amd-amdhsa--gfx950"
.text
.globl standalone__kv_cache_quant_int4_int2_kv_with_per_channel_or_per_token_scales__sampling_kernel
.p2align 8
.type standalone__kv_cache_quant_int4_int2_kv_with_per_channel_or_per_token_scales__sampling_kernel,@function
standalone__kv_cache_quant_int4_int2_kv_with_per_channel_or_per_token_scales__sampling_kernel:
  s_cmp_ge_u32 s2, 256
  s_cbranch_scc1 L_end
  s_load_dwordx16 s[44:59], s[0:1], 0
  s_load_dwordx4 s[80:83], s[0:1], 64
  v_lshrrev_b32 v1, 6, v0
  v_and_b32 v0, 63, v0
  v_readfirstlane_b32 s3, v1
  s_bfe_u32 s4, s2, 0x10002
  s_lshr_b32 s5, s2, 3
  s_lshl_b32 s5, s5, 2
  s_and_b32 s70, s2, 3
  s_add_u32 s5, s5, s70
  s_lshl_b32 s5, s5, 5
  s_mov_b32 s22, 6291456
  s_mov_b32 s23, 0x20000
  s_mov_b32 s26, 6291456
  s_mov_b32 s27, 0x20000
  s_mov_b32 s30, 2097152
  s_mov_b32 s31, 0x20000
  s_mov_b32 s34, 2097152
  s_mov_b32 s35, 0x20000
  s_mov_b32 s10, 805306368
  s_mov_b32 s11, 0x20000
  s_mov_b32 s38, 393216
  s_mov_b32 s39, 0x20000
  s_mov_b32 s18, 805306368
  s_mov_b32 s19, 0x20000
  s_mov_b32 s14, 805306368
  s_mov_b32 s15, 0x20000
  s_mov_b32 s42, 25165824
  s_mov_b32 s43, 0x20000
  s_cmp_eq_u32 s3, 2
  s_cbranch_scc1 L_helper
  v_and_b32 v112, 3, v0
  v_bfe_u32 v113, v0, 2, 2
  v_lshrrev_b32 v114, 4, v0
  v_and_b32 v115, 15, v0
  v_lshlrev_b32 v148, 4, v112
  v_lshl_add_u32 v148, v114, 6, v148
  v_lshrrev_b32 v237, 1, v148
  v_and_b32 v235, 2, v113
  v_lshlrev_b32 v234, 5, v235
  v_add_u32 v234, 129, v234
  v_and_b32 v149, 1, v113
  v_lshl_add_u32 v235, v149, 2, v235
  v_mul_u32_u24 v149, 33024, v149
  v_add_u32 v236, v148, v149
  v_subrev_u32 v236, 33024, v236
  v_mul_u32_u24 v149, 384, v113
  v_add_u32 v239, v149, v237
  v_mov_b32 v108, 2147483632
  s_mov_b32 s90, 0xaaaaaaab
  s_mov_b32 s91, 0x492492
  s_movk_i32 s63, 768
  s_mov_b32 s64, s3
  s_mov_b32 s97, 8
  s_mov_b32 s99, 8
  s_mov_b32 s96, 0
  v_lshlrev_b32 v118, 4, v0
  s_mul_i32 s70, s2, 2
  s_add_u32 s70, s70, s3
  s_mul_i32 s88, s70, 4096
  s_mul_i32 s86, s70, 12288
  s_waitcnt lgkmcnt(0)
  s_mov_b32 s20, s50
  s_and_b32 s21, s51, 0xffff
  s_mov_b32 s24, s52
  s_and_b32 s25, s53, 0xffff
  s_mov_b32 s28, s54
  s_and_b32 s29, s55, 0xffff
  s_mov_b32 s32, s56
  s_and_b32 s33, s57, 0xffff
  buffer_load_dwordx4 v[132:135], v118, s[20:23], s86 offen offset:0
  buffer_load_dwordx4 v[132:135], v118, s[24:27], s86 offen offset:0
  buffer_load_dwordx4 v[132:135], v118, s[28:31], s88 offen offset:0
  buffer_load_dwordx4 v[132:135], v118, s[32:35], s88 offen offset:0
  buffer_load_dwordx4 v[132:135], v118, s[20:23], s86 offen offset:1024
  buffer_load_dwordx4 v[132:135], v118, s[24:27], s86 offen offset:1024
  buffer_load_dwordx4 v[132:135], v118, s[28:31], s88 offen offset:1024
  buffer_load_dwordx4 v[132:135], v118, s[32:35], s88 offen offset:1024
  s_mov_b32 s8, s46
  s_and_b32 s9, s47, 0xffff
  s_mov_b32 s36, s44
  s_and_b32 s37, s45, 0xffff
  s_mov_b32 s16, s46
  s_and_b32 s17, s47, 0xffff
  s_mov_b32 s12, s48
  s_and_b32 s13, s49, 0xffff
  s_mov_b32 s40, s82
  s_and_b32 s41, s83, 0xffff
  s_mov_b32 s56, 0x0f0f0f0f
  s_mov_b32 s57, 0x0f0f0f0f
  s_mov_b32 s58, 0xffff
  s_mov_b32 s59, 0xffff
  s_andn2_b32 s70, s64, 1
  s_or_b32 s70, s70, s4
  s_lshr_b32 s71, s64, 5
  s_lshr_b32 s85, s96, s71
  s_cmp_lt_u32 s64, s97
  s_cselect_b32 s70, s70, s64
  s_cselect_b32 s85, s64, s85
  s_and_b32 s85, s85, 1
  s_mul_i32 s71, s71, 4064
  s_add_u32 s70, s70, s71
  s_add_u32 s70, s70, s5
  s_mul_hi_u32 s84, s70, s90
  s_lshr_b32 s84, s84, 1
  s_mul_i32 s71, s84, 3
  s_sub_u32 s70, s70, s71
  s_lshl3_add_u32 s85, s70, s85
  s_mul_i32 s61, s84, 196608
  s_lshr_b32 s89, s84, 4
  s_lshl_b32 s70, s85, 5
  v_add_u32 v100, s70, v234
  v_mul_u32_u24 v100, 21846, v100
  v_lshrrev_b32 v100, 16, v100
  v_add_u32 v148, s85, v235
  v_lshrrev_b32 v149, v148, s91
  v_and_b32 v149, 1, v149
  v_cmp_eq_u32 s[54:55], 1, v149
  s_nop 1
  s_and_b64 s[52:53], s[54:55], s[56:57]
  s_andn2_b64 s[54:55], s[54:55], s[56:57]
  v_mul_u32_u24 v148, 43, v148
  v_lshrrev_b32 v148, 8, v148
  v_mul_u32_u24 v148, 384, v148
  v_add_u32 v238, v148, v237
  v_mad_u32_u24 v92, v100, s63, v236
  v_add_u32 v93, 768, v92
  v_add_u32 v94, 4608, v92
  v_add_u32 v95, 7680, v92
  v_cndmask_b32 v92, v92, v108, s[52:53]
  v_cndmask_b32 v95, v95, v108, s[54:55]
  s_mov_b32 s60, s61
  s_mul_i32 s70, s89, 1536
  buffer_load_dwordx2 v[178:179], v239, s[36:39], s70 offen offset:0
  buffer_load_dwordx2 v[180:181], v239, s[36:39], s70 offen offset:128
  buffer_load_dwordx2 v[182:183], v239, s[36:39], s70 offen offset:256
  buffer_load_dwordx4 v[4:7], v92, s[8:11], s60 offen offset:0 nt
  buffer_load_dwordx4 v[132:135], v118, s[20:23], s86 offen offset:2048
  buffer_load_dwordx4 v[132:135], v118, s[24:27], s86 offen offset:2048
  buffer_load_dwordx4 v[132:135], v118, s[28:31], s88 offen offset:2048
  buffer_load_dwordx4 v[132:135], v118, s[32:35], s88 offen offset:2048
  buffer_load_dwordx4 v[132:135], v118, s[20:23], s86 offen offset:3072
  buffer_load_dwordx4 v[132:135], v118, s[24:27], s86 offen offset:3072
  buffer_load_dwordx4 v[132:135], v118, s[28:31], s88 offen offset:3072
  buffer_load_dwordx4 v[132:135], v118, s[32:35], s88 offen offset:3072
  s_barrier
  s_add_u32 s86, s86, 4096
  s_waitcnt vmcnt(15)
  buffer_load_dwordx4 v[132:135], v118, s[20:23], s86 offen offset:0
  s_waitcnt vmcnt(15)
  buffer_load_dwordx4 v[132:135], v118, s[24:27], s86 offen offset:0
  s_waitcnt vmcnt(15)
  buffer_load_dwordx4 v[132:135], v118, s[20:23], s86 offen offset:1024
  s_waitcnt vmcnt(15)
  buffer_load_dwordx4 v[132:135], v118, s[24:27], s86 offen offset:1024
  s_waitcnt vmcnt(15)
  buffer_load_dwordx4 v[132:135], v118, s[20:23], s86 offen offset:2048
  s_waitcnt vmcnt(15)
  buffer_load_dwordx4 v[132:135], v118, s[24:27], s86 offen offset:2048
  s_waitcnt vmcnt(15)
  buffer_load_dwordx4 v[132:135], v118, s[20:23], s86 offen offset:3072
  s_waitcnt vmcnt(15)
  buffer_load_dwordx4 v[132:135], v118, s[24:27], s86 offen offset:3072
  s_add_u32 s86, s86, 4096
  s_waitcnt vmcnt(15)
  buffer_load_dwordx4 v[132:135], v118, s[20:23], s86 offen offset:0
  s_waitcnt vmcnt(15)
  buffer_load_dwordx4 v[132:135], v118, s[24:27], s86 offen offset:0
  s_waitcnt vmcnt(15)
  buffer_load_dwordx4 v[132:135], v118, s[20:23], s86 offen offset:1024
  s_waitcnt vmcnt(15)
  buffer_load_dwordx4 v[132:135], v118, s[24:27], s86 offen offset:1024
  s_waitcnt vmcnt(15)
  buffer_load_dwordx4 v[132:135], v118, s[20:23], s86 offen offset:2048
  s_waitcnt vmcnt(15)
  buffer_load_dwordx4 v[132:135], v118, s[24:27], s86 offen offset:2048
  s_waitcnt vmcnt(15)
  buffer_load_dwordx4 v[132:135], v118, s[20:23], s86 offen offset:3072
  s_waitcnt vmcnt(15)
  buffer_load_dwordx4 v[132:135], v118, s[24:27], s86 offen offset:3072
  s_mul_i32 s62, s84, 1536
  buffer_load_dwordx2 v[184:185], v238, s[20:23], s62 offen offset:0
  buffer_load_dwordx2 v[190:191], v238, s[24:27], s62 offen offset:0
  buffer_load_dwordx2 v[186:187], v238, s[20:23], s62 offen offset:128
  buffer_load_dwordx2 v[192:193], v238, s[24:27], s62 offen offset:128
  buffer_load_dwordx2 v[188:189], v238, s[20:23], s62 offen offset:256
  buffer_load_dwordx2 v[194:195], v238, s[24:27], s62 offen offset:256
  s_waitcnt vmcnt(16)
  buffer_load_dwordx4 v[8:11], v92, s[8:11], s60 offen offset:256 nt
  s_waitcnt vmcnt(16)
  buffer_load_dwordx4 v[12:15], v92, s[8:11], s60 offen offset:512 nt
  s_waitcnt vmcnt(16)
  buffer_load_dwordx4 v[16:19], v93, s[8:11], s60 offen offset:0 nt
  s_waitcnt vmcnt(16)
  buffer_load_dwordx4 v[20:23], v93, s[8:11], s60 offen offset:256 nt
  s_waitcnt vmcnt(16)
  buffer_load_dwordx4 v[24:27], v93, s[8:11], s60 offen offset:512 nt
  s_waitcnt vmcnt(16)
  buffer_load_dwordx4 v[28:31], v93, s[8:11], s60 offen offset:768 nt
  s_waitcnt vmcnt(16)
  buffer_load_dwordx4 v[32:35], v93, s[8:11], s60 offen offset:1024 nt
  s_waitcnt vmcnt(16)
  buffer_load_dwordx4 v[36:39], v93, s[8:11], s60 offen offset:1280 nt
  s_waitcnt vmcnt(16)
  buffer_load_dwordx4 v[40:43], v93, s[8:11], s60 offen offset:1536 nt
  s_waitcnt vmcnt(16)
  buffer_load_dwordx4 v[44:47], v93, s[8:11], s60 offen offset:1792 nt
  s_waitcnt vmcnt(16)
  buffer_load_dwordx4 v[48:51], v93, s[8:11], s60 offen offset:2048 nt
  s_waitcnt vmcnt(17)
  buffer_load_dwordx4 v[52:55], v93, s[8:11], s60 offen offset:2304 nt
  s_waitcnt vmcnt(18)
  buffer_load_dwordx4 v[56:59], v93, s[8:11], s60 offen offset:2560 nt
  s_waitcnt vmcnt(19)
  buffer_load_dwordx4 v[60:63], v93, s[8:11], s60 offen offset:2816 nt
  s_mov_b32 s88, s89
  s_mov_b64 vcc, 0
  v_lshlrev_b32 v148, 4, v115
  v_and_b32 v97, 2, v114
  v_lshlrev_b32 v96, 5, v97
  v_add_u32 v96, 129, v96
  v_and_b32 v149, 1, v114
  v_lshl_add_u32 v97, v149, 2, v97
  v_mul_u32_u24 v149, 33024, v149
  v_add_u32 v98, v148, v149
  v_subrev_u32 v98, 33024, v98
  v_and_b32 v149, 1, v114
  v_mul_u32_u24 v149, 86, v149
  v_lshl_add_u32 v99, v115, 1, v149
  v_subrev_u32 v99, 86, v99
  v_lshlrev_b32 v104, 4, v114
  v_lshrrev_b32 v148, 2, v0
  s_mul_i32 s70, s3, 384
  v_lshl_add_u32 v102, v148, 4, s70
  v_lshl_add_u32 v103, v148, 3, s70
  s_mul_i32 s70, s3, 3072
  s_add_u32 s70, s70, 36864
  v_lshl_add_u32 v105, v0, 4, s70
  s_lshl_b32 s70, s3, 5
  s_add_u32 s70, s70, 43008
  v_lshl_add_u32 v106, v113, 3, s70
  s_lshl_b32 s70, s3, 2
  s_add_u32 s70, s70, 61712
  v_mov_b32 v107, s70
  v_lshrrev_b32 v109, 5, v0
  v_mul_u32_u24 v109, 16, v109
  s_lshl2_add_u32 s70, s3, 61728
  v_add_u32 v109, s70, v109
  v_mov_b32 v116, 0
  v_mov_b32 v117, 0
  v_mov_b32 v240, 0xff800000
  s_mov_b32 s65, 0xffff0000
  s_mov_b32 s66, 0x3fb8aa3b
  s_mov_b32 s68, 0x4893cd3a
  s_mov_b32 s92, 0x7f000000
  s_mov_b32 s94, 0x34800000
  s_mov_b32 s69, 0x4893cd3a
  s_mov_b32 s93, 0x7f000000
  s_mov_b32 s95, 0x34800000
  s_mov_b32 s72, 0x11111111
  s_mov_b32 s73, 0x11111111
  s_mov_b32 s44, 0
  s_mov_b32 s74, 0x22222222
  s_mov_b32 s75, 0x22222222
  s_mov_b32 s45, 0
  s_mov_b32 s76, 0x44444444
  s_mov_b32 s77, 0x44444444
  s_mov_b32 s46, 0
  s_mov_b32 s78, 0x88888888
  s_mov_b32 s79, 0x88888888
  s_mov_b32 s47, 0
  s_mov_b32 s100, 0
  s_waitcnt vmcnt(14)
  v_mov_b32 v132, 0
  v_mov_b32 v133, 0
  v_mov_b32 v134, 0
  v_mov_b32 v135, 0
  v_mov_b32 v136, 0
  v_mov_b32 v137, 0
  v_mov_b32 v138, 0
  v_mov_b32 v139, 0
  v_mov_b32 v140, 0
  v_mov_b32 v141, 0
  v_mov_b32 v142, 0
  v_mov_b32 v143, 0
  v_mov_b32 v144, 0xff800000
  v_mov_b32 v146, 0x7f800000
  v_mov_b32 v147, 0
L_k:
  v_add_u32 v148, s85, v97
  v_lshrrev_b32 v149, v148, s91
  v_and_b32 v149, 1, v149
  v_cmp_eq_u32 s[50:51], 1, v149
  s_nop 1
  s_and_b64 s[48:49], s[50:51], s[58:59]
  s_andn2_b64 s[50:51], s[50:51], s[58:59]
  s_add_u32 s64, s64, 2
  ds_read_b32 v110, v109
  s_waitcnt vmcnt(14)
  s_cbranch_vccnz L_kw0_0
  s_waitcnt vmcnt(10)
L_kw0_0:
  buffer_load_dwordx4 v[64:67], v93, s[8:11], s60 offen offset:3072 nt
  v_lshlrev_b32 v208, 16, v190
  v_and_b32 v209, s65, v190
  v_lshlrev_b32 v210, 16, v191
  v_and_b32 v211, s65, v191
  v_lshlrev_b32 v196, 16, v184
  v_and_b32 v197, s65, v184
  v_lshlrev_b32 v198, 16, v185
  v_and_b32 v199, s65, v185
  v_pk_mul_f32 v[208:209], v[208:209], s[94:95]
  v_mov_b32 v172, v178
  v_pk_mul_f32 v[210:211], v[210:211], s[94:95]
  v_mov_b32 v173, v179
  v_pk_fma_f32 v[112:113], v[4:5], s[92:93], v[208:209] neg_lo:[0,0,1] neg_hi:[0,0,1]
  v_pk_fma_f32 v[114:115], v[6:7], s[92:93], v[210:211] neg_lo:[0,0,1] neg_hi:[0,0,1]
  v_cvt_pk_bf16_f32 v112, 0, v112
  v_cvt_pk_bf16_f32 v113, 0, v113
  v_cvt_pk_bf16_f32 v114, 0, v114
  v_cvt_pk_bf16_f32 v115, 0, v115
  v_pk_mul_f32 v[112:113], v[112:113], v[196:197]
  v_pk_mul_f32 v[114:115], v[114:115], v[198:199]
  v_cvt_pk_bf16_f32 v220, v112, v113
  v_cvt_pk_bf16_f32 v221, v114, v115
  s_waitcnt lgkmcnt(0)
  s_sub_u32 s70, s64, 2
  v_cmp_lt_u32 vcc, s70, v110
  s_waitcnt vmcnt(14)
  s_cbranch_vccnz L_kw0_1
  s_waitcnt vmcnt(10)
L_kw0_1:
  buffer_load_dwordx4 v[68:71], v93, s[8:11], s60 offen offset:3328 nt
  v_lshlrev_b32 v212, 16, v192
  v_and_b32 v213, s65, v192
  v_lshlrev_b32 v214, 16, v193
  v_and_b32 v215, s65, v193
  v_lshlrev_b32 v200, 16, v186
  v_and_b32 v201, s65, v186
  v_lshlrev_b32 v202, 16, v187
  v_and_b32 v203, s65, v187
  v_pk_mul_f32 v[212:213], v[212:213], s[94:95]
  v_mov_b32 v174, v180
  v_pk_mul_f32 v[214:215], v[214:215], s[94:95]
  v_mov_b32 v175, v181
  v_pk_fma_f32 v[112:113], v[8:9], s[92:93], v[212:213] neg_lo:[0,0,1] neg_hi:[0,0,1]
  v_pk_fma_f32 v[114:115], v[10:11], s[92:93], v[214:215] neg_lo:[0,0,1] neg_hi:[0,0,1]
  v_cvt_pk_bf16_f32 v112, 0, v112
  v_cvt_pk_bf16_f32 v113, 0, v113
  v_cvt_pk_bf16_f32 v114, 0, v114
  v_cvt_pk_bf16_f32 v115, 0, v115
  v_pk_mul_f32 v[112:113], v[112:113], v[200:201]
  v_pk_mul_f32 v[114:115], v[114:115], v[202:203]
  v_cvt_pk_bf16_f32 v222, v112, v113
  v_cvt_pk_bf16_f32 v223, v114, v115
  s_waitcnt vmcnt(14)
  s_cbranch_vccnz L_kw0_2
  s_waitcnt vmcnt(10)
L_kw0_2:
  buffer_load_dwordx4 v[72:75], v93, s[8:11], s60 offen offset:3584 nt
  v_mfma_f32_16x16x32_bf16 v[228:231], v[220:223], v[172:175], 0
  v_lshlrev_b32 v216, 16, v194
  v_and_b32 v217, s65, v194
  v_lshlrev_b32 v218, 16, v195
  v_and_b32 v219, s65, v195
  v_lshlrev_b32 v204, 16, v188
  v_and_b32 v205, s65, v188
  v_lshlrev_b32 v206, 16, v189
  v_and_b32 v207, s65, v189
  v_pk_mul_f32 v[216:217], v[216:217], s[94:95]
  v_mov_b32 v176, v182
  v_pk_mul_f32 v[218:219], v[218:219], s[94:95]
  v_mov_b32 v177, v183
  v_pk_fma_f32 v[112:113], v[12:13], s[92:93], v[216:217] neg_lo:[0,0,1] neg_hi:[0,0,1]
  v_pk_fma_f32 v[114:115], v[14:15], s[92:93], v[218:219] neg_lo:[0,0,1] neg_hi:[0,0,1]
  v_cvt_pk_bf16_f32 v112, 0, v112
  v_cvt_pk_bf16_f32 v113, 0, v113
  v_cvt_pk_bf16_f32 v114, 0, v114
  v_cvt_pk_bf16_f32 v115, 0, v115
  v_pk_mul_f32 v[112:113], v[112:113], v[204:205]
  v_pk_mul_f32 v[114:115], v[114:115], v[206:207]
  v_cvt_pk_bf16_f32 v224, v112, v113
  v_cvt_pk_bf16_f32 v225, v114, v115
  s_waitcnt vmcnt(14)
  s_cbranch_vccnz L_kw0_3
  s_waitcnt vmcnt(10)
L_kw0_3:
  buffer_load_dwordx4 v[76:79], v94, s[8:11], s60 offen offset:0 nt
  v_mfma_f32_16x16x16_bf16 v[228:231], v[224:225], v[176:177], v[228:231]
  v_pk_fma_f32 v[112:113], v[16:17], s[92:93], v[208:209] neg_lo:[0,0,1] neg_hi:[0,0,1]
  v_pk_fma_f32 v[114:115], v[18:19], s[92:93], v[210:211] neg_lo:[0,0,1] neg_hi:[0,0,1]
  v_cvt_pk_bf16_f32 v112, 0, v112
  v_cvt_pk_bf16_f32 v113, 0, v113
  v_cvt_pk_bf16_f32 v114, 0, v114
  v_cvt_pk_bf16_f32 v115, 0, v115
  v_pk_mul_f32 v[112:113], v[112:113], v[196:197]
  v_pk_mul_f32 v[114:115], v[114:115], v[198:199]
  v_cvt_pk_bf16_f32 v220, v112, v113
  v_cvt_pk_bf16_f32 v221, v114, v115
  s_waitcnt vmcnt(14)
  s_cbranch_vccnz L_kw0_4
  s_waitcnt vmcnt(10)
L_kw0_4:
  buffer_load_dwordx4 v[80:83], v94, s[8:11], s60 offen offset:256 nt
  v_pk_fma_f32 v[112:113], v[20:21], s[92:93], v[212:213] neg_lo:[0,0,1] neg_hi:[0,0,1]
  v_pk_fma_f32 v[114:115], v[22:23], s[92:93], v[214:215] neg_lo:[0,0,1] neg_hi:[0,0,1]
  v_mov_b32_dpp v148, v228 quad_perm:[0,0,0,0] row_mask:0xf bank_mask:0xf
  v_mov_b32_dpp v149, v230 quad_perm:[2,2,2,2] row_mask:0xf bank_mask:0xf
  v_cvt_pk_bf16_f32 v112, 0, v112
  v_cvt_pk_bf16_f32 v113, 0, v113
  v_add_f32_dpp v148, v229, v148 quad_perm:[1,1,1,1] row_mask:0xf bank_mask:0xf
  v_add_f32_dpp v149, v231, v149 quad_perm:[3,3,3,3] row_mask:0xf bank_mask:0xf
  v_cvt_pk_bf16_f32 v114, 0, v114
  v_cvt_pk_bf16_f32 v115, 0, v115
  v_add_f32 v232, v148, v149
  v_pk_mul_f32 v[112:113], v[112:113], v[200:201]
  v_pk_mul_f32 v[114:115], v[114:115], v[202:203]
  v_cvt_pk_bf16_f32 v222, v112, v113
  v_cvt_pk_bf16_f32 v223, v114, v115
  s_waitcnt vmcnt(14)
  s_cbranch_vccnz L_kw0_5
  s_waitcnt vmcnt(10)
L_kw0_5:
  buffer_load_dwordx4 v[84:87], v94, s[8:11], s60 offen offset:512 nt
  v_mfma_f32_16x16x32_bf16 v[228:231], v[220:223], v[172:175], 0
  v_pk_fma_f32 v[112:113], v[24:25], s[92:93], v[216:217] neg_lo:[0,0,1] neg_hi:[0,0,1]
  v_pk_fma_f32 v[114:115], v[26:27], s[92:93], v[218:219] neg_lo:[0,0,1] neg_hi:[0,0,1]
  v_cvt_pk_bf16_f32 v112, 0, v112
  v_cndmask_b32 v232, v232, v240, s[48:49]
  v_cvt_pk_bf16_f32 v113, 0, v113
  v_cvt_pk_bf16_f32 v114, 0, v114
  v_cvt_pk_bf16_f32 v115, 0, v115
  v_pk_mul_f32 v[112:113], v[112:113], v[204:205]
  v_pk_mul_f32 v[114:115], v[114:115], v[206:207]
  v_cvt_pk_bf16_f32 v224, v112, v113
  v_cvt_pk_bf16_f32 v225, v114, v115
  s_waitcnt vmcnt(14)
  s_cbranch_vccnz L_kw0_6
  s_waitcnt vmcnt(10)
L_kw0_6:
  buffer_load_dwordx4 v[88:91], v94, s[8:11], s60 offen offset:768 nt
  v_mfma_f32_16x16x16_bf16 v[228:231], v[224:225], v[176:177], v[228:231]
  v_pk_fma_f32 v[112:113], v[28:29], s[92:93], v[208:209] neg_lo:[0,0,1] neg_hi:[0,0,1]
  v_pk_fma_f32 v[114:115], v[30:31], s[92:93], v[210:211] neg_lo:[0,0,1] neg_hi:[0,0,1]
  v_cvt_pk_bf16_f32 v112, 0, v112
  v_cvt_pk_bf16_f32 v113, 0, v113
  v_cvt_pk_bf16_f32 v114, 0, v114
  v_cvt_pk_bf16_f32 v115, 0, v115
  v_pk_mul_f32 v[112:113], v[112:113], v[196:197]
  v_pk_mul_f32 v[114:115], v[114:115], v[198:199]
  v_cvt_pk_bf16_f32 v220, v112, v113
  v_cvt_pk_bf16_f32 v221, v114, v115
  s_waitcnt vmcnt(14)
  s_cbranch_vccnz L_kw0_7
  s_waitcnt vmcnt(10)
L_kw0_7:
  buffer_load_dwordx4 v[4:7], v94, s[8:11], s60 offen offset:1024 nt
  v_pk_fma_f32 v[112:113], v[32:33], s[92:93], v[212:213] neg_lo:[0,0,1] neg_hi:[0,0,1]
  v_pk_fma_f32 v[114:115], v[34:35], s[92:93], v[214:215] neg_lo:[0,0,1] neg_hi:[0,0,1]
  v_mov_b32_dpp v148, v228 quad_perm:[0,0,0,0] row_mask:0xf bank_mask:0xf
  v_mov_b32_dpp v149, v230 quad_perm:[2,2,2,2] row_mask:0xf bank_mask:0xf
  v_cvt_pk_bf16_f32 v112, 0, v112
  v_cvt_pk_bf16_f32 v113, 0, v113
  v_add_f32_dpp v148, v229, v148 quad_perm:[1,1,1,1] row_mask:0xf bank_mask:0xf
  v_add_f32_dpp v149, v231, v149 quad_perm:[3,3,3,3] row_mask:0xf bank_mask:0xf
  v_cvt_pk_bf16_f32 v114, 0, v114
  v_cvt_pk_bf16_f32 v115, 0, v115
  v_add_f32 v233, v148, v149
  v_pk_mul_f32 v[112:113], v[112:113], v[200:201]
  v_pk_mul_f32 v[114:115], v[114:115], v[202:203]
  v_cvt_pk_bf16_f32 v222, v112, v113
  v_cvt_pk_bf16_f32 v223, v114, v115
  s_waitcnt vmcnt(14)
  s_cbranch_vccnz L_kw0_8
  s_waitcnt vmcnt(10)
L_kw0_8:
  buffer_load_dwordx4 v[8:11], v94, s[8:11], s60 offen offset:1280 nt
  v_mfma_f32_16x16x32_bf16 v[228:231], v[220:223], v[172:175], 0
  v_pk_fma_f32 v[112:113], v[36:37], s[92:93], v[216:217] neg_lo:[0,0,1] neg_hi:[0,0,1]
  v_pk_fma_f32 v[114:115], v[38:39], s[92:93], v[218:219] neg_lo:[0,0,1] neg_hi:[0,0,1]
  v_cvt_pk_bf16_f32 v112, 0, v112
  v_cvt_pk_bf16_f32 v232, 0, v232
  v_cvt_pk_bf16_f32 v113, 0, v113
  v_cvt_pk_bf16_f32 v233, 0, v233
  v_cvt_pk_bf16_f32 v114, 0, v114
  v_pk_mul_f32 v[232:233], v[232:233], s[68:69]
  v_cvt_pk_bf16_f32 v115, 0, v115
  v_cvt_pk_bf16_f32 v124, v232, v233
  v_pk_mul_f32 v[112:113], v[112:113], v[204:205]
  v_pk_mul_f32 v[114:115], v[114:115], v[206:207]
  v_cvt_pk_bf16_f32 v224, v112, v113
  v_cvt_pk_bf16_f32 v225, v114, v115
  s_waitcnt vmcnt(14)
  s_cbranch_vccnz L_kw0_9
  s_waitcnt vmcnt(10)
L_kw0_9:
  buffer_load_dwordx4 v[12:15], v94, s[8:11], s60 offen offset:1536 nt
  v_mfma_f32_16x16x16_bf16 v[228:231], v[224:225], v[176:177], v[228:231]
  v_pk_fma_f32 v[112:113], v[40:41], s[92:93], v[208:209] neg_lo:[0,0,1] neg_hi:[0,0,1]
  v_pk_fma_f32 v[114:115], v[42:43], s[92:93], v[210:211] neg_lo:[0,0,1] neg_hi:[0,0,1]
  v_cvt_pk_bf16_f32 v112, 0, v112
  v_cvt_pk_bf16_f32 v113, 0, v113
  v_cvt_pk_bf16_f32 v114, 0, v114
  v_cvt_pk_bf16_f32 v115, 0, v115
  v_pk_mul_f32 v[112:113], v[112:113], v[196:197]
  v_pk_mul_f32 v[114:115], v[114:115], v[198:199]
  v_cvt_pk_bf16_f32 v220, v112, v113
  v_cvt_pk_bf16_f32 v221, v114, v115
  s_waitcnt vmcnt(14)
  s_cbranch_vccnz L_kw0_10
  s_waitcnt vmcnt(10)
L_kw0_10:
  buffer_load_dwordx4 v[16:19], v94, s[8:11], s60 offen offset:1792 nt
  v_pk_fma_f32 v[112:113], v[44:45], s[92:93], v[212:213] neg_lo:[0,0,1] neg_hi:[0,0,1]
  v_pk_fma_f32 v[114:115], v[46:47], s[92:93], v[214:215] neg_lo:[0,0,1] neg_hi:[0,0,1]
  v_mov_b32_dpp v148, v228 quad_perm:[0,0,0,0] row_mask:0xf bank_mask:0xf
  v_mov_b32_dpp v149, v230 quad_perm:[2,2,2,2] row_mask:0xf bank_mask:0xf
  v_cvt_pk_bf16_f32 v112, 0, v112
  v_cvt_pk_bf16_f32 v113, 0, v113
  v_add_f32_dpp v148, v229, v148 quad_perm:[1,1,1,1] row_mask:0xf bank_mask:0xf
  v_add_f32_dpp v149, v231, v149 quad_perm:[3,3,3,3] row_mask:0xf bank_mask:0xf
  v_cvt_pk_bf16_f32 v114, 0, v114
  v_cvt_pk_bf16_f32 v115, 0, v115
  v_add_f32 v232, v148, v149
  v_pk_mul_f32 v[112:113], v[112:113], v[200:201]
  v_pk_mul_f32 v[114:115], v[114:115], v[202:203]
  v_cvt_pk_bf16_f32 v222, v112, v113
  v_cvt_pk_bf16_f32 v223, v114, v115
  s_waitcnt vmcnt(14)
  s_cbranch_vccnz L_kw0_11
  s_waitcnt vmcnt(10)
L_kw0_11:
  buffer_load_dwordx4 v[20:23], v94, s[8:11], s60 offen offset:2048 nt
  v_mfma_f32_16x16x32_bf16 v[228:231], v[220:223], v[172:175], 0
  v_pk_fma_f32 v[112:113], v[48:49], s[92:93], v[216:217] neg_lo:[0,0,1] neg_hi:[0,0,1]
  v_pk_fma_f32 v[114:115], v[50:51], s[92:93], v[218:219] neg_lo:[0,0,1] neg_hi:[0,0,1]
  v_cvt_pk_bf16_f32 v112, 0, v112
  v_cvt_pk_bf16_f32 v113, 0, v113
  v_cvt_pk_bf16_f32 v114, 0, v114
  v_cvt_pk_bf16_f32 v115, 0, v115
  v_pk_mul_f32 v[112:113], v[112:113], v[204:205]
  v_pk_mul_f32 v[114:115], v[114:115], v[206:207]
  v_cvt_pk_bf16_f32 v224, v112, v113
  v_cvt_pk_bf16_f32 v225, v114, v115
  s_waitcnt vmcnt(14)
  s_cbranch_vccnz L_kw0_12
  s_waitcnt vmcnt(10)
L_kw0_12:
  buffer_load_dwordx4 v[24:27], v94, s[8:11], s60 offen offset:2304 nt
  v_mfma_f32_16x16x16_bf16 v[228:231], v[224:225], v[176:177], v[228:231]
  v_pk_fma_f32 v[112:113], v[52:53], s[92:93], v[208:209] neg_lo:[0,0,1] neg_hi:[0,0,1]
  v_pk_fma_f32 v[114:115], v[54:55], s[92:93], v[210:211] neg_lo:[0,0,1] neg_hi:[0,0,1]
  v_cvt_pk_bf16_f32 v112, 0, v112
  v_cvt_pk_bf16_f32 v113, 0, v113
  v_cvt_pk_bf16_f32 v114, 0, v114
  v_cvt_pk_bf16_f32 v115, 0, v115
  v_pk_mul_f32 v[112:113], v[112:113], v[196:197]
  v_pk_mul_f32 v[114:115], v[114:115], v[198:199]
  v_cvt_pk_bf16_f32 v220, v112, v113
  v_cvt_pk_bf16_f32 v221, v114, v115
  s_waitcnt vmcnt(14)
  s_cbranch_vccnz L_kw0_13
  s_waitcnt vmcnt(10)
L_kw0_13:
  buffer_load_dwordx4 v[28:31], v94, s[8:11], s60 offen offset:2560 nt
  v_pk_fma_f32 v[112:113], v[56:57], s[92:93], v[212:213] neg_lo:[0,0,1] neg_hi:[0,0,1]
  v_pk_fma_f32 v[114:115], v[58:59], s[92:93], v[214:215] neg_lo:[0,0,1] neg_hi:[0,0,1]
  v_mov_b32_dpp v148, v228 quad_perm:[0,0,0,0] row_mask:0xf bank_mask:0xf
  v_mov_b32_dpp v149, v230 quad_perm:[2,2,2,2] row_mask:0xf bank_mask:0xf
  v_cvt_pk_bf16_f32 v112, 0, v112
  v_cvt_pk_bf16_f32 v113, 0, v113
  v_add_f32_dpp v148, v229, v148 quad_perm:[1,1,1,1] row_mask:0xf bank_mask:0xf
  v_add_f32_dpp v149, v231, v149 quad_perm:[3,3,3,3] row_mask:0xf bank_mask:0xf
  v_cvt_pk_bf16_f32 v114, 0, v114
  v_cvt_pk_bf16_f32 v115, 0, v115
  v_add_f32 v233, v148, v149
  v_pk_mul_f32 v[112:113], v[112:113], v[200:201]
  v_pk_mul_f32 v[114:115], v[114:115], v[202:203]
  v_cvt_pk_bf16_f32 v222, v112, v113
  v_cvt_pk_bf16_f32 v223, v114, v115
  s_waitcnt vmcnt(14)
  s_cbranch_vccnz L_kw0_14
  s_waitcnt vmcnt(10)
L_kw0_14:
  buffer_load_dwordx4 v[32:35], v94, s[8:11], s60 offen offset:2816 nt
  v_mfma_f32_16x16x32_bf16 v[228:231], v[220:223], v[172:175], 0
  v_pk_fma_f32 v[112:113], v[60:61], s[92:93], v[216:217] neg_lo:[0,0,1] neg_hi:[0,0,1]
  v_pk_fma_f32 v[114:115], v[62:63], s[92:93], v[218:219] neg_lo:[0,0,1] neg_hi:[0,0,1]
  s_cmp_lt_u32 s64, s99
  s_cbranch_scc1 L_k_known0
L_k_spin0:
  v_mov_b32 v148, 61696
  ds_read_b32 v148, v148
  s_waitcnt lgkmcnt(0)
  v_readfirstlane_b32 s96, v148
  s_nop 1
  s_cmp_eq_u32 s96, 0
  s_cbranch_scc1 L_k_spin0
  s_mov_b32 s99, -1
  s_bitcmp1_b32 s96, 6
  s_cselect_b32 s97, 255, s97
L_k_known0:
  s_andn2_b32 s70, s64, 1
  s_or_b32 s70, s70, s4
  s_lshr_b32 s71, s64, 5
  s_lshr_b32 s85, s96, s71
  s_cmp_lt_u32 s64, s97
  s_cselect_b32 s70, s70, s64
  s_cselect_b32 s85, s64, s85
  s_and_b32 s85, s85, 1
  s_mul_i32 s71, s71, 4064
  s_add_u32 s70, s70, s71
  s_add_u32 s70, s70, s5
  s_mul_hi_u32 s84, s70, s90
  s_lshr_b32 s84, s84, 1
  s_mul_i32 s71, s84, 3
  s_sub_u32 s70, s70, s71
  s_lshl3_add_u32 s85, s70, s85
  s_mul_i32 s61, s84, 196608
  s_lshr_b32 s89, s84, 4
  s_lshl_b32 s70, s85, 5
  v_add_u32 v100, s70, v234
  v_mul_u32_u24 v100, 21846, v100
  v_lshrrev_b32 v100, 16, v100
  v_add_u32 v148, s85, v235
  v_lshrrev_b32 v149, v148, s91
  v_and_b32 v149, 1, v149
  v_cmp_eq_u32 s[54:55], 1, v149
  s_nop 1
  s_and_b64 s[52:53], s[54:55], s[56:57]
  s_andn2_b64 s[54:55], s[54:55], s[56:57]
  v_mul_u32_u24 v148, 43, v148
  v_lshrrev_b32 v148, 8, v148
  v_mul_u32_u24 v148, 384, v148
  v_add_u32 v238, v148, v237
  s_cmp_eq_u32 s89, s88
  s_cbranch_scc1 L_k_sameq0
  s_mul_i32 s70, s89, 1536
  buffer_load_dwordx2 v[178:179], v239, s[36:39], s70 offen offset:0
  buffer_load_dwordx2 v[180:181], v239, s[36:39], s70 offen offset:128
  buffer_load_dwordx2 v[182:183], v239, s[36:39], s70 offen offset:256
  s_mov_b32 s88, s89
L_k_sameq0:
  s_mul_i32 s62, s84, 1536
  buffer_load_dwordx2 v[184:185], v238, s[20:23], s62 offen offset:0
  buffer_load_dwordx2 v[190:191], v238, s[24:27], s62 offen offset:0
  buffer_load_dwordx2 v[186:187], v238, s[20:23], s62 offen offset:128
  buffer_load_dwordx2 v[192:193], v238, s[24:27], s62 offen offset:128
  buffer_load_dwordx2 v[188:189], v238, s[20:23], s62 offen offset:256
  buffer_load_dwordx2 v[194:195], v238, s[24:27], s62 offen offset:256
  v_cvt_pk_bf16_f32 v112, 0, v112
  v_cvt_pk_bf16_f32 v232, 0, v232
  v_cvt_pk_bf16_f32 v113, 0, v113
  v_cvt_pk_bf16_f32 v233, 0, v233
  v_cvt_pk_bf16_f32 v114, 0, v114
  v_pk_mul_f32 v[232:233], v[232:233], s[68:69]
  v_cvt_pk_bf16_f32 v115, 0, v115
  v_cvt_pk_bf16_f32 v125, v232, v233
  v_pk_mul_f32 v[112:113], v[112:113], v[204:205]
  v_pk_mul_f32 v[114:115], v[114:115], v[206:207]
  v_cvt_pk_bf16_f32 v224, v112, v113
  v_cvt_pk_bf16_f32 v225, v114, v115
  s_waitcnt vmcnt(20)
  s_cbranch_vccnz L_kw0_15
  s_waitcnt vmcnt(16)
L_kw0_15:
  buffer_load_dwordx4 v[36:39], v95, s[8:11], s60 offen offset:0 nt
  v_mfma_f32_16x16x16_bf16 v[228:231], v[224:225], v[176:177], v[228:231]
  v_pk_fma_f32 v[112:113], v[64:65], s[92:93], v[208:209] neg_lo:[0,0,1] neg_hi:[0,0,1]
  v_pk_fma_f32 v[114:115], v[66:67], s[92:93], v[210:211] neg_lo:[0,0,1] neg_hi:[0,0,1]
  v_cvt_pk_bf16_f32 v112, 0, v112
  v_cvt_pk_bf16_f32 v113, 0, v113
  v_cvt_pk_bf16_f32 v114, 0, v114
  v_cvt_pk_bf16_f32 v115, 0, v115
  v_pk_mul_f32 v[112:113], v[112:113], v[196:197]
  v_pk_mul_f32 v[114:115], v[114:115], v[198:199]
  v_cvt_pk_bf16_f32 v220, v112, v113
  v_cvt_pk_bf16_f32 v221, v114, v115
  s_waitcnt vmcnt(20)
  s_cbranch_vccnz L_kw0_16
  s_waitcnt vmcnt(16)
L_kw0_16:
  buffer_load_dwordx4 v[40:43], v95, s[8:11], s60 offen offset:256 nt
  v_pk_fma_f32 v[112:113], v[68:69], s[92:93], v[212:213] neg_lo:[0,0,1] neg_hi:[0,0,1]
  v_pk_fma_f32 v[114:115], v[70:71], s[92:93], v[214:215] neg_lo:[0,0,1] neg_hi:[0,0,1]
  v_mov_b32_dpp v148, v228 quad_perm:[0,0,0,0] row_mask:0xf bank_mask:0xf
  v_mov_b32_dpp v149, v230 quad_perm:[2,2,2,2] row_mask:0xf bank_mask:0xf
  v_cvt_pk_bf16_f32 v112, 0, v112
  v_cvt_pk_bf16_f32 v113, 0, v113
  v_add_f32_dpp v148, v229, v148 quad_perm:[1,1,1,1] row_mask:0xf bank_mask:0xf
  v_add_f32_dpp v149, v231, v149 quad_perm:[3,3,3,3] row_mask:0xf bank_mask:0xf
  v_cvt_pk_bf16_f32 v114, 0, v114
  v_cvt_pk_bf16_f32 v115, 0, v115
  v_add_f32 v232, v148, v149
  v_pk_mul_f32 v[112:113], v[112:113], v[200:201]
  v_pk_mul_f32 v[114:115], v[114:115], v[202:203]
  v_cvt_pk_bf16_f32 v222, v112, v113
  v_cvt_pk_bf16_f32 v223, v114, v115
  s_waitcnt vmcnt(20)
  s_cbranch_vccnz L_kw0_17
  s_waitcnt vmcnt(16)
L_kw0_17:
  buffer_load_dwordx4 v[44:47], v95, s[8:11], s60 offen offset:512 nt
  v_mfma_f32_16x16x32_bf16 v[228:231], v[220:223], v[172:175], 0
  v_pk_fma_f32 v[112:113], v[72:73], s[92:93], v[216:217] neg_lo:[0,0,1] neg_hi:[0,0,1]
  v_pk_fma_f32 v[114:115], v[74:75], s[92:93], v[218:219] neg_lo:[0,0,1] neg_hi:[0,0,1]
  v_cvt_pk_bf16_f32 v112, 0, v112
  v_cvt_pk_bf16_f32 v113, 0, v113
  v_cvt_pk_bf16_f32 v114, 0, v114
  v_cvt_pk_bf16_f32 v115, 0, v115
  v_pk_mul_f32 v[112:113], v[112:113], v[204:205]
  v_pk_mul_f32 v[114:115], v[114:115], v[206:207]
  v_cvt_pk_bf16_f32 v224, v112, v113
  v_cvt_pk_bf16_f32 v225, v114, v115
  v_mad_u32_u24 v92, v100, s63, v236
  v_add_u32 v93, 768, v92
  v_add_u32 v94, 4608, v92
  v_add_u32 v95, 7680, v92
  v_cndmask_b32 v92, v92, v108, s[52:53]
  v_cndmask_b32 v95, v95, v108, s[54:55]
  s_waitcnt vmcnt(20)
  s_cbranch_vccnz L_kw0_18
  s_waitcnt vmcnt(16)
L_kw0_18:
  buffer_load_dwordx4 v[48:51], v92, s[16:19], s61 offen offset:0 nt
  v_mfma_f32_16x16x16_bf16 v[228:231], v[224:225], v[176:177], v[228:231]
  v_pk_fma_f32 v[112:113], v[76:77], s[92:93], v[208:209] neg_lo:[0,0,1] neg_hi:[0,0,1]
  v_pk_fma_f32 v[114:115], v[78:79], s[92:93], v[210:211] neg_lo:[0,0,1] neg_hi:[0,0,1]
  v_cvt_pk_bf16_f32 v112, 0, v112
  v_cvt_pk_bf16_f32 v113, 0, v113
  v_cvt_pk_bf16_f32 v114, 0, v114
  v_cvt_pk_bf16_f32 v115, 0, v115
  v_pk_mul_f32 v[112:113], v[112:113], v[196:197]
  v_pk_mul_f32 v[114:115], v[114:115], v[198:199]
  v_cvt_pk_bf16_f32 v220, v112, v113
  v_cvt_pk_bf16_f32 v221, v114, v115
  s_waitcnt vmcnt(20)
  s_cbranch_vccnz L_kw0_19
  s_waitcnt vmcnt(16)
L_kw0_19:
  buffer_load_dwordx4 v[52:55], v92, s[16:19], s61 offen offset:256 nt
  v_pk_fma_f32 v[112:113], v[80:81], s[92:93], v[212:213] neg_lo:[0,0,1] neg_hi:[0,0,1]
  v_pk_fma_f32 v[114:115], v[82:83], s[92:93], v[214:215] neg_lo:[0,0,1] neg_hi:[0,0,1]
  v_mov_b32_dpp v148, v228 quad_perm:[0,0,0,0] row_mask:0xf bank_mask:0xf
  v_mov_b32_dpp v149, v230 quad_perm:[2,2,2,2] row_mask:0xf bank_mask:0xf
  v_cvt_pk_bf16_f32 v112, 0, v112
  v_cvt_pk_bf16_f32 v113, 0, v113
  v_add_f32_dpp v148, v229, v148 quad_perm:[1,1,1,1] row_mask:0xf bank_mask:0xf
  v_add_f32_dpp v149, v231, v149 quad_perm:[3,3,3,3] row_mask:0xf bank_mask:0xf
  v_cvt_pk_bf16_f32 v114, 0, v114
  v_cvt_pk_bf16_f32 v115, 0, v115
  v_add_f32 v233, v148, v149
  v_pk_mul_f32 v[112:113], v[112:113], v[200:201]
  v_pk_mul_f32 v[114:115], v[114:115], v[202:203]
  v_cvt_pk_bf16_f32 v222, v112, v113
  v_cvt_pk_bf16_f32 v223, v114, v115
  s_waitcnt vmcnt(20)
  s_cbranch_vccnz L_kw0_20
  s_waitcnt vmcnt(16)
L_kw0_20:
  buffer_load_dwordx4 v[56:59], v92, s[16:19], s61 offen offset:512 nt
  v_mfma_f32_16x16x32_bf16 v[228:231], v[220:223], v[172:175], 0
  v_pk_fma_f32 v[112:113], v[84:85], s[92:93], v[216:217] neg_lo:[0,0,1] neg_hi:[0,0,1]
  v_pk_fma_f32 v[114:115], v[86:87], s[92:93], v[218:219] neg_lo:[0,0,1] neg_hi:[0,0,1]
  v_cvt_pk_bf16_f32 v112, 0, v112
  v_cvt_pk_bf16_f32 v232, 0, v232
  v_cvt_pk_bf16_f32 v113, 0, v113
  v_cvt_pk_bf16_f32 v233, 0, v233
  v_cvt_pk_bf16_f32 v114, 0, v114
  v_pk_mul_f32 v[232:233], v[232:233], s[68:69]
  v_cvt_pk_bf16_f32 v115, 0, v115
  v_cvt_pk_bf16_f32 v126, v232, v233
  v_pk_mul_f32 v[112:113], v[112:113], v[204:205]
  v_pk_mul_f32 v[114:115], v[114:115], v[206:207]
  v_cvt_pk_bf16_f32 v224, v112, v113
  v_cvt_pk_bf16_f32 v225, v114, v115
  s_waitcnt vmcnt(20)
  s_cbranch_vccnz L_kw0_21
  s_waitcnt vmcnt(16)
L_kw0_21:
  buffer_load_dwordx4 v[60:63], v93, s[16:19], s61 offen offset:0 nt
  v_mfma_f32_16x16x16_bf16 v[228:231], v[224:225], v[176:177], v[228:231]
  v_pk_fma_f32 v[112:113], v[88:89], s[92:93], v[208:209] neg_lo:[0,0,1] neg_hi:[0,0,1]
  v_pk_fma_f32 v[114:115], v[90:91], s[92:93], v[210:211] neg_lo:[0,0,1] neg_hi:[0,0,1]
  v_cvt_pk_bf16_f32 v112, 0, v112
  v_cvt_pk_bf16_f32 v113, 0, v113
  v_cvt_pk_bf16_f32 v114, 0, v114
  v_cvt_pk_bf16_f32 v115, 0, v115
  v_pk_mul_f32 v[112:113], v[112:113], v[196:197]
  v_pk_mul_f32 v[114:115], v[114:115], v[198:199]
  v_cvt_pk_bf16_f32 v220, v112, v113
  v_cvt_pk_bf16_f32 v221, v114, v115
  s_waitcnt vmcnt(20)
  s_cbranch_vccnz L_kw0_22
  s_waitcnt vmcnt(16)
L_kw0_22:
  buffer_load_dwordx4 v[64:67], v93, s[16:19], s61 offen offset:256 nt
  v_pk_fma_f32 v[112:113], v[4:5], s[92:93], v[212:213] neg_lo:[0,0,1] neg_hi:[0,0,1]
  v_pk_fma_f32 v[114:115], v[6:7], s[92:93], v[214:215] neg_lo:[0,0,1] neg_hi:[0,0,1]
  v_mov_b32_dpp v148, v228 quad_perm:[0,0,0,0] row_mask:0xf bank_mask:0xf
  v_mov_b32_dpp v149, v230 quad_perm:[2,2,2,2] row_mask:0xf bank_mask:0xf
  v_cvt_pk_bf16_f32 v112, 0, v112
  v_cvt_pk_bf16_f32 v113, 0, v113
  v_add_f32_dpp v148, v229, v148 quad_perm:[1,1,1,1] row_mask:0xf bank_mask:0xf
  v_add_f32_dpp v149, v231, v149 quad_perm:[3,3,3,3] row_mask:0xf bank_mask:0xf
  v_cvt_pk_bf16_f32 v114, 0, v114
  v_cvt_pk_bf16_f32 v115, 0, v115
  v_add_f32 v232, v148, v149
  v_pk_mul_f32 v[112:113], v[112:113], v[200:201]
  v_pk_mul_f32 v[114:115], v[114:115], v[202:203]
  v_cvt_pk_bf16_f32 v222, v112, v113
  v_cvt_pk_bf16_f32 v223, v114, v115
  s_waitcnt vmcnt(20)
  s_cbranch_vccnz L_kw0_23
  s_waitcnt vmcnt(16)
L_kw0_23:
  buffer_load_dwordx4 v[68:71], v93, s[16:19], s61 offen offset:512 nt
  v_mfma_f32_16x16x32_bf16 v[228:231], v[220:223], v[172:175], 0
  v_pk_fma_f32 v[112:113], v[8:9], s[92:93], v[216:217] neg_lo:[0,0,1] neg_hi:[0,0,1]
  v_pk_fma_f32 v[114:115], v[10:11], s[92:93], v[218:219] neg_lo:[0,0,1] neg_hi:[0,0,1]
  v_cvt_pk_bf16_f32 v112, 0, v112
  v_cvt_pk_bf16_f32 v113, 0, v113
  v_cvt_pk_bf16_f32 v114, 0, v114
  v_cvt_pk_bf16_f32 v115, 0, v115
  v_pk_mul_f32 v[112:113], v[112:113], v[204:205]
  v_pk_mul_f32 v[114:115], v[114:115], v[206:207]
  v_cvt_pk_bf16_f32 v224, v112, v113
  v_cvt_pk_bf16_f32 v225, v114, v115
  s_waitcnt vmcnt(20)
  s_cbranch_vccnz L_kw0_24
  s_waitcnt vmcnt(16)
L_kw0_24:
  buffer_load_dwordx4 v[72:75], v93, s[16:19], s61 offen offset:768 nt
  v_mfma_f32_16x16x16_bf16 v[228:231], v[224:225], v[176:177], v[228:231]
  v_pk_fma_f32 v[112:113], v[12:13], s[92:93], v[208:209] neg_lo:[0,0,1] neg_hi:[0,0,1]
  v_pk_fma_f32 v[114:115], v[14:15], s[92:93], v[210:211] neg_lo:[0,0,1] neg_hi:[0,0,1]
  v_cvt_pk_bf16_f32 v112, 0, v112
  v_cvt_pk_bf16_f32 v113, 0, v113
  v_cvt_pk_bf16_f32 v114, 0, v114
  v_cvt_pk_bf16_f32 v115, 0, v115
  v_pk_mul_f32 v[112:113], v[112:113], v[196:197]
  v_pk_mul_f32 v[114:115], v[114:115], v[198:199]
  v_cvt_pk_bf16_f32 v220, v112, v113
  v_cvt_pk_bf16_f32 v221, v114, v115
  s_waitcnt vmcnt(20)
  s_cbranch_vccnz L_kw0_25
  s_waitcnt vmcnt(16)
L_kw0_25:
  buffer_load_dwordx4 v[76:79], v93, s[16:19], s61 offen offset:1024 nt
  v_pk_fma_f32 v[112:113], v[16:17], s[92:93], v[212:213] neg_lo:[0,0,1] neg_hi:[0,0,1]
  v_pk_fma_f32 v[114:115], v[18:19], s[92:93], v[214:215] neg_lo:[0,0,1] neg_hi:[0,0,1]
  v_mov_b32_dpp v148, v228 quad_perm:[0,0,0,0] row_mask:0xf bank_mask:0xf
  v_mov_b32_dpp v149, v230 quad_perm:[2,2,2,2] row_mask:0xf bank_mask:0xf
  v_cvt_pk_bf16_f32 v112, 0, v112
  v_cvt_pk_bf16_f32 v113, 0, v113
  v_add_f32_dpp v148, v229, v148 quad_perm:[1,1,1,1] row_mask:0xf bank_mask:0xf
  v_add_f32_dpp v149, v231, v149 quad_perm:[3,3,3,3] row_mask:0xf bank_mask:0xf
  v_cvt_pk_bf16_f32 v114, 0, v114
  v_cvt_pk_bf16_f32 v115, 0, v115
  v_add_f32 v233, v148, v149
  v_pk_mul_f32 v[112:113], v[112:113], v[200:201]
  v_pk_mul_f32 v[114:115], v[114:115], v[202:203]
  v_cvt_pk_bf16_f32 v222, v112, v113
  v_cvt_pk_bf16_f32 v223, v114, v115
  s_waitcnt vmcnt(20)
  s_cbranch_vccnz L_kw0_26
  s_waitcnt vmcnt(10)
L_kw0_26:
  buffer_load_dwordx4 v[80:83], v93, s[16:19], s61 offen offset:1280 nt
  v_mfma_f32_16x16x32_bf16 v[228:231], v[220:223], v[172:175], 0
  v_pk_fma_f32 v[112:113], v[20:21], s[92:93], v[216:217] neg_lo:[0,0,1] neg_hi:[0,0,1]
  v_pk_fma_f32 v[114:115], v[22:23], s[92:93], v[218:219] neg_lo:[0,0,1] neg_hi:[0,0,1]
  v_cvt_pk_bf16_f32 v112, 0, v112
  v_cvt_pk_bf16_f32 v232, 0, v232
  v_cvt_pk_bf16_f32 v113, 0, v113
  v_cvt_pk_bf16_f32 v233, 0, v233
  v_cvt_pk_bf16_f32 v114, 0, v114
  v_pk_mul_f32 v[232:233], v[232:233], s[68:69]
  v_cvt_pk_bf16_f32 v115, 0, v115
  v_cvt_pk_bf16_f32 v127, v232, v233
  v_pk_mul_f32 v[112:113], v[112:113], v[204:205]
  v_pk_mul_f32 v[114:115], v[114:115], v[206:207]
  v_cvt_pk_bf16_f32 v224, v112, v113
  v_cvt_pk_bf16_f32 v225, v114, v115
  s_waitcnt vmcnt(20)
  s_cbranch_vccnz L_kw0_27
  s_waitcnt vmcnt(10)
L_kw0_27:
  buffer_load_dwordx4 v[84:87], v93, s[16:19], s61 offen offset:1536 nt
  v_mfma_f32_16x16x16_bf16 v[228:231], v[224:225], v[176:177], v[228:231]
  v_pk_fma_f32 v[112:113], v[24:25], s[92:93], v[208:209] neg_lo:[0,0,1] neg_hi:[0,0,1]
  v_pk_fma_f32 v[114:115], v[26:27], s[92:93], v[210:211] neg_lo:[0,0,1] neg_hi:[0,0,1]
  v_cvt_pk_bf16_f32 v112, 0, v112
  v_cvt_pk_bf16_f32 v113, 0, v113
  v_cvt_pk_bf16_f32 v114, 0, v114
  v_cvt_pk_bf16_f32 v115, 0, v115
  v_pk_mul_f32 v[112:113], v[112:113], v[196:197]
  v_pk_mul_f32 v[114:115], v[114:115], v[198:199]
  v_cvt_pk_bf16_f32 v220, v112, v113
  v_cvt_pk_bf16_f32 v221, v114, v115
  s_waitcnt vmcnt(20)
  s_cbranch_vccnz L_kw0_28
  s_waitcnt vmcnt(10)
L_kw0_28:
  buffer_load_dwordx4 v[88:91], v93, s[16:19], s61 offen offset:1792 nt
  v_pk_fma_f32 v[112:113], v[28:29], s[92:93], v[212:213] neg_lo:[0,0,1] neg_hi:[0,0,1]
  v_pk_fma_f32 v[114:115], v[30:31], s[92:93], v[214:215] neg_lo:[0,0,1] neg_hi:[0,0,1]
  v_mov_b32_dpp v148, v228 quad_perm:[0,0,0,0] row_mask:0xf bank_mask:0xf
  v_mov_b32_dpp v149, v230 quad_perm:[2,2,2,2] row_mask:0xf bank_mask:0xf
  v_cvt_pk_bf16_f32 v112, 0, v112
  v_cvt_pk_bf16_f32 v113, 0, v113
  v_add_f32_dpp v148, v229, v148 quad_perm:[1,1,1,1] row_mask:0xf bank_mask:0xf
  v_add_f32_dpp v149, v231, v149 quad_perm:[3,3,3,3] row_mask:0xf bank_mask:0xf
  v_cvt_pk_bf16_f32 v114, 0, v114
  v_cvt_pk_bf16_f32 v115, 0, v115
  v_add_f32 v232, v148, v149
  v_pk_mul_f32 v[112:113], v[112:113], v[200:201]
  v_pk_mul_f32 v[114:115], v[114:115], v[202:203]
  v_cvt_pk_bf16_f32 v222, v112, v113
  v_cvt_pk_bf16_f32 v223, v114, v115
  s_waitcnt vmcnt(20)
  s_cbranch_vccnz L_kw0_29
  s_waitcnt vmcnt(10)
L_kw0_29:
  buffer_load_dwordx4 v[4:7], v93, s[16:19], s61 offen offset:2048 nt
  v_mfma_f32_16x16x32_bf16 v[228:231], v[220:223], v[172:175], 0
  v_pk_fma_f32 v[112:113], v[32:33], s[92:93], v[216:217] neg_lo:[0,0,1] neg_hi:[0,0,1]
  v_pk_fma_f32 v[114:115], v[34:35], s[92:93], v[218:219] neg_lo:[0,0,1] neg_hi:[0,0,1]
  v_cvt_pk_bf16_f32 v112, 0, v112
  v_cvt_pk_bf16_f32 v113, 0, v113
  v_cvt_pk_bf16_f32 v114, 0, v114
  v_cvt_pk_bf16_f32 v115, 0, v115
  v_pk_mul_f32 v[112:113], v[112:113], v[204:205]
  v_pk_mul_f32 v[114:115], v[114:115], v[206:207]
  v_cvt_pk_bf16_f32 v224, v112, v113
  v_cvt_pk_bf16_f32 v225, v114, v115
  s_waitcnt vmcnt(14)
  s_cbranch_vccnz L_kw0_30
  s_waitcnt vmcnt(10)
L_kw0_30:
  buffer_load_dwordx4 v[8:11], v93, s[16:19], s61 offen offset:2304 nt
  v_mfma_f32_16x16x16_bf16 v[228:231], v[224:225], v[176:177], v[228:231]
  v_pk_fma_f32 v[112:113], v[36:37], s[92:93], v[208:209] neg_lo:[0,0,1] neg_hi:[0,0,1]
  v_pk_fma_f32 v[114:115], v[38:39], s[92:93], v[210:211] neg_lo:[0,0,1] neg_hi:[0,0,1]
  v_cvt_pk_bf16_f32 v112, 0, v112
  v_cvt_pk_bf16_f32 v113, 0, v113
  v_cvt_pk_bf16_f32 v114, 0, v114
  v_cvt_pk_bf16_f32 v115, 0, v115
  v_pk_mul_f32 v[112:113], v[112:113], v[196:197]
  v_pk_mul_f32 v[114:115], v[114:115], v[198:199]
  v_cvt_pk_bf16_f32 v220, v112, v113
  v_cvt_pk_bf16_f32 v221, v114, v115
  s_waitcnt vmcnt(14)
  s_cbranch_vccnz L_kw0_31
  s_waitcnt vmcnt(10)
L_kw0_31:
  buffer_load_dwordx4 v[12:15], v93, s[16:19], s61 offen offset:2560 nt
  v_pk_fma_f32 v[112:113], v[40:41], s[92:93], v[212:213] neg_lo:[0,0,1] neg_hi:[0,0,1]
  v_pk_fma_f32 v[114:115], v[42:43], s[92:93], v[214:215] neg_lo:[0,0,1] neg_hi:[0,0,1]
  v_mov_b32_dpp v148, v228 quad_perm:[0,0,0,0] row_mask:0xf bank_mask:0xf
  v_mov_b32_dpp v149, v230 quad_perm:[2,2,2,2] row_mask:0xf bank_mask:0xf
  v_cvt_pk_bf16_f32 v112, 0, v112
  v_cvt_pk_bf16_f32 v113, 0, v113
  v_add_f32_dpp v148, v229, v148 quad_perm:[1,1,1,1] row_mask:0xf bank_mask:0xf
  v_add_f32_dpp v149, v231, v149 quad_perm:[3,3,3,3] row_mask:0xf bank_mask:0xf
  v_cvt_pk_bf16_f32 v114, 0, v114
  v_cvt_pk_bf16_f32 v115, 0, v115
  v_add_f32 v233, v148, v149
  v_pk_mul_f32 v[112:113], v[112:113], v[200:201]
  v_pk_mul_f32 v[114:115], v[114:115], v[202:203]
  v_cvt_pk_bf16_f32 v222, v112, v113
  v_cvt_pk_bf16_f32 v223, v114, v115
  s_waitcnt vmcnt(14)
  s_cbranch_vccnz L_kw0_32
  s_waitcnt vmcnt(10)
L_kw0_32:
  buffer_load_dwordx4 v[16:19], v93, s[16:19], s61 offen offset:2816 nt
  v_mfma_f32_16x16x32_bf16 v[228:231], v[220:223], v[172:175], 0
  v_pk_fma_f32 v[112:113], v[44:45], s[92:93], v[216:217] neg_lo:[0,0,1] neg_hi:[0,0,1]
  v_pk_fma_f32 v[114:115], v[46:47], s[92:93], v[218:219] neg_lo:[0,0,1] neg_hi:[0,0,1]
  v_cvt_pk_bf16_f32 v112, 0, v112
  v_cvt_pk_bf16_f32 v232, 0, v232
  v_cvt_pk_bf16_f32 v113, 0, v113
  v_cvt_pk_bf16_f32 v233, 0, v233
  v_cvt_pk_bf16_f32 v114, 0, v114
  v_pk_mul_f32 v[232:233], v[232:233], s[68:69]
  v_cvt_pk_bf16_f32 v115, 0, v115
  v_cvt_pk_bf16_f32 v128, v232, v233
  v_pk_mul_f32 v[112:113], v[112:113], v[204:205]
  v_pk_mul_f32 v[114:115], v[114:115], v[206:207]
  v_cvt_pk_bf16_f32 v224, v112, v113
  v_cvt_pk_bf16_f32 v225, v114, v115
  s_mov_b32 s60, s61
  v_mov_b32 v150, s64
  v_mfma_f32_16x16x16_bf16 v[228:231], v[224:225], v[176:177], v[228:231]
  ds_write_b128 v102, v[124:127]
  v_add_u32 v102, 768, v102
  s_nop 5
  v_mov_b32_dpp v148, v228 quad_perm:[0,0,0,0] row_mask:0xf bank_mask:0xf
  v_mov_b32_dpp v149, v230 quad_perm:[2,2,2,2] row_mask:0xf bank_mask:0xf
  s_nop 0
  v_add_f32_dpp v148, v229, v148 quad_perm:[1,1,1,1] row_mask:0xf bank_mask:0xf
  v_add_f32_dpp v149, v231, v149 quad_perm:[3,3,3,3] row_mask:0xf bank_mask:0xf
  v_add_f32 v232, v148, v149
  v_cndmask_b32 v232, v232, v240, s[50:51]
  v_cvt_pk_bf16_f32 v232, 0, v232
  v_cvt_pk_bf16_f32 v233, 0, v233
  v_pk_mul_f32 v[232:233], v[232:233], s[68:69]
  v_cvt_pk_bf16_f32 v129, v232, v233
  ds_write_b64 v103, v[128:129] offset:256
  ds_write_b32 v107, v150
  v_add_u32 v103, 768, v103
  v_add_u32 v148, s85, v97
  v_lshrrev_b32 v149, v148, s91
  v_and_b32 v149, 1, v149
  v_cmp_eq_u32 s[50:51], 1, v149
  s_nop 1
  s_and_b64 s[48:49], s[50:51], s[58:59]
  s_andn2_b64 s[50:51], s[50:51], s[58:59]
  s_add_u32 s64, s64, 2
  ds_read_b32 v110, v109
  s_waitcnt vmcnt(14)
  s_cbranch_vccnz L_kw1_0
  s_waitcnt vmcnt(10)
L_kw1_0:
  buffer_load_dwordx4 v[20:23], v93, s[8:11], s60 offen offset:3072 nt
  v_lshlrev_b32 v208, 16, v190
  v_and_b32 v209, s65, v190
  v_lshlrev_b32 v210, 16, v191
  v_and_b32 v211, s65, v191
  v_lshlrev_b32 v196, 16, v184
  v_and_b32 v197, s65, v184
  v_lshlrev_b32 v198, 16, v185
  v_and_b32 v199, s65, v185
  v_pk_mul_f32 v[208:209], v[208:209], s[94:95]
  v_mov_b32 v172, v178
  v_pk_mul_f32 v[210:211], v[210:211], s[94:95]
  v_mov_b32 v173, v179
  v_pk_fma_f32 v[112:113], v[48:49], s[92:93], v[208:209] neg_lo:[0,0,1] neg_hi:[0,0,1]
  v_pk_fma_f32 v[114:115], v[50:51], s[92:93], v[210:211] neg_lo:[0,0,1] neg_hi:[0,0,1]
  v_cvt_pk_bf16_f32 v112, 0, v112
  v_cvt_pk_bf16_f32 v113, 0, v113
  v_cvt_pk_bf16_f32 v114, 0, v114
  v_cvt_pk_bf16_f32 v115, 0, v115
  v_pk_mul_f32 v[112:113], v[112:113], v[196:197]
  v_pk_mul_f32 v[114:115], v[114:115], v[198:199]
  v_cvt_pk_bf16_f32 v220, v112, v113
  v_cvt_pk_bf16_f32 v221, v114, v115
  s_waitcnt lgkmcnt(0)
  s_sub_u32 s70, s64, 2
  v_cmp_lt_u32 vcc, s70, v110
  s_waitcnt vmcnt(14)
  s_cbranch_vccnz L_kw1_1
  s_waitcnt vmcnt(10)
L_kw1_1:
  buffer_load_dwordx4 v[24:27], v93, s[8:11], s60 offen offset:3328 nt
  v_lshlrev_b32 v212, 16, v192
  v_and_b32 v213, s65, v192
  v_lshlrev_b32 v214, 16, v193
  v_and_b32 v215, s65, v193
  v_lshlrev_b32 v200, 16, v186
  v_and_b32 v201, s65, v186
  v_lshlrev_b32 v202, 16, v187
  v_and_b32 v203, s65, v187
  v_pk_mul_f32 v[212:213], v[212:213], s[94:95]
  v_mov_b32 v174, v180
  v_pk_mul_f32 v[214:215], v[214:215], s[94:95]
  v_mov_b32 v175, v181
  v_pk_fma_f32 v[112:113], v[52:53], s[92:93], v[212:213] neg_lo:[0,0,1] neg_hi:[0,0,1]
  v_pk_fma_f32 v[114:115], v[54:55], s[92:93], v[214:215] neg_lo:[0,0,1] neg_hi:[0,0,1]
  v_cvt_pk_bf16_f32 v112, 0, v112
  v_cvt_pk_bf16_f32 v113, 0, v113
  v_cvt_pk_bf16_f32 v114, 0, v114
  v_cvt_pk_bf16_f32 v115, 0, v115
  v_pk_mul_f32 v[112:113], v[112:113], v[200:201]
  v_pk_mul_f32 v[114:115], v[114:115], v[202:203]
  v_cvt_pk_bf16_f32 v222, v112, v113
  v_cvt_pk_bf16_f32 v223, v114, v115
  s_waitcnt vmcnt(14)
  s_cbranch_vccnz L_kw1_2
  s_waitcnt vmcnt(10)
L_kw1_2:
  buffer_load_dwordx4 v[28:31], v93, s[8:11], s60 offen offset:3584 nt
  v_mfma_f32_16x16x32_bf16 v[228:231], v[220:223], v[172:175], 0
  v_lshlrev_b32 v216, 16, v194
  v_and_b32 v217, s65, v194
  v_lshlrev_b32 v218, 16, v195
  v_and_b32 v219, s65, v195
  v_lshlrev_b32 v204, 16, v188
  v_and_b32 v205, s65, v188
  v_lshlrev_b32 v206, 16, v189
  v_and_b32 v207, s65, v189
  v_pk_mul_f32 v[216:217], v[216:217], s[94:95]
  v_mov_b32 v176, v182
  v_pk_mul_f32 v[218:219], v[218:219], s[94:95]
  v_mov_b32 v177, v183
  v_pk_fma_f32 v[112:113], v[56:57], s[92:93], v[216:217] neg_lo:[0,0,1] neg_hi:[0,0,1]
  v_pk_fma_f32 v[114:115], v[58:59], s[92:93], v[218:219] neg_lo:[0,0,1] neg_hi:[0,0,1]
  v_cvt_pk_bf16_f32 v112, 0, v112
  v_cvt_pk_bf16_f32 v113, 0, v113
  v_cvt_pk_bf16_f32 v114, 0, v114
  v_cvt_pk_bf16_f32 v115, 0, v115
  v_pk_mul_f32 v[112:113], v[112:113], v[204:205]
  v_pk_mul_f32 v[114:115], v[114:115], v[206:207]
  v_cvt_pk_bf16_f32 v224, v112, v113
  v_cvt_pk_bf16_f32 v225, v114, v115
  s_waitcnt vmcnt(14)
  s_cbranch_vccnz L_kw1_3
  s_waitcnt vmcnt(10)
L_kw1_3:
  buffer_load_dwordx4 v[32:35], v94, s[8:11], s60 offen offset:0 nt
  v_mfma_f32_16x16x16_bf16 v[228:231], v[224:225], v[176:177], v[228:231]
  v_pk_fma_f32 v[112:113], v[60:61], s[92:93], v[208:209] neg_lo:[0,0,1] neg_hi:[0,0,1]
  v_pk_fma_f32 v[114:115], v[62:63], s[92:93], v[210:211] neg_lo:[0,0,1] neg_hi:[0,0,1]
  v_cvt_pk_bf16_f32 v112, 0, v112
  v_cvt_pk_bf16_f32 v113, 0, v113
  v_cvt_pk_bf16_f32 v114, 0, v114
  v_cvt_pk_bf16_f32 v115, 0, v115
  v_pk_mul_f32 v[112:113], v[112:113], v[196:197]
  v_pk_mul_f32 v[114:115], v[114:115], v[198:199]
  v_cvt_pk_bf16_f32 v220, v112, v113
  v_cvt_pk_bf16_f32 v221, v114, v115
  s_waitcnt vmcnt(14)
  s_cbranch_vccnz L_kw1_4
  s_waitcnt vmcnt(10)
L_kw1_4:
  buffer_load_dwordx4 v[36:39], v94, s[8:11], s60 offen offset:256 nt
  v_pk_fma_f32 v[112:113], v[64:65], s[92:93], v[212:213] neg_lo:[0,0,1] neg_hi:[0,0,1]
  v_pk_fma_f32 v[114:115], v[66:67], s[92:93], v[214:215] neg_lo:[0,0,1] neg_hi:[0,0,1]
  v_mov_b32_dpp v148, v228 quad_perm:[0,0,0,0] row_mask:0xf bank_mask:0xf
  v_mov_b32_dpp v149, v230 quad_perm:[2,2,2,2] row_mask:0xf bank_mask:0xf
  v_cvt_pk_bf16_f32 v112, 0, v112
  v_cvt_pk_bf16_f32 v113, 0, v113
  v_add_f32_dpp v148, v229, v148 quad_perm:[1,1,1,1] row_mask:0xf bank_mask:0xf
  v_add_f32_dpp v149, v231, v149 quad_perm:[3,3,3,3] row_mask:0xf bank_mask:0xf
  v_cvt_pk_bf16_f32 v114, 0, v114
  v_cvt_pk_bf16_f32 v115, 0, v115
  v_add_f32 v232, v148, v149
  v_pk_mul_f32 v[112:113], v[112:113], v[200:201]
  v_pk_mul_f32 v[114:115], v[114:115], v[202:203]
  v_cvt_pk_bf16_f32 v222, v112, v113
  v_cvt_pk_bf16_f32 v223, v114, v115
  s_waitcnt vmcnt(14)
  s_cbranch_vccnz L_kw1_5
  s_waitcnt vmcnt(10)
L_kw1_5:
  buffer_load_dwordx4 v[40:43], v94, s[8:11], s60 offen offset:512 nt
  v_mfma_f32_16x16x32_bf16 v[228:231], v[220:223], v[172:175], 0
  v_pk_fma_f32 v[112:113], v[68:69], s[92:93], v[216:217] neg_lo:[0,0,1] neg_hi:[0,0,1]
  v_pk_fma_f32 v[114:115], v[70:71], s[92:93], v[218:219] neg_lo:[0,0,1] neg_hi:[0,0,1]
  v_cvt_pk_bf16_f32 v112, 0, v112
  v_cndmask_b32 v232, v232, v240, s[48:49]
  v_cvt_pk_bf16_f32 v113, 0, v113
  v_cvt_pk_bf16_f32 v114, 0, v114
  v_cvt_pk_bf16_f32 v115, 0, v115
  v_pk_mul_f32 v[112:113], v[112:113], v[204:205]
  v_pk_mul_f32 v[114:115], v[114:115], v[206:207]
  v_cvt_pk_bf16_f32 v224, v112, v113
  v_cvt_pk_bf16_f32 v225, v114, v115
  s_waitcnt vmcnt(14)
  s_cbranch_vccnz L_kw1_6
  s_waitcnt vmcnt(10)
L_kw1_6:
  buffer_load_dwordx4 v[44:47], v94, s[8:11], s60 offen offset:768 nt
  v_mfma_f32_16x16x16_bf16 v[228:231], v[224:225], v[176:177], v[228:231]
  v_pk_fma_f32 v[112:113], v[72:73], s[92:93], v[208:209] neg_lo:[0,0,1] neg_hi:[0,0,1]
  v_pk_fma_f32 v[114:115], v[74:75], s[92:93], v[210:211] neg_lo:[0,0,1] neg_hi:[0,0,1]
  v_cvt_pk_bf16_f32 v112, 0, v112
  v_cvt_pk_bf16_f32 v113, 0, v113
  v_cvt_pk_bf16_f32 v114, 0, v114
  v_cvt_pk_bf16_f32 v115, 0, v115
  v_pk_mul_f32 v[112:113], v[112:113], v[196:197]
  v_pk_mul_f32 v[114:115], v[114:115], v[198:199]
  v_cvt_pk_bf16_f32 v220, v112, v113
  v_cvt_pk_bf16_f32 v221, v114, v115
  s_waitcnt vmcnt(14)
  s_cbranch_vccnz L_kw1_7
  s_waitcnt vmcnt(10)
L_kw1_7:
  buffer_load_dwordx4 v[48:51], v94, s[8:11], s60 offen offset:1024 nt
  v_pk_fma_f32 v[112:113], v[76:77], s[92:93], v[212:213] neg_lo:[0,0,1] neg_hi:[0,0,1]
  v_pk_fma_f32 v[114:115], v[78:79], s[92:93], v[214:215] neg_lo:[0,0,1] neg_hi:[0,0,1]
  v_mov_b32_dpp v148, v228 quad_perm:[0,0,0,0] row_mask:0xf bank_mask:0xf
  v_mov_b32_dpp v149, v230 quad_perm:[2,2,2,2] row_mask:0xf bank_mask:0xf
  v_cvt_pk_bf16_f32 v112, 0, v112
  v_cvt_pk_bf16_f32 v113, 0, v113
  v_add_f32_dpp v148, v229, v148 quad_perm:[1,1,1,1] row_mask:0xf bank_mask:0xf
  v_add_f32_dpp v149, v231, v149 quad_perm:[3,3,3,3] row_mask:0xf bank_mask:0xf
  v_cvt_pk_bf16_f32 v114, 0, v114
  v_cvt_pk_bf16_f32 v115, 0, v115
  v_add_f32 v233, v148, v149
  v_pk_mul_f32 v[112:113], v[112:113], v[200:201]
  v_pk_mul_f32 v[114:115], v[114:115], v[202:203]
  v_cvt_pk_bf16_f32 v222, v112, v113
  v_cvt_pk_bf16_f32 v223, v114, v115
  s_waitcnt vmcnt(14)
  s_cbranch_vccnz L_kw1_8
  s_waitcnt vmcnt(10)
L_kw1_8:
  buffer_load_dwordx4 v[52:55], v94, s[8:11], s60 offen offset:1280 nt
  v_mfma_f32_16x16x32_bf16 v[228:231], v[220:223], v[172:175], 0
  v_pk_fma_f32 v[112:113], v[80:81], s[92:93], v[216:217] neg_lo:[0,0,1] neg_hi:[0,0,1]
  v_pk_fma_f32 v[114:115], v[82:83], s[92:93], v[218:219] neg_lo:[0,0,1] neg_hi:[0,0,1]
  v_cvt_pk_bf16_f32 v112, 0, v112
  v_cvt_pk_bf16_f32 v232, 0, v232
  v_cvt_pk_bf16_f32 v113, 0, v113
  v_cvt_pk_bf16_f32 v233, 0, v233
  v_cvt_pk_bf16_f32 v114, 0, v114
  v_pk_mul_f32 v[232:233], v[232:233], s[68:69]
  v_cvt_pk_bf16_f32 v115, 0, v115
  v_cvt_pk_bf16_f32 v124, v232, v233
  v_pk_mul_f32 v[112:113], v[112:113], v[204:205]
  v_pk_mul_f32 v[114:115], v[114:115], v[206:207]
  v_cvt_pk_bf16_f32 v224, v112, v113
  v_cvt_pk_bf16_f32 v225, v114, v115
  s_waitcnt vmcnt(14)
  s_cbranch_vccnz L_kw1_9
  s_waitcnt vmcnt(10)
L_kw1_9:
  buffer_load_dwordx4 v[56:59], v94, s[8:11], s60 offen offset:1536 nt
  v_mfma_f32_16x16x16_bf16 v[228:231], v[224:225], v[176:177], v[228:231]
  v_pk_fma_f32 v[112:113], v[84:85], s[92:93], v[208:209] neg_lo:[0,0,1] neg_hi:[0,0,1]
  v_pk_fma_f32 v[114:115], v[86:87], s[92:93], v[210:211] neg_lo:[0,0,1] neg_hi:[0,0,1]
  v_cvt_pk_bf16_f32 v112, 0, v112
  v_cvt_pk_bf16_f32 v113, 0, v113
  v_cvt_pk_bf16_f32 v114, 0, v114
  v_cvt_pk_bf16_f32 v115, 0, v115
  v_pk_mul_f32 v[112:113], v[112:113], v[196:197]
  v_pk_mul_f32 v[114:115], v[114:115], v[198:199]
  v_cvt_pk_bf16_f32 v220, v112, v113
  v_cvt_pk_bf16_f32 v221, v114, v115
  s_waitcnt vmcnt(14)
  s_cbranch_vccnz L_kw1_10
  s_waitcnt vmcnt(10)
L_kw1_10:
  buffer_load_dwordx4 v[60:63], v94, s[8:11], s60 offen offset:1792 nt
  v_pk_fma_f32 v[112:113], v[88:89], s[92:93], v[212:213] neg_lo:[0,0,1] neg_hi:[0,0,1]
  v_pk_fma_f32 v[114:115], v[90:91], s[92:93], v[214:215] neg_lo:[0,0,1] neg_hi:[0,0,1]
  v_mov_b32_dpp v148, v228 quad_perm:[0,0,0,0] row_mask:0xf bank_mask:0xf
  v_mov_b32_dpp v149, v230 quad_perm:[2,2,2,2] row_mask:0xf bank_mask:0xf
  v_cvt_pk_bf16_f32 v112, 0, v112
  v_cvt_pk_bf16_f32 v113, 0, v113
  v_add_f32_dpp v148, v229, v148 quad_perm:[1,1,1,1] row_mask:0xf bank_mask:0xf
  v_add_f32_dpp v149, v231, v149 quad_perm:[3,3,3,3] row_mask:0xf bank_mask:0xf
  v_cvt_pk_bf16_f32 v114, 0, v114
  v_cvt_pk_bf16_f32 v115, 0, v115
  v_add_f32 v232, v148, v149
  v_pk_mul_f32 v[112:113], v[112:113], v[200:201]
  v_pk_mul_f32 v[114:115], v[114:115], v[202:203]
  v_cvt_pk_bf16_f32 v222, v112, v113
  v_cvt_pk_bf16_f32 v223, v114, v115
  s_waitcnt vmcnt(14)
  s_cbranch_vccnz L_kw1_11
  s_waitcnt vmcnt(10)
L_kw1_11:
  buffer_load_dwordx4 v[64:67], v94, s[8:11], s60 offen offset:2048 nt
  v_mfma_f32_16x16x32_bf16 v[228:231], v[220:223], v[172:175], 0
  v_pk_fma_f32 v[112:113], v[4:5], s[92:93], v[216:217] neg_lo:[0,0,1] neg_hi:[0,0,1]
  v_pk_fma_f32 v[114:115], v[6:7], s[92:93], v[218:219] neg_lo:[0,0,1] neg_hi:[0,0,1]
  v_cvt_pk_bf16_f32 v112, 0, v112
  v_cvt_pk_bf16_f32 v113, 0, v113
  v_cvt_pk_bf16_f32 v114, 0, v114
  v_cvt_pk_bf16_f32 v115, 0, v115
  v_pk_mul_f32 v[112:113], v[112:113], v[204:205]
  v_pk_mul_f32 v[114:115], v[114:115], v[206:207]
  v_cvt_pk_bf16_f32 v224, v112, v113
  v_cvt_pk_bf16_f32 v225, v114, v115
  s_waitcnt vmcnt(14)
  s_cbranch_vccnz L_kw1_12
  s_waitcnt vmcnt(10)
L_kw1_12:
  buffer_load_dwordx4 v[68:71], v94, s[8:11], s60 offen offset:2304 nt
  v_mfma_f32_16x16x16_bf16 v[228:231], v[224:225], v[176:177], v[228:231]
  v_pk_fma_f32 v[112:113], v[8:9], s[92:93], v[208:209] neg_lo:[0,0,1] neg_hi:[0,0,1]
  v_pk_fma_f32 v[114:115], v[10:11], s[92:93], v[210:211] neg_lo:[0,0,1] neg_hi:[0,0,1]
  v_cvt_pk_bf16_f32 v112, 0, v112
  v_cvt_pk_bf16_f32 v113, 0, v113
  v_cvt_pk_bf16_f32 v114, 0, v114
  v_cvt_pk_bf16_f32 v115, 0, v115
  v_pk_mul_f32 v[112:113], v[112:113], v[196:197]
  v_pk_mul_f32 v[114:115], v[114:115], v[198:199]
  v_cvt_pk_bf16_f32 v220, v112, v113
  v_cvt_pk_bf16_f32 v221, v114, v115
  s_waitcnt vmcnt(14)
  s_cbranch_vccnz L_kw1_13
  s_waitcnt vmcnt(10)
L_kw1_13:
  buffer_load_dwordx4 v[72:75], v94, s[8:11], s60 offen offset:2560 nt
  v_pk_fma_f32 v[112:113], v[12:13], s[92:93], v[212:213] neg_lo:[0,0,1] neg_hi:[0,0,1]
  v_pk_fma_f32 v[114:115], v[14:15], s[92:93], v[214:215] neg_lo:[0,0,1] neg_hi:[0,0,1]
  v_mov_b32_dpp v148, v228 quad_perm:[0,0,0,0] row_mask:0xf bank_mask:0xf
  v_mov_b32_dpp v149, v230 quad_perm:[2,2,2,2] row_mask:0xf bank_mask:0xf
  v_cvt_pk_bf16_f32 v112, 0, v112
  v_cvt_pk_bf16_f32 v113, 0, v113
  v_add_f32_dpp v148, v229, v148 quad_perm:[1,1,1,1] row_mask:0xf bank_mask:0xf
  v_add_f32_dpp v149, v231, v149 quad_perm:[3,3,3,3] row_mask:0xf bank_mask:0xf
  v_cvt_pk_bf16_f32 v114, 0, v114
  v_cvt_pk_bf16_f32 v115, 0, v115
  v_add_f32 v233, v148, v149
  v_pk_mul_f32 v[112:113], v[112:113], v[200:201]
  v_pk_mul_f32 v[114:115], v[114:115], v[202:203]
  v_cvt_pk_bf16_f32 v222, v112, v113
  v_cvt_pk_bf16_f32 v223, v114, v115
  s_waitcnt vmcnt(14)
  s_cbranch_vccnz L_kw1_14
  s_waitcnt vmcnt(10)
L_kw1_14:
  buffer_load_dwordx4 v[76:79], v94, s[8:11], s60 offen offset:2816 nt
  v_mfma_f32_16x16x32_bf16 v[228:231], v[220:223], v[172:175], 0
  v_pk_fma_f32 v[112:113], v[16:17], s[92:93], v[216:217] neg_lo:[0,0,1] neg_hi:[0,0,1]
  v_pk_fma_f32 v[114:115], v[18:19], s[92:93], v[218:219] neg_lo:[0,0,1] neg_hi:[0,0,1]
  s_cmp_lt_u32 s64, s99
  s_cbranch_scc1 L_k_known1
L_k_spin1:
  v_mov_b32 v148, 61696
  ds_read_b32 v148, v148
  s_waitcnt lgkmcnt(0)
  v_readfirstlane_b32 s96, v148
  s_nop 1
  s_cmp_eq_u32 s96, 0
  s_cbranch_scc1 L_k_spin1
  s_mov_b32 s99, -1
  s_bitcmp1_b32 s96, 6
  s_cselect_b32 s97, 255, s97
L_k_known1:
  s_andn2_b32 s70, s64, 1
  s_or_b32 s70, s70, s4
  s_lshr_b32 s71, s64, 5
  s_lshr_b32 s85, s96, s71
  s_cmp_lt_u32 s64, s97
  s_cselect_b32 s70, s70, s64
  s_cselect_b32 s85, s64, s85
  s_and_b32 s85, s85, 1
  s_mul_i32 s71, s71, 4064
  s_add_u32 s70, s70, s71
  s_add_u32 s70, s70, s5
  s_mul_hi_u32 s84, s70, s90
  s_lshr_b32 s84, s84, 1
  s_mul_i32 s71, s84, 3
  s_sub_u32 s70, s70, s71
  s_lshl3_add_u32 s85, s70, s85
  s_mul_i32 s61, s84, 196608
  s_lshr_b32 s89, s84, 4
  s_lshl_b32 s70, s85, 5
  v_add_u32 v100, s70, v234
  v_mul_u32_u24 v100, 21846, v100
  v_lshrrev_b32 v100, 16, v100
  v_add_u32 v148, s85, v235
  v_lshrrev_b32 v149, v148, s91
  v_and_b32 v149, 1, v149
  v_cmp_eq_u32 s[54:55], 1, v149
  s_nop 1
  s_and_b64 s[52:53], s[54:55], s[56:57]
  s_andn2_b64 s[54:55], s[54:55], s[56:57]
  v_mul_u32_u24 v148, 43, v148
  v_lshrrev_b32 v148, 8, v148
  v_mul_u32_u24 v148, 384, v148
  v_add_u32 v238, v148, v237
  s_cmp_eq_u32 s89, s88
  s_cbranch_scc1 L_k_sameq1
  s_mul_i32 s70, s89, 1536
  buffer_load_dwordx2 v[178:179], v239, s[36:39], s70 offen offset:0
  buffer_load_dwordx2 v[180:181], v239, s[36:39], s70 offen offset:128
  buffer_load_dwordx2 v[182:183], v239, s[36:39], s70 offen offset:256
  s_mov_b32 s88, s89
L_k_sameq1:
  s_mul_i32 s62, s84, 1536
  buffer_load_dwordx2 v[184:185], v238, s[20:23], s62 offen offset:0
  buffer_load_dwordx2 v[190:191], v238, s[24:27], s62 offen offset:0
  buffer_load_dwordx2 v[186:187], v238, s[20:23], s62 offen offset:128
  buffer_load_dwordx2 v[192:193], v238, s[24:27], s62 offen offset:128
  buffer_load_dwordx2 v[188:189], v238, s[20:23], s62 offen offset:256
  buffer_load_dwordx2 v[194:195], v238, s[24:27], s62 offen offset:256
  v_cvt_pk_bf16_f32 v112, 0, v112
  v_cvt_pk_bf16_f32 v232, 0, v232
  v_cvt_pk_bf16_f32 v113, 0, v113
  v_cvt_pk_bf16_f32 v233, 0, v233
  v_cvt_pk_bf16_f32 v114, 0, v114
  v_pk_mul_f32 v[232:233], v[232:233], s[68:69]
  v_cvt_pk_bf16_f32 v115, 0, v115
  v_cvt_pk_bf16_f32 v125, v232, v233
  v_pk_mul_f32 v[112:113], v[112:113], v[204:205]
  v_pk_mul_f32 v[114:115], v[114:115], v[206:207]
  v_cvt_pk_bf16_f32 v224, v112, v113
  v_cvt_pk_bf16_f32 v225, v114, v115
  s_waitcnt vmcnt(20)
  s_cbranch_vccnz L_kw1_15
  s_waitcnt vmcnt(16)
L_kw1_15:
  buffer_load_dwordx4 v[80:83], v95, s[8:11], s60 offen offset:0 nt
  v_mfma_f32_16x16x16_bf16 v[228:231], v[224:225], v[176:177], v[228:231]
  v_pk_fma_f32 v[112:113], v[20:21], s[92:93], v[208:209] neg_lo:[0,0,1] neg_hi:[0,0,1]
  v_pk_fma_f32 v[114:115], v[22:23], s[92:93], v[210:211] neg_lo:[0,0,1] neg_hi:[0,0,1]
  v_cvt_pk_bf16_f32 v112, 0, v112
  v_cvt_pk_bf16_f32 v113, 0, v113
  v_cvt_pk_bf16_f32 v114, 0, v114
  v_cvt_pk_bf16_f32 v115, 0, v115
  v_pk_mul_f32 v[112:113], v[112:113], v[196:197]
  v_pk_mul_f32 v[114:115], v[114:115], v[198:199]
  v_cvt_pk_bf16_f32 v220, v112, v113
  v_cvt_pk_bf16_f32 v221, v114, v115
  s_waitcnt vmcnt(20)
  s_cbranch_vccnz L_kw1_16
  s_waitcnt vmcnt(16)
L_kw1_16:
  buffer_load_dwordx4 v[84:87], v95, s[8:11], s60 offen offset:256 nt
  v_pk_fma_f32 v[112:113], v[24:25], s[92:93], v[212:213] neg_lo:[0,0,1] neg_hi:[0,0,1]
  v_pk_fma_f32 v[114:115], v[26:27], s[92:93], v[214:215] neg_lo:[0,0,1] neg_hi:[0,0,1]
  v_mov_b32_dpp v148, v228 quad_perm:[0,0,0,0] row_mask:0xf bank_mask:0xf
  v_mov_b32_dpp v149, v230 quad_perm:[2,2,2,2] row_mask:0xf bank_mask:0xf
  v_cvt_pk_bf16_f32 v112, 0, v112
  v_cvt_pk_bf16_f32 v113, 0, v113
  v_add_f32_dpp v148, v229, v148 quad_perm:[1,1,1,1] row_mask:0xf bank_mask:0xf
  v_add_f32_dpp v149, v231, v149 quad_perm:[3,3,3,3] row_mask:0xf bank_mask:0xf
  v_cvt_pk_bf16_f32 v114, 0, v114
  v_cvt_pk_bf16_f32 v115, 0, v115
  v_add_f32 v232, v148, v149
  v_pk_mul_f32 v[112:113], v[112:113], v[200:201]
  v_pk_mul_f32 v[114:115], v[114:115], v[202:203]
  v_cvt_pk_bf16_f32 v222, v112, v113
  v_cvt_pk_bf16_f32 v223, v114, v115
  s_waitcnt vmcnt(20)
  s_cbranch_vccnz L_kw1_17
  s_waitcnt vmcnt(16)
L_kw1_17:
  buffer_load_dwordx4 v[88:91], v95, s[8:11], s60 offen offset:512 nt
  v_mfma_f32_16x16x32_bf16 v[228:231], v[220:223], v[172:175], 0
  v_pk_fma_f32 v[112:113], v[28:29], s[92:93], v[216:217] neg_lo:[0,0,1] neg_hi:[0,0,1]
  v_pk_fma_f32 v[114:115], v[30:31], s[92:93], v[218:219] neg_lo:[0,0,1] neg_hi:[0,0,1]
  v_cvt_pk_bf16_f32 v112, 0, v112
  v_cvt_pk_bf16_f32 v113, 0, v113
  v_cvt_pk_bf16_f32 v114, 0, v114
  v_cvt_pk_bf16_f32 v115, 0, v115
  v_pk_mul_f32 v[112:113], v[112:113], v[204:205]
  v_pk_mul_f32 v[114:115], v[114:115], v[206:207]
  v_cvt_pk_bf16_f32 v224, v112, v113
  v_cvt_pk_bf16_f32 v225, v114, v115
  s_cmp_lt_u32 s64, 96
  s_cbranch_scc1 L_k_keep1
  s_bitcmp1_b32 s96, 6
  s_cselect_b32 s97, 255, 0
  v_mov_b32 v152, v148
  v_mov_b32 v153, v149
  s_andn2_b32 s70, s3, 1
  s_or_b32 s70, s70, s4
  s_lshr_b32 s71, s3, 5
  s_lshr_b32 s85, s96, s71
  s_lshr_b32 s85, s85, 3
  s_cmp_lt_u32 s3, s97
  s_cselect_b32 s70, s70, s3
  s_cselect_b32 s85, s3, s85
  s_and_b32 s85, s85, 1
  s_mul_i32 s71, s71, 4064
  s_add_u32 s70, s70, s71
  s_add_u32 s70, s70, s5
  s_mul_hi_u32 s84, s70, s90
  s_lshr_b32 s84, s84, 1
  s_mul_i32 s71, s84, 3
  s_sub_u32 s70, s70, s71
  s_lshl3_add_u32 s85, s70, s85
  s_mul_i32 s61, s84, 196608
  s_lshr_b32 s89, s84, 4
  s_lshl_b32 s70, s85, 5
  v_add_u32 v100, s70, v96
  v_mul_u32_u24 v100, 21846, v100
  v_lshrrev_b32 v100, 16, v100
  v_add_u32 v148, s85, v97
  v_lshrrev_b32 v149, v148, s91
  v_and_b32 v149, 1, v149
  v_cmp_eq_u32 s[54:55], 1, v149
  s_nop 1
  s_and_b64 s[52:53], s[54:55], s[58:59]
  s_andn2_b64 s[54:55], s[54:55], s[58:59]
  v_mov_b32 v148, v152
  v_mov_b32 v149, v153
  s_mov_b32 s16, s12
  s_mov_b32 s17, s13
  s_lshl_b32 s62, s84, 9
  v_lshl_add_u32 v101, v100, 1, v99
  buffer_load_short_d16_hi v116, v101, s[32:35], s62 offen
  buffer_load_short_d16_hi v117, v101, s[28:31], s62 offen
  v_mov_b32 v236, v98
L_k_keep1:
  v_mad_u32_u24 v92, v100, s63, v236
  v_add_u32 v93, 768, v92
  v_add_u32 v94, 4608, v92
  v_add_u32 v95, 7680, v92
  v_cndmask_b32 v92, v92, v108, s[52:53]
  v_cndmask_b32 v95, v95, v108, s[54:55]
  s_waitcnt vmcnt(20)
  s_cbranch_vccnz L_kw1_18
  s_waitcnt vmcnt(16)
L_kw1_18:
  buffer_load_dwordx4 v[4:7], v92, s[16:19], s61 offen offset:0 nt
  v_mfma_f32_16x16x16_bf16 v[228:231], v[224:225], v[176:177], v[228:231]
  v_pk_fma_f32 v[112:113], v[32:33], s[92:93], v[208:209] neg_lo:[0,0,1] neg_hi:[0,0,1]
  v_pk_fma_f32 v[114:115], v[34:35], s[92:93], v[210:211] neg_lo:[0,0,1] neg_hi:[0,0,1]
  v_cvt_pk_bf16_f32 v112, 0, v112
  v_cvt_pk_bf16_f32 v113, 0, v113
  v_cvt_pk_bf16_f32 v114, 0, v114
  v_cvt_pk_bf16_f32 v115, 0, v115
  v_pk_mul_f32 v[112:113], v[112:113], v[196:197]
  v_pk_mul_f32 v[114:115], v[114:115], v[198:199]
  v_cvt_pk_bf16_f32 v220, v112, v113
  v_cvt_pk_bf16_f32 v221, v114, v115
  s_waitcnt vmcnt(20)
  s_cbranch_vccnz L_kw1_19
  s_waitcnt vmcnt(16)
L_kw1_19:
  buffer_load_dwordx4 v[8:11], v92, s[16:19], s61 offen offset:256 nt
  v_pk_fma_f32 v[112:113], v[36:37], s[92:93], v[212:213] neg_lo:[0,0,1] neg_hi:[0,0,1]
  v_pk_fma_f32 v[114:115], v[38:39], s[92:93], v[214:215] neg_lo:[0,0,1] neg_hi:[0,0,1]
  v_mov_b32_dpp v148, v228 quad_perm:[0,0,0,0] row_mask:0xf bank_mask:0xf
  v_mov_b32_dpp v149, v230 quad_perm:[2,2,2,2] row_mask:0xf bank_mask:0xf
  v_cvt_pk_bf16_f32 v112, 0, v112
  v_cvt_pk_bf16_f32 v113, 0, v113
  v_add_f32_dpp v148, v229, v148 quad_perm:[1,1,1,1] row_mask:0xf bank_mask:0xf
  v_add_f32_dpp v149, v231, v149 quad_perm:[3,3,3,3] row_mask:0xf bank_mask:0xf
  v_cvt_pk_bf16_f32 v114, 0, v114
  v_cvt_pk_bf16_f32 v115, 0, v115
  v_add_f32 v233, v148, v149
  v_pk_mul_f32 v[112:113], v[112:113], v[200:201]
  v_pk_mul_f32 v[114:115], v[114:115], v[202:203]
  v_cvt_pk_bf16_f32 v222, v112, v113
  v_cvt_pk_bf16_f32 v223, v114, v115
  s_waitcnt vmcnt(20)
  s_cbranch_vccnz L_kw1_20
  s_waitcnt vmcnt(16)
L_kw1_20:
  buffer_load_dwordx4 v[12:15], v92, s[16:19], s61 offen offset:512 nt
  v_mfma_f32_16x16x32_bf16 v[228:231], v[220:223], v[172:175], 0
  v_pk_fma_f32 v[112:113], v[40:41], s[92:93], v[216:217] neg_lo:[0,0,1] neg_hi:[0,0,1]
  v_pk_fma_f32 v[114:115], v[42:43], s[92:93], v[218:219] neg_lo:[0,0,1] neg_hi:[0,0,1]
  v_cvt_pk_bf16_f32 v112, 0, v112
  v_cvt_pk_bf16_f32 v232, 0, v232
  v_cvt_pk_bf16_f32 v113, 0, v113
  v_cvt_pk_bf16_f32 v233, 0, v233
  v_cvt_pk_bf16_f32 v114, 0, v114
  v_pk_mul_f32 v[232:233], v[232:233], s[68:69]
  v_cvt_pk_bf16_f32 v115, 0, v115
  v_cvt_pk_bf16_f32 v126, v232, v233
  v_pk_mul_f32 v[112:113], v[112:113], v[204:205]
  v_pk_mul_f32 v[114:115], v[114:115], v[206:207]
  v_cvt_pk_bf16_f32 v224, v112, v113
  v_cvt_pk_bf16_f32 v225, v114, v115
  s_waitcnt vmcnt(20)
  s_cbranch_vccnz L_kw1_21
  s_waitcnt vmcnt(16)
L_kw1_21:
  buffer_load_dwordx4 v[16:19], v93, s[16:19], s61 offen offset:0 nt
  v_mfma_f32_16x16x16_bf16 v[228:231], v[224:225], v[176:177], v[228:231]
  v_pk_fma_f32 v[112:113], v[44:45], s[92:93], v[208:209] neg_lo:[0,0,1] neg_hi:[0,0,1]
  v_pk_fma_f32 v[114:115], v[46:47], s[92:93], v[210:211] neg_lo:[0,0,1] neg_hi:[0,0,1]
  v_cvt_pk_bf16_f32 v112, 0, v112
  v_cvt_pk_bf16_f32 v113, 0, v113
  v_cvt_pk_bf16_f32 v114, 0, v114
  v_cvt_pk_bf16_f32 v115, 0, v115
  v_pk_mul_f32 v[112:113], v[112:113], v[196:197]
  v_pk_mul_f32 v[114:115], v[114:115], v[198:199]
  v_cvt_pk_bf16_f32 v220, v112, v113
  v_cvt_pk_bf16_f32 v221, v114, v115
  s_waitcnt vmcnt(20)
  s_cbranch_vccnz L_kw1_22
  s_waitcnt vmcnt(16)
L_kw1_22:
  buffer_load_dwordx4 v[20:23], v93, s[16:19], s61 offen offset:256 nt
  v_pk_fma_f32 v[112:113], v[48:49], s[92:93], v[212:213] neg_lo:[0,0,1] neg_hi:[0,0,1]
  v_pk_fma_f32 v[114:115], v[50:51], s[92:93], v[214:215] neg_lo:[0,0,1] neg_hi:[0,0,1]
  v_mov_b32_dpp v148, v228 quad_perm:[0,0,0,0] row_mask:0xf bank_mask:0xf
  v_mov_b32_dpp v149, v230 quad_perm:[2,2,2,2] row_mask:0xf bank_mask:0xf
  v_cvt_pk_bf16_f32 v112, 0, v112
  v_cvt_pk_bf16_f32 v113, 0, v113
  v_add_f32_dpp v148, v229, v148 quad_perm:[1,1,1,1] row_mask:0xf bank_mask:0xf
  v_add_f32_dpp v149, v231, v149 quad_perm:[3,3,3,3] row_mask:0xf bank_mask:0xf
  v_cvt_pk_bf16_f32 v114, 0, v114
  v_cvt_pk_bf16_f32 v115, 0, v115
  v_add_f32 v232, v148, v149
  v_pk_mul_f32 v[112:113], v[112:113], v[200:201]
  v_pk_mul_f32 v[114:115], v[114:115], v[202:203]
  v_cvt_pk_bf16_f32 v222, v112, v113
  v_cvt_pk_bf16_f32 v223, v114, v115
  s_waitcnt vmcnt(20)
  s_cbranch_vccnz L_kw1_23
  s_waitcnt vmcnt(16)
L_kw1_23:
  buffer_load_dwordx4 v[24:27], v93, s[16:19], s61 offen offset:512 nt
  v_mfma_f32_16x16x32_bf16 v[228:231], v[220:223], v[172:175], 0
  v_pk_fma_f32 v[112:113], v[52:53], s[92:93], v[216:217] neg_lo:[0,0,1] neg_hi:[0,0,1]
  v_pk_fma_f32 v[114:115], v[54:55], s[92:93], v[218:219] neg_lo:[0,0,1] neg_hi:[0,0,1]
  v_cvt_pk_bf16_f32 v112, 0, v112
  v_cvt_pk_bf16_f32 v113, 0, v113
  v_cvt_pk_bf16_f32 v114, 0, v114
  v_cvt_pk_bf16_f32 v115, 0, v115
  v_pk_mul_f32 v[112:113], v[112:113], v[204:205]
  v_pk_mul_f32 v[114:115], v[114:115], v[206:207]
  v_cvt_pk_bf16_f32 v224, v112, v113
  v_cvt_pk_bf16_f32 v225, v114, v115
  s_waitcnt vmcnt(20)
  s_cbranch_vccnz L_kw1_24
  s_waitcnt vmcnt(16)
L_kw1_24:
  buffer_load_dwordx4 v[28:31], v93, s[16:19], s61 offen offset:768 nt
  v_mfma_f32_16x16x16_bf16 v[228:231], v[224:225], v[176:177], v[228:231]
  v_pk_fma_f32 v[112:113], v[56:57], s[92:93], v[208:209] neg_lo:[0,0,1] neg_hi:[0,0,1]
  v_pk_fma_f32 v[114:115], v[58:59], s[92:93], v[210:211] neg_lo:[0,0,1] neg_hi:[0,0,1]
  v_cvt_pk_bf16_f32 v112, 0, v112
  v_cvt_pk_bf16_f32 v113, 0, v113
  v_cvt_pk_bf16_f32 v114, 0, v114
  v_cvt_pk_bf16_f32 v115, 0, v115
  v_pk_mul_f32 v[112:113], v[112:113], v[196:197]
  v_pk_mul_f32 v[114:115], v[114:115], v[198:199]
  v_cvt_pk_bf16_f32 v220, v112, v113
  v_cvt_pk_bf16_f32 v221, v114, v115
  s_waitcnt vmcnt(20)
  s_cbranch_vccnz L_kw1_25
  s_waitcnt vmcnt(16)
L_kw1_25:
  buffer_load_dwordx4 v[32:35], v93, s[16:19], s61 offen offset:1024 nt
  v_pk_fma_f32 v[112:113], v[60:61], s[92:93], v[212:213] neg_lo:[0,0,1] neg_hi:[0,0,1]
  v_pk_fma_f32 v[114:115], v[62:63], s[92:93], v[214:215] neg_lo:[0,0,1] neg_hi:[0,0,1]
  v_mov_b32_dpp v148, v228 quad_perm:[0,0,0,0] row_mask:0xf bank_mask:0xf
  v_mov_b32_dpp v149, v230 quad_perm:[2,2,2,2] row_mask:0xf bank_mask:0xf
  v_cvt_pk_bf16_f32 v112, 0, v112
  v_cvt_pk_bf16_f32 v113, 0, v113
  v_add_f32_dpp v148, v229, v148 quad_perm:[1,1,1,1] row_mask:0xf bank_mask:0xf
  v_add_f32_dpp v149, v231, v149 quad_perm:[3,3,3,3] row_mask:0xf bank_mask:0xf
  v_cvt_pk_bf16_f32 v114, 0, v114
  v_cvt_pk_bf16_f32 v115, 0, v115
  v_add_f32 v233, v148, v149
  v_pk_mul_f32 v[112:113], v[112:113], v[200:201]
  v_pk_mul_f32 v[114:115], v[114:115], v[202:203]
  v_cvt_pk_bf16_f32 v222, v112, v113
  v_cvt_pk_bf16_f32 v223, v114, v115
  s_waitcnt vmcnt(20)
  s_cbranch_vccnz L_kw1_26
  s_waitcnt vmcnt(10)
L_kw1_26:
  buffer_load_dwordx4 v[36:39], v93, s[16:19], s61 offen offset:1280 nt
  v_mfma_f32_16x16x32_bf16 v[228:231], v[220:223], v[172:175], 0
  v_pk_fma_f32 v[112:113], v[64:65], s[92:93], v[216:217] neg_lo:[0,0,1] neg_hi:[0,0,1]
  v_pk_fma_f32 v[114:115], v[66:67], s[92:93], v[218:219] neg_lo:[0,0,1] neg_hi:[0,0,1]
  v_cvt_pk_bf16_f32 v112, 0, v112
  v_cvt_pk_bf16_f32 v232, 0, v232
  v_cvt_pk_bf16_f32 v113, 0, v113
  v_cvt_pk_bf16_f32 v233, 0, v233
  v_cvt_pk_bf16_f32 v114, 0, v114
  v_pk_mul_f32 v[232:233], v[232:233], s[68:69]
  v_cvt_pk_bf16_f32 v115, 0, v115
  v_cvt_pk_bf16_f32 v127, v232, v233
  v_pk_mul_f32 v[112:113], v[112:113], v[204:205]
  v_pk_mul_f32 v[114:115], v[114:115], v[206:207]
  v_cvt_pk_bf16_f32 v224, v112, v113
  v_cvt_pk_bf16_f32 v225, v114, v115
  s_waitcnt vmcnt(20)
  s_cbranch_vccnz L_kw1_27
  s_waitcnt vmcnt(10)
L_kw1_27:
  buffer_load_dwordx4 v[40:43], v93, s[16:19], s61 offen offset:1536 nt
  v_mfma_f32_16x16x16_bf16 v[228:231], v[224:225], v[176:177], v[228:231]
  v_pk_fma_f32 v[112:113], v[68:69], s[92:93], v[208:209] neg_lo:[0,0,1] neg_hi:[0,0,1]
  v_pk_fma_f32 v[114:115], v[70:71], s[92:93], v[210:211] neg_lo:[0,0,1] neg_hi:[0,0,1]
  v_cvt_pk_bf16_f32 v112, 0, v112
  v_cvt_pk_bf16_f32 v113, 0, v113
  v_cvt_pk_bf16_f32 v114, 0, v114
  v_cvt_pk_bf16_f32 v115, 0, v115
  v_pk_mul_f32 v[112:113], v[112:113], v[196:197]
  v_pk_mul_f32 v[114:115], v[114:115], v[198:199]
  v_cvt_pk_bf16_f32 v220, v112, v113
  v_cvt_pk_bf16_f32 v221, v114, v115
  s_waitcnt vmcnt(20)
  s_cbranch_vccnz L_kw1_28
  s_waitcnt vmcnt(10)
L_kw1_28:
  buffer_load_dwordx4 v[44:47], v93, s[16:19], s61 offen offset:1792 nt
  v_pk_fma_f32 v[112:113], v[72:73], s[92:93], v[212:213] neg_lo:[0,0,1] neg_hi:[0,0,1]
  v_pk_fma_f32 v[114:115], v[74:75], s[92:93], v[214:215] neg_lo:[0,0,1] neg_hi:[0,0,1]
  v_mov_b32_dpp v148, v228 quad_perm:[0,0,0,0] row_mask:0xf bank_mask:0xf
  v_mov_b32_dpp v149, v230 quad_perm:[2,2,2,2] row_mask:0xf bank_mask:0xf
  v_cvt_pk_bf16_f32 v112, 0, v112
  v_cvt_pk_bf16_f32 v113, 0, v113
  v_add_f32_dpp v148, v229, v148 quad_perm:[1,1,1,1] row_mask:0xf bank_mask:0xf
  v_add_f32_dpp v149, v231, v149 quad_perm:[3,3,3,3] row_mask:0xf bank_mask:0xf
  v_cvt_pk_bf16_f32 v114, 0, v114
  v_cvt_pk_bf16_f32 v115, 0, v115
  v_add_f32 v232, v148, v149
  v_pk_mul_f32 v[112:113], v[112:113], v[200:201]
  v_pk_mul_f32 v[114:115], v[114:115], v[202:203]
  v_cvt_pk_bf16_f32 v222, v112, v113
  v_cvt_pk_bf16_f32 v223, v114, v115
  s_waitcnt vmcnt(20)
  s_cbranch_vccnz L_kw1_29
  s_waitcnt vmcnt(10)
L_kw1_29:
  buffer_load_dwordx4 v[48:51], v93, s[16:19], s61 offen offset:2048 nt
  v_mfma_f32_16x16x32_bf16 v[228:231], v[220:223], v[172:175], 0
  v_pk_fma_f32 v[112:113], v[76:77], s[92:93], v[216:217] neg_lo:[0,0,1] neg_hi:[0,0,1]
  v_pk_fma_f32 v[114:115], v[78:79], s[92:93], v[218:219] neg_lo:[0,0,1] neg_hi:[0,0,1]
  v_cvt_pk_bf16_f32 v112, 0, v112
  v_cvt_pk_bf16_f32 v113, 0, v113
  v_cvt_pk_bf16_f32 v114, 0, v114
  v_cvt_pk_bf16_f32 v115, 0, v115
  v_pk_mul_f32 v[112:113], v[112:113], v[204:205]
  v_pk_mul_f32 v[114:115], v[114:115], v[206:207]
  v_cvt_pk_bf16_f32 v224, v112, v113
  v_cvt_pk_bf16_f32 v225, v114, v115
  s_waitcnt vmcnt(14)
  s_cbranch_vccnz L_kw1_30
  s_waitcnt vmcnt(10)
L_kw1_30:
  buffer_load_dwordx4 v[52:55], v93, s[16:19], s61 offen offset:2304 nt
  v_mfma_f32_16x16x16_bf16 v[228:231], v[224:225], v[176:177], v[228:231]
  v_pk_fma_f32 v[112:113], v[80:81], s[92:93], v[208:209] neg_lo:[0,0,1] neg_hi:[0,0,1]
  v_pk_fma_f32 v[114:115], v[82:83], s[92:93], v[210:211] neg_lo:[0,0,1] neg_hi:[0,0,1]
  v_cvt_pk_bf16_f32 v112, 0, v112
  v_cvt_pk_bf16_f32 v113, 0, v113
  v_cvt_pk_bf16_f32 v114, 0, v114
  v_cvt_pk_bf16_f32 v115, 0, v115
  v_pk_mul_f32 v[112:113], v[112:113], v[196:197]
  v_pk_mul_f32 v[114:115], v[114:115], v[198:199]
  v_cvt_pk_bf16_f32 v220, v112, v113
  v_cvt_pk_bf16_f32 v221, v114, v115
  s_waitcnt vmcnt(14)
  s_cbranch_vccnz L_kw1_31
  s_waitcnt vmcnt(10)
L_kw1_31:
  buffer_load_dwordx4 v[56:59], v93, s[16:19], s61 offen offset:2560 nt
  v_pk_fma_f32 v[112:113], v[84:85], s[92:93], v[212:213] neg_lo:[0,0,1] neg_hi:[0,0,1]
  v_pk_fma_f32 v[114:115], v[86:87], s[92:93], v[214:215] neg_lo:[0,0,1] neg_hi:[0,0,1]
  v_mov_b32_dpp v148, v228 quad_perm:[0,0,0,0] row_mask:0xf bank_mask:0xf
  v_mov_b32_dpp v149, v230 quad_perm:[2,2,2,2] row_mask:0xf bank_mask:0xf
  v_cvt_pk_bf16_f32 v112, 0, v112
  v_cvt_pk_bf16_f32 v113, 0, v113
  v_add_f32_dpp v148, v229, v148 quad_perm:[1,1,1,1] row_mask:0xf bank_mask:0xf
  v_add_f32_dpp v149, v231, v149 quad_perm:[3,3,3,3] row_mask:0xf bank_mask:0xf
  v_cvt_pk_bf16_f32 v114, 0, v114
  v_cvt_pk_bf16_f32 v115, 0, v115
  v_add_f32 v233, v148, v149
  v_pk_mul_f32 v[112:113], v[112:113], v[200:201]
  v_pk_mul_f32 v[114:115], v[114:115], v[202:203]
  v_cvt_pk_bf16_f32 v222, v112, v113
  v_cvt_pk_bf16_f32 v223, v114, v115
  s_waitcnt vmcnt(14)
  s_cbranch_vccnz L_kw1_32
  s_waitcnt vmcnt(10)
L_kw1_32:
  buffer_load_dwordx4 v[60:63], v93, s[16:19], s61 offen offset:2816 nt
  v_mfma_f32_16x16x32_bf16 v[228:231], v[220:223], v[172:175], 0
  v_pk_fma_f32 v[112:113], v[88:89], s[92:93], v[216:217] neg_lo:[0,0,1] neg_hi:[0,0,1]
  v_pk_fma_f32 v[114:115], v[90:91], s[92:93], v[218:219] neg_lo:[0,0,1] neg_hi:[0,0,1]
  v_cvt_pk_bf16_f32 v112, 0, v112
  v_cvt_pk_bf16_f32 v232, 0, v232
  v_cvt_pk_bf16_f32 v113, 0, v113
  v_cvt_pk_bf16_f32 v233, 0, v233
  v_cvt_pk_bf16_f32 v114, 0, v114
  v_pk_mul_f32 v[232:233], v[232:233], s[68:69]
  v_cvt_pk_bf16_f32 v115, 0, v115
  v_cvt_pk_bf16_f32 v128, v232, v233
  v_pk_mul_f32 v[112:113], v[112:113], v[204:205]
  v_pk_mul_f32 v[114:115], v[114:115], v[206:207]
  v_cvt_pk_bf16_f32 v224, v112, v113
  v_cvt_pk_bf16_f32 v225, v114, v115
  s_mov_b32 s60, s61
  v_mov_b32 v150, s64
  v_mfma_f32_16x16x16_bf16 v[228:231], v[224:225], v[176:177], v[228:231]
  ds_write_b128 v102, v[124:127]
  v_add_u32 v102, 768, v102
  s_nop 5
  v_mov_b32_dpp v148, v228 quad_perm:[0,0,0,0] row_mask:0xf bank_mask:0xf
  v_mov_b32_dpp v149, v230 quad_perm:[2,2,2,2] row_mask:0xf bank_mask:0xf
  s_nop 0
  v_add_f32_dpp v148, v229, v148 quad_perm:[1,1,1,1] row_mask:0xf bank_mask:0xf
  v_add_f32_dpp v149, v231, v149 quad_perm:[3,3,3,3] row_mask:0xf bank_mask:0xf
  v_add_f32 v232, v148, v149
  v_cndmask_b32 v232, v232, v240, s[50:51]
  v_cvt_pk_bf16_f32 v232, 0, v232
  v_cvt_pk_bf16_f32 v233, 0, v233
  v_pk_mul_f32 v[232:233], v[232:233], s[68:69]
  v_cvt_pk_bf16_f32 v129, v232, v233
  ds_write_b64 v103, v[128:129] offset:256
  ds_write_b32 v107, v150
  v_add_u32 v103, 768, v103
  s_cmp_lt_u32 s64, 96
  s_cbranch_scc1 L_k
  v_subrev_u32 v102, 36864, v102
  v_subrev_u32 v103, 36864, v103
  s_mov_b32 s64, s3
  s_mov_b32 s88, s89
  s_mov_b32 s99, 0
  s_load_dwordx2 s[44:45], s[0:1], 56
  s_waitcnt lgkmcnt(0)
  s_mov_b32 s36, s44
  s_and_b32 s37, s45, 0xffff
  s_cmp_lt_u32 s64, s99
  s_cbranch_scc1 L_v0_ok
L_v0_spin:
  v_mov_b32 v148, 61700
  ds_read_b32 v148, v148
  s_waitcnt lgkmcnt(0)
  v_readfirstlane_b32 s99, v148
  s_nop 1
  s_cmp_lt_u32 s64, s99
  s_cbranch_scc0 L_v0_spin
L_v0_ok:
  ds_read_b128 v[124:127], v102
  ds_read_b64 v[128:129], v103 offset:256
L_v0:
  s_mov_b32 s86, s84
  s_mov_b32 s87, s85
  s_add_u32 s64, s64, 2
  s_cmp_lt_u32 s64, s99
  s_cbranch_scc1 L_v10_ok
L_v10_spin:
  v_mov_b32 v148, 61700
  ds_read_b32 v148, v148
  s_waitcnt lgkmcnt(0)
  v_readfirstlane_b32 s99, v148
  s_nop 1
  s_cmp_lt_u32 s64, s99
  s_cbranch_scc0 L_v10_spin
L_v10_ok:
  s_andn2_b32 s70, s64, 1
  s_or_b32 s70, s70, s4
  s_lshr_b32 s71, s64, 5
  s_lshr_b32 s85, s96, s71
  s_lshr_b32 s85, s85, 3
  s_cmp_lt_u32 s64, s97
  s_cselect_b32 s70, s70, s64
  s_cselect_b32 s85, s64, s85
  s_and_b32 s85, s85, 1
  s_mul_i32 s71, s71, 4064
  s_add_u32 s70, s70, s71
  s_add_u32 s70, s70, s5
  s_mul_hi_u32 s84, s70, s90
  s_lshr_b32 s84, s84, 1
  s_mul_i32 s71, s84, 3
  s_sub_u32 s70, s70, s71
  s_lshl3_add_u32 s85, s70, s85
  s_mul_i32 s61, s84, 196608
  s_lshr_b32 s89, s84, 4
  s_lshl_b32 s70, s85, 5
  v_add_u32 v100, s70, v96
  v_mul_u32_u24 v100, 21846, v100
  v_lshrrev_b32 v100, 16, v100
  v_add_u32 v148, s85, v97
  v_lshrrev_b32 v149, v148, s91
  v_and_b32 v149, 1, v149
  v_cmp_eq_u32 s[54:55], 1, v149
  s_nop 1
  s_and_b64 s[52:53], s[54:55], s[58:59]
  s_andn2_b64 s[54:55], s[54:55], s[58:59]
  s_cmp_lt_u32 s64, 96
  s_cselect_b32 s61, s61, 805306368
  s_add_u32 s70, s64, 94
  v_mov_b32 v150, s70
  ds_read_b32 v110, v109
  ds_write_b32 v107, v150
  s_waitcnt vmcnt(14)
  s_cbranch_vccnz L_vw0_0
  s_waitcnt vmcnt(10)
L_vw0_0:
  buffer_load_dwordx4 v[64:67], v93, s[12:15], s60 offen offset:3072 nt
  v_mul_f32 v118, s94, v116
  v_mul_f32 v119, 0x4a800000, v117
  s_nop 0
  v_mov_b32_dpp v120, v118 row_newbcast:0 row_mask:0xf bank_mask:0xf
  v_mov_b32_dpp v121, v119 row_newbcast:0 row_mask:0xf bank_mask:0xf
  v_pk_fma_f32 v[196:197], v[4:5], s[92:93], v[120:121] op_sel_hi:[1,1,0] neg_lo:[0,0,1] neg_hi:[0,0,1]
  v_pk_fma_f32 v[198:199], v[6:7], s[92:93], v[120:121] op_sel_hi:[1,1,0] neg_lo:[0,0,1] neg_hi:[0,0,1]
  v_cvt_pk_bf16_f32 v196, 0, v196
  s_waitcnt lgkmcnt(0)
  v_cvt_pk_bf16_f32 v197, 0, v197
  v_cmp_lt_u32 vcc, v150, v110
  v_cvt_pk_bf16_f32 v198, 0, v198
  v_lshlrev_b32 v152, 16, v124
  v_cvt_pk_bf16_f32 v199, 0, v199
  v_and_b32 v153, s65, v124
  v_pk_mul_f32 v[196:197], v[196:197], v[120:121] op_sel:[0,1]
  v_lshlrev_b32 v154, 16, v125
  v_pk_mul_f32 v[198:199], v[198:199], v[120:121] op_sel:[0,1]
  s_waitcnt vmcnt(14)
  s_cbranch_vccnz L_vw0_1
  s_waitcnt vmcnt(10)
L_vw0_1:
  buffer_load_dwordx4 v[68:71], v93, s[12:15], s60 offen offset:3328 nt
  v_pk_fma_f32 v[200:201], v[8:9], s[92:93], v[120:121] op_sel_hi:[1,1,0] neg_lo:[0,0,1] neg_hi:[0,0,1]
  v_pk_fma_f32 v[202:203], v[10:11], s[92:93], v[120:121] op_sel_hi:[1,1,0] neg_lo:[0,0,1] neg_hi:[0,0,1]
  v_cvt_pk_bf16_f32 v200, 0, v200
  v_and_b32 v155, s65, v125
  v_cvt_pk_bf16_f32 v201, 0, v201
  v_lshlrev_b32 v156, 16, v126
  v_cvt_pk_bf16_f32 v202, 0, v202
  v_and_b32 v157, s65, v126
  v_cvt_pk_bf16_f32 v203, 0, v203
  v_lshlrev_b32 v158, 16, v127
  v_pk_mul_f32 v[200:201], v[200:201], v[120:121] op_sel:[0,1]
  v_and_b32 v159, s65, v127
  v_pk_mul_f32 v[202:203], v[202:203], v[120:121] op_sel:[0,1]
  s_waitcnt vmcnt(14)
  s_cbranch_vccnz L_vw0_2
  s_waitcnt vmcnt(10)
L_vw0_2:
  buffer_load_dwordx4 v[72:75], v93, s[12:15], s60 offen offset:3584 nt
  v_pk_fma_f32 v[204:205], v[12:13], s[92:93], v[120:121] op_sel_hi:[1,1,0] neg_lo:[0,0,1] neg_hi:[0,0,1]
  v_pk_fma_f32 v[206:207], v[14:15], s[92:93], v[120:121] op_sel_hi:[1,1,0] neg_lo:[0,0,1] neg_hi:[0,0,1]
  v_cvt_pk_bf16_f32 v204, 0, v204
  v_lshlrev_b32 v160, 16, v128
  v_cvt_pk_bf16_f32 v205, 0, v205
  v_and_b32 v161, s65, v128
  v_cvt_pk_bf16_f32 v206, 0, v206
  v_lshlrev_b32 v162, 16, v129
  v_cvt_pk_bf16_f32 v207, 0, v207
  v_add_u32 v102, 768, v102
  v_pk_mul_f32 v[204:205], v[204:205], v[120:121] op_sel:[0,1]
  v_add_u32 v103, 768, v103
  v_pk_mul_f32 v[206:207], v[206:207], v[120:121] op_sel:[0,1]
  s_waitcnt vmcnt(14)
  s_cbranch_vccnz L_vw0_3
  s_waitcnt vmcnt(10)
L_vw0_3:
  buffer_load_dwordx4 v[76:79], v94, s[12:15], s60 offen offset:0 nt
  v_mov_b32_dpp v120, v118 row_newbcast:1 row_mask:0xf bank_mask:0xf
  v_mov_b32_dpp v121, v119 row_newbcast:1 row_mask:0xf bank_mask:0xf
  v_pk_fma_f32 v[112:113], v[16:17], s[92:93], v[120:121] op_sel_hi:[1,1,0] neg_lo:[0,0,1] neg_hi:[0,0,1]
  v_pk_fma_f32 v[114:115], v[18:19], s[92:93], v[120:121] op_sel_hi:[1,1,0] neg_lo:[0,0,1] neg_hi:[0,0,1]
  s_lshl_b32 s62, s84, 9
  v_lshl_add_u32 v101, v100, 1, v99
  buffer_load_short_d16_hi v116, v101, s[32:35], s62 offen
  buffer_load_short_d16_hi v117, v101, s[28:31], s62 offen
  v_cvt_pk_bf16_f32 v112, 0, v112
  v_max3_f32 v148, v152, v153, v154
  v_cvt_pk_bf16_f32 v113, 0, v113
  ds_read_b128 v[124:127], v102
  v_cvt_pk_bf16_f32 v114, 0, v114
  ds_read_b64 v[128:129], v103 offset:256
  v_cvt_pk_bf16_f32 v115, 0, v115
  v_max3_f32 v149, v155, v156, v157
  v_pk_mul_f32 v[112:113], v[112:113], v[120:121] op_sel:[0,1]
  v_max3_f32 v148, v148, v158, v159
  v_pk_mul_f32 v[114:115], v[114:115], v[120:121] op_sel:[0,1]
  v_cvt_pk_bf16_f32 v208, v196, v112
  v_cvt_pk_bf16_f32 v212, v197, v113
  v_cvt_pk_bf16_f32 v216, v198, v114
  v_cvt_pk_bf16_f32 v220, v199, v115
  s_waitcnt vmcnt(16)
  s_cbranch_vccnz L_vw0_4
  s_waitcnt vmcnt(12)
L_vw0_4:
  buffer_load_dwordx4 v[80:83], v94, s[12:15], s60 offen offset:256 nt
  v_pk_fma_f32 v[112:113], v[20:21], s[92:93], v[120:121] op_sel_hi:[1,1,0] neg_lo:[0,0,1] neg_hi:[0,0,1]
  v_pk_fma_f32 v[114:115], v[22:23], s[92:93], v[120:121] op_sel_hi:[1,1,0] neg_lo:[0,0,1] neg_hi:[0,0,1]
  v_cvt_pk_bf16_f32 v112, 0, v112
  v_max3_f32 v149, v149, v160, v161
  v_cvt_pk_bf16_f32 v113, 0, v113
  v_max3_f32 v148, v148, v162, v144
  v_cvt_pk_bf16_f32 v114, 0, v114
  v_max_f32 v148, v148, v149
  v_cvt_pk_bf16_f32 v115, 0, v115
  v_mov_b32 v149, v148
  v_pk_mul_f32 v[112:113], v[112:113], v[120:121] op_sel:[0,1]
  s_nop 0
  v_permlane32_swap_b32 v148, v149
  v_pk_mul_f32 v[114:115], v[114:115], v[120:121] op_sel:[0,1]
  v_cvt_pk_bf16_f32 v224, v200, v112
  v_cvt_pk_bf16_f32 v228, v201, v113
  v_cvt_pk_bf16_f32 v232, v202, v114
  v_cvt_pk_bf16_f32 v236, v203, v115
  s_waitcnt vmcnt(16)
  s_cbranch_vccnz L_vw0_5
  s_waitcnt vmcnt(12)
L_vw0_5:
  buffer_load_dwordx4 v[84:87], v94, s[12:15], s60 offen offset:512 nt
  v_pk_fma_f32 v[112:113], v[24:25], s[92:93], v[120:121] op_sel_hi:[1,1,0] neg_lo:[0,0,1] neg_hi:[0,0,1]
  v_pk_fma_f32 v[114:115], v[26:27], s[92:93], v[120:121] op_sel_hi:[1,1,0] neg_lo:[0,0,1] neg_hi:[0,0,1]
  v_cvt_pk_bf16_f32 v112, 0, v112
  v_max_f32 v148, v148, v149
  v_cvt_pk_bf16_f32 v113, 0, v113
  v_mov_b32 v149, v148
  v_cvt_pk_bf16_f32 v114, 0, v114
  s_nop 0
  v_permlane16_swap_b32 v148, v149
  v_cvt_pk_bf16_f32 v115, 0, v115
  v_max_f32 v144, v148, v149
  v_pk_mul_f32 v[112:113], v[112:113], v[120:121] op_sel:[0,1]
  v_mul_f32 v148, s66, v144
  v_pk_mul_f32 v[114:115], v[114:115], v[120:121] op_sel:[0,1]
  v_cvt_pk_bf16_f32 v240, v204, v112
  v_cvt_pk_bf16_f32 v244, v205, v113
  v_cvt_pk_bf16_f32 v248, v206, v114
  v_cvt_pk_bf16_f32 v252, v207, v115
  s_waitcnt vmcnt(16)
  s_cbranch_vccnz L_vw0_6
  s_waitcnt vmcnt(12)
L_vw0_6:
  buffer_load_dwordx4 v[88:91], v94, s[12:15], s60 offen offset:768 nt
  v_mov_b32_dpp v120, v118 row_newbcast:2 row_mask:0xf bank_mask:0xf
  v_mov_b32_dpp v121, v119 row_newbcast:2 row_mask:0xf bank_mask:0xf
  v_pk_fma_f32 v[196:197], v[28:29], s[92:93], v[120:121] op_sel_hi:[1,1,0] neg_lo:[0,0,1] neg_hi:[0,0,1]
  v_pk_fma_f32 v[198:199], v[30:31], s[92:93], v[120:121] op_sel_hi:[1,1,0] neg_lo:[0,0,1] neg_hi:[0,0,1]
  v_cvt_pk_bf16_f32 v196, 0, v196
  v_add_f32 v150, v148, v146
  v_cvt_pk_bf16_f32 v197, 0, v197
  v_sub_f32 v146, 0, v148
  v_cvt_pk_bf16_f32 v198, 0, v198
  v_exp_f32 v150, -v150
  v_cvt_pk_bf16_f32 v199, 0, v199
  ds_bpermute_b32 v151, v104, v150
  v_pk_mul_f32 v[196:197], v[196:197], v[120:121] op_sel:[0,1]
  v_fma_f32 v152, v152, s66, v146
  v_pk_mul_f32 v[198:199], v[198:199], v[120:121] op_sel:[0,1]
  s_waitcnt vmcnt(16)
  s_cbranch_vccnz L_vw0_7
  s_waitcnt vmcnt(12)
L_vw0_7:
  buffer_load_dwordx4 v[4:7], v94, s[12:15], s60 offen offset:1024 nt
  v_pk_fma_f32 v[200:201], v[32:33], s[92:93], v[120:121] op_sel_hi:[1,1,0] neg_lo:[0,0,1] neg_hi:[0,0,1]
  v_pk_fma_f32 v[202:203], v[34:35], s[92:93], v[120:121] op_sel_hi:[1,1,0] neg_lo:[0,0,1] neg_hi:[0,0,1]
  v_cvt_pk_bf16_f32 v200, 0, v200
  v_exp_f32 v152, v152
  v_cvt_pk_bf16_f32 v201, 0, v201
  v_fma_f32 v153, v153, s66, v146
  v_cvt_pk_bf16_f32 v202, 0, v202
  v_exp_f32 v153, v153
  v_cvt_pk_bf16_f32 v203, 0, v203
  v_fma_f32 v154, v154, s66, v146
  v_pk_mul_f32 v[200:201], v[200:201], v[120:121] op_sel:[0,1]
  v_exp_f32 v154, v154
  v_pk_mul_f32 v[202:203], v[202:203], v[120:121] op_sel:[0,1]
  s_waitcnt vmcnt(16)
  s_cbranch_vccnz L_vw0_8
  s_waitcnt vmcnt(12)
L_vw0_8:
  buffer_load_dwordx4 v[8:11], v94, s[12:15], s60 offen offset:1280 nt
  v_pk_fma_f32 v[204:205], v[36:37], s[92:93], v[120:121] op_sel_hi:[1,1,0] neg_lo:[0,0,1] neg_hi:[0,0,1]
  v_pk_fma_f32 v[206:207], v[38:39], s[92:93], v[120:121] op_sel_hi:[1,1,0] neg_lo:[0,0,1] neg_hi:[0,0,1]
  v_cvt_pk_bf16_f32 v204, 0, v204
  v_fma_f32 v155, v155, s66, v146
  v_cvt_pk_bf16_f32 v205, 0, v205
  v_exp_f32 v155, v155
  v_cvt_pk_bf16_f32 v206, 0, v206
  v_fma_f32 v156, v156, s66, v146
  v_cvt_pk_bf16_f32 v207, 0, v207
  v_exp_f32 v156, v156
  v_pk_mul_f32 v[204:205], v[204:205], v[120:121] op_sel:[0,1]
  v_fma_f32 v157, v157, s66, v146
  v_pk_mul_f32 v[206:207], v[206:207], v[120:121] op_sel:[0,1]
  s_waitcnt vmcnt(16)
  s_cbranch_vccnz L_vw0_9
  s_waitcnt vmcnt(12)
L_vw0_9:
  buffer_load_dwordx4 v[12:15], v94, s[12:15], s60 offen offset:1536 nt
  v_mov_b32_dpp v120, v118 row_newbcast:3 row_mask:0xf bank_mask:0xf
  v_mov_b32_dpp v121, v119 row_newbcast:3 row_mask:0xf bank_mask:0xf
  v_pk_fma_f32 v[112:113], v[40:41], s[92:93], v[120:121] op_sel_hi:[1,1,0] neg_lo:[0,0,1] neg_hi:[0,0,1]
  v_pk_fma_f32 v[114:115], v[42:43], s[92:93], v[120:121] op_sel_hi:[1,1,0] neg_lo:[0,0,1] neg_hi:[0,0,1]
  v_cvt_pk_bf16_f32 v112, 0, v112
  v_exp_f32 v157, v157
  v_cvt_pk_bf16_f32 v113, 0, v113
  v_fma_f32 v158, v158, s66, v146
  v_cvt_pk_bf16_f32 v114, 0, v114
  v_exp_f32 v158, v158
  v_cvt_pk_bf16_f32 v115, 0, v115
  v_fma_f32 v159, v159, s66, v146
  v_pk_mul_f32 v[112:113], v[112:113], v[120:121] op_sel:[0,1]
  v_exp_f32 v159, v159
  v_pk_mul_f32 v[114:115], v[114:115], v[120:121] op_sel:[0,1]
  v_cvt_pk_bf16_f32 v209, v196, v112
  v_cvt_pk_bf16_f32 v213, v197, v113
  v_cvt_pk_bf16_f32 v217, v198, v114
  v_cvt_pk_bf16_f32 v221, v199, v115
  s_waitcnt vmcnt(16)
  s_cbranch_vccnz L_vw0_10
  s_waitcnt vmcnt(12)
L_vw0_10:
  buffer_load_dwordx4 v[16:19], v94, s[12:15], s60 offen offset:1792 nt
  v_pk_fma_f32 v[112:113], v[44:45], s[92:93], v[120:121] op_sel_hi:[1,1,0] neg_lo:[0,0,1] neg_hi:[0,0,1]
  v_pk_fma_f32 v[114:115], v[46:47], s[92:93], v[120:121] op_sel_hi:[1,1,0] neg_lo:[0,0,1] neg_hi:[0,0,1]
  v_cvt_pk_bf16_f32 v112, 0, v112
  v_fma_f32 v160, v160, s66, v146
  v_cvt_pk_bf16_f32 v113, 0, v113
  v_exp_f32 v160, v160
  v_cvt_pk_bf16_f32 v114, 0, v114
  v_fma_f32 v161, v161, s66, v146
  v_cvt_pk_bf16_f32 v115, 0, v115
  v_exp_f32 v161, v161
  v_pk_mul_f32 v[112:113], v[112:113], v[120:121] op_sel:[0,1]
  v_fma_f32 v162, v162, s66, v146
  v_pk_mul_f32 v[114:115], v[114:115], v[120:121] op_sel:[0,1]
  v_cvt_pk_bf16_f32 v225, v200, v112
  v_cvt_pk_bf16_f32 v229, v201, v113
  v_cvt_pk_bf16_f32 v233, v202, v114
  v_cvt_pk_bf16_f32 v237, v203, v115
  s_waitcnt vmcnt(16)
  s_cbranch_vccnz L_vw0_11
  s_waitcnt vmcnt(12)
L_vw0_11:
  buffer_load_dwordx4 v[20:23], v94, s[12:15], s60 offen offset:2048 nt
  v_pk_fma_f32 v[112:113], v[48:49], s[92:93], v[120:121] op_sel_hi:[1,1,0] neg_lo:[0,0,1] neg_hi:[0,0,1]
  v_pk_fma_f32 v[114:115], v[50:51], s[92:93], v[120:121] op_sel_hi:[1,1,0] neg_lo:[0,0,1] neg_hi:[0,0,1]
  v_cvt_pk_bf16_f32 v112, 0, v112
  v_exp_f32 v162, v162
  v_cvt_pk_bf16_f32 v113, 0, v113
  v_add_f32 v148, v152, v153
  v_cvt_pk_bf16_f32 v114, 0, v114
  v_add_f32 v149, v154, v155
  v_cvt_pk_bf16_f32 v115, 0, v115
  v_add_f32 v148, v148, v156
  v_pk_mul_f32 v[112:113], v[112:113], v[120:121] op_sel:[0,1]
  v_add_f32 v149, v149, v157
  v_pk_mul_f32 v[114:115], v[114:115], v[120:121] op_sel:[0,1]
  v_cvt_pk_bf16_f32 v241, v204, v112
  v_cvt_pk_bf16_f32 v245, v205, v113
  v_cvt_pk_bf16_f32 v249, v206, v114
  v_cvt_pk_bf16_f32 v253, v207, v115
  s_waitcnt vmcnt(16)
  s_cbranch_vccnz L_vw0_12
  s_waitcnt vmcnt(12)
L_vw0_12:
  buffer_load_dwordx4 v[24:27], v94, s[12:15], s60 offen offset:2304 nt
  v_mov_b32_dpp v120, v118 row_newbcast:4 row_mask:0xf bank_mask:0xf
  v_mov_b32_dpp v121, v119 row_newbcast:4 row_mask:0xf bank_mask:0xf
  v_pk_fma_f32 v[196:197], v[52:53], s[92:93], v[120:121] op_sel_hi:[1,1,0] neg_lo:[0,0,1] neg_hi:[0,0,1]
  v_pk_fma_f32 v[198:199], v[54:55], s[92:93], v[120:121] op_sel_hi:[1,1,0] neg_lo:[0,0,1] neg_hi:[0,0,1]
  v_cvt_pk_bf16_f32 v196, 0, v196
  v_add_f32 v148, v148, v158
  v_cvt_pk_bf16_f32 v197, 0, v197
  v_add_f32 v149, v149, v159
  v_cvt_pk_bf16_f32 v198, 0, v198
  v_add_f32 v148, v148, v160
  v_cvt_pk_bf16_f32 v199, 0, v199
  v_add_f32 v149, v149, v161
  v_pk_mul_f32 v[196:197], v[196:197], v[120:121] op_sel:[0,1]
  v_add_f32 v148, v148, v162
  v_pk_mul_f32 v[198:199], v[198:199], v[120:121] op_sel:[0,1]
  s_waitcnt vmcnt(16)
  s_cbranch_vccnz L_vw0_13
  s_waitcnt vmcnt(12)
L_vw0_13:
  buffer_load_dwordx4 v[28:31], v94, s[12:15], s60 offen offset:2560 nt
  v_pk_fma_f32 v[200:201], v[56:57], s[92:93], v[120:121] op_sel_hi:[1,1,0] neg_lo:[0,0,1] neg_hi:[0,0,1]
  v_pk_fma_f32 v[202:203], v[58:59], s[92:93], v[120:121] op_sel_hi:[1,1,0] neg_lo:[0,0,1] neg_hi:[0,0,1]
  v_cvt_pk_bf16_f32 v200, 0, v200
  v_add_f32 v148, v148, v149
  v_cvt_pk_bf16_f32 v201, 0, v201
  v_fma_f32 v147, v147, v150, v148
  v_cvt_pk_bf16_f32 v202, 0, v202
  v_cvt_pk_bf16_f32 v163, v152, v153
  v_cvt_pk_bf16_f32 v203, 0, v203
  v_cvt_pk_bf16_f32 v164, v154, v155
  v_pk_mul_f32 v[200:201], v[200:201], v[120:121] op_sel:[0,1]
  v_cvt_pk_bf16_f32 v165, v156, v157
  v_pk_mul_f32 v[202:203], v[202:203], v[120:121] op_sel:[0,1]
  s_waitcnt vmcnt(16)
  s_cbranch_vccnz L_vw0_14
  s_waitcnt vmcnt(12)
L_vw0_14:
  buffer_load_dwordx4 v[32:35], v94, s[12:15], s60 offen offset:2816 nt
  v_pk_fma_f32 v[204:205], v[60:61], s[92:93], v[120:121] op_sel_hi:[1,1,0] neg_lo:[0,0,1] neg_hi:[0,0,1]
  v_pk_fma_f32 v[206:207], v[62:63], s[92:93], v[120:121] op_sel_hi:[1,1,0] neg_lo:[0,0,1] neg_hi:[0,0,1]
  v_cvt_pk_bf16_f32 v204, 0, v204
  v_cvt_pk_bf16_f32 v166, v158, v159
  v_cvt_pk_bf16_f32 v205, 0, v205
  v_cvt_pk_bf16_f32 v167, v160, v161
  v_cvt_pk_bf16_f32 v206, 0, v206
  v_cvt_pk_bf16_f32 v168, v162, 0
  v_cvt_pk_bf16_f32 v207, 0, v207
  v_cndmask_b32 v172, 0, v163, s[72:73]
  v_pk_mul_f32 v[204:205], v[204:205], v[120:121] op_sel:[0,1]
  v_cndmask_b32 v173, 0, v164, s[72:73]
  v_pk_mul_f32 v[206:207], v[206:207], v[120:121] op_sel:[0,1]
  s_waitcnt vmcnt(16)
  s_cbranch_vccnz L_vw0_15
  s_waitcnt vmcnt(10)
L_vw0_15:
  buffer_load_dwordx4 v[36:39], v95, s[12:15], s60 offen offset:0 nt
  v_mov_b32_dpp v120, v118 row_newbcast:5 row_mask:0xf bank_mask:0xf
  v_mov_b32_dpp v121, v119 row_newbcast:5 row_mask:0xf bank_mask:0xf
  v_pk_fma_f32 v[112:113], v[64:65], s[92:93], v[120:121] op_sel_hi:[1,1,0] neg_lo:[0,0,1] neg_hi:[0,0,1]
  v_pk_fma_f32 v[114:115], v[66:67], s[92:93], v[120:121] op_sel_hi:[1,1,0] neg_lo:[0,0,1] neg_hi:[0,0,1]
  v_cvt_pk_bf16_f32 v112, 0, v112
  v_cndmask_b32 v174, 0, v165, s[72:73]
  v_cvt_pk_bf16_f32 v113, 0, v113
  v_cndmask_b32 v175, 0, v166, s[72:73]
  v_cvt_pk_bf16_f32 v114, 0, v114
  v_cndmask_b32 v176, 0, v163, s[74:75]
  v_cvt_pk_bf16_f32 v115, 0, v115
  v_cndmask_b32 v177, 0, v164, s[74:75]
  v_pk_mul_f32 v[112:113], v[112:113], v[120:121] op_sel:[0,1]
  v_cndmask_b32 v178, 0, v165, s[74:75]
  v_pk_mul_f32 v[114:115], v[114:115], v[120:121] op_sel:[0,1]
  v_cvt_pk_bf16_f32 v210, v196, v112
  v_cvt_pk_bf16_f32 v214, v197, v113
  v_cvt_pk_bf16_f32 v218, v198, v114
  v_cvt_pk_bf16_f32 v222, v199, v115
  s_waitcnt vmcnt(16)
  s_cbranch_vccnz L_vw0_16
  s_waitcnt vmcnt(10)
L_vw0_16:
  buffer_load_dwordx4 v[40:43], v95, s[12:15], s60 offen offset:256 nt
  v_pk_fma_f32 v[112:113], v[68:69], s[92:93], v[120:121] op_sel_hi:[1,1,0] neg_lo:[0,0,1] neg_hi:[0,0,1]
  v_pk_fma_f32 v[114:115], v[70:71], s[92:93], v[120:121] op_sel_hi:[1,1,0] neg_lo:[0,0,1] neg_hi:[0,0,1]
  v_cvt_pk_bf16_f32 v112, 0, v112
  v_cndmask_b32 v179, 0, v166, s[74:75]
  v_cvt_pk_bf16_f32 v113, 0, v113
  v_cndmask_b32 v180, 0, v163, s[76:77]
  v_cvt_pk_bf16_f32 v114, 0, v114
  v_cndmask_b32 v181, 0, v164, s[76:77]
  v_cvt_pk_bf16_f32 v115, 0, v115
  v_cndmask_b32 v182, 0, v165, s[76:77]
  v_pk_mul_f32 v[112:113], v[112:113], v[120:121] op_sel:[0,1]
  v_cndmask_b32 v183, 0, v166, s[76:77]
  v_pk_mul_f32 v[114:115], v[114:115], v[120:121] op_sel:[0,1]
  v_cvt_pk_bf16_f32 v226, v200, v112
  v_cvt_pk_bf16_f32 v230, v201, v113
  v_cvt_pk_bf16_f32 v234, v202, v114
  v_cvt_pk_bf16_f32 v238, v203, v115
  s_waitcnt vmcnt(16)
  s_cbranch_vccnz L_vw0_17
  s_waitcnt vmcnt(10)
L_vw0_17:
  buffer_load_dwordx4 v[44:47], v95, s[12:15], s60 offen offset:512 nt
  v_pk_fma_f32 v[112:113], v[72:73], s[92:93], v[120:121] op_sel_hi:[1,1,0] neg_lo:[0,0,1] neg_hi:[0,0,1]
  v_pk_fma_f32 v[114:115], v[74:75], s[92:93], v[120:121] op_sel_hi:[1,1,0] neg_lo:[0,0,1] neg_hi:[0,0,1]
  v_cvt_pk_bf16_f32 v112, 0, v112
  v_cndmask_b32 v184, 0, v163, s[78:79]
  v_cvt_pk_bf16_f32 v113, 0, v113
  v_cndmask_b32 v185, 0, v164, s[78:79]
  v_cvt_pk_bf16_f32 v114, 0, v114
  v_cndmask_b32 v186, 0, v165, s[78:79]
  v_cvt_pk_bf16_f32 v115, 0, v115
  v_cndmask_b32 v187, 0, v166, s[78:79]
  v_pk_mul_f32 v[112:113], v[112:113], v[120:121] op_sel:[0,1]
  s_waitcnt lgkmcnt(0)
  v_pk_mul_f32 v[114:115], v[114:115], v[120:121] op_sel:[0,1]
  v_cvt_pk_bf16_f32 v242, v204, v112
  v_cvt_pk_bf16_f32 v246, v205, v113
  v_cvt_pk_bf16_f32 v250, v206, v114
  v_cvt_pk_bf16_f32 v254, v207, v115
  v_mad_u32_u24 v92, v100, s63, v98
  v_add_u32 v93, 768, v92
  v_add_u32 v94, 4608, v92
  v_add_u32 v95, 7680, v92
  v_cndmask_b32 v92, v92, v108, s[52:53]
  v_cndmask_b32 v95, v95, v108, s[54:55]
  s_waitcnt vmcnt(16)
  s_cbranch_vccnz L_vw0_18
  s_waitcnt vmcnt(10)
L_vw0_18:
  buffer_load_dwordx4 v[48:51], v92, s[12:15], s61 offen offset:0 nt
  v_mov_b32_dpp v120, v118 row_newbcast:6 row_mask:0xf bank_mask:0xf
  v_mov_b32_dpp v121, v119 row_newbcast:6 row_mask:0xf bank_mask:0xf
  v_pk_fma_f32 v[196:197], v[76:77], s[92:93], v[120:121] op_sel_hi:[1,1,0] neg_lo:[0,0,1] neg_hi:[0,0,1]
  v_pk_fma_f32 v[198:199], v[78:79], s[92:93], v[120:121] op_sel_hi:[1,1,0] neg_lo:[0,0,1] neg_hi:[0,0,1]
  v_cvt_pk_bf16_f32 v196, 0, v196
  v_mul_f32 v132, v151, v132
  v_cvt_pk_bf16_f32 v197, 0, v197
  v_mul_f32 v133, v151, v133
  v_cvt_pk_bf16_f32 v198, 0, v198
  v_mul_f32 v134, v151, v134
  v_cvt_pk_bf16_f32 v199, 0, v199
  v_mul_f32 v135, v151, v135
  v_pk_mul_f32 v[196:197], v[196:197], v[120:121] op_sel:[0,1]
  v_mul_f32 v136, v151, v136
  v_pk_mul_f32 v[198:199], v[198:199], v[120:121] op_sel:[0,1]
  s_waitcnt vmcnt(14)
  s_cbranch_vccnz L_vw0_19
  s_waitcnt vmcnt(10)
L_vw0_19:
  buffer_load_dwordx4 v[52:55], v92, s[12:15], s61 offen offset:256 nt
  v_pk_fma_f32 v[200:201], v[80:81], s[92:93], v[120:121] op_sel_hi:[1,1,0] neg_lo:[0,0,1] neg_hi:[0,0,1]
  v_pk_fma_f32 v[202:203], v[82:83], s[92:93], v[120:121] op_sel_hi:[1,1,0] neg_lo:[0,0,1] neg_hi:[0,0,1]
  v_cvt_pk_bf16_f32 v200, 0, v200
  v_mul_f32 v137, v151, v137
  v_cvt_pk_bf16_f32 v201, 0, v201
  v_mul_f32 v138, v151, v138
  v_cvt_pk_bf16_f32 v202, 0, v202
  v_mul_f32 v139, v151, v139
  v_cvt_pk_bf16_f32 v203, 0, v203
  v_mul_f32 v140, v151, v140
  v_pk_mul_f32 v[200:201], v[200:201], v[120:121] op_sel:[0,1]
  v_mul_f32 v141, v151, v141
  v_pk_mul_f32 v[202:203], v[202:203], v[120:121] op_sel:[0,1]
  s_waitcnt vmcnt(14)
  s_cbranch_vccnz L_vw0_20
  s_waitcnt vmcnt(10)
L_vw0_20:
  buffer_load_dwordx4 v[56:59], v92, s[12:15], s61 offen offset:512 nt
  v_pk_fma_f32 v[204:205], v[84:85], s[92:93], v[120:121] op_sel_hi:[1,1,0] neg_lo:[0,0,1] neg_hi:[0,0,1]
  v_pk_fma_f32 v[206:207], v[86:87], s[92:93], v[120:121] op_sel_hi:[1,1,0] neg_lo:[0,0,1] neg_hi:[0,0,1]
  v_cvt_pk_bf16_f32 v204, 0, v204
  v_mul_f32 v142, v151, v142
  v_cvt_pk_bf16_f32 v205, 0, v205
  v_mul_f32 v143, v151, v143
  v_cvt_pk_bf16_f32 v206, 0, v206
  v_cvt_pk_bf16_f32 v207, 0, v207
  v_pk_mul_f32 v[204:205], v[204:205], v[120:121] op_sel:[0,1]
  v_pk_mul_f32 v[206:207], v[206:207], v[120:121] op_sel:[0,1]
  s_waitcnt vmcnt(14)
  s_cbranch_vccnz L_vw0_21
  s_waitcnt vmcnt(10)
L_vw0_21:
  buffer_load_dwordx4 v[60:63], v93, s[12:15], s61 offen offset:0 nt
  v_mov_b32_dpp v120, v118 row_newbcast:7 row_mask:0xf bank_mask:0xf
  v_mov_b32_dpp v121, v119 row_newbcast:7 row_mask:0xf bank_mask:0xf
  v_pk_fma_f32 v[112:113], v[88:89], s[92:93], v[120:121] op_sel_hi:[1,1,0] neg_lo:[0,0,1] neg_hi:[0,0,1]
  v_pk_fma_f32 v[114:115], v[90:91], s[92:93], v[120:121] op_sel_hi:[1,1,0] neg_lo:[0,0,1] neg_hi:[0,0,1]
  v_cvt_pk_bf16_f32 v112, 0, v112
  v_cvt_pk_bf16_f32 v113, 0, v113
  v_cvt_pk_bf16_f32 v114, 0, v114
  v_cvt_pk_bf16_f32 v115, 0, v115
  v_pk_mul_f32 v[112:113], v[112:113], v[120:121] op_sel:[0,1]
  v_pk_mul_f32 v[114:115], v[114:115], v[120:121] op_sel:[0,1]
  v_cvt_pk_bf16_f32 v211, v196, v112
  v_cvt_pk_bf16_f32 v215, v197, v113
  v_cvt_pk_bf16_f32 v219, v198, v114
  v_cvt_pk_bf16_f32 v223, v199, v115
  v_mfma_f32_16x16x32_bf16 v[132:135], v[172:175], v[208:211], v[132:135]
  v_mfma_f32_16x16x32_bf16 v[132:135], v[176:179], v[212:215], v[132:135]
  v_mfma_f32_16x16x32_bf16 v[132:135], v[180:183], v[216:219], v[132:135]
  v_mfma_f32_16x16x32_bf16 v[132:135], v[184:187], v[220:223], v[132:135]
  s_waitcnt vmcnt(14)
  s_cbranch_vccnz L_vw0_22
  s_waitcnt vmcnt(10)
L_vw0_22:
  buffer_load_dwordx4 v[64:67], v93, s[12:15], s61 offen offset:256 nt
  v_pk_fma_f32 v[112:113], v[4:5], s[92:93], v[120:121] op_sel_hi:[1,1,0] neg_lo:[0,0,1] neg_hi:[0,0,1]
  v_pk_fma_f32 v[114:115], v[6:7], s[92:93], v[120:121] op_sel_hi:[1,1,0] neg_lo:[0,0,1] neg_hi:[0,0,1]
  v_cvt_pk_bf16_f32 v112, 0, v112
  v_cvt_pk_bf16_f32 v113, 0, v113
  v_cvt_pk_bf16_f32 v114, 0, v114
  v_cvt_pk_bf16_f32 v115, 0, v115
  v_pk_mul_f32 v[112:113], v[112:113], v[120:121] op_sel:[0,1]
  v_pk_mul_f32 v[114:115], v[114:115], v[120:121] op_sel:[0,1]
  v_cvt_pk_bf16_f32 v227, v200, v112
  v_cvt_pk_bf16_f32 v231, v201, v113
  v_cvt_pk_bf16_f32 v235, v202, v114
  v_cvt_pk_bf16_f32 v239, v203, v115
  v_mfma_f32_16x16x32_bf16 v[136:139], v[172:175], v[224:227], v[136:139]
  v_mfma_f32_16x16x32_bf16 v[136:139], v[176:179], v[228:231], v[136:139]
  v_mfma_f32_16x16x32_bf16 v[136:139], v[180:183], v[232:235], v[136:139]
  v_mfma_f32_16x16x32_bf16 v[136:139], v[184:187], v[236:239], v[136:139]
  s_waitcnt vmcnt(14)
  s_cbranch_vccnz L_vw0_23
  s_waitcnt vmcnt(10)
L_vw0_23:
  buffer_load_dwordx4 v[68:71], v93, s[12:15], s61 offen offset:512 nt
  v_pk_fma_f32 v[112:113], v[8:9], s[92:93], v[120:121] op_sel_hi:[1,1,0] neg_lo:[0,0,1] neg_hi:[0,0,1]
  v_pk_fma_f32 v[114:115], v[10:11], s[92:93], v[120:121] op_sel_hi:[1,1,0] neg_lo:[0,0,1] neg_hi:[0,0,1]
  v_cvt_pk_bf16_f32 v112, 0, v112
  v_cvt_pk_bf16_f32 v113, 0, v113
  v_cvt_pk_bf16_f32 v114, 0, v114
  v_cvt_pk_bf16_f32 v115, 0, v115
  v_pk_mul_f32 v[112:113], v[112:113], v[120:121] op_sel:[0,1]
  v_pk_mul_f32 v[114:115], v[114:115], v[120:121] op_sel:[0,1]
  v_cvt_pk_bf16_f32 v243, v204, v112
  v_cvt_pk_bf16_f32 v247, v205, v113
  v_cvt_pk_bf16_f32 v251, v206, v114
  v_cvt_pk_bf16_f32 v255, v207, v115
  v_mfma_f32_16x16x32_bf16 v[140:143], v[172:175], v[240:243], v[140:143]
  v_mfma_f32_16x16x32_bf16 v[140:143], v[176:179], v[244:247], v[140:143]
  v_mfma_f32_16x16x32_bf16 v[140:143], v[180:183], v[248:251], v[140:143]
  v_mfma_f32_16x16x32_bf16 v[140:143], v[184:187], v[252:255], v[140:143]
  s_waitcnt vmcnt(14)
  s_cbranch_vccnz L_vw0_24
  s_waitcnt vmcnt(10)
L_vw0_24:
  buffer_load_dwordx4 v[72:75], v93, s[12:15], s61 offen offset:768 nt
  v_mov_b32_dpp v120, v118 row_newbcast:8 row_mask:0xf bank_mask:0xf
  v_mov_b32_dpp v121, v119 row_newbcast:8 row_mask:0xf bank_mask:0xf
  v_pk_fma_f32 v[196:197], v[12:13], s[92:93], v[120:121] op_sel_hi:[1,1,0] neg_lo:[0,0,1] neg_hi:[0,0,1]
  v_pk_fma_f32 v[198:199], v[14:15], s[92:93], v[120:121] op_sel_hi:[1,1,0] neg_lo:[0,0,1] neg_hi:[0,0,1]
  v_cvt_pk_bf16_f32 v196, 0, v196
  v_cndmask_b32 v188, 0, v167, s[72:73]
  v_cvt_pk_bf16_f32 v197, 0, v197
  v_cndmask_b32 v189, 0, v168, s[72:73]
  v_cvt_pk_bf16_f32 v198, 0, v198
  v_cndmask_b32 v190, 0, v167, s[74:75]
  v_cvt_pk_bf16_f32 v199, 0, v199
  v_cndmask_b32 v191, 0, v168, s[74:75]
  v_pk_mul_f32 v[196:197], v[196:197], v[120:121] op_sel:[0,1]
  v_cndmask_b32 v192, 0, v167, s[76:77]
  v_pk_mul_f32 v[198:199], v[198:199], v[120:121] op_sel:[0,1]
  s_waitcnt vmcnt(14)
  s_cbranch_vccnz L_vw0_25
  s_waitcnt vmcnt(10)
L_vw0_25:
  buffer_load_dwordx4 v[76:79], v93, s[12:15], s61 offen offset:1024 nt
  v_pk_fma_f32 v[200:201], v[16:17], s[92:93], v[120:121] op_sel_hi:[1,1,0] neg_lo:[0,0,1] neg_hi:[0,0,1]
  v_pk_fma_f32 v[202:203], v[18:19], s[92:93], v[120:121] op_sel_hi:[1,1,0] neg_lo:[0,0,1] neg_hi:[0,0,1]
  v_cvt_pk_bf16_f32 v200, 0, v200
  v_cndmask_b32 v193, 0, v168, s[76:77]
  v_cvt_pk_bf16_f32 v201, 0, v201
  v_cndmask_b32 v194, 0, v167, s[78:79]
  v_cvt_pk_bf16_f32 v202, 0, v202
  v_cndmask_b32 v195, 0, v168, s[78:79]
  v_cvt_pk_bf16_f32 v203, 0, v203
  v_pk_mul_f32 v[200:201], v[200:201], v[120:121] op_sel:[0,1]
  v_pk_mul_f32 v[202:203], v[202:203], v[120:121] op_sel:[0,1]
  s_waitcnt vmcnt(14)
  s_cbranch_vccnz L_vw0_26
  s_waitcnt vmcnt(10)
L_vw0_26:
  buffer_load_dwordx4 v[80:83], v93, s[12:15], s61 offen offset:1280 nt
  v_pk_fma_f32 v[204:205], v[20:21], s[92:93], v[120:121] op_sel_hi:[1,1,0] neg_lo:[0,0,1] neg_hi:[0,0,1]
  v_pk_fma_f32 v[206:207], v[22:23], s[92:93], v[120:121] op_sel_hi:[1,1,0] neg_lo:[0,0,1] neg_hi:[0,0,1]
  v_cvt_pk_bf16_f32 v204, 0, v204
  v_cvt_pk_bf16_f32 v205, 0, v205
  v_cvt_pk_bf16_f32 v206, 0, v206
  v_cvt_pk_bf16_f32 v207, 0, v207
  v_pk_mul_f32 v[204:205], v[204:205], v[120:121] op_sel:[0,1]
  v_pk_mul_f32 v[206:207], v[206:207], v[120:121] op_sel:[0,1]
  s_waitcnt vmcnt(14)
  s_cbranch_vccnz L_vw0_27
  s_waitcnt vmcnt(10)
L_vw0_27:
  buffer_load_dwordx4 v[84:87], v93, s[12:15], s61 offen offset:1536 nt
  v_mov_b32_dpp v120, v118 row_newbcast:9 row_mask:0xf bank_mask:0xf
  v_mov_b32_dpp v121, v119 row_newbcast:9 row_mask:0xf bank_mask:0xf
  v_pk_fma_f32 v[112:113], v[24:25], s[92:93], v[120:121] op_sel_hi:[1,1,0] neg_lo:[0,0,1] neg_hi:[0,0,1]
  v_pk_fma_f32 v[114:115], v[26:27], s[92:93], v[120:121] op_sel_hi:[1,1,0] neg_lo:[0,0,1] neg_hi:[0,0,1]
  v_cvt_pk_bf16_f32 v112, 0, v112
  v_cvt_pk_bf16_f32 v113, 0, v113
  v_cvt_pk_bf16_f32 v114, 0, v114
  v_cvt_pk_bf16_f32 v115, 0, v115
  v_pk_mul_f32 v[112:113], v[112:113], v[120:121] op_sel:[0,1]
  v_pk_mul_f32 v[114:115], v[114:115], v[120:121] op_sel:[0,1]
  v_cvt_pk_bf16_f32 v208, v196, v112
  v_cvt_pk_bf16_f32 v212, v197, v113
  v_cvt_pk_bf16_f32 v216, v198, v114
  v_cvt_pk_bf16_f32 v220, v199, v115
  s_waitcnt vmcnt(14)
  s_cbranch_vccnz L_vw0_28
  s_waitcnt vmcnt(10)
L_vw0_28:
  buffer_load_dwordx4 v[88:91], v93, s[12:15], s61 offen offset:1792 nt
  v_pk_fma_f32 v[112:113], v[28:29], s[92:93], v[120:121] op_sel_hi:[1,1,0] neg_lo:[0,0,1] neg_hi:[0,0,1]
  v_pk_fma_f32 v[114:115], v[30:31], s[92:93], v[120:121] op_sel_hi:[1,1,0] neg_lo:[0,0,1] neg_hi:[0,0,1]
  v_cvt_pk_bf16_f32 v112, 0, v112
  v_cvt_pk_bf16_f32 v113, 0, v113
  v_cvt_pk_bf16_f32 v114, 0, v114
  v_cvt_pk_bf16_f32 v115, 0, v115
  v_pk_mul_f32 v[112:113], v[112:113], v[120:121] op_sel:[0,1]
  v_pk_mul_f32 v[114:115], v[114:115], v[120:121] op_sel:[0,1]
  v_cvt_pk_bf16_f32 v224, v200, v112
  v_cvt_pk_bf16_f32 v228, v201, v113
  v_cvt_pk_bf16_f32 v232, v202, v114
  v_cvt_pk_bf16_f32 v236, v203, v115
  s_waitcnt vmcnt(14)
  s_cbranch_vccnz L_vw0_29
  s_waitcnt vmcnt(10)
L_vw0_29:
  buffer_load_dwordx4 v[4:7], v93, s[12:15], s61 offen offset:2048 nt
  v_pk_fma_f32 v[112:113], v[32:33], s[92:93], v[120:121] op_sel_hi:[1,1,0] neg_lo:[0,0,1] neg_hi:[0,0,1]
  v_pk_fma_f32 v[114:115], v[34:35], s[92:93], v[120:121] op_sel_hi:[1,1,0] neg_lo:[0,0,1] neg_hi:[0,0,1]
  v_cvt_pk_bf16_f32 v112, 0, v112
  v_cvt_pk_bf16_f32 v113, 0, v113
  v_cvt_pk_bf16_f32 v114, 0, v114
  v_cvt_pk_bf16_f32 v115, 0, v115
  v_pk_mul_f32 v[112:113], v[112:113], v[120:121] op_sel:[0,1]
  v_pk_mul_f32 v[114:115], v[114:115], v[120:121] op_sel:[0,1]
  v_cvt_pk_bf16_f32 v240, v204, v112
  v_cvt_pk_bf16_f32 v244, v205, v113
  v_cvt_pk_bf16_f32 v248, v206, v114
  v_cvt_pk_bf16_f32 v252, v207, v115
  s_waitcnt vmcnt(14)
  s_cbranch_vccnz L_vw0_30
  s_waitcnt vmcnt(10)
L_vw0_30:
  buffer_load_dwordx4 v[8:11], v93, s[12:15], s61 offen offset:2304 nt
  v_mov_b32_dpp v120, v118 row_newbcast:10 row_mask:0xf bank_mask:0xf
  v_mov_b32_dpp v121, v119 row_newbcast:10 row_mask:0xf bank_mask:0xf
  v_pk_fma_f32 v[196:197], v[36:37], s[92:93], v[120:121] op_sel_hi:[1,1,0] neg_lo:[0,0,1] neg_hi:[0,0,1]
  v_pk_fma_f32 v[198:199], v[38:39], s[92:93], v[120:121] op_sel_hi:[1,1,0] neg_lo:[0,0,1] neg_hi:[0,0,1]
  v_cvt_pk_bf16_f32 v196, 0, v196
  v_cvt_pk_bf16_f32 v197, 0, v197
  v_cvt_pk_bf16_f32 v198, 0, v198
  v_cvt_pk_bf16_f32 v199, 0, v199
  v_pk_mul_f32 v[196:197], v[196:197], v[120:121] op_sel:[0,1]
  v_pk_mul_f32 v[198:199], v[198:199], v[120:121] op_sel:[0,1]
  v_cvt_pk_bf16_f32 v209, v196, 0
  v_cvt_pk_bf16_f32 v213, v197, 0
  v_cvt_pk_bf16_f32 v217, v198, 0
  v_cvt_pk_bf16_f32 v221, v199, 0
  v_mfma_f32_16x16x16_bf16 v[132:135], v[188:189], v[208:209], v[132:135]
  v_mfma_f32_16x16x16_bf16 v[132:135], v[190:191], v[212:213], v[132:135]
  v_mfma_f32_16x16x16_bf16 v[132:135], v[192:193], v[216:217], v[132:135]
  v_mfma_f32_16x16x16_bf16 v[132:135], v[194:195], v[220:221], v[132:135]
  s_waitcnt vmcnt(14)
  s_cbranch_vccnz L_vw0_31
  s_waitcnt vmcnt(10)
L_vw0_31:
  buffer_load_dwordx4 v[12:15], v93, s[12:15], s61 offen offset:2560 nt
  v_pk_fma_f32 v[200:201], v[40:41], s[92:93], v[120:121] op_sel_hi:[1,1,0] neg_lo:[0,0,1] neg_hi:[0,0,1]
  v_pk_fma_f32 v[202:203], v[42:43], s[92:93], v[120:121] op_sel_hi:[1,1,0] neg_lo:[0,0,1] neg_hi:[0,0,1]
  v_cvt_pk_bf16_f32 v200, 0, v200
  v_cvt_pk_bf16_f32 v201, 0, v201
  v_cvt_pk_bf16_f32 v202, 0, v202
  v_cvt_pk_bf16_f32 v203, 0, v203
  v_pk_mul_f32 v[200:201], v[200:201], v[120:121] op_sel:[0,1]
  v_pk_mul_f32 v[202:203], v[202:203], v[120:121] op_sel:[0,1]
  v_cvt_pk_bf16_f32 v225, v200, 0
  v_cvt_pk_bf16_f32 v229, v201, 0
  v_cvt_pk_bf16_f32 v233, v202, 0
  v_cvt_pk_bf16_f32 v237, v203, 0
  v_mfma_f32_16x16x16_bf16 v[136:139], v[188:189], v[224:225], v[136:139]
  v_mfma_f32_16x16x16_bf16 v[136:139], v[190:191], v[228:229], v[136:139]
  v_mfma_f32_16x16x16_bf16 v[136:139], v[192:193], v[232:233], v[136:139]
  v_mfma_f32_16x16x16_bf16 v[136:139], v[194:195], v[236:237], v[136:139]
  s_waitcnt vmcnt(14)
  s_cbranch_vccnz L_vw0_32
  s_waitcnt vmcnt(10)
L_vw0_32:
  buffer_load_dwordx4 v[16:19], v93, s[12:15], s61 offen offset:2816 nt
  v_pk_fma_f32 v[204:205], v[44:45], s[92:93], v[120:121] op_sel_hi:[1,1,0] neg_lo:[0,0,1] neg_hi:[0,0,1]
  v_pk_fma_f32 v[206:207], v[46:47], s[92:93], v[120:121] op_sel_hi:[1,1,0] neg_lo:[0,0,1] neg_hi:[0,0,1]
  v_cvt_pk_bf16_f32 v204, 0, v204
  v_cvt_pk_bf16_f32 v205, 0, v205
  v_cvt_pk_bf16_f32 v206, 0, v206
  v_cvt_pk_bf16_f32 v207, 0, v207
  v_pk_mul_f32 v[204:205], v[204:205], v[120:121] op_sel:[0,1]
  v_pk_mul_f32 v[206:207], v[206:207], v[120:121] op_sel:[0,1]
  v_cvt_pk_bf16_f32 v241, v204, 0
  v_cvt_pk_bf16_f32 v245, v205, 0
  v_cvt_pk_bf16_f32 v249, v206, 0
  v_cvt_pk_bf16_f32 v253, v207, 0
  v_mfma_f32_16x16x16_bf16 v[140:143], v[188:189], v[240:241], v[140:143]
  v_mfma_f32_16x16x16_bf16 v[140:143], v[190:191], v[244:245], v[140:143]
  v_mfma_f32_16x16x16_bf16 v[140:143], v[192:193], v[248:249], v[140:143]
  v_mfma_f32_16x16x16_bf16 v[140:143], v[194:195], v[252:253], v[140:143]
  s_mov_b32 s60, s61
  s_cmp_eq_u32 s89, s88
  s_cbranch_scc1 L_v1
  s_mov_b32 s88, s89
  v_mov_b32 v149, v147
  s_nop 1
  v_permlane32_swap_b32 v147, v149
  v_add_f32 v147, v147, v149
  v_mov_b32 v149, v147
  s_nop 1
  v_permlane16_swap_b32 v147, v149
  v_add_f32 v147, v147, v149
  ds_write_b64 v106, v[146:147]
  ds_write_b128 v105, v[132:135] offset:0
  ds_write_b128 v105, v[136:139] offset:1024
  ds_write_b128 v105, v[140:143] offset:2048
  s_and_b32 s70, s86, 15
  s_cmp_ge_u32 s70, 12
  s_cselect_b32 s70, 2, 0
  s_and_b32 s71, s87, 1
  s_bitcmp1_b32 s96, 6
  s_cselect_b32 s71, s4, s71
  s_add_u32 s70, s70, s71
  s_lshr_b32 s71, s86, 4
  s_lshl2_add_u32 s70, s71, s70
  s_add_u32 s71, s3, 0
  s_cmp_eq_u32 s100, s71
  s_cselect_b32 s44, s70, s44
  s_add_u32 s71, s3, 2
  s_cmp_eq_u32 s100, s71
  s_cselect_b32 s45, s70, s45
  s_add_u32 s100, s100, 1
  s_waitcnt lgkmcnt(0)
  v_add_u32 v105, 6208, v105
  v_add_u32 v106, 6208, v106
  v_mov_b32 v132, 0
  v_mov_b32 v133, 0
  v_mov_b32 v134, 0
  v_mov_b32 v135, 0
  v_mov_b32 v136, 0
  v_mov_b32 v137, 0
  v_mov_b32 v138, 0
  v_mov_b32 v139, 0
  v_mov_b32 v140, 0
  v_mov_b32 v141, 0
  v_mov_b32 v142, 0
  v_mov_b32 v143, 0
  v_mov_b32 v144, 0xff800000
  v_mov_b32 v146, 0x7f800000
  v_mov_b32 v147, 0
L_v1:
  s_mov_b32 s86, s84
  s_mov_b32 s87, s85
  s_add_u32 s64, s64, 2
  s_cmp_lt_u32 s64, s99
  s_cbranch_scc1 L_v11_ok
L_v11_spin:
  v_mov_b32 v148, 61700
  ds_read_b32 v148, v148
  s_waitcnt lgkmcnt(0)
  v_readfirstlane_b32 s99, v148
  s_nop 1
  s_cmp_lt_u32 s64, s99
  s_cbranch_scc0 L_v11_spin
L_v11_ok:
  s_andn2_b32 s70, s64, 1
  s_or_b32 s70, s70, s4
  s_lshr_b32 s71, s64, 5
  s_lshr_b32 s85, s96, s71
  s_lshr_b32 s85, s85, 3
  s_cmp_lt_u32 s64, s97
  s_cselect_b32 s70, s70, s64
  s_cselect_b32 s85, s64, s85
  s_and_b32 s85, s85, 1
  s_mul_i32 s71, s71, 4064
  s_add_u32 s70, s70, s71
  s_add_u32 s70, s70, s5
  s_mul_hi_u32 s84, s70, s90
  s_lshr_b32 s84, s84, 1
  s_mul_i32 s71, s84, 3
  s_sub_u32 s70, s70, s71
  s_lshl3_add_u32 s85, s70, s85
  s_mul_i32 s61, s84, 196608
  s_lshr_b32 s89, s84, 4
  s_lshl_b32 s70, s85, 5
  v_add_u32 v100, s70, v96
  v_mul_u32_u24 v100, 21846, v100
  v_lshrrev_b32 v100, 16, v100
  v_add_u32 v148, s85, v97
  v_lshrrev_b32 v149, v148, s91
  v_and_b32 v149, 1, v149
  v_cmp_eq_u32 s[54:55], 1, v149
  s_nop 1
  s_and_b64 s[52:53], s[54:55], s[58:59]
  s_andn2_b64 s[54:55], s[54:55], s[58:59]
  s_cmp_lt_u32 s64, 96
  s_cselect_b32 s61, s61, 805306368
  s_add_u32 s70, s64, 94
  v_mov_b32 v150, s70
  ds_read_b32 v110, v109
  ds_write_b32 v107, v150
  s_waitcnt vmcnt(14)
  s_cbranch_vccnz L_vw1_0
  s_waitcnt vmcnt(10)
L_vw1_0:
  buffer_load_dwordx4 v[20:23], v93, s[12:15], s60 offen offset:3072 nt
  v_mul_f32 v118, s94, v116
  v_mul_f32 v119, 0x4a800000, v117
  s_nop 0
  v_mov_b32_dpp v120, v118 row_newbcast:0 row_mask:0xf bank_mask:0xf
  v_mov_b32_dpp v121, v119 row_newbcast:0 row_mask:0xf bank_mask:0xf
  v_pk_fma_f32 v[196:197], v[48:49], s[92:93], v[120:121] op_sel_hi:[1,1,0] neg_lo:[0,0,1] neg_hi:[0,0,1]
  v_pk_fma_f32 v[198:199], v[50:51], s[92:93], v[120:121] op_sel_hi:[1,1,0] neg_lo:[0,0,1] neg_hi:[0,0,1]
  v_cvt_pk_bf16_f32 v196, 0, v196
  s_waitcnt lgkmcnt(0)
  v_cvt_pk_bf16_f32 v197, 0, v197
  v_cmp_lt_u32 vcc, v150, v110
  v_cvt_pk_bf16_f32 v198, 0, v198
  v_lshlrev_b32 v152, 16, v124
  v_cvt_pk_bf16_f32 v199, 0, v199
  v_and_b32 v153, s65, v124
  v_pk_mul_f32 v[196:197], v[196:197], v[120:121] op_sel:[0,1]
  v_lshlrev_b32 v154, 16, v125
  v_pk_mul_f32 v[198:199], v[198:199], v[120:121] op_sel:[0,1]
  s_waitcnt vmcnt(14)
  s_cbranch_vccnz L_vw1_1
  s_waitcnt vmcnt(10)
L_vw1_1:
  buffer_load_dwordx4 v[24:27], v93, s[12:15], s60 offen offset:3328 nt
  v_pk_fma_f32 v[200:201], v[52:53], s[92:93], v[120:121] op_sel_hi:[1,1,0] neg_lo:[0,0,1] neg_hi:[0,0,1]
  v_pk_fma_f32 v[202:203], v[54:55], s[92:93], v[120:121] op_sel_hi:[1,1,0] neg_lo:[0,0,1] neg_hi:[0,0,1]
  v_cvt_pk_bf16_f32 v200, 0, v200
  v_and_b32 v155, s65, v125
  v_cvt_pk_bf16_f32 v201, 0, v201
  v_lshlrev_b32 v156, 16, v126
  v_cvt_pk_bf16_f32 v202, 0, v202
  v_and_b32 v157, s65, v126
  v_cvt_pk_bf16_f32 v203, 0, v203
  v_lshlrev_b32 v158, 16, v127
  v_pk_mul_f32 v[200:201], v[200:201], v[120:121] op_sel:[0,1]
  v_and_b32 v159, s65, v127
  v_pk_mul_f32 v[202:203], v[202:203], v[120:121] op_sel:[0,1]
  s_waitcnt vmcnt(14)
  s_cbranch_vccnz L_vw1_2
  s_waitcnt vmcnt(10)
L_vw1_2:
  buffer_load_dwordx4 v[28:31], v93, s[12:15], s60 offen offset:3584 nt
  v_pk_fma_f32 v[204:205], v[56:57], s[92:93], v[120:121] op_sel_hi:[1,1,0] neg_lo:[0,0,1] neg_hi:[0,0,1]
  v_pk_fma_f32 v[206:207], v[58:59], s[92:93], v[120:121] op_sel_hi:[1,1,0] neg_lo:[0,0,1] neg_hi:[0,0,1]
  v_cvt_pk_bf16_f32 v204, 0, v204
  v_lshlrev_b32 v160, 16, v128
  v_cvt_pk_bf16_f32 v205, 0, v205
  v_and_b32 v161, s65, v128
  v_cvt_pk_bf16_f32 v206, 0, v206
  v_lshlrev_b32 v162, 16, v129
  v_cvt_pk_bf16_f32 v207, 0, v207
  v_add_u32 v102, 768, v102
  v_pk_mul_f32 v[204:205], v[204:205], v[120:121] op_sel:[0,1]
  v_add_u32 v103, 768, v103
  v_pk_mul_f32 v[206:207], v[206:207], v[120:121] op_sel:[0,1]
  s_waitcnt vmcnt(14)
  s_cbranch_vccnz L_vw1_3
  s_waitcnt vmcnt(10)
L_vw1_3:
  buffer_load_dwordx4 v[32:35], v94, s[12:15], s60 offen offset:0 nt
  v_mov_b32_dpp v120, v118 row_newbcast:1 row_mask:0xf bank_mask:0xf
  v_mov_b32_dpp v121, v119 row_newbcast:1 row_mask:0xf bank_mask:0xf
  v_pk_fma_f32 v[112:113], v[60:61], s[92:93], v[120:121] op_sel_hi:[1,1,0] neg_lo:[0,0,1] neg_hi:[0,0,1]
  v_pk_fma_f32 v[114:115], v[62:63], s[92:93], v[120:121] op_sel_hi:[1,1,0] neg_lo:[0,0,1] neg_hi:[0,0,1]
  s_lshl_b32 s62, s84, 9
  v_lshl_add_u32 v101, v100, 1, v99
  buffer_load_short_d16_hi v116, v101, s[32:35], s62 offen
  buffer_load_short_d16_hi v117, v101, s[28:31], s62 offen
  v_cvt_pk_bf16_f32 v112, 0, v112
  v_max3_f32 v148, v152, v153, v154
  v_cvt_pk_bf16_f32 v113, 0, v113
  ds_read_b128 v[124:127], v102
  v_cvt_pk_bf16_f32 v114, 0, v114
  ds_read_b64 v[128:129], v103 offset:256
  v_cvt_pk_bf16_f32 v115, 0, v115
  v_max3_f32 v149, v155, v156, v157
  v_pk_mul_f32 v[112:113], v[112:113], v[120:121] op_sel:[0,1]
  v_max3_f32 v148, v148, v158, v159
  v_pk_mul_f32 v[114:115], v[114:115], v[120:121] op_sel:[0,1]
  v_cvt_pk_bf16_f32 v208, v196, v112
  v_cvt_pk_bf16_f32 v212, v197, v113
  v_cvt_pk_bf16_f32 v216, v198, v114
  v_cvt_pk_bf16_f32 v220, v199, v115
  s_waitcnt vmcnt(16)
  s_cbranch_vccnz L_vw1_4
  s_waitcnt vmcnt(12)
L_vw1_4:
  buffer_load_dwordx4 v[36:39], v94, s[12:15], s60 offen offset:256 nt
  v_pk_fma_f32 v[112:113], v[64:65], s[92:93], v[120:121] op_sel_hi:[1,1,0] neg_lo:[0,0,1] neg_hi:[0,0,1]
  v_pk_fma_f32 v[114:115], v[66:67], s[92:93], v[120:121] op_sel_hi:[1,1,0] neg_lo:[0,0,1] neg_hi:[0,0,1]
  v_cvt_pk_bf16_f32 v112, 0, v112
  v_max3_f32 v149, v149, v160, v161
  v_cvt_pk_bf16_f32 v113, 0, v113
  v_max3_f32 v148, v148, v162, v144
  v_cvt_pk_bf16_f32 v114, 0, v114
  v_max_f32 v148, v148, v149
  v_cvt_pk_bf16_f32 v115, 0, v115
  v_mov_b32 v149, v148
  v_pk_mul_f32 v[112:113], v[112:113], v[120:121] op_sel:[0,1]
  s_nop 0
  v_permlane32_swap_b32 v148, v149
  v_pk_mul_f32 v[114:115], v[114:115], v[120:121] op_sel:[0,1]
  v_cvt_pk_bf16_f32 v224, v200, v112
  v_cvt_pk_bf16_f32 v228, v201, v113
  v_cvt_pk_bf16_f32 v232, v202, v114
  v_cvt_pk_bf16_f32 v236, v203, v115
  s_waitcnt vmcnt(16)
  s_cbranch_vccnz L_vw1_5
  s_waitcnt vmcnt(12)
L_vw1_5:
  buffer_load_dwordx4 v[40:43], v94, s[12:15], s60 offen offset:512 nt
  v_pk_fma_f32 v[112:113], v[68:69], s[92:93], v[120:121] op_sel_hi:[1,1,0] neg_lo:[0,0,1] neg_hi:[0,0,1]
  v_pk_fma_f32 v[114:115], v[70:71], s[92:93], v[120:121] op_sel_hi:[1,1,0] neg_lo:[0,0,1] neg_hi:[0,0,1]
  v_cvt_pk_bf16_f32 v112, 0, v112
  v_max_f32 v148, v148, v149
  v_cvt_pk_bf16_f32 v113, 0, v113
  v_mov_b32 v149, v148
  v_cvt_pk_bf16_f32 v114, 0, v114
  s_nop 0
  v_permlane16_swap_b32 v148, v149
  v_cvt_pk_bf16_f32 v115, 0, v115
  v_max_f32 v144, v148, v149
  v_pk_mul_f32 v[112:113], v[112:113], v[120:121] op_sel:[0,1]
  v_mul_f32 v148, s66, v144
  v_pk_mul_f32 v[114:115], v[114:115], v[120:121] op_sel:[0,1]
  v_cvt_pk_bf16_f32 v240, v204, v112
  v_cvt_pk_bf16_f32 v244, v205, v113
  v_cvt_pk_bf16_f32 v248, v206, v114
  v_cvt_pk_bf16_f32 v252, v207, v115
  s_waitcnt vmcnt(16)
  s_cbranch_vccnz L_vw1_6
  s_waitcnt vmcnt(12)
L_vw1_6:
  buffer_load_dwordx4 v[44:47], v94, s[12:15], s60 offen offset:768 nt
  v_mov_b32_dpp v120, v118 row_newbcast:2 row_mask:0xf bank_mask:0xf
  v_mov_b32_dpp v121, v119 row_newbcast:2 row_mask:0xf bank_mask:0xf
  v_pk_fma_f32 v[196:197], v[72:73], s[92:93], v[120:121] op_sel_hi:[1,1,0] neg_lo:[0,0,1] neg_hi:[0,0,1]
  v_pk_fma_f32 v[198:199], v[74:75], s[92:93], v[120:121] op_sel_hi:[1,1,0] neg_lo:[0,0,1] neg_hi:[0,0,1]
  v_cvt_pk_bf16_f32 v196, 0, v196
  v_add_f32 v150, v148, v146
  v_cvt_pk_bf16_f32 v197, 0, v197
  v_sub_f32 v146, 0, v148
  v_cvt_pk_bf16_f32 v198, 0, v198
  v_exp_f32 v150, -v150
  v_cvt_pk_bf16_f32 v199, 0, v199
  ds_bpermute_b32 v151, v104, v150
  v_pk_mul_f32 v[196:197], v[196:197], v[120:121] op_sel:[0,1]
  v_fma_f32 v152, v152, s66, v146
  v_pk_mul_f32 v[198:199], v[198:199], v[120:121] op_sel:[0,1]
  s_waitcnt vmcnt(16)
  s_cbranch_vccnz L_vw1_7
  s_waitcnt vmcnt(12)
L_vw1_7:
  buffer_load_dwordx4 v[48:51], v94, s[12:15], s60 offen offset:1024 nt
  v_pk_fma_f32 v[200:201], v[76:77], s[92:93], v[120:121] op_sel_hi:[1,1,0] neg_lo:[0,0,1] neg_hi:[0,0,1]
  v_pk_fma_f32 v[202:203], v[78:79], s[92:93], v[120:121] op_sel_hi:[1,1,0] neg_lo:[0,0,1] neg_hi:[0,0,1]
  v_cvt_pk_bf16_f32 v200, 0, v200
  v_exp_f32 v152, v152
  v_cvt_pk_bf16_f32 v201, 0, v201
  v_fma_f32 v153, v153, s66, v146
  v_cvt_pk_bf16_f32 v202, 0, v202
  v_exp_f32 v153, v153
  v_cvt_pk_bf16_f32 v203, 0, v203
  v_fma_f32 v154, v154, s66, v146
  v_pk_mul_f32 v[200:201], v[200:201], v[120:121] op_sel:[0,1]
  v_exp_f32 v154, v154
  v_pk_mul_f32 v[202:203], v[202:203], v[120:121] op_sel:[0,1]
  s_waitcnt vmcnt(16)
  s_cbranch_vccnz L_vw1_8
  s_waitcnt vmcnt(12)
L_vw1_8:
  buffer_load_dwordx4 v[52:55], v94, s[12:15], s60 offen offset:1280 nt
  v_pk_fma_f32 v[204:205], v[80:81], s[92:93], v[120:121] op_sel_hi:[1,1,0] neg_lo:[0,0,1] neg_hi:[0,0,1]
  v_pk_fma_f32 v[206:207], v[82:83], s[92:93], v[120:121] op_sel_hi:[1,1,0] neg_lo:[0,0,1] neg_hi:[0,0,1]
  v_cvt_pk_bf16_f32 v204, 0, v204
  v_fma_f32 v155, v155, s66, v146
  v_cvt_pk_bf16_f32 v205, 0, v205
  v_exp_f32 v155, v155
  v_cvt_pk_bf16_f32 v206, 0, v206
  v_fma_f32 v156, v156, s66, v146
  v_cvt_pk_bf16_f32 v207, 0, v207
  v_exp_f32 v156, v156
  v_pk_mul_f32 v[204:205], v[204:205], v[120:121] op_sel:[0,1]
  v_fma_f32 v157, v157, s66, v146
  v_pk_mul_f32 v[206:207], v[206:207], v[120:121] op_sel:[0,1]
  s_waitcnt vmcnt(16)
  s_cbranch_vccnz L_vw1_9
  s_waitcnt vmcnt(12)
L_vw1_9:
  buffer_load_dwordx4 v[56:59], v94, s[12:15], s60 offen offset:1536 nt
  v_mov_b32_dpp v120, v118 row_newbcast:3 row_mask:0xf bank_mask:0xf
  v_mov_b32_dpp v121, v119 row_newbcast:3 row_mask:0xf bank_mask:0xf
  v_pk_fma_f32 v[112:113], v[84:85], s[92:93], v[120:121] op_sel_hi:[1,1,0] neg_lo:[0,0,1] neg_hi:[0,0,1]
  v_pk_fma_f32 v[114:115], v[86:87], s[92:93], v[120:121] op_sel_hi:[1,1,0] neg_lo:[0,0,1] neg_hi:[0,0,1]
  v_cvt_pk_bf16_f32 v112, 0, v112
  v_exp_f32 v157, v157
  v_cvt_pk_bf16_f32 v113, 0, v113
  v_fma_f32 v158, v158, s66, v146
  v_cvt_pk_bf16_f32 v114, 0, v114
  v_exp_f32 v158, v158
  v_cvt_pk_bf16_f32 v115, 0, v115
  v_fma_f32 v159, v159, s66, v146
  v_pk_mul_f32 v[112:113], v[112:113], v[120:121] op_sel:[0,1]
  v_exp_f32 v159, v159
  v_pk_mul_f32 v[114:115], v[114:115], v[120:121] op_sel:[0,1]
  v_cvt_pk_bf16_f32 v209, v196, v112
  v_cvt_pk_bf16_f32 v213, v197, v113
  v_cvt_pk_bf16_f32 v217, v198, v114
  v_cvt_pk_bf16_f32 v221, v199, v115
  s_waitcnt vmcnt(16)
  s_cbranch_vccnz L_vw1_10
  s_waitcnt vmcnt(12)
L_vw1_10:
  buffer_load_dwordx4 v[60:63], v94, s[12:15], s60 offen offset:1792 nt
  v_pk_fma_f32 v[112:113], v[88:89], s[92:93], v[120:121] op_sel_hi:[1,1,0] neg_lo:[0,0,1] neg_hi:[0,0,1]
  v_pk_fma_f32 v[114:115], v[90:91], s[92:93], v[120:121] op_sel_hi:[1,1,0] neg_lo:[0,0,1] neg_hi:[0,0,1]
  v_cvt_pk_bf16_f32 v112, 0, v112
  v_fma_f32 v160, v160, s66, v146
  v_cvt_pk_bf16_f32 v113, 0, v113
  v_exp_f32 v160, v160
  v_cvt_pk_bf16_f32 v114, 0, v114
  v_fma_f32 v161, v161, s66, v146
  v_cvt_pk_bf16_f32 v115, 0, v115
  v_exp_f32 v161, v161
  v_pk_mul_f32 v[112:113], v[112:113], v[120:121] op_sel:[0,1]
  v_fma_f32 v162, v162, s66, v146
  v_pk_mul_f32 v[114:115], v[114:115], v[120:121] op_sel:[0,1]
  v_cvt_pk_bf16_f32 v225, v200, v112
  v_cvt_pk_bf16_f32 v229, v201, v113
  v_cvt_pk_bf16_f32 v233, v202, v114
  v_cvt_pk_bf16_f32 v237, v203, v115
  s_waitcnt vmcnt(16)
  s_cbranch_vccnz L_vw1_11
  s_waitcnt vmcnt(12)
L_vw1_11:
  buffer_load_dwordx4 v[64:67], v94, s[12:15], s60 offen offset:2048 nt
  v_pk_fma_f32 v[112:113], v[4:5], s[92:93], v[120:121] op_sel_hi:[1,1,0] neg_lo:[0,0,1] neg_hi:[0,0,1]
  v_pk_fma_f32 v[114:115], v[6:7], s[92:93], v[120:121] op_sel_hi:[1,1,0] neg_lo:[0,0,1] neg_hi:[0,0,1]
  v_cvt_pk_bf16_f32 v112, 0, v112
  v_exp_f32 v162, v162
  v_cvt_pk_bf16_f32 v113, 0, v113
  v_add_f32 v148, v152, v153
  v_cvt_pk_bf16_f32 v114, 0, v114
  v_add_f32 v149, v154, v155
  v_cvt_pk_bf16_f32 v115, 0, v115
  v_add_f32 v148, v148, v156
  v_pk_mul_f32 v[112:113], v[112:113], v[120:121] op_sel:[0,1]
  v_add_f32 v149, v149, v157
  v_pk_mul_f32 v[114:115], v[114:115], v[120:121] op_sel:[0,1]
  v_cvt_pk_bf16_f32 v241, v204, v112
  v_cvt_pk_bf16_f32 v245, v205, v113
  v_cvt_pk_bf16_f32 v249, v206, v114
  v_cvt_pk_bf16_f32 v253, v207, v115
  s_waitcnt vmcnt(16)
  s_cbranch_vccnz L_vw1_12
  s_waitcnt vmcnt(12)
L_vw1_12:
  buffer_load_dwordx4 v[68:71], v94, s[12:15], s60 offen offset:2304 nt
  v_mov_b32_dpp v120, v118 row_newbcast:4 row_mask:0xf bank_mask:0xf
  v_mov_b32_dpp v121, v119 row_newbcast:4 row_mask:0xf bank_mask:0xf
  v_pk_fma_f32 v[196:197], v[8:9], s[92:93], v[120:121] op_sel_hi:[1,1,0] neg_lo:[0,0,1] neg_hi:[0,0,1]
  v_pk_fma_f32 v[198:199], v[10:11], s[92:93], v[120:121] op_sel_hi:[1,1,0] neg_lo:[0,0,1] neg_hi:[0,0,1]
  v_cvt_pk_bf16_f32 v196, 0, v196
  v_add_f32 v148, v148, v158
  v_cvt_pk_bf16_f32 v197, 0, v197
  v_add_f32 v149, v149, v159
  v_cvt_pk_bf16_f32 v198, 0, v198
  v_add_f32 v148, v148, v160
  v_cvt_pk_bf16_f32 v199, 0, v199
  v_add_f32 v149, v149, v161
  v_pk_mul_f32 v[196:197], v[196:197], v[120:121] op_sel:[0,1]
  v_add_f32 v148, v148, v162
  v_pk_mul_f32 v[198:199], v[198:199], v[120:121] op_sel:[0,1]
  s_waitcnt vmcnt(16)
  s_cbranch_vccnz L_vw1_13
  s_waitcnt vmcnt(12)
L_vw1_13:
  buffer_load_dwordx4 v[72:75], v94, s[12:15], s60 offen offset:2560 nt
  v_pk_fma_f32 v[200:201], v[12:13], s[92:93], v[120:121] op_sel_hi:[1,1,0] neg_lo:[0,0,1] neg_hi:[0,0,1]
  v_pk_fma_f32 v[202:203], v[14:15], s[92:93], v[120:121] op_sel_hi:[1,1,0] neg_lo:[0,0,1] neg_hi:[0,0,1]
  v_cvt_pk_bf16_f32 v200, 0, v200
  v_add_f32 v148, v148, v149
  v_cvt_pk_bf16_f32 v201, 0, v201
  v_fma_f32 v147, v147, v150, v148
  v_cvt_pk_bf16_f32 v202, 0, v202
  v_cvt_pk_bf16_f32 v163, v152, v153
  v_cvt_pk_bf16_f32 v203, 0, v203
  v_cvt_pk_bf16_f32 v164, v154, v155
  v_pk_mul_f32 v[200:201], v[200:201], v[120:121] op_sel:[0,1]
  v_cvt_pk_bf16_f32 v165, v156, v157
  v_pk_mul_f32 v[202:203], v[202:203], v[120:121] op_sel:[0,1]
  s_waitcnt vmcnt(16)
  s_cbranch_vccnz L_vw1_14
  s_waitcnt vmcnt(12)
L_vw1_14:
  buffer_load_dwordx4 v[76:79], v94, s[12:15], s60 offen offset:2816 nt
  v_pk_fma_f32 v[204:205], v[16:17], s[92:93], v[120:121] op_sel_hi:[1,1,0] neg_lo:[0,0,1] neg_hi:[0,0,1]
  v_pk_fma_f32 v[206:207], v[18:19], s[92:93], v[120:121] op_sel_hi:[1,1,0] neg_lo:[0,0,1] neg_hi:[0,0,1]
  v_cvt_pk_bf16_f32 v204, 0, v204
  v_cvt_pk_bf16_f32 v166, v158, v159
  v_cvt_pk_bf16_f32 v205, 0, v205
  v_cvt_pk_bf16_f32 v167, v160, v161
  v_cvt_pk_bf16_f32 v206, 0, v206
  v_cvt_pk_bf16_f32 v168, v162, 0
  v_cvt_pk_bf16_f32 v207, 0, v207
  v_cndmask_b32 v172, 0, v163, s[72:73]
  v_pk_mul_f32 v[204:205], v[204:205], v[120:121] op_sel:[0,1]
  v_cndmask_b32 v173, 0, v164, s[72:73]
  v_pk_mul_f32 v[206:207], v[206:207], v[120:121] op_sel:[0,1]
  s_waitcnt vmcnt(16)
  s_cbranch_vccnz L_vw1_15
  s_waitcnt vmcnt(10)
L_vw1_15:
  buffer_load_dwordx4 v[80:83], v95, s[12:15], s60 offen offset:0 nt
  v_mov_b32_dpp v120, v118 row_newbcast:5 row_mask:0xf bank_mask:0xf
  v_mov_b32_dpp v121, v119 row_newbcast:5 row_mask:0xf bank_mask:0xf
  v_pk_fma_f32 v[112:113], v[20:21], s[92:93], v[120:121] op_sel_hi:[1,1,0] neg_lo:[0,0,1] neg_hi:[0,0,1]
  v_pk_fma_f32 v[114:115], v[22:23], s[92:93], v[120:121] op_sel_hi:[1,1,0] neg_lo:[0,0,1] neg_hi:[0,0,1]
  v_cvt_pk_bf16_f32 v112, 0, v112
  v_cndmask_b32 v174, 0, v165, s[72:73]
  v_cvt_pk_bf16_f32 v113, 0, v113
  v_cndmask_b32 v175, 0, v166, s[72:73]
  v_cvt_pk_bf16_f32 v114, 0, v114
  v_cndmask_b32 v176, 0, v163, s[74:75]
  v_cvt_pk_bf16_f32 v115, 0, v115
  v_cndmask_b32 v177, 0, v164, s[74:75]
  v_pk_mul_f32 v[112:113], v[112:113], v[120:121] op_sel:[0,1]
  v_cndmask_b32 v178, 0, v165, s[74:75]
  v_pk_mul_f32 v[114:115], v[114:115], v[120:121] op_sel:[0,1]
  v_cvt_pk_bf16_f32 v210, v196, v112
  v_cvt_pk_bf16_f32 v214, v197, v113
  v_cvt_pk_bf16_f32 v218, v198, v114
  v_cvt_pk_bf16_f32 v222, v199, v115
  s_waitcnt vmcnt(16)
  s_cbranch_vccnz L_vw1_16
  s_waitcnt vmcnt(10)
L_vw1_16:
  buffer_load_dwordx4 v[84:87], v95, s[12:15], s60 offen offset:256 nt
  v_pk_fma_f32 v[112:113], v[24:25], s[92:93], v[120:121] op_sel_hi:[1,1,0] neg_lo:[0,0,1] neg_hi:[0,0,1]
  v_pk_fma_f32 v[114:115], v[26:27], s[92:93], v[120:121] op_sel_hi:[1,1,0] neg_lo:[0,0,1] neg_hi:[0,0,1]
  v_cvt_pk_bf16_f32 v112, 0, v112
  v_cndmask_b32 v179, 0, v166, s[74:75]
  v_cvt_pk_bf16_f32 v113, 0, v113
  v_cndmask_b32 v180, 0, v163, s[76:77]
  v_cvt_pk_bf16_f32 v114, 0, v114
  v_cndmask_b32 v181, 0, v164, s[76:77]
  v_cvt_pk_bf16_f32 v115, 0, v115
  v_cndmask_b32 v182, 0, v165, s[76:77]
  v_pk_mul_f32 v[112:113], v[112:113], v[120:121] op_sel:[0,1]
  v_cndmask_b32 v183, 0, v166, s[76:77]
  v_pk_mul_f32 v[114:115], v[114:115], v[120:121] op_sel:[0,1]
  v_cvt_pk_bf16_f32 v226, v200, v112
  v_cvt_pk_bf16_f32 v230, v201, v113
  v_cvt_pk_bf16_f32 v234, v202, v114
  v_cvt_pk_bf16_f32 v238, v203, v115
  s_waitcnt vmcnt(16)
  s_cbranch_vccnz L_vw1_17
  s_waitcnt vmcnt(10)
L_vw1_17:
  buffer_load_dwordx4 v[88:91], v95, s[12:15], s60 offen offset:512 nt
  v_pk_fma_f32 v[112:113], v[28:29], s[92:93], v[120:121] op_sel_hi:[1,1,0] neg_lo:[0,0,1] neg_hi:[0,0,1]
  v_pk_fma_f32 v[114:115], v[30:31], s[92:93], v[120:121] op_sel_hi:[1,1,0] neg_lo:[0,0,1] neg_hi:[0,0,1]
  v_cvt_pk_bf16_f32 v112, 0, v112
  v_cndmask_b32 v184, 0, v163, s[78:79]
  v_cvt_pk_bf16_f32 v113, 0, v113
  v_cndmask_b32 v185, 0, v164, s[78:79]
  v_cvt_pk_bf16_f32 v114, 0, v114
  v_cndmask_b32 v186, 0, v165, s[78:79]
  v_cvt_pk_bf16_f32 v115, 0, v115
  v_cndmask_b32 v187, 0, v166, s[78:79]
  v_pk_mul_f32 v[112:113], v[112:113], v[120:121] op_sel:[0,1]
  s_waitcnt lgkmcnt(0)
  v_pk_mul_f32 v[114:115], v[114:115], v[120:121] op_sel:[0,1]
  v_cvt_pk_bf16_f32 v242, v204, v112
  v_cvt_pk_bf16_f32 v246, v205, v113
  v_cvt_pk_bf16_f32 v250, v206, v114
  v_cvt_pk_bf16_f32 v254, v207, v115
  v_mad_u32_u24 v92, v100, s63, v98
  v_add_u32 v93, 768, v92
  v_add_u32 v94, 4608, v92
  v_add_u32 v95, 7680, v92
  v_cndmask_b32 v92, v92, v108, s[52:53]
  v_cndmask_b32 v95, v95, v108, s[54:55]
  s_waitcnt vmcnt(16)
  s_cbranch_vccnz L_vw1_18
  s_waitcnt vmcnt(10)
L_vw1_18:
  buffer_load_dwordx4 v[4:7], v92, s[12:15], s61 offen offset:0 nt
  v_mov_b32_dpp v120, v118 row_newbcast:6 row_mask:0xf bank_mask:0xf
  v_mov_b32_dpp v121, v119 row_newbcast:6 row_mask:0xf bank_mask:0xf
  v_pk_fma_f32 v[196:197], v[32:33], s[92:93], v[120:121] op_sel_hi:[1,1,0] neg_lo:[0,0,1] neg_hi:[0,0,1]
  v_pk_fma_f32 v[198:199], v[34:35], s[92:93], v[120:121] op_sel_hi:[1,1,0] neg_lo:[0,0,1] neg_hi:[0,0,1]
  v_cvt_pk_bf16_f32 v196, 0, v196
  v_mul_f32 v132, v151, v132
  v_cvt_pk_bf16_f32 v197, 0, v197
  v_mul_f32 v133, v151, v133
  v_cvt_pk_bf16_f32 v198, 0, v198
  v_mul_f32 v134, v151, v134
  v_cvt_pk_bf16_f32 v199, 0, v199
  v_mul_f32 v135, v151, v135
  v_pk_mul_f32 v[196:197], v[196:197], v[120:121] op_sel:[0,1]
  v_mul_f32 v136, v151, v136
  v_pk_mul_f32 v[198:199], v[198:199], v[120:121] op_sel:[0,1]
  s_waitcnt vmcnt(14)
  s_cbranch_vccnz L_vw1_19
  s_waitcnt vmcnt(10)
L_vw1_19:
  buffer_load_dwordx4 v[8:11], v92, s[12:15], s61 offen offset:256 nt
  v_pk_fma_f32 v[200:201], v[36:37], s[92:93], v[120:121] op_sel_hi:[1,1,0] neg_lo:[0,0,1] neg_hi:[0,0,1]
  v_pk_fma_f32 v[202:203], v[38:39], s[92:93], v[120:121] op_sel_hi:[1,1,0] neg_lo:[0,0,1] neg_hi:[0,0,1]
  v_cvt_pk_bf16_f32 v200, 0, v200
  v_mul_f32 v137, v151, v137
  v_cvt_pk_bf16_f32 v201, 0, v201
  v_mul_f32 v138, v151, v138
  v_cvt_pk_bf16_f32 v202, 0, v202
  v_mul_f32 v139, v151, v139
  v_cvt_pk_bf16_f32 v203, 0, v203
  v_mul_f32 v140, v151, v140
  v_pk_mul_f32 v[200:201], v[200:201], v[120:121] op_sel:[0,1]
  v_mul_f32 v141, v151, v141
  v_pk_mul_f32 v[202:203], v[202:203], v[120:121] op_sel:[0,1]
  s_waitcnt vmcnt(14)
  s_cbranch_vccnz L_vw1_20
  s_waitcnt vmcnt(10)
L_vw1_20:
  buffer_load_dwordx4 v[12:15], v92, s[12:15], s61 offen offset:512 nt
  v_pk_fma_f32 v[204:205], v[40:41], s[92:93], v[120:121] op_sel_hi:[1,1,0] neg_lo:[0,0,1] neg_hi:[0,0,1]
  v_pk_fma_f32 v[206:207], v[42:43], s[92:93], v[120:121] op_sel_hi:[1,1,0] neg_lo:[0,0,1] neg_hi:[0,0,1]
  v_cvt_pk_bf16_f32 v204, 0, v204
  v_mul_f32 v142, v151, v142
  v_cvt_pk_bf16_f32 v205, 0, v205
  v_mul_f32 v143, v151, v143
  v_cvt_pk_bf16_f32 v206, 0, v206
  v_cvt_pk_bf16_f32 v207, 0, v207
  v_pk_mul_f32 v[204:205], v[204:205], v[120:121] op_sel:[0,1]
  v_pk_mul_f32 v[206:207], v[206:207], v[120:121] op_sel:[0,1]
  s_waitcnt vmcnt(14)
  s_cbranch_vccnz L_vw1_21
  s_waitcnt vmcnt(10)
L_vw1_21:
  buffer_load_dwordx4 v[16:19], v93, s[12:15], s61 offen offset:0 nt
  v_mov_b32_dpp v120, v118 row_newbcast:7 row_mask:0xf bank_mask:0xf
  v_mov_b32_dpp v121, v119 row_newbcast:7 row_mask:0xf bank_mask:0xf
  v_pk_fma_f32 v[112:113], v[44:45], s[92:93], v[120:121] op_sel_hi:[1,1,0] neg_lo:[0,0,1] neg_hi:[0,0,1]
  v_pk_fma_f32 v[114:115], v[46:47], s[92:93], v[120:121] op_sel_hi:[1,1,0] neg_lo:[0,0,1] neg_hi:[0,0,1]
  v_cvt_pk_bf16_f32 v112, 0, v112
  v_cvt_pk_bf16_f32 v113, 0, v113
  v_cvt_pk_bf16_f32 v114, 0, v114
  v_cvt_pk_bf16_f32 v115, 0, v115
  v_pk_mul_f32 v[112:113], v[112:113], v[120:121] op_sel:[0,1]
  v_pk_mul_f32 v[114:115], v[114:115], v[120:121] op_sel:[0,1]
  v_cvt_pk_bf16_f32 v211, v196, v112
  v_cvt_pk_bf16_f32 v215, v197, v113
  v_cvt_pk_bf16_f32 v219, v198, v114
  v_cvt_pk_bf16_f32 v223, v199, v115
  v_mfma_f32_16x16x32_bf16 v[132:135], v[172:175], v[208:211], v[132:135]
  v_mfma_f32_16x16x32_bf16 v[132:135], v[176:179], v[212:215], v[132:135]
  v_mfma_f32_16x16x32_bf16 v[132:135], v[180:183], v[216:219], v[132:135]
  v_mfma_f32_16x16x32_bf16 v[132:135], v[184:187], v[220:223], v[132:135]
  s_waitcnt vmcnt(14)
  s_cbranch_vccnz L_vw1_22
  s_waitcnt vmcnt(10)
L_vw1_22:
  buffer_load_dwordx4 v[20:23], v93, s[12:15], s61 offen offset:256 nt
  v_pk_fma_f32 v[112:113], v[48:49], s[92:93], v[120:121] op_sel_hi:[1,1,0] neg_lo:[0,0,1] neg_hi:[0,0,1]
  v_pk_fma_f32 v[114:115], v[50:51], s[92:93], v[120:121] op_sel_hi:[1,1,0] neg_lo:[0,0,1] neg_hi:[0,0,1]
  v_cvt_pk_bf16_f32 v112, 0, v112
  v_cvt_pk_bf16_f32 v113, 0, v113
  v_cvt_pk_bf16_f32 v114, 0, v114
  v_cvt_pk_bf16_f32 v115, 0, v115
  v_pk_mul_f32 v[112:113], v[112:113], v[120:121] op_sel:[0,1]
  v_pk_mul_f32 v[114:115], v[114:115], v[120:121] op_sel:[0,1]
  v_cvt_pk_bf16_f32 v227, v200, v112
  v_cvt_pk_bf16_f32 v231, v201, v113
  v_cvt_pk_bf16_f32 v235, v202, v114
  v_cvt_pk_bf16_f32 v239, v203, v115
  v_mfma_f32_16x16x32_bf16 v[136:139], v[172:175], v[224:227], v[136:139]
  v_mfma_f32_16x16x32_bf16 v[136:139], v[176:179], v[228:231], v[136:139]
  v_mfma_f32_16x16x32_bf16 v[136:139], v[180:183], v[232:235], v[136:139]
  v_mfma_f32_16x16x32_bf16 v[136:139], v[184:187], v[236:239], v[136:139]
  s_waitcnt vmcnt(14)
  s_cbranch_vccnz L_vw1_23
  s_waitcnt vmcnt(10)
L_vw1_23:
  buffer_load_dwordx4 v[24:27], v93, s[12:15], s61 offen offset:512 nt
  v_pk_fma_f32 v[112:113], v[52:53], s[92:93], v[120:121] op_sel_hi:[1,1,0] neg_lo:[0,0,1] neg_hi:[0,0,1]
  v_pk_fma_f32 v[114:115], v[54:55], s[92:93], v[120:121] op_sel_hi:[1,1,0] neg_lo:[0,0,1] neg_hi:[0,0,1]
  v_cvt_pk_bf16_f32 v112, 0, v112
  v_cvt_pk_bf16_f32 v113, 0, v113
  v_cvt_pk_bf16_f32 v114, 0, v114
  v_cvt_pk_bf16_f32 v115, 0, v115
  v_pk_mul_f32 v[112:113], v[112:113], v[120:121] op_sel:[0,1]
  v_pk_mul_f32 v[114:115], v[114:115], v[120:121] op_sel:[0,1]
  v_cvt_pk_bf16_f32 v243, v204, v112
  v_cvt_pk_bf16_f32 v247, v205, v113
  v_cvt_pk_bf16_f32 v251, v206, v114
  v_cvt_pk_bf16_f32 v255, v207, v115
  v_mfma_f32_16x16x32_bf16 v[140:143], v[172:175], v[240:243], v[140:143]
  v_mfma_f32_16x16x32_bf16 v[140:143], v[176:179], v[244:247], v[140:143]
  v_mfma_f32_16x16x32_bf16 v[140:143], v[180:183], v[248:251], v[140:143]
  v_mfma_f32_16x16x32_bf16 v[140:143], v[184:187], v[252:255], v[140:143]
  s_waitcnt vmcnt(14)
  s_cbranch_vccnz L_vw1_24
  s_waitcnt vmcnt(10)
L_vw1_24:
  buffer_load_dwordx4 v[28:31], v93, s[12:15], s61 offen offset:768 nt
  v_mov_b32_dpp v120, v118 row_newbcast:8 row_mask:0xf bank_mask:0xf
  v_mov_b32_dpp v121, v119 row_newbcast:8 row_mask:0xf bank_mask:0xf
  v_pk_fma_f32 v[196:197], v[56:57], s[92:93], v[120:121] op_sel_hi:[1,1,0] neg_lo:[0,0,1] neg_hi:[0,0,1]
  v_pk_fma_f32 v[198:199], v[58:59], s[92:93], v[120:121] op_sel_hi:[1,1,0] neg_lo:[0,0,1] neg_hi:[0,0,1]
  v_cvt_pk_bf16_f32 v196, 0, v196
  v_cndmask_b32 v188, 0, v167, s[72:73]
  v_cvt_pk_bf16_f32 v197, 0, v197
  v_cndmask_b32 v189, 0, v168, s[72:73]
  v_cvt_pk_bf16_f32 v198, 0, v198
  v_cndmask_b32 v190, 0, v167, s[74:75]
  v_cvt_pk_bf16_f32 v199, 0, v199
  v_cndmask_b32 v191, 0, v168, s[74:75]
  v_pk_mul_f32 v[196:197], v[196:197], v[120:121] op_sel:[0,1]
  v_cndmask_b32 v192, 0, v167, s[76:77]
  v_pk_mul_f32 v[198:199], v[198:199], v[120:121] op_sel:[0,1]
  s_waitcnt vmcnt(14)
  s_cbranch_vccnz L_vw1_25
  s_waitcnt vmcnt(10)
L_vw1_25:
  buffer_load_dwordx4 v[32:35], v93, s[12:15], s61 offen offset:1024 nt
  v_pk_fma_f32 v[200:201], v[60:61], s[92:93], v[120:121] op_sel_hi:[1,1,0] neg_lo:[0,0,1] neg_hi:[0,0,1]
  v_pk_fma_f32 v[202:203], v[62:63], s[92:93], v[120:121] op_sel_hi:[1,1,0] neg_lo:[0,0,1] neg_hi:[0,0,1]
  v_cvt_pk_bf16_f32 v200, 0, v200
  v_cndmask_b32 v193, 0, v168, s[76:77]
  v_cvt_pk_bf16_f32 v201, 0, v201
  v_cndmask_b32 v194, 0, v167, s[78:79]
  v_cvt_pk_bf16_f32 v202, 0, v202
  v_cndmask_b32 v195, 0, v168, s[78:79]
  v_cvt_pk_bf16_f32 v203, 0, v203
  v_pk_mul_f32 v[200:201], v[200:201], v[120:121] op_sel:[0,1]
  v_pk_mul_f32 v[202:203], v[202:203], v[120:121] op_sel:[0,1]
  s_waitcnt vmcnt(14)
  s_cbranch_vccnz L_vw1_26
  s_waitcnt vmcnt(10)
L_vw1_26:
  buffer_load_dwordx4 v[36:39], v93, s[12:15], s61 offen offset:1280 nt
  v_pk_fma_f32 v[204:205], v[64:65], s[92:93], v[120:121] op_sel_hi:[1,1,0] neg_lo:[0,0,1] neg_hi:[0,0,1]
  v_pk_fma_f32 v[206:207], v[66:67], s[92:93], v[120:121] op_sel_hi:[1,1,0] neg_lo:[0,0,1] neg_hi:[0,0,1]
  v_cvt_pk_bf16_f32 v204, 0, v204
  v_cvt_pk_bf16_f32 v205, 0, v205
  v_cvt_pk_bf16_f32 v206, 0, v206
  v_cvt_pk_bf16_f32 v207, 0, v207
  v_pk_mul_f32 v[204:205], v[204:205], v[120:121] op_sel:[0,1]
  v_pk_mul_f32 v[206:207], v[206:207], v[120:121] op_sel:[0,1]
  s_waitcnt vmcnt(14)
  s_cbranch_vccnz L_vw1_27
  s_waitcnt vmcnt(10)
L_vw1_27:
  buffer_load_dwordx4 v[40:43], v93, s[12:15], s61 offen offset:1536 nt
  v_mov_b32_dpp v120, v118 row_newbcast:9 row_mask:0xf bank_mask:0xf
  v_mov_b32_dpp v121, v119 row_newbcast:9 row_mask:0xf bank_mask:0xf
  v_pk_fma_f32 v[112:113], v[68:69], s[92:93], v[120:121] op_sel_hi:[1,1,0] neg_lo:[0,0,1] neg_hi:[0,0,1]
  v_pk_fma_f32 v[114:115], v[70:71], s[92:93], v[120:121] op_sel_hi:[1,1,0] neg_lo:[0,0,1] neg_hi:[0,0,1]
  v_cvt_pk_bf16_f32 v112, 0, v112
  v_cvt_pk_bf16_f32 v113, 0, v113
  v_cvt_pk_bf16_f32 v114, 0, v114
  v_cvt_pk_bf16_f32 v115, 0, v115
  v_pk_mul_f32 v[112:113], v[112:113], v[120:121] op_sel:[0,1]
  v_pk_mul_f32 v[114:115], v[114:115], v[120:121] op_sel:[0,1]
  v_cvt_pk_bf16_f32 v208, v196, v112
  v_cvt_pk_bf16_f32 v212, v197, v113
  v_cvt_pk_bf16_f32 v216, v198, v114
  v_cvt_pk_bf16_f32 v220, v199, v115
  s_waitcnt vmcnt(14)
  s_cbranch_vccnz L_vw1_28
  s_waitcnt vmcnt(10)
L_vw1_28:
  buffer_load_dwordx4 v[44:47], v93, s[12:15], s61 offen offset:1792 nt
  v_pk_fma_f32 v[112:113], v[72:73], s[92:93], v[120:121] op_sel_hi:[1,1,0] neg_lo:[0,0,1] neg_hi:[0,0,1]
  v_pk_fma_f32 v[114:115], v[74:75], s[92:93], v[120:121] op_sel_hi:[1,1,0] neg_lo:[0,0,1] neg_hi:[0,0,1]
  v_cvt_pk_bf16_f32 v112, 0, v112
  v_cvt_pk_bf16_f32 v113, 0, v113
  v_cvt_pk_bf16_f32 v114, 0, v114
  v_cvt_pk_bf16_f32 v115, 0, v115
  v_pk_mul_f32 v[112:113], v[112:113], v[120:121] op_sel:[0,1]
  v_pk_mul_f32 v[114:115], v[114:115], v[120:121] op_sel:[0,1]
  v_cvt_pk_bf16_f32 v224, v200, v112
  v_cvt_pk_bf16_f32 v228, v201, v113
  v_cvt_pk_bf16_f32 v232, v202, v114
  v_cvt_pk_bf16_f32 v236, v203, v115
  s_waitcnt vmcnt(14)
  s_cbranch_vccnz L_vw1_29
  s_waitcnt vmcnt(10)
L_vw1_29:
  buffer_load_dwordx4 v[48:51], v93, s[12:15], s61 offen offset:2048 nt
  v_pk_fma_f32 v[112:113], v[76:77], s[92:93], v[120:121] op_sel_hi:[1,1,0] neg_lo:[0,0,1] neg_hi:[0,0,1]
  v_pk_fma_f32 v[114:115], v[78:79], s[92:93], v[120:121] op_sel_hi:[1,1,0] neg_lo:[0,0,1] neg_hi:[0,0,1]
  v_cvt_pk_bf16_f32 v112, 0, v112
  v_cvt_pk_bf16_f32 v113, 0, v113
  v_cvt_pk_bf16_f32 v114, 0, v114
  v_cvt_pk_bf16_f32 v115, 0, v115
  v_pk_mul_f32 v[112:113], v[112:113], v[120:121] op_sel:[0,1]
  v_pk_mul_f32 v[114:115], v[114:115], v[120:121] op_sel:[0,1]
  v_cvt_pk_bf16_f32 v240, v204, v112
  v_cvt_pk_bf16_f32 v244, v205, v113
  v_cvt_pk_bf16_f32 v248, v206, v114
  v_cvt_pk_bf16_f32 v252, v207, v115
  s_waitcnt vmcnt(14)
  s_cbranch_vccnz L_vw1_30
  s_waitcnt vmcnt(10)
L_vw1_30:
  buffer_load_dwordx4 v[52:55], v93, s[12:15], s61 offen offset:2304 nt
  v_mov_b32_dpp v120, v118 row_newbcast:10 row_mask:0xf bank_mask:0xf
  v_mov_b32_dpp v121, v119 row_newbcast:10 row_mask:0xf bank_mask:0xf
  v_pk_fma_f32 v[196:197], v[80:81], s[92:93], v[120:121] op_sel_hi:[1,1,0] neg_lo:[0,0,1] neg_hi:[0,0,1]
  v_pk_fma_f32 v[198:199], v[82:83], s[92:93], v[120:121] op_sel_hi:[1,1,0] neg_lo:[0,0,1] neg_hi:[0,0,1]
  v_cvt_pk_bf16_f32 v196, 0, v196
  v_cvt_pk_bf16_f32 v197, 0, v197
  v_cvt_pk_bf16_f32 v198, 0, v198
  v_cvt_pk_bf16_f32 v199, 0, v199
  v_pk_mul_f32 v[196:197], v[196:197], v[120:121] op_sel:[0,1]
  v_pk_mul_f32 v[198:199], v[198:199], v[120:121] op_sel:[0,1]
  v_cvt_pk_bf16_f32 v209, v196, 0
  v_cvt_pk_bf16_f32 v213, v197, 0
  v_cvt_pk_bf16_f32 v217, v198, 0
  v_cvt_pk_bf16_f32 v221, v199, 0
  v_mfma_f32_16x16x16_bf16 v[132:135], v[188:189], v[208:209], v[132:135]
  v_mfma_f32_16x16x16_bf16 v[132:135], v[190:191], v[212:213], v[132:135]
  v_mfma_f32_16x16x16_bf16 v[132:135], v[192:193], v[216:217], v[132:135]
  v_mfma_f32_16x16x16_bf16 v[132:135], v[194:195], v[220:221], v[132:135]
  s_waitcnt vmcnt(14)
  s_cbranch_vccnz L_vw1_31
  s_waitcnt vmcnt(10)
L_vw1_31:
  buffer_load_dwordx4 v[56:59], v93, s[12:15], s61 offen offset:2560 nt
  v_pk_fma_f32 v[200:201], v[84:85], s[92:93], v[120:121] op_sel_hi:[1,1,0] neg_lo:[0,0,1] neg_hi:[0,0,1]
  v_pk_fma_f32 v[202:203], v[86:87], s[92:93], v[120:121] op_sel_hi:[1,1,0] neg_lo:[0,0,1] neg_hi:[0,0,1]
  v_cvt_pk_bf16_f32 v200, 0, v200
  v_cvt_pk_bf16_f32 v201, 0, v201
  v_cvt_pk_bf16_f32 v202, 0, v202
  v_cvt_pk_bf16_f32 v203, 0, v203
  v_pk_mul_f32 v[200:201], v[200:201], v[120:121] op_sel:[0,1]
  v_pk_mul_f32 v[202:203], v[202:203], v[120:121] op_sel:[0,1]
  v_cvt_pk_bf16_f32 v225, v200, 0
  v_cvt_pk_bf16_f32 v229, v201, 0
  v_cvt_pk_bf16_f32 v233, v202, 0
  v_cvt_pk_bf16_f32 v237, v203, 0
  v_mfma_f32_16x16x16_bf16 v[136:139], v[188:189], v[224:225], v[136:139]
  v_mfma_f32_16x16x16_bf16 v[136:139], v[190:191], v[228:229], v[136:139]
  v_mfma_f32_16x16x16_bf16 v[136:139], v[192:193], v[232:233], v[136:139]
  v_mfma_f32_16x16x16_bf16 v[136:139], v[194:195], v[236:237], v[136:139]
  s_waitcnt vmcnt(14)
  s_cbranch_vccnz L_vw1_32
  s_waitcnt vmcnt(10)
L_vw1_32:
  buffer_load_dwordx4 v[60:63], v93, s[12:15], s61 offen offset:2816 nt
  v_pk_fma_f32 v[204:205], v[88:89], s[92:93], v[120:121] op_sel_hi:[1,1,0] neg_lo:[0,0,1] neg_hi:[0,0,1]
  v_pk_fma_f32 v[206:207], v[90:91], s[92:93], v[120:121] op_sel_hi:[1,1,0] neg_lo:[0,0,1] neg_hi:[0,0,1]
  v_cvt_pk_bf16_f32 v204, 0, v204
  v_cvt_pk_bf16_f32 v205, 0, v205
  v_cvt_pk_bf16_f32 v206, 0, v206
  v_cvt_pk_bf16_f32 v207, 0, v207
  v_pk_mul_f32 v[204:205], v[204:205], v[120:121] op_sel:[0,1]
  v_pk_mul_f32 v[206:207], v[206:207], v[120:121] op_sel:[0,1]
  v_cvt_pk_bf16_f32 v241, v204, 0
  v_cvt_pk_bf16_f32 v245, v205, 0
  v_cvt_pk_bf16_f32 v249, v206, 0
  v_cvt_pk_bf16_f32 v253, v207, 0
  v_mfma_f32_16x16x16_bf16 v[140:143], v[188:189], v[240:241], v[140:143]
  v_mfma_f32_16x16x16_bf16 v[140:143], v[190:191], v[244:245], v[140:143]
  v_mfma_f32_16x16x16_bf16 v[140:143], v[192:193], v[248:249], v[140:143]
  v_mfma_f32_16x16x16_bf16 v[140:143], v[194:195], v[252:253], v[140:143]
  s_mov_b32 s60, s61
  s_cmp_ge_u32 s64, 96
  s_cbranch_scc1 L_v_done
  s_cmp_eq_u32 s89, s88
  s_cbranch_scc1 L_v0
  s_mov_b32 s88, s89
  v_mov_b32 v149, v147
  s_nop 1
  v_permlane32_swap_b32 v147, v149
  v_add_f32 v147, v147, v149
  v_mov_b32 v149, v147
  s_nop 1
  v_permlane16_swap_b32 v147, v149
  v_add_f32 v147, v147, v149
  ds_write_b64 v106, v[146:147]
  ds_write_b128 v105, v[132:135] offset:0
  ds_write_b128 v105, v[136:139] offset:1024
  ds_write_b128 v105, v[140:143] offset:2048
  s_and_b32 s70, s86, 15
  s_cmp_ge_u32 s70, 12
  s_cselect_b32 s70, 2, 0
  s_and_b32 s71, s87, 1
  s_bitcmp1_b32 s96, 6
  s_cselect_b32 s71, s4, s71
  s_add_u32 s70, s70, s71
  s_lshr_b32 s71, s86, 4
  s_lshl2_add_u32 s70, s71, s70
  s_add_u32 s71, s3, 0
  s_cmp_eq_u32 s100, s71
  s_cselect_b32 s44, s70, s44
  s_add_u32 s71, s3, 2
  s_cmp_eq_u32 s100, s71
  s_cselect_b32 s45, s70, s45
  s_add_u32 s100, s100, 1
  s_waitcnt lgkmcnt(0)
  v_add_u32 v105, 6208, v105
  v_add_u32 v106, 6208, v106
  v_mov_b32 v132, 0
  v_mov_b32 v133, 0
  v_mov_b32 v134, 0
  v_mov_b32 v135, 0
  v_mov_b32 v136, 0
  v_mov_b32 v137, 0
  v_mov_b32 v138, 0
  v_mov_b32 v139, 0
  v_mov_b32 v140, 0
  v_mov_b32 v141, 0
  v_mov_b32 v142, 0
  v_mov_b32 v143, 0
  v_mov_b32 v144, 0xff800000
  v_mov_b32 v146, 0x7f800000
  v_mov_b32 v147, 0
  s_branch L_v0
L_v_done:
  v_mov_b32 v149, v147
  s_nop 1
  v_permlane32_swap_b32 v147, v149
  v_add_f32 v147, v147, v149
  v_mov_b32 v149, v147
  s_nop 1
  v_permlane16_swap_b32 v147, v149
  v_add_f32 v147, v147, v149
  ds_write_b64 v106, v[146:147]
  ds_write_b128 v105, v[132:135] offset:0
  ds_write_b128 v105, v[136:139] offset:1024
  ds_write_b128 v105, v[140:143] offset:2048
  s_and_b32 s70, s86, 15
  s_cmp_ge_u32 s70, 12
  s_cselect_b32 s70, 2, 0
  s_and_b32 s71, s87, 1
  s_bitcmp1_b32 s96, 6
  s_cselect_b32 s71, s4, s71
  s_add_u32 s70, s70, s71
  s_lshr_b32 s71, s86, 4
  s_lshl2_add_u32 s70, s71, s70
  s_add_u32 s71, s3, 0
  s_cmp_eq_u32 s100, s71
  s_cselect_b32 s44, s70, s44
  s_add_u32 s71, s3, 2
  s_cmp_eq_u32 s100, s71
  s_cselect_b32 s45, s70, s45
  s_add_u32 s100, s100, 1
  s_waitcnt lgkmcnt(0)
  s_waitcnt vmcnt(0)
  s_barrier
  v_lshrrev_b32 v150, 1, v104
  v_lshlrev_b32 v151, 4, v0
  s_mul_i32 s70, s3, 6208
  s_add_u32 s70, s70, 36864
  v_add_u32 v148, s70, v150
  ds_read_b64 v[4:5], v148 offset:6144
  ds_read_b64 v[6:7], v148 offset:6176
  v_add_u32 v148, s70, v151
  ds_read_b128 v[172:175], v148 offset:0
  ds_read_b128 v[176:179], v148 offset:1024
  ds_read_b128 v[180:183], v148 offset:2048
  ds_read_b128 v[184:187], v148 offset:3072
  ds_read_b128 v[188:191], v148 offset:4096
  ds_read_b128 v[192:195], v148 offset:5120
  s_mul_i32 s70, s3, 6208
  s_add_u32 s70, s70, 49280
  v_add_u32 v148, s70, v150
  ds_read_b64 v[8:9], v148 offset:6144
  ds_read_b64 v[10:11], v148 offset:6176
  v_add_u32 v148, s70, v151
  ds_read_b128 v[196:199], v148 offset:0
  ds_read_b128 v[200:203], v148 offset:1024
  ds_read_b128 v[204:207], v148 offset:2048
  ds_read_b128 v[208:211], v148 offset:3072
  ds_read_b128 v[212:215], v148 offset:4096
  ds_read_b128 v[216:219], v148 offset:5120
  v_mov_b32 v148, 61708
  ds_read_b32 v144, v148
  s_mov_b32 s100, -1
  s_add_u32 s97, s4, 1
  s_waitcnt lgkmcnt(0)
  v_min_f32 v28, v4, v6
  v_sub_f32 v4, v28, v4
  v_sub_f32 v6, v28, v6
  v_exp_f32 v4, v4
  v_exp_f32 v6, v6
  v_mul_f32 v29, v4, v5
  v_fma_f32 v29, v6, v7, v29
  v_mul_f32 v12, v4, v172
  v_fma_f32 v12, v6, v184, v12
  v_mul_f32 v13, v4, v173
  v_fma_f32 v13, v6, v185, v13
  v_mul_f32 v14, v4, v174
  v_fma_f32 v14, v6, v186, v14
  v_mul_f32 v16, v4, v175
  v_fma_f32 v16, v6, v187, v16
  v_mul_f32 v17, v4, v176
  v_fma_f32 v17, v6, v188, v17
  v_mul_f32 v18, v4, v177
  v_fma_f32 v18, v6, v189, v18
  v_mul_f32 v20, v4, v178
  v_fma_f32 v20, v6, v190, v20
  v_mul_f32 v21, v4, v179
  v_fma_f32 v21, v6, v191, v21
  v_mul_f32 v22, v4, v180
  v_fma_f32 v22, v6, v192, v22
  v_mul_f32 v24, v4, v181
  v_fma_f32 v24, v6, v193, v24
  v_mul_f32 v25, v4, v182
  v_fma_f32 v25, v6, v194, v25
  v_mul_f32 v26, v4, v183
  v_fma_f32 v26, v6, v195, v26
  s_bfe_u32 s70, s44, 0x20001
  s_cmp_eq_u32 s70, s97
  s_cbranch_scc1 L_own0
  v_mov_b32 v15, v144
  v_mov_b32 v19, v144
  v_mov_b32 v23, v144
  v_mov_b32 v27, v144
  v_mov_b32 v31, v144
  s_mul_i32 s70, s44, 5120
  s_add_u32 s70, s70, 1048576
  s_add_u32 s71, s70, 4096
  buffer_store_dwordx4 v[12:15], v151, s[40:43], s70 offen offset:0 sc1
  buffer_store_dwordx4 v[16:19], v151, s[40:43], s70 offen offset:1024 sc1
  buffer_store_dwordx4 v[20:23], v151, s[40:43], s70 offen offset:2048 sc1
  buffer_store_dwordx4 v[24:27], v151, s[40:43], s70 offen offset:3072 sc1
  buffer_store_dwordx4 v[28:31], v151, s[40:43], s71 offen offset:0 sc1
  s_branch L_pub0
L_own0:
  v_mov_b32 v52, v12
  v_mov_b32 v53, v13
  v_mov_b32 v54, v14
  v_mov_b32 v56, v16
  v_mov_b32 v57, v17
  v_mov_b32 v58, v18
  v_mov_b32 v60, v20
  v_mov_b32 v61, v21
  v_mov_b32 v62, v22
  v_mov_b32 v64, v24
  v_mov_b32 v65, v25
  v_mov_b32 v66, v26
  v_mov_b32 v68, v28
  v_mov_b32 v69, v29
  s_mov_b32 s100, s44
L_pub0:
  v_min_f32 v48, v8, v10
  v_sub_f32 v8, v48, v8
  v_sub_f32 v10, v48, v10
  v_exp_f32 v8, v8
  v_exp_f32 v10, v10
  v_mul_f32 v49, v8, v9
  v_fma_f32 v49, v10, v11, v49
  v_mul_f32 v32, v8, v196
  v_fma_f32 v32, v10, v208, v32
  v_mul_f32 v33, v8, v197
  v_fma_f32 v33, v10, v209, v33
  v_mul_f32 v34, v8, v198
  v_fma_f32 v34, v10, v210, v34
  v_mul_f32 v36, v8, v199
  v_fma_f32 v36, v10, v211, v36
  v_mul_f32 v37, v8, v200
  v_fma_f32 v37, v10, v212, v37
  v_mul_f32 v38, v8, v201
  v_fma_f32 v38, v10, v213, v38
  v_mul_f32 v40, v8, v202
  v_fma_f32 v40, v10, v214, v40
  v_mul_f32 v41, v8, v203
  v_fma_f32 v41, v10, v215, v41
  v_mul_f32 v42, v8, v204
  v_fma_f32 v42, v10, v216, v42
  v_mul_f32 v44, v8, v205
  v_fma_f32 v44, v10, v217, v44
  v_mul_f32 v45, v8, v206
  v_fma_f32 v45, v10, v218, v45
  v_mul_f32 v46, v8, v207
  v_fma_f32 v46, v10, v219, v46
  s_bfe_u32 s70, s45, 0x20001
  s_cmp_eq_u32 s70, s97
  s_cbranch_scc1 L_own1
  v_mov_b32 v35, v144
  v_mov_b32 v39, v144
  v_mov_b32 v43, v144
  v_mov_b32 v47, v144
  v_mov_b32 v51, v144
  s_mul_i32 s70, s45, 5120
  s_add_u32 s70, s70, 1048576
  s_add_u32 s71, s70, 4096
  buffer_store_dwordx4 v[32:35], v151, s[40:43], s70 offen offset:0 sc1
  buffer_store_dwordx4 v[36:39], v151, s[40:43], s70 offen offset:1024 sc1
  buffer_store_dwordx4 v[40:43], v151, s[40:43], s70 offen offset:2048 sc1
  buffer_store_dwordx4 v[44:47], v151, s[40:43], s70 offen offset:3072 sc1
  buffer_store_dwordx4 v[48:51], v151, s[40:43], s71 offen offset:0 sc1
  s_branch L_pub1
L_own1:
  v_mov_b32 v52, v32
  v_mov_b32 v53, v33
  v_mov_b32 v54, v34
  v_mov_b32 v56, v36
  v_mov_b32 v57, v37
  v_mov_b32 v58, v38
  v_mov_b32 v60, v40
  v_mov_b32 v61, v41
  v_mov_b32 v62, v42
  v_mov_b32 v64, v44
  v_mov_b32 v65, v45
  v_mov_b32 v66, v46
  v_mov_b32 v68, v48
  v_mov_b32 v69, v49
  s_mov_b32 s100, s45
L_pub1:
  s_cmp_eq_u32 s100, -1
  s_cbranch_scc1 L_fin
  s_xor_b32 s84, s100, 1
  s_andn2_b32 s86, s100, 1
  s_xor_b32 s86, s86, 2
  s_add_u32 s88, s86, 1
  s_mul_i32 s84, s84, 5120
  s_add_u32 s84, s84, 1048576
  s_add_u32 s85, s84, 4096
  s_mul_i32 s86, s86, 5120
  s_add_u32 s86, s86, 1048576
  s_add_u32 s87, s86, 4096
  s_mul_i32 s88, s88, 5120
  s_add_u32 s88, s88, 1048576
  s_add_u32 s89, s88, 4096
  v_mov_b32 v149, s85
  v_writelane_b32 v149, s87, 1
  v_writelane_b32 v149, s89, 2
  s_mov_b32 s64, 0
L_gather:
  buffer_load_dwordx4 v[172:175], v151, s[40:43], s84 offen offset:0 sc1
  buffer_load_dwordx4 v[176:179], v151, s[40:43], s84 offen offset:1024 sc1
  buffer_load_dwordx4 v[180:183], v151, s[40:43], s84 offen offset:2048 sc1
  buffer_load_dwordx4 v[184:187], v151, s[40:43], s84 offen offset:3072 sc1
  buffer_load_dwordx4 v[188:191], v151, s[40:43], s85 offen offset:0 sc1
  buffer_load_dwordx4 v[192:195], v151, s[40:43], s86 offen offset:0 sc1
  buffer_load_dwordx4 v[196:199], v151, s[40:43], s86 offen offset:1024 sc1
  buffer_load_dwordx4 v[200:203], v151, s[40:43], s86 offen offset:2048 sc1
  buffer_load_dwordx4 v[204:207], v151, s[40:43], s86 offen offset:3072 sc1
  buffer_load_dwordx4 v[208:211], v151, s[40:43], s87 offen offset:0 sc1
  buffer_load_dwordx4 v[212:215], v151, s[40:43], s88 offen offset:0 sc1
  buffer_load_dwordx4 v[216:219], v151, s[40:43], s88 offen offset:1024 sc1
  buffer_load_dwordx4 v[220:223], v151, s[40:43], s88 offen offset:2048 sc1
  buffer_load_dwordx4 v[224:227], v151, s[40:43], s88 offen offset:3072 sc1
  buffer_load_dwordx4 v[228:231], v151, s[40:43], s89 offen offset:0 sc1
  s_waitcnt vmcnt(0)
  v_xor_b32 v148, v144, v175
  v_xor_b32 v179, v144, v179
  v_xor_b32 v183, v144, v183
  v_xor_b32 v187, v144, v187
  v_xor_b32 v191, v144, v191
  v_xor_b32 v195, v144, v195
  v_xor_b32 v199, v144, v199
  v_xor_b32 v203, v144, v203
  v_xor_b32 v207, v144, v207
  v_xor_b32 v211, v144, v211
  v_xor_b32 v215, v144, v215
  v_xor_b32 v219, v144, v219
  v_xor_b32 v223, v144, v223
  v_xor_b32 v227, v144, v227
  v_xor_b32 v231, v144, v231
  v_or3_b32 v148, v148, v179, v183
  v_or3_b32 v148, v148, v187, v191
  v_or3_b32 v148, v148, v195, v199
  v_or3_b32 v148, v148, v203, v207
  v_or3_b32 v148, v148, v211, v215
  v_or3_b32 v148, v148, v219, v223
  v_or3_b32 v148, v148, v227, v231
  v_cmp_ne_u32 s[70:71], 0, v148
  s_nop 1
  s_cmp_eq_u64 s[70:71], 0
  s_cbranch_scc1 L_gathered
L_poll:
  s_add_u32 s64, s64, 1
  s_cmp_gt_u32 s64, 20000
  s_cbranch_scc1 L_end
  s_branch L_gather
  buffer_load_dword v148, v149, s[40:43], 0 offen offset:1020 sc1
  s_waitcnt vmcnt(0)
  v_cmp_ne_u32 s[70:71], v144, v148
  s_nop 1
  s_cmp_lg_u64 s[70:71], 0
  s_cbranch_scc1 L_poll
  s_mov_b64 exec, -1
  s_branch L_gather
L_gathered:
  v_min_f32 v148, v68, v188
  v_min3_f32 v148, v148, v208, v228
  v_sub_f32 v68, v148, v68
  v_sub_f32 v188, v148, v188
  v_sub_f32 v208, v148, v208
  v_sub_f32 v228, v148, v228
  v_exp_f32 v68, v68
  v_exp_f32 v188, v188
  v_exp_f32 v208, v208
  v_exp_f32 v228, v228
  v_mul_f32 v69, v68, v69
  v_mul_f32 v189, v188, v189
  v_mul_f32 v209, v208, v209
  v_mul_f32 v229, v228, v229
  v_add_f32 v69, v69, v189
  v_add_f32 v209, v209, v229
  v_add_f32 v69, v69, v209
  v_rcp_f32 v149, v69
  v_mul_f32 v52, v68, v52
  v_mul_f32 v172, v188, v172
  v_mul_f32 v192, v208, v192
  v_mul_f32 v212, v228, v212
  v_add_f32 v52, v52, v172
  v_add_f32 v192, v192, v212
  v_add_f32 v52, v52, v192
  v_mul_f32 v53, v68, v53
  v_mul_f32 v173, v188, v173
  v_mul_f32 v193, v208, v193
  v_mul_f32 v213, v228, v213
  v_add_f32 v53, v53, v173
  v_add_f32 v193, v193, v213
  v_add_f32 v53, v53, v193
  v_mul_f32 v54, v68, v54
  v_mul_f32 v174, v188, v174
  v_mul_f32 v194, v208, v194
  v_mul_f32 v214, v228, v214
  v_add_f32 v54, v54, v174
  v_add_f32 v194, v194, v214
  v_add_f32 v54, v54, v194
  v_mul_f32 v56, v68, v56
  v_mul_f32 v176, v188, v176
  v_mul_f32 v196, v208, v196
  v_mul_f32 v216, v228, v216
  v_add_f32 v56, v56, v176
  v_add_f32 v196, v196, v216
  v_add_f32 v56, v56, v196
  v_mul_f32 v57, v68, v57
  v_mul_f32 v177, v188, v177
  v_mul_f32 v197, v208, v197
  v_mul_f32 v217, v228, v217
  v_add_f32 v57, v57, v177
  v_add_f32 v197, v197, v217
  v_add_f32 v57, v57, v197
  v_mul_f32 v58, v68, v58
  v_mul_f32 v178, v188, v178
  v_mul_f32 v198, v208, v198
  v_mul_f32 v218, v228, v218
  v_add_f32 v58, v58, v178
  v_add_f32 v198, v198, v218
  v_add_f32 v58, v58, v198
  v_mul_f32 v60, v68, v60
  v_mul_f32 v180, v188, v180
  v_mul_f32 v200, v208, v200
  v_mul_f32 v220, v228, v220
  v_add_f32 v60, v60, v180
  v_add_f32 v200, v200, v220
  v_add_f32 v60, v60, v200
  v_mul_f32 v61, v68, v61
  v_mul_f32 v181, v188, v181
  v_mul_f32 v201, v208, v201
  v_mul_f32 v221, v228, v221
  v_add_f32 v61, v61, v181
  v_add_f32 v201, v201, v221
  v_add_f32 v61, v61, v201
  v_mul_f32 v62, v68, v62
  v_mul_f32 v182, v188, v182
  v_mul_f32 v202, v208, v202
  v_mul_f32 v222, v228, v222
  v_add_f32 v62, v62, v182
  v_add_f32 v202, v202, v222
  v_add_f32 v62, v62, v202
  v_mul_f32 v64, v68, v64
  v_mul_f32 v184, v188, v184
  v_mul_f32 v204, v208, v204
  v_mul_f32 v224, v228, v224
  v_add_f32 v64, v64, v184
  v_add_f32 v204, v204, v224
  v_add_f32 v64, v64, v204
  v_mul_f32 v65, v68, v65
  v_mul_f32 v185, v188, v185
  v_mul_f32 v205, v208, v205
  v_mul_f32 v225, v228, v225
  v_add_f32 v65, v65, v185
  v_add_f32 v205, v205, v225
  v_add_f32 v65, v65, v205
  v_mul_f32 v66, v68, v66
  v_mul_f32 v186, v188, v186
  v_mul_f32 v206, v208, v206
  v_mul_f32 v226, v228, v226
  v_add_f32 v66, v66, v186
  v_add_f32 v206, v206, v226
  v_add_f32 v66, v66, v206
  v_mul_f32 v52, v149, v52
  v_mul_f32 v53, v149, v53
  v_mul_f32 v54, v149, v54
  v_mul_f32 v56, v149, v56
  v_mul_f32 v57, v149, v57
  v_mul_f32 v58, v149, v58
  v_mul_f32 v60, v149, v60
  v_mul_f32 v61, v149, v61
  v_mul_f32 v62, v149, v62
  v_mul_f32 v64, v149, v64
  v_mul_f32 v65, v149, v65
  v_mul_f32 v66, v149, v66
  v_mul_u32_u24 v148, 24, v104
  v_and_b32 v149, 15, v0
  v_lshl_add_u32 v148, v149, 3, v148
  s_lshr_b32 s70, s100, 2
  s_mul_i32 s70, s70, 1536
  v_cvt_pk_bf16_f32 v132, v52, v53
  v_cvt_pk_bf16_f32 v133, v54, v56
  buffer_store_dwordx2 v[132:133], v148, s[36:39], s70 offen offset:0
  v_cvt_pk_bf16_f32 v134, v57, v58
  v_cvt_pk_bf16_f32 v135, v60, v61
  buffer_store_dwordx2 v[134:135], v148, s[36:39], s70 offen offset:128
  v_cvt_pk_bf16_f32 v136, v62, v64
  v_cvt_pk_bf16_f32 v137, v65, v66
  buffer_store_dwordx2 v[136:137], v148, s[36:39], s70 offen offset:256
L_fin:
L_end:
  s_endpgm
L_helper:
  v_lshlrev_b32 v1, 2, v0
  v_add_u32 v1, 61696, v1
  v_mov_b32 v2, 0
  s_mov_b64 exec, 0xffff
  ds_write_b32 v1, v2
  s_mov_b64 exec, -1
  s_waitcnt lgkmcnt(0)
  s_mov_b32 s20, s50
  s_and_b32 s21, s51, 0xffff
  s_mov_b32 s24, s52
  s_and_b32 s25, s53, 0xffff
  s_mov_b32 s28, s54
  s_and_b32 s29, s55, 0xffff
  s_mov_b32 s32, s56
  s_and_b32 s33, s57, 0xffff
  s_mov_b32 s8, s46
  s_and_b32 s9, s47, 0xffff
  s_mov_b32 s36, s44
  s_and_b32 s37, s45, 0xffff
  s_mov_b32 s16, s46
  s_and_b32 s17, s47, 0xffff
  s_mov_b32 s12, s48
  s_and_b32 s13, s49, 0xffff
  s_mov_b32 s40, s82
  s_and_b32 s41, s83, 0xffff
  s_barrier
  s_memrealtime s[72:73]
  s_getpc_b64 s[54:55]
L_h_pc:
  s_sub_u32 s54, s54, L_h_pc - L_k
  s_subb_u32 s55, s55, 0
  s_and_b32 s54, s54, -16
  s_lshr_b32 s70, s2, 3
  s_lshl_b32 s70, s70, 10
  v_lshl_add_u32 v106, v0, 4, s70
  v_mov_b32 v107, s55
  v_add_co_u32 v106, vcc, s54, v106
  s_nop 1
  v_addc_co_u32 v107, vcc, 0, v107, vcc
  s_lshr_b32 s70, s2, 3
  s_cmp_lt_i32 s70, (L_code_end - L_k) / 1024 - 0
  s_cbranch_scc0 L_h_cta
  global_load_dwordx4 v[110:113], v[106:107], off
  s_lshr_b32 s70, s2, 3
  s_cmp_lt_i32 s70, (L_code_end - L_k) / 1024 - 32
  s_cbranch_scc0 L_h_cta
  v_add_co_u32 v108, vcc, 0x8000, v106
  s_nop 1
  v_addc_co_u32 v109, vcc, 0, v107, vcc
  global_load_dwordx4 v[110:113], v[108:109], off
L_h_cta:
  s_lshr_b32 s70, s2, 4
  s_and_b32 s70, s70, 8
  s_and_b32 s71, s2, 7
  s_add_u32 s70, s70, s71
  s_lshl_b32 s70, s70, 4
  v_lshl_add_u32 v104, v0, 3, s70
  v_and_b32 v105, 31, v0
  v_lshlrev_b32 v105, 3, v105
  v_and_b32 v115, 1, v0
  v_lshlrev_b32 v115, 2, v115
  v_add_u32 v115, 61712, v115
  v_mov_b32 v116, 0
  v_mov_b32 v117, 0
  s_getreg_b32 s50, hwreg(HW_REG_XCC_ID)
  s_bfe_u32 s50, s50, 0x10002
  s_bfe_u32 s52, s2, 0x30003
  s_cmp_eq_u32 s52, 7
  s_cbranch_scc1 L_h_voted
  s_bitcmp1_b32 s2, 6
  s_cbranch_scc1 L_h_voted
  s_cmp_eq_u32 s52, 6
  s_cbranch_scc0 L_h_probe
  s_xor_b32 s48, s50, s4
  s_and_b32 s52, s2, 3
  s_lshl2_add_u32 s52, s52, 36
  s_branch L_h_vote
L_h_probe:
  s_cmp_ge_u32 s52, 3
  s_cselect_b32 s16, s12, s8
  s_cselect_b32 s17, s13, s9
  s_cselect_b32 s70, 3, 0
  s_sub_u32 s70, s52, s70
  s_lshl_b32 s70, s70, 28
  s_lshl_b32 s44, s5, 16
  s_add_u32 s44, s44, s70
  s_lshl_b32 s70, s4, 16
  s_add_u32 s44, s44, s70
  s_add_u32 s44, s44, 0x1c0000
  s_mul_i32 s70, s2, 0x2a95
  s_and_b32 s70, s70, 0x7f80
  s_add_u32 s44, s44, s70
  s_add_u32 s70, s44, 0x8000
  s_buffer_load_dword s58, s[16:19], s70
  s_mov_b32 s45, -1
  s_mov_b32 s46, -1
  s_mul_i32 s52, s52, 6
  s_waitcnt lgkmcnt(0)
  s_xor_b32 s70, s44, 0
  s_memtime s[54:55]
  s_waitcnt lgkmcnt(0)
  s_buffer_load_dword s58, s[16:19], s70
  s_waitcnt lgkmcnt(0)
  s_memtime s[56:57]
  s_waitcnt lgkmcnt(0)
  s_sub_u32 s56, s56, s54
  s_min_u32 s45, s45, s56
  s_xor_b32 s70, s44, 8192
  s_memtime s[54:55]
  s_waitcnt lgkmcnt(0)
  s_buffer_load_dword s58, s[16:19], s70
  s_waitcnt lgkmcnt(0)
  s_memtime s[56:57]
  s_waitcnt lgkmcnt(0)
  s_sub_u32 s56, s56, s54
  s_min_u32 s46, s46, s56
  s_xor_b32 s70, s44, 25472
  s_memtime s[54:55]
  s_waitcnt lgkmcnt(0)
  s_buffer_load_dword s58, s[16:19], s70
  s_waitcnt lgkmcnt(0)
  s_memtime s[56:57]
  s_waitcnt lgkmcnt(0)
  s_sub_u32 s56, s56, s54
  s_min_u32 s46, s46, s56
  s_xor_b32 s70, s44, 17280
  s_memtime s[54:55]
  s_waitcnt lgkmcnt(0)
  s_buffer_load_dword s58, s[16:19], s70
  s_waitcnt lgkmcnt(0)
  s_memtime s[56:57]
  s_waitcnt lgkmcnt(0)
  s_sub_u32 s56, s56, s54
  s_min_u32 s45, s45, s56
  s_xor_b32 s70, s44, 5888
  s_memtime s[54:55]
  s_waitcnt lgkmcnt(0)
  s_buffer_load_dword s58, s[16:19], s70
  s_waitcnt lgkmcnt(0)
  s_memtime s[56:57]
  s_waitcnt lgkmcnt(0)
  s_sub_u32 s56, s56, s54
  s_min_u32 s45, s45, s56
  s_xor_b32 s70, s44, 14080
  s_memtime s[54:55]
  s_waitcnt lgkmcnt(0)
  s_buffer_load_dword s58, s[16:19], s70
  s_waitcnt lgkmcnt(0)
  s_memtime s[56:57]
  s_waitcnt lgkmcnt(0)
  s_sub_u32 s56, s56, s54
  s_min_u32 s46, s46, s56
  s_cmp_lt_u32 s46, s45
  s_cselect_b32 s48, 1, 0
  s_lshr_b32 s70, s44, 13
  s_xor_b32 s70, s70, s2
  s_xor_b32 s70, s70, s50
  s_and_b32 s70, s70, 1
  s_xor_b32 s48, s48, s70
L_h_vote:
  s_mov_b32 s49, 0
  s_lshl_b64 s[48:49], s[48:49], s52
  s_or_b32 s49, s49, 0x1000000
  s_atomic_add_x2 s[48:49], s[80:81], 0
L_h_voted:
  s_waitcnt lgkmcnt(0)
  s_cmp_lg_u32 s2, 56
  s_cbranch_scc1 L_h_nonce
  s_lshl_b64 s[54:55], s[72:73], 2
  s_atomic_add_x2 s[54:55], s[80:81], 8
  s_waitcnt lgkmcnt(0)
L_h_nonce:
  s_mov_b32 s76, 12
  s_mov_b32 s77, 7340032
  s_getpc_b64 s[86:87]
L_h_pc2:
  s_add_u32 s86, s86, L_h_cp - L_h_pc2
  s_addc_u32 s87, s87, 0
  v_mov_b32 v1, 61712
L_h_progv:
  s_sleep 8
  ds_read_b128 v[8:11], v1
  s_waitcnt lgkmcnt(0)
  v_min_u32 v8, v8, v9
  s_nop 0
  v_readfirstlane_b32 s54, v8
  s_nop 1
  s_cmp_lt_u32 s54, 4
  s_cbranch_scc1 L_h_progv
  s_sleep 56
  s_load_dwordx2 s[48:49], s[80:81], 0
  s_mov_b32 s59, 0
L_h_votes:
  s_waitcnt lgkmcnt(0)
  s_lshr_b32 s70, s49, 24
  s_cmp_eq_u32 s70, 112
  s_cbranch_scc1 L_h_votes_done
  s_add_u32 s59, s59, 1
  s_cmp_gt_u32 s59, 2000
  s_cbranch_scc1 L_h_votes_done
  s_sleep 64
  s_mov_b64 s[48:49], 0
  s_atomic_or_x2 s[48:49], s[80:81], 0 glc
  s_branch L_h_votes
L_h_votes_done:
  s_mov_b32 s96, 0x80
  s_bfe_u64 s[54:55], s[48:49], 0x60000
  s_cmp_gt_u32 s54, 8
  s_cselect_b32 s56, 1, 0
  s_or_b32 s96, s96, s56
  s_sub_u32 s54, s54, 7
  s_cmp_lt_u32 s54, 3
  s_cselect_b32 s56, 64, 0
  s_or_b32 s96, s96, s56
  s_bfe_u64 s[54:55], s[48:49], 0x60006
  s_cmp_gt_u32 s54, 8
  s_cselect_b32 s56, 2, 0
  s_or_b32 s96, s96, s56
  s_sub_u32 s54, s54, 7
  s_cmp_lt_u32 s54, 3
  s_cselect_b32 s56, 64, 0
  s_or_b32 s96, s96, s56
  s_bfe_u64 s[54:55], s[48:49], 0x6000c
  s_cmp_gt_u32 s54, 8
  s_cselect_b32 s56, 4, 0
  s_or_b32 s96, s96, s56
  s_sub_u32 s54, s54, 7
  s_cmp_lt_u32 s54, 3
  s_cselect_b32 s56, 64, 0
  s_or_b32 s96, s96, s56
  s_bfe_u64 s[54:55], s[48:49], 0x60012
  s_cmp_gt_u32 s54, 8
  s_cselect_b32 s56, 8, 0
  s_or_b32 s96, s96, s56
  s_sub_u32 s54, s54, 7
  s_cmp_lt_u32 s54, 3
  s_cselect_b32 s56, 64, 0
  s_or_b32 s96, s96, s56
  s_bfe_u64 s[54:55], s[48:49], 0x60018
  s_cmp_gt_u32 s54, 8
  s_cselect_b32 s56, 16, 0
  s_or_b32 s96, s96, s56
  s_sub_u32 s54, s54, 7
  s_cmp_lt_u32 s54, 3
  s_cselect_b32 s56, 64, 0
  s_or_b32 s96, s96, s56
  s_bfe_u64 s[54:55], s[48:49], 0x6001e
  s_cmp_gt_u32 s54, 8
  s_cselect_b32 s56, 32, 0
  s_or_b32 s96, s96, s56
  s_sub_u32 s54, s54, 7
  s_cmp_lt_u32 s54, 3
  s_cselect_b32 s56, 64, 0
  s_or_b32 s96, s96, s56
  s_and_b32 s70, s2, 3
  s_lshl2_add_u32 s70, s70, 4
  s_lshr_b32 s54, s49, s70
  s_and_b32 s56, s54, 3
  s_cselect_b32 s56, 64, 0
  s_or_b32 s96, s96, s56
  s_lshr_b32 s54, s54, 2
  s_xor_b32 s54, s54, s2
  s_xor_b32 s54, s54, s4
  s_and_b32 s54, s54, 1
  s_mul_i32 s54, s54, 63
  s_xor_b32 s96, s96, s54
  v_mov_b32 v1, 61696
  v_mov_b32 v8, s96
  ds_write_b32 v1, v8
  v_lshlrev_b32 v3, 4, v0
  s_load_dwordx2 s[74:75], s[80:81], 8
L_h_getnonce:
  s_waitcnt lgkmcnt(0)
  s_cmp_lg_u64 s[74:75], 0
  s_cbranch_scc1 L_h_gotnonce
  s_sleep 32
  s_atomic_or_x2 s[74:75], s[80:81], 8 glc
  s_branch L_h_getnonce
L_h_gotnonce:
  s_lshr_b64 s[54:55], s[74:75], 2
  v_mov_b32 v1, 61708
  v_mov_b32 v8, s54
  ds_write_b32 v1, v8
  s_mov_b32 s78, 60
  s_swappc_b64 s[84:85], s[86:87]
  s_bitcmp1_b32 s96, 6
  s_cbranch_scc1 L_h_skipa0
  s_lshl_b32 s62, s2, 8
  s_add_u32 s62, s62, 7405568
  s_xor_b32 s63, s62, 1024
  s_lshr_b32 s58, s96, 3
  s_xor_b32 s58, s58, s96
  s_lshr_b32 s70, s5, 4
  s_lshr_b32 s44, s70, 5
  s_lshl_b32 s44, s44, 21
  s_add_u32 s44, s44, 8388608
  s_and_b32 s64, s70, 31
  s_add_u32 s70, s64, s4
  s_lshl_b32 s70, s70, 10
  s_add_u32 s60, s44, s70
  s_xor_b32 s61, s60, 1024
  v_mov_b32 v1, 61712
L_h_proga:
  s_sleep 8
  ds_read_b128 v[8:11], v1
  s_waitcnt lgkmcnt(0)
  v_min_u32 v8, v8, v9
  s_nop 0
  v_readfirstlane_b32 s54, v8
  s_nop 1
  s_cmp_lt_u32 s54, 64
  s_cbranch_scc1 L_h_proga
  ds_read_b128 v[8:11], v3 offset:0
  ds_read_b128 v[12:15], v3 offset:1024
  ds_read_b128 v[16:19], v3 offset:2048
  s_waitcnt lgkmcnt(0)
  s_xor_b32 s70, s60, 0
  buffer_store_dwordx4 v[8:11], v3, s[40:43], s70 offen sc1
  s_xor_b32 s70, s60, 32768
  buffer_store_dwordx4 v[12:15], v3, s[40:43], s70 offen sc1
  s_xor_b32 s70, s60, 65536
  buffer_store_dwordx4 v[16:19], v3, s[40:43], s70 offen sc1
  s_bitcmp0_b32 s58, 0
  s_cbranch_scc1 L_h_e0
  ds_read_b128 v[20:23], v3 offset:3072
  ds_read_b128 v[24:27], v3 offset:4096
  ds_read_b128 v[28:31], v3 offset:5120
  ds_read_b128 v[32:35], v3 offset:6144
  ds_read_b128 v[36:39], v3 offset:7168
  ds_read_b128 v[40:43], v3 offset:8192
  ds_read_b128 v[44:47], v3 offset:9216
  ds_read_b128 v[48:51], v3 offset:10240
  ds_read_b128 v[52:55], v3 offset:11264
  s_waitcnt lgkmcnt(0)
  s_xor_b32 s70, s60, 98304
  buffer_store_dwordx4 v[20:23], v3, s[40:43], s70 offen sc1
  s_xor_b32 s70, s60, 132096
  buffer_store_dwordx4 v[24:27], v3, s[40:43], s70 offen sc1
  s_xor_b32 s70, s60, 164864
  buffer_store_dwordx4 v[28:31], v3, s[40:43], s70 offen sc1
  s_xor_b32 s70, s60, 197632
  buffer_store_dwordx4 v[32:35], v3, s[40:43], s70 offen sc1
  s_xor_b32 s70, s60, 230400
  buffer_store_dwordx4 v[36:39], v3, s[40:43], s70 offen sc1
  s_xor_b32 s70, s60, 264192
  buffer_store_dwordx4 v[40:43], v3, s[40:43], s70 offen sc1
  s_xor_b32 s70, s60, 296960
  buffer_store_dwordx4 v[44:47], v3, s[40:43], s70 offen sc1
  s_xor_b32 s70, s60, 329728
  buffer_store_dwordx4 v[48:51], v3, s[40:43], s70 offen sc1
  s_xor_b32 s70, s60, 362496
  buffer_store_dwordx4 v[52:55], v3, s[40:43], s70 offen sc1
L_h_e0:
  s_bitcmp0_b32 s58, 1
  s_cbranch_scc1 L_h_e1
  ds_read_b128 v[56:59], v3 offset:12288
  ds_read_b128 v[60:63], v3 offset:13312
  ds_read_b128 v[64:67], v3 offset:14336
  ds_read_b128 v[68:71], v3 offset:15360
  ds_read_b128 v[72:75], v3 offset:16384
  ds_read_b128 v[76:79], v3 offset:17408
  ds_read_b128 v[80:83], v3 offset:18432
  ds_read_b128 v[84:87], v3 offset:19456
  ds_read_b128 v[88:91], v3 offset:20480
  ds_read_b128 v[92:95], v3 offset:21504
  ds_read_b128 v[96:99], v3 offset:22528
  ds_read_b128 v[100:103], v3 offset:23552
  s_waitcnt lgkmcnt(0)
  s_xor_b32 s70, s60, 396288
  buffer_store_dwordx4 v[56:59], v3, s[40:43], s70 offen sc1
  s_xor_b32 s70, s60, 429056
  buffer_store_dwordx4 v[60:63], v3, s[40:43], s70 offen sc1
  s_xor_b32 s70, s60, 461824
  buffer_store_dwordx4 v[64:67], v3, s[40:43], s70 offen sc1
  s_xor_b32 s70, s60, 494592
  buffer_store_dwordx4 v[68:71], v3, s[40:43], s70 offen sc1
  s_xor_b32 s70, s60, 541696
  buffer_store_dwordx4 v[72:75], v3, s[40:43], s70 offen sc1
  s_xor_b32 s70, s60, 574464
  buffer_store_dwordx4 v[76:79], v3, s[40:43], s70 offen sc1
  s_xor_b32 s70, s60, 607232
  buffer_store_dwordx4 v[80:83], v3, s[40:43], s70 offen sc1
  s_xor_b32 s70, s60, 640000
  buffer_store_dwordx4 v[84:87], v3, s[40:43], s70 offen sc1
  s_xor_b32 s70, s60, 671744
  buffer_store_dwordx4 v[88:91], v3, s[40:43], s70 offen sc1
  s_xor_b32 s70, s60, 704512
  buffer_store_dwordx4 v[92:95], v3, s[40:43], s70 offen sc1
  s_xor_b32 s70, s60, 737280
  buffer_store_dwordx4 v[96:99], v3, s[40:43], s70 offen sc1
  s_xor_b32 s70, s60, 770048
  buffer_store_dwordx4 v[100:103], v3, s[40:43], s70 offen sc1
L_h_e1:
  s_add_u32 s54, s74, 1
  v_mov_b32 v5, 0
  s_waitcnt vmcnt(0)
  v_mov_b32 v8, s54
  v_mov_b32 v9, s75
  s_mov_b64 exec, 1
  buffer_store_dwordx2 v[8:9], v5, s[40:43], s62 offen sc1
  s_mov_b64 exec, -1
L_h_skipa0:
  s_mov_b32 s78, 68
  s_swappc_b64 s[84:85], s[86:87]
  s_bitcmp1_b32 s96, 6
  s_cbranch_scc1 L_h_skipa
  v_mov_b32 v1, 61712
L_h_progia:
  s_sleep 8
  ds_read_b128 v[8:11], v1
  s_waitcnt lgkmcnt(0)
  v_min_u32 v8, v8, v9
  s_nop 0
  v_readfirstlane_b32 s54, v8
  s_nop 1
  s_cmp_lt_u32 s54, 72
  s_cbranch_scc1 L_h_progia
  s_add_u32 s54, s74, 1
  v_mov_b32 v5, 0
  s_mov_b64 exec, 1
  s_mov_b32 s59, 0
L_h_flaga:
  buffer_load_dwordx2 v[10:11], v5, s[40:43], s63 offen sc1
  s_waitcnt vmcnt(0)
  v_readfirstlane_b32 s56, v10
  v_readfirstlane_b32 s57, v11
  s_nop 0
  s_sub_u32 s56, s56, s54
  s_xor_b32 s57, s57, s75
  s_lshr_b32 s56, s56, 1
  s_or_b32 s56, s56, s57
  s_cbranch_scc0 L_h_flaga_done
  s_add_u32 s59, s59, 1
  s_cmp_gt_u32 s59, 2000
  s_cbranch_scc1 L_h_flaga_done
  s_sleep 32
  s_branch L_h_flaga
L_h_flaga_done:
  s_mov_b64 exec, -1
  s_bfe_u32 s54, s96, 0x10003
  s_mul_i32 s54, s54, 384
  v_lshrrev_b32 v4, 3, v0
  v_add_u32 v5, 0, v4
  v_mul_u32_u24 v5, 21846, v5
  v_bfe_u32 v5, v5, 16, 1
  v_mul_u32_u24 v6, 384, v5
  v_sub_u32 v6, v3, v6
  v_add_u32 v6, s54, v6
  v_add_u32 v6, 0, v6
  v_add_u32 v5, s64, v5
  v_lshrrev_b32 v2, 12, v6
  v_xor_b32 v5, v5, v2
  v_lshrrev_b32 v2, 10, v6
  v_lshl_add_u32 v5, v2, 5, v5
  v_and_b32 v6, 1023, v6
  v_lshl_add_u32 v5, v5, 10, v6
  buffer_load_dwordx4 v[8:11], v5, s[40:43], s44 offen sc1
  v_add_u32 v5, 8, v4
  v_mul_u32_u24 v5, 21846, v5
  v_bfe_u32 v5, v5, 16, 1
  v_mul_u32_u24 v6, 384, v5
  v_sub_u32 v6, v3, v6
  v_add_u32 v6, s54, v6
  v_add_u32 v6, 1024, v6
  v_add_u32 v5, s64, v5
  v_lshrrev_b32 v2, 12, v6
  v_xor_b32 v5, v5, v2
  v_lshrrev_b32 v2, 10, v6
  v_lshl_add_u32 v5, v2, 5, v5
  v_and_b32 v6, 1023, v6
  v_lshl_add_u32 v5, v5, 10, v6
  buffer_load_dwordx4 v[12:15], v5, s[40:43], s44 offen sc1
  v_add_u32 v5, 16, v4
  v_mul_u32_u24 v5, 21846, v5
  v_bfe_u32 v5, v5, 16, 1
  v_mul_u32_u24 v6, 384, v5
  v_sub_u32 v6, v3, v6
  v_add_u32 v6, s54, v6
  v_add_u32 v6, 2048, v6
  v_add_u32 v5, s64, v5
  v_lshrrev_b32 v2, 12, v6
  v_xor_b32 v5, v5, v2
  v_lshrrev_b32 v2, 10, v6
  v_lshl_add_u32 v5, v2, 5, v5
  v_and_b32 v6, 1023, v6
  v_lshl_add_u32 v5, v5, 10, v6
  buffer_load_dwordx4 v[16:19], v5, s[40:43], s44 offen sc1
  s_waitcnt vmcnt(0)
  ds_write_b128 v3, v[8:11] offset:0
  ds_write_b128 v3, v[12:15] offset:1024
  ds_write_b128 v3, v[16:19] offset:2048
  s_bitcmp0_b32 s58, 0
  s_cbranch_scc1 L_h_i0
  s_xor_b32 s70, s61, 98304
  s_waitcnt vmcnt(3)
  buffer_load_dwordx4 v[20:23], v3, s[40:43], s70 offen sc1
  s_xor_b32 s70, s61, 132096
  s_waitcnt vmcnt(3)
  buffer_load_dwordx4 v[24:27], v3, s[40:43], s70 offen sc1
  s_xor_b32 s70, s61, 164864
  s_waitcnt vmcnt(3)
  buffer_load_dwordx4 v[28:31], v3, s[40:43], s70 offen sc1
  s_xor_b32 s70, s61, 197632
  s_waitcnt vmcnt(3)
  buffer_load_dwordx4 v[32:35], v3, s[40:43], s70 offen sc1
  s_xor_b32 s70, s61, 230400
  s_waitcnt vmcnt(3)
  buffer_load_dwordx4 v[36:39], v3, s[40:43], s70 offen sc1
  s_xor_b32 s70, s61, 264192
  s_waitcnt vmcnt(3)
  buffer_load_dwordx4 v[40:43], v3, s[40:43], s70 offen sc1
  s_xor_b32 s70, s61, 296960
  s_waitcnt vmcnt(3)
  buffer_load_dwordx4 v[44:47], v3, s[40:43], s70 offen sc1
  s_xor_b32 s70, s61, 329728
  s_waitcnt vmcnt(3)
  buffer_load_dwordx4 v[48:51], v3, s[40:43], s70 offen sc1
  s_xor_b32 s70, s61, 362496
  s_waitcnt vmcnt(3)
  buffer_load_dwordx4 v[52:55], v3, s[40:43], s70 offen sc1
  s_waitcnt vmcnt(0)
  ds_write_b128 v3, v[20:23] offset:3072
  ds_write_b128 v3, v[24:27] offset:4096
  ds_write_b128 v3, v[28:31] offset:5120
  ds_write_b128 v3, v[32:35] offset:6144
  ds_write_b128 v3, v[36:39] offset:7168
  ds_write_b128 v3, v[40:43] offset:8192
  ds_write_b128 v3, v[44:47] offset:9216
  ds_write_b128 v3, v[48:51] offset:10240
  ds_write_b128 v3, v[52:55] offset:11264
L_h_i0:
  s_bitcmp0_b32 s58, 1
  s_cbranch_scc1 L_h_i1
  s_xor_b32 s70, s61, 396288
  s_waitcnt vmcnt(3)
  buffer_load_dwordx4 v[56:59], v3, s[40:43], s70 offen sc1
  s_xor_b32 s70, s61, 429056
  s_waitcnt vmcnt(3)
  buffer_load_dwordx4 v[60:63], v3, s[40:43], s70 offen sc1
  s_xor_b32 s70, s61, 461824
  s_waitcnt vmcnt(3)
  buffer_load_dwordx4 v[64:67], v3, s[40:43], s70 offen sc1
  s_xor_b32 s70, s61, 494592
  s_waitcnt vmcnt(3)
  buffer_load_dwordx4 v[68:71], v3, s[40:43], s70 offen sc1
  s_xor_b32 s70, s61, 541696
  s_waitcnt vmcnt(3)
  buffer_load_dwordx4 v[72:75], v3, s[40:43], s70 offen sc1
  s_xor_b32 s70, s61, 574464
  s_waitcnt vmcnt(3)
  buffer_load_dwordx4 v[76:79], v3, s[40:43], s70 offen sc1
  s_xor_b32 s70, s61, 607232
  s_waitcnt vmcnt(3)
  buffer_load_dwordx4 v[80:83], v3, s[40:43], s70 offen sc1
  s_xor_b32 s70, s61, 640000
  s_waitcnt vmcnt(3)
  buffer_load_dwordx4 v[84:87], v3, s[40:43], s70 offen sc1
  s_xor_b32 s70, s61, 671744
  s_waitcnt vmcnt(3)
  buffer_load_dwordx4 v[88:91], v3, s[40:43], s70 offen sc1
  s_xor_b32 s70, s61, 704512
  s_waitcnt vmcnt(3)
  buffer_load_dwordx4 v[92:95], v3, s[40:43], s70 offen sc1
  s_xor_b32 s70, s61, 737280
  s_waitcnt vmcnt(3)
  buffer_load_dwordx4 v[96:99], v3, s[40:43], s70 offen sc1
  s_xor_b32 s70, s61, 770048
  s_waitcnt vmcnt(3)
  buffer_load_dwordx4 v[100:103], v3, s[40:43], s70 offen sc1
  s_waitcnt vmcnt(0)
  ds_write_b128 v3, v[56:59] offset:12288
  ds_write_b128 v3, v[60:63] offset:13312
  ds_write_b128 v3, v[64:67] offset:14336
  ds_write_b128 v3, v[68:71] offset:15360
  ds_write_b128 v3, v[72:75] offset:16384
  ds_write_b128 v3, v[76:79] offset:17408
  ds_write_b128 v3, v[80:83] offset:18432
  ds_write_b128 v3, v[84:87] offset:19456
  ds_write_b128 v3, v[88:91] offset:20480
  ds_write_b128 v3, v[92:95] offset:21504
  ds_write_b128 v3, v[96:99] offset:22528
  ds_write_b128 v3, v[100:103] offset:23552
L_h_i1:
L_h_skipa:
  s_lshr_b32 s70, s96, 4
  s_andn2_b32 s58, s58, s70
  s_bitcmp0_b32 s58, 2
  s_cselect_b32 s70, 255, 64
  v_mov_b32 v1, 61700
  v_mov_b32 v5, s70
  ds_write_b32 v1, v5
  s_mov_b32 s78, 92
  s_swappc_b64 s[84:85], s[86:87]
  s_lshr_b32 s70, s2, 3
  s_cmp_lt_i32 s70, (L_code_end - L_k) / 1024 - 0
  s_cbranch_scc0 L_h_ctb
  global_load_dwordx4 v[110:113], v[106:107], off
  s_lshr_b32 s70, s2, 3
  s_cmp_lt_i32 s70, (L_code_end - L_k) / 1024 - 32
  s_cbranch_scc0 L_h_ctb
  v_add_co_u32 v108, vcc, 0x8000, v106
  s_nop 1
  v_addc_co_u32 v109, vcc, 0, v107, vcc
  global_load_dwordx4 v[110:113], v[108:109], off
L_h_ctb:
  s_bitcmp0_b32 s58, 2
  s_cbranch_scc1 L_h_skipb0
  v_mov_b32 v1, 61712
L_h_progb:
  s_sleep 8
  ds_read_b128 v[8:11], v1
  s_waitcnt lgkmcnt(0)
  v_min_u32 v8, v8, v9
  s_nop 0
  v_readfirstlane_b32 s54, v8
  s_nop 1
  s_cmp_lt_u32 s54, 96
  s_cbranch_scc1 L_h_progb
  ds_read_b128 v[8:11], v3 offset:24576
  ds_read_b128 v[12:15], v3 offset:25600
  ds_read_b128 v[16:19], v3 offset:26624
  ds_read_b128 v[20:23], v3 offset:27648
  ds_read_b128 v[24:27], v3 offset:28672
  ds_read_b128 v[28:31], v3 offset:29696
  ds_read_b128 v[32:35], v3 offset:30720
  ds_read_b128 v[36:39], v3 offset:31744
  ds_read_b128 v[40:43], v3 offset:32768
  ds_read_b128 v[44:47], v3 offset:33792
  ds_read_b128 v[48:51], v3 offset:34816
  ds_read_b128 v[52:55], v3 offset:35840
  s_waitcnt lgkmcnt(0)
  s_xor_b32 s70, s60, 805888
  buffer_store_dwordx4 v[8:11], v3, s[40:43], s70 offen sc1
  s_xor_b32 s70, s60, 838656
  buffer_store_dwordx4 v[12:15], v3, s[40:43], s70 offen sc1
  s_xor_b32 s70, s60, 871424
  buffer_store_dwordx4 v[16:19], v3, s[40:43], s70 offen sc1
  s_xor_b32 s70, s60, 904192
  buffer_store_dwordx4 v[20:23], v3, s[40:43], s70 offen sc1
  s_xor_b32 s70, s60, 935936
  buffer_store_dwordx4 v[24:27], v3, s[40:43], s70 offen sc1
  s_xor_b32 s70, s60, 968704
  buffer_store_dwordx4 v[28:31], v3, s[40:43], s70 offen sc1
  s_xor_b32 s70, s60, 1001472
  buffer_store_dwordx4 v[32:35], v3, s[40:43], s70 offen sc1
  s_xor_b32 s70, s60, 1034240
  buffer_store_dwordx4 v[36:39], v3, s[40:43], s70 offen sc1
  s_xor_b32 s70, s60, 1052672
  buffer_store_dwordx4 v[40:43], v3, s[40:43], s70 offen sc1
  s_xor_b32 s70, s60, 1085440
  buffer_store_dwordx4 v[44:47], v3, s[40:43], s70 offen sc1
  s_xor_b32 s70, s60, 1118208
  buffer_store_dwordx4 v[48:51], v3, s[40:43], s70 offen sc1
  s_xor_b32 s70, s60, 1150976
  buffer_store_dwordx4 v[52:55], v3, s[40:43], s70 offen sc1
  s_add_u32 s54, s74, 2
  v_mov_b32 v5, 0
  s_waitcnt vmcnt(0)
  v_mov_b32 v8, s54
  v_mov_b32 v9, s75
  s_mov_b64 exec, 1
  buffer_store_dwordx2 v[8:9], v5, s[40:43], s62 offen sc1
  s_mov_b64 exec, -1
L_h_skipb0:
  s_mov_b32 s78, 100
  s_swappc_b64 s[84:85], s[86:87]
  s_bitcmp0_b32 s58, 2
  s_cbranch_scc1 L_h_all
  v_mov_b32 v1, 61712
L_h_progib:
  s_sleep 8
  ds_read_b128 v[8:11], v1
  s_waitcnt lgkmcnt(0)
  v_min_u32 v8, v8, v9
  s_nop 0
  v_readfirstlane_b32 s54, v8
  s_nop 1
  s_cmp_lt_u32 s54, 104
  s_cbranch_scc1 L_h_progib
  s_add_u32 s54, s74, 2
  v_mov_b32 v5, 0
  s_mov_b64 exec, 1
  s_mov_b32 s59, 0
L_h_flagb:
  buffer_load_dwordx2 v[10:11], v5, s[40:43], s63 offen sc1
  s_waitcnt vmcnt(0)
  v_readfirstlane_b32 s56, v10
  v_readfirstlane_b32 s57, v11
  s_nop 0
  s_sub_u32 s56, s56, s54
  s_xor_b32 s57, s57, s75
  s_lshr_b32 s56, s56, 1
  s_or_b32 s56, s56, s57
  s_cbranch_scc0 L_h_flagb_done
  s_add_u32 s59, s59, 1
  s_cmp_gt_u32 s59, 2000
  s_cbranch_scc1 L_h_flagb_done
  s_sleep 32
  s_branch L_h_flagb
L_h_flagb_done:
  s_mov_b64 exec, -1
  s_xor_b32 s70, s61, 805888
  s_waitcnt vmcnt(3)
  buffer_load_dwordx4 v[8:11], v3, s[40:43], s70 offen sc1
  s_xor_b32 s70, s61, 838656
  s_waitcnt vmcnt(3)
  buffer_load_dwordx4 v[12:15], v3, s[40:43], s70 offen sc1
  s_xor_b32 s70, s61, 871424
  s_waitcnt vmcnt(3)
  buffer_load_dwordx4 v[16:19], v3, s[40:43], s70 offen sc1
  s_xor_b32 s70, s61, 904192
  s_waitcnt vmcnt(3)
  buffer_load_dwordx4 v[20:23], v3, s[40:43], s70 offen sc1
  s_xor_b32 s70, s61, 935936
  s_waitcnt vmcnt(3)
  buffer_load_dwordx4 v[24:27], v3, s[40:43], s70 offen sc1
  s_xor_b32 s70, s61, 968704
  s_waitcnt vmcnt(3)
  buffer_load_dwordx4 v[28:31], v3, s[40:43], s70 offen sc1
  s_xor_b32 s70, s61, 1001472
  s_waitcnt vmcnt(3)
  buffer_load_dwordx4 v[32:35], v3, s[40:43], s70 offen sc1
  s_xor_b32 s70, s61, 1034240
  s_waitcnt vmcnt(3)
  buffer_load_dwordx4 v[36:39], v3, s[40:43], s70 offen sc1
  s_xor_b32 s70, s61, 1052672
  s_waitcnt vmcnt(3)
  buffer_load_dwordx4 v[40:43], v3, s[40:43], s70 offen sc1
  s_xor_b32 s70, s61, 1085440
  s_waitcnt vmcnt(3)
  buffer_load_dwordx4 v[44:47], v3, s[40:43], s70 offen sc1
  s_xor_b32 s70, s61, 1118208
  s_waitcnt vmcnt(3)
  buffer_load_dwordx4 v[48:51], v3, s[40:43], s70 offen sc1
  s_xor_b32 s70, s61, 1150976
  s_waitcnt vmcnt(3)
  buffer_load_dwordx4 v[52:55], v3, s[40:43], s70 offen sc1
  s_waitcnt vmcnt(0)
  ds_write_b128 v3, v[8:11] offset:24576
  ds_write_b128 v3, v[12:15] offset:25600
  ds_write_b128 v3, v[16:19] offset:26624
  ds_write_b128 v3, v[20:23] offset:27648
  ds_write_b128 v3, v[24:27] offset:28672
  ds_write_b128 v3, v[28:31] offset:29696
  ds_write_b128 v3, v[32:35] offset:30720
  ds_write_b128 v3, v[36:39] offset:31744
  ds_write_b128 v3, v[40:43] offset:32768
  ds_write_b128 v3, v[44:47] offset:33792
  ds_write_b128 v3, v[48:51] offset:34816
  ds_write_b128 v3, v[52:55] offset:35840
  v_mov_b32 v1, 61700
  v_mov_b32 v5, 255
  ds_write_b32 v1, v5
L_h_all:
  s_mov_b32 s78, 172
  s_swappc_b64 s[84:85], s[86:87]
  s_lshr_b32 s70, s2, 3
  s_cmp_lt_i32 s70, (L_code_end - L_k) / 1024 - 0
  s_cbranch_scc0 L_h_ctc
  global_load_dwordx4 v[110:113], v[106:107], off
  s_lshr_b32 s70, s2, 3
  s_cmp_lt_i32 s70, (L_code_end - L_k) / 1024 - 32
  s_cbranch_scc0 L_h_ctc
  v_add_co_u32 v108, vcc, 0x8000, v106
  s_nop 1
  v_addc_co_u32 v109, vcc, 0, v107, vcc
  global_load_dwordx4 v[110:113], v[108:109], off
L_h_ctc:
  s_mov_b32 s78, 182
  s_swappc_b64 s[84:85], s[86:87]
  s_waitcnt lgkmcnt(0)
  s_endpgm
L_h_cp:
  s_cmp_gt_u32 s76, s78
  s_cbranch_scc0 L_h_cpgo
  s_setpc_b64 s[84:85]
L_h_cpgo:
  ds_read_b32 v8, v115
  s_memrealtime s[54:55]
  s_waitcnt lgkmcnt(0)
  v_mov_b32 v118, s54
  v_mov_b32 v119, s55
  v_cmp_gt_u32 vcc, s76, v8
  s_nop 1
  s_cmp_eq_u32 vcc_lo, 0
  s_cbranch_scc1 L_h_cpnext
L_h_cpm:
  s_sleep 2
  ds_read_b32 v8, v115
  s_memrealtime s[54:55]
  s_waitcnt lgkmcnt(0)
  v_mov_b32 v10, s54
  v_mov_b32 v11, s55
  v_cndmask_b32 v118, v118, v10, vcc
  v_cndmask_b32 v119, v119, v11, vcc
  v_cmp_gt_u32 vcc, s76, v8
  s_nop 1
  s_cmp_lg_u32 vcc_lo, 0
  s_cbranch_scc1 L_h_cpm
  s_and_b32 s70, s2, 0x78
  s_cbranch_scc1 L_h_np
  s_mov_b64 exec, 3
  buffer_store_dwordx2 v[118:119], v104, s[40:43], s77 offen sc1
  s_mov_b64 exec, -1
L_h_np:
  s_add_u32 s50, s76, 4
  v_mov_b32 v1, 61712
L_h_progc1:
  s_sleep 4
  ds_read_b128 v[8:11], v1
  s_waitcnt lgkmcnt(0)
  v_min_u32 v8, v8, v9
  s_nop 0
  v_readfirstlane_b32 s54, v8
  s_nop 1
  s_cmp_lt_u32 s54, s50
  s_cbranch_scc1 L_h_progc1
  buffer_load_dwordx2 v[8:9], v105, s[40:43], s77 offen
  v_mov_b32 v10, s73
  s_waitcnt vmcnt(0)
  ds_read_b32 v12, v115
  v_subrev_co_u32 v8, vcc, s72, v8
  s_nop 1
  v_subb_co_u32 v9, vcc, v9, v10, vcc
  v_lshrrev_b32 v10, 24, v8
  v_or_b32 v9, v9, v10
  v_cmp_eq_u32 vcc, 0, v9
  s_nop 1
  v_cndmask_b32 v8, 0, v8, vcc
  s_bcnt1_i32_b32 s56, vcc_lo
  s_nop 0
  v_add_u32_dpp v8, v8, v8 row_ror:8 row_mask:0xf bank_mask:0xf
  s_nop 1
  v_add_u32_dpp v8, v8, v8 row_ror:4 row_mask:0xf bank_mask:0xf
  s_nop 1
  v_add_u32_dpp v8, v8, v8 row_ror:2 row_mask:0xf bank_mask:0xf
  s_nop 1
  v_add_u32_dpp v8, v8, v8 row_ror:1 row_mask:0xf bank_mask:0xf
  s_nop 0
  v_readlane_b32 s54, v8, 0
  v_readlane_b32 s70, v8, 16
  v_subrev_u32 v8, s72, v118
  v_mul_lo_u32 v8, v8, s56
  s_add_u32 s54, s54, s70
  s_max_u32 s56, s56, 1
  v_subrev_u32 v8, s54, v8
  v_cvt_f32_u32 v9, s56
  v_cvt_f32_i32 v8, v8
  v_rcp_f32 v9, v9
  s_nop 0
  v_mul_f32 v8, v8, v9
  v_cvt_i32_f32 v8, v8
  s_waitcnt lgkmcnt(0)
  v_add_u32 v12, 2, v12
  v_min_u32 v9, v116, v12
  v_subrev_u32 v9, s76, v9
  v_max_i32 v9, 0, v9
  v_lshrrev_b32 v9, 1, v9
  v_mul_u32_u24 v9, 22, v9
  v_sub_u32 v8, v8, v9
  v_add_u32 v9, 11, v8
  v_max_i32 v9, 0, v9
  v_min_i32 v9, 2000, v9
  v_mul_u32_u24 v9, 2978, v9
  v_lshrrev_b32 v9, 16, v9
  v_cmp_ne_u32 vcc, 0, v9
  v_lshl_add_u32 v9, v9, 1, v12
  s_nop 0
  v_cndmask_b32 v116, 0, v9, vcc
  ds_write_b32 v115, v116 offset:16
L_h_cpnext:
  s_add_u32 s76, s76, 8
  s_add_u32 s77, s77, 256
  s_branch L_h_cp
L_code_end:
.section .rodata,"a"
.p2align 6
.amdhsa_kernel standalone__kv_cache_quant_int4_int2_kv_with_per_channel_or_per_token_scales__sampling_kernel
  .amdhsa_next_free_vgpr 256
  .amdhsa_next_free_sgpr 102
  .amdhsa_accum_offset 256
  .amdhsa_group_segment_fixed_size 0
  .amdhsa_kernarg_size 80
  .amdhsa_user_sgpr_count 2
  .amdhsa_user_sgpr_kernarg_segment_ptr 1
  .amdhsa_system_sgpr_workgroup_id_x 1
  .amdhsa_float_denorm_mode_32 3
.end_amdhsa_kernel
```

```asm
; @launch grid=(256,1,1) block=(192,1,1) lds=62464
.amdgcn_target "amdgcn-amd-amdhsa--gfx950"
.text
.globl standalone__kv_cache_quant_int4_int2_kv_with_per_channel_or_per_token_scales__sampling_kernel
.p2align 8
.type standalone__kv_cache_quant_int4_int2_kv_with_per_channel_or_per_token_scales__sampling_kernel,@function
standalone__kv_cache_quant_int4_int2_kv_with_per_channel_or_per_token_scales__sampling_kernel:
  s_cmp_ge_u32 s2, 256
  s_cbranch_scc1 L_end
  s_load_dwordx16 s[44:59], s[0:1], 0
  s_load_dwordx4 s[80:83], s[0:1], 64
  v_lshrrev_b32 v1, 6, v0
  v_and_b32 v0, 63, v0
  v_readfirstlane_b32 s3, v1
  s_bfe_u32 s4, s2, 0x10002
  s_lshr_b32 s5, s2, 3
  s_lshl_b32 s5, s5, 2
  s_and_b32 s70, s2, 3
  s_add_u32 s5, s5, s70
  s_lshl_b32 s5, s5, 5
  s_mov_b32 s22, 6291456
  s_mov_b32 s23, 0x20000
  s_mov_b32 s26, 6291456
  s_mov_b32 s27, 0x20000
  s_mov_b32 s30, 2097152
  s_mov_b32 s31, 0x20000
  s_mov_b32 s34, 2097152
  s_mov_b32 s35, 0x20000
  s_mov_b32 s10, 805306368
  s_mov_b32 s11, 0x20000
  s_mov_b32 s38, 393216
  s_mov_b32 s39, 0x20000
  s_mov_b32 s18, 805306368
  s_mov_b32 s19, 0x20000
  s_mov_b32 s14, 805306368
  s_mov_b32 s15, 0x20000
  s_mov_b32 s42, 25165824
  s_mov_b32 s43, 0x20000
  s_cmp_eq_u32 s3, 2
  s_cbranch_scc1 L_helper
  v_and_b32 v114, 3, v0
  v_bfe_u32 v115, v0, 2, 2
  v_lshrrev_b32 v116, 4, v0
  v_and_b32 v117, 15, v0
  v_lshlrev_b32 v148, 4, v114
  v_lshl_add_u32 v148, v116, 6, v148
  v_lshrrev_b32 v237, 1, v148
  v_and_b32 v235, 2, v115
  v_lshlrev_b32 v234, 5, v235
  v_add_u32 v234, 129, v234
  v_and_b32 v149, 1, v115
  v_lshl_add_u32 v235, v149, 2, v235
  v_mul_u32_u24 v149, 33024, v149
  v_add_u32 v236, v148, v149
  v_subrev_u32 v236, 33024, v236
  v_mul_u32_u24 v149, 384, v115
  v_add_u32 v239, v149, v237
  v_mov_b32 v108, 2147483632
  s_mov_b32 s90, 0xaaaaaaab
  s_mov_b32 s91, 0x492492
  s_movk_i32 s63, 768
  s_mov_b32 s64, s3
  s_mov_b32 s97, 8
  s_mov_b32 s99, 8
  s_mov_b32 s96, 0
  v_lshlrev_b32 v120, 4, v0
  s_mul_i32 s70, s2, 2
  s_add_u32 s70, s70, s3
  s_mul_i32 s88, s70, 4096
  s_mul_i32 s86, s70, 12288
  s_waitcnt lgkmcnt(0)
  s_mov_b32 s20, s50
  s_and_b32 s21, s51, 0xffff
  s_mov_b32 s24, s52
  s_and_b32 s25, s53, 0xffff
  s_mov_b32 s28, s54
  s_and_b32 s29, s55, 0xffff
  s_mov_b32 s32, s56
  s_and_b32 s33, s57, 0xffff
  buffer_load_dwordx4 v[132:135], v120, s[20:23], s86 offen offset:0
  buffer_load_dwordx4 v[132:135], v120, s[24:27], s86 offen offset:0
  buffer_load_dwordx4 v[132:135], v120, s[28:31], s88 offen offset:0
  buffer_load_dwordx4 v[132:135], v120, s[32:35], s88 offen offset:0
  buffer_load_dwordx4 v[132:135], v120, s[20:23], s86 offen offset:1024
  buffer_load_dwordx4 v[132:135], v120, s[24:27], s86 offen offset:1024
  buffer_load_dwordx4 v[132:135], v120, s[28:31], s88 offen offset:1024
  buffer_load_dwordx4 v[132:135], v120, s[32:35], s88 offen offset:1024
  s_mov_b32 s8, s46
  s_and_b32 s9, s47, 0xffff
  s_mov_b32 s36, s44
  s_and_b32 s37, s45, 0xffff
  s_mov_b32 s16, s46
  s_and_b32 s17, s47, 0xffff
  s_mov_b32 s12, s48
  s_and_b32 s13, s49, 0xffff
  s_mov_b32 s40, s82
  s_and_b32 s41, s83, 0xffff
  s_mov_b32 s56, 0x0f0f0f0f
  s_mov_b32 s57, 0x0f0f0f0f
  s_mov_b32 s58, 0xffff
  s_mov_b32 s59, 0xffff
  s_andn2_b32 s70, s64, 1
  s_or_b32 s70, s70, s4
  s_lshr_b32 s71, s64, 5
  s_lshr_b32 s85, s96, s71
  s_cmp_lt_u32 s64, s97
  s_cselect_b32 s70, s70, s64
  s_cselect_b32 s85, s64, s85
  s_and_b32 s85, s85, 1
  s_mul_i32 s71, s71, 4064
  s_add_u32 s70, s70, s71
  s_add_u32 s70, s70, s5
  s_mul_hi_u32 s84, s70, s90
  s_lshr_b32 s84, s84, 1
  s_mul_i32 s71, s84, 3
  s_sub_u32 s70, s70, s71
  s_lshl3_add_u32 s85, s70, s85
  s_mul_i32 s61, s84, 196608
  s_lshr_b32 s89, s84, 4
  s_lshl_b32 s70, s85, 5
  v_add_u32 v100, s70, v234
  v_mul_u32_u24 v100, 21846, v100
  v_lshrrev_b32 v100, 16, v100
  v_add_u32 v148, s85, v235
  v_lshrrev_b32 v149, v148, s91
  v_and_b32 v149, 1, v149
  v_cmp_eq_u32 s[54:55], 1, v149
  s_nop 1
  s_and_b64 s[52:53], s[54:55], s[56:57]
  s_andn2_b64 s[54:55], s[54:55], s[56:57]
  v_mul_u32_u24 v148, 43, v148
  v_lshrrev_b32 v148, 8, v148
  v_mul_u32_u24 v148, 384, v148
  v_add_u32 v238, v148, v237
  v_mad_u32_u24 v92, v100, s63, v236
  v_add_u32 v93, 768, v92
  v_add_u32 v94, 4608, v92
  v_add_u32 v95, 7680, v92
  v_cndmask_b32 v92, v92, v108, s[52:53]
  v_cndmask_b32 v95, v95, v108, s[54:55]
  s_mov_b32 s60, s61
  s_mul_i32 s70, s89, 1536
  buffer_load_dwordx2 v[178:179], v239, s[36:39], s70 offen offset:0
  buffer_load_dwordx2 v[180:181], v239, s[36:39], s70 offen offset:128
  buffer_load_dwordx2 v[182:183], v239, s[36:39], s70 offen offset:256
  buffer_load_dwordx4 v[4:7], v92, s[8:11], s60 offen offset:0 nt
  buffer_load_dwordx4 v[132:135], v120, s[20:23], s86 offen offset:2048
  buffer_load_dwordx4 v[132:135], v120, s[24:27], s86 offen offset:2048
  buffer_load_dwordx4 v[132:135], v120, s[28:31], s88 offen offset:2048
  buffer_load_dwordx4 v[132:135], v120, s[32:35], s88 offen offset:2048
  buffer_load_dwordx4 v[132:135], v120, s[20:23], s86 offen offset:3072
  buffer_load_dwordx4 v[132:135], v120, s[24:27], s86 offen offset:3072
  buffer_load_dwordx4 v[132:135], v120, s[28:31], s88 offen offset:3072
  buffer_load_dwordx4 v[132:135], v120, s[32:35], s88 offen offset:3072
  s_barrier
  s_add_u32 s86, s86, 4096
  s_waitcnt vmcnt(15)
  buffer_load_dwordx4 v[132:135], v120, s[20:23], s86 offen offset:0
  s_waitcnt vmcnt(15)
  buffer_load_dwordx4 v[132:135], v120, s[24:27], s86 offen offset:0
  s_waitcnt vmcnt(15)
  buffer_load_dwordx4 v[132:135], v120, s[20:23], s86 offen offset:1024
  s_waitcnt vmcnt(15)
  buffer_load_dwordx4 v[132:135], v120, s[24:27], s86 offen offset:1024
  s_waitcnt vmcnt(15)
  buffer_load_dwordx4 v[132:135], v120, s[20:23], s86 offen offset:2048
  s_waitcnt vmcnt(15)
  buffer_load_dwordx4 v[132:135], v120, s[24:27], s86 offen offset:2048
  s_waitcnt vmcnt(15)
  buffer_load_dwordx4 v[132:135], v120, s[20:23], s86 offen offset:3072
  s_waitcnt vmcnt(15)
  buffer_load_dwordx4 v[132:135], v120, s[24:27], s86 offen offset:3072
  s_add_u32 s86, s86, 4096
  s_waitcnt vmcnt(15)
  buffer_load_dwordx4 v[132:135], v120, s[20:23], s86 offen offset:0
  s_waitcnt vmcnt(15)
  buffer_load_dwordx4 v[132:135], v120, s[24:27], s86 offen offset:0
  s_waitcnt vmcnt(15)
  buffer_load_dwordx4 v[132:135], v120, s[20:23], s86 offen offset:1024
  s_waitcnt vmcnt(15)
  buffer_load_dwordx4 v[132:135], v120, s[24:27], s86 offen offset:1024
  s_waitcnt vmcnt(15)
  buffer_load_dwordx4 v[132:135], v120, s[20:23], s86 offen offset:2048
  s_waitcnt vmcnt(15)
  buffer_load_dwordx4 v[132:135], v120, s[24:27], s86 offen offset:2048
  s_waitcnt vmcnt(15)
  buffer_load_dwordx4 v[132:135], v120, s[20:23], s86 offen offset:3072
  s_waitcnt vmcnt(15)
  buffer_load_dwordx4 v[132:135], v120, s[24:27], s86 offen offset:3072
  s_mul_i32 s62, s84, 1536
  buffer_load_dwordx2 v[184:185], v238, s[20:23], s62 offen offset:0
  buffer_load_dwordx2 v[190:191], v238, s[24:27], s62 offen offset:0
  buffer_load_dwordx2 v[186:187], v238, s[20:23], s62 offen offset:128
  buffer_load_dwordx2 v[192:193], v238, s[24:27], s62 offen offset:128
  buffer_load_dwordx2 v[188:189], v238, s[20:23], s62 offen offset:256
  buffer_load_dwordx2 v[194:195], v238, s[24:27], s62 offen offset:256
  s_waitcnt vmcnt(15)
  buffer_load_dwordx4 v[8:11], v92, s[8:11], s60 offen offset:256 nt
  s_waitcnt vmcnt(15)
  buffer_load_dwordx4 v[12:15], v92, s[8:11], s60 offen offset:512 nt
  s_waitcnt vmcnt(15)
  buffer_load_dwordx4 v[16:19], v93, s[8:11], s60 offen offset:0 nt
  s_waitcnt vmcnt(15)
  buffer_load_dwordx4 v[20:23], v93, s[8:11], s60 offen offset:256 nt
  s_waitcnt vmcnt(15)
  buffer_load_dwordx4 v[24:27], v93, s[8:11], s60 offen offset:512 nt
  s_waitcnt vmcnt(15)
  buffer_load_dwordx4 v[28:31], v93, s[8:11], s60 offen offset:768 nt
  s_waitcnt vmcnt(15)
  buffer_load_dwordx4 v[32:35], v93, s[8:11], s60 offen offset:1024 nt
  s_waitcnt vmcnt(15)
  buffer_load_dwordx4 v[36:39], v93, s[8:11], s60 offen offset:1280 nt
  s_waitcnt vmcnt(15)
  buffer_load_dwordx4 v[40:43], v93, s[8:11], s60 offen offset:1536 nt
  s_waitcnt vmcnt(15)
  buffer_load_dwordx4 v[44:47], v93, s[8:11], s60 offen offset:1792 nt
  s_waitcnt vmcnt(16)
  buffer_load_dwordx4 v[48:51], v93, s[8:11], s60 offen offset:2048 nt
  s_waitcnt vmcnt(17)
  buffer_load_dwordx4 v[52:55], v93, s[8:11], s60 offen offset:2304 nt
  s_waitcnt vmcnt(18)
  buffer_load_dwordx4 v[56:59], v93, s[8:11], s60 offen offset:2560 nt
  s_waitcnt vmcnt(19)
  buffer_load_dwordx4 v[60:63], v93, s[8:11], s60 offen offset:2816 nt
  s_mov_b32 s88, s89
  s_mov_b64 vcc, 0
  v_lshlrev_b32 v148, 4, v117
  v_and_b32 v97, 2, v116
  v_lshlrev_b32 v96, 5, v97
  v_add_u32 v96, 129, v96
  v_and_b32 v149, 1, v116
  v_lshl_add_u32 v97, v149, 2, v97
  v_mul_u32_u24 v149, 33024, v149
  v_add_u32 v98, v148, v149
  v_subrev_u32 v98, 33024, v98
  v_and_b32 v149, 1, v116
  v_mul_u32_u24 v149, 86, v149
  v_lshl_add_u32 v99, v117, 1, v149
  v_subrev_u32 v99, 86, v99
  v_lshlrev_b32 v104, 4, v116
  v_lshrrev_b32 v148, 2, v0
  s_mul_i32 s70, s3, 384
  v_lshl_add_u32 v102, v148, 4, s70
  v_lshl_add_u32 v103, v148, 3, s70
  s_mul_i32 s70, s3, 3072
  s_add_u32 s70, s70, 36864
  v_lshl_add_u32 v105, v0, 4, s70
  s_lshl_b32 s70, s3, 5
  s_add_u32 s70, s70, 43008
  v_lshl_add_u32 v106, v115, 3, s70
  s_lshl_b32 s70, s3, 2
  s_add_u32 s70, s70, 61712
  v_mov_b32 v107, s70
  v_lshrrev_b32 v111, 5, v0
  v_mul_u32_u24 v109, 16, v111
  v_mov_b32 v111, 0
  s_lshl2_add_u32 s70, s3, 61728
  v_add_u32 v109, s70, v109
  v_mov_b32 v118, 0
  v_mov_b32 v119, 0
  v_mov_b32 v240, 0xff800000
  s_mov_b32 s65, 0xffff0000
  s_mov_b32 s66, 0x3fb8aa3b
  s_mov_b32 s68, 0x4893cd3a
  s_mov_b32 s92, 0x7f000000
  s_mov_b32 s94, 0x34800000
  s_mov_b32 s69, 0x4893cd3a
  s_mov_b32 s93, 0x7f000000
  s_mov_b32 s95, 0x34800000
  s_mov_b32 s72, 0x11111111
  s_mov_b32 s73, 0x11111111
  s_mov_b32 s44, 0
  s_mov_b32 s74, 0x22222222
  s_mov_b32 s75, 0x22222222
  s_mov_b32 s45, 0
  s_mov_b32 s76, 0x44444444
  s_mov_b32 s77, 0x44444444
  s_mov_b32 s78, 0x88888888
  s_mov_b32 s79, 0x88888888
  s_mov_b32 s100, 0
  s_waitcnt vmcnt(14)
  v_mov_b32 v150, 1
  ds_write_b32 v107, v150
  v_mov_b32 v132, 0
  v_mov_b32 v133, 0
  v_mov_b32 v134, 0
  v_mov_b32 v135, 0
  v_mov_b32 v136, 0
  v_mov_b32 v137, 0
  v_mov_b32 v138, 0
  v_mov_b32 v139, 0
  v_mov_b32 v140, 0
  v_mov_b32 v141, 0
  v_mov_b32 v142, 0
  v_mov_b32 v143, 0
  v_mov_b32 v144, 0xff800000
  v_mov_b32 v146, 0x7f800000
  v_mov_b32 v147, 0
L_k:
  v_add_u32 v148, s85, v97
  v_lshrrev_b32 v149, v148, s91
  v_and_b32 v149, 1, v149
  v_cmp_eq_u32 s[50:51], 1, v149
  s_nop 1
  s_and_b64 s[48:49], s[50:51], s[58:59]
  s_andn2_b64 s[50:51], s[50:51], s[58:59]
  s_add_u32 s64, s64, 2
  s_sub_u32 s70, s64, 2
  v_add_u32 v112, s70, v111
  ds_read_b32 v110, v109
  s_waitcnt vmcnt(14)
  s_cbranch_vccnz L_kw0_0
  s_waitcnt vmcnt(9)
L_kw0_0:
  buffer_load_dwordx4 v[64:67], v93, s[8:11], s60 offen offset:3072 nt
  v_lshlrev_b32 v208, 16, v190
  v_and_b32 v209, s65, v190
  v_lshlrev_b32 v210, 16, v191
  v_and_b32 v211, s65, v191
  v_lshlrev_b32 v196, 16, v184
  v_and_b32 v197, s65, v184
  v_lshlrev_b32 v198, 16, v185
  v_and_b32 v199, s65, v185
  v_pk_mul_f32 v[208:209], v[208:209], s[94:95]
  v_mov_b32 v172, v178
  v_pk_mul_f32 v[210:211], v[210:211], s[94:95]
  v_mov_b32 v173, v179
  v_pk_fma_f32 v[114:115], v[4:5], s[92:93], v[208:209] neg_lo:[0,0,1] neg_hi:[0,0,1]
  v_pk_fma_f32 v[116:117], v[6:7], s[92:93], v[210:211] neg_lo:[0,0,1] neg_hi:[0,0,1]
  v_cvt_pk_bf16_f32 v114, 0, v114
  v_cvt_pk_bf16_f32 v115, 0, v115
  v_cvt_pk_bf16_f32 v116, 0, v116
  v_cvt_pk_bf16_f32 v117, 0, v117
  v_pk_mul_f32 v[114:115], v[114:115], v[196:197]
  v_pk_mul_f32 v[116:117], v[116:117], v[198:199]
  v_cvt_pk_bf16_f32 v220, v114, v115
  v_cvt_pk_bf16_f32 v221, v116, v117
  s_waitcnt lgkmcnt(0)
  v_cmp_lt_i32 vcc, v112, v110
  s_waitcnt vmcnt(14)
  buffer_load_dwordx4 v[68:71], v93, s[8:11], s60 offen offset:3328 nt
  v_lshlrev_b32 v212, 16, v192
  v_and_b32 v213, s65, v192
  v_lshlrev_b32 v214, 16, v193
  v_and_b32 v215, s65, v193
  v_lshlrev_b32 v200, 16, v186
  v_and_b32 v201, s65, v186
  v_lshlrev_b32 v202, 16, v187
  v_and_b32 v203, s65, v187
  v_pk_mul_f32 v[212:213], v[212:213], s[94:95]
  v_mov_b32 v174, v180
  v_pk_mul_f32 v[214:215], v[214:215], s[94:95]
  v_mov_b32 v175, v181
  v_pk_fma_f32 v[114:115], v[8:9], s[92:93], v[212:213] neg_lo:[0,0,1] neg_hi:[0,0,1]
  v_pk_fma_f32 v[116:117], v[10:11], s[92:93], v[214:215] neg_lo:[0,0,1] neg_hi:[0,0,1]
  v_cvt_pk_bf16_f32 v114, 0, v114
  v_cvt_pk_bf16_f32 v115, 0, v115
  v_cvt_pk_bf16_f32 v116, 0, v116
  v_cvt_pk_bf16_f32 v117, 0, v117
  v_pk_mul_f32 v[114:115], v[114:115], v[200:201]
  v_pk_mul_f32 v[116:117], v[116:117], v[202:203]
  v_cvt_pk_bf16_f32 v222, v114, v115
  v_cvt_pk_bf16_f32 v223, v116, v117
  s_waitcnt vmcnt(14)
  buffer_load_dwordx4 v[72:75], v93, s[8:11], s60 offen offset:3584 nt
  v_mfma_f32_16x16x32_bf16 v[228:231], v[220:223], v[172:175], 0
  v_lshlrev_b32 v216, 16, v194
  v_and_b32 v217, s65, v194
  v_lshlrev_b32 v218, 16, v195
  v_and_b32 v219, s65, v195
  v_lshlrev_b32 v204, 16, v188
  v_and_b32 v205, s65, v188
  v_lshlrev_b32 v206, 16, v189
  v_and_b32 v207, s65, v189
  v_pk_mul_f32 v[216:217], v[216:217], s[94:95]
  v_mov_b32 v176, v182
  v_pk_mul_f32 v[218:219], v[218:219], s[94:95]
  v_mov_b32 v177, v183
  v_pk_fma_f32 v[114:115], v[12:13], s[92:93], v[216:217] neg_lo:[0,0,1] neg_hi:[0,0,1]
  v_pk_fma_f32 v[116:117], v[14:15], s[92:93], v[218:219] neg_lo:[0,0,1] neg_hi:[0,0,1]
  v_cvt_pk_bf16_f32 v114, 0, v114
  v_cvt_pk_bf16_f32 v115, 0, v115
  v_cvt_pk_bf16_f32 v116, 0, v116
  v_cvt_pk_bf16_f32 v117, 0, v117
  v_pk_mul_f32 v[114:115], v[114:115], v[204:205]
  v_pk_mul_f32 v[116:117], v[116:117], v[206:207]
  v_cvt_pk_bf16_f32 v224, v114, v115
  v_cvt_pk_bf16_f32 v225, v116, v117
  s_waitcnt vmcnt(14)
  s_cbranch_vccnz L_kw0_3
  s_waitcnt vmcnt(9)
L_kw0_3:
  buffer_load_dwordx4 v[76:79], v94, s[8:11], s60 offen offset:0 nt
  v_mfma_f32_16x16x16_bf16 v[228:231], v[224:225], v[176:177], v[228:231]
  v_pk_fma_f32 v[114:115], v[16:17], s[92:93], v[208:209] neg_lo:[0,0,1] neg_hi:[0,0,1]
  v_pk_fma_f32 v[116:117], v[18:19], s[92:93], v[210:211] neg_lo:[0,0,1] neg_hi:[0,0,1]
  v_cvt_pk_bf16_f32 v114, 0, v114
  v_cvt_pk_bf16_f32 v115, 0, v115
  v_cvt_pk_bf16_f32 v116, 0, v116
  v_cvt_pk_bf16_f32 v117, 0, v117
  v_pk_mul_f32 v[114:115], v[114:115], v[196:197]
  v_pk_mul_f32 v[116:117], v[116:117], v[198:199]
  v_cvt_pk_bf16_f32 v220, v114, v115
  v_cvt_pk_bf16_f32 v221, v116, v117
  s_waitcnt vmcnt(14)
  buffer_load_dwordx4 v[80:83], v94, s[8:11], s60 offen offset:256 nt
  v_pk_fma_f32 v[114:115], v[20:21], s[92:93], v[212:213] neg_lo:[0,0,1] neg_hi:[0,0,1]
  v_pk_fma_f32 v[116:117], v[22:23], s[92:93], v[214:215] neg_lo:[0,0,1] neg_hi:[0,0,1]
  v_mov_b32_dpp v148, v228 quad_perm:[0,0,0,0] row_mask:0xf bank_mask:0xf
  v_mov_b32_dpp v149, v230 quad_perm:[2,2,2,2] row_mask:0xf bank_mask:0xf
  v_cvt_pk_bf16_f32 v114, 0, v114
  v_cvt_pk_bf16_f32 v115, 0, v115
  v_add_f32_dpp v148, v229, v148 quad_perm:[1,1,1,1] row_mask:0xf bank_mask:0xf
  v_add_f32_dpp v149, v231, v149 quad_perm:[3,3,3,3] row_mask:0xf bank_mask:0xf
  v_cvt_pk_bf16_f32 v116, 0, v116
  v_cvt_pk_bf16_f32 v117, 0, v117
  v_add_f32 v232, v148, v149
  v_pk_mul_f32 v[114:115], v[114:115], v[200:201]
  v_pk_mul_f32 v[116:117], v[116:117], v[202:203]
  v_cvt_pk_bf16_f32 v222, v114, v115
  v_cvt_pk_bf16_f32 v223, v116, v117
  s_waitcnt vmcnt(14)
  buffer_load_dwordx4 v[84:87], v94, s[8:11], s60 offen offset:512 nt
  v_mfma_f32_16x16x32_bf16 v[228:231], v[220:223], v[172:175], 0
  v_pk_fma_f32 v[114:115], v[24:25], s[92:93], v[216:217] neg_lo:[0,0,1] neg_hi:[0,0,1]
  v_pk_fma_f32 v[116:117], v[26:27], s[92:93], v[218:219] neg_lo:[0,0,1] neg_hi:[0,0,1]
  v_cvt_pk_bf16_f32 v114, 0, v114
  v_cndmask_b32 v232, v232, v240, s[48:49]
  v_cvt_pk_bf16_f32 v115, 0, v115
  v_cvt_pk_bf16_f32 v116, 0, v116
  v_cvt_pk_bf16_f32 v117, 0, v117
  v_pk_mul_f32 v[114:115], v[114:115], v[204:205]
  v_pk_mul_f32 v[116:117], v[116:117], v[206:207]
  v_cvt_pk_bf16_f32 v224, v114, v115
  v_cvt_pk_bf16_f32 v225, v116, v117
  s_waitcnt vmcnt(14)
  s_cbranch_vccnz L_kw0_6
  s_waitcnt vmcnt(9)
L_kw0_6:
  buffer_load_dwordx4 v[88:91], v94, s[8:11], s60 offen offset:768 nt
  v_mfma_f32_16x16x16_bf16 v[228:231], v[224:225], v[176:177], v[228:231]
  v_pk_fma_f32 v[114:115], v[28:29], s[92:93], v[208:209] neg_lo:[0,0,1] neg_hi:[0,0,1]
  v_pk_fma_f32 v[116:117], v[30:31], s[92:93], v[210:211] neg_lo:[0,0,1] neg_hi:[0,0,1]
  v_cvt_pk_bf16_f32 v114, 0, v114
  v_cvt_pk_bf16_f32 v115, 0, v115
  v_cvt_pk_bf16_f32 v116, 0, v116
  v_cvt_pk_bf16_f32 v117, 0, v117
  v_pk_mul_f32 v[114:115], v[114:115], v[196:197]
  v_pk_mul_f32 v[116:117], v[116:117], v[198:199]
  v_cvt_pk_bf16_f32 v220, v114, v115
  v_cvt_pk_bf16_f32 v221, v116, v117
  s_waitcnt vmcnt(14)
  buffer_load_dwordx4 v[4:7], v94, s[8:11], s60 offen offset:1024 nt
  v_pk_fma_f32 v[114:115], v[32:33], s[92:93], v[212:213] neg_lo:[0,0,1] neg_hi:[0,0,1]
  v_pk_fma_f32 v[116:117], v[34:35], s[92:93], v[214:215] neg_lo:[0,0,1] neg_hi:[0,0,1]
  v_mov_b32_dpp v148, v228 quad_perm:[0,0,0,0] row_mask:0xf bank_mask:0xf
  v_mov_b32_dpp v149, v230 quad_perm:[2,2,2,2] row_mask:0xf bank_mask:0xf
  v_cvt_pk_bf16_f32 v114, 0, v114
  v_cvt_pk_bf16_f32 v115, 0, v115
  v_add_f32_dpp v148, v229, v148 quad_perm:[1,1,1,1] row_mask:0xf bank_mask:0xf
  v_add_f32_dpp v149, v231, v149 quad_perm:[3,3,3,3] row_mask:0xf bank_mask:0xf
  v_cvt_pk_bf16_f32 v116, 0, v116
  v_cvt_pk_bf16_f32 v117, 0, v117
  v_add_f32 v233, v148, v149
  v_pk_mul_f32 v[114:115], v[114:115], v[200:201]
  v_pk_mul_f32 v[116:117], v[116:117], v[202:203]
  v_cvt_pk_bf16_f32 v222, v114, v115
  v_cvt_pk_bf16_f32 v223, v116, v117
  s_waitcnt vmcnt(14)
  buffer_load_dwordx4 v[8:11], v94, s[8:11], s60 offen offset:1280 nt
  v_mfma_f32_16x16x32_bf16 v[228:231], v[220:223], v[172:175], 0
  v_pk_fma_f32 v[114:115], v[36:37], s[92:93], v[216:217] neg_lo:[0,0,1] neg_hi:[0,0,1]
  v_pk_fma_f32 v[116:117], v[38:39], s[92:93], v[218:219] neg_lo:[0,0,1] neg_hi:[0,0,1]
  v_cvt_pk_bf16_f32 v114, 0, v114
  v_cvt_pk_bf16_f32 v232, 0, v232
  v_cvt_pk_bf16_f32 v115, 0, v115
  v_cvt_pk_bf16_f32 v233, 0, v233
  v_cvt_pk_bf16_f32 v116, 0, v116
  v_pk_mul_f32 v[232:233], v[232:233], s[68:69]
  v_cvt_pk_bf16_f32 v117, 0, v117
  v_cvt_pk_bf16_f32 v124, v232, v233
  v_pk_mul_f32 v[114:115], v[114:115], v[204:205]
  v_pk_mul_f32 v[116:117], v[116:117], v[206:207]
  v_cvt_pk_bf16_f32 v224, v114, v115
  v_cvt_pk_bf16_f32 v225, v116, v117
  s_waitcnt vmcnt(14)
  s_cbranch_vccnz L_kw0_9
  s_waitcnt vmcnt(9)
L_kw0_9:
  buffer_load_dwordx4 v[12:15], v94, s[8:11], s60 offen offset:1536 nt
  v_mfma_f32_16x16x16_bf16 v[228:231], v[224:225], v[176:177], v[228:231]
  v_pk_fma_f32 v[114:115], v[40:41], s[92:93], v[208:209] neg_lo:[0,0,1] neg_hi:[0,0,1]
  v_pk_fma_f32 v[116:117], v[42:43], s[92:93], v[210:211] neg_lo:[0,0,1] neg_hi:[0,0,1]
  v_cvt_pk_bf16_f32 v114, 0, v114
  v_cvt_pk_bf16_f32 v115, 0, v115
  v_cvt_pk_bf16_f32 v116, 0, v116
  v_cvt_pk_bf16_f32 v117, 0, v117
  v_pk_mul_f32 v[114:115], v[114:115], v[196:197]
  v_pk_mul_f32 v[116:117], v[116:117], v[198:199]
  v_cvt_pk_bf16_f32 v220, v114, v115
  v_cvt_pk_bf16_f32 v221, v116, v117
  s_waitcnt vmcnt(14)
  buffer_load_dwordx4 v[16:19], v94, s[8:11], s60 offen offset:1792 nt
  v_pk_fma_f32 v[114:115], v[44:45], s[92:93], v[212:213] neg_lo:[0,0,1] neg_hi:[0,0,1]
  v_pk_fma_f32 v[116:117], v[46:47], s[92:93], v[214:215] neg_lo:[0,0,1] neg_hi:[0,0,1]
  v_mov_b32_dpp v148, v228 quad_perm:[0,0,0,0] row_mask:0xf bank_mask:0xf
  v_mov_b32_dpp v149, v230 quad_perm:[2,2,2,2] row_mask:0xf bank_mask:0xf
  v_cvt_pk_bf16_f32 v114, 0, v114
  v_cvt_pk_bf16_f32 v115, 0, v115
  v_add_f32_dpp v148, v229, v148 quad_perm:[1,1,1,1] row_mask:0xf bank_mask:0xf
  v_add_f32_dpp v149, v231, v149 quad_perm:[3,3,3,3] row_mask:0xf bank_mask:0xf
  v_cvt_pk_bf16_f32 v116, 0, v116
  v_cvt_pk_bf16_f32 v117, 0, v117
  v_add_f32 v232, v148, v149
  v_pk_mul_f32 v[114:115], v[114:115], v[200:201]
  v_pk_mul_f32 v[116:117], v[116:117], v[202:203]
  v_cvt_pk_bf16_f32 v222, v114, v115
  v_cvt_pk_bf16_f32 v223, v116, v117
  s_waitcnt vmcnt(14)
  buffer_load_dwordx4 v[20:23], v94, s[8:11], s60 offen offset:2048 nt
  v_mfma_f32_16x16x32_bf16 v[228:231], v[220:223], v[172:175], 0
  v_pk_fma_f32 v[114:115], v[48:49], s[92:93], v[216:217] neg_lo:[0,0,1] neg_hi:[0,0,1]
  v_pk_fma_f32 v[116:117], v[50:51], s[92:93], v[218:219] neg_lo:[0,0,1] neg_hi:[0,0,1]
  v_cvt_pk_bf16_f32 v114, 0, v114
  v_cvt_pk_bf16_f32 v115, 0, v115
  v_cvt_pk_bf16_f32 v116, 0, v116
  v_cvt_pk_bf16_f32 v117, 0, v117
  v_pk_mul_f32 v[114:115], v[114:115], v[204:205]
  v_pk_mul_f32 v[116:117], v[116:117], v[206:207]
  v_cvt_pk_bf16_f32 v224, v114, v115
  v_cvt_pk_bf16_f32 v225, v116, v117
  s_waitcnt vmcnt(14)
  s_cbranch_vccnz L_kw0_12
  s_waitcnt vmcnt(9)
L_kw0_12:
  buffer_load_dwordx4 v[24:27], v94, s[8:11], s60 offen offset:2304 nt
  v_mfma_f32_16x16x16_bf16 v[228:231], v[224:225], v[176:177], v[228:231]
  v_pk_fma_f32 v[114:115], v[52:53], s[92:93], v[208:209] neg_lo:[0,0,1] neg_hi:[0,0,1]
  v_pk_fma_f32 v[116:117], v[54:55], s[92:93], v[210:211] neg_lo:[0,0,1] neg_hi:[0,0,1]
  v_cvt_pk_bf16_f32 v114, 0, v114
  v_cvt_pk_bf16_f32 v115, 0, v115
  v_cvt_pk_bf16_f32 v116, 0, v116
  v_cvt_pk_bf16_f32 v117, 0, v117
  v_pk_mul_f32 v[114:115], v[114:115], v[196:197]
  v_pk_mul_f32 v[116:117], v[116:117], v[198:199]
  v_cvt_pk_bf16_f32 v220, v114, v115
  v_cvt_pk_bf16_f32 v221, v116, v117
  s_waitcnt vmcnt(14)
  buffer_load_dwordx4 v[28:31], v94, s[8:11], s60 offen offset:2560 nt
  v_pk_fma_f32 v[114:115], v[56:57], s[92:93], v[212:213] neg_lo:[0,0,1] neg_hi:[0,0,1]
  v_pk_fma_f32 v[116:117], v[58:59], s[92:93], v[214:215] neg_lo:[0,0,1] neg_hi:[0,0,1]
  v_mov_b32_dpp v148, v228 quad_perm:[0,0,0,0] row_mask:0xf bank_mask:0xf
  v_mov_b32_dpp v149, v230 quad_perm:[2,2,2,2] row_mask:0xf bank_mask:0xf
  v_cvt_pk_bf16_f32 v114, 0, v114
  v_cvt_pk_bf16_f32 v115, 0, v115
  v_add_f32_dpp v148, v229, v148 quad_perm:[1,1,1,1] row_mask:0xf bank_mask:0xf
  v_add_f32_dpp v149, v231, v149 quad_perm:[3,3,3,3] row_mask:0xf bank_mask:0xf
  v_cvt_pk_bf16_f32 v116, 0, v116
  v_cvt_pk_bf16_f32 v117, 0, v117
  v_add_f32 v233, v148, v149
  v_pk_mul_f32 v[114:115], v[114:115], v[200:201]
  v_pk_mul_f32 v[116:117], v[116:117], v[202:203]
  v_cvt_pk_bf16_f32 v222, v114, v115
  v_cvt_pk_bf16_f32 v223, v116, v117
  s_waitcnt vmcnt(14)
  buffer_load_dwordx4 v[32:35], v94, s[8:11], s60 offen offset:2816 nt
  v_mfma_f32_16x16x32_bf16 v[228:231], v[220:223], v[172:175], 0
  v_pk_fma_f32 v[114:115], v[60:61], s[92:93], v[216:217] neg_lo:[0,0,1] neg_hi:[0,0,1]
  v_pk_fma_f32 v[116:117], v[62:63], s[92:93], v[218:219] neg_lo:[0,0,1] neg_hi:[0,0,1]
  v_cvt_pk_bf16_f32 v114, 0, v114
  v_cvt_pk_bf16_f32 v232, 0, v232
  v_cvt_pk_bf16_f32 v115, 0, v115
  v_cvt_pk_bf16_f32 v233, 0, v233
  v_cvt_pk_bf16_f32 v116, 0, v116
  v_pk_mul_f32 v[232:233], v[232:233], s[68:69]
  v_cvt_pk_bf16_f32 v117, 0, v117
  v_cvt_pk_bf16_f32 v125, v232, v233
  v_pk_mul_f32 v[114:115], v[114:115], v[204:205]
  v_pk_mul_f32 v[116:117], v[116:117], v[206:207]
  v_cvt_pk_bf16_f32 v224, v114, v115
  v_cvt_pk_bf16_f32 v225, v116, v117
  s_waitcnt vmcnt(14)
  s_cbranch_vccnz L_kw0_15
  s_waitcnt vmcnt(9)
L_kw0_15:
  buffer_load_dwordx4 v[36:39], v95, s[8:11], s60 offen offset:0 nt
  v_mfma_f32_16x16x16_bf16 v[228:231], v[224:225], v[176:177], v[228:231]
  v_pk_fma_f32 v[114:115], v[64:65], s[92:93], v[208:209] neg_lo:[0,0,1] neg_hi:[0,0,1]
  v_pk_fma_f32 v[116:117], v[66:67], s[92:93], v[210:211] neg_lo:[0,0,1] neg_hi:[0,0,1]
  v_cvt_pk_bf16_f32 v114, 0, v114
  v_cvt_pk_bf16_f32 v115, 0, v115
  v_cvt_pk_bf16_f32 v116, 0, v116
  v_cvt_pk_bf16_f32 v117, 0, v117
  v_pk_mul_f32 v[114:115], v[114:115], v[196:197]
  v_pk_mul_f32 v[116:117], v[116:117], v[198:199]
  v_cvt_pk_bf16_f32 v220, v114, v115
  v_cvt_pk_bf16_f32 v221, v116, v117
  s_waitcnt vmcnt(14)
  buffer_load_dwordx4 v[40:43], v95, s[8:11], s60 offen offset:256 nt
  v_pk_fma_f32 v[114:115], v[68:69], s[92:93], v[212:213] neg_lo:[0,0,1] neg_hi:[0,0,1]
  v_pk_fma_f32 v[116:117], v[70:71], s[92:93], v[214:215] neg_lo:[0,0,1] neg_hi:[0,0,1]
  v_mov_b32_dpp v148, v228 quad_perm:[0,0,0,0] row_mask:0xf bank_mask:0xf
  v_mov_b32_dpp v149, v230 quad_perm:[2,2,2,2] row_mask:0xf bank_mask:0xf
  v_cvt_pk_bf16_f32 v114, 0, v114
  v_cvt_pk_bf16_f32 v115, 0, v115
  v_add_f32_dpp v148, v229, v148 quad_perm:[1,1,1,1] row_mask:0xf bank_mask:0xf
  v_add_f32_dpp v149, v231, v149 quad_perm:[3,3,3,3] row_mask:0xf bank_mask:0xf
  v_cvt_pk_bf16_f32 v116, 0, v116
  v_cvt_pk_bf16_f32 v117, 0, v117
  v_add_f32 v232, v148, v149
  v_pk_mul_f32 v[114:115], v[114:115], v[200:201]
  v_pk_mul_f32 v[116:117], v[116:117], v[202:203]
  v_cvt_pk_bf16_f32 v222, v114, v115
  v_cvt_pk_bf16_f32 v223, v116, v117
  s_waitcnt vmcnt(14)
  buffer_load_dwordx4 v[44:47], v95, s[8:11], s60 offen offset:512 nt
  v_mfma_f32_16x16x32_bf16 v[228:231], v[220:223], v[172:175], 0
  v_pk_fma_f32 v[114:115], v[72:73], s[92:93], v[216:217] neg_lo:[0,0,1] neg_hi:[0,0,1]
  v_pk_fma_f32 v[116:117], v[74:75], s[92:93], v[218:219] neg_lo:[0,0,1] neg_hi:[0,0,1]
  s_cmp_lt_u32 s64, s99
  s_cbranch_scc1 L_k_known0
L_k_spin0:
  v_mov_b32 v148, 61696
  ds_read_b32 v148, v148
  s_waitcnt lgkmcnt(0)
  v_readfirstlane_b32 s96, v148
  s_nop 1
  s_cmp_eq_u32 s96, 0
  s_cbranch_scc1 L_k_spin0
  s_mov_b32 s99, -1
  s_bitcmp1_b32 s96, 6
  s_cselect_b32 s97, 255, s97
L_k_known0:
  s_andn2_b32 s70, s64, 1
  s_or_b32 s70, s70, s4
  s_lshr_b32 s71, s64, 5
  s_lshr_b32 s85, s96, s71
  s_cmp_lt_u32 s64, s97
  s_cselect_b32 s70, s70, s64
  s_cselect_b32 s85, s64, s85
  s_and_b32 s85, s85, 1
  s_mul_i32 s71, s71, 4064
  s_add_u32 s70, s70, s71
  s_add_u32 s70, s70, s5
  s_mul_hi_u32 s84, s70, s90
  s_lshr_b32 s84, s84, 1
  s_mul_i32 s71, s84, 3
  s_sub_u32 s70, s70, s71
  s_lshl3_add_u32 s85, s70, s85
  s_mul_i32 s61, s84, 196608
  s_lshr_b32 s89, s84, 4
  s_lshl_b32 s70, s85, 5
  v_add_u32 v100, s70, v234
  v_mul_u32_u24 v100, 21846, v100
  v_lshrrev_b32 v100, 16, v100
  v_add_u32 v148, s85, v235
  v_lshrrev_b32 v149, v148, s91
  v_and_b32 v149, 1, v149
  v_cmp_eq_u32 s[54:55], 1, v149
  s_nop 1
  s_and_b64 s[52:53], s[54:55], s[56:57]
  s_andn2_b64 s[54:55], s[54:55], s[56:57]
  v_mul_u32_u24 v148, 43, v148
  v_lshrrev_b32 v148, 8, v148
  v_mul_u32_u24 v148, 384, v148
  v_add_u32 v238, v148, v237
  s_cmp_eq_u32 s89, s88
  s_cbranch_scc1 L_k_sameq0
  s_mul_i32 s70, s89, 1536
  buffer_load_dwordx2 v[178:179], v239, s[36:39], s70 offen offset:0
  buffer_load_dwordx2 v[180:181], v239, s[36:39], s70 offen offset:128
  buffer_load_dwordx2 v[182:183], v239, s[36:39], s70 offen offset:256
  s_mov_b32 s88, s89
L_k_sameq0:
  s_mul_i32 s62, s84, 1536
  buffer_load_dwordx2 v[184:185], v238, s[20:23], s62 offen offset:0
  buffer_load_dwordx2 v[190:191], v238, s[24:27], s62 offen offset:0
  buffer_load_dwordx2 v[186:187], v238, s[20:23], s62 offen offset:128
  buffer_load_dwordx2 v[192:193], v238, s[24:27], s62 offen offset:128
  buffer_load_dwordx2 v[188:189], v238, s[20:23], s62 offen offset:256
  buffer_load_dwordx2 v[194:195], v238, s[24:27], s62 offen offset:256
  v_cvt_pk_bf16_f32 v114, 0, v114
  v_cvt_pk_bf16_f32 v115, 0, v115
  v_cvt_pk_bf16_f32 v116, 0, v116
  v_cvt_pk_bf16_f32 v117, 0, v117
  v_pk_mul_f32 v[114:115], v[114:115], v[204:205]
  v_pk_mul_f32 v[116:117], v[116:117], v[206:207]
  v_cvt_pk_bf16_f32 v224, v114, v115
  v_cvt_pk_bf16_f32 v225, v116, v117
  v_mad_u32_u24 v92, v100, s63, v236
  v_add_u32 v93, 768, v92
  v_add_u32 v94, 4608, v92
  v_add_u32 v95, 7680, v92
  v_cndmask_b32 v92, v92, v108, s[52:53]
  v_cndmask_b32 v95, v95, v108, s[54:55]
  s_waitcnt vmcnt(20)
  s_cbranch_vccnz L_kw0_18
  s_waitcnt vmcnt(15)
L_kw0_18:
  buffer_load_dwordx4 v[48:51], v92, s[16:19], s61 offen offset:0 nt
  v_mfma_f32_16x16x16_bf16 v[228:231], v[224:225], v[176:177], v[228:231]
  v_pk_fma_f32 v[114:115], v[76:77], s[92:93], v[208:209] neg_lo:[0,0,1] neg_hi:[0,0,1]
  v_pk_fma_f32 v[116:117], v[78:79], s[92:93], v[210:211] neg_lo:[0,0,1] neg_hi:[0,0,1]
  v_cvt_pk_bf16_f32 v114, 0, v114
  v_cvt_pk_bf16_f32 v115, 0, v115
  v_cvt_pk_bf16_f32 v116, 0, v116
  v_cvt_pk_bf16_f32 v117, 0, v117
  v_pk_mul_f32 v[114:115], v[114:115], v[196:197]
  v_pk_mul_f32 v[116:117], v[116:117], v[198:199]
  v_cvt_pk_bf16_f32 v220, v114, v115
  v_cvt_pk_bf16_f32 v221, v116, v117
  s_waitcnt vmcnt(20)
  buffer_load_dwordx4 v[52:55], v92, s[16:19], s61 offen offset:256 nt
  v_pk_fma_f32 v[114:115], v[80:81], s[92:93], v[212:213] neg_lo:[0,0,1] neg_hi:[0,0,1]
  v_pk_fma_f32 v[116:117], v[82:83], s[92:93], v[214:215] neg_lo:[0,0,1] neg_hi:[0,0,1]
  v_mov_b32_dpp v148, v228 quad_perm:[0,0,0,0] row_mask:0xf bank_mask:0xf
  v_mov_b32_dpp v149, v230 quad_perm:[2,2,2,2] row_mask:0xf bank_mask:0xf
  v_cvt_pk_bf16_f32 v114, 0, v114
  v_cvt_pk_bf16_f32 v115, 0, v115
  v_add_f32_dpp v148, v229, v148 quad_perm:[1,1,1,1] row_mask:0xf bank_mask:0xf
  v_add_f32_dpp v149, v231, v149 quad_perm:[3,3,3,3] row_mask:0xf bank_mask:0xf
  v_cvt_pk_bf16_f32 v116, 0, v116
  v_cvt_pk_bf16_f32 v117, 0, v117
  v_add_f32 v233, v148, v149
  v_pk_mul_f32 v[114:115], v[114:115], v[200:201]
  v_pk_mul_f32 v[116:117], v[116:117], v[202:203]
  v_cvt_pk_bf16_f32 v222, v114, v115
  v_cvt_pk_bf16_f32 v223, v116, v117
  s_waitcnt vmcnt(20)
  buffer_load_dwordx4 v[56:59], v92, s[16:19], s61 offen offset:512 nt
  v_mfma_f32_16x16x32_bf16 v[228:231], v[220:223], v[172:175], 0
  v_pk_fma_f32 v[114:115], v[84:85], s[92:93], v[216:217] neg_lo:[0,0,1] neg_hi:[0,0,1]
  v_pk_fma_f32 v[116:117], v[86:87], s[92:93], v[218:219] neg_lo:[0,0,1] neg_hi:[0,0,1]
  v_cvt_pk_bf16_f32 v114, 0, v114
  v_cvt_pk_bf16_f32 v232, 0, v232
  v_cvt_pk_bf16_f32 v115, 0, v115
  v_cvt_pk_bf16_f32 v233, 0, v233
  v_cvt_pk_bf16_f32 v116, 0, v116
  v_pk_mul_f32 v[232:233], v[232:233], s[68:69]
  v_cvt_pk_bf16_f32 v117, 0, v117
  v_cvt_pk_bf16_f32 v126, v232, v233
  v_pk_mul_f32 v[114:115], v[114:115], v[204:205]
  v_pk_mul_f32 v[116:117], v[116:117], v[206:207]
  v_cvt_pk_bf16_f32 v224, v114, v115
  v_cvt_pk_bf16_f32 v225, v116, v117
  s_waitcnt vmcnt(20)
  s_cbranch_vccnz L_kw0_21
  s_waitcnt vmcnt(15)
L_kw0_21:
  buffer_load_dwordx4 v[60:63], v93, s[16:19], s61 offen offset:0 nt
  v_mfma_f32_16x16x16_bf16 v[228:231], v[224:225], v[176:177], v[228:231]
  v_pk_fma_f32 v[114:115], v[88:89], s[92:93], v[208:209] neg_lo:[0,0,1] neg_hi:[0,0,1]
  v_pk_fma_f32 v[116:117], v[90:91], s[92:93], v[210:211] neg_lo:[0,0,1] neg_hi:[0,0,1]
  v_cvt_pk_bf16_f32 v114, 0, v114
  v_cvt_pk_bf16_f32 v115, 0, v115
  v_cvt_pk_bf16_f32 v116, 0, v116
  v_cvt_pk_bf16_f32 v117, 0, v117
  v_pk_mul_f32 v[114:115], v[114:115], v[196:197]
  v_pk_mul_f32 v[116:117], v[116:117], v[198:199]
  v_cvt_pk_bf16_f32 v220, v114, v115
  v_cvt_pk_bf16_f32 v221, v116, v117
  s_waitcnt vmcnt(20)
  buffer_load_dwordx4 v[64:67], v93, s[16:19], s61 offen offset:256 nt
  v_pk_fma_f32 v[114:115], v[4:5], s[92:93], v[212:213] neg_lo:[0,0,1] neg_hi:[0,0,1]
  v_pk_fma_f32 v[116:117], v[6:7], s[92:93], v[214:215] neg_lo:[0,0,1] neg_hi:[0,0,1]
  v_mov_b32_dpp v148, v228 quad_perm:[0,0,0,0] row_mask:0xf bank_mask:0xf
  v_mov_b32_dpp v149, v230 quad_perm:[2,2,2,2] row_mask:0xf bank_mask:0xf
  v_cvt_pk_bf16_f32 v114, 0, v114
  v_cvt_pk_bf16_f32 v115, 0, v115
  v_add_f32_dpp v148, v229, v148 quad_perm:[1,1,1,1] row_mask:0xf bank_mask:0xf
  v_add_f32_dpp v149, v231, v149 quad_perm:[3,3,3,3] row_mask:0xf bank_mask:0xf
  v_cvt_pk_bf16_f32 v116, 0, v116
  v_cvt_pk_bf16_f32 v117, 0, v117
  v_add_f32 v232, v148, v149
  v_pk_mul_f32 v[114:115], v[114:115], v[200:201]
  v_pk_mul_f32 v[116:117], v[116:117], v[202:203]
  v_cvt_pk_bf16_f32 v222, v114, v115
  v_cvt_pk_bf16_f32 v223, v116, v117
  s_waitcnt vmcnt(20)
  buffer_load_dwordx4 v[68:71], v93, s[16:19], s61 offen offset:512 nt
  v_mfma_f32_16x16x32_bf16 v[228:231], v[220:223], v[172:175], 0
  v_pk_fma_f32 v[114:115], v[8:9], s[92:93], v[216:217] neg_lo:[0,0,1] neg_hi:[0,0,1]
  v_pk_fma_f32 v[116:117], v[10:11], s[92:93], v[218:219] neg_lo:[0,0,1] neg_hi:[0,0,1]
  v_cvt_pk_bf16_f32 v114, 0, v114
  v_cvt_pk_bf16_f32 v115, 0, v115
  v_cvt_pk_bf16_f32 v116, 0, v116
  v_cvt_pk_bf16_f32 v117, 0, v117
  v_pk_mul_f32 v[114:115], v[114:115], v[204:205]
  v_pk_mul_f32 v[116:117], v[116:117], v[206:207]
  v_cvt_pk_bf16_f32 v224, v114, v115
  v_cvt_pk_bf16_f32 v225, v116, v117
  s_waitcnt vmcnt(20)
  s_cbranch_vccnz L_kw0_24
  s_waitcnt vmcnt(15)
L_kw0_24:
  buffer_load_dwordx4 v[72:75], v93, s[16:19], s61 offen offset:768 nt
  v_mfma_f32_16x16x16_bf16 v[228:231], v[224:225], v[176:177], v[228:231]
  v_pk_fma_f32 v[114:115], v[12:13], s[92:93], v[208:209] neg_lo:[0,0,1] neg_hi:[0,0,1]
  v_pk_fma_f32 v[116:117], v[14:15], s[92:93], v[210:211] neg_lo:[0,0,1] neg_hi:[0,0,1]
  v_cvt_pk_bf16_f32 v114, 0, v114
  v_cvt_pk_bf16_f32 v115, 0, v115
  v_cvt_pk_bf16_f32 v116, 0, v116
  v_cvt_pk_bf16_f32 v117, 0, v117
  v_pk_mul_f32 v[114:115], v[114:115], v[196:197]
  v_pk_mul_f32 v[116:117], v[116:117], v[198:199]
  v_cvt_pk_bf16_f32 v220, v114, v115
  v_cvt_pk_bf16_f32 v221, v116, v117
  s_waitcnt vmcnt(20)
  buffer_load_dwordx4 v[76:79], v93, s[16:19], s61 offen offset:1024 nt
  v_pk_fma_f32 v[114:115], v[16:17], s[92:93], v[212:213] neg_lo:[0,0,1] neg_hi:[0,0,1]
  v_pk_fma_f32 v[116:117], v[18:19], s[92:93], v[214:215] neg_lo:[0,0,1] neg_hi:[0,0,1]
  v_mov_b32_dpp v148, v228 quad_perm:[0,0,0,0] row_mask:0xf bank_mask:0xf
  v_mov_b32_dpp v149, v230 quad_perm:[2,2,2,2] row_mask:0xf bank_mask:0xf
  v_cvt_pk_bf16_f32 v114, 0, v114
  v_cvt_pk_bf16_f32 v115, 0, v115
  v_add_f32_dpp v148, v229, v148 quad_perm:[1,1,1,1] row_mask:0xf bank_mask:0xf
  v_add_f32_dpp v149, v231, v149 quad_perm:[3,3,3,3] row_mask:0xf bank_mask:0xf
  v_cvt_pk_bf16_f32 v116, 0, v116
  v_cvt_pk_bf16_f32 v117, 0, v117
  v_add_f32 v233, v148, v149
  v_pk_mul_f32 v[114:115], v[114:115], v[200:201]
  v_pk_mul_f32 v[116:117], v[116:117], v[202:203]
  v_cvt_pk_bf16_f32 v222, v114, v115
  v_cvt_pk_bf16_f32 v223, v116, v117
  s_waitcnt vmcnt(20)
  buffer_load_dwordx4 v[80:83], v93, s[16:19], s61 offen offset:1280 nt
  v_mfma_f32_16x16x32_bf16 v[228:231], v[220:223], v[172:175], 0
  v_pk_fma_f32 v[114:115], v[20:21], s[92:93], v[216:217] neg_lo:[0,0,1] neg_hi:[0,0,1]
  v_pk_fma_f32 v[116:117], v[22:23], s[92:93], v[218:219] neg_lo:[0,0,1] neg_hi:[0,0,1]
  v_cvt_pk_bf16_f32 v114, 0, v114
  v_cvt_pk_bf16_f32 v232, 0, v232
  v_cvt_pk_bf16_f32 v115, 0, v115
  v_cvt_pk_bf16_f32 v233, 0, v233
  v_cvt_pk_bf16_f32 v116, 0, v116
  v_pk_mul_f32 v[232:233], v[232:233], s[68:69]
  v_cvt_pk_bf16_f32 v117, 0, v117
  v_cvt_pk_bf16_f32 v127, v232, v233
  v_pk_mul_f32 v[114:115], v[114:115], v[204:205]
  v_pk_mul_f32 v[116:117], v[116:117], v[206:207]
  v_cvt_pk_bf16_f32 v224, v114, v115
  v_cvt_pk_bf16_f32 v225, v116, v117
  s_waitcnt vmcnt(20)
  s_cbranch_vccnz L_kw0_27
  s_waitcnt vmcnt(15)
L_kw0_27:
  buffer_load_dwordx4 v[84:87], v93, s[16:19], s61 offen offset:1536 nt
  v_mfma_f32_16x16x16_bf16 v[228:231], v[224:225], v[176:177], v[228:231]
  v_pk_fma_f32 v[114:115], v[24:25], s[92:93], v[208:209] neg_lo:[0,0,1] neg_hi:[0,0,1]
  v_pk_fma_f32 v[116:117], v[26:27], s[92:93], v[210:211] neg_lo:[0,0,1] neg_hi:[0,0,1]
  v_cvt_pk_bf16_f32 v114, 0, v114
  v_cvt_pk_bf16_f32 v115, 0, v115
  v_cvt_pk_bf16_f32 v116, 0, v116
  v_cvt_pk_bf16_f32 v117, 0, v117
  v_pk_mul_f32 v[114:115], v[114:115], v[196:197]
  v_pk_mul_f32 v[116:117], v[116:117], v[198:199]
  v_cvt_pk_bf16_f32 v220, v114, v115
  v_cvt_pk_bf16_f32 v221, v116, v117
  s_waitcnt vmcnt(20)
  buffer_load_dwordx4 v[88:91], v93, s[16:19], s61 offen offset:1792 nt
  v_pk_fma_f32 v[114:115], v[28:29], s[92:93], v[212:213] neg_lo:[0,0,1] neg_hi:[0,0,1]
  v_pk_fma_f32 v[116:117], v[30:31], s[92:93], v[214:215] neg_lo:[0,0,1] neg_hi:[0,0,1]
  v_mov_b32_dpp v148, v228 quad_perm:[0,0,0,0] row_mask:0xf bank_mask:0xf
  v_mov_b32_dpp v149, v230 quad_perm:[2,2,2,2] row_mask:0xf bank_mask:0xf
  v_cvt_pk_bf16_f32 v114, 0, v114
  v_cvt_pk_bf16_f32 v115, 0, v115
  v_add_f32_dpp v148, v229, v148 quad_perm:[1,1,1,1] row_mask:0xf bank_mask:0xf
  v_add_f32_dpp v149, v231, v149 quad_perm:[3,3,3,3] row_mask:0xf bank_mask:0xf
  v_cvt_pk_bf16_f32 v116, 0, v116
  v_cvt_pk_bf16_f32 v117, 0, v117
  v_add_f32 v232, v148, v149
  v_pk_mul_f32 v[114:115], v[114:115], v[200:201]
  v_pk_mul_f32 v[116:117], v[116:117], v[202:203]
  v_cvt_pk_bf16_f32 v222, v114, v115
  v_cvt_pk_bf16_f32 v223, v116, v117
  s_waitcnt vmcnt(20)
  buffer_load_dwordx4 v[4:7], v93, s[16:19], s61 offen offset:2048 nt
  v_mfma_f32_16x16x32_bf16 v[228:231], v[220:223], v[172:175], 0
  v_pk_fma_f32 v[114:115], v[32:33], s[92:93], v[216:217] neg_lo:[0,0,1] neg_hi:[0,0,1]
  v_pk_fma_f32 v[116:117], v[34:35], s[92:93], v[218:219] neg_lo:[0,0,1] neg_hi:[0,0,1]
  v_cvt_pk_bf16_f32 v114, 0, v114
  v_cvt_pk_bf16_f32 v115, 0, v115
  v_cvt_pk_bf16_f32 v116, 0, v116
  v_cvt_pk_bf16_f32 v117, 0, v117
  v_pk_mul_f32 v[114:115], v[114:115], v[204:205]
  v_pk_mul_f32 v[116:117], v[116:117], v[206:207]
  v_cvt_pk_bf16_f32 v224, v114, v115
  v_cvt_pk_bf16_f32 v225, v116, v117
  s_waitcnt vmcnt(20)
  s_cbranch_vccnz L_kw0_30
  s_waitcnt vmcnt(9)
L_kw0_30:
  buffer_load_dwordx4 v[8:11], v93, s[16:19], s61 offen offset:2304 nt
  v_mfma_f32_16x16x16_bf16 v[228:231], v[224:225], v[176:177], v[228:231]
  v_pk_fma_f32 v[114:115], v[36:37], s[92:93], v[208:209] neg_lo:[0,0,1] neg_hi:[0,0,1]
  v_pk_fma_f32 v[116:117], v[38:39], s[92:93], v[210:211] neg_lo:[0,0,1] neg_hi:[0,0,1]
  v_cvt_pk_bf16_f32 v114, 0, v114
  v_cvt_pk_bf16_f32 v115, 0, v115
  v_cvt_pk_bf16_f32 v116, 0, v116
  v_cvt_pk_bf16_f32 v117, 0, v117
  v_pk_mul_f32 v[114:115], v[114:115], v[196:197]
  v_pk_mul_f32 v[116:117], v[116:117], v[198:199]
  v_cvt_pk_bf16_f32 v220, v114, v115
  v_cvt_pk_bf16_f32 v221, v116, v117
  s_waitcnt vmcnt(20)
  buffer_load_dwordx4 v[12:15], v93, s[16:19], s61 offen offset:2560 nt
  v_pk_fma_f32 v[114:115], v[40:41], s[92:93], v[212:213] neg_lo:[0,0,1] neg_hi:[0,0,1]
  v_pk_fma_f32 v[116:117], v[42:43], s[92:93], v[214:215] neg_lo:[0,0,1] neg_hi:[0,0,1]
  v_mov_b32_dpp v148, v228 quad_perm:[0,0,0,0] row_mask:0xf bank_mask:0xf
  v_mov_b32_dpp v149, v230 quad_perm:[2,2,2,2] row_mask:0xf bank_mask:0xf
  v_cvt_pk_bf16_f32 v114, 0, v114
  v_cvt_pk_bf16_f32 v115, 0, v115
  v_add_f32_dpp v148, v229, v148 quad_perm:[1,1,1,1] row_mask:0xf bank_mask:0xf
  v_add_f32_dpp v149, v231, v149 quad_perm:[3,3,3,3] row_mask:0xf bank_mask:0xf
  v_cvt_pk_bf16_f32 v116, 0, v116
  v_cvt_pk_bf16_f32 v117, 0, v117
  v_add_f32 v233, v148, v149
  v_pk_mul_f32 v[114:115], v[114:115], v[200:201]
  v_pk_mul_f32 v[116:117], v[116:117], v[202:203]
  v_cvt_pk_bf16_f32 v222, v114, v115
  v_cvt_pk_bf16_f32 v223, v116, v117
  s_waitcnt vmcnt(20)
  buffer_load_dwordx4 v[16:19], v93, s[16:19], s61 offen offset:2816 nt
  v_mfma_f32_16x16x32_bf16 v[228:231], v[220:223], v[172:175], 0
  v_pk_fma_f32 v[114:115], v[44:45], s[92:93], v[216:217] neg_lo:[0,0,1] neg_hi:[0,0,1]
  v_pk_fma_f32 v[116:117], v[46:47], s[92:93], v[218:219] neg_lo:[0,0,1] neg_hi:[0,0,1]
  v_cvt_pk_bf16_f32 v114, 0, v114
  v_cvt_pk_bf16_f32 v232, 0, v232
  v_cvt_pk_bf16_f32 v115, 0, v115
  v_cvt_pk_bf16_f32 v233, 0, v233
  v_cvt_pk_bf16_f32 v116, 0, v116
  v_pk_mul_f32 v[232:233], v[232:233], s[68:69]
  v_cvt_pk_bf16_f32 v117, 0, v117
  v_cvt_pk_bf16_f32 v128, v232, v233
  v_pk_mul_f32 v[114:115], v[114:115], v[204:205]
  v_pk_mul_f32 v[116:117], v[116:117], v[206:207]
  v_cvt_pk_bf16_f32 v224, v114, v115
  v_cvt_pk_bf16_f32 v225, v116, v117
  s_mov_b32 s60, s61
  v_mov_b32 v150, s64
  v_mfma_f32_16x16x16_bf16 v[228:231], v[224:225], v[176:177], v[228:231]
  ds_write_b128 v102, v[124:127]
  v_add_u32 v102, 768, v102
  s_nop 5
  v_mov_b32_dpp v148, v228 quad_perm:[0,0,0,0] row_mask:0xf bank_mask:0xf
  v_mov_b32_dpp v149, v230 quad_perm:[2,2,2,2] row_mask:0xf bank_mask:0xf
  s_nop 0
  v_add_f32_dpp v148, v229, v148 quad_perm:[1,1,1,1] row_mask:0xf bank_mask:0xf
  v_add_f32_dpp v149, v231, v149 quad_perm:[3,3,3,3] row_mask:0xf bank_mask:0xf
  v_add_f32 v232, v148, v149
  v_cndmask_b32 v232, v232, v240, s[50:51]
  v_cvt_pk_bf16_f32 v232, 0, v232
  v_cvt_pk_bf16_f32 v233, 0, v233
  v_pk_mul_f32 v[232:233], v[232:233], s[68:69]
  v_cvt_pk_bf16_f32 v129, v232, v233
  ds_write_b64 v103, v[128:129] offset:256
  ds_write_b32 v107, v150
  v_add_u32 v103, 768, v103
  v_add_u32 v148, s85, v97
  v_lshrrev_b32 v149, v148, s91
  v_and_b32 v149, 1, v149
  v_cmp_eq_u32 s[50:51], 1, v149
  s_nop 1
  s_and_b64 s[48:49], s[50:51], s[58:59]
  s_andn2_b64 s[50:51], s[50:51], s[58:59]
  s_add_u32 s64, s64, 2
  s_sub_u32 s70, s64, 2
  v_add_u32 v112, s70, v111
  ds_read_b32 v110, v109
  s_waitcnt vmcnt(14)
  s_cbranch_vccnz L_kw1_0
  s_waitcnt vmcnt(9)
L_kw1_0:
  buffer_load_dwordx4 v[20:23], v93, s[8:11], s60 offen offset:3072 nt
  v_lshlrev_b32 v208, 16, v190
  v_and_b32 v209, s65, v190
  v_lshlrev_b32 v210, 16, v191
  v_and_b32 v211, s65, v191
  v_lshlrev_b32 v196, 16, v184
  v_and_b32 v197, s65, v184
  v_lshlrev_b32 v198, 16, v185
  v_and_b32 v199, s65, v185
  v_pk_mul_f32 v[208:209], v[208:209], s[94:95]
  v_mov_b32 v172, v178
  v_pk_mul_f32 v[210:211], v[210:211], s[94:95]
  v_mov_b32 v173, v179
  v_pk_fma_f32 v[114:115], v[48:49], s[92:93], v[208:209] neg_lo:[0,0,1] neg_hi:[0,0,1]
  v_pk_fma_f32 v[116:117], v[50:51], s[92:93], v[210:211] neg_lo:[0,0,1] neg_hi:[0,0,1]
  v_cvt_pk_bf16_f32 v114, 0, v114
  v_cvt_pk_bf16_f32 v115, 0, v115
  v_cvt_pk_bf16_f32 v116, 0, v116
  v_cvt_pk_bf16_f32 v117, 0, v117
  v_pk_mul_f32 v[114:115], v[114:115], v[196:197]
  v_pk_mul_f32 v[116:117], v[116:117], v[198:199]
  v_cvt_pk_bf16_f32 v220, v114, v115
  v_cvt_pk_bf16_f32 v221, v116, v117
  s_waitcnt lgkmcnt(0)
  v_cmp_lt_i32 vcc, v112, v110
  s_waitcnt vmcnt(14)
  buffer_load_dwordx4 v[24:27], v93, s[8:11], s60 offen offset:3328 nt
  v_lshlrev_b32 v212, 16, v192
  v_and_b32 v213, s65, v192
  v_lshlrev_b32 v214, 16, v193
  v_and_b32 v215, s65, v193
  v_lshlrev_b32 v200, 16, v186
  v_and_b32 v201, s65, v186
  v_lshlrev_b32 v202, 16, v187
  v_and_b32 v203, s65, v187
  v_pk_mul_f32 v[212:213], v[212:213], s[94:95]
  v_mov_b32 v174, v180
  v_pk_mul_f32 v[214:215], v[214:215], s[94:95]
  v_mov_b32 v175, v181
  v_pk_fma_f32 v[114:115], v[52:53], s[92:93], v[212:213] neg_lo:[0,0,1] neg_hi:[0,0,1]
  v_pk_fma_f32 v[116:117], v[54:55], s[92:93], v[214:215] neg_lo:[0,0,1] neg_hi:[0,0,1]
  v_cvt_pk_bf16_f32 v114, 0, v114
  v_cvt_pk_bf16_f32 v115, 0, v115
  v_cvt_pk_bf16_f32 v116, 0, v116
  v_cvt_pk_bf16_f32 v117, 0, v117
  v_pk_mul_f32 v[114:115], v[114:115], v[200:201]
  v_pk_mul_f32 v[116:117], v[116:117], v[202:203]
  v_cvt_pk_bf16_f32 v222, v114, v115
  v_cvt_pk_bf16_f32 v223, v116, v117
  s_waitcnt vmcnt(14)
  buffer_load_dwordx4 v[28:31], v93, s[8:11], s60 offen offset:3584 nt
  v_mfma_f32_16x16x32_bf16 v[228:231], v[220:223], v[172:175], 0
  v_lshlrev_b32 v216, 16, v194
  v_and_b32 v217, s65, v194
  v_lshlrev_b32 v218, 16, v195
  v_and_b32 v219, s65, v195
  v_lshlrev_b32 v204, 16, v188
  v_and_b32 v205, s65, v188
  v_lshlrev_b32 v206, 16, v189
  v_and_b32 v207, s65, v189
  v_pk_mul_f32 v[216:217], v[216:217], s[94:95]
  v_mov_b32 v176, v182
  v_pk_mul_f32 v[218:219], v[218:219], s[94:95]
  v_mov_b32 v177, v183
  v_pk_fma_f32 v[114:115], v[56:57], s[92:93], v[216:217] neg_lo:[0,0,1] neg_hi:[0,0,1]
  v_pk_fma_f32 v[116:117], v[58:59], s[92:93], v[218:219] neg_lo:[0,0,1] neg_hi:[0,0,1]
  v_cvt_pk_bf16_f32 v114, 0, v114
  v_cvt_pk_bf16_f32 v115, 0, v115
  v_cvt_pk_bf16_f32 v116, 0, v116
  v_cvt_pk_bf16_f32 v117, 0, v117
  v_pk_mul_f32 v[114:115], v[114:115], v[204:205]
  v_pk_mul_f32 v[116:117], v[116:117], v[206:207]
  v_cvt_pk_bf16_f32 v224, v114, v115
  v_cvt_pk_bf16_f32 v225, v116, v117
  s_waitcnt vmcnt(14)
  s_cbranch_vccnz L_kw1_3
  s_waitcnt vmcnt(9)
L_kw1_3:
  buffer_load_dwordx4 v[32:35], v94, s[8:11], s60 offen offset:0 nt
  v_mfma_f32_16x16x16_bf16 v[228:231], v[224:225], v[176:177], v[228:231]
  v_pk_fma_f32 v[114:115], v[60:61], s[92:93], v[208:209] neg_lo:[0,0,1] neg_hi:[0,0,1]
  v_pk_fma_f32 v[116:117], v[62:63], s[92:93], v[210:211] neg_lo:[0,0,1] neg_hi:[0,0,1]
  v_cvt_pk_bf16_f32 v114, 0, v114
  v_cvt_pk_bf16_f32 v115, 0, v115
  v_cvt_pk_bf16_f32 v116, 0, v116
  v_cvt_pk_bf16_f32 v117, 0, v117
  v_pk_mul_f32 v[114:115], v[114:115], v[196:197]
  v_pk_mul_f32 v[116:117], v[116:117], v[198:199]
  v_cvt_pk_bf16_f32 v220, v114, v115
  v_cvt_pk_bf16_f32 v221, v116, v117
  s_waitcnt vmcnt(14)
  buffer_load_dwordx4 v[36:39], v94, s[8:11], s60 offen offset:256 nt
  v_pk_fma_f32 v[114:115], v[64:65], s[92:93], v[212:213] neg_lo:[0,0,1] neg_hi:[0,0,1]
  v_pk_fma_f32 v[116:117], v[66:67], s[92:93], v[214:215] neg_lo:[0,0,1] neg_hi:[0,0,1]
  v_mov_b32_dpp v148, v228 quad_perm:[0,0,0,0] row_mask:0xf bank_mask:0xf
  v_mov_b32_dpp v149, v230 quad_perm:[2,2,2,2] row_mask:0xf bank_mask:0xf
  v_cvt_pk_bf16_f32 v114, 0, v114
  v_cvt_pk_bf16_f32 v115, 0, v115
  v_add_f32_dpp v148, v229, v148 quad_perm:[1,1,1,1] row_mask:0xf bank_mask:0xf
  v_add_f32_dpp v149, v231, v149 quad_perm:[3,3,3,3] row_mask:0xf bank_mask:0xf
  v_cvt_pk_bf16_f32 v116, 0, v116
  v_cvt_pk_bf16_f32 v117, 0, v117
  v_add_f32 v232, v148, v149
  v_pk_mul_f32 v[114:115], v[114:115], v[200:201]
  v_pk_mul_f32 v[116:117], v[116:117], v[202:203]
  v_cvt_pk_bf16_f32 v222, v114, v115
  v_cvt_pk_bf16_f32 v223, v116, v117
  s_waitcnt vmcnt(14)
  buffer_load_dwordx4 v[40:43], v94, s[8:11], s60 offen offset:512 nt
  v_mfma_f32_16x16x32_bf16 v[228:231], v[220:223], v[172:175], 0
  v_pk_fma_f32 v[114:115], v[68:69], s[92:93], v[216:217] neg_lo:[0,0,1] neg_hi:[0,0,1]
  v_pk_fma_f32 v[116:117], v[70:71], s[92:93], v[218:219] neg_lo:[0,0,1] neg_hi:[0,0,1]
  v_cvt_pk_bf16_f32 v114, 0, v114
  v_cndmask_b32 v232, v232, v240, s[48:49]
  v_cvt_pk_bf16_f32 v115, 0, v115
  v_cvt_pk_bf16_f32 v116, 0, v116
  v_cvt_pk_bf16_f32 v117, 0, v117
  v_pk_mul_f32 v[114:115], v[114:115], v[204:205]
  v_pk_mul_f32 v[116:117], v[116:117], v[206:207]
  v_cvt_pk_bf16_f32 v224, v114, v115
  v_cvt_pk_bf16_f32 v225, v116, v117
  s_waitcnt vmcnt(14)
  s_cbranch_vccnz L_kw1_6
  s_waitcnt vmcnt(9)
L_kw1_6:
  buffer_load_dwordx4 v[44:47], v94, s[8:11], s60 offen offset:768 nt
  v_mfma_f32_16x16x16_bf16 v[228:231], v[224:225], v[176:177], v[228:231]
  v_pk_fma_f32 v[114:115], v[72:73], s[92:93], v[208:209] neg_lo:[0,0,1] neg_hi:[0,0,1]
  v_pk_fma_f32 v[116:117], v[74:75], s[92:93], v[210:211] neg_lo:[0,0,1] neg_hi:[0,0,1]
  v_cvt_pk_bf16_f32 v114, 0, v114
  v_cvt_pk_bf16_f32 v115, 0, v115
  v_cvt_pk_bf16_f32 v116, 0, v116
  v_cvt_pk_bf16_f32 v117, 0, v117
  v_pk_mul_f32 v[114:115], v[114:115], v[196:197]
  v_pk_mul_f32 v[116:117], v[116:117], v[198:199]
  v_cvt_pk_bf16_f32 v220, v114, v115
  v_cvt_pk_bf16_f32 v221, v116, v117
  s_waitcnt vmcnt(14)
  buffer_load_dwordx4 v[48:51], v94, s[8:11], s60 offen offset:1024 nt
  v_pk_fma_f32 v[114:115], v[76:77], s[92:93], v[212:213] neg_lo:[0,0,1] neg_hi:[0,0,1]
  v_pk_fma_f32 v[116:117], v[78:79], s[92:93], v[214:215] neg_lo:[0,0,1] neg_hi:[0,0,1]
  v_mov_b32_dpp v148, v228 quad_perm:[0,0,0,0] row_mask:0xf bank_mask:0xf
  v_mov_b32_dpp v149, v230 quad_perm:[2,2,2,2] row_mask:0xf bank_mask:0xf
  v_cvt_pk_bf16_f32 v114, 0, v114
  v_cvt_pk_bf16_f32 v115, 0, v115
  v_add_f32_dpp v148, v229, v148 quad_perm:[1,1,1,1] row_mask:0xf bank_mask:0xf
  v_add_f32_dpp v149, v231, v149 quad_perm:[3,3,3,3] row_mask:0xf bank_mask:0xf
  v_cvt_pk_bf16_f32 v116, 0, v116
  v_cvt_pk_bf16_f32 v117, 0, v117
  v_add_f32 v233, v148, v149
  v_pk_mul_f32 v[114:115], v[114:115], v[200:201]
  v_pk_mul_f32 v[116:117], v[116:117], v[202:203]
  v_cvt_pk_bf16_f32 v222, v114, v115
  v_cvt_pk_bf16_f32 v223, v116, v117
  s_waitcnt vmcnt(14)
  buffer_load_dwordx4 v[52:55], v94, s[8:11], s60 offen offset:1280 nt
  v_mfma_f32_16x16x32_bf16 v[228:231], v[220:223], v[172:175], 0
  v_pk_fma_f32 v[114:115], v[80:81], s[92:93], v[216:217] neg_lo:[0,0,1] neg_hi:[0,0,1]
  v_pk_fma_f32 v[116:117], v[82:83], s[92:93], v[218:219] neg_lo:[0,0,1] neg_hi:[0,0,1]
  v_cvt_pk_bf16_f32 v114, 0, v114
  v_cvt_pk_bf16_f32 v232, 0, v232
  v_cvt_pk_bf16_f32 v115, 0, v115
  v_cvt_pk_bf16_f32 v233, 0, v233
  v_cvt_pk_bf16_f32 v116, 0, v116
  v_pk_mul_f32 v[232:233], v[232:233], s[68:69]
  v_cvt_pk_bf16_f32 v117, 0, v117
  v_cvt_pk_bf16_f32 v124, v232, v233
  v_pk_mul_f32 v[114:115], v[114:115], v[204:205]
  v_pk_mul_f32 v[116:117], v[116:117], v[206:207]
  v_cvt_pk_bf16_f32 v224, v114, v115
  v_cvt_pk_bf16_f32 v225, v116, v117
  s_waitcnt vmcnt(14)
  s_cbranch_vccnz L_kw1_9
  s_waitcnt vmcnt(9)
L_kw1_9:
  buffer_load_dwordx4 v[56:59], v94, s[8:11], s60 offen offset:1536 nt
  v_mfma_f32_16x16x16_bf16 v[228:231], v[224:225], v[176:177], v[228:231]
  v_pk_fma_f32 v[114:115], v[84:85], s[92:93], v[208:209] neg_lo:[0,0,1] neg_hi:[0,0,1]
  v_pk_fma_f32 v[116:117], v[86:87], s[92:93], v[210:211] neg_lo:[0,0,1] neg_hi:[0,0,1]
  v_cvt_pk_bf16_f32 v114, 0, v114
  v_cvt_pk_bf16_f32 v115, 0, v115
  v_cvt_pk_bf16_f32 v116, 0, v116
  v_cvt_pk_bf16_f32 v117, 0, v117
  v_pk_mul_f32 v[114:115], v[114:115], v[196:197]
  v_pk_mul_f32 v[116:117], v[116:117], v[198:199]
  v_cvt_pk_bf16_f32 v220, v114, v115
  v_cvt_pk_bf16_f32 v221, v116, v117
  s_waitcnt vmcnt(14)
  buffer_load_dwordx4 v[60:63], v94, s[8:11], s60 offen offset:1792 nt
  v_pk_fma_f32 v[114:115], v[88:89], s[92:93], v[212:213] neg_lo:[0,0,1] neg_hi:[0,0,1]
  v_pk_fma_f32 v[116:117], v[90:91], s[92:93], v[214:215] neg_lo:[0,0,1] neg_hi:[0,0,1]
  v_mov_b32_dpp v148, v228 quad_perm:[0,0,0,0] row_mask:0xf bank_mask:0xf
  v_mov_b32_dpp v149, v230 quad_perm:[2,2,2,2] row_mask:0xf bank_mask:0xf
  v_cvt_pk_bf16_f32 v114, 0, v114
  v_cvt_pk_bf16_f32 v115, 0, v115
  v_add_f32_dpp v148, v229, v148 quad_perm:[1,1,1,1] row_mask:0xf bank_mask:0xf
  v_add_f32_dpp v149, v231, v149 quad_perm:[3,3,3,3] row_mask:0xf bank_mask:0xf
  v_cvt_pk_bf16_f32 v116, 0, v116
  v_cvt_pk_bf16_f32 v117, 0, v117
  v_add_f32 v232, v148, v149
  v_pk_mul_f32 v[114:115], v[114:115], v[200:201]
  v_pk_mul_f32 v[116:117], v[116:117], v[202:203]
  v_cvt_pk_bf16_f32 v222, v114, v115
  v_cvt_pk_bf16_f32 v223, v116, v117
  s_waitcnt vmcnt(14)
  buffer_load_dwordx4 v[64:67], v94, s[8:11], s60 offen offset:2048 nt
  v_mfma_f32_16x16x32_bf16 v[228:231], v[220:223], v[172:175], 0
  v_pk_fma_f32 v[114:115], v[4:5], s[92:93], v[216:217] neg_lo:[0,0,1] neg_hi:[0,0,1]
  v_pk_fma_f32 v[116:117], v[6:7], s[92:93], v[218:219] neg_lo:[0,0,1] neg_hi:[0,0,1]
  v_cvt_pk_bf16_f32 v114, 0, v114
  v_cvt_pk_bf16_f32 v115, 0, v115
  v_cvt_pk_bf16_f32 v116, 0, v116
  v_cvt_pk_bf16_f32 v117, 0, v117
  v_pk_mul_f32 v[114:115], v[114:115], v[204:205]
  v_pk_mul_f32 v[116:117], v[116:117], v[206:207]
  v_cvt_pk_bf16_f32 v224, v114, v115
  v_cvt_pk_bf16_f32 v225, v116, v117
  s_waitcnt vmcnt(14)
  s_cbranch_vccnz L_kw1_12
  s_waitcnt vmcnt(9)
L_kw1_12:
  buffer_load_dwordx4 v[68:71], v94, s[8:11], s60 offen offset:2304 nt
  v_mfma_f32_16x16x16_bf16 v[228:231], v[224:225], v[176:177], v[228:231]
  v_pk_fma_f32 v[114:115], v[8:9], s[92:93], v[208:209] neg_lo:[0,0,1] neg_hi:[0,0,1]
  v_pk_fma_f32 v[116:117], v[10:11], s[92:93], v[210:211] neg_lo:[0,0,1] neg_hi:[0,0,1]
  v_cvt_pk_bf16_f32 v114, 0, v114
  v_cvt_pk_bf16_f32 v115, 0, v115
  v_cvt_pk_bf16_f32 v116, 0, v116
  v_cvt_pk_bf16_f32 v117, 0, v117
  v_pk_mul_f32 v[114:115], v[114:115], v[196:197]
  v_pk_mul_f32 v[116:117], v[116:117], v[198:199]
  v_cvt_pk_bf16_f32 v220, v114, v115
  v_cvt_pk_bf16_f32 v221, v116, v117
  s_waitcnt vmcnt(14)
  buffer_load_dwordx4 v[72:75], v94, s[8:11], s60 offen offset:2560 nt
  v_pk_fma_f32 v[114:115], v[12:13], s[92:93], v[212:213] neg_lo:[0,0,1] neg_hi:[0,0,1]
  v_pk_fma_f32 v[116:117], v[14:15], s[92:93], v[214:215] neg_lo:[0,0,1] neg_hi:[0,0,1]
  v_mov_b32_dpp v148, v228 quad_perm:[0,0,0,0] row_mask:0xf bank_mask:0xf
  v_mov_b32_dpp v149, v230 quad_perm:[2,2,2,2] row_mask:0xf bank_mask:0xf
  v_cvt_pk_bf16_f32 v114, 0, v114
  v_cvt_pk_bf16_f32 v115, 0, v115
  v_add_f32_dpp v148, v229, v148 quad_perm:[1,1,1,1] row_mask:0xf bank_mask:0xf
  v_add_f32_dpp v149, v231, v149 quad_perm:[3,3,3,3] row_mask:0xf bank_mask:0xf
  v_cvt_pk_bf16_f32 v116, 0, v116
  v_cvt_pk_bf16_f32 v117, 0, v117
  v_add_f32 v233, v148, v149
  v_pk_mul_f32 v[114:115], v[114:115], v[200:201]
  v_pk_mul_f32 v[116:117], v[116:117], v[202:203]
  v_cvt_pk_bf16_f32 v222, v114, v115
  v_cvt_pk_bf16_f32 v223, v116, v117
  s_waitcnt vmcnt(14)
  buffer_load_dwordx4 v[76:79], v94, s[8:11], s60 offen offset:2816 nt
  v_mfma_f32_16x16x32_bf16 v[228:231], v[220:223], v[172:175], 0
  v_pk_fma_f32 v[114:115], v[16:17], s[92:93], v[216:217] neg_lo:[0,0,1] neg_hi:[0,0,1]
  v_pk_fma_f32 v[116:117], v[18:19], s[92:93], v[218:219] neg_lo:[0,0,1] neg_hi:[0,0,1]
  v_cvt_pk_bf16_f32 v114, 0, v114
  v_cvt_pk_bf16_f32 v232, 0, v232
  v_cvt_pk_bf16_f32 v115, 0, v115
  v_cvt_pk_bf16_f32 v233, 0, v233
  v_cvt_pk_bf16_f32 v116, 0, v116
  v_pk_mul_f32 v[232:233], v[232:233], s[68:69]
  v_cvt_pk_bf16_f32 v117, 0, v117
  v_cvt_pk_bf16_f32 v125, v232, v233
  v_pk_mul_f32 v[114:115], v[114:115], v[204:205]
  v_pk_mul_f32 v[116:117], v[116:117], v[206:207]
  v_cvt_pk_bf16_f32 v224, v114, v115
  v_cvt_pk_bf16_f32 v225, v116, v117
  s_waitcnt vmcnt(14)
  s_cbranch_vccnz L_kw1_15
  s_waitcnt vmcnt(9)
L_kw1_15:
  buffer_load_dwordx4 v[80:83], v95, s[8:11], s60 offen offset:0 nt
  v_mfma_f32_16x16x16_bf16 v[228:231], v[224:225], v[176:177], v[228:231]
  v_pk_fma_f32 v[114:115], v[20:21], s[92:93], v[208:209] neg_lo:[0,0,1] neg_hi:[0,0,1]
  v_pk_fma_f32 v[116:117], v[22:23], s[92:93], v[210:211] neg_lo:[0,0,1] neg_hi:[0,0,1]
  v_cvt_pk_bf16_f32 v114, 0, v114
  v_cvt_pk_bf16_f32 v115, 0, v115
  v_cvt_pk_bf16_f32 v116, 0, v116
  v_cvt_pk_bf16_f32 v117, 0, v117
  v_pk_mul_f32 v[114:115], v[114:115], v[196:197]
  v_pk_mul_f32 v[116:117], v[116:117], v[198:199]
  v_cvt_pk_bf16_f32 v220, v114, v115
  v_cvt_pk_bf16_f32 v221, v116, v117
  s_waitcnt vmcnt(14)
  buffer_load_dwordx4 v[84:87], v95, s[8:11], s60 offen offset:256 nt
  v_pk_fma_f32 v[114:115], v[24:25], s[92:93], v[212:213] neg_lo:[0,0,1] neg_hi:[0,0,1]
  v_pk_fma_f32 v[116:117], v[26:27], s[92:93], v[214:215] neg_lo:[0,0,1] neg_hi:[0,0,1]
  v_mov_b32_dpp v148, v228 quad_perm:[0,0,0,0] row_mask:0xf bank_mask:0xf
  v_mov_b32_dpp v149, v230 quad_perm:[2,2,2,2] row_mask:0xf bank_mask:0xf
  v_cvt_pk_bf16_f32 v114, 0, v114
  v_cvt_pk_bf16_f32 v115, 0, v115
  v_add_f32_dpp v148, v229, v148 quad_perm:[1,1,1,1] row_mask:0xf bank_mask:0xf
  v_add_f32_dpp v149, v231, v149 quad_perm:[3,3,3,3] row_mask:0xf bank_mask:0xf
  v_cvt_pk_bf16_f32 v116, 0, v116
  v_cvt_pk_bf16_f32 v117, 0, v117
  v_add_f32 v232, v148, v149
  v_pk_mul_f32 v[114:115], v[114:115], v[200:201]
  v_pk_mul_f32 v[116:117], v[116:117], v[202:203]
  v_cvt_pk_bf16_f32 v222, v114, v115
  v_cvt_pk_bf16_f32 v223, v116, v117
  s_waitcnt vmcnt(14)
  buffer_load_dwordx4 v[88:91], v95, s[8:11], s60 offen offset:512 nt
  v_mfma_f32_16x16x32_bf16 v[228:231], v[220:223], v[172:175], 0
  v_pk_fma_f32 v[114:115], v[28:29], s[92:93], v[216:217] neg_lo:[0,0,1] neg_hi:[0,0,1]
  v_pk_fma_f32 v[116:117], v[30:31], s[92:93], v[218:219] neg_lo:[0,0,1] neg_hi:[0,0,1]
  s_cmp_lt_u32 s64, s99
  s_cbranch_scc1 L_k_known1
L_k_spin1:
  v_mov_b32 v148, 61696
  ds_read_b32 v148, v148
  s_waitcnt lgkmcnt(0)
  v_readfirstlane_b32 s96, v148
  s_nop 1
  s_cmp_eq_u32 s96, 0
  s_cbranch_scc1 L_k_spin1
  s_mov_b32 s99, -1
  s_bitcmp1_b32 s96, 6
  s_cselect_b32 s97, 255, s97
L_k_known1:
  s_andn2_b32 s70, s64, 1
  s_or_b32 s70, s70, s4
  s_lshr_b32 s71, s64, 5
  s_lshr_b32 s85, s96, s71
  s_cmp_lt_u32 s64, s97
  s_cselect_b32 s70, s70, s64
  s_cselect_b32 s85, s64, s85
  s_and_b32 s85, s85, 1
  s_mul_i32 s71, s71, 4064
  s_add_u32 s70, s70, s71
  s_add_u32 s70, s70, s5
  s_mul_hi_u32 s84, s70, s90
  s_lshr_b32 s84, s84, 1
  s_mul_i32 s71, s84, 3
  s_sub_u32 s70, s70, s71
  s_lshl3_add_u32 s85, s70, s85
  s_mul_i32 s61, s84, 196608
  s_lshr_b32 s89, s84, 4
  s_lshl_b32 s70, s85, 5
  v_add_u32 v100, s70, v234
  v_mul_u32_u24 v100, 21846, v100
  v_lshrrev_b32 v100, 16, v100
  v_add_u32 v148, s85, v235
  v_lshrrev_b32 v149, v148, s91
  v_and_b32 v149, 1, v149
  v_cmp_eq_u32 s[54:55], 1, v149
  s_nop 1
  s_and_b64 s[52:53], s[54:55], s[56:57]
  s_andn2_b64 s[54:55], s[54:55], s[56:57]
  v_mul_u32_u24 v148, 43, v148
  v_lshrrev_b32 v148, 8, v148
  v_mul_u32_u24 v148, 384, v148
  v_add_u32 v238, v148, v237
  s_cmp_eq_u32 s89, s88
  s_cbranch_scc1 L_k_sameq1
  s_mul_i32 s70, s89, 1536
  buffer_load_dwordx2 v[178:179], v239, s[36:39], s70 offen offset:0
  buffer_load_dwordx2 v[180:181], v239, s[36:39], s70 offen offset:128
  buffer_load_dwordx2 v[182:183], v239, s[36:39], s70 offen offset:256
  s_mov_b32 s88, s89
L_k_sameq1:
  s_mul_i32 s62, s84, 1536
  buffer_load_dwordx2 v[184:185], v238, s[20:23], s62 offen offset:0
  buffer_load_dwordx2 v[190:191], v238, s[24:27], s62 offen offset:0
  buffer_load_dwordx2 v[186:187], v238, s[20:23], s62 offen offset:128
  buffer_load_dwordx2 v[192:193], v238, s[24:27], s62 offen offset:128
  buffer_load_dwordx2 v[188:189], v238, s[20:23], s62 offen offset:256
  buffer_load_dwordx2 v[194:195], v238, s[24:27], s62 offen offset:256
  v_cvt_pk_bf16_f32 v114, 0, v114
  v_cvt_pk_bf16_f32 v115, 0, v115
  v_cvt_pk_bf16_f32 v116, 0, v116
  v_cvt_pk_bf16_f32 v117, 0, v117
  v_pk_mul_f32 v[114:115], v[114:115], v[204:205]
  v_pk_mul_f32 v[116:117], v[116:117], v[206:207]
  v_cvt_pk_bf16_f32 v224, v114, v115
  v_cvt_pk_bf16_f32 v225, v116, v117
  s_cmp_lt_u32 s64, 96
  s_cbranch_scc1 L_k_keep1
  s_bitcmp1_b32 s96, 6
  s_cselect_b32 s97, 255, 0
  v_mov_b32 v152, v148
  v_mov_b32 v153, v149
  s_andn2_b32 s70, s3, 1
  s_or_b32 s70, s70, s4
  s_lshr_b32 s71, s3, 5
  s_lshr_b32 s85, s96, s71
  s_lshr_b32 s85, s85, 3
  s_cmp_lt_u32 s3, s97
  s_cselect_b32 s70, s70, s3
  s_cselect_b32 s85, s3, s85
  s_and_b32 s85, s85, 1
  s_mul_i32 s71, s71, 4064
  s_add_u32 s70, s70, s71
  s_add_u32 s70, s70, s5
  s_mul_hi_u32 s84, s70, s90
  s_lshr_b32 s84, s84, 1
  s_mul_i32 s71, s84, 3
  s_sub_u32 s70, s70, s71
  s_lshl3_add_u32 s85, s70, s85
  s_mul_i32 s61, s84, 196608
  s_lshr_b32 s89, s84, 4
  s_lshl_b32 s70, s85, 5
  v_add_u32 v100, s70, v96
  v_mul_u32_u24 v100, 21846, v100
  v_lshrrev_b32 v100, 16, v100
  v_add_u32 v148, s85, v97
  v_lshrrev_b32 v149, v148, s91
  v_and_b32 v149, 1, v149
  v_cmp_eq_u32 s[54:55], 1, v149
  s_nop 1
  s_and_b64 s[52:53], s[54:55], s[58:59]
  s_andn2_b64 s[54:55], s[54:55], s[58:59]
  v_mov_b32 v148, v152
  v_mov_b32 v149, v153
  s_mov_b32 s16, s12
  s_mov_b32 s17, s13
  s_lshl_b32 s62, s84, 9
  v_lshl_add_u32 v101, v100, 1, v99
  buffer_load_short_d16_hi v118, v101, s[32:35], s62 offen
  buffer_load_short_d16_hi v119, v101, s[28:31], s62 offen
  v_mov_b32 v236, v98
L_k_keep1:
  v_mad_u32_u24 v92, v100, s63, v236
  v_add_u32 v93, 768, v92
  v_add_u32 v94, 4608, v92
  v_add_u32 v95, 7680, v92
  v_cndmask_b32 v92, v92, v108, s[52:53]
  v_cndmask_b32 v95, v95, v108, s[54:55]
  s_waitcnt vmcnt(20)
  s_cbranch_vccnz L_kw1_18
  s_waitcnt vmcnt(15)
L_kw1_18:
  buffer_load_dwordx4 v[4:7], v92, s[16:19], s61 offen offset:0 nt
  v_mfma_f32_16x16x16_bf16 v[228:231], v[224:225], v[176:177], v[228:231]
  v_pk_fma_f32 v[114:115], v[32:33], s[92:93], v[208:209] neg_lo:[0,0,1] neg_hi:[0,0,1]
  v_pk_fma_f32 v[116:117], v[34:35], s[92:93], v[210:211] neg_lo:[0,0,1] neg_hi:[0,0,1]
  v_cvt_pk_bf16_f32 v114, 0, v114
  v_cvt_pk_bf16_f32 v115, 0, v115
  v_cvt_pk_bf16_f32 v116, 0, v116
  v_cvt_pk_bf16_f32 v117, 0, v117
  v_pk_mul_f32 v[114:115], v[114:115], v[196:197]
  v_pk_mul_f32 v[116:117], v[116:117], v[198:199]
  v_cvt_pk_bf16_f32 v220, v114, v115
  v_cvt_pk_bf16_f32 v221, v116, v117
  s_waitcnt vmcnt(20)
  buffer_load_dwordx4 v[8:11], v92, s[16:19], s61 offen offset:256 nt
  v_pk_fma_f32 v[114:115], v[36:37], s[92:93], v[212:213] neg_lo:[0,0,1] neg_hi:[0,0,1]
  v_pk_fma_f32 v[116:117], v[38:39], s[92:93], v[214:215] neg_lo:[0,0,1] neg_hi:[0,0,1]
  v_mov_b32_dpp v148, v228 quad_perm:[0,0,0,0] row_mask:0xf bank_mask:0xf
  v_mov_b32_dpp v149, v230 quad_perm:[2,2,2,2] row_mask:0xf bank_mask:0xf
  v_cvt_pk_bf16_f32 v114, 0, v114
  v_cvt_pk_bf16_f32 v115, 0, v115
  v_add_f32_dpp v148, v229, v148 quad_perm:[1,1,1,1] row_mask:0xf bank_mask:0xf
  v_add_f32_dpp v149, v231, v149 quad_perm:[3,3,3,3] row_mask:0xf bank_mask:0xf
  v_cvt_pk_bf16_f32 v116, 0, v116
  v_cvt_pk_bf16_f32 v117, 0, v117
  v_add_f32 v233, v148, v149
  v_pk_mul_f32 v[114:115], v[114:115], v[200:201]
  v_pk_mul_f32 v[116:117], v[116:117], v[202:203]
  v_cvt_pk_bf16_f32 v222, v114, v115
  v_cvt_pk_bf16_f32 v223, v116, v117
  s_waitcnt vmcnt(20)
  buffer_load_dwordx4 v[12:15], v92, s[16:19], s61 offen offset:512 nt
  v_mfma_f32_16x16x32_bf16 v[228:231], v[220:223], v[172:175], 0
  v_pk_fma_f32 v[114:115], v[40:41], s[92:93], v[216:217] neg_lo:[0,0,1] neg_hi:[0,0,1]
  v_pk_fma_f32 v[116:117], v[42:43], s[92:93], v[218:219] neg_lo:[0,0,1] neg_hi:[0,0,1]
  v_cvt_pk_bf16_f32 v114, 0, v114
  v_cvt_pk_bf16_f32 v232, 0, v232
  v_cvt_pk_bf16_f32 v115, 0, v115
  v_cvt_pk_bf16_f32 v233, 0, v233
  v_cvt_pk_bf16_f32 v116, 0, v116
  v_pk_mul_f32 v[232:233], v[232:233], s[68:69]
  v_cvt_pk_bf16_f32 v117, 0, v117
  v_cvt_pk_bf16_f32 v126, v232, v233
  v_pk_mul_f32 v[114:115], v[114:115], v[204:205]
  v_pk_mul_f32 v[116:117], v[116:117], v[206:207]
  v_cvt_pk_bf16_f32 v224, v114, v115
  v_cvt_pk_bf16_f32 v225, v116, v117
  s_waitcnt vmcnt(20)
  s_cbranch_vccnz L_kw1_21
  s_waitcnt vmcnt(15)
L_kw1_21:
  buffer_load_dwordx4 v[16:19], v93, s[16:19], s61 offen offset:0 nt
  v_mfma_f32_16x16x16_bf16 v[228:231], v[224:225], v[176:177], v[228:231]
  v_pk_fma_f32 v[114:115], v[44:45], s[92:93], v[208:209] neg_lo:[0,0,1] neg_hi:[0,0,1]
  v_pk_fma_f32 v[116:117], v[46:47], s[92:93], v[210:211] neg_lo:[0,0,1] neg_hi:[0,0,1]
  v_cvt_pk_bf16_f32 v114, 0, v114
  v_cvt_pk_bf16_f32 v115, 0, v115
  v_cvt_pk_bf16_f32 v116, 0, v116
  v_cvt_pk_bf16_f32 v117, 0, v117
  v_pk_mul_f32 v[114:115], v[114:115], v[196:197]
  v_pk_mul_f32 v[116:117], v[116:117], v[198:199]
  v_cvt_pk_bf16_f32 v220, v114, v115
  v_cvt_pk_bf16_f32 v221, v116, v117
  s_waitcnt vmcnt(20)
  buffer_load_dwordx4 v[20:23], v93, s[16:19], s61 offen offset:256 nt
  v_pk_fma_f32 v[114:115], v[48:49], s[92:93], v[212:213] neg_lo:[0,0,1] neg_hi:[0,0,1]
  v_pk_fma_f32 v[116:117], v[50:51], s[92:93], v[214:215] neg_lo:[0,0,1] neg_hi:[0,0,1]
  v_mov_b32_dpp v148, v228 quad_perm:[0,0,0,0] row_mask:0xf bank_mask:0xf
  v_mov_b32_dpp v149, v230 quad_perm:[2,2,2,2] row_mask:0xf bank_mask:0xf
  v_cvt_pk_bf16_f32 v114, 0, v114
  v_cvt_pk_bf16_f32 v115, 0, v115
  v_add_f32_dpp v148, v229, v148 quad_perm:[1,1,1,1] row_mask:0xf bank_mask:0xf
  v_add_f32_dpp v149, v231, v149 quad_perm:[3,3,3,3] row_mask:0xf bank_mask:0xf
  v_cvt_pk_bf16_f32 v116, 0, v116
  v_cvt_pk_bf16_f32 v117, 0, v117
  v_add_f32 v232, v148, v149
  v_pk_mul_f32 v[114:115], v[114:115], v[200:201]
  v_pk_mul_f32 v[116:117], v[116:117], v[202:203]
  v_cvt_pk_bf16_f32 v222, v114, v115
  v_cvt_pk_bf16_f32 v223, v116, v117
  s_waitcnt vmcnt(20)
  buffer_load_dwordx4 v[24:27], v93, s[16:19], s61 offen offset:512 nt
  v_mfma_f32_16x16x32_bf16 v[228:231], v[220:223], v[172:175], 0
  v_pk_fma_f32 v[114:115], v[52:53], s[92:93], v[216:217] neg_lo:[0,0,1] neg_hi:[0,0,1]
  v_pk_fma_f32 v[116:117], v[54:55], s[92:93], v[218:219] neg_lo:[0,0,1] neg_hi:[0,0,1]
  v_cvt_pk_bf16_f32 v114, 0, v114
  v_cvt_pk_bf16_f32 v115, 0, v115
  v_cvt_pk_bf16_f32 v116, 0, v116
  v_cvt_pk_bf16_f32 v117, 0, v117
  v_pk_mul_f32 v[114:115], v[114:115], v[204:205]
  v_pk_mul_f32 v[116:117], v[116:117], v[206:207]
  v_cvt_pk_bf16_f32 v224, v114, v115
  v_cvt_pk_bf16_f32 v225, v116, v117
  s_waitcnt vmcnt(20)
  s_cbranch_vccnz L_kw1_24
  s_waitcnt vmcnt(15)
L_kw1_24:
  buffer_load_dwordx4 v[28:31], v93, s[16:19], s61 offen offset:768 nt
  v_mfma_f32_16x16x16_bf16 v[228:231], v[224:225], v[176:177], v[228:231]
  v_pk_fma_f32 v[114:115], v[56:57], s[92:93], v[208:209] neg_lo:[0,0,1] neg_hi:[0,0,1]
  v_pk_fma_f32 v[116:117], v[58:59], s[92:93], v[210:211] neg_lo:[0,0,1] neg_hi:[0,0,1]
  v_cvt_pk_bf16_f32 v114, 0, v114
  v_cvt_pk_bf16_f32 v115, 0, v115
  v_cvt_pk_bf16_f32 v116, 0, v116
  v_cvt_pk_bf16_f32 v117, 0, v117
  v_pk_mul_f32 v[114:115], v[114:115], v[196:197]
  v_pk_mul_f32 v[116:117], v[116:117], v[198:199]
  v_cvt_pk_bf16_f32 v220, v114, v115
  v_cvt_pk_bf16_f32 v221, v116, v117
  s_waitcnt vmcnt(20)
  buffer_load_dwordx4 v[32:35], v93, s[16:19], s61 offen offset:1024 nt
  v_pk_fma_f32 v[114:115], v[60:61], s[92:93], v[212:213] neg_lo:[0,0,1] neg_hi:[0,0,1]
  v_pk_fma_f32 v[116:117], v[62:63], s[92:93], v[214:215] neg_lo:[0,0,1] neg_hi:[0,0,1]
  v_mov_b32_dpp v148, v228 quad_perm:[0,0,0,0] row_mask:0xf bank_mask:0xf
  v_mov_b32_dpp v149, v230 quad_perm:[2,2,2,2] row_mask:0xf bank_mask:0xf
  v_cvt_pk_bf16_f32 v114, 0, v114
  v_cvt_pk_bf16_f32 v115, 0, v115
  v_add_f32_dpp v148, v229, v148 quad_perm:[1,1,1,1] row_mask:0xf bank_mask:0xf
  v_add_f32_dpp v149, v231, v149 quad_perm:[3,3,3,3] row_mask:0xf bank_mask:0xf
  v_cvt_pk_bf16_f32 v116, 0, v116
  v_cvt_pk_bf16_f32 v117, 0, v117
  v_add_f32 v233, v148, v149
  v_pk_mul_f32 v[114:115], v[114:115], v[200:201]
  v_pk_mul_f32 v[116:117], v[116:117], v[202:203]
  v_cvt_pk_bf16_f32 v222, v114, v115
  v_cvt_pk_bf16_f32 v223, v116, v117
  s_waitcnt vmcnt(20)
  buffer_load_dwordx4 v[36:39], v93, s[16:19], s61 offen offset:1280 nt
  v_mfma_f32_16x16x32_bf16 v[228:231], v[220:223], v[172:175], 0
  v_pk_fma_f32 v[114:115], v[64:65], s[92:93], v[216:217] neg_lo:[0,0,1] neg_hi:[0,0,1]
  v_pk_fma_f32 v[116:117], v[66:67], s[92:93], v[218:219] neg_lo:[0,0,1] neg_hi:[0,0,1]
  v_cvt_pk_bf16_f32 v114, 0, v114
  v_cvt_pk_bf16_f32 v232, 0, v232
  v_cvt_pk_bf16_f32 v115, 0, v115
  v_cvt_pk_bf16_f32 v233, 0, v233
  v_cvt_pk_bf16_f32 v116, 0, v116
  v_pk_mul_f32 v[232:233], v[232:233], s[68:69]
  v_cvt_pk_bf16_f32 v117, 0, v117
  v_cvt_pk_bf16_f32 v127, v232, v233
  v_pk_mul_f32 v[114:115], v[114:115], v[204:205]
  v_pk_mul_f32 v[116:117], v[116:117], v[206:207]
  v_cvt_pk_bf16_f32 v224, v114, v115
  v_cvt_pk_bf16_f32 v225, v116, v117
  s_waitcnt vmcnt(20)
  s_cbranch_vccnz L_kw1_27
  s_waitcnt vmcnt(15)
L_kw1_27:
  buffer_load_dwordx4 v[40:43], v93, s[16:19], s61 offen offset:1536 nt
  v_mfma_f32_16x16x16_bf16 v[228:231], v[224:225], v[176:177], v[228:231]
  v_pk_fma_f32 v[114:115], v[68:69], s[92:93], v[208:209] neg_lo:[0,0,1] neg_hi:[0,0,1]
  v_pk_fma_f32 v[116:117], v[70:71], s[92:93], v[210:211] neg_lo:[0,0,1] neg_hi:[0,0,1]
  v_cvt_pk_bf16_f32 v114, 0, v114
  v_cvt_pk_bf16_f32 v115, 0, v115
  v_cvt_pk_bf16_f32 v116, 0, v116
  v_cvt_pk_bf16_f32 v117, 0, v117
  v_pk_mul_f32 v[114:115], v[114:115], v[196:197]
  v_pk_mul_f32 v[116:117], v[116:117], v[198:199]
  v_cvt_pk_bf16_f32 v220, v114, v115
  v_cvt_pk_bf16_f32 v221, v116, v117
  s_waitcnt vmcnt(20)
  buffer_load_dwordx4 v[44:47], v93, s[16:19], s61 offen offset:1792 nt
  v_pk_fma_f32 v[114:115], v[72:73], s[92:93], v[212:213] neg_lo:[0,0,1] neg_hi:[0,0,1]
  v_pk_fma_f32 v[116:117], v[74:75], s[92:93], v[214:215] neg_lo:[0,0,1] neg_hi:[0,0,1]
  v_mov_b32_dpp v148, v228 quad_perm:[0,0,0,0] row_mask:0xf bank_mask:0xf
  v_mov_b32_dpp v149, v230 quad_perm:[2,2,2,2] row_mask:0xf bank_mask:0xf
  v_cvt_pk_bf16_f32 v114, 0, v114
  v_cvt_pk_bf16_f32 v115, 0, v115
  v_add_f32_dpp v148, v229, v148 quad_perm:[1,1,1,1] row_mask:0xf bank_mask:0xf
  v_add_f32_dpp v149, v231, v149 quad_perm:[3,3,3,3] row_mask:0xf bank_mask:0xf
  v_cvt_pk_bf16_f32 v116, 0, v116
  v_cvt_pk_bf16_f32 v117, 0, v117
  v_add_f32 v232, v148, v149
  v_pk_mul_f32 v[114:115], v[114:115], v[200:201]
  v_pk_mul_f32 v[116:117], v[116:117], v[202:203]
  v_cvt_pk_bf16_f32 v222, v114, v115
  v_cvt_pk_bf16_f32 v223, v116, v117
  s_waitcnt vmcnt(20)
  buffer_load_dwordx4 v[48:51], v93, s[16:19], s61 offen offset:2048 nt
  v_mfma_f32_16x16x32_bf16 v[228:231], v[220:223], v[172:175], 0
  v_pk_fma_f32 v[114:115], v[76:77], s[92:93], v[216:217] neg_lo:[0,0,1] neg_hi:[0,0,1]
  v_pk_fma_f32 v[116:117], v[78:79], s[92:93], v[218:219] neg_lo:[0,0,1] neg_hi:[0,0,1]
  v_cvt_pk_bf16_f32 v114, 0, v114
  v_cvt_pk_bf16_f32 v115, 0, v115
  v_cvt_pk_bf16_f32 v116, 0, v116
  v_cvt_pk_bf16_f32 v117, 0, v117
  v_pk_mul_f32 v[114:115], v[114:115], v[204:205]
  v_pk_mul_f32 v[116:117], v[116:117], v[206:207]
  v_cvt_pk_bf16_f32 v224, v114, v115
  v_cvt_pk_bf16_f32 v225, v116, v117
  s_waitcnt vmcnt(20)
  s_cbranch_vccnz L_kw1_30
  s_waitcnt vmcnt(9)
L_kw1_30:
  buffer_load_dwordx4 v[52:55], v93, s[16:19], s61 offen offset:2304 nt
  v_mfma_f32_16x16x16_bf16 v[228:231], v[224:225], v[176:177], v[228:231]
  v_pk_fma_f32 v[114:115], v[80:81], s[92:93], v[208:209] neg_lo:[0,0,1] neg_hi:[0,0,1]
  v_pk_fma_f32 v[116:117], v[82:83], s[92:93], v[210:211] neg_lo:[0,0,1] neg_hi:[0,0,1]
  v_cvt_pk_bf16_f32 v114, 0, v114
  v_cvt_pk_bf16_f32 v115, 0, v115
  v_cvt_pk_bf16_f32 v116, 0, v116
  v_cvt_pk_bf16_f32 v117, 0, v117
  v_pk_mul_f32 v[114:115], v[114:115], v[196:197]
  v_pk_mul_f32 v[116:117], v[116:117], v[198:199]
  v_cvt_pk_bf16_f32 v220, v114, v115
  v_cvt_pk_bf16_f32 v221, v116, v117
  s_waitcnt vmcnt(20)
  buffer_load_dwordx4 v[56:59], v93, s[16:19], s61 offen offset:2560 nt
  v_pk_fma_f32 v[114:115], v[84:85], s[92:93], v[212:213] neg_lo:[0,0,1] neg_hi:[0,0,1]
  v_pk_fma_f32 v[116:117], v[86:87], s[92:93], v[214:215] neg_lo:[0,0,1] neg_hi:[0,0,1]
  v_mov_b32_dpp v148, v228 quad_perm:[0,0,0,0] row_mask:0xf bank_mask:0xf
  v_mov_b32_dpp v149, v230 quad_perm:[2,2,2,2] row_mask:0xf bank_mask:0xf
  v_cvt_pk_bf16_f32 v114, 0, v114
  v_cvt_pk_bf16_f32 v115, 0, v115
  v_add_f32_dpp v148, v229, v148 quad_perm:[1,1,1,1] row_mask:0xf bank_mask:0xf
  v_add_f32_dpp v149, v231, v149 quad_perm:[3,3,3,3] row_mask:0xf bank_mask:0xf
  v_cvt_pk_bf16_f32 v116, 0, v116
  v_cvt_pk_bf16_f32 v117, 0, v117
  v_add_f32 v233, v148, v149
  v_pk_mul_f32 v[114:115], v[114:115], v[200:201]
  v_pk_mul_f32 v[116:117], v[116:117], v[202:203]
  v_cvt_pk_bf16_f32 v222, v114, v115
  v_cvt_pk_bf16_f32 v223, v116, v117
  s_waitcnt vmcnt(20)
  buffer_load_dwordx4 v[60:63], v93, s[16:19], s61 offen offset:2816 nt
  v_mfma_f32_16x16x32_bf16 v[228:231], v[220:223], v[172:175], 0
  v_pk_fma_f32 v[114:115], v[88:89], s[92:93], v[216:217] neg_lo:[0,0,1] neg_hi:[0,0,1]
  v_pk_fma_f32 v[116:117], v[90:91], s[92:93], v[218:219] neg_lo:[0,0,1] neg_hi:[0,0,1]
  v_cvt_pk_bf16_f32 v114, 0, v114
  v_cvt_pk_bf16_f32 v232, 0, v232
  v_cvt_pk_bf16_f32 v115, 0, v115
  v_cvt_pk_bf16_f32 v233, 0, v233
  v_cvt_pk_bf16_f32 v116, 0, v116
  v_pk_mul_f32 v[232:233], v[232:233], s[68:69]
  v_cvt_pk_bf16_f32 v117, 0, v117
  v_cvt_pk_bf16_f32 v128, v232, v233
  v_pk_mul_f32 v[114:115], v[114:115], v[204:205]
  v_pk_mul_f32 v[116:117], v[116:117], v[206:207]
  v_cvt_pk_bf16_f32 v224, v114, v115
  v_cvt_pk_bf16_f32 v225, v116, v117
  s_mov_b32 s60, s61
  v_mov_b32 v150, s64
  v_mfma_f32_16x16x16_bf16 v[228:231], v[224:225], v[176:177], v[228:231]
  ds_write_b128 v102, v[124:127]
  v_add_u32 v102, 768, v102
  s_nop 5
  v_mov_b32_dpp v148, v228 quad_perm:[0,0,0,0] row_mask:0xf bank_mask:0xf
  v_mov_b32_dpp v149, v230 quad_perm:[2,2,2,2] row_mask:0xf bank_mask:0xf
  s_nop 0
  v_add_f32_dpp v148, v229, v148 quad_perm:[1,1,1,1] row_mask:0xf bank_mask:0xf
  v_add_f32_dpp v149, v231, v149 quad_perm:[3,3,3,3] row_mask:0xf bank_mask:0xf
  v_add_f32 v232, v148, v149
  v_cndmask_b32 v232, v232, v240, s[50:51]
  v_cvt_pk_bf16_f32 v232, 0, v232
  v_cvt_pk_bf16_f32 v233, 0, v233
  v_pk_mul_f32 v[232:233], v[232:233], s[68:69]
  v_cvt_pk_bf16_f32 v129, v232, v233
  ds_write_b64 v103, v[128:129] offset:256
  ds_write_b32 v107, v150
  v_add_u32 v103, 768, v103
  s_cmp_lt_u32 s64, 96
  s_cbranch_scc1 L_k
  v_subrev_u32 v102, 36864, v102
  v_subrev_u32 v103, 36864, v103
  s_mov_b32 s64, s3
  s_mov_b32 s88, s89
  s_mov_b32 s99, 0
  s_mov_b32 s92, 0x7f000000
  s_mov_b32 s93, 0x7f000000
  s_load_dwordx2 s[44:45], s[0:1], 56
  s_waitcnt lgkmcnt(0)
  s_mov_b32 s36, s44
  s_and_b32 s37, s45, 0xffff
  s_cmp_lt_u32 s64, s99
  s_cbranch_scc1 L_v0_ok
L_v0_spin:
  v_mov_b32 v148, 61700
  ds_read_b32 v148, v148
  s_waitcnt lgkmcnt(0)
  v_readfirstlane_b32 s99, v148
  s_nop 1
  s_cmp_lt_u32 s64, s99
  s_cbranch_scc0 L_v0_spin
L_v0_ok:
  ds_read_b128 v[124:127], v102
  ds_read_b64 v[128:129], v103 offset:256
L_v0:
  s_mov_b32 s86, s84
  s_mov_b32 s87, s85
  s_add_u32 s64, s64, 2
  s_cmp_lt_u32 s64, s99
  s_cbranch_scc1 L_v10_ok
L_v10_spin:
  v_mov_b32 v148, 61700
  ds_read_b32 v148, v148
  s_waitcnt lgkmcnt(0)
  v_readfirstlane_b32 s99, v148
  s_nop 1
  s_cmp_lt_u32 s64, s99
  s_cbranch_scc0 L_v10_spin
L_v10_ok:
  s_andn2_b32 s70, s64, 1
  s_or_b32 s70, s70, s4
  s_lshr_b32 s71, s64, 5
  s_lshr_b32 s85, s96, s71
  s_lshr_b32 s85, s85, 3
  s_cmp_lt_u32 s64, s97
  s_cselect_b32 s70, s70, s64
  s_cselect_b32 s85, s64, s85
  s_and_b32 s85, s85, 1
  s_mul_i32 s71, s71, 4064
  s_add_u32 s70, s70, s71
  s_add_u32 s70, s70, s5
  s_mul_hi_u32 s84, s70, s90
  s_lshr_b32 s84, s84, 1
  s_mul_i32 s71, s84, 3
  s_sub_u32 s70, s70, s71
  s_lshl3_add_u32 s85, s70, s85
  s_mul_i32 s61, s84, 196608
  s_lshr_b32 s89, s84, 4
  s_lshl_b32 s70, s85, 5
  v_add_u32 v100, s70, v96
  v_mul_u32_u24 v100, 21846, v100
  v_lshrrev_b32 v100, 16, v100
  v_add_u32 v148, s85, v97
  v_lshrrev_b32 v149, v148, s91
  v_and_b32 v149, 1, v149
  v_cmp_eq_u32 s[54:55], 1, v149
  s_nop 1
  s_and_b64 s[52:53], s[54:55], s[58:59]
  s_andn2_b64 s[54:55], s[54:55], s[58:59]
  s_cmp_lt_u32 s64, 96
  s_cselect_b32 s61, s61, 805306368
  s_add_u32 s70, s64, 94
  v_mov_b32 v150, s70
  v_add_u32 v112, s70, v111
  ds_write_b32 v107, v150
  ds_read_b32 v110, v109
  s_waitcnt vmcnt(14)
  s_cbranch_vccnz L_vw0_0
  s_waitcnt vmcnt(9)
L_vw0_0:
  buffer_load_dwordx4 v[64:67], v93, s[12:15], s60 offen offset:3072 nt
  v_mul_f32 v120, 0x34800000, v118
  v_mul_f32 v121, 0x4a800000, v119
  s_nop 0
  v_mov_b32_dpp v122, v120 row_newbcast:0 row_mask:0xf bank_mask:0xf
  v_mov_b32_dpp v123, v121 row_newbcast:0 row_mask:0xf bank_mask:0xf
  v_pk_fma_f32 v[196:197], v[4:5], s[92:93], v[122:123] op_sel_hi:[1,1,0] neg_lo:[0,0,1] neg_hi:[0,0,1]
  v_pk_fma_f32 v[198:199], v[6:7], s[92:93], v[122:123] op_sel_hi:[1,1,0] neg_lo:[0,0,1] neg_hi:[0,0,1]
  v_cvt_pk_bf16_f32 v196, 0, v196
  s_waitcnt lgkmcnt(0)
  v_cvt_pk_bf16_f32 v197, 0, v197
  v_lshlrev_b32 v152, 16, v124
  v_cvt_pk_bf16_f32 v198, 0, v198
  v_and_b32 v153, s65, v124
  v_cvt_pk_bf16_f32 v199, 0, v199
  v_lshlrev_b32 v154, 16, v125
  v_pk_mul_f32 v[196:197], v[196:197], v[122:123] op_sel:[0,1]
  v_and_b32 v155, s65, v125
  v_pk_mul_f32 v[198:199], v[198:199], v[122:123] op_sel:[0,1]
  s_waitcnt lgkmcnt(0)
  v_cmp_lt_i32 vcc, v112, v110
  s_waitcnt vmcnt(14)
  buffer_load_dwordx4 v[68:71], v93, s[12:15], s60 offen offset:3328 nt
  v_pk_fma_f32 v[200:201], v[8:9], s[92:93], v[122:123] op_sel_hi:[1,1,0] neg_lo:[0,0,1] neg_hi:[0,0,1]
  v_pk_fma_f32 v[202:203], v[10:11], s[92:93], v[122:123] op_sel_hi:[1,1,0] neg_lo:[0,0,1] neg_hi:[0,0,1]
  v_cvt_pk_bf16_f32 v200, 0, v200
  v_lshlrev_b32 v156, 16, v126
  v_cvt_pk_bf16_f32 v201, 0, v201
  v_and_b32 v157, s65, v126
  v_cvt_pk_bf16_f32 v202, 0, v202
  v_lshlrev_b32 v158, 16, v127
  v_cvt_pk_bf16_f32 v203, 0, v203
  v_and_b32 v159, s65, v127
  v_pk_mul_f32 v[200:201], v[200:201], v[122:123] op_sel:[0,1]
  v_lshlrev_b32 v160, 16, v128
  v_pk_mul_f32 v[202:203], v[202:203], v[122:123] op_sel:[0,1]
  s_waitcnt vmcnt(14)
  buffer_load_dwordx4 v[72:75], v93, s[12:15], s60 offen offset:3584 nt
  v_pk_fma_f32 v[204:205], v[12:13], s[92:93], v[122:123] op_sel_hi:[1,1,0] neg_lo:[0,0,1] neg_hi:[0,0,1]
  v_pk_fma_f32 v[206:207], v[14:15], s[92:93], v[122:123] op_sel_hi:[1,1,0] neg_lo:[0,0,1] neg_hi:[0,0,1]
  v_cvt_pk_bf16_f32 v204, 0, v204
  v_and_b32 v161, s65, v128
  v_cvt_pk_bf16_f32 v205, 0, v205
  v_lshlrev_b32 v162, 16, v129
  v_cvt_pk_bf16_f32 v206, 0, v206
  v_add_u32 v102, 768, v102
  v_cvt_pk_bf16_f32 v207, 0, v207
  v_add_u32 v103, 768, v103
  v_pk_mul_f32 v[204:205], v[204:205], v[122:123] op_sel:[0,1]
  v_max3_f32 v148, v152, v153, v154
  v_pk_mul_f32 v[206:207], v[206:207], v[122:123] op_sel:[0,1]
  s_waitcnt vmcnt(14)
  s_cbranch_vccnz L_vw0_3
  s_waitcnt vmcnt(9)
L_vw0_3:
  buffer_load_dwordx4 v[76:79], v94, s[12:15], s60 offen offset:0 nt
  v_mov_b32_dpp v122, v120 row_newbcast:1 row_mask:0xf bank_mask:0xf
  v_mov_b32_dpp v123, v121 row_newbcast:1 row_mask:0xf bank_mask:0xf
  v_pk_fma_f32 v[114:115], v[16:17], s[92:93], v[122:123] op_sel_hi:[1,1,0] neg_lo:[0,0,1] neg_hi:[0,0,1]
  v_pk_fma_f32 v[116:117], v[18:19], s[92:93], v[122:123] op_sel_hi:[1,1,0] neg_lo:[0,0,1] neg_hi:[0,0,1]
  s_lshl_b32 s62, s84, 9
  v_lshl_add_u32 v101, v100, 1, v99
  buffer_load_short_d16_hi v118, v101, s[32:35], s62 offen
  buffer_load_short_d16_hi v119, v101, s[28:31], s62 offen
  v_cvt_pk_bf16_f32 v114, 0, v114
  ds_read_b128 v[124:127], v102
  v_cvt_pk_bf16_f32 v115, 0, v115
  ds_read_b64 v[128:129], v103 offset:256
  v_cvt_pk_bf16_f32 v116, 0, v116
  v_max3_f32 v149, v155, v156, v157
  v_cvt_pk_bf16_f32 v117, 0, v117
  v_max3_f32 v148, v148, v158, v159
  v_pk_mul_f32 v[114:115], v[114:115], v[122:123] op_sel:[0,1]
  v_max3_f32 v149, v149, v160, v161
  v_pk_mul_f32 v[116:117], v[116:117], v[122:123] op_sel:[0,1]
  v_cvt_pk_bf16_f32 v208, v196, v114
  v_cvt_pk_bf16_f32 v212, v197, v115
  v_cvt_pk_bf16_f32 v216, v198, v116
  v_cvt_pk_bf16_f32 v220, v199, v117
  s_waitcnt vmcnt(16)
  buffer_load_dwordx4 v[80:83], v94, s[12:15], s60 offen offset:256 nt
  v_pk_fma_f32 v[114:115], v[20:21], s[92:93], v[122:123] op_sel_hi:[1,1,0] neg_lo:[0,0,1] neg_hi:[0,0,1]
  v_pk_fma_f32 v[116:117], v[22:23], s[92:93], v[122:123] op_sel_hi:[1,1,0] neg_lo:[0,0,1] neg_hi:[0,0,1]
  v_cvt_pk_bf16_f32 v114, 0, v114
  v_max3_f32 v148, v148, v162, v144
  v_cvt_pk_bf16_f32 v115, 0, v115
  v_max_f32 v148, v148, v149
  v_cvt_pk_bf16_f32 v116, 0, v116
  v_mov_b32 v149, v148
  v_cvt_pk_bf16_f32 v117, 0, v117
  s_nop 0
  v_permlane32_swap_b32 v148, v149
  v_pk_mul_f32 v[114:115], v[114:115], v[122:123] op_sel:[0,1]
  v_max_f32 v148, v148, v149
  v_pk_mul_f32 v[116:117], v[116:117], v[122:123] op_sel:[0,1]
  v_cvt_pk_bf16_f32 v224, v200, v114
  v_cvt_pk_bf16_f32 v228, v201, v115
  v_cvt_pk_bf16_f32 v232, v202, v116
  v_cvt_pk_bf16_f32 v236, v203, v117
  s_waitcnt vmcnt(16)
  buffer_load_dwordx4 v[84:87], v94, s[12:15], s60 offen offset:512 nt
  v_pk_fma_f32 v[114:115], v[24:25], s[92:93], v[122:123] op_sel_hi:[1,1,0] neg_lo:[0,0,1] neg_hi:[0,0,1]
  v_pk_fma_f32 v[116:117], v[26:27], s[92:93], v[122:123] op_sel_hi:[1,1,0] neg_lo:[0,0,1] neg_hi:[0,0,1]
  v_cvt_pk_bf16_f32 v114, 0, v114
  v_mov_b32 v149, v148
  v_cvt_pk_bf16_f32 v115, 0, v115
  s_nop 0
  v_permlane16_swap_b32 v148, v149
  v_cvt_pk_bf16_f32 v116, 0, v116
  v_max_f32 v144, v148, v149
  v_cvt_pk_bf16_f32 v117, 0, v117
  v_mul_f32 v148, s66, v144
  v_pk_mul_f32 v[114:115], v[114:115], v[122:123] op_sel:[0,1]
  v_add_f32 v150, v148, v146
  v_pk_mul_f32 v[116:117], v[116:117], v[122:123] op_sel:[0,1]
  v_cvt_pk_bf16_f32 v240, v204, v114
  v_cvt_pk_bf16_f32 v244, v205, v115
  v_cvt_pk_bf16_f32 v248, v206, v116
  v_cvt_pk_bf16_f32 v252, v207, v117
  s_waitcnt vmcnt(16)
  s_cbranch_vccnz L_vw0_6
  s_waitcnt vmcnt(11)
L_vw0_6:
  buffer_load_dwordx4 v[88:91], v94, s[12:15], s60 offen offset:768 nt
  v_mov_b32_dpp v122, v120 row_newbcast:2 row_mask:0xf bank_mask:0xf
  v_mov_b32_dpp v123, v121 row_newbcast:2 row_mask:0xf bank_mask:0xf
  v_pk_fma_f32 v[196:197], v[28:29], s[92:93], v[122:123] op_sel_hi:[1,1,0] neg_lo:[0,0,1] neg_hi:[0,0,1]
  v_pk_fma_f32 v[198:199], v[30:31], s[92:93], v[122:123] op_sel_hi:[1,1,0] neg_lo:[0,0,1] neg_hi:[0,0,1]
  v_cvt_pk_bf16_f32 v196, 0, v196
  v_sub_f32 v146, 0, v148
  v_cvt_pk_bf16_f32 v197, 0, v197
  v_exp_f32 v150, -v150
  v_cvt_pk_bf16_f32 v198, 0, v198
  ds_bpermute_b32 v151, v104, v150
  v_cvt_pk_bf16_f32 v199, 0, v199
  v_fma_f32 v152, v152, s66, v146
  v_pk_mul_f32 v[196:197], v[196:197], v[122:123] op_sel:[0,1]
  v_exp_f32 v152, v152
  v_pk_mul_f32 v[198:199], v[198:199], v[122:123] op_sel:[0,1]
  s_waitcnt vmcnt(16)
  buffer_load_dwordx4 v[4:7], v94, s[12:15], s60 offen offset:1024 nt
  v_pk_fma_f32 v[200:201], v[32:33], s[92:93], v[122:123] op_sel_hi:[1,1,0] neg_lo:[0,0,1] neg_hi:[0,0,1]
  v_pk_fma_f32 v[202:203], v[34:35], s[92:93], v[122:123] op_sel_hi:[1,1,0] neg_lo:[0,0,1] neg_hi:[0,0,1]
  v_cvt_pk_bf16_f32 v200, 0, v200
  v_fma_f32 v153, v153, s66, v146
  v_cvt_pk_bf16_f32 v201, 0, v201
  v_exp_f32 v153, v153
  v_cvt_pk_bf16_f32 v202, 0, v202
  v_fma_f32 v154, v154, s66, v146
  v_cvt_pk_bf16_f32 v203, 0, v203
  v_exp_f32 v154, v154
  v_pk_mul_f32 v[200:201], v[200:201], v[122:123] op_sel:[0,1]
  v_fma_f32 v155, v155, s66, v146
  v_pk_mul_f32 v[202:203], v[202:203], v[122:123] op_sel:[0,1]
  s_waitcnt vmcnt(16)
  buffer_load_dwordx4 v[8:11], v94, s[12:15], s60 offen offset:1280 nt
  v_pk_fma_f32 v[204:205], v[36:37], s[92:93], v[122:123] op_sel_hi:[1,1,0] neg_lo:[0,0,1] neg_hi:[0,0,1]
  v_pk_fma_f32 v[206:207], v[38:39], s[92:93], v[122:123] op_sel_hi:[1,1,0] neg_lo:[0,0,1] neg_hi:[0,0,1]
  v_cvt_pk_bf16_f32 v204, 0, v204
  v_exp_f32 v155, v155
  v_cvt_pk_bf16_f32 v205, 0, v205
  v_fma_f32 v156, v156, s66, v146
  v_cvt_pk_bf16_f32 v206, 0, v206
  v_exp_f32 v156, v156
  v_cvt_pk_bf16_f32 v207, 0, v207
  v_fma_f32 v157, v157, s66, v146
  v_pk_mul_f32 v[204:205], v[204:205], v[122:123] op_sel:[0,1]
  v_exp_f32 v157, v157
  v_pk_mul_f32 v[206:207], v[206:207], v[122:123] op_sel:[0,1]
  s_waitcnt vmcnt(16)
  s_cbranch_vccnz L_vw0_9
  s_waitcnt vmcnt(11)
L_vw0_9:
  buffer_load_dwordx4 v[12:15], v94, s[12:15], s60 offen offset:1536 nt
  v_mov_b32_dpp v122, v120 row_newbcast:3 row_mask:0xf bank_mask:0xf
  v_mov_b32_dpp v123, v121 row_newbcast:3 row_mask:0xf bank_mask:0xf
  v_pk_fma_f32 v[114:115], v[40:41], s[92:93], v[122:123] op_sel_hi:[1,1,0] neg_lo:[0,0,1] neg_hi:[0,0,1]
  v_pk_fma_f32 v[116:117], v[42:43], s[92:93], v[122:123] op_sel_hi:[1,1,0] neg_lo:[0,0,1] neg_hi:[0,0,1]
  v_cvt_pk_bf16_f32 v114, 0, v114
  v_fma_f32 v158, v158, s66, v146
  v_cvt_pk_bf16_f32 v115, 0, v115
  v_exp_f32 v158, v158
  v_cvt_pk_bf16_f32 v116, 0, v116
  v_fma_f32 v159, v159, s66, v146
  v_cvt_pk_bf16_f32 v117, 0, v117
  v_exp_f32 v159, v159
  v_pk_mul_f32 v[114:115], v[114:115], v[122:123] op_sel:[0,1]
  v_fma_f32 v160, v160, s66, v146
  v_pk_mul_f32 v[116:117], v[116:117], v[122:123] op_sel:[0,1]
  v_cvt_pk_bf16_f32 v209, v196, v114
  v_cvt_pk_bf16_f32 v213, v197, v115
  v_cvt_pk_bf16_f32 v217, v198, v116
  v_cvt_pk_bf16_f32 v221, v199, v117
  s_waitcnt vmcnt(16)
  buffer_load_dwordx4 v[16:19], v94, s[12:15], s60 offen offset:1792 nt
  v_pk_fma_f32 v[114:115], v[44:45], s[92:93], v[122:123] op_sel_hi:[1,1,0] neg_lo:[0,0,1] neg_hi:[0,0,1]
  v_pk_fma_f32 v[116:117], v[46:47], s[92:93], v[122:123] op_sel_hi:[1,1,0] neg_lo:[0,0,1] neg_hi:[0,0,1]
  v_cvt_pk_bf16_f32 v114, 0, v114
  v_exp_f32 v160, v160
  v_cvt_pk_bf16_f32 v115, 0, v115
  v_fma_f32 v161, v161, s66, v146
  v_cvt_pk_bf16_f32 v116, 0, v116
  v_exp_f32 v161, v161
  v_cvt_pk_bf16_f32 v117, 0, v117
  v_fma_f32 v162, v162, s66, v146
  v_pk_mul_f32 v[114:115], v[114:115], v[122:123] op_sel:[0,1]
  v_exp_f32 v162, v162
  v_pk_mul_f32 v[116:117], v[116:117], v[122:123] op_sel:[0,1]
  v_cvt_pk_bf16_f32 v225, v200, v114
  v_cvt_pk_bf16_f32 v229, v201, v115
  v_cvt_pk_bf16_f32 v233, v202, v116
  v_cvt_pk_bf16_f32 v237, v203, v117
  s_waitcnt vmcnt(16)
  buffer_load_dwordx4 v[20:23], v94, s[12:15], s60 offen offset:2048 nt
  v_pk_fma_f32 v[114:115], v[48:49], s[92:93], v[122:123] op_sel_hi:[1,1,0] neg_lo:[0,0,1] neg_hi:[0,0,1]
  v_pk_fma_f32 v[116:117], v[50:51], s[92:93], v[122:123] op_sel_hi:[1,1,0] neg_lo:[0,0,1] neg_hi:[0,0,1]
  v_cvt_pk_bf16_f32 v114, 0, v114
  v_add_f32 v148, v152, v153
  v_cvt_pk_bf16_f32 v115, 0, v115
  v_add_f32 v149, v154, v155
  v_cvt_pk_bf16_f32 v116, 0, v116
  v_add_f32 v148, v148, v156
  v_cvt_pk_bf16_f32 v117, 0, v117
  v_add_f32 v149, v149, v157
  v_pk_mul_f32 v[114:115], v[114:115], v[122:123] op_sel:[0,1]
  v_add_f32 v148, v148, v158
  v_pk_mul_f32 v[116:117], v[116:117], v[122:123] op_sel:[0,1]
  v_cvt_pk_bf16_f32 v241, v204, v114
  v_cvt_pk_bf16_f32 v245, v205, v115
  v_cvt_pk_bf16_f32 v249, v206, v116
  v_cvt_pk_bf16_f32 v253, v207, v117
  s_waitcnt vmcnt(16)
  s_cbranch_vccnz L_vw0_12
  s_waitcnt vmcnt(11)
L_vw0_12:
  buffer_load_dwordx4 v[24:27], v94, s[12:15], s60 offen offset:2304 nt
  v_mov_b32_dpp v122, v120 row_newbcast:4 row_mask:0xf bank_mask:0xf
  v_mov_b32_dpp v123, v121 row_newbcast:4 row_mask:0xf bank_mask:0xf
  v_pk_fma_f32 v[196:197], v[52:53], s[92:93], v[122:123] op_sel_hi:[1,1,0] neg_lo:[0,0,1] neg_hi:[0,0,1]
  v_pk_fma_f32 v[198:199], v[54:55], s[92:93], v[122:123] op_sel_hi:[1,1,0] neg_lo:[0,0,1] neg_hi:[0,0,1]
  v_cvt_pk_bf16_f32 v196, 0, v196
  v_add_f32 v149, v149, v159
  v_cvt_pk_bf16_f32 v197, 0, v197
  v_add_f32 v148, v148, v160
  v_cvt_pk_bf16_f32 v198, 0, v198
  v_add_f32 v149, v149, v161
  v_cvt_pk_bf16_f32 v199, 0, v199
  v_add_f32 v148, v148, v162
  v_pk_mul_f32 v[196:197], v[196:197], v[122:123] op_sel:[0,1]
  v_add_f32 v148, v148, v149
  v_pk_mul_f32 v[198:199], v[198:199], v[122:123] op_sel:[0,1]
  s_waitcnt vmcnt(16)
  buffer_load_dwordx4 v[28:31], v94, s[12:15], s60 offen offset:2560 nt
  v_pk_fma_f32 v[200:201], v[56:57], s[92:93], v[122:123] op_sel_hi:[1,1,0] neg_lo:[0,0,1] neg_hi:[0,0,1]
  v_pk_fma_f32 v[202:203], v[58:59], s[92:93], v[122:123] op_sel_hi:[1,1,0] neg_lo:[0,0,1] neg_hi:[0,0,1]
  v_cvt_pk_bf16_f32 v200, 0, v200
  v_fma_f32 v147, v147, v150, v148
  v_cvt_pk_bf16_f32 v201, 0, v201
  v_cvt_pk_bf16_f32 v163, v152, v153
  v_cvt_pk_bf16_f32 v202, 0, v202
  v_cvt_pk_bf16_f32 v164, v154, v155
  v_cvt_pk_bf16_f32 v203, 0, v203
  v_cvt_pk_bf16_f32 v165, v156, v157
  v_pk_mul_f32 v[200:201], v[200:201], v[122:123] op_sel:[0,1]
  v_cvt_pk_bf16_f32 v166, v158, v159
  v_pk_mul_f32 v[202:203], v[202:203], v[122:123] op_sel:[0,1]
  s_waitcnt vmcnt(16)
  buffer_load_dwordx4 v[32:35], v94, s[12:15], s60 offen offset:2816 nt
  v_pk_fma_f32 v[204:205], v[60:61], s[92:93], v[122:123] op_sel_hi:[1,1,0] neg_lo:[0,0,1] neg_hi:[0,0,1]
  v_pk_fma_f32 v[206:207], v[62:63], s[92:93], v[122:123] op_sel_hi:[1,1,0] neg_lo:[0,0,1] neg_hi:[0,0,1]
  v_cvt_pk_bf16_f32 v204, 0, v204
  v_cvt_pk_bf16_f32 v167, v160, v161
  v_cvt_pk_bf16_f32 v205, 0, v205
  v_cvt_pk_bf16_f32 v168, v162, 0
  v_cvt_pk_bf16_f32 v206, 0, v206
  v_cndmask_b32 v172, 0, v163, s[72:73]
  v_cvt_pk_bf16_f32 v207, 0, v207
  v_cndmask_b32 v173, 0, v164, s[72:73]
  v_pk_mul_f32 v[204:205], v[204:205], v[122:123] op_sel:[0,1]
  v_cndmask_b32 v174, 0, v165, s[72:73]
  v_pk_mul_f32 v[206:207], v[206:207], v[122:123] op_sel:[0,1]
  s_waitcnt vmcnt(16)
  s_cbranch_vccnz L_vw0_15
  s_waitcnt vmcnt(9)
L_vw0_15:
  buffer_load_dwordx4 v[36:39], v95, s[12:15], s60 offen offset:0 nt
  v_mov_b32_dpp v122, v120 row_newbcast:5 row_mask:0xf bank_mask:0xf
  v_mov_b32_dpp v123, v121 row_newbcast:5 row_mask:0xf bank_mask:0xf
  v_pk_fma_f32 v[114:115], v[64:65], s[92:93], v[122:123] op_sel_hi:[1,1,0] neg_lo:[0,0,1] neg_hi:[0,0,1]
  v_pk_fma_f32 v[116:117], v[66:67], s[92:93], v[122:123] op_sel_hi:[1,1,0] neg_lo:[0,0,1] neg_hi:[0,0,1]
  v_cvt_pk_bf16_f32 v114, 0, v114
  v_cndmask_b32 v175, 0, v166, s[72:73]
  v_cvt_pk_bf16_f32 v115, 0, v115
  v_cndmask_b32 v176, 0, v163, s[74:75]
  v_cvt_pk_bf16_f32 v116, 0, v116
  v_cndmask_b32 v177, 0, v164, s[74:75]
  v_cvt_pk_bf16_f32 v117, 0, v117
  v_cndmask_b32 v178, 0, v165, s[74:75]
  v_pk_mul_f32 v[114:115], v[114:115], v[122:123] op_sel:[0,1]
  v_cndmask_b32 v179, 0, v166, s[74:75]
  v_pk_mul_f32 v[116:117], v[116:117], v[122:123] op_sel:[0,1]
  v_cvt_pk_bf16_f32 v210, v196, v114
  v_cvt_pk_bf16_f32 v214, v197, v115
  v_cvt_pk_bf16_f32 v218, v198, v116
  v_cvt_pk_bf16_f32 v222, v199, v117
  s_waitcnt vmcnt(16)
  buffer_load_dwordx4 v[40:43], v95, s[12:15], s60 offen offset:256 nt
  v_pk_fma_f32 v[114:115], v[68:69], s[92:93], v[122:123] op_sel_hi:[1,1,0] neg_lo:[0,0,1] neg_hi:[0,0,1]
  v_pk_fma_f32 v[116:117], v[70:71], s[92:93], v[122:123] op_sel_hi:[1,1,0] neg_lo:[0,0,1] neg_hi:[0,0,1]
  v_cvt_pk_bf16_f32 v114, 0, v114
  v_cndmask_b32 v180, 0, v163, s[76:77]
  v_cvt_pk_bf16_f32 v115, 0, v115
  v_cndmask_b32 v181, 0, v164, s[76:77]
  v_cvt_pk_bf16_f32 v116, 0, v116
  v_cndmask_b32 v182, 0, v165, s[76:77]
  v_cvt_pk_bf16_f32 v117, 0, v117
  v_cndmask_b32 v183, 0, v166, s[76:77]
  v_pk_mul_f32 v[114:115], v[114:115], v[122:123] op_sel:[0,1]
  v_cndmask_b32 v184, 0, v163, s[78:79]
  v_pk_mul_f32 v[116:117], v[116:117], v[122:123] op_sel:[0,1]
  v_cvt_pk_bf16_f32 v226, v200, v114
  v_cvt_pk_bf16_f32 v230, v201, v115
  v_cvt_pk_bf16_f32 v234, v202, v116
  v_cvt_pk_bf16_f32 v238, v203, v117
  s_waitcnt vmcnt(16)
  buffer_load_dwordx4 v[44:47], v95, s[12:15], s60 offen offset:512 nt
  v_pk_fma_f32 v[114:115], v[72:73], s[92:93], v[122:123] op_sel_hi:[1,1,0] neg_lo:[0,0,1] neg_hi:[0,0,1]
  v_pk_fma_f32 v[116:117], v[74:75], s[92:93], v[122:123] op_sel_hi:[1,1,0] neg_lo:[0,0,1] neg_hi:[0,0,1]
  v_cvt_pk_bf16_f32 v114, 0, v114
  v_cndmask_b32 v185, 0, v164, s[78:79]
  v_cvt_pk_bf16_f32 v115, 0, v115
  v_cndmask_b32 v186, 0, v165, s[78:79]
  v_cvt_pk_bf16_f32 v116, 0, v116
  v_cndmask_b32 v187, 0, v166, s[78:79]
  v_cvt_pk_bf16_f32 v117, 0, v117
  s_waitcnt lgkmcnt(0)
  v_pk_mul_f32 v[114:115], v[114:115], v[122:123] op_sel:[0,1]
  v_mul_f32 v132, v151, v132
  v_pk_mul_f32 v[116:117], v[116:117], v[122:123] op_sel:[0,1]
  v_cvt_pk_bf16_f32 v242, v204, v114
  v_cvt_pk_bf16_f32 v246, v205, v115
  v_cvt_pk_bf16_f32 v250, v206, v116
  v_cvt_pk_bf16_f32 v254, v207, v117
  v_mad_u32_u24 v92, v100, s63, v98
  v_add_u32 v93, 768, v92
  v_add_u32 v94, 4608, v92
  v_add_u32 v95, 7680, v92
  v_cndmask_b32 v92, v92, v108, s[52:53]
  v_cndmask_b32 v95, v95, v108, s[54:55]
  s_waitcnt vmcnt(16)
  s_cbranch_vccnz L_vw0_18
  s_waitcnt vmcnt(9)
L_vw0_18:
  buffer_load_dwordx4 v[48:51], v92, s[12:15], s61 offen offset:0 nt
  v_mov_b32_dpp v122, v120 row_newbcast:6 row_mask:0xf bank_mask:0xf
  v_mov_b32_dpp v123, v121 row_newbcast:6 row_mask:0xf bank_mask:0xf
  v_pk_fma_f32 v[196:197], v[76:77], s[92:93], v[122:123] op_sel_hi:[1,1,0] neg_lo:[0,0,1] neg_hi:[0,0,1]
  v_pk_fma_f32 v[198:199], v[78:79], s[92:93], v[122:123] op_sel_hi:[1,1,0] neg_lo:[0,0,1] neg_hi:[0,0,1]
  v_cvt_pk_bf16_f32 v196, 0, v196
  v_mul_f32 v133, v151, v133
  v_cvt_pk_bf16_f32 v197, 0, v197
  v_mul_f32 v134, v151, v134
  v_cvt_pk_bf16_f32 v198, 0, v198
  v_mul_f32 v135, v151, v135
  v_cvt_pk_bf16_f32 v199, 0, v199
  v_mul_f32 v136, v151, v136
  v_pk_mul_f32 v[196:197], v[196:197], v[122:123] op_sel:[0,1]
  v_mul_f32 v137, v151, v137
  v_pk_mul_f32 v[198:199], v[198:199], v[122:123] op_sel:[0,1]
  s_waitcnt vmcnt(14)
  buffer_load_dwordx4 v[52:55], v92, s[12:15], s61 offen offset:256 nt
  v_pk_fma_f32 v[200:201], v[80:81], s[92:93], v[122:123] op_sel_hi:[1,1,0] neg_lo:[0,0,1] neg_hi:[0,0,1]
  v_pk_fma_f32 v[202:203], v[82:83], s[92:93], v[122:123] op_sel_hi:[1,1,0] neg_lo:[0,0,1] neg_hi:[0,0,1]
  v_cvt_pk_bf16_f32 v200, 0, v200
  v_mul_f32 v138, v151, v138
  v_cvt_pk_bf16_f32 v201, 0, v201
  v_mul_f32 v139, v151, v139
  v_cvt_pk_bf16_f32 v202, 0, v202
  v_mul_f32 v140, v151, v140
  v_cvt_pk_bf16_f32 v203, 0, v203
  v_mul_f32 v141, v151, v141
  v_pk_mul_f32 v[200:201], v[200:201], v[122:123] op_sel:[0,1]
  v_mul_f32 v142, v151, v142
  v_pk_mul_f32 v[202:203], v[202:203], v[122:123] op_sel:[0,1]
  s_waitcnt vmcnt(14)
  buffer_load_dwordx4 v[56:59], v92, s[12:15], s61 offen offset:512 nt
  v_pk_fma_f32 v[204:205], v[84:85], s[92:93], v[122:123] op_sel_hi:[1,1,0] neg_lo:[0,0,1] neg_hi:[0,0,1]
  v_pk_fma_f32 v[206:207], v[86:87], s[92:93], v[122:123] op_sel_hi:[1,1,0] neg_lo:[0,0,1] neg_hi:[0,0,1]
  v_cvt_pk_bf16_f32 v204, 0, v204
  v_mul_f32 v143, v151, v143
  v_cvt_pk_bf16_f32 v205, 0, v205
  v_cvt_pk_bf16_f32 v206, 0, v206
  v_cvt_pk_bf16_f32 v207, 0, v207
  v_pk_mul_f32 v[204:205], v[204:205], v[122:123] op_sel:[0,1]
  v_pk_mul_f32 v[206:207], v[206:207], v[122:123] op_sel:[0,1]
  s_waitcnt vmcnt(14)
  s_cbranch_vccnz L_vw0_21
  s_waitcnt vmcnt(9)
L_vw0_21:
  buffer_load_dwordx4 v[60:63], v93, s[12:15], s61 offen offset:0 nt
  v_mov_b32_dpp v122, v120 row_newbcast:7 row_mask:0xf bank_mask:0xf
  v_mov_b32_dpp v123, v121 row_newbcast:7 row_mask:0xf bank_mask:0xf
  v_pk_fma_f32 v[114:115], v[88:89], s[92:93], v[122:123] op_sel_hi:[1,1,0] neg_lo:[0,0,1] neg_hi:[0,0,1]
  v_pk_fma_f32 v[116:117], v[90:91], s[92:93], v[122:123] op_sel_hi:[1,1,0] neg_lo:[0,0,1] neg_hi:[0,0,1]
  v_cvt_pk_bf16_f32 v114, 0, v114
  v_cvt_pk_bf16_f32 v115, 0, v115
  v_cvt_pk_bf16_f32 v116, 0, v116
  v_cvt_pk_bf16_f32 v117, 0, v117
  v_pk_mul_f32 v[114:115], v[114:115], v[122:123] op_sel:[0,1]
  v_pk_mul_f32 v[116:117], v[116:117], v[122:123] op_sel:[0,1]
  v_cvt_pk_bf16_f32 v211, v196, v114
  v_cvt_pk_bf16_f32 v215, v197, v115
  v_cvt_pk_bf16_f32 v219, v198, v116
  v_cvt_pk_bf16_f32 v223, v199, v117
  v_mfma_f32_16x16x32_bf16 v[132:135], v[172:175], v[208:211], v[132:135]
  v_mfma_f32_16x16x32_bf16 v[132:135], v[176:179], v[212:215], v[132:135]
  v_mfma_f32_16x16x32_bf16 v[132:135], v[180:183], v[216:219], v[132:135]
  v_mfma_f32_16x16x32_bf16 v[132:135], v[184:187], v[220:223], v[132:135]
  s_waitcnt vmcnt(14)
  buffer_load_dwordx4 v[64:67], v93, s[12:15], s61 offen offset:256 nt
  v_pk_fma_f32 v[114:115], v[4:5], s[92:93], v[122:123] op_sel_hi:[1,1,0] neg_lo:[0,0,1] neg_hi:[0,0,1]
  v_pk_fma_f32 v[116:117], v[6:7], s[92:93], v[122:123] op_sel_hi:[1,1,0] neg_lo:[0,0,1] neg_hi:[0,0,1]
  v_cvt_pk_bf16_f32 v114, 0, v114
  v_cvt_pk_bf16_f32 v115, 0, v115
  v_cvt_pk_bf16_f32 v116, 0, v116
  v_cvt_pk_bf16_f32 v117, 0, v117
  v_pk_mul_f32 v[114:115], v[114:115], v[122:123] op_sel:[0,1]
  v_pk_mul_f32 v[116:117], v[116:117], v[122:123] op_sel:[0,1]
  v_cvt_pk_bf16_f32 v227, v200, v114
  v_cvt_pk_bf16_f32 v231, v201, v115
  v_cvt_pk_bf16_f32 v235, v202, v116
  v_cvt_pk_bf16_f32 v239, v203, v117
  v_mfma_f32_16x16x32_bf16 v[136:139], v[172:175], v[224:227], v[136:139]
  v_mfma_f32_16x16x32_bf16 v[136:139], v[176:179], v[228:231], v[136:139]
  v_mfma_f32_16x16x32_bf16 v[136:139], v[180:183], v[232:235], v[136:139]
  v_mfma_f32_16x16x32_bf16 v[136:139], v[184:187], v[236:239], v[136:139]
  s_waitcnt vmcnt(14)
  buffer_load_dwordx4 v[68:71], v93, s[12:15], s61 offen offset:512 nt
  v_pk_fma_f32 v[114:115], v[8:9], s[92:93], v[122:123] op_sel_hi:[1,1,0] neg_lo:[0,0,1] neg_hi:[0,0,1]
  v_pk_fma_f32 v[116:117], v[10:11], s[92:93], v[122:123] op_sel_hi:[1,1,0] neg_lo:[0,0,1] neg_hi:[0,0,1]
  v_cvt_pk_bf16_f32 v114, 0, v114
  v_cvt_pk_bf16_f32 v115, 0, v115
  v_cvt_pk_bf16_f32 v116, 0, v116
  v_cvt_pk_bf16_f32 v117, 0, v117
  v_pk_mul_f32 v[114:115], v[114:115], v[122:123] op_sel:[0,1]
  v_pk_mul_f32 v[116:117], v[116:117], v[122:123] op_sel:[0,1]
  v_cvt_pk_bf16_f32 v243, v204, v114
  v_cvt_pk_bf16_f32 v247, v205, v115
  v_cvt_pk_bf16_f32 v251, v206, v116
  v_cvt_pk_bf16_f32 v255, v207, v117
  v_mfma_f32_16x16x32_bf16 v[140:143], v[172:175], v[240:243], v[140:143]
  v_mfma_f32_16x16x32_bf16 v[140:143], v[176:179], v[244:247], v[140:143]
  v_mfma_f32_16x16x32_bf16 v[140:143], v[180:183], v[248:251], v[140:143]
  v_mfma_f32_16x16x32_bf16 v[140:143], v[184:187], v[252:255], v[140:143]
  s_waitcnt vmcnt(14)
  s_cbranch_vccnz L_vw0_24
  s_waitcnt vmcnt(9)
L_vw0_24:
  buffer_load_dwordx4 v[72:75], v93, s[12:15], s61 offen offset:768 nt
  v_mov_b32_dpp v122, v120 row_newbcast:8 row_mask:0xf bank_mask:0xf
  v_mov_b32_dpp v123, v121 row_newbcast:8 row_mask:0xf bank_mask:0xf
  v_pk_fma_f32 v[196:197], v[12:13], s[92:93], v[122:123] op_sel_hi:[1,1,0] neg_lo:[0,0,1] neg_hi:[0,0,1]
  v_pk_fma_f32 v[198:199], v[14:15], s[92:93], v[122:123] op_sel_hi:[1,1,0] neg_lo:[0,0,1] neg_hi:[0,0,1]
  v_cvt_pk_bf16_f32 v196, 0, v196
  v_cndmask_b32 v188, 0, v167, s[72:73]
  v_cvt_pk_bf16_f32 v197, 0, v197
  v_cndmask_b32 v189, 0, v168, s[72:73]
  v_cvt_pk_bf16_f32 v198, 0, v198
  v_cndmask_b32 v190, 0, v167, s[74:75]
  v_cvt_pk_bf16_f32 v199, 0, v199
  v_cndmask_b32 v191, 0, v168, s[74:75]
  v_pk_mul_f32 v[196:197], v[196:197], v[122:123] op_sel:[0,1]
  v_cndmask_b32 v192, 0, v167, s[76:77]
  v_pk_mul_f32 v[198:199], v[198:199], v[122:123] op_sel:[0,1]
  s_waitcnt vmcnt(14)
  buffer_load_dwordx4 v[76:79], v93, s[12:15], s61 offen offset:1024 nt
  v_pk_fma_f32 v[200:201], v[16:17], s[92:93], v[122:123] op_sel_hi:[1,1,0] neg_lo:[0,0,1] neg_hi:[0,0,1]
  v_pk_fma_f32 v[202:203], v[18:19], s[92:93], v[122:123] op_sel_hi:[1,1,0] neg_lo:[0,0,1] neg_hi:[0,0,1]
  v_cvt_pk_bf16_f32 v200, 0, v200
  v_cndmask_b32 v193, 0, v168, s[76:77]
  v_cvt_pk_bf16_f32 v201, 0, v201
  v_cndmask_b32 v194, 0, v167, s[78:79]
  v_cvt_pk_bf16_f32 v202, 0, v202
  v_cndmask_b32 v195, 0, v168, s[78:79]
  v_cvt_pk_bf16_f32 v203, 0, v203
  v_pk_mul_f32 v[200:201], v[200:201], v[122:123] op_sel:[0,1]
  v_pk_mul_f32 v[202:203], v[202:203], v[122:123] op_sel:[0,1]
  s_waitcnt vmcnt(14)
  buffer_load_dwordx4 v[80:83], v93, s[12:15], s61 offen offset:1280 nt
  v_pk_fma_f32 v[204:205], v[20:21], s[92:93], v[122:123] op_sel_hi:[1,1,0] neg_lo:[0,0,1] neg_hi:[0,0,1]
  v_pk_fma_f32 v[206:207], v[22:23], s[92:93], v[122:123] op_sel_hi:[1,1,0] neg_lo:[0,0,1] neg_hi:[0,0,1]
  v_cvt_pk_bf16_f32 v204, 0, v204
  v_cvt_pk_bf16_f32 v205, 0, v205
  v_cvt_pk_bf16_f32 v206, 0, v206
  v_cvt_pk_bf16_f32 v207, 0, v207
  v_pk_mul_f32 v[204:205], v[204:205], v[122:123] op_sel:[0,1]
  v_pk_mul_f32 v[206:207], v[206:207], v[122:123] op_sel:[0,1]
  s_waitcnt vmcnt(14)
  s_cbranch_vccnz L_vw0_27
  s_waitcnt vmcnt(9)
L_vw0_27:
  buffer_load_dwordx4 v[84:87], v93, s[12:15], s61 offen offset:1536 nt
  v_mov_b32_dpp v122, v120 row_newbcast:9 row_mask:0xf bank_mask:0xf
  v_mov_b32_dpp v123, v121 row_newbcast:9 row_mask:0xf bank_mask:0xf
  v_pk_fma_f32 v[114:115], v[24:25], s[92:93], v[122:123] op_sel_hi:[1,1,0] neg_lo:[0,0,1] neg_hi:[0,0,1]
  v_pk_fma_f32 v[116:117], v[26:27], s[92:93], v[122:123] op_sel_hi:[1,1,0] neg_lo:[0,0,1] neg_hi:[0,0,1]
  v_cvt_pk_bf16_f32 v114, 0, v114
  v_cvt_pk_bf16_f32 v115, 0, v115
  v_cvt_pk_bf16_f32 v116, 0, v116
  v_cvt_pk_bf16_f32 v117, 0, v117
  v_pk_mul_f32 v[114:115], v[114:115], v[122:123] op_sel:[0,1]
  v_pk_mul_f32 v[116:117], v[116:117], v[122:123] op_sel:[0,1]
  v_cvt_pk_bf16_f32 v208, v196, v114
  v_cvt_pk_bf16_f32 v212, v197, v115
  v_cvt_pk_bf16_f32 v216, v198, v116
  v_cvt_pk_bf16_f32 v220, v199, v117
  s_waitcnt vmcnt(14)
  buffer_load_dwordx4 v[88:91], v93, s[12:15], s61 offen offset:1792 nt
  v_pk_fma_f32 v[114:115], v[28:29], s[92:93], v[122:123] op_sel_hi:[1,1,0] neg_lo:[0,0,1] neg_hi:[0,0,1]
  v_pk_fma_f32 v[116:117], v[30:31], s[92:93], v[122:123] op_sel_hi:[1,1,0] neg_lo:[0,0,1] neg_hi:[0,0,1]
  v_cvt_pk_bf16_f32 v114, 0, v114
  v_cvt_pk_bf16_f32 v115, 0, v115
  v_cvt_pk_bf16_f32 v116, 0, v116
  v_cvt_pk_bf16_f32 v117, 0, v117
  v_pk_mul_f32 v[114:115], v[114:115], v[122:123] op_sel:[0,1]
  v_pk_mul_f32 v[116:117], v[116:117], v[122:123] op_sel:[0,1]
  v_cvt_pk_bf16_f32 v224, v200, v114
  v_cvt_pk_bf16_f32 v228, v201, v115
  v_cvt_pk_bf16_f32 v232, v202, v116
  v_cvt_pk_bf16_f32 v236, v203, v117
  s_waitcnt vmcnt(14)
  buffer_load_dwordx4 v[4:7], v93, s[12:15], s61 offen offset:2048 nt
  v_pk_fma_f32 v[114:115], v[32:33], s[92:93], v[122:123] op_sel_hi:[1,1,0] neg_lo:[0,0,1] neg_hi:[0,0,1]
  v_pk_fma_f32 v[116:117], v[34:35], s[92:93], v[122:123] op_sel_hi:[1,1,0] neg_lo:[0,0,1] neg_hi:[0,0,1]
  v_cvt_pk_bf16_f32 v114, 0, v114
  v_cvt_pk_bf16_f32 v115, 0, v115
  v_cvt_pk_bf16_f32 v116, 0, v116
  v_cvt_pk_bf16_f32 v117, 0, v117
  v_pk_mul_f32 v[114:115], v[114:115], v[122:123] op_sel:[0,1]
  v_pk_mul_f32 v[116:117], v[116:117], v[122:123] op_sel:[0,1]
  v_cvt_pk_bf16_f32 v240, v204, v114
  v_cvt_pk_bf16_f32 v244, v205, v115
  v_cvt_pk_bf16_f32 v248, v206, v116
  v_cvt_pk_bf16_f32 v252, v207, v117
  s_waitcnt vmcnt(14)
  s_cbranch_vccnz L_vw0_30
  s_waitcnt vmcnt(9)
L_vw0_30:
  buffer_load_dwordx4 v[8:11], v93, s[12:15], s61 offen offset:2304 nt
  v_mov_b32_dpp v122, v120 row_newbcast:10 row_mask:0xf bank_mask:0xf
  v_mov_b32_dpp v123, v121 row_newbcast:10 row_mask:0xf bank_mask:0xf
  v_pk_fma_f32 v[196:197], v[36:37], s[92:93], v[122:123] op_sel_hi:[1,1,0] neg_lo:[0,0,1] neg_hi:[0,0,1]
  v_pk_fma_f32 v[198:199], v[38:39], s[92:93], v[122:123] op_sel_hi:[1,1,0] neg_lo:[0,0,1] neg_hi:[0,0,1]
  v_cvt_pk_bf16_f32 v196, 0, v196
  v_cvt_pk_bf16_f32 v197, 0, v197
  v_cvt_pk_bf16_f32 v198, 0, v198
  v_cvt_pk_bf16_f32 v199, 0, v199
  v_pk_mul_f32 v[196:197], v[196:197], v[122:123] op_sel:[0,1]
  v_pk_mul_f32 v[198:199], v[198:199], v[122:123] op_sel:[0,1]
  v_cvt_pk_bf16_f32 v209, v196, 0
  v_cvt_pk_bf16_f32 v213, v197, 0
  v_cvt_pk_bf16_f32 v217, v198, 0
  v_cvt_pk_bf16_f32 v221, v199, 0
  v_mfma_f32_16x16x16_bf16 v[132:135], v[188:189], v[208:209], v[132:135]
  v_mfma_f32_16x16x16_bf16 v[132:135], v[190:191], v[212:213], v[132:135]
  v_mfma_f32_16x16x16_bf16 v[132:135], v[192:193], v[216:217], v[132:135]
  v_mfma_f32_16x16x16_bf16 v[132:135], v[194:195], v[220:221], v[132:135]
  s_waitcnt vmcnt(14)
  buffer_load_dwordx4 v[12:15], v93, s[12:15], s61 offen offset:2560 nt
  v_pk_fma_f32 v[200:201], v[40:41], s[92:93], v[122:123] op_sel_hi:[1,1,0] neg_lo:[0,0,1] neg_hi:[0,0,1]
  v_pk_fma_f32 v[202:203], v[42:43], s[92:93], v[122:123] op_sel_hi:[1,1,0] neg_lo:[0,0,1] neg_hi:[0,0,1]
  v_cvt_pk_bf16_f32 v200, 0, v200
  v_cvt_pk_bf16_f32 v201, 0, v201
  v_cvt_pk_bf16_f32 v202, 0, v202
  v_cvt_pk_bf16_f32 v203, 0, v203
  v_pk_mul_f32 v[200:201], v[200:201], v[122:123] op_sel:[0,1]
  v_pk_mul_f32 v[202:203], v[202:203], v[122:123] op_sel:[0,1]
  v_cvt_pk_bf16_f32 v225, v200, 0
  v_cvt_pk_bf16_f32 v229, v201, 0
  v_cvt_pk_bf16_f32 v233, v202, 0
  v_cvt_pk_bf16_f32 v237, v203, 0
  v_mfma_f32_16x16x16_bf16 v[136:139], v[188:189], v[224:225], v[136:139]
  v_mfma_f32_16x16x16_bf16 v[136:139], v[190:191], v[228:229], v[136:139]
  v_mfma_f32_16x16x16_bf16 v[136:139], v[192:193], v[232:233], v[136:139]
  v_mfma_f32_16x16x16_bf16 v[136:139], v[194:195], v[236:237], v[136:139]
  s_waitcnt vmcnt(14)
  buffer_load_dwordx4 v[16:19], v93, s[12:15], s61 offen offset:2816 nt
  v_pk_fma_f32 v[204:205], v[44:45], s[92:93], v[122:123] op_sel_hi:[1,1,0] neg_lo:[0,0,1] neg_hi:[0,0,1]
  v_pk_fma_f32 v[206:207], v[46:47], s[92:93], v[122:123] op_sel_hi:[1,1,0] neg_lo:[0,0,1] neg_hi:[0,0,1]
  v_cvt_pk_bf16_f32 v204, 0, v204
  v_cvt_pk_bf16_f32 v205, 0, v205
  v_cvt_pk_bf16_f32 v206, 0, v206
  v_cvt_pk_bf16_f32 v207, 0, v207
  v_pk_mul_f32 v[204:205], v[204:205], v[122:123] op_sel:[0,1]
  v_pk_mul_f32 v[206:207], v[206:207], v[122:123] op_sel:[0,1]
  v_cvt_pk_bf16_f32 v241, v204, 0
  v_cvt_pk_bf16_f32 v245, v205, 0
  v_cvt_pk_bf16_f32 v249, v206, 0
  v_cvt_pk_bf16_f32 v253, v207, 0
  v_mfma_f32_16x16x16_bf16 v[140:143], v[188:189], v[240:241], v[140:143]
  v_mfma_f32_16x16x16_bf16 v[140:143], v[190:191], v[244:245], v[140:143]
  v_mfma_f32_16x16x16_bf16 v[140:143], v[192:193], v[248:249], v[140:143]
  v_mfma_f32_16x16x16_bf16 v[140:143], v[194:195], v[252:253], v[140:143]
  s_mov_b32 s60, s61
  s_cmp_eq_u32 s89, s88
  s_cbranch_scc1 L_v1
  s_mov_b32 s88, s89
  v_mov_b32 v149, v147
  s_nop 1
  v_permlane32_swap_b32 v147, v149
  v_add_f32 v147, v147, v149
  v_mov_b32 v149, v147
  s_nop 1
  v_permlane16_swap_b32 v147, v149
  v_add_f32 v147, v147, v149
  ds_write_b64 v106, v[146:147]
  ds_write_b128 v105, v[132:135] offset:0
  ds_write_b128 v105, v[136:139] offset:1024
  ds_write_b128 v105, v[140:143] offset:2048
  s_and_b32 s70, s86, 15
  s_cmp_ge_u32 s70, 12
  s_cselect_b32 s70, 2, 0
  s_and_b32 s71, s87, 1
  s_bitcmp1_b32 s96, 6
  s_cselect_b32 s71, s4, s71
  s_add_u32 s70, s70, s71
  s_lshr_b32 s71, s86, 4
  s_lshl2_add_u32 s70, s71, s70
  s_add_u32 s71, s3, 0
  s_cmp_eq_u32 s100, s71
  s_cselect_b32 s44, s70, s44
  s_add_u32 s71, s3, 2
  s_cmp_eq_u32 s100, s71
  s_cselect_b32 s45, s70, s45
  s_add_u32 s100, s100, 1
  s_waitcnt lgkmcnt(0)
  v_add_u32 v105, 6208, v105
  v_add_u32 v106, 6208, v106
  v_mov_b32 v132, 0
  v_mov_b32 v133, 0
  v_mov_b32 v134, 0
  v_mov_b32 v135, 0
  v_mov_b32 v136, 0
  v_mov_b32 v137, 0
  v_mov_b32 v138, 0
  v_mov_b32 v139, 0
  v_mov_b32 v140, 0
  v_mov_b32 v141, 0
  v_mov_b32 v142, 0
  v_mov_b32 v143, 0
  v_mov_b32 v144, 0xff800000
  v_mov_b32 v146, 0x7f800000
  v_mov_b32 v147, 0
L_v1:
  s_mov_b32 s86, s84
  s_mov_b32 s87, s85
  s_add_u32 s64, s64, 2
  s_cmp_lt_u32 s64, s99
  s_cbranch_scc1 L_v11_ok
L_v11_spin:
  v_mov_b32 v148, 61700
  ds_read_b32 v148, v148
  s_waitcnt lgkmcnt(0)
  v_readfirstlane_b32 s99, v148
  s_nop 1
  s_cmp_lt_u32 s64, s99
  s_cbranch_scc0 L_v11_spin
L_v11_ok:
  s_andn2_b32 s70, s64, 1
  s_or_b32 s70, s70, s4
  s_lshr_b32 s71, s64, 5
  s_lshr_b32 s85, s96, s71
  s_lshr_b32 s85, s85, 3
  s_cmp_lt_u32 s64, s97
  s_cselect_b32 s70, s70, s64
  s_cselect_b32 s85, s64, s85
  s_and_b32 s85, s85, 1
  s_mul_i32 s71, s71, 4064
  s_add_u32 s70, s70, s71
  s_add_u32 s70, s70, s5
  s_mul_hi_u32 s84, s70, s90
  s_lshr_b32 s84, s84, 1
  s_mul_i32 s71, s84, 3
  s_sub_u32 s70, s70, s71
  s_lshl3_add_u32 s85, s70, s85
  s_mul_i32 s61, s84, 196608
  s_lshr_b32 s89, s84, 4
  s_lshl_b32 s70, s85, 5
  v_add_u32 v100, s70, v96
  v_mul_u32_u24 v100, 21846, v100
  v_lshrrev_b32 v100, 16, v100
  v_add_u32 v148, s85, v97
  v_lshrrev_b32 v149, v148, s91
  v_and_b32 v149, 1, v149
  v_cmp_eq_u32 s[54:55], 1, v149
  s_nop 1
  s_and_b64 s[52:53], s[54:55], s[58:59]
  s_andn2_b64 s[54:55], s[54:55], s[58:59]
  s_cmp_lt_u32 s64, 96
  s_cselect_b32 s61, s61, 805306368
  s_add_u32 s70, s64, 94
  v_mov_b32 v150, s70
  v_add_u32 v112, s70, v111
  ds_write_b32 v107, v150
  ds_read_b32 v110, v109
  s_waitcnt vmcnt(14)
  s_cbranch_vccnz L_vw1_0
  s_waitcnt vmcnt(9)
L_vw1_0:
  buffer_load_dwordx4 v[20:23], v93, s[12:15], s60 offen offset:3072 nt
  v_mul_f32 v120, 0x34800000, v118
  v_mul_f32 v121, 0x4a800000, v119
  s_nop 0
  v_mov_b32_dpp v122, v120 row_newbcast:0 row_mask:0xf bank_mask:0xf
  v_mov_b32_dpp v123, v121 row_newbcast:0 row_mask:0xf bank_mask:0xf
  v_pk_fma_f32 v[196:197], v[48:49], s[92:93], v[122:123] op_sel_hi:[1,1,0] neg_lo:[0,0,1] neg_hi:[0,0,1]
  v_pk_fma_f32 v[198:199], v[50:51], s[92:93], v[122:123] op_sel_hi:[1,1,0] neg_lo:[0,0,1] neg_hi:[0,0,1]
  v_cvt_pk_bf16_f32 v196, 0, v196
  s_waitcnt lgkmcnt(0)
  v_cvt_pk_bf16_f32 v197, 0, v197
  v_lshlrev_b32 v152, 16, v124
  v_cvt_pk_bf16_f32 v198, 0, v198
  v_and_b32 v153, s65, v124
  v_cvt_pk_bf16_f32 v199, 0, v199
  v_lshlrev_b32 v154, 16, v125
  v_pk_mul_f32 v[196:197], v[196:197], v[122:123] op_sel:[0,1]
  v_and_b32 v155, s65, v125
  v_pk_mul_f32 v[198:199], v[198:199], v[122:123] op_sel:[0,1]
  s_waitcnt lgkmcnt(0)
  v_cmp_lt_i32 vcc, v112, v110
  s_waitcnt vmcnt(14)
  buffer_load_dwordx4 v[24:27], v93, s[12:15], s60 offen offset:3328 nt
  v_pk_fma_f32 v[200:201], v[52:53], s[92:93], v[122:123] op_sel_hi:[1,1,0] neg_lo:[0,0,1] neg_hi:[0,0,1]
  v_pk_fma_f32 v[202:203], v[54:55], s[92:93], v[122:123] op_sel_hi:[1,1,0] neg_lo:[0,0,1] neg_hi:[0,0,1]
  v_cvt_pk_bf16_f32 v200, 0, v200
  v_lshlrev_b32 v156, 16, v126
  v_cvt_pk_bf16_f32 v201, 0, v201
  v_and_b32 v157, s65, v126
  v_cvt_pk_bf16_f32 v202, 0, v202
  v_lshlrev_b32 v158, 16, v127
  v_cvt_pk_bf16_f32 v203, 0, v203
  v_and_b32 v159, s65, v127
  v_pk_mul_f32 v[200:201], v[200:201], v[122:123] op_sel:[0,1]
  v_lshlrev_b32 v160, 16, v128
  v_pk_mul_f32 v[202:203], v[202:203], v[122:123] op_sel:[0,1]
  s_waitcnt vmcnt(14)
  buffer_load_dwordx4 v[28:31], v93, s[12:15], s60 offen offset:3584 nt
  v_pk_fma_f32 v[204:205], v[56:57], s[92:93], v[122:123] op_sel_hi:[1,1,0] neg_lo:[0,0,1] neg_hi:[0,0,1]
  v_pk_fma_f32 v[206:207], v[58:59], s[92:93], v[122:123] op_sel_hi:[1,1,0] neg_lo:[0,0,1] neg_hi:[0,0,1]
  v_cvt_pk_bf16_f32 v204, 0, v204
  v_and_b32 v161, s65, v128
  v_cvt_pk_bf16_f32 v205, 0, v205
  v_lshlrev_b32 v162, 16, v129
  v_cvt_pk_bf16_f32 v206, 0, v206
  v_add_u32 v102, 768, v102
  v_cvt_pk_bf16_f32 v207, 0, v207
  v_add_u32 v103, 768, v103
  v_pk_mul_f32 v[204:205], v[204:205], v[122:123] op_sel:[0,1]
  v_max3_f32 v148, v152, v153, v154
  v_pk_mul_f32 v[206:207], v[206:207], v[122:123] op_sel:[0,1]
  s_waitcnt vmcnt(14)
  s_cbranch_vccnz L_vw1_3
  s_waitcnt vmcnt(9)
L_vw1_3:
  buffer_load_dwordx4 v[32:35], v94, s[12:15], s60 offen offset:0 nt
  v_mov_b32_dpp v122, v120 row_newbcast:1 row_mask:0xf bank_mask:0xf
  v_mov_b32_dpp v123, v121 row_newbcast:1 row_mask:0xf bank_mask:0xf
  v_pk_fma_f32 v[114:115], v[60:61], s[92:93], v[122:123] op_sel_hi:[1,1,0] neg_lo:[0,0,1] neg_hi:[0,0,1]
  v_pk_fma_f32 v[116:117], v[62:63], s[92:93], v[122:123] op_sel_hi:[1,1,0] neg_lo:[0,0,1] neg_hi:[0,0,1]
  s_lshl_b32 s62, s84, 9
  v_lshl_add_u32 v101, v100, 1, v99
  buffer_load_short_d16_hi v118, v101, s[32:35], s62 offen
  buffer_load_short_d16_hi v119, v101, s[28:31], s62 offen
  v_cvt_pk_bf16_f32 v114, 0, v114
  ds_read_b128 v[124:127], v102
  v_cvt_pk_bf16_f32 v115, 0, v115
  ds_read_b64 v[128:129], v103 offset:256
  v_cvt_pk_bf16_f32 v116, 0, v116
  v_max3_f32 v149, v155, v156, v157
  v_cvt_pk_bf16_f32 v117, 0, v117
  v_max3_f32 v148, v148, v158, v159
  v_pk_mul_f32 v[114:115], v[114:115], v[122:123] op_sel:[0,1]
  v_max3_f32 v149, v149, v160, v161
  v_pk_mul_f32 v[116:117], v[116:117], v[122:123] op_sel:[0,1]
  v_cvt_pk_bf16_f32 v208, v196, v114
  v_cvt_pk_bf16_f32 v212, v197, v115
  v_cvt_pk_bf16_f32 v216, v198, v116
  v_cvt_pk_bf16_f32 v220, v199, v117
  s_waitcnt vmcnt(16)
  buffer_load_dwordx4 v[36:39], v94, s[12:15], s60 offen offset:256 nt
  v_pk_fma_f32 v[114:115], v[64:65], s[92:93], v[122:123] op_sel_hi:[1,1,0] neg_lo:[0,0,1] neg_hi:[0,0,1]
  v_pk_fma_f32 v[116:117], v[66:67], s[92:93], v[122:123] op_sel_hi:[1,1,0] neg_lo:[0,0,1] neg_hi:[0,0,1]
  v_cvt_pk_bf16_f32 v114, 0, v114
  v_max3_f32 v148, v148, v162, v144
  v_cvt_pk_bf16_f32 v115, 0, v115
  v_max_f32 v148, v148, v149
  v_cvt_pk_bf16_f32 v116, 0, v116
  v_mov_b32 v149, v148
  v_cvt_pk_bf16_f32 v117, 0, v117
  s_nop 0
  v_permlane32_swap_b32 v148, v149
  v_pk_mul_f32 v[114:115], v[114:115], v[122:123] op_sel:[0,1]
  v_max_f32 v148, v148, v149
  v_pk_mul_f32 v[116:117], v[116:117], v[122:123] op_sel:[0,1]
  v_cvt_pk_bf16_f32 v224, v200, v114
  v_cvt_pk_bf16_f32 v228, v201, v115
  v_cvt_pk_bf16_f32 v232, v202, v116
  v_cvt_pk_bf16_f32 v236, v203, v117
  s_waitcnt vmcnt(16)
  buffer_load_dwordx4 v[40:43], v94, s[12:15], s60 offen offset:512 nt
  v_pk_fma_f32 v[114:115], v[68:69], s[92:93], v[122:123] op_sel_hi:[1,1,0] neg_lo:[0,0,1] neg_hi:[0,0,1]
  v_pk_fma_f32 v[116:117], v[70:71], s[92:93], v[122:123] op_sel_hi:[1,1,0] neg_lo:[0,0,1] neg_hi:[0,0,1]
  v_cvt_pk_bf16_f32 v114, 0, v114
  v_mov_b32 v149, v148
  v_cvt_pk_bf16_f32 v115, 0, v115
  s_nop 0
  v_permlane16_swap_b32 v148, v149
  v_cvt_pk_bf16_f32 v116, 0, v116
  v_max_f32 v144, v148, v149
  v_cvt_pk_bf16_f32 v117, 0, v117
  v_mul_f32 v148, s66, v144
  v_pk_mul_f32 v[114:115], v[114:115], v[122:123] op_sel:[0,1]
  v_add_f32 v150, v148, v146
  v_pk_mul_f32 v[116:117], v[116:117], v[122:123] op_sel:[0,1]
  v_cvt_pk_bf16_f32 v240, v204, v114
  v_cvt_pk_bf16_f32 v244, v205, v115
  v_cvt_pk_bf16_f32 v248, v206, v116
  v_cvt_pk_bf16_f32 v252, v207, v117
  s_waitcnt vmcnt(16)
  s_cbranch_vccnz L_vw1_6
  s_waitcnt vmcnt(11)
L_vw1_6:
  buffer_load_dwordx4 v[44:47], v94, s[12:15], s60 offen offset:768 nt
  v_mov_b32_dpp v122, v120 row_newbcast:2 row_mask:0xf bank_mask:0xf
  v_mov_b32_dpp v123, v121 row_newbcast:2 row_mask:0xf bank_mask:0xf
  v_pk_fma_f32 v[196:197], v[72:73], s[92:93], v[122:123] op_sel_hi:[1,1,0] neg_lo:[0,0,1] neg_hi:[0,0,1]
  v_pk_fma_f32 v[198:199], v[74:75], s[92:93], v[122:123] op_sel_hi:[1,1,0] neg_lo:[0,0,1] neg_hi:[0,0,1]
  v_cvt_pk_bf16_f32 v196, 0, v196
  v_sub_f32 v146, 0, v148
  v_cvt_pk_bf16_f32 v197, 0, v197
  v_exp_f32 v150, -v150
  v_cvt_pk_bf16_f32 v198, 0, v198
  ds_bpermute_b32 v151, v104, v150
  v_cvt_pk_bf16_f32 v199, 0, v199
  v_fma_f32 v152, v152, s66, v146
  v_pk_mul_f32 v[196:197], v[196:197], v[122:123] op_sel:[0,1]
  v_exp_f32 v152, v152
  v_pk_mul_f32 v[198:199], v[198:199], v[122:123] op_sel:[0,1]
  s_waitcnt vmcnt(16)
  buffer_load_dwordx4 v[48:51], v94, s[12:15], s60 offen offset:1024 nt
  v_pk_fma_f32 v[200:201], v[76:77], s[92:93], v[122:123] op_sel_hi:[1,1,0] neg_lo:[0,0,1] neg_hi:[0,0,1]
  v_pk_fma_f32 v[202:203], v[78:79], s[92:93], v[122:123] op_sel_hi:[1,1,0] neg_lo:[0,0,1] neg_hi:[0,0,1]
  v_cvt_pk_bf16_f32 v200, 0, v200
  v_fma_f32 v153, v153, s66, v146
  v_cvt_pk_bf16_f32 v201, 0, v201
  v_exp_f32 v153, v153
  v_cvt_pk_bf16_f32 v202, 0, v202
  v_fma_f32 v154, v154, s66, v146
  v_cvt_pk_bf16_f32 v203, 0, v203
  v_exp_f32 v154, v154
  v_pk_mul_f32 v[200:201], v[200:201], v[122:123] op_sel:[0,1]
  v_fma_f32 v155, v155, s66, v146
  v_pk_mul_f32 v[202:203], v[202:203], v[122:123] op_sel:[0,1]
  s_waitcnt vmcnt(16)
  buffer_load_dwordx4 v[52:55], v94, s[12:15], s60 offen offset:1280 nt
  v_pk_fma_f32 v[204:205], v[80:81], s[92:93], v[122:123] op_sel_hi:[1,1,0] neg_lo:[0,0,1] neg_hi:[0,0,1]
  v_pk_fma_f32 v[206:207], v[82:83], s[92:93], v[122:123] op_sel_hi:[1,1,0] neg_lo:[0,0,1] neg_hi:[0,0,1]
  v_cvt_pk_bf16_f32 v204, 0, v204
  v_exp_f32 v155, v155
  v_cvt_pk_bf16_f32 v205, 0, v205
  v_fma_f32 v156, v156, s66, v146
  v_cvt_pk_bf16_f32 v206, 0, v206
  v_exp_f32 v156, v156
  v_cvt_pk_bf16_f32 v207, 0, v207
  v_fma_f32 v157, v157, s66, v146
  v_pk_mul_f32 v[204:205], v[204:205], v[122:123] op_sel:[0,1]
  v_exp_f32 v157, v157
  v_pk_mul_f32 v[206:207], v[206:207], v[122:123] op_sel:[0,1]
  s_waitcnt vmcnt(16)
  s_cbranch_vccnz L_vw1_9
  s_waitcnt vmcnt(11)
L_vw1_9:
  buffer_load_dwordx4 v[56:59], v94, s[12:15], s60 offen offset:1536 nt
  v_mov_b32_dpp v122, v120 row_newbcast:3 row_mask:0xf bank_mask:0xf
  v_mov_b32_dpp v123, v121 row_newbcast:3 row_mask:0xf bank_mask:0xf
  v_pk_fma_f32 v[114:115], v[84:85], s[92:93], v[122:123] op_sel_hi:[1,1,0] neg_lo:[0,0,1] neg_hi:[0,0,1]
  v_pk_fma_f32 v[116:117], v[86:87], s[92:93], v[122:123] op_sel_hi:[1,1,0] neg_lo:[0,0,1] neg_hi:[0,0,1]
  v_cvt_pk_bf16_f32 v114, 0, v114
  v_fma_f32 v158, v158, s66, v146
  v_cvt_pk_bf16_f32 v115, 0, v115
  v_exp_f32 v158, v158
  v_cvt_pk_bf16_f32 v116, 0, v116
  v_fma_f32 v159, v159, s66, v146
  v_cvt_pk_bf16_f32 v117, 0, v117
  v_exp_f32 v159, v159
  v_pk_mul_f32 v[114:115], v[114:115], v[122:123] op_sel:[0,1]
  v_fma_f32 v160, v160, s66, v146
  v_pk_mul_f32 v[116:117], v[116:117], v[122:123] op_sel:[0,1]
  v_cvt_pk_bf16_f32 v209, v196, v114
  v_cvt_pk_bf16_f32 v213, v197, v115
  v_cvt_pk_bf16_f32 v217, v198, v116
  v_cvt_pk_bf16_f32 v221, v199, v117
  s_waitcnt vmcnt(16)
  buffer_load_dwordx4 v[60:63], v94, s[12:15], s60 offen offset:1792 nt
  v_pk_fma_f32 v[114:115], v[88:89], s[92:93], v[122:123] op_sel_hi:[1,1,0] neg_lo:[0,0,1] neg_hi:[0,0,1]
  v_pk_fma_f32 v[116:117], v[90:91], s[92:93], v[122:123] op_sel_hi:[1,1,0] neg_lo:[0,0,1] neg_hi:[0,0,1]
  v_cvt_pk_bf16_f32 v114, 0, v114
  v_exp_f32 v160, v160
  v_cvt_pk_bf16_f32 v115, 0, v115
  v_fma_f32 v161, v161, s66, v146
  v_cvt_pk_bf16_f32 v116, 0, v116
  v_exp_f32 v161, v161
  v_cvt_pk_bf16_f32 v117, 0, v117
  v_fma_f32 v162, v162, s66, v146
  v_pk_mul_f32 v[114:115], v[114:115], v[122:123] op_sel:[0,1]
  v_exp_f32 v162, v162
  v_pk_mul_f32 v[116:117], v[116:117], v[122:123] op_sel:[0,1]
  v_cvt_pk_bf16_f32 v225, v200, v114
  v_cvt_pk_bf16_f32 v229, v201, v115
  v_cvt_pk_bf16_f32 v233, v202, v116
  v_cvt_pk_bf16_f32 v237, v203, v117
  s_waitcnt vmcnt(16)
  buffer_load_dwordx4 v[64:67], v94, s[12:15], s60 offen offset:2048 nt
  v_pk_fma_f32 v[114:115], v[4:5], s[92:93], v[122:123] op_sel_hi:[1,1,0] neg_lo:[0,0,1] neg_hi:[0,0,1]
  v_pk_fma_f32 v[116:117], v[6:7], s[92:93], v[122:123] op_sel_hi:[1,1,0] neg_lo:[0,0,1] neg_hi:[0,0,1]
  v_cvt_pk_bf16_f32 v114, 0, v114
  v_add_f32 v148, v152, v153
  v_cvt_pk_bf16_f32 v115, 0, v115
  v_add_f32 v149, v154, v155
  v_cvt_pk_bf16_f32 v116, 0, v116
  v_add_f32 v148, v148, v156
  v_cvt_pk_bf16_f32 v117, 0, v117
  v_add_f32 v149, v149, v157
  v_pk_mul_f32 v[114:115], v[114:115], v[122:123] op_sel:[0,1]
  v_add_f32 v148, v148, v158
  v_pk_mul_f32 v[116:117], v[116:117], v[122:123] op_sel:[0,1]
  v_cvt_pk_bf16_f32 v241, v204, v114
  v_cvt_pk_bf16_f32 v245, v205, v115
  v_cvt_pk_bf16_f32 v249, v206, v116
  v_cvt_pk_bf16_f32 v253, v207, v117
  s_waitcnt vmcnt(16)
  s_cbranch_vccnz L_vw1_12
  s_waitcnt vmcnt(11)
L_vw1_12:
  buffer_load_dwordx4 v[68:71], v94, s[12:15], s60 offen offset:2304 nt
  v_mov_b32_dpp v122, v120 row_newbcast:4 row_mask:0xf bank_mask:0xf
  v_mov_b32_dpp v123, v121 row_newbcast:4 row_mask:0xf bank_mask:0xf
  v_pk_fma_f32 v[196:197], v[8:9], s[92:93], v[122:123] op_sel_hi:[1,1,0] neg_lo:[0,0,1] neg_hi:[0,0,1]
  v_pk_fma_f32 v[198:199], v[10:11], s[92:93], v[122:123] op_sel_hi:[1,1,0] neg_lo:[0,0,1] neg_hi:[0,0,1]
  v_cvt_pk_bf16_f32 v196, 0, v196
  v_add_f32 v149, v149, v159
  v_cvt_pk_bf16_f32 v197, 0, v197
  v_add_f32 v148, v148, v160
  v_cvt_pk_bf16_f32 v198, 0, v198
  v_add_f32 v149, v149, v161
  v_cvt_pk_bf16_f32 v199, 0, v199
  v_add_f32 v148, v148, v162
  v_pk_mul_f32 v[196:197], v[196:197], v[122:123] op_sel:[0,1]
  v_add_f32 v148, v148, v149
  v_pk_mul_f32 v[198:199], v[198:199], v[122:123] op_sel:[0,1]
  s_waitcnt vmcnt(16)
  buffer_load_dwordx4 v[72:75], v94, s[12:15], s60 offen offset:2560 nt
  v_pk_fma_f32 v[200:201], v[12:13], s[92:93], v[122:123] op_sel_hi:[1,1,0] neg_lo:[0,0,1] neg_hi:[0,0,1]
  v_pk_fma_f32 v[202:203], v[14:15], s[92:93], v[122:123] op_sel_hi:[1,1,0] neg_lo:[0,0,1] neg_hi:[0,0,1]
  v_cvt_pk_bf16_f32 v200, 0, v200
  v_fma_f32 v147, v147, v150, v148
  v_cvt_pk_bf16_f32 v201, 0, v201
  v_cvt_pk_bf16_f32 v163, v152, v153
  v_cvt_pk_bf16_f32 v202, 0, v202
  v_cvt_pk_bf16_f32 v164, v154, v155
  v_cvt_pk_bf16_f32 v203, 0, v203
  v_cvt_pk_bf16_f32 v165, v156, v157
  v_pk_mul_f32 v[200:201], v[200:201], v[122:123] op_sel:[0,1]
  v_cvt_pk_bf16_f32 v166, v158, v159
  v_pk_mul_f32 v[202:203], v[202:203], v[122:123] op_sel:[0,1]
  s_waitcnt vmcnt(16)
  buffer_load_dwordx4 v[76:79], v94, s[12:15], s60 offen offset:2816 nt
  v_pk_fma_f32 v[204:205], v[16:17], s[92:93], v[122:123] op_sel_hi:[1,1,0] neg_lo:[0,0,1] neg_hi:[0,0,1]
  v_pk_fma_f32 v[206:207], v[18:19], s[92:93], v[122:123] op_sel_hi:[1,1,0] neg_lo:[0,0,1] neg_hi:[0,0,1]
  v_cvt_pk_bf16_f32 v204, 0, v204
  v_cvt_pk_bf16_f32 v167, v160, v161
  v_cvt_pk_bf16_f32 v205, 0, v205
  v_cvt_pk_bf16_f32 v168, v162, 0
  v_cvt_pk_bf16_f32 v206, 0, v206
  v_cndmask_b32 v172, 0, v163, s[72:73]
  v_cvt_pk_bf16_f32 v207, 0, v207
  v_cndmask_b32 v173, 0, v164, s[72:73]
  v_pk_mul_f32 v[204:205], v[204:205], v[122:123] op_sel:[0,1]
  v_cndmask_b32 v174, 0, v165, s[72:73]
  v_pk_mul_f32 v[206:207], v[206:207], v[122:123] op_sel:[0,1]
  s_waitcnt vmcnt(16)
  s_cbranch_vccnz L_vw1_15
  s_waitcnt vmcnt(9)
L_vw1_15:
  buffer_load_dwordx4 v[80:83], v95, s[12:15], s60 offen offset:0 nt
  v_mov_b32_dpp v122, v120 row_newbcast:5 row_mask:0xf bank_mask:0xf
  v_mov_b32_dpp v123, v121 row_newbcast:5 row_mask:0xf bank_mask:0xf
  v_pk_fma_f32 v[114:115], v[20:21], s[92:93], v[122:123] op_sel_hi:[1,1,0] neg_lo:[0,0,1] neg_hi:[0,0,1]
  v_pk_fma_f32 v[116:117], v[22:23], s[92:93], v[122:123] op_sel_hi:[1,1,0] neg_lo:[0,0,1] neg_hi:[0,0,1]
  v_cvt_pk_bf16_f32 v114, 0, v114
  v_cndmask_b32 v175, 0, v166, s[72:73]
  v_cvt_pk_bf16_f32 v115, 0, v115
  v_cndmask_b32 v176, 0, v163, s[74:75]
  v_cvt_pk_bf16_f32 v116, 0, v116
  v_cndmask_b32 v177, 0, v164, s[74:75]
  v_cvt_pk_bf16_f32 v117, 0, v117
  v_cndmask_b32 v178, 0, v165, s[74:75]
  v_pk_mul_f32 v[114:115], v[114:115], v[122:123] op_sel:[0,1]
  v_cndmask_b32 v179, 0, v166, s[74:75]
  v_pk_mul_f32 v[116:117], v[116:117], v[122:123] op_sel:[0,1]
  v_cvt_pk_bf16_f32 v210, v196, v114
  v_cvt_pk_bf16_f32 v214, v197, v115
  v_cvt_pk_bf16_f32 v218, v198, v116
  v_cvt_pk_bf16_f32 v222, v199, v117
  s_waitcnt vmcnt(16)
  buffer_load_dwordx4 v[84:87], v95, s[12:15], s60 offen offset:256 nt
  v_pk_fma_f32 v[114:115], v[24:25], s[92:93], v[122:123] op_sel_hi:[1,1,0] neg_lo:[0,0,1] neg_hi:[0,0,1]
  v_pk_fma_f32 v[116:117], v[26:27], s[92:93], v[122:123] op_sel_hi:[1,1,0] neg_lo:[0,0,1] neg_hi:[0,0,1]
  v_cvt_pk_bf16_f32 v114, 0, v114
  v_cndmask_b32 v180, 0, v163, s[76:77]
  v_cvt_pk_bf16_f32 v115, 0, v115
  v_cndmask_b32 v181, 0, v164, s[76:77]
  v_cvt_pk_bf16_f32 v116, 0, v116
  v_cndmask_b32 v182, 0, v165, s[76:77]
  v_cvt_pk_bf16_f32 v117, 0, v117
  v_cndmask_b32 v183, 0, v166, s[76:77]
  v_pk_mul_f32 v[114:115], v[114:115], v[122:123] op_sel:[0,1]
  v_cndmask_b32 v184, 0, v163, s[78:79]
  v_pk_mul_f32 v[116:117], v[116:117], v[122:123] op_sel:[0,1]
  v_cvt_pk_bf16_f32 v226, v200, v114
  v_cvt_pk_bf16_f32 v230, v201, v115
  v_cvt_pk_bf16_f32 v234, v202, v116
  v_cvt_pk_bf16_f32 v238, v203, v117
  s_waitcnt vmcnt(16)
  buffer_load_dwordx4 v[88:91], v95, s[12:15], s60 offen offset:512 nt
  v_pk_fma_f32 v[114:115], v[28:29], s[92:93], v[122:123] op_sel_hi:[1,1,0] neg_lo:[0,0,1] neg_hi:[0,0,1]
  v_pk_fma_f32 v[116:117], v[30:31], s[92:93], v[122:123] op_sel_hi:[1,1,0] neg_lo:[0,0,1] neg_hi:[0,0,1]
  v_cvt_pk_bf16_f32 v114, 0, v114
  v_cndmask_b32 v185, 0, v164, s[78:79]
  v_cvt_pk_bf16_f32 v115, 0, v115
  v_cndmask_b32 v186, 0, v165, s[78:79]
  v_cvt_pk_bf16_f32 v116, 0, v116
  v_cndmask_b32 v187, 0, v166, s[78:79]
  v_cvt_pk_bf16_f32 v117, 0, v117
  s_waitcnt lgkmcnt(0)
  v_pk_mul_f32 v[114:115], v[114:115], v[122:123] op_sel:[0,1]
  v_mul_f32 v132, v151, v132
  v_pk_mul_f32 v[116:117], v[116:117], v[122:123] op_sel:[0,1]
  v_cvt_pk_bf16_f32 v242, v204, v114
  v_cvt_pk_bf16_f32 v246, v205, v115
  v_cvt_pk_bf16_f32 v250, v206, v116
  v_cvt_pk_bf16_f32 v254, v207, v117
  v_mad_u32_u24 v92, v100, s63, v98
  v_add_u32 v93, 768, v92
  v_add_u32 v94, 4608, v92
  v_add_u32 v95, 7680, v92
  v_cndmask_b32 v92, v92, v108, s[52:53]
  v_cndmask_b32 v95, v95, v108, s[54:55]
  s_waitcnt vmcnt(16)
  s_cbranch_vccnz L_vw1_18
  s_waitcnt vmcnt(9)
L_vw1_18:
  buffer_load_dwordx4 v[4:7], v92, s[12:15], s61 offen offset:0 nt
  v_mov_b32_dpp v122, v120 row_newbcast:6 row_mask:0xf bank_mask:0xf
  v_mov_b32_dpp v123, v121 row_newbcast:6 row_mask:0xf bank_mask:0xf
  v_pk_fma_f32 v[196:197], v[32:33], s[92:93], v[122:123] op_sel_hi:[1,1,0] neg_lo:[0,0,1] neg_hi:[0,0,1]
  v_pk_fma_f32 v[198:199], v[34:35], s[92:93], v[122:123] op_sel_hi:[1,1,0] neg_lo:[0,0,1] neg_hi:[0,0,1]
  v_cvt_pk_bf16_f32 v196, 0, v196
  v_mul_f32 v133, v151, v133
  v_cvt_pk_bf16_f32 v197, 0, v197
  v_mul_f32 v134, v151, v134
  v_cvt_pk_bf16_f32 v198, 0, v198
  v_mul_f32 v135, v151, v135
  v_cvt_pk_bf16_f32 v199, 0, v199
  v_mul_f32 v136, v151, v136
  v_pk_mul_f32 v[196:197], v[196:197], v[122:123] op_sel:[0,1]
  v_mul_f32 v137, v151, v137
  v_pk_mul_f32 v[198:199], v[198:199], v[122:123] op_sel:[0,1]
  s_waitcnt vmcnt(14)
  buffer_load_dwordx4 v[8:11], v92, s[12:15], s61 offen offset:256 nt
  v_pk_fma_f32 v[200:201], v[36:37], s[92:93], v[122:123] op_sel_hi:[1,1,0] neg_lo:[0,0,1] neg_hi:[0,0,1]
  v_pk_fma_f32 v[202:203], v[38:39], s[92:93], v[122:123] op_sel_hi:[1,1,0] neg_lo:[0,0,1] neg_hi:[0,0,1]
  v_cvt_pk_bf16_f32 v200, 0, v200
  v_mul_f32 v138, v151, v138
  v_cvt_pk_bf16_f32 v201, 0, v201
  v_mul_f32 v139, v151, v139
  v_cvt_pk_bf16_f32 v202, 0, v202
  v_mul_f32 v140, v151, v140
  v_cvt_pk_bf16_f32 v203, 0, v203
  v_mul_f32 v141, v151, v141
  v_pk_mul_f32 v[200:201], v[200:201], v[122:123] op_sel:[0,1]
  v_mul_f32 v142, v151, v142
  v_pk_mul_f32 v[202:203], v[202:203], v[122:123] op_sel:[0,1]
  s_waitcnt vmcnt(14)
  buffer_load_dwordx4 v[12:15], v92, s[12:15], s61 offen offset:512 nt
  v_pk_fma_f32 v[204:205], v[40:41], s[92:93], v[122:123] op_sel_hi:[1,1,0] neg_lo:[0,0,1] neg_hi:[0,0,1]
  v_pk_fma_f32 v[206:207], v[42:43], s[92:93], v[122:123] op_sel_hi:[1,1,0] neg_lo:[0,0,1] neg_hi:[0,0,1]
  v_cvt_pk_bf16_f32 v204, 0, v204
  v_mul_f32 v143, v151, v143
  v_cvt_pk_bf16_f32 v205, 0, v205
  v_cvt_pk_bf16_f32 v206, 0, v206
  v_cvt_pk_bf16_f32 v207, 0, v207
  v_pk_mul_f32 v[204:205], v[204:205], v[122:123] op_sel:[0,1]
  v_pk_mul_f32 v[206:207], v[206:207], v[122:123] op_sel:[0,1]
  s_waitcnt vmcnt(14)
  s_cbranch_vccnz L_vw1_21
  s_waitcnt vmcnt(9)
L_vw1_21:
  buffer_load_dwordx4 v[16:19], v93, s[12:15], s61 offen offset:0 nt
  v_mov_b32_dpp v122, v120 row_newbcast:7 row_mask:0xf bank_mask:0xf
  v_mov_b32_dpp v123, v121 row_newbcast:7 row_mask:0xf bank_mask:0xf
  v_pk_fma_f32 v[114:115], v[44:45], s[92:93], v[122:123] op_sel_hi:[1,1,0] neg_lo:[0,0,1] neg_hi:[0,0,1]
  v_pk_fma_f32 v[116:117], v[46:47], s[92:93], v[122:123] op_sel_hi:[1,1,0] neg_lo:[0,0,1] neg_hi:[0,0,1]
  v_cvt_pk_bf16_f32 v114, 0, v114
  v_cvt_pk_bf16_f32 v115, 0, v115
  v_cvt_pk_bf16_f32 v116, 0, v116
  v_cvt_pk_bf16_f32 v117, 0, v117
  v_pk_mul_f32 v[114:115], v[114:115], v[122:123] op_sel:[0,1]
  v_pk_mul_f32 v[116:117], v[116:117], v[122:123] op_sel:[0,1]
  v_cvt_pk_bf16_f32 v211, v196, v114
  v_cvt_pk_bf16_f32 v215, v197, v115
  v_cvt_pk_bf16_f32 v219, v198, v116
  v_cvt_pk_bf16_f32 v223, v199, v117
  v_mfma_f32_16x16x32_bf16 v[132:135], v[172:175], v[208:211], v[132:135]
  v_mfma_f32_16x16x32_bf16 v[132:135], v[176:179], v[212:215], v[132:135]
  v_mfma_f32_16x16x32_bf16 v[132:135], v[180:183], v[216:219], v[132:135]
  v_mfma_f32_16x16x32_bf16 v[132:135], v[184:187], v[220:223], v[132:135]
  s_waitcnt vmcnt(14)
  buffer_load_dwordx4 v[20:23], v93, s[12:15], s61 offen offset:256 nt
  v_pk_fma_f32 v[114:115], v[48:49], s[92:93], v[122:123] op_sel_hi:[1,1,0] neg_lo:[0,0,1] neg_hi:[0,0,1]
  v_pk_fma_f32 v[116:117], v[50:51], s[92:93], v[122:123] op_sel_hi:[1,1,0] neg_lo:[0,0,1] neg_hi:[0,0,1]
  v_cvt_pk_bf16_f32 v114, 0, v114
  v_cvt_pk_bf16_f32 v115, 0, v115
  v_cvt_pk_bf16_f32 v116, 0, v116
  v_cvt_pk_bf16_f32 v117, 0, v117
  v_pk_mul_f32 v[114:115], v[114:115], v[122:123] op_sel:[0,1]
  v_pk_mul_f32 v[116:117], v[116:117], v[122:123] op_sel:[0,1]
  v_cvt_pk_bf16_f32 v227, v200, v114
  v_cvt_pk_bf16_f32 v231, v201, v115
  v_cvt_pk_bf16_f32 v235, v202, v116
  v_cvt_pk_bf16_f32 v239, v203, v117
  v_mfma_f32_16x16x32_bf16 v[136:139], v[172:175], v[224:227], v[136:139]
  v_mfma_f32_16x16x32_bf16 v[136:139], v[176:179], v[228:231], v[136:139]
  v_mfma_f32_16x16x32_bf16 v[136:139], v[180:183], v[232:235], v[136:139]
  v_mfma_f32_16x16x32_bf16 v[136:139], v[184:187], v[236:239], v[136:139]
  s_waitcnt vmcnt(14)
  buffer_load_dwordx4 v[24:27], v93, s[12:15], s61 offen offset:512 nt
  v_pk_fma_f32 v[114:115], v[52:53], s[92:93], v[122:123] op_sel_hi:[1,1,0] neg_lo:[0,0,1] neg_hi:[0,0,1]
  v_pk_fma_f32 v[116:117], v[54:55], s[92:93], v[122:123] op_sel_hi:[1,1,0] neg_lo:[0,0,1] neg_hi:[0,0,1]
  v_cvt_pk_bf16_f32 v114, 0, v114
  v_cvt_pk_bf16_f32 v115, 0, v115
  v_cvt_pk_bf16_f32 v116, 0, v116
  v_cvt_pk_bf16_f32 v117, 0, v117
  v_pk_mul_f32 v[114:115], v[114:115], v[122:123] op_sel:[0,1]
  v_pk_mul_f32 v[116:117], v[116:117], v[122:123] op_sel:[0,1]
  v_cvt_pk_bf16_f32 v243, v204, v114
  v_cvt_pk_bf16_f32 v247, v205, v115
  v_cvt_pk_bf16_f32 v251, v206, v116
  v_cvt_pk_bf16_f32 v255, v207, v117
  v_mfma_f32_16x16x32_bf16 v[140:143], v[172:175], v[240:243], v[140:143]
  v_mfma_f32_16x16x32_bf16 v[140:143], v[176:179], v[244:247], v[140:143]
  v_mfma_f32_16x16x32_bf16 v[140:143], v[180:183], v[248:251], v[140:143]
  v_mfma_f32_16x16x32_bf16 v[140:143], v[184:187], v[252:255], v[140:143]
  s_waitcnt vmcnt(14)
  s_cbranch_vccnz L_vw1_24
  s_waitcnt vmcnt(9)
L_vw1_24:
  buffer_load_dwordx4 v[28:31], v93, s[12:15], s61 offen offset:768 nt
  v_mov_b32_dpp v122, v120 row_newbcast:8 row_mask:0xf bank_mask:0xf
  v_mov_b32_dpp v123, v121 row_newbcast:8 row_mask:0xf bank_mask:0xf
  v_pk_fma_f32 v[196:197], v[56:57], s[92:93], v[122:123] op_sel_hi:[1,1,0] neg_lo:[0,0,1] neg_hi:[0,0,1]
  v_pk_fma_f32 v[198:199], v[58:59], s[92:93], v[122:123] op_sel_hi:[1,1,0] neg_lo:[0,0,1] neg_hi:[0,0,1]
  v_cvt_pk_bf16_f32 v196, 0, v196
  v_cndmask_b32 v188, 0, v167, s[72:73]
  v_cvt_pk_bf16_f32 v197, 0, v197
  v_cndmask_b32 v189, 0, v168, s[72:73]
  v_cvt_pk_bf16_f32 v198, 0, v198
  v_cndmask_b32 v190, 0, v167, s[74:75]
  v_cvt_pk_bf16_f32 v199, 0, v199
  v_cndmask_b32 v191, 0, v168, s[74:75]
  v_pk_mul_f32 v[196:197], v[196:197], v[122:123] op_sel:[0,1]
  v_cndmask_b32 v192, 0, v167, s[76:77]
  v_pk_mul_f32 v[198:199], v[198:199], v[122:123] op_sel:[0,1]
  s_waitcnt vmcnt(14)
  buffer_load_dwordx4 v[32:35], v93, s[12:15], s61 offen offset:1024 nt
  v_pk_fma_f32 v[200:201], v[60:61], s[92:93], v[122:123] op_sel_hi:[1,1,0] neg_lo:[0,0,1] neg_hi:[0,0,1]
  v_pk_fma_f32 v[202:203], v[62:63], s[92:93], v[122:123] op_sel_hi:[1,1,0] neg_lo:[0,0,1] neg_hi:[0,0,1]
  v_cvt_pk_bf16_f32 v200, 0, v200
  v_cndmask_b32 v193, 0, v168, s[76:77]
  v_cvt_pk_bf16_f32 v201, 0, v201
  v_cndmask_b32 v194, 0, v167, s[78:79]
  v_cvt_pk_bf16_f32 v202, 0, v202
  v_cndmask_b32 v195, 0, v168, s[78:79]
  v_cvt_pk_bf16_f32 v203, 0, v203
  v_pk_mul_f32 v[200:201], v[200:201], v[122:123] op_sel:[0,1]
  v_pk_mul_f32 v[202:203], v[202:203], v[122:123] op_sel:[0,1]
  s_waitcnt vmcnt(14)
  buffer_load_dwordx4 v[36:39], v93, s[12:15], s61 offen offset:1280 nt
  v_pk_fma_f32 v[204:205], v[64:65], s[92:93], v[122:123] op_sel_hi:[1,1,0] neg_lo:[0,0,1] neg_hi:[0,0,1]
  v_pk_fma_f32 v[206:207], v[66:67], s[92:93], v[122:123] op_sel_hi:[1,1,0] neg_lo:[0,0,1] neg_hi:[0,0,1]
  v_cvt_pk_bf16_f32 v204, 0, v204
  v_cvt_pk_bf16_f32 v205, 0, v205
  v_cvt_pk_bf16_f32 v206, 0, v206
  v_cvt_pk_bf16_f32 v207, 0, v207
  v_pk_mul_f32 v[204:205], v[204:205], v[122:123] op_sel:[0,1]
  v_pk_mul_f32 v[206:207], v[206:207], v[122:123] op_sel:[0,1]
  s_waitcnt vmcnt(14)
  s_cbranch_vccnz L_vw1_27
  s_waitcnt vmcnt(9)
L_vw1_27:
  buffer_load_dwordx4 v[40:43], v93, s[12:15], s61 offen offset:1536 nt
  v_mov_b32_dpp v122, v120 row_newbcast:9 row_mask:0xf bank_mask:0xf
  v_mov_b32_dpp v123, v121 row_newbcast:9 row_mask:0xf bank_mask:0xf
  v_pk_fma_f32 v[114:115], v[68:69], s[92:93], v[122:123] op_sel_hi:[1,1,0] neg_lo:[0,0,1] neg_hi:[0,0,1]
  v_pk_fma_f32 v[116:117], v[70:71], s[92:93], v[122:123] op_sel_hi:[1,1,0] neg_lo:[0,0,1] neg_hi:[0,0,1]
  v_cvt_pk_bf16_f32 v114, 0, v114
  v_cvt_pk_bf16_f32 v115, 0, v115
  v_cvt_pk_bf16_f32 v116, 0, v116
  v_cvt_pk_bf16_f32 v117, 0, v117
  v_pk_mul_f32 v[114:115], v[114:115], v[122:123] op_sel:[0,1]
  v_pk_mul_f32 v[116:117], v[116:117], v[122:123] op_sel:[0,1]
  v_cvt_pk_bf16_f32 v208, v196, v114
  v_cvt_pk_bf16_f32 v212, v197, v115
  v_cvt_pk_bf16_f32 v216, v198, v116
  v_cvt_pk_bf16_f32 v220, v199, v117
  s_waitcnt vmcnt(14)
  buffer_load_dwordx4 v[44:47], v93, s[12:15], s61 offen offset:1792 nt
  v_pk_fma_f32 v[114:115], v[72:73], s[92:93], v[122:123] op_sel_hi:[1,1,0] neg_lo:[0,0,1] neg_hi:[0,0,1]
  v_pk_fma_f32 v[116:117], v[74:75], s[92:93], v[122:123] op_sel_hi:[1,1,0] neg_lo:[0,0,1] neg_hi:[0,0,1]
  v_cvt_pk_bf16_f32 v114, 0, v114
  v_cvt_pk_bf16_f32 v115, 0, v115
  v_cvt_pk_bf16_f32 v116, 0, v116
  v_cvt_pk_bf16_f32 v117, 0, v117
  v_pk_mul_f32 v[114:115], v[114:115], v[122:123] op_sel:[0,1]
  v_pk_mul_f32 v[116:117], v[116:117], v[122:123] op_sel:[0,1]
  v_cvt_pk_bf16_f32 v224, v200, v114
  v_cvt_pk_bf16_f32 v228, v201, v115
  v_cvt_pk_bf16_f32 v232, v202, v116
  v_cvt_pk_bf16_f32 v236, v203, v117
  s_waitcnt vmcnt(14)
  buffer_load_dwordx4 v[48:51], v93, s[12:15], s61 offen offset:2048 nt
  v_pk_fma_f32 v[114:115], v[76:77], s[92:93], v[122:123] op_sel_hi:[1,1,0] neg_lo:[0,0,1] neg_hi:[0,0,1]
  v_pk_fma_f32 v[116:117], v[78:79], s[92:93], v[122:123] op_sel_hi:[1,1,0] neg_lo:[0,0,1] neg_hi:[0,0,1]
  v_cvt_pk_bf16_f32 v114, 0, v114
  v_cvt_pk_bf16_f32 v115, 0, v115
  v_cvt_pk_bf16_f32 v116, 0, v116
  v_cvt_pk_bf16_f32 v117, 0, v117
  v_pk_mul_f32 v[114:115], v[114:115], v[122:123] op_sel:[0,1]
  v_pk_mul_f32 v[116:117], v[116:117], v[122:123] op_sel:[0,1]
  v_cvt_pk_bf16_f32 v240, v204, v114
  v_cvt_pk_bf16_f32 v244, v205, v115
  v_cvt_pk_bf16_f32 v248, v206, v116
  v_cvt_pk_bf16_f32 v252, v207, v117
  s_waitcnt vmcnt(14)
  s_cbranch_vccnz L_vw1_30
  s_waitcnt vmcnt(9)
L_vw1_30:
  buffer_load_dwordx4 v[52:55], v93, s[12:15], s61 offen offset:2304 nt
  v_mov_b32_dpp v122, v120 row_newbcast:10 row_mask:0xf bank_mask:0xf
  v_mov_b32_dpp v123, v121 row_newbcast:10 row_mask:0xf bank_mask:0xf
  v_pk_fma_f32 v[196:197], v[80:81], s[92:93], v[122:123] op_sel_hi:[1,1,0] neg_lo:[0,0,1] neg_hi:[0,0,1]
  v_pk_fma_f32 v[198:199], v[82:83], s[92:93], v[122:123] op_sel_hi:[1,1,0] neg_lo:[0,0,1] neg_hi:[0,0,1]
  v_cvt_pk_bf16_f32 v196, 0, v196
  v_cvt_pk_bf16_f32 v197, 0, v197
  v_cvt_pk_bf16_f32 v198, 0, v198
  v_cvt_pk_bf16_f32 v199, 0, v199
  v_pk_mul_f32 v[196:197], v[196:197], v[122:123] op_sel:[0,1]
  v_pk_mul_f32 v[198:199], v[198:199], v[122:123] op_sel:[0,1]
  v_cvt_pk_bf16_f32 v209, v196, 0
  v_cvt_pk_bf16_f32 v213, v197, 0
  v_cvt_pk_bf16_f32 v217, v198, 0
  v_cvt_pk_bf16_f32 v221, v199, 0
  v_mfma_f32_16x16x16_bf16 v[132:135], v[188:189], v[208:209], v[132:135]
  v_mfma_f32_16x16x16_bf16 v[132:135], v[190:191], v[212:213], v[132:135]
  v_mfma_f32_16x16x16_bf16 v[132:135], v[192:193], v[216:217], v[132:135]
  v_mfma_f32_16x16x16_bf16 v[132:135], v[194:195], v[220:221], v[132:135]
  s_waitcnt vmcnt(14)
  buffer_load_dwordx4 v[56:59], v93, s[12:15], s61 offen offset:2560 nt
  v_pk_fma_f32 v[200:201], v[84:85], s[92:93], v[122:123] op_sel_hi:[1,1,0] neg_lo:[0,0,1] neg_hi:[0,0,1]
  v_pk_fma_f32 v[202:203], v[86:87], s[92:93], v[122:123] op_sel_hi:[1,1,0] neg_lo:[0,0,1] neg_hi:[0,0,1]
  v_cvt_pk_bf16_f32 v200, 0, v200
  v_cvt_pk_bf16_f32 v201, 0, v201
  v_cvt_pk_bf16_f32 v202, 0, v202
  v_cvt_pk_bf16_f32 v203, 0, v203
  v_pk_mul_f32 v[200:201], v[200:201], v[122:123] op_sel:[0,1]
  v_pk_mul_f32 v[202:203], v[202:203], v[122:123] op_sel:[0,1]
  v_cvt_pk_bf16_f32 v225, v200, 0
  v_cvt_pk_bf16_f32 v229, v201, 0
  v_cvt_pk_bf16_f32 v233, v202, 0
  v_cvt_pk_bf16_f32 v237, v203, 0
  v_mfma_f32_16x16x16_bf16 v[136:139], v[188:189], v[224:225], v[136:139]
  v_mfma_f32_16x16x16_bf16 v[136:139], v[190:191], v[228:229], v[136:139]
  v_mfma_f32_16x16x16_bf16 v[136:139], v[192:193], v[232:233], v[136:139]
  v_mfma_f32_16x16x16_bf16 v[136:139], v[194:195], v[236:237], v[136:139]
  s_waitcnt vmcnt(14)
  buffer_load_dwordx4 v[60:63], v93, s[12:15], s61 offen offset:2816 nt
  v_pk_fma_f32 v[204:205], v[88:89], s[92:93], v[122:123] op_sel_hi:[1,1,0] neg_lo:[0,0,1] neg_hi:[0,0,1]
  v_pk_fma_f32 v[206:207], v[90:91], s[92:93], v[122:123] op_sel_hi:[1,1,0] neg_lo:[0,0,1] neg_hi:[0,0,1]
  v_cvt_pk_bf16_f32 v204, 0, v204
  v_cvt_pk_bf16_f32 v205, 0, v205
  v_cvt_pk_bf16_f32 v206, 0, v206
  v_cvt_pk_bf16_f32 v207, 0, v207
  v_pk_mul_f32 v[204:205], v[204:205], v[122:123] op_sel:[0,1]
  v_pk_mul_f32 v[206:207], v[206:207], v[122:123] op_sel:[0,1]
  v_cvt_pk_bf16_f32 v241, v204, 0
  v_cvt_pk_bf16_f32 v245, v205, 0
  v_cvt_pk_bf16_f32 v249, v206, 0
  v_cvt_pk_bf16_f32 v253, v207, 0
  v_mfma_f32_16x16x16_bf16 v[140:143], v[188:189], v[240:241], v[140:143]
  v_mfma_f32_16x16x16_bf16 v[140:143], v[190:191], v[244:245], v[140:143]
  v_mfma_f32_16x16x16_bf16 v[140:143], v[192:193], v[248:249], v[140:143]
  v_mfma_f32_16x16x16_bf16 v[140:143], v[194:195], v[252:253], v[140:143]
  s_mov_b32 s60, s61
  s_cmp_ge_u32 s64, 96
  s_cbranch_scc1 L_v_done
  s_cmp_eq_u32 s89, s88
  s_cbranch_scc1 L_v0
  s_mov_b32 s88, s89
  v_mov_b32 v149, v147
  s_nop 1
  v_permlane32_swap_b32 v147, v149
  v_add_f32 v147, v147, v149
  v_mov_b32 v149, v147
  s_nop 1
  v_permlane16_swap_b32 v147, v149
  v_add_f32 v147, v147, v149
  ds_write_b64 v106, v[146:147]
  ds_write_b128 v105, v[132:135] offset:0
  ds_write_b128 v105, v[136:139] offset:1024
  ds_write_b128 v105, v[140:143] offset:2048
  s_and_b32 s70, s86, 15
  s_cmp_ge_u32 s70, 12
  s_cselect_b32 s70, 2, 0
  s_and_b32 s71, s87, 1
  s_bitcmp1_b32 s96, 6
  s_cselect_b32 s71, s4, s71
  s_add_u32 s70, s70, s71
  s_lshr_b32 s71, s86, 4
  s_lshl2_add_u32 s70, s71, s70
  s_add_u32 s71, s3, 0
  s_cmp_eq_u32 s100, s71
  s_cselect_b32 s44, s70, s44
  s_add_u32 s71, s3, 2
  s_cmp_eq_u32 s100, s71
  s_cselect_b32 s45, s70, s45
  s_add_u32 s100, s100, 1
  s_waitcnt lgkmcnt(0)
  v_add_u32 v105, 6208, v105
  v_add_u32 v106, 6208, v106
  v_mov_b32 v132, 0
  v_mov_b32 v133, 0
  v_mov_b32 v134, 0
  v_mov_b32 v135, 0
  v_mov_b32 v136, 0
  v_mov_b32 v137, 0
  v_mov_b32 v138, 0
  v_mov_b32 v139, 0
  v_mov_b32 v140, 0
  v_mov_b32 v141, 0
  v_mov_b32 v142, 0
  v_mov_b32 v143, 0
  v_mov_b32 v144, 0xff800000
  v_mov_b32 v146, 0x7f800000
  v_mov_b32 v147, 0
  s_branch L_v0
L_v_done:
  v_mov_b32 v149, v147
  s_nop 1
  v_permlane32_swap_b32 v147, v149
  v_add_f32 v147, v147, v149
  v_mov_b32 v149, v147
  s_nop 1
  v_permlane16_swap_b32 v147, v149
  v_add_f32 v147, v147, v149
  ds_write_b64 v106, v[146:147]
  ds_write_b128 v105, v[132:135] offset:0
  ds_write_b128 v105, v[136:139] offset:1024
  ds_write_b128 v105, v[140:143] offset:2048
  s_and_b32 s70, s86, 15
  s_cmp_ge_u32 s70, 12
  s_cselect_b32 s70, 2, 0
  s_and_b32 s71, s87, 1
  s_bitcmp1_b32 s96, 6
  s_cselect_b32 s71, s4, s71
  s_add_u32 s70, s70, s71
  s_lshr_b32 s71, s86, 4
  s_lshl2_add_u32 s70, s71, s70
  s_add_u32 s71, s3, 0
  s_cmp_eq_u32 s100, s71
  s_cselect_b32 s44, s70, s44
  s_add_u32 s71, s3, 2
  s_cmp_eq_u32 s100, s71
  s_cselect_b32 s45, s70, s45
  s_add_u32 s100, s100, 1
  s_waitcnt lgkmcnt(0)
  s_waitcnt vmcnt(0)
  s_barrier
  v_lshrrev_b32 v150, 1, v104
  v_lshlrev_b32 v151, 4, v0
  s_mul_i32 s70, s3, 6208
  s_add_u32 s70, s70, 36864
  v_add_u32 v148, s70, v150
  ds_read_b64 v[4:5], v148 offset:6144
  ds_read_b64 v[6:7], v148 offset:6176
  v_add_u32 v148, s70, v151
  ds_read_b128 v[172:175], v148 offset:0
  ds_read_b128 v[176:179], v148 offset:1024
  ds_read_b128 v[180:183], v148 offset:2048
  ds_read_b128 v[184:187], v148 offset:3072
  ds_read_b128 v[188:191], v148 offset:4096
  ds_read_b128 v[192:195], v148 offset:5120
  s_mul_i32 s70, s3, 6208
  s_add_u32 s70, s70, 49280
  v_add_u32 v148, s70, v150
  ds_read_b64 v[8:9], v148 offset:6144
  ds_read_b64 v[10:11], v148 offset:6176
  v_add_u32 v148, s70, v151
  ds_read_b128 v[196:199], v148 offset:0
  ds_read_b128 v[200:203], v148 offset:1024
  ds_read_b128 v[204:207], v148 offset:2048
  ds_read_b128 v[208:211], v148 offset:3072
  ds_read_b128 v[212:215], v148 offset:4096
  ds_read_b128 v[216:219], v148 offset:5120
  v_mov_b32 v148, 61708
  ds_read_b32 v144, v148
  s_mov_b32 s100, -1
  s_add_u32 s97, s4, 1
  s_waitcnt lgkmcnt(0)
  v_min_f32 v28, v4, v6
  v_sub_f32 v4, v28, v4
  v_sub_f32 v6, v28, v6
  v_exp_f32 v4, v4
  v_exp_f32 v6, v6
  v_mul_f32 v29, v4, v5
  v_fma_f32 v29, v6, v7, v29
  v_mul_f32 v12, v4, v172
  v_fma_f32 v12, v6, v184, v12
  v_mul_f32 v13, v4, v173
  v_fma_f32 v13, v6, v185, v13
  v_mul_f32 v14, v4, v174
  v_fma_f32 v14, v6, v186, v14
  v_mul_f32 v16, v4, v175
  v_fma_f32 v16, v6, v187, v16
  v_mul_f32 v17, v4, v176
  v_fma_f32 v17, v6, v188, v17
  v_mul_f32 v18, v4, v177
  v_fma_f32 v18, v6, v189, v18
  v_mul_f32 v20, v4, v178
  v_fma_f32 v20, v6, v190, v20
  v_mul_f32 v21, v4, v179
  v_fma_f32 v21, v6, v191, v21
  v_mul_f32 v22, v4, v180
  v_fma_f32 v22, v6, v192, v22
  v_mul_f32 v24, v4, v181
  v_fma_f32 v24, v6, v193, v24
  v_mul_f32 v25, v4, v182
  v_fma_f32 v25, v6, v194, v25
  v_mul_f32 v26, v4, v183
  v_fma_f32 v26, v6, v195, v26
  s_bfe_u32 s70, s44, 0x20001
  s_cmp_eq_u32 s70, s97
  s_cbranch_scc1 L_own0
  v_mov_b32 v15, v144
  v_mov_b32 v19, v144
  v_mov_b32 v23, v144
  v_mov_b32 v27, v144
  v_mov_b32 v31, v144
  s_mul_i32 s70, s44, 5120
  s_add_u32 s70, s70, 1048576
  s_add_u32 s71, s70, 4096
  buffer_store_dwordx4 v[12:15], v151, s[40:43], s70 offen offset:0 sc1
  buffer_store_dwordx4 v[16:19], v151, s[40:43], s70 offen offset:1024 sc1
  buffer_store_dwordx4 v[20:23], v151, s[40:43], s70 offen offset:2048 sc1
  buffer_store_dwordx4 v[24:27], v151, s[40:43], s70 offen offset:3072 sc1
  buffer_store_dwordx4 v[28:31], v151, s[40:43], s71 offen offset:0 sc1
  s_branch L_pub0
L_own0:
  v_mov_b32 v52, v12
  v_mov_b32 v53, v13
  v_mov_b32 v54, v14
  v_mov_b32 v56, v16
  v_mov_b32 v57, v17
  v_mov_b32 v58, v18
  v_mov_b32 v60, v20
  v_mov_b32 v61, v21
  v_mov_b32 v62, v22
  v_mov_b32 v64, v24
  v_mov_b32 v65, v25
  v_mov_b32 v66, v26
  v_mov_b32 v68, v28
  v_mov_b32 v69, v29
  s_mov_b32 s100, s44
L_pub0:
  v_min_f32 v48, v8, v10
  v_sub_f32 v8, v48, v8
  v_sub_f32 v10, v48, v10
  v_exp_f32 v8, v8
  v_exp_f32 v10, v10
  v_mul_f32 v49, v8, v9
  v_fma_f32 v49, v10, v11, v49
  v_mul_f32 v32, v8, v196
  v_fma_f32 v32, v10, v208, v32
  v_mul_f32 v33, v8, v197
  v_fma_f32 v33, v10, v209, v33
  v_mul_f32 v34, v8, v198
  v_fma_f32 v34, v10, v210, v34
  v_mul_f32 v36, v8, v199
  v_fma_f32 v36, v10, v211, v36
  v_mul_f32 v37, v8, v200
  v_fma_f32 v37, v10, v212, v37
  v_mul_f32 v38, v8, v201
  v_fma_f32 v38, v10, v213, v38
  v_mul_f32 v40, v8, v202
  v_fma_f32 v40, v10, v214, v40
  v_mul_f32 v41, v8, v203
  v_fma_f32 v41, v10, v215, v41
  v_mul_f32 v42, v8, v204
  v_fma_f32 v42, v10, v216, v42
  v_mul_f32 v44, v8, v205
  v_fma_f32 v44, v10, v217, v44
  v_mul_f32 v45, v8, v206
  v_fma_f32 v45, v10, v218, v45
  v_mul_f32 v46, v8, v207
  v_fma_f32 v46, v10, v219, v46
  s_bfe_u32 s70, s45, 0x20001
  s_cmp_eq_u32 s70, s97
  s_cbranch_scc1 L_own1
  v_mov_b32 v35, v144
  v_mov_b32 v39, v144
  v_mov_b32 v43, v144
  v_mov_b32 v47, v144
  v_mov_b32 v51, v144
  s_mul_i32 s70, s45, 5120
  s_add_u32 s70, s70, 1048576
  s_add_u32 s71, s70, 4096
  buffer_store_dwordx4 v[32:35], v151, s[40:43], s70 offen offset:0 sc1
  buffer_store_dwordx4 v[36:39], v151, s[40:43], s70 offen offset:1024 sc1
  buffer_store_dwordx4 v[40:43], v151, s[40:43], s70 offen offset:2048 sc1
  buffer_store_dwordx4 v[44:47], v151, s[40:43], s70 offen offset:3072 sc1
  buffer_store_dwordx4 v[48:51], v151, s[40:43], s71 offen offset:0 sc1
  s_branch L_pub1
L_own1:
  v_mov_b32 v52, v32
  v_mov_b32 v53, v33
  v_mov_b32 v54, v34
  v_mov_b32 v56, v36
  v_mov_b32 v57, v37
  v_mov_b32 v58, v38
  v_mov_b32 v60, v40
  v_mov_b32 v61, v41
  v_mov_b32 v62, v42
  v_mov_b32 v64, v44
  v_mov_b32 v65, v45
  v_mov_b32 v66, v46
  v_mov_b32 v68, v48
  v_mov_b32 v69, v49
  s_mov_b32 s100, s45
L_pub1:
  s_cmp_eq_u32 s100, -1
  s_cbranch_scc1 L_fin
  s_xor_b32 s84, s100, 1
  s_andn2_b32 s86, s100, 1
  s_xor_b32 s86, s86, 2
  s_add_u32 s88, s86, 1
  s_mul_i32 s84, s84, 5120
  s_add_u32 s84, s84, 1048576
  s_add_u32 s85, s84, 4096
  s_mul_i32 s86, s86, 5120
  s_add_u32 s86, s86, 1048576
  s_add_u32 s87, s86, 4096
  s_mul_i32 s88, s88, 5120
  s_add_u32 s88, s88, 1048576
  s_add_u32 s89, s88, 4096
  v_mov_b32 v149, s85
  v_writelane_b32 v149, s87, 1
  v_writelane_b32 v149, s89, 2
  s_mov_b32 s64, 0
L_gather:
  buffer_load_dwordx4 v[172:175], v151, s[40:43], s84 offen offset:0 sc1
  buffer_load_dwordx4 v[176:179], v151, s[40:43], s84 offen offset:1024 sc1
  buffer_load_dwordx4 v[180:183], v151, s[40:43], s84 offen offset:2048 sc1
  buffer_load_dwordx4 v[184:187], v151, s[40:43], s84 offen offset:3072 sc1
  buffer_load_dwordx4 v[188:191], v151, s[40:43], s85 offen offset:0 sc1
  buffer_load_dwordx4 v[192:195], v151, s[40:43], s86 offen offset:0 sc1
  buffer_load_dwordx4 v[196:199], v151, s[40:43], s86 offen offset:1024 sc1
  buffer_load_dwordx4 v[200:203], v151, s[40:43], s86 offen offset:2048 sc1
  buffer_load_dwordx4 v[204:207], v151, s[40:43], s86 offen offset:3072 sc1
  buffer_load_dwordx4 v[208:211], v151, s[40:43], s87 offen offset:0 sc1
  buffer_load_dwordx4 v[212:215], v151, s[40:43], s88 offen offset:0 sc1
  buffer_load_dwordx4 v[216:219], v151, s[40:43], s88 offen offset:1024 sc1
  buffer_load_dwordx4 v[220:223], v151, s[40:43], s88 offen offset:2048 sc1
  buffer_load_dwordx4 v[224:227], v151, s[40:43], s88 offen offset:3072 sc1
  buffer_load_dwordx4 v[228:231], v151, s[40:43], s89 offen offset:0 sc1
  s_waitcnt vmcnt(0)
  v_xor_b32 v148, v144, v175
  v_xor_b32 v179, v144, v179
  v_xor_b32 v183, v144, v183
  v_xor_b32 v187, v144, v187
  v_xor_b32 v191, v144, v191
  v_xor_b32 v195, v144, v195
  v_xor_b32 v199, v144, v199
  v_xor_b32 v203, v144, v203
  v_xor_b32 v207, v144, v207
  v_xor_b32 v211, v144, v211
  v_xor_b32 v215, v144, v215
  v_xor_b32 v219, v144, v219
  v_xor_b32 v223, v144, v223
  v_xor_b32 v227, v144, v227
  v_xor_b32 v231, v144, v231
  v_or3_b32 v148, v148, v179, v183
  v_or3_b32 v148, v148, v187, v191
  v_or3_b32 v148, v148, v195, v199
  v_or3_b32 v148, v148, v203, v207
  v_or3_b32 v148, v148, v211, v215
  v_or3_b32 v148, v148, v219, v223
  v_or3_b32 v148, v148, v227, v231
  v_cmp_ne_u32 s[70:71], 0, v148
  s_nop 1
  s_cmp_eq_u64 s[70:71], 0
  s_cbranch_scc1 L_gathered
L_poll:
  s_add_u32 s64, s64, 1
  s_cmp_gt_u32 s64, 20000
  s_cbranch_scc1 L_end
  s_branch L_gather
  buffer_load_dword v148, v149, s[40:43], 0 offen offset:1020 sc1
  s_waitcnt vmcnt(0)
  v_cmp_ne_u32 s[70:71], v144, v148
  s_nop 1
  s_cmp_lg_u64 s[70:71], 0
  s_cbranch_scc1 L_poll
  s_mov_b64 exec, -1
  s_branch L_gather
L_gathered:
  v_min_f32 v148, v68, v188
  v_min3_f32 v148, v148, v208, v228
  v_sub_f32 v68, v148, v68
  v_sub_f32 v188, v148, v188
  v_sub_f32 v208, v148, v208
  v_sub_f32 v228, v148, v228
  v_exp_f32 v68, v68
  v_exp_f32 v188, v188
  v_exp_f32 v208, v208
  v_exp_f32 v228, v228
  v_mul_f32 v69, v68, v69
  v_mul_f32 v189, v188, v189
  v_mul_f32 v209, v208, v209
  v_mul_f32 v229, v228, v229
  v_add_f32 v69, v69, v189
  v_add_f32 v209, v209, v229
  v_add_f32 v69, v69, v209
  v_rcp_f32 v149, v69
  v_mul_f32 v52, v68, v52
  v_mul_f32 v172, v188, v172
  v_mul_f32 v192, v208, v192
  v_mul_f32 v212, v228, v212
  v_add_f32 v52, v52, v172
  v_add_f32 v192, v192, v212
  v_add_f32 v52, v52, v192
  v_mul_f32 v53, v68, v53
  v_mul_f32 v173, v188, v173
  v_mul_f32 v193, v208, v193
  v_mul_f32 v213, v228, v213
  v_add_f32 v53, v53, v173
  v_add_f32 v193, v193, v213
  v_add_f32 v53, v53, v193
  v_mul_f32 v54, v68, v54
  v_mul_f32 v174, v188, v174
  v_mul_f32 v194, v208, v194
  v_mul_f32 v214, v228, v214
  v_add_f32 v54, v54, v174
  v_add_f32 v194, v194, v214
  v_add_f32 v54, v54, v194
  v_mul_f32 v56, v68, v56
  v_mul_f32 v176, v188, v176
  v_mul_f32 v196, v208, v196
  v_mul_f32 v216, v228, v216
  v_add_f32 v56, v56, v176
  v_add_f32 v196, v196, v216
  v_add_f32 v56, v56, v196
  v_mul_f32 v57, v68, v57
  v_mul_f32 v177, v188, v177
  v_mul_f32 v197, v208, v197
  v_mul_f32 v217, v228, v217
  v_add_f32 v57, v57, v177
  v_add_f32 v197, v197, v217
  v_add_f32 v57, v57, v197
  v_mul_f32 v58, v68, v58
  v_mul_f32 v178, v188, v178
  v_mul_f32 v198, v208, v198
  v_mul_f32 v218, v228, v218
  v_add_f32 v58, v58, v178
  v_add_f32 v198, v198, v218
  v_add_f32 v58, v58, v198
  v_mul_f32 v60, v68, v60
  v_mul_f32 v180, v188, v180
  v_mul_f32 v200, v208, v200
  v_mul_f32 v220, v228, v220
  v_add_f32 v60, v60, v180
  v_add_f32 v200, v200, v220
  v_add_f32 v60, v60, v200
  v_mul_f32 v61, v68, v61
  v_mul_f32 v181, v188, v181
  v_mul_f32 v201, v208, v201
  v_mul_f32 v221, v228, v221
  v_add_f32 v61, v61, v181
  v_add_f32 v201, v201, v221
  v_add_f32 v61, v61, v201
  v_mul_f32 v62, v68, v62
  v_mul_f32 v182, v188, v182
  v_mul_f32 v202, v208, v202
  v_mul_f32 v222, v228, v222
  v_add_f32 v62, v62, v182
  v_add_f32 v202, v202, v222
  v_add_f32 v62, v62, v202
  v_mul_f32 v64, v68, v64
  v_mul_f32 v184, v188, v184
  v_mul_f32 v204, v208, v204
  v_mul_f32 v224, v228, v224
  v_add_f32 v64, v64, v184
  v_add_f32 v204, v204, v224
  v_add_f32 v64, v64, v204
  v_mul_f32 v65, v68, v65
  v_mul_f32 v185, v188, v185
  v_mul_f32 v205, v208, v205
  v_mul_f32 v225, v228, v225
  v_add_f32 v65, v65, v185
  v_add_f32 v205, v205, v225
  v_add_f32 v65, v65, v205
  v_mul_f32 v66, v68, v66
  v_mul_f32 v186, v188, v186
  v_mul_f32 v206, v208, v206
  v_mul_f32 v226, v228, v226
  v_add_f32 v66, v66, v186
  v_add_f32 v206, v206, v226
  v_add_f32 v66, v66, v206
  v_mul_f32 v52, v149, v52
  v_mul_f32 v53, v149, v53
  v_mul_f32 v54, v149, v54
  v_mul_f32 v56, v149, v56
  v_mul_f32 v57, v149, v57
  v_mul_f32 v58, v149, v58
  v_mul_f32 v60, v149, v60
  v_mul_f32 v61, v149, v61
  v_mul_f32 v62, v149, v62
  v_mul_f32 v64, v149, v64
  v_mul_f32 v65, v149, v65
  v_mul_f32 v66, v149, v66
  v_mul_u32_u24 v148, 24, v104
  v_and_b32 v149, 15, v0
  v_lshl_add_u32 v148, v149, 3, v148
  s_lshr_b32 s70, s100, 2
  s_mul_i32 s70, s70, 1536
  v_cvt_pk_bf16_f32 v132, v52, v53
  v_cvt_pk_bf16_f32 v133, v54, v56
  buffer_store_dwordx2 v[132:133], v148, s[36:39], s70 offen offset:0
  v_cvt_pk_bf16_f32 v134, v57, v58
  v_cvt_pk_bf16_f32 v135, v60, v61
  buffer_store_dwordx2 v[134:135], v148, s[36:39], s70 offen offset:128
  v_cvt_pk_bf16_f32 v136, v62, v64
  v_cvt_pk_bf16_f32 v137, v65, v66
  buffer_store_dwordx2 v[136:137], v148, s[36:39], s70 offen offset:256
L_fin:
L_end:
  s_endpgm
L_helper:
  v_lshlrev_b32 v1, 2, v0
  v_add_u32 v1, 61696, v1
  v_mov_b32 v2, 0
  s_mov_b64 exec, 0xffff
  ds_write_b32 v1, v2
  s_mov_b64 exec, -1
  s_waitcnt lgkmcnt(0)
  s_mov_b32 s20, s50
  s_and_b32 s21, s51, 0xffff
  s_mov_b32 s24, s52
  s_and_b32 s25, s53, 0xffff
  s_mov_b32 s28, s54
  s_and_b32 s29, s55, 0xffff
  s_mov_b32 s32, s56
  s_and_b32 s33, s57, 0xffff
  s_mov_b32 s8, s46
  s_and_b32 s9, s47, 0xffff
  s_mov_b32 s36, s44
  s_and_b32 s37, s45, 0xffff
  s_mov_b32 s16, s46
  s_and_b32 s17, s47, 0xffff
  s_mov_b32 s12, s48
  s_and_b32 s13, s49, 0xffff
  s_mov_b32 s40, s82
  s_and_b32 s41, s83, 0xffff
  s_barrier
  s_memrealtime s[72:73]
  s_getpc_b64 s[54:55]
L_h_pc:
  s_sub_u32 s54, s54, L_h_pc - L_k
  s_subb_u32 s55, s55, 0
  s_and_b32 s54, s54, -16
  s_lshr_b32 s70, s2, 3
  s_lshl_b32 s70, s70, 10
  v_lshl_add_u32 v106, v0, 4, s70
  v_mov_b32 v107, s55
  v_add_co_u32 v106, vcc, s54, v106
  s_nop 1
  v_addc_co_u32 v107, vcc, 0, v107, vcc
  s_lshr_b32 s70, s2, 3
  s_cmp_lt_i32 s70, (L_code_end - L_k) / 1024 - 0
  s_cbranch_scc0 L_h_cta
  global_load_dwordx4 v[110:113], v[106:107], off
  s_lshr_b32 s70, s2, 3
  s_cmp_lt_i32 s70, (L_code_end - L_k) / 1024 - 32
  s_cbranch_scc0 L_h_cta
  v_add_co_u32 v108, vcc, 0x8000, v106
  s_nop 1
  v_addc_co_u32 v109, vcc, 0, v107, vcc
  global_load_dwordx4 v[110:113], v[108:109], off
L_h_cta:
  s_lshr_b32 s70, s2, 4
  s_and_b32 s70, s70, 8
  s_and_b32 s71, s2, 7
  s_add_u32 s70, s70, s71
  s_lshl_b32 s70, s70, 4
  v_lshl_add_u32 v104, v0, 3, s70
  v_and_b32 v105, 31, v0
  v_lshlrev_b32 v105, 3, v105
  v_and_b32 v115, 1, v0
  v_lshlrev_b32 v115, 2, v115
  v_add_u32 v115, 61712, v115
  v_mov_b32 v116, 0
  v_mov_b32 v117, 0
  s_getreg_b32 s50, hwreg(HW_REG_XCC_ID)
  s_bfe_u32 s50, s50, 0x10002
  s_bfe_u32 s52, s2, 0x30003
  s_cmp_eq_u32 s52, 7
  s_cbranch_scc1 L_h_voted
  s_lshr_b32 s70, s2, 6
  s_xor_b32 s70, s70, s2
  s_and_b32 s70, s70, 3
  s_cbranch_scc1 L_h_voted
  s_cmp_eq_u32 s52, 6
  s_cbranch_scc0 L_h_probe
  s_xor_b32 s48, s50, s4
  s_and_b32 s52, s2, 3
  s_lshl2_add_u32 s52, s52, 36
  s_branch L_h_vote
L_h_probe:
  s_cmp_ge_u32 s52, 3
  s_cselect_b32 s16, s12, s8
  s_cselect_b32 s17, s13, s9
  s_cselect_b32 s70, 3, 0
  s_sub_u32 s70, s52, s70
  s_lshl_b32 s70, s70, 28
  s_lshl_b32 s44, s5, 16
  s_add_u32 s44, s44, s70
  s_lshl_b32 s70, s4, 16
  s_add_u32 s44, s44, s70
  s_add_u32 s44, s44, 0x1c0000
  s_mul_i32 s70, s2, 0x2a95
  s_and_b32 s70, s70, 0x7f80
  s_add_u32 s44, s44, s70
  s_add_u32 s70, s44, 0x8000
  s_buffer_load_dword s58, s[16:19], s70
  s_mov_b32 s45, -1
  s_mov_b32 s46, -1
  s_mul_i32 s52, s52, 6
  s_waitcnt lgkmcnt(0)
  v_mov_b32 v1, 61712
L_h_progp:
  s_sleep 2
  ds_read_b128 v[8:11], v1
  s_waitcnt lgkmcnt(0)
  v_min_u32 v8, v8, v9
  s_nop 0
  v_readfirstlane_b32 s54, v8
  s_nop 1
  s_cmp_lt_u32 s54, 1
  s_cbranch_scc1 L_h_progp
  s_xor_b32 s70, s44, 0
  s_memtime s[54:55]
  s_waitcnt lgkmcnt(0)
  s_buffer_load_dword s58, s[16:19], s70
  s_waitcnt lgkmcnt(0)
  s_memtime s[56:57]
  s_waitcnt lgkmcnt(0)
  s_sub_u32 s56, s56, s54
  s_min_u32 s45, s45, s56
  s_xor_b32 s70, s44, 8192
  s_memtime s[54:55]
  s_waitcnt lgkmcnt(0)
  s_buffer_load_dword s58, s[16:19], s70
  s_waitcnt lgkmcnt(0)
  s_memtime s[56:57]
  s_waitcnt lgkmcnt(0)
  s_sub_u32 s56, s56, s54
  s_min_u32 s46, s46, s56
  s_xor_b32 s70, s44, 25472
  s_memtime s[54:55]
  s_waitcnt lgkmcnt(0)
  s_buffer_load_dword s58, s[16:19], s70
  s_waitcnt lgkmcnt(0)
  s_memtime s[56:57]
  s_waitcnt lgkmcnt(0)
  s_sub_u32 s56, s56, s54
  s_min_u32 s46, s46, s56
  s_xor_b32 s70, s44, 17280
  s_memtime s[54:55]
  s_waitcnt lgkmcnt(0)
  s_buffer_load_dword s58, s[16:19], s70
  s_waitcnt lgkmcnt(0)
  s_memtime s[56:57]
  s_waitcnt lgkmcnt(0)
  s_sub_u32 s56, s56, s54
  s_min_u32 s45, s45, s56
  s_xor_b32 s70, s44, 5888
  s_memtime s[54:55]
  s_waitcnt lgkmcnt(0)
  s_buffer_load_dword s58, s[16:19], s70
  s_waitcnt lgkmcnt(0)
  s_memtime s[56:57]
  s_waitcnt lgkmcnt(0)
  s_sub_u32 s56, s56, s54
  s_min_u32 s45, s45, s56
  s_xor_b32 s70, s44, 14080
  s_memtime s[54:55]
  s_waitcnt lgkmcnt(0)
  s_buffer_load_dword s58, s[16:19], s70
  s_waitcnt lgkmcnt(0)
  s_memtime s[56:57]
  s_waitcnt lgkmcnt(0)
  s_sub_u32 s56, s56, s54
  s_min_u32 s46, s46, s56
  s_cmp_lt_u32 s46, s45
  s_cselect_b32 s48, 1, 0
  s_lshr_b32 s70, s44, 13
  s_xor_b32 s70, s70, s2
  s_xor_b32 s70, s70, s50
  s_and_b32 s70, s70, 1
  s_xor_b32 s48, s48, s70
L_h_vote:
  s_mov_b32 s49, 0
  s_lshl_b64 s[48:49], s[48:49], s52
  s_or_b32 s49, s49, 0x1000000
  s_atomic_add_x2 s[48:49], s[80:81], 0
L_h_voted:
  s_waitcnt lgkmcnt(0)
  s_cmp_lg_u32 s2, 56
  s_cbranch_scc1 L_h_nonce
  s_lshl_b64 s[54:55], s[72:73], 2
  s_atomic_add_x2 s[54:55], s[80:81], 8
  s_waitcnt lgkmcnt(0)
L_h_nonce:
  s_mov_b32 s76, 12
  s_mov_b32 s77, 7340032
  s_getpc_b64 s[86:87]
L_h_pc2:
  s_add_u32 s86, s86, L_h_cp - L_h_pc2
  s_addc_u32 s87, s87, 0
  v_mov_b32 v1, 61712
L_h_progv:
  s_sleep 8
  ds_read_b128 v[8:11], v1
  s_waitcnt lgkmcnt(0)
  v_min_u32 v8, v8, v9
  s_nop 0
  v_readfirstlane_b32 s54, v8
  s_nop 1
  s_cmp_lt_u32 s54, 6
  s_cbranch_scc1 L_h_progv
  s_load_dwordx2 s[48:49], s[80:81], 0
  s_mov_b32 s59, 0
L_h_votes:
  s_waitcnt lgkmcnt(0)
  s_lshr_b32 s70, s49, 24
  s_cmp_eq_u32 s70, 56
  s_cbranch_scc1 L_h_votes_done
  s_add_u32 s59, s59, 1
  s_cmp_gt_u32 s59, 2000
  s_cbranch_scc1 L_h_votes_done
  s_sleep 64
  s_mov_b64 s[48:49], 0
  s_atomic_or_x2 s[48:49], s[80:81], 0 glc
  s_branch L_h_votes
L_h_votes_done:
  s_mov_b32 s96, 0x80
  s_bfe_u64 s[54:55], s[48:49], 0x60000
  s_cmp_gt_u32 s54, 4
  s_cselect_b32 s56, 1, 0
  s_or_b32 s96, s96, s56
  s_sub_u32 s54, s54, 3
  s_cmp_lt_u32 s54, 3
  s_cselect_b32 s56, 64, 0
  s_or_b32 s96, s96, s56
  s_bfe_u64 s[54:55], s[48:49], 0x60006
  s_cmp_gt_u32 s54, 4
  s_cselect_b32 s56, 2, 0
  s_or_b32 s96, s96, s56
  s_sub_u32 s54, s54, 3
  s_cmp_lt_u32 s54, 3
  s_cselect_b32 s56, 64, 0
  s_or_b32 s96, s96, s56
  s_bfe_u64 s[54:55], s[48:49], 0x6000c
  s_cmp_gt_u32 s54, 4
  s_cselect_b32 s56, 4, 0
  s_or_b32 s96, s96, s56
  s_sub_u32 s54, s54, 3
  s_cmp_lt_u32 s54, 3
  s_cselect_b32 s56, 64, 0
  s_or_b32 s96, s96, s56
  s_bfe_u64 s[54:55], s[48:49], 0x60012
  s_cmp_gt_u32 s54, 4
  s_cselect_b32 s56, 8, 0
  s_or_b32 s96, s96, s56
  s_sub_u32 s54, s54, 3
  s_cmp_lt_u32 s54, 3
  s_cselect_b32 s56, 64, 0
  s_or_b32 s96, s96, s56
  s_bfe_u64 s[54:55], s[48:49], 0x60018
  s_cmp_gt_u32 s54, 4
  s_cselect_b32 s56, 16, 0
  s_or_b32 s96, s96, s56
  s_sub_u32 s54, s54, 3
  s_cmp_lt_u32 s54, 3
  s_cselect_b32 s56, 64, 0
  s_or_b32 s96, s96, s56
  s_bfe_u64 s[54:55], s[48:49], 0x6001e
  s_cmp_gt_u32 s54, 4
  s_cselect_b32 s56, 32, 0
  s_or_b32 s96, s96, s56
  s_sub_u32 s54, s54, 3
  s_cmp_lt_u32 s54, 3
  s_cselect_b32 s56, 64, 0
  s_or_b32 s96, s96, s56
  s_and_b32 s70, s2, 3
  s_lshl2_add_u32 s70, s70, 4
  s_lshr_b32 s54, s49, s70
  s_and_b32 s56, s54, 1
  s_cselect_b32 s56, 64, 0
  s_or_b32 s96, s96, s56
  s_lshr_b32 s54, s54, 1
  s_xor_b32 s54, s54, s2
  s_xor_b32 s54, s54, s4
  s_and_b32 s54, s54, 1
  s_mul_i32 s54, s54, 63
  s_xor_b32 s96, s96, s54
  v_mov_b32 v1, 61696
  v_mov_b32 v8, s96
  ds_write_b32 v1, v8
  v_lshlrev_b32 v3, 4, v0
  s_load_dwordx2 s[74:75], s[80:81], 8
L_h_getnonce:
  s_waitcnt lgkmcnt(0)
  s_cmp_lg_u64 s[74:75], 0
  s_cbranch_scc1 L_h_gotnonce
  s_sleep 32
  s_atomic_or_x2 s[74:75], s[80:81], 8 glc
  s_branch L_h_getnonce
L_h_gotnonce:
  s_lshr_b64 s[54:55], s[74:75], 2
  v_mov_b32 v1, 61708
  v_mov_b32 v8, s54
  ds_write_b32 v1, v8
  s_mov_b32 s78, 60
  s_swappc_b64 s[84:85], s[86:87]
  s_bitcmp1_b32 s96, 6
  s_cbranch_scc1 L_h_skipa0
  s_lshl_b32 s62, s2, 8
  s_add_u32 s62, s62, 7405568
  s_xor_b32 s63, s62, 1024
  s_lshr_b32 s58, s96, 3
  s_xor_b32 s58, s58, s96
  s_lshr_b32 s70, s5, 4
  s_lshr_b32 s44, s70, 5
  s_lshl_b32 s44, s44, 21
  s_add_u32 s44, s44, 8388608
  s_and_b32 s64, s70, 31
  s_add_u32 s70, s64, s4
  s_lshl_b32 s70, s70, 10
  s_add_u32 s60, s44, s70
  s_xor_b32 s61, s60, 1024
  v_mov_b32 v1, 61712
L_h_proga:
  s_sleep 8
  ds_read_b128 v[8:11], v1
  s_waitcnt lgkmcnt(0)
  v_min_u32 v8, v8, v9
  s_nop 0
  v_readfirstlane_b32 s54, v8
  s_nop 1
  s_cmp_lt_u32 s54, 64
  s_cbranch_scc1 L_h_proga
  ds_read_b128 v[8:11], v3 offset:0
  ds_read_b128 v[12:15], v3 offset:1024
  ds_read_b128 v[16:19], v3 offset:2048
  s_waitcnt lgkmcnt(0)
  s_xor_b32 s70, s60, 0
  buffer_store_dwordx4 v[8:11], v3, s[40:43], s70 offen sc1
  s_xor_b32 s70, s60, 32768
  buffer_store_dwordx4 v[12:15], v3, s[40:43], s70 offen sc1
  s_xor_b32 s70, s60, 65536
  buffer_store_dwordx4 v[16:19], v3, s[40:43], s70 offen sc1
  s_bitcmp0_b32 s58, 0
  s_cbranch_scc1 L_h_e0
  ds_read_b128 v[20:23], v3 offset:3072
  ds_read_b128 v[24:27], v3 offset:4096
  ds_read_b128 v[28:31], v3 offset:5120
  ds_read_b128 v[32:35], v3 offset:6144
  ds_read_b128 v[36:39], v3 offset:7168
  ds_read_b128 v[40:43], v3 offset:8192
  ds_read_b128 v[44:47], v3 offset:9216
  ds_read_b128 v[48:51], v3 offset:10240
  ds_read_b128 v[52:55], v3 offset:11264
  s_waitcnt lgkmcnt(0)
  s_xor_b32 s70, s60, 98304
  buffer_store_dwordx4 v[20:23], v3, s[40:43], s70 offen sc1
  s_xor_b32 s70, s60, 132096
  buffer_store_dwordx4 v[24:27], v3, s[40:43], s70 offen sc1
  s_xor_b32 s70, s60, 164864
  buffer_store_dwordx4 v[28:31], v3, s[40:43], s70 offen sc1
  s_xor_b32 s70, s60, 197632
  buffer_store_dwordx4 v[32:35], v3, s[40:43], s70 offen sc1
  s_xor_b32 s70, s60, 230400
  buffer_store_dwordx4 v[36:39], v3, s[40:43], s70 offen sc1
  s_xor_b32 s70, s60, 264192
  buffer_store_dwordx4 v[40:43], v3, s[40:43], s70 offen sc1
  s_xor_b32 s70, s60, 296960
  buffer_store_dwordx4 v[44:47], v3, s[40:43], s70 offen sc1
  s_xor_b32 s70, s60, 329728
  buffer_store_dwordx4 v[48:51], v3, s[40:43], s70 offen sc1
  s_xor_b32 s70, s60, 362496
  buffer_store_dwordx4 v[52:55], v3, s[40:43], s70 offen sc1
L_h_e0:
  s_bitcmp0_b32 s58, 1
  s_cbranch_scc1 L_h_e1
  ds_read_b128 v[56:59], v3 offset:12288
  ds_read_b128 v[60:63], v3 offset:13312
  ds_read_b128 v[64:67], v3 offset:14336
  ds_read_b128 v[68:71], v3 offset:15360
  ds_read_b128 v[72:75], v3 offset:16384
  ds_read_b128 v[76:79], v3 offset:17408
  ds_read_b128 v[80:83], v3 offset:18432
  ds_read_b128 v[84:87], v3 offset:19456
  ds_read_b128 v[88:91], v3 offset:20480
  ds_read_b128 v[92:95], v3 offset:21504
  ds_read_b128 v[96:99], v3 offset:22528
  ds_read_b128 v[100:103], v3 offset:23552
  s_waitcnt lgkmcnt(0)
  s_xor_b32 s70, s60, 396288
  buffer_store_dwordx4 v[56:59], v3, s[40:43], s70 offen sc1
  s_xor_b32 s70, s60, 429056
  buffer_store_dwordx4 v[60:63], v3, s[40:43], s70 offen sc1
  s_xor_b32 s70, s60, 461824
  buffer_store_dwordx4 v[64:67], v3, s[40:43], s70 offen sc1
  s_xor_b32 s70, s60, 494592
  buffer_store_dwordx4 v[68:71], v3, s[40:43], s70 offen sc1
  s_xor_b32 s70, s60, 541696
  buffer_store_dwordx4 v[72:75], v3, s[40:43], s70 offen sc1
  s_xor_b32 s70, s60, 574464
  buffer_store_dwordx4 v[76:79], v3, s[40:43], s70 offen sc1
  s_xor_b32 s70, s60, 607232
  buffer_store_dwordx4 v[80:83], v3, s[40:43], s70 offen sc1
  s_xor_b32 s70, s60, 640000
  buffer_store_dwordx4 v[84:87], v3, s[40:43], s70 offen sc1
  s_xor_b32 s70, s60, 671744
  buffer_store_dwordx4 v[88:91], v3, s[40:43], s70 offen sc1
  s_xor_b32 s70, s60, 704512
  buffer_store_dwordx4 v[92:95], v3, s[40:43], s70 offen sc1
  s_xor_b32 s70, s60, 737280
  buffer_store_dwordx4 v[96:99], v3, s[40:43], s70 offen sc1
  s_xor_b32 s70, s60, 770048
  buffer_store_dwordx4 v[100:103], v3, s[40:43], s70 offen sc1
L_h_e1:
  s_add_u32 s54, s74, 1
  v_mov_b32 v5, 0
  s_waitcnt vmcnt(0)
  v_mov_b32 v8, s54
  v_mov_b32 v9, s75
  s_mov_b64 exec, 1
  buffer_store_dwordx2 v[8:9], v5, s[40:43], s62 offen sc1
  s_mov_b64 exec, -1
L_h_skipa0:
  s_mov_b32 s78, 60
  s_swappc_b64 s[84:85], s[86:87]
  s_bitcmp1_b32 s96, 6
  s_cbranch_scc1 L_h_skipa
  s_add_u32 s54, s74, 1
  v_mov_b32 v5, 0
  s_mov_b64 exec, 1
  s_mov_b32 s59, 0
L_h_flaga:
  buffer_load_dwordx2 v[10:11], v5, s[40:43], s63 offen sc1
  s_waitcnt vmcnt(0)
  v_readfirstlane_b32 s56, v10
  v_readfirstlane_b32 s57, v11
  s_nop 0
  s_sub_u32 s56, s56, s54
  s_xor_b32 s57, s57, s75
  s_lshr_b32 s56, s56, 1
  s_or_b32 s56, s56, s57
  s_cbranch_scc0 L_h_flaga_done
  s_add_u32 s59, s59, 1
  s_cmp_gt_u32 s59, 2000
  s_cbranch_scc1 L_h_flaga_done
  s_sleep 32
  s_branch L_h_flaga
L_h_flaga_done:
  s_mov_b64 exec, -1
  s_bfe_u32 s54, s96, 0x10003
  s_mul_i32 s54, s54, 384
  v_lshrrev_b32 v4, 3, v0
  v_add_u32 v5, 0, v4
  v_mul_u32_u24 v5, 21846, v5
  v_bfe_u32 v5, v5, 16, 1
  v_mul_u32_u24 v6, 384, v5
  v_sub_u32 v6, v3, v6
  v_add_u32 v6, s54, v6
  v_add_u32 v6, 0, v6
  v_add_u32 v5, s64, v5
  v_lshrrev_b32 v2, 12, v6
  v_xor_b32 v5, v5, v2
  v_lshrrev_b32 v2, 10, v6
  v_lshl_add_u32 v5, v2, 5, v5
  v_and_b32 v6, 1023, v6
  v_lshl_add_u32 v5, v5, 10, v6
  buffer_load_dwordx4 v[8:11], v5, s[40:43], s44 offen sc1
  v_add_u32 v5, 8, v4
  v_mul_u32_u24 v5, 21846, v5
  v_bfe_u32 v5, v5, 16, 1
  v_mul_u32_u24 v6, 384, v5
  v_sub_u32 v6, v3, v6
  v_add_u32 v6, s54, v6
  v_add_u32 v6, 1024, v6
  v_add_u32 v5, s64, v5
  v_lshrrev_b32 v2, 12, v6
  v_xor_b32 v5, v5, v2
  v_lshrrev_b32 v2, 10, v6
  v_lshl_add_u32 v5, v2, 5, v5
  v_and_b32 v6, 1023, v6
  v_lshl_add_u32 v5, v5, 10, v6
  buffer_load_dwordx4 v[12:15], v5, s[40:43], s44 offen sc1
  v_add_u32 v5, 16, v4
  v_mul_u32_u24 v5, 21846, v5
  v_bfe_u32 v5, v5, 16, 1
  v_mul_u32_u24 v6, 384, v5
  v_sub_u32 v6, v3, v6
  v_add_u32 v6, s54, v6
  v_add_u32 v6, 2048, v6
  v_add_u32 v5, s64, v5
  v_lshrrev_b32 v2, 12, v6
  v_xor_b32 v5, v5, v2
  v_lshrrev_b32 v2, 10, v6
  v_lshl_add_u32 v5, v2, 5, v5
  v_and_b32 v6, 1023, v6
  v_lshl_add_u32 v5, v5, 10, v6
  buffer_load_dwordx4 v[16:19], v5, s[40:43], s44 offen sc1
  s_waitcnt vmcnt(0)
  ds_write_b128 v3, v[8:11] offset:0
  ds_write_b128 v3, v[12:15] offset:1024
  ds_write_b128 v3, v[16:19] offset:2048
  s_bitcmp0_b32 s58, 0
  s_cbranch_scc1 L_h_i0
  s_xor_b32 s70, s61, 98304
  buffer_load_dwordx4 v[20:23], v3, s[40:43], s70 offen sc1
  s_xor_b32 s70, s61, 132096
  buffer_load_dwordx4 v[24:27], v3, s[40:43], s70 offen sc1
  s_xor_b32 s70, s61, 164864
  buffer_load_dwordx4 v[28:31], v3, s[40:43], s70 offen sc1
  s_xor_b32 s70, s61, 197632
  buffer_load_dwordx4 v[32:35], v3, s[40:43], s70 offen sc1
  s_xor_b32 s70, s61, 230400
  buffer_load_dwordx4 v[36:39], v3, s[40:43], s70 offen sc1
  s_xor_b32 s70, s61, 264192
  buffer_load_dwordx4 v[40:43], v3, s[40:43], s70 offen sc1
  s_xor_b32 s70, s61, 296960
  buffer_load_dwordx4 v[44:47], v3, s[40:43], s70 offen sc1
  s_xor_b32 s70, s61, 329728
  buffer_load_dwordx4 v[48:51], v3, s[40:43], s70 offen sc1
  s_xor_b32 s70, s61, 362496
  buffer_load_dwordx4 v[52:55], v3, s[40:43], s70 offen sc1
  s_waitcnt vmcnt(0)
  ds_write_b128 v3, v[20:23] offset:3072
  ds_write_b128 v3, v[24:27] offset:4096
  ds_write_b128 v3, v[28:31] offset:5120
  ds_write_b128 v3, v[32:35] offset:6144
  ds_write_b128 v3, v[36:39] offset:7168
  ds_write_b128 v3, v[40:43] offset:8192
  ds_write_b128 v3, v[44:47] offset:9216
  ds_write_b128 v3, v[48:51] offset:10240
  ds_write_b128 v3, v[52:55] offset:11264
L_h_i0:
  s_bitcmp0_b32 s58, 1
  s_cbranch_scc1 L_h_i1
  s_xor_b32 s70, s61, 396288
  buffer_load_dwordx4 v[56:59], v3, s[40:43], s70 offen sc1
  s_xor_b32 s70, s61, 429056
  buffer_load_dwordx4 v[60:63], v3, s[40:43], s70 offen sc1
  s_xor_b32 s70, s61, 461824
  buffer_load_dwordx4 v[64:67], v3, s[40:43], s70 offen sc1
  s_xor_b32 s70, s61, 494592
  buffer_load_dwordx4 v[68:71], v3, s[40:43], s70 offen sc1
  s_xor_b32 s70, s61, 541696
  buffer_load_dwordx4 v[72:75], v3, s[40:43], s70 offen sc1
  s_xor_b32 s70, s61, 574464
  buffer_load_dwordx4 v[76:79], v3, s[40:43], s70 offen sc1
  s_xor_b32 s70, s61, 607232
  buffer_load_dwordx4 v[80:83], v3, s[40:43], s70 offen sc1
  s_xor_b32 s70, s61, 640000
  buffer_load_dwordx4 v[84:87], v3, s[40:43], s70 offen sc1
  s_xor_b32 s70, s61, 671744
  buffer_load_dwordx4 v[88:91], v3, s[40:43], s70 offen sc1
  s_xor_b32 s70, s61, 704512
  buffer_load_dwordx4 v[92:95], v3, s[40:43], s70 offen sc1
  s_xor_b32 s70, s61, 737280
  buffer_load_dwordx4 v[96:99], v3, s[40:43], s70 offen sc1
  s_xor_b32 s70, s61, 770048
  buffer_load_dwordx4 v[100:103], v3, s[40:43], s70 offen sc1
  s_waitcnt vmcnt(0)
  ds_write_b128 v3, v[56:59] offset:12288
  ds_write_b128 v3, v[60:63] offset:13312
  ds_write_b128 v3, v[64:67] offset:14336
  ds_write_b128 v3, v[68:71] offset:15360
  ds_write_b128 v3, v[72:75] offset:16384
  ds_write_b128 v3, v[76:79] offset:17408
  ds_write_b128 v3, v[80:83] offset:18432
  ds_write_b128 v3, v[84:87] offset:19456
  ds_write_b128 v3, v[88:91] offset:20480
  ds_write_b128 v3, v[92:95] offset:21504
  ds_write_b128 v3, v[96:99] offset:22528
  ds_write_b128 v3, v[100:103] offset:23552
L_h_i1:
L_h_skipa:
  s_lshr_b32 s70, s96, 4
  s_andn2_b32 s58, s58, s70
  s_bitcmp0_b32 s58, 2
  s_cselect_b32 s70, 255, 64
  v_mov_b32 v1, 61700
  v_mov_b32 v5, s70
  ds_write_b32 v1, v5
  s_mov_b32 s78, 92
  s_swappc_b64 s[84:85], s[86:87]
  s_lshr_b32 s70, s2, 3
  s_cmp_lt_i32 s70, (L_code_end - L_k) / 1024 - 0
  s_cbranch_scc0 L_h_ctb
  global_load_dwordx4 v[110:113], v[106:107], off
  s_lshr_b32 s70, s2, 3
  s_cmp_lt_i32 s70, (L_code_end - L_k) / 1024 - 32
  s_cbranch_scc0 L_h_ctb
  v_add_co_u32 v108, vcc, 0x8000, v106
  s_nop 1
  v_addc_co_u32 v109, vcc, 0, v107, vcc
  global_load_dwordx4 v[110:113], v[108:109], off
L_h_ctb:
  s_bitcmp0_b32 s58, 2
  s_cbranch_scc1 L_h_skipb0
  v_mov_b32 v1, 61712
L_h_progb:
  s_sleep 8
  ds_read_b128 v[8:11], v1
  s_waitcnt lgkmcnt(0)
  v_min_u32 v8, v8, v9
  s_nop 0
  v_readfirstlane_b32 s54, v8
  s_nop 1
  s_cmp_lt_u32 s54, 96
  s_cbranch_scc1 L_h_progb
  ds_read_b128 v[8:11], v3 offset:24576
  ds_read_b128 v[12:15], v3 offset:25600
  ds_read_b128 v[16:19], v3 offset:26624
  ds_read_b128 v[20:23], v3 offset:27648
  ds_read_b128 v[24:27], v3 offset:28672
  ds_read_b128 v[28:31], v3 offset:29696
  ds_read_b128 v[32:35], v3 offset:30720
  ds_read_b128 v[36:39], v3 offset:31744
  ds_read_b128 v[40:43], v3 offset:32768
  ds_read_b128 v[44:47], v3 offset:33792
  ds_read_b128 v[48:51], v3 offset:34816
  ds_read_b128 v[52:55], v3 offset:35840
  s_waitcnt lgkmcnt(0)
  s_xor_b32 s70, s60, 805888
  buffer_store_dwordx4 v[8:11], v3, s[40:43], s70 offen sc1
  s_xor_b32 s70, s60, 838656
  buffer_store_dwordx4 v[12:15], v3, s[40:43], s70 offen sc1
  s_xor_b32 s70, s60, 871424
  buffer_store_dwordx4 v[16:19], v3, s[40:43], s70 offen sc1
  s_xor_b32 s70, s60, 904192
  buffer_store_dwordx4 v[20:23], v3, s[40:43], s70 offen sc1
  s_xor_b32 s70, s60, 935936
  buffer_store_dwordx4 v[24:27], v3, s[40:43], s70 offen sc1
  s_xor_b32 s70, s60, 968704
  buffer_store_dwordx4 v[28:31], v3, s[40:43], s70 offen sc1
  s_xor_b32 s70, s60, 1001472
  buffer_store_dwordx4 v[32:35], v3, s[40:43], s70 offen sc1
  s_xor_b32 s70, s60, 1034240
  buffer_store_dwordx4 v[36:39], v3, s[40:43], s70 offen sc1
  s_xor_b32 s70, s60, 1052672
  buffer_store_dwordx4 v[40:43], v3, s[40:43], s70 offen sc1
  s_xor_b32 s70, s60, 1085440
  buffer_store_dwordx4 v[44:47], v3, s[40:43], s70 offen sc1
  s_xor_b32 s70, s60, 1118208
  buffer_store_dwordx4 v[48:51], v3, s[40:43], s70 offen sc1
  s_xor_b32 s70, s60, 1150976
  buffer_store_dwordx4 v[52:55], v3, s[40:43], s70 offen sc1
  s_add_u32 s54, s74, 2
  v_mov_b32 v5, 0
  s_waitcnt vmcnt(0)
  v_mov_b32 v8, s54
  v_mov_b32 v9, s75
  s_mov_b64 exec, 1
  buffer_store_dwordx2 v[8:9], v5, s[40:43], s62 offen sc1
  s_mov_b64 exec, -1
L_h_skipb0:
  s_mov_b32 s78, 92
  s_swappc_b64 s[84:85], s[86:87]
  s_bitcmp0_b32 s58, 2
  s_cbranch_scc1 L_h_all
  s_add_u32 s54, s74, 2
  v_mov_b32 v5, 0
  s_mov_b64 exec, 1
  s_mov_b32 s59, 0
L_h_flagb:
  buffer_load_dwordx2 v[10:11], v5, s[40:43], s63 offen sc1
  s_waitcnt vmcnt(0)
  v_readfirstlane_b32 s56, v10
  v_readfirstlane_b32 s57, v11
  s_nop 0
  s_sub_u32 s56, s56, s54
  s_xor_b32 s57, s57, s75
  s_lshr_b32 s56, s56, 1
  s_or_b32 s56, s56, s57
  s_cbranch_scc0 L_h_flagb_done
  s_add_u32 s59, s59, 1
  s_cmp_gt_u32 s59, 2000
  s_cbranch_scc1 L_h_flagb_done
  s_sleep 32
  s_branch L_h_flagb
L_h_flagb_done:
  s_mov_b64 exec, -1
  s_xor_b32 s70, s61, 805888
  buffer_load_dwordx4 v[8:11], v3, s[40:43], s70 offen sc1
  s_xor_b32 s70, s61, 838656
  buffer_load_dwordx4 v[12:15], v3, s[40:43], s70 offen sc1
  s_xor_b32 s70, s61, 871424
  buffer_load_dwordx4 v[16:19], v3, s[40:43], s70 offen sc1
  s_xor_b32 s70, s61, 904192
  buffer_load_dwordx4 v[20:23], v3, s[40:43], s70 offen sc1
  s_xor_b32 s70, s61, 935936
  buffer_load_dwordx4 v[24:27], v3, s[40:43], s70 offen sc1
  s_xor_b32 s70, s61, 968704
  buffer_load_dwordx4 v[28:31], v3, s[40:43], s70 offen sc1
  s_xor_b32 s70, s61, 1001472
  buffer_load_dwordx4 v[32:35], v3, s[40:43], s70 offen sc1
  s_xor_b32 s70, s61, 1034240
  buffer_load_dwordx4 v[36:39], v3, s[40:43], s70 offen sc1
  s_xor_b32 s70, s61, 1052672
  buffer_load_dwordx4 v[40:43], v3, s[40:43], s70 offen sc1
  s_xor_b32 s70, s61, 1085440
  buffer_load_dwordx4 v[44:47], v3, s[40:43], s70 offen sc1
  s_xor_b32 s70, s61, 1118208
  buffer_load_dwordx4 v[48:51], v3, s[40:43], s70 offen sc1
  s_xor_b32 s70, s61, 1150976
  buffer_load_dwordx4 v[52:55], v3, s[40:43], s70 offen sc1
  s_waitcnt vmcnt(0)
  ds_write_b128 v3, v[8:11] offset:24576
  ds_write_b128 v3, v[12:15] offset:25600
  ds_write_b128 v3, v[16:19] offset:26624
  ds_write_b128 v3, v[20:23] offset:27648
  ds_write_b128 v3, v[24:27] offset:28672
  ds_write_b128 v3, v[28:31] offset:29696
  ds_write_b128 v3, v[32:35] offset:30720
  ds_write_b128 v3, v[36:39] offset:31744
  ds_write_b128 v3, v[40:43] offset:32768
  ds_write_b128 v3, v[44:47] offset:33792
  ds_write_b128 v3, v[48:51] offset:34816
  ds_write_b128 v3, v[52:55] offset:35840
  v_mov_b32 v1, 61700
  v_mov_b32 v5, 255
  ds_write_b32 v1, v5
L_h_all:
  s_mov_b32 s78, 172
  s_swappc_b64 s[84:85], s[86:87]
  s_lshr_b32 s70, s2, 3
  s_cmp_lt_i32 s70, (L_code_end - L_k) / 1024 - 0
  s_cbranch_scc0 L_h_ctc
  global_load_dwordx4 v[110:113], v[106:107], off
  s_lshr_b32 s70, s2, 3
  s_cmp_lt_i32 s70, (L_code_end - L_k) / 1024 - 32
  s_cbranch_scc0 L_h_ctc
  v_add_co_u32 v108, vcc, 0x8000, v106
  s_nop 1
  v_addc_co_u32 v109, vcc, 0, v107, vcc
  global_load_dwordx4 v[110:113], v[108:109], off
L_h_ctc:
  s_mov_b32 s78, 182
  s_swappc_b64 s[84:85], s[86:87]
  s_waitcnt lgkmcnt(0)
  s_endpgm
L_h_cp:
  s_cmp_gt_u32 s76, s78
  s_cbranch_scc0 L_h_cpgo
  s_setpc_b64 s[84:85]
L_h_cpgo:
  ds_read_b32 v8, v115
  s_memrealtime s[54:55]
  s_waitcnt lgkmcnt(0)
  v_mov_b32 v118, s54
  v_mov_b32 v119, s55
  v_cmp_gt_u32 vcc, s76, v8
  s_nop 1
  s_cmp_eq_u32 vcc_lo, 0
  s_cbranch_scc1 L_h_cpnext
L_h_cpm:
  s_sleep 2
  ds_read_b32 v8, v115
  s_memrealtime s[54:55]
  s_waitcnt lgkmcnt(0)
  v_mov_b32 v10, s54
  v_mov_b32 v11, s55
  v_cndmask_b32 v118, v118, v10, vcc
  v_cndmask_b32 v119, v119, v11, vcc
  v_cmp_gt_u32 vcc, s76, v8
  s_nop 1
  s_cmp_lg_u32 vcc_lo, 0
  s_cbranch_scc1 L_h_cpm
  s_and_b32 s70, s2, 0x78
  s_cbranch_scc1 L_h_np
  s_mov_b64 exec, 3
  buffer_store_dwordx2 v[118:119], v104, s[40:43], s77 offen sc1
  s_mov_b64 exec, -1
L_h_np:
  s_add_u32 s50, s76, 4
  v_mov_b32 v1, 61712
L_h_progc1:
  s_sleep 4
  ds_read_b128 v[8:11], v1
  s_waitcnt lgkmcnt(0)
  v_min_u32 v8, v8, v9
  s_nop 0
  v_readfirstlane_b32 s54, v8
  s_nop 1
  s_cmp_lt_u32 s54, s50
  s_cbranch_scc1 L_h_progc1
  buffer_load_dwordx2 v[8:9], v105, s[40:43], s77 offen
  v_mov_b32 v10, s73
  s_waitcnt vmcnt(0)
  ds_read_b32 v12, v115
  v_subrev_co_u32 v8, vcc, s72, v8
  s_nop 1
  v_subb_co_u32 v9, vcc, v9, v10, vcc
  v_lshrrev_b32 v10, 24, v8
  v_or_b32 v9, v9, v10
  v_cmp_eq_u32 vcc, 0, v9
  s_nop 1
  v_cndmask_b32 v8, 0, v8, vcc
  s_bcnt1_i32_b32 s56, vcc_lo
  s_nop 0
  v_add_u32_dpp v8, v8, v8 row_ror:8 row_mask:0xf bank_mask:0xf
  s_nop 1
  v_add_u32_dpp v8, v8, v8 row_ror:4 row_mask:0xf bank_mask:0xf
  s_nop 1
  v_add_u32_dpp v8, v8, v8 row_ror:2 row_mask:0xf bank_mask:0xf
  s_nop 1
  v_add_u32_dpp v8, v8, v8 row_ror:1 row_mask:0xf bank_mask:0xf
  s_nop 0
  v_readlane_b32 s54, v8, 0
  v_readlane_b32 s70, v8, 16
  v_subrev_u32 v8, s72, v118
  v_mul_lo_u32 v8, v8, s56
  s_add_u32 s54, s54, s70
  s_max_u32 s56, s56, 1
  v_subrev_u32 v8, s54, v8
  v_cvt_f32_u32 v9, s56
  v_cvt_f32_i32 v8, v8
  v_rcp_f32 v9, v9
  s_nop 0
  v_mul_f32 v8, v8, v9
  v_cvt_i32_f32 v8, v8
  s_waitcnt lgkmcnt(0)
  v_add_u32 v12, 2, v12
  v_min_u32 v9, v116, v12
  v_subrev_u32 v9, s76, v9
  v_max_i32 v9, 0, v9
  v_lshrrev_b32 v9, 1, v9
  v_mul_u32_u24 v9, 22, v9
  v_sub_u32 v8, v8, v9
  v_add_u32 v9, 11, v8
  v_max_i32 v9, 0, v9
  v_min_i32 v9, 2000, v9
  v_mul_u32_u24 v9, 2978, v9
  v_lshrrev_b32 v9, 16, v9
  v_cmp_ne_u32 vcc, 0, v9
  v_lshl_add_u32 v9, v9, 1, v12
  s_nop 0
  v_cndmask_b32 v116, 0, v9, vcc
  ds_write_b32 v115, v116 offset:16
L_h_cpnext:
  s_add_u32 s76, s76, 8
  s_add_u32 s77, s77, 256
  s_branch L_h_cp
L_code_end:
.section .rodata,"a"
.p2align 6
.amdhsa_kernel standalone__kv_cache_quant_int4_int2_kv_with_per_channel_or_per_token_scales__sampling_kernel
  .amdhsa_next_free_vgpr 256
  .amdhsa_next_free_sgpr 102
  .amdhsa_accum_offset 256
  .amdhsa_group_segment_fixed_size 0
  .amdhsa_kernarg_size 80
  .amdhsa_user_sgpr_count 2
  .amdhsa_user_sgpr_kernarg_segment_ptr 1
  .amdhsa_system_sgpr_workgroup_id_x 1
  .amdhsa_float_denorm_mode_32 3
.end_amdhsa_kernel
```

```asm
; @launch grid=(256,1,1) block=(192,1,1) lds=62464
.amdgcn_target "amdgcn-amd-amdhsa--gfx950"
.text
.globl standalone__kv_cache_quant_int4_int2_kv_with_per_channel_or_per_token_scales__sampling_kernel
.p2align 8
.type standalone__kv_cache_quant_int4_int2_kv_with_per_channel_or_per_token_scales__sampling_kernel,@function
standalone__kv_cache_quant_int4_int2_kv_with_per_channel_or_per_token_scales__sampling_kernel:
  s_cmp_ge_u32 s2, 256
  s_cbranch_scc1 L_end
  s_load_dwordx16 s[44:59], s[0:1], 0
  s_load_dwordx4 s[80:83], s[0:1], 64
  v_lshrrev_b32 v1, 6, v0
  v_and_b32 v0, 63, v0
  v_readfirstlane_b32 s3, v1
  s_bfe_u32 s4, s2, 0x10002
  s_lshr_b32 s5, s2, 3
  s_lshl_b32 s5, s5, 2
  s_and_b32 s70, s2, 3
  s_add_u32 s5, s5, s70
  s_lshl_b32 s5, s5, 5
  s_mov_b32 s22, 6291456
  s_mov_b32 s23, 0x20000
  s_mov_b32 s26, 6291456
  s_mov_b32 s27, 0x20000
  s_mov_b32 s30, 2097152
  s_mov_b32 s31, 0x20000
  s_mov_b32 s34, 2097152
  s_mov_b32 s35, 0x20000
  s_mov_b32 s10, 805306368
  s_mov_b32 s11, 0x20000
  s_mov_b32 s38, 393216
  s_mov_b32 s39, 0x20000
  s_mov_b32 s18, 805306368
  s_mov_b32 s19, 0x20000
  s_mov_b32 s14, 805306368
  s_mov_b32 s15, 0x20000
  s_mov_b32 s42, 25165824
  s_mov_b32 s43, 0x20000
  s_cmp_eq_u32 s3, 2
  s_cbranch_scc1 L_helper
  v_and_b32 v108, 3, v0
  v_bfe_u32 v109, v0, 2, 2
  v_lshrrev_b32 v110, 4, v0
  v_and_b32 v111, 15, v0
  v_lshlrev_b32 v144, 4, v108
  v_lshl_add_u32 v144, v110, 6, v144
  v_lshrrev_b32 v233, 1, v144
  v_and_b32 v231, 2, v109
  v_lshlrev_b32 v230, 5, v231
  v_add_u32 v230, 129, v230
  v_and_b32 v145, 1, v109
  v_lshl_add_u32 v231, v145, 2, v231
  v_mul_u32_u24 v145, 33024, v145
  v_add_u32 v232, v144, v145
  v_subrev_u32 v232, 33024, v232
  v_mul_u32_u24 v145, 384, v109
  v_add_u32 v235, v145, v233
  v_mov_b32 v105, 2147483632
  s_mov_b32 s90, 0xaaaaaaab
  s_mov_b32 s91, 0x492492
  s_movk_i32 s63, 768
  s_mov_b32 s64, s3
  s_mov_b32 s99, 8
  s_mov_b32 s96, 0
  v_lshlrev_b32 v114, 4, v0
  s_lshl1_add_u32 s70, s2, s3
  s_mul_i32 s88, s70, 4096
  s_mul_i32 s86, s70, 12288
  s_waitcnt lgkmcnt(0)
  s_mov_b32 s20, s50
  s_and_b32 s21, s51, 0xffff
  s_mov_b32 s24, s52
  s_and_b32 s25, s53, 0xffff
  s_mov_b32 s28, s54
  s_and_b32 s29, s55, 0xffff
  s_mov_b32 s32, s56
  s_and_b32 s33, s57, 0xffff
  buffer_load_dwordx4 v[128:131], v114, s[20:23], s86 offen offset:0
  buffer_load_dwordx4 v[128:131], v114, s[24:27], s86 offen offset:0
  buffer_load_dwordx4 v[128:131], v114, s[28:31], s88 offen offset:0
  buffer_load_dwordx4 v[128:131], v114, s[32:35], s88 offen offset:0
  buffer_load_dwordx4 v[128:131], v114, s[20:23], s86 offen offset:1024
  buffer_load_dwordx4 v[128:131], v114, s[24:27], s86 offen offset:1024
  buffer_load_dwordx4 v[128:131], v114, s[28:31], s88 offen offset:1024
  buffer_load_dwordx4 v[128:131], v114, s[32:35], s88 offen offset:1024
  s_mov_b32 s8, s46
  s_and_b32 s9, s47, 0xffff
  s_mov_b32 s36, s44
  s_and_b32 s37, s45, 0xffff
  s_mov_b32 s16, s46
  s_and_b32 s17, s47, 0xffff
  s_mov_b32 s12, s48
  s_and_b32 s13, s49, 0xffff
  s_mov_b32 s40, s82
  s_and_b32 s41, s83, 0xffff
  s_mov_b64 s[46:47], s[58:59]
  s_mov_b32 s56, 0x0f0f0f0f
  s_mov_b32 s57, 0x0f0f0f0f
  s_mov_b32 s58, 0xffff
  s_mov_b32 s59, 0xffff
  s_lshr_b32 s71, s64, 5
  s_lshr_b32 s85, s96, s71
  s_andn2_b32 s70, s64, 1
  s_or_b32 s70, s70, s4
  s_cmp_lt_u32 s64, 8
  s_cselect_b32 s70, s70, s64
  s_cselect_b32 s85, s64, s85
  s_and_b32 s85, s85, 1
  s_add_u32 s70, s70, s5
  s_mul_i32 s71, s71, 4064
  s_add_u32 s70, s70, s71
  s_mul_hi_u32 s84, s70, s90
  s_lshr_b32 s84, s84, 1
  s_mul_i32 s71, s84, 3
  s_sub_u32 s70, s70, s71
  s_lshl3_add_u32 s85, s70, s85
  s_mul_i32 s61, s84, 196608
  s_lshr_b32 s89, s84, 4
  s_lshl_b32 s70, s85, 5
  v_add_u32 v97, s70, v230
  v_mul_u32_u24 v97, 21846, v97
  v_lshrrev_b32 v97, 16, v97
  v_add_u32 v144, s85, v231
  v_lshrrev_b32 v145, v144, s91
  v_and_b32 v145, 1, v145
  v_cmp_eq_u32 s[54:55], 1, v145
  s_nop 1
  s_and_b64 s[52:53], s[54:55], s[56:57]
  s_andn2_b64 s[54:55], s[54:55], s[56:57]
  v_mul_u32_u24 v144, 43, v144
  v_lshrrev_b32 v144, 8, v144
  v_mul_u32_u24 v144, 384, v144
  v_add_u32 v234, v144, v233
  v_mad_u32_u24 v92, v97, s63, v232
  v_add_u32 v93, 768, v92
  v_add_u32 v94, 4608, v92
  v_add_u32 v95, 7680, v92
  v_cndmask_b32 v92, v92, v105, s[52:53]
  v_cndmask_b32 v95, v95, v105, s[54:55]
  s_mov_b32 s60, s61
  s_mul_i32 s70, s89, 1536
  buffer_load_dwordx2 v[174:175], v235, s[36:39], s70 offen offset:0
  buffer_load_dwordx2 v[176:177], v235, s[36:39], s70 offen offset:128
  buffer_load_dwordx2 v[178:179], v235, s[36:39], s70 offen offset:256
  buffer_load_dwordx4 v[4:7], v92, s[8:11], s60 offen offset:0 nt
  buffer_load_dwordx4 v[128:131], v114, s[20:23], s86 offen offset:2048
  buffer_load_dwordx4 v[128:131], v114, s[24:27], s86 offen offset:2048
  buffer_load_dwordx4 v[128:131], v114, s[28:31], s88 offen offset:2048
  buffer_load_dwordx4 v[128:131], v114, s[32:35], s88 offen offset:2048
  buffer_load_dwordx4 v[128:131], v114, s[20:23], s86 offen offset:3072
  buffer_load_dwordx4 v[128:131], v114, s[24:27], s86 offen offset:3072
  buffer_load_dwordx4 v[128:131], v114, s[28:31], s88 offen offset:3072
  buffer_load_dwordx4 v[128:131], v114, s[32:35], s88 offen offset:3072
  s_barrier
  s_mov_b64 vcc, 0
  v_lshlrev_b32 v144, 4, v111
  v_and_b32 v2, 2, v110
  v_lshlrev_b32 v1, 5, v2
  v_add_u32 v1, 129, v1
  v_and_b32 v145, 1, v110
  v_lshl_add_u32 v2, v145, 2, v2
  v_mul_u32_u24 v145, 33024, v145
  v_add_u32 v3, v144, v145
  v_subrev_u32 v3, 33024, v3
  v_and_b32 v145, 1, v110
  v_mul_u32_u24 v145, 86, v145
  v_lshl_add_u32 v96, v111, 1, v145
  v_subrev_u32 v96, 86, v96
  v_lshlrev_b32 v101, 4, v110
  v_lshrrev_b32 v144, 2, v0
  s_mul_i32 s70, s3, 384
  v_lshl_add_u32 v99, v144, 4, s70
  v_lshl_add_u32 v100, v144, 3, s70
  s_mul_i32 s70, s3, 3072
  s_add_u32 s70, s70, 36864
  v_lshl_add_u32 v102, v0, 4, s70
  s_lshl_b32 s70, s3, 5
  s_add_u32 s70, s70, 43008
  v_lshl_add_u32 v103, v109, 3, s70
  s_lshl2_add_u32 s70, s3, 61712
  v_mov_b32 v104, s70
  v_mov_b32 v112, 0
  v_mov_b32 v113, 0
  v_mov_b32 v236, 0xff800000
  v_mov_b32 v146, 1
  s_mov_b32 s65, 0xffff0000
  s_mov_b32 s66, 0x3fb8aa3b
  s_mov_b32 s68, 0x4893cd3a
  s_mov_b32 s92, 0x7f000000
  s_mov_b32 s94, 0x34800000
  s_mov_b32 s44, 0
  s_mov_b32 s69, 0x4893cd3a
  s_mov_b32 s93, 0x7f000000
  s_mov_b32 s95, 0x34800000
  s_mov_b32 s45, 0
  s_mov_b32 s72, 0x11111111
  s_mov_b32 s73, 0x11111111
  s_mov_b32 s74, 0x22222222
  s_mov_b32 s75, 0x22222222
  s_mov_b32 s76, 0x44444444
  s_mov_b32 s77, 0x44444444
  s_mov_b32 s78, 0x88888888
  s_mov_b32 s79, 0x88888888
  s_mov_b32 s100, 0
  s_add_u32 s86, s86, 4096
  s_waitcnt vmcnt(15)
  buffer_load_dwordx4 v[128:131], v114, s[20:23], s86 offen offset:0
  s_waitcnt vmcnt(15)
  buffer_load_dwordx4 v[128:131], v114, s[24:27], s86 offen offset:0
  s_waitcnt vmcnt(15)
  buffer_load_dwordx4 v[128:131], v114, s[20:23], s86 offen offset:1024
  s_waitcnt vmcnt(15)
  buffer_load_dwordx4 v[128:131], v114, s[24:27], s86 offen offset:1024
  s_waitcnt vmcnt(15)
  buffer_load_dwordx4 v[128:131], v114, s[20:23], s86 offen offset:2048
  s_waitcnt vmcnt(15)
  buffer_load_dwordx4 v[128:131], v114, s[24:27], s86 offen offset:2048
  s_waitcnt vmcnt(15)
  buffer_load_dwordx4 v[128:131], v114, s[20:23], s86 offen offset:3072
  s_waitcnt vmcnt(15)
  buffer_load_dwordx4 v[128:131], v114, s[24:27], s86 offen offset:3072
  s_add_u32 s86, s86, 4096
  s_waitcnt vmcnt(15)
  buffer_load_dwordx4 v[128:131], v114, s[20:23], s86 offen offset:0
  s_waitcnt vmcnt(15)
  buffer_load_dwordx4 v[128:131], v114, s[24:27], s86 offen offset:0
  s_waitcnt vmcnt(15)
  buffer_load_dwordx4 v[128:131], v114, s[20:23], s86 offen offset:1024
  s_waitcnt vmcnt(15)
  buffer_load_dwordx4 v[128:131], v114, s[24:27], s86 offen offset:1024
  s_waitcnt vmcnt(15)
  buffer_load_dwordx4 v[128:131], v114, s[20:23], s86 offen offset:2048
  s_waitcnt vmcnt(15)
  buffer_load_dwordx4 v[128:131], v114, s[24:27], s86 offen offset:2048
  s_waitcnt vmcnt(15)
  buffer_load_dwordx4 v[128:131], v114, s[20:23], s86 offen offset:3072
  s_waitcnt vmcnt(15)
  buffer_load_dwordx4 v[128:131], v114, s[24:27], s86 offen offset:3072
  s_mov_b32 s88, s89
  s_mul_i32 s62, s84, 1536
  buffer_load_dwordx2 v[180:181], v234, s[20:23], s62 offen offset:0
  buffer_load_dwordx2 v[186:187], v234, s[24:27], s62 offen offset:0
  buffer_load_dwordx2 v[182:183], v234, s[20:23], s62 offen offset:128
  buffer_load_dwordx2 v[188:189], v234, s[24:27], s62 offen offset:128
  buffer_load_dwordx2 v[184:185], v234, s[20:23], s62 offen offset:256
  buffer_load_dwordx2 v[190:191], v234, s[24:27], s62 offen offset:256
  s_waitcnt vmcnt(15)
  buffer_load_dwordx4 v[8:11], v92, s[8:11], s60 offen offset:256 nt
  s_waitcnt vmcnt(15)
  buffer_load_dwordx4 v[12:15], v92, s[8:11], s60 offen offset:512 nt
  s_waitcnt vmcnt(15)
  buffer_load_dwordx4 v[16:19], v93, s[8:11], s60 offen offset:0 nt
  s_waitcnt vmcnt(15)
  buffer_load_dwordx4 v[20:23], v93, s[8:11], s60 offen offset:256 nt
  s_waitcnt vmcnt(15)
  buffer_load_dwordx4 v[24:27], v93, s[8:11], s60 offen offset:512 nt
  s_waitcnt vmcnt(15)
  buffer_load_dwordx4 v[28:31], v93, s[8:11], s60 offen offset:768 nt
  s_waitcnt vmcnt(15)
  buffer_load_dwordx4 v[32:35], v93, s[8:11], s60 offen offset:1024 nt
  s_waitcnt vmcnt(15)
  buffer_load_dwordx4 v[36:39], v93, s[8:11], s60 offen offset:1280 nt
  s_waitcnt vmcnt(15)
  buffer_load_dwordx4 v[40:43], v93, s[8:11], s60 offen offset:1536 nt
  s_waitcnt vmcnt(15)
  buffer_load_dwordx4 v[44:47], v93, s[8:11], s60 offen offset:1792 nt
  s_waitcnt vmcnt(16)
  buffer_load_dwordx4 v[48:51], v93, s[8:11], s60 offen offset:2048 nt
  s_waitcnt vmcnt(17)
  buffer_load_dwordx4 v[52:55], v93, s[8:11], s60 offen offset:2304 nt
  s_waitcnt vmcnt(18)
  buffer_load_dwordx4 v[56:59], v93, s[8:11], s60 offen offset:2560 nt
  s_waitcnt vmcnt(19)
  buffer_load_dwordx4 v[60:63], v93, s[8:11], s60 offen offset:2816 nt
  s_waitcnt vmcnt(14)
  ds_write_b32 v104, v146
L_k:
  v_add_u32 v144, s85, v2
  v_lshrrev_b32 v145, v144, s91
  v_and_b32 v145, 1, v145
  v_cmp_eq_u32 s[50:51], 1, v145
  s_nop 1
  s_and_b64 s[48:49], s[50:51], s[58:59]
  s_andn2_b64 s[50:51], s[50:51], s[58:59]
  s_mov_b32 s97, s64
  s_add_u32 s64, s64, 2
  ds_read_b32 v106, v104 offset:8
  s_waitcnt vmcnt(14)
  s_cbranch_vccnz L_kw0_0
  s_waitcnt vmcnt(9)
L_kw0_0:
  buffer_load_dwordx4 v[64:67], v93, s[8:11], s60 offen offset:3072 nt
  v_lshlrev_b32 v204, 16, v186
  v_and_b32 v205, s65, v186
  v_lshlrev_b32 v206, 16, v187
  v_and_b32 v207, s65, v187
  v_lshlrev_b32 v192, 16, v180
  v_and_b32 v193, s65, v180
  v_lshlrev_b32 v194, 16, v181
  v_and_b32 v195, s65, v181
  v_pk_mul_f32 v[204:205], v[204:205], s[94:95]
  v_mov_b32 v168, v174
  v_pk_mul_f32 v[206:207], v[206:207], s[94:95]
  v_mov_b32 v169, v175
  v_pk_fma_f32 v[108:109], v[4:5], s[92:93], v[204:205] neg_lo:[0,0,1] neg_hi:[0,0,1]
  v_pk_fma_f32 v[110:111], v[6:7], s[92:93], v[206:207] neg_lo:[0,0,1] neg_hi:[0,0,1]
  v_cvt_pk_bf16_f32 v108, 0, v108
  v_cvt_pk_bf16_f32 v109, 0, v109
  v_cvt_pk_bf16_f32 v110, 0, v110
  v_cvt_pk_bf16_f32 v111, 0, v111
  v_pk_mul_f32 v[108:109], v[108:109], v[192:193]
  v_pk_mul_f32 v[110:111], v[110:111], v[194:195]
  v_cvt_pk_bf16_f32 v216, v108, v109
  v_cvt_pk_bf16_f32 v217, v110, v111
  s_waitcnt lgkmcnt(0)
  v_cmp_lt_u32 vcc, s97, v106
  s_waitcnt vmcnt(14)
  buffer_load_dwordx4 v[68:71], v93, s[8:11], s60 offen offset:3328 nt
  v_lshlrev_b32 v208, 16, v188
  v_and_b32 v209, s65, v188
  v_lshlrev_b32 v210, 16, v189
  v_and_b32 v211, s65, v189
  v_lshlrev_b32 v196, 16, v182
  v_and_b32 v197, s65, v182
  v_lshlrev_b32 v198, 16, v183
  v_and_b32 v199, s65, v183
  v_pk_mul_f32 v[208:209], v[208:209], s[94:95]
  v_mov_b32 v170, v176
  v_pk_mul_f32 v[210:211], v[210:211], s[94:95]
  v_mov_b32 v171, v177
  v_pk_fma_f32 v[108:109], v[8:9], s[92:93], v[208:209] neg_lo:[0,0,1] neg_hi:[0,0,1]
  v_pk_fma_f32 v[110:111], v[10:11], s[92:93], v[210:211] neg_lo:[0,0,1] neg_hi:[0,0,1]
  v_cvt_pk_bf16_f32 v108, 0, v108
  v_cvt_pk_bf16_f32 v109, 0, v109
  v_cvt_pk_bf16_f32 v110, 0, v110
  v_cvt_pk_bf16_f32 v111, 0, v111
  v_pk_mul_f32 v[108:109], v[108:109], v[196:197]
  v_pk_mul_f32 v[110:111], v[110:111], v[198:199]
  v_cvt_pk_bf16_f32 v218, v108, v109
  v_cvt_pk_bf16_f32 v219, v110, v111
  s_waitcnt vmcnt(14)
  buffer_load_dwordx4 v[72:75], v93, s[8:11], s60 offen offset:3584 nt
  v_mfma_f32_16x16x32_bf16 v[224:227], v[216:219], v[168:171], 0
  v_lshlrev_b32 v212, 16, v190
  v_and_b32 v213, s65, v190
  v_lshlrev_b32 v214, 16, v191
  v_and_b32 v215, s65, v191
  v_lshlrev_b32 v200, 16, v184
  v_and_b32 v201, s65, v184
  v_lshlrev_b32 v202, 16, v185
  v_and_b32 v203, s65, v185
  v_pk_mul_f32 v[212:213], v[212:213], s[94:95]
  v_mov_b32 v172, v178
  v_pk_mul_f32 v[214:215], v[214:215], s[94:95]
  v_mov_b32 v173, v179
  v_pk_fma_f32 v[108:109], v[12:13], s[92:93], v[212:213] neg_lo:[0,0,1] neg_hi:[0,0,1]
  v_pk_fma_f32 v[110:111], v[14:15], s[92:93], v[214:215] neg_lo:[0,0,1] neg_hi:[0,0,1]
  v_cvt_pk_bf16_f32 v108, 0, v108
  v_cvt_pk_bf16_f32 v109, 0, v109
  v_cvt_pk_bf16_f32 v110, 0, v110
  v_cvt_pk_bf16_f32 v111, 0, v111
  v_pk_mul_f32 v[108:109], v[108:109], v[200:201]
  v_pk_mul_f32 v[110:111], v[110:111], v[202:203]
  v_cvt_pk_bf16_f32 v220, v108, v109
  v_cvt_pk_bf16_f32 v221, v110, v111
  s_waitcnt vmcnt(14)
  s_cbranch_vccnz L_kw0_3
  s_waitcnt vmcnt(9)
L_kw0_3:
  buffer_load_dwordx4 v[76:79], v94, s[8:11], s60 offen offset:0 nt
  v_mfma_f32_16x16x16_bf16 v[224:227], v[220:221], v[172:173], v[224:227]
  v_pk_fma_f32 v[108:109], v[16:17], s[92:93], v[204:205] neg_lo:[0,0,1] neg_hi:[0,0,1]
  v_pk_fma_f32 v[110:111], v[18:19], s[92:93], v[206:207] neg_lo:[0,0,1] neg_hi:[0,0,1]
  v_cvt_pk_bf16_f32 v108, 0, v108
  v_cvt_pk_bf16_f32 v109, 0, v109
  v_cvt_pk_bf16_f32 v110, 0, v110
  v_cvt_pk_bf16_f32 v111, 0, v111
  v_pk_mul_f32 v[108:109], v[108:109], v[192:193]
  v_pk_mul_f32 v[110:111], v[110:111], v[194:195]
  v_cvt_pk_bf16_f32 v216, v108, v109
  v_cvt_pk_bf16_f32 v217, v110, v111
  s_waitcnt vmcnt(14)
  buffer_load_dwordx4 v[80:83], v94, s[8:11], s60 offen offset:256 nt
  v_pk_fma_f32 v[108:109], v[20:21], s[92:93], v[208:209] neg_lo:[0,0,1] neg_hi:[0,0,1]
  v_pk_fma_f32 v[110:111], v[22:23], s[92:93], v[210:211] neg_lo:[0,0,1] neg_hi:[0,0,1]
  v_mov_b32_dpp v144, v224 quad_perm:[0,0,0,0] row_mask:0xf bank_mask:0xf
  v_mov_b32_dpp v145, v226 quad_perm:[2,2,2,2] row_mask:0xf bank_mask:0xf
  v_cvt_pk_bf16_f32 v108, 0, v108
  v_cvt_pk_bf16_f32 v109, 0, v109
  v_add_f32_dpp v144, v225, v144 quad_perm:[1,1,1,1] row_mask:0xf bank_mask:0xf
  v_add_f32_dpp v145, v227, v145 quad_perm:[3,3,3,3] row_mask:0xf bank_mask:0xf
  v_cvt_pk_bf16_f32 v110, 0, v110
  v_cvt_pk_bf16_f32 v111, 0, v111
  v_add_f32 v228, v144, v145
  v_pk_mul_f32 v[108:109], v[108:109], v[196:197]
  v_pk_mul_f32 v[110:111], v[110:111], v[198:199]
  v_cvt_pk_bf16_f32 v218, v108, v109
  v_cvt_pk_bf16_f32 v219, v110, v111
  s_waitcnt vmcnt(14)
  buffer_load_dwordx4 v[84:87], v94, s[8:11], s60 offen offset:512 nt
  v_mfma_f32_16x16x32_bf16 v[224:227], v[216:219], v[168:171], 0
  v_pk_fma_f32 v[108:109], v[24:25], s[92:93], v[212:213] neg_lo:[0,0,1] neg_hi:[0,0,1]
  v_pk_fma_f32 v[110:111], v[26:27], s[92:93], v[214:215] neg_lo:[0,0,1] neg_hi:[0,0,1]
  v_cvt_pk_bf16_f32 v108, 0, v108
  v_cndmask_b32 v228, v228, v236, s[48:49]
  v_cvt_pk_bf16_f32 v109, 0, v109
  v_cvt_pk_bf16_f32 v110, 0, v110
  v_cvt_pk_bf16_f32 v111, 0, v111
  v_pk_mul_f32 v[108:109], v[108:109], v[200:201]
  v_pk_mul_f32 v[110:111], v[110:111], v[202:203]
  v_cvt_pk_bf16_f32 v220, v108, v109
  v_cvt_pk_bf16_f32 v221, v110, v111
  s_waitcnt vmcnt(14)
  s_cbranch_vccnz L_kw0_6
  s_waitcnt vmcnt(9)
L_kw0_6:
  buffer_load_dwordx4 v[88:91], v94, s[8:11], s60 offen offset:768 nt
  v_mfma_f32_16x16x16_bf16 v[224:227], v[220:221], v[172:173], v[224:227]
  v_pk_fma_f32 v[108:109], v[28:29], s[92:93], v[204:205] neg_lo:[0,0,1] neg_hi:[0,0,1]
  v_pk_fma_f32 v[110:111], v[30:31], s[92:93], v[206:207] neg_lo:[0,0,1] neg_hi:[0,0,1]
  v_cvt_pk_bf16_f32 v108, 0, v108
  v_cvt_pk_bf16_f32 v109, 0, v109
  v_cvt_pk_bf16_f32 v110, 0, v110
  v_cvt_pk_bf16_f32 v111, 0, v111
  v_pk_mul_f32 v[108:109], v[108:109], v[192:193]
  v_pk_mul_f32 v[110:111], v[110:111], v[194:195]
  v_cvt_pk_bf16_f32 v216, v108, v109
  v_cvt_pk_bf16_f32 v217, v110, v111
  s_waitcnt vmcnt(14)
  buffer_load_dwordx4 v[4:7], v94, s[8:11], s60 offen offset:1024 nt
  v_pk_fma_f32 v[108:109], v[32:33], s[92:93], v[208:209] neg_lo:[0,0,1] neg_hi:[0,0,1]
  v_pk_fma_f32 v[110:111], v[34:35], s[92:93], v[210:211] neg_lo:[0,0,1] neg_hi:[0,0,1]
  v_mov_b32_dpp v144, v224 quad_perm:[0,0,0,0] row_mask:0xf bank_mask:0xf
  v_mov_b32_dpp v145, v226 quad_perm:[2,2,2,2] row_mask:0xf bank_mask:0xf
  v_cvt_pk_bf16_f32 v108, 0, v108
  v_cvt_pk_bf16_f32 v109, 0, v109
  v_add_f32_dpp v144, v225, v144 quad_perm:[1,1,1,1] row_mask:0xf bank_mask:0xf
  v_add_f32_dpp v145, v227, v145 quad_perm:[3,3,3,3] row_mask:0xf bank_mask:0xf
  v_cvt_pk_bf16_f32 v110, 0, v110
  v_cvt_pk_bf16_f32 v111, 0, v111
  v_add_f32 v229, v144, v145
  v_pk_mul_f32 v[108:109], v[108:109], v[196:197]
  v_pk_mul_f32 v[110:111], v[110:111], v[198:199]
  v_cvt_pk_bf16_f32 v218, v108, v109
  v_cvt_pk_bf16_f32 v219, v110, v111
  s_waitcnt vmcnt(14)
  buffer_load_dwordx4 v[8:11], v94, s[8:11], s60 offen offset:1280 nt
  v_mfma_f32_16x16x32_bf16 v[224:227], v[216:219], v[168:171], 0
  v_pk_fma_f32 v[108:109], v[36:37], s[92:93], v[212:213] neg_lo:[0,0,1] neg_hi:[0,0,1]
  v_pk_fma_f32 v[110:111], v[38:39], s[92:93], v[214:215] neg_lo:[0,0,1] neg_hi:[0,0,1]
  v_cvt_pk_bf16_f32 v108, 0, v108
  v_cvt_pk_bf16_f32 v228, 0, v228
  v_cvt_pk_bf16_f32 v109, 0, v109
  v_cvt_pk_bf16_f32 v229, 0, v229
  v_cvt_pk_bf16_f32 v110, 0, v110
  v_pk_mul_f32 v[228:229], v[228:229], s[68:69]
  v_cvt_pk_bf16_f32 v111, 0, v111
  v_cvt_pk_bf16_f32 v120, v228, v229
  v_pk_mul_f32 v[108:109], v[108:109], v[200:201]
  v_pk_mul_f32 v[110:111], v[110:111], v[202:203]
  v_cvt_pk_bf16_f32 v220, v108, v109
  v_cvt_pk_bf16_f32 v221, v110, v111
  s_waitcnt vmcnt(14)
  s_cbranch_vccnz L_kw0_9
  s_waitcnt vmcnt(9)
L_kw0_9:
  buffer_load_dwordx4 v[12:15], v94, s[8:11], s60 offen offset:1536 nt
  v_mfma_f32_16x16x16_bf16 v[224:227], v[220:221], v[172:173], v[224:227]
  v_pk_fma_f32 v[108:109], v[40:41], s[92:93], v[204:205] neg_lo:[0,0,1] neg_hi:[0,0,1]
  v_pk_fma_f32 v[110:111], v[42:43], s[92:93], v[206:207] neg_lo:[0,0,1] neg_hi:[0,0,1]
  v_cvt_pk_bf16_f32 v108, 0, v108
  v_cvt_pk_bf16_f32 v109, 0, v109
  v_cvt_pk_bf16_f32 v110, 0, v110
  v_cvt_pk_bf16_f32 v111, 0, v111
  v_pk_mul_f32 v[108:109], v[108:109], v[192:193]
  v_pk_mul_f32 v[110:111], v[110:111], v[194:195]
  v_cvt_pk_bf16_f32 v216, v108, v109
  v_cvt_pk_bf16_f32 v217, v110, v111
  s_waitcnt vmcnt(14)
  buffer_load_dwordx4 v[16:19], v94, s[8:11], s60 offen offset:1792 nt
  v_pk_fma_f32 v[108:109], v[44:45], s[92:93], v[208:209] neg_lo:[0,0,1] neg_hi:[0,0,1]
  v_pk_fma_f32 v[110:111], v[46:47], s[92:93], v[210:211] neg_lo:[0,0,1] neg_hi:[0,0,1]
  v_mov_b32_dpp v144, v224 quad_perm:[0,0,0,0] row_mask:0xf bank_mask:0xf
  v_mov_b32_dpp v145, v226 quad_perm:[2,2,2,2] row_mask:0xf bank_mask:0xf
  v_cvt_pk_bf16_f32 v108, 0, v108
  v_cvt_pk_bf16_f32 v109, 0, v109
  v_add_f32_dpp v144, v225, v144 quad_perm:[1,1,1,1] row_mask:0xf bank_mask:0xf
  v_add_f32_dpp v145, v227, v145 quad_perm:[3,3,3,3] row_mask:0xf bank_mask:0xf
  v_cvt_pk_bf16_f32 v110, 0, v110
  v_cvt_pk_bf16_f32 v111, 0, v111
  v_add_f32 v228, v144, v145
  v_pk_mul_f32 v[108:109], v[108:109], v[196:197]
  v_pk_mul_f32 v[110:111], v[110:111], v[198:199]
  v_cvt_pk_bf16_f32 v218, v108, v109
  v_cvt_pk_bf16_f32 v219, v110, v111
  s_waitcnt vmcnt(14)
  buffer_load_dwordx4 v[20:23], v94, s[8:11], s60 offen offset:2048 nt
  v_mfma_f32_16x16x32_bf16 v[224:227], v[216:219], v[168:171], 0
  v_pk_fma_f32 v[108:109], v[48:49], s[92:93], v[212:213] neg_lo:[0,0,1] neg_hi:[0,0,1]
  v_pk_fma_f32 v[110:111], v[50:51], s[92:93], v[214:215] neg_lo:[0,0,1] neg_hi:[0,0,1]
  v_cvt_pk_bf16_f32 v108, 0, v108
  v_cvt_pk_bf16_f32 v109, 0, v109
  v_cvt_pk_bf16_f32 v110, 0, v110
  v_cvt_pk_bf16_f32 v111, 0, v111
  v_pk_mul_f32 v[108:109], v[108:109], v[200:201]
  v_pk_mul_f32 v[110:111], v[110:111], v[202:203]
  v_cvt_pk_bf16_f32 v220, v108, v109
  v_cvt_pk_bf16_f32 v221, v110, v111
  s_waitcnt vmcnt(14)
  s_cbranch_vccnz L_kw0_12
  s_waitcnt vmcnt(9)
L_kw0_12:
  buffer_load_dwordx4 v[24:27], v94, s[8:11], s60 offen offset:2304 nt
  v_mfma_f32_16x16x16_bf16 v[224:227], v[220:221], v[172:173], v[224:227]
  v_pk_fma_f32 v[108:109], v[52:53], s[92:93], v[204:205] neg_lo:[0,0,1] neg_hi:[0,0,1]
  v_pk_fma_f32 v[110:111], v[54:55], s[92:93], v[206:207] neg_lo:[0,0,1] neg_hi:[0,0,1]
  v_cvt_pk_bf16_f32 v108, 0, v108
  v_cvt_pk_bf16_f32 v109, 0, v109
  v_cvt_pk_bf16_f32 v110, 0, v110
  v_cvt_pk_bf16_f32 v111, 0, v111
  v_pk_mul_f32 v[108:109], v[108:109], v[192:193]
  v_pk_mul_f32 v[110:111], v[110:111], v[194:195]
  v_cvt_pk_bf16_f32 v216, v108, v109
  v_cvt_pk_bf16_f32 v217, v110, v111
  s_waitcnt vmcnt(14)
  buffer_load_dwordx4 v[28:31], v94, s[8:11], s60 offen offset:2560 nt
  v_pk_fma_f32 v[108:109], v[56:57], s[92:93], v[208:209] neg_lo:[0,0,1] neg_hi:[0,0,1]
  v_pk_fma_f32 v[110:111], v[58:59], s[92:93], v[210:211] neg_lo:[0,0,1] neg_hi:[0,0,1]
  v_mov_b32_dpp v144, v224 quad_perm:[0,0,0,0] row_mask:0xf bank_mask:0xf
  v_mov_b32_dpp v145, v226 quad_perm:[2,2,2,2] row_mask:0xf bank_mask:0xf
  v_cvt_pk_bf16_f32 v108, 0, v108
  v_cvt_pk_bf16_f32 v109, 0, v109
  v_add_f32_dpp v144, v225, v144 quad_perm:[1,1,1,1] row_mask:0xf bank_mask:0xf
  v_add_f32_dpp v145, v227, v145 quad_perm:[3,3,3,3] row_mask:0xf bank_mask:0xf
  v_cvt_pk_bf16_f32 v110, 0, v110
  v_cvt_pk_bf16_f32 v111, 0, v111
  v_add_f32 v229, v144, v145
  v_pk_mul_f32 v[108:109], v[108:109], v[196:197]
  v_pk_mul_f32 v[110:111], v[110:111], v[198:199]
  v_cvt_pk_bf16_f32 v218, v108, v109
  v_cvt_pk_bf16_f32 v219, v110, v111
  s_waitcnt vmcnt(14)
  buffer_load_dwordx4 v[32:35], v94, s[8:11], s60 offen offset:2816 nt
  v_mfma_f32_16x16x32_bf16 v[224:227], v[216:219], v[168:171], 0
  v_pk_fma_f32 v[108:109], v[60:61], s[92:93], v[212:213] neg_lo:[0,0,1] neg_hi:[0,0,1]
  v_pk_fma_f32 v[110:111], v[62:63], s[92:93], v[214:215] neg_lo:[0,0,1] neg_hi:[0,0,1]
  v_cvt_pk_bf16_f32 v108, 0, v108
  v_cvt_pk_bf16_f32 v228, 0, v228
  v_cvt_pk_bf16_f32 v109, 0, v109
  v_cvt_pk_bf16_f32 v229, 0, v229
  v_cvt_pk_bf16_f32 v110, 0, v110
  v_pk_mul_f32 v[228:229], v[228:229], s[68:69]
  v_cvt_pk_bf16_f32 v111, 0, v111
  v_cvt_pk_bf16_f32 v121, v228, v229
  v_pk_mul_f32 v[108:109], v[108:109], v[200:201]
  v_pk_mul_f32 v[110:111], v[110:111], v[202:203]
  v_cvt_pk_bf16_f32 v220, v108, v109
  v_cvt_pk_bf16_f32 v221, v110, v111
  s_waitcnt vmcnt(14)
  s_cbranch_vccnz L_kw0_15
  s_waitcnt vmcnt(9)
L_kw0_15:
  buffer_load_dwordx4 v[36:39], v95, s[8:11], s60 offen offset:0 nt
  v_mfma_f32_16x16x16_bf16 v[224:227], v[220:221], v[172:173], v[224:227]
  v_pk_fma_f32 v[108:109], v[64:65], s[92:93], v[204:205] neg_lo:[0,0,1] neg_hi:[0,0,1]
  v_pk_fma_f32 v[110:111], v[66:67], s[92:93], v[206:207] neg_lo:[0,0,1] neg_hi:[0,0,1]
  v_cvt_pk_bf16_f32 v108, 0, v108
  v_cvt_pk_bf16_f32 v109, 0, v109
  v_cvt_pk_bf16_f32 v110, 0, v110
  v_cvt_pk_bf16_f32 v111, 0, v111
  v_pk_mul_f32 v[108:109], v[108:109], v[192:193]
  v_pk_mul_f32 v[110:111], v[110:111], v[194:195]
  v_cvt_pk_bf16_f32 v216, v108, v109
  v_cvt_pk_bf16_f32 v217, v110, v111
  s_waitcnt vmcnt(14)
  buffer_load_dwordx4 v[40:43], v95, s[8:11], s60 offen offset:256 nt
  v_pk_fma_f32 v[108:109], v[68:69], s[92:93], v[208:209] neg_lo:[0,0,1] neg_hi:[0,0,1]
  v_pk_fma_f32 v[110:111], v[70:71], s[92:93], v[210:211] neg_lo:[0,0,1] neg_hi:[0,0,1]
  v_mov_b32_dpp v144, v224 quad_perm:[0,0,0,0] row_mask:0xf bank_mask:0xf
  v_mov_b32_dpp v145, v226 quad_perm:[2,2,2,2] row_mask:0xf bank_mask:0xf
  v_cvt_pk_bf16_f32 v108, 0, v108
  v_cvt_pk_bf16_f32 v109, 0, v109
  v_add_f32_dpp v144, v225, v144 quad_perm:[1,1,1,1] row_mask:0xf bank_mask:0xf
  v_add_f32_dpp v145, v227, v145 quad_perm:[3,3,3,3] row_mask:0xf bank_mask:0xf
  v_cvt_pk_bf16_f32 v110, 0, v110
  v_cvt_pk_bf16_f32 v111, 0, v111
  v_add_f32 v228, v144, v145
  v_pk_mul_f32 v[108:109], v[108:109], v[196:197]
  v_pk_mul_f32 v[110:111], v[110:111], v[198:199]
  v_cvt_pk_bf16_f32 v218, v108, v109
  v_cvt_pk_bf16_f32 v219, v110, v111
  s_waitcnt vmcnt(14)
  buffer_load_dwordx4 v[44:47], v95, s[8:11], s60 offen offset:512 nt
  v_mfma_f32_16x16x32_bf16 v[224:227], v[216:219], v[168:171], 0
  v_pk_fma_f32 v[108:109], v[72:73], s[92:93], v[212:213] neg_lo:[0,0,1] neg_hi:[0,0,1]
  v_pk_fma_f32 v[110:111], v[74:75], s[92:93], v[214:215] neg_lo:[0,0,1] neg_hi:[0,0,1]
  s_cmp_lt_u32 s64, s99
  s_cbranch_scc1 L_k_known0
L_k_spin0:
  v_mov_b32 v144, 61696
  ds_read_b32 v144, v144
  s_waitcnt lgkmcnt(0)
  v_readfirstlane_b32 s96, v144
  s_nop 1
  s_cmp_eq_u32 s96, 0
  s_cbranch_scc1 L_k_spin0
  s_mov_b32 s99, -1
L_k_known0:
  s_lshr_b32 s71, s64, 5
  s_lshr_b32 s85, s96, s71
  s_andn2_b32 s70, s64, 1
  s_or_b32 s70, s70, s4
  s_cmp_lt_u32 s64, 8
  s_cselect_b32 s70, s70, s64
  s_cselect_b32 s85, s64, s85
  s_and_b32 s85, s85, 1
  s_add_u32 s70, s70, s5
  s_mul_i32 s71, s71, 4064
  s_add_u32 s70, s70, s71
  s_mul_hi_u32 s84, s70, s90
  s_lshr_b32 s84, s84, 1
  s_mul_i32 s71, s84, 3
  s_sub_u32 s70, s70, s71
  s_lshl3_add_u32 s85, s70, s85
  s_mul_i32 s61, s84, 196608
  s_lshr_b32 s89, s84, 4
  s_lshl_b32 s70, s85, 5
  v_add_u32 v97, s70, v230
  v_mul_u32_u24 v97, 21846, v97
  v_lshrrev_b32 v97, 16, v97
  v_add_u32 v144, s85, v231
  v_lshrrev_b32 v145, v144, s91
  v_and_b32 v145, 1, v145
  v_cmp_eq_u32 s[54:55], 1, v145
  s_nop 1
  s_and_b64 s[52:53], s[54:55], s[56:57]
  s_andn2_b64 s[54:55], s[54:55], s[56:57]
  v_mul_u32_u24 v144, 43, v144
  v_lshrrev_b32 v144, 8, v144
  v_mul_u32_u24 v144, 384, v144
  v_add_u32 v234, v144, v233
  s_cmp_eq_u32 s89, s88
  s_cbranch_scc1 L_k_sameq0
  s_mul_i32 s70, s89, 1536
  buffer_load_dwordx2 v[174:175], v235, s[36:39], s70 offen offset:0
  buffer_load_dwordx2 v[176:177], v235, s[36:39], s70 offen offset:128
  buffer_load_dwordx2 v[178:179], v235, s[36:39], s70 offen offset:256
  s_mov_b32 s88, s89
L_k_sameq0:
  s_mul_i32 s62, s84, 1536
  buffer_load_dwordx2 v[180:181], v234, s[20:23], s62 offen offset:0
  buffer_load_dwordx2 v[186:187], v234, s[24:27], s62 offen offset:0
  buffer_load_dwordx2 v[182:183], v234, s[20:23], s62 offen offset:128
  buffer_load_dwordx2 v[188:189], v234, s[24:27], s62 offen offset:128
  buffer_load_dwordx2 v[184:185], v234, s[20:23], s62 offen offset:256
  buffer_load_dwordx2 v[190:191], v234, s[24:27], s62 offen offset:256
  v_cvt_pk_bf16_f32 v108, 0, v108
  v_cvt_pk_bf16_f32 v109, 0, v109
  v_cvt_pk_bf16_f32 v110, 0, v110
  v_cvt_pk_bf16_f32 v111, 0, v111
  v_pk_mul_f32 v[108:109], v[108:109], v[200:201]
  v_pk_mul_f32 v[110:111], v[110:111], v[202:203]
  v_cvt_pk_bf16_f32 v220, v108, v109
  v_cvt_pk_bf16_f32 v221, v110, v111
  v_mad_u32_u24 v92, v97, s63, v232
  v_add_u32 v93, 768, v92
  v_add_u32 v94, 4608, v92
  v_add_u32 v95, 7680, v92
  v_cndmask_b32 v92, v92, v105, s[52:53]
  v_cndmask_b32 v95, v95, v105, s[54:55]
  s_waitcnt vmcnt(20)
  s_cbranch_vccnz L_kw0_18
  s_waitcnt vmcnt(15)
L_kw0_18:
  buffer_load_dwordx4 v[48:51], v92, s[16:19], s61 offen offset:0 nt
  v_mfma_f32_16x16x16_bf16 v[224:227], v[220:221], v[172:173], v[224:227]
  v_pk_fma_f32 v[108:109], v[76:77], s[92:93], v[204:205] neg_lo:[0,0,1] neg_hi:[0,0,1]
  v_pk_fma_f32 v[110:111], v[78:79], s[92:93], v[206:207] neg_lo:[0,0,1] neg_hi:[0,0,1]
  v_cvt_pk_bf16_f32 v108, 0, v108
  v_cvt_pk_bf16_f32 v109, 0, v109
  v_cvt_pk_bf16_f32 v110, 0, v110
  v_cvt_pk_bf16_f32 v111, 0, v111
  v_pk_mul_f32 v[108:109], v[108:109], v[192:193]
  v_pk_mul_f32 v[110:111], v[110:111], v[194:195]
  v_cvt_pk_bf16_f32 v216, v108, v109
  v_cvt_pk_bf16_f32 v217, v110, v111
  s_waitcnt vmcnt(20)
  buffer_load_dwordx4 v[52:55], v92, s[16:19], s61 offen offset:256 nt
  v_pk_fma_f32 v[108:109], v[80:81], s[92:93], v[208:209] neg_lo:[0,0,1] neg_hi:[0,0,1]
  v_pk_fma_f32 v[110:111], v[82:83], s[92:93], v[210:211] neg_lo:[0,0,1] neg_hi:[0,0,1]
  v_mov_b32_dpp v144, v224 quad_perm:[0,0,0,0] row_mask:0xf bank_mask:0xf
  v_mov_b32_dpp v145, v226 quad_perm:[2,2,2,2] row_mask:0xf bank_mask:0xf
  v_cvt_pk_bf16_f32 v108, 0, v108
  v_cvt_pk_bf16_f32 v109, 0, v109
  v_add_f32_dpp v144, v225, v144 quad_perm:[1,1,1,1] row_mask:0xf bank_mask:0xf
  v_add_f32_dpp v145, v227, v145 quad_perm:[3,3,3,3] row_mask:0xf bank_mask:0xf
  v_cvt_pk_bf16_f32 v110, 0, v110
  v_cvt_pk_bf16_f32 v111, 0, v111
  v_add_f32 v229, v144, v145
  v_pk_mul_f32 v[108:109], v[108:109], v[196:197]
  v_pk_mul_f32 v[110:111], v[110:111], v[198:199]
  v_cvt_pk_bf16_f32 v218, v108, v109
  v_cvt_pk_bf16_f32 v219, v110, v111
  s_waitcnt vmcnt(20)
  buffer_load_dwordx4 v[56:59], v92, s[16:19], s61 offen offset:512 nt
  v_mfma_f32_16x16x32_bf16 v[224:227], v[216:219], v[168:171], 0
  v_pk_fma_f32 v[108:109], v[84:85], s[92:93], v[212:213] neg_lo:[0,0,1] neg_hi:[0,0,1]
  v_pk_fma_f32 v[110:111], v[86:87], s[92:93], v[214:215] neg_lo:[0,0,1] neg_hi:[0,0,1]
  v_cvt_pk_bf16_f32 v108, 0, v108
  v_cvt_pk_bf16_f32 v228, 0, v228
  v_cvt_pk_bf16_f32 v109, 0, v109
  v_cvt_pk_bf16_f32 v229, 0, v229
  v_cvt_pk_bf16_f32 v110, 0, v110
  v_pk_mul_f32 v[228:229], v[228:229], s[68:69]
  v_cvt_pk_bf16_f32 v111, 0, v111
  v_cvt_pk_bf16_f32 v122, v228, v229
  v_pk_mul_f32 v[108:109], v[108:109], v[200:201]
  v_pk_mul_f32 v[110:111], v[110:111], v[202:203]
  v_cvt_pk_bf16_f32 v220, v108, v109
  v_cvt_pk_bf16_f32 v221, v110, v111
  s_waitcnt vmcnt(20)
  s_cbranch_vccnz L_kw0_21
  s_waitcnt vmcnt(15)
L_kw0_21:
  buffer_load_dwordx4 v[60:63], v93, s[16:19], s61 offen offset:0 nt
  v_mfma_f32_16x16x16_bf16 v[224:227], v[220:221], v[172:173], v[224:227]
  v_pk_fma_f32 v[108:109], v[88:89], s[92:93], v[204:205] neg_lo:[0,0,1] neg_hi:[0,0,1]
  v_pk_fma_f32 v[110:111], v[90:91], s[92:93], v[206:207] neg_lo:[0,0,1] neg_hi:[0,0,1]
  v_cvt_pk_bf16_f32 v108, 0, v108
  v_cvt_pk_bf16_f32 v109, 0, v109
  v_cvt_pk_bf16_f32 v110, 0, v110
  v_cvt_pk_bf16_f32 v111, 0, v111
  v_pk_mul_f32 v[108:109], v[108:109], v[192:193]
  v_pk_mul_f32 v[110:111], v[110:111], v[194:195]
  v_cvt_pk_bf16_f32 v216, v108, v109
  v_cvt_pk_bf16_f32 v217, v110, v111
  s_waitcnt vmcnt(20)
  buffer_load_dwordx4 v[64:67], v93, s[16:19], s61 offen offset:256 nt
  v_pk_fma_f32 v[108:109], v[4:5], s[92:93], v[208:209] neg_lo:[0,0,1] neg_hi:[0,0,1]
  v_pk_fma_f32 v[110:111], v[6:7], s[92:93], v[210:211] neg_lo:[0,0,1] neg_hi:[0,0,1]
  v_mov_b32_dpp v144, v224 quad_perm:[0,0,0,0] row_mask:0xf bank_mask:0xf
  v_mov_b32_dpp v145, v226 quad_perm:[2,2,2,2] row_mask:0xf bank_mask:0xf
  v_cvt_pk_bf16_f32 v108, 0, v108
  v_cvt_pk_bf16_f32 v109, 0, v109
  v_add_f32_dpp v144, v225, v144 quad_perm:[1,1,1,1] row_mask:0xf bank_mask:0xf
  v_add_f32_dpp v145, v227, v145 quad_perm:[3,3,3,3] row_mask:0xf bank_mask:0xf
  v_cvt_pk_bf16_f32 v110, 0, v110
  v_cvt_pk_bf16_f32 v111, 0, v111
  v_add_f32 v228, v144, v145
  v_pk_mul_f32 v[108:109], v[108:109], v[196:197]
  v_pk_mul_f32 v[110:111], v[110:111], v[198:199]
  v_cvt_pk_bf16_f32 v218, v108, v109
  v_cvt_pk_bf16_f32 v219, v110, v111
  s_waitcnt vmcnt(20)
  buffer_load_dwordx4 v[68:71], v93, s[16:19], s61 offen offset:512 nt
  v_mfma_f32_16x16x32_bf16 v[224:227], v[216:219], v[168:171], 0
  v_pk_fma_f32 v[108:109], v[8:9], s[92:93], v[212:213] neg_lo:[0,0,1] neg_hi:[0,0,1]
  v_pk_fma_f32 v[110:111], v[10:11], s[92:93], v[214:215] neg_lo:[0,0,1] neg_hi:[0,0,1]
  v_cvt_pk_bf16_f32 v108, 0, v108
  v_cvt_pk_bf16_f32 v109, 0, v109
  v_cvt_pk_bf16_f32 v110, 0, v110
  v_cvt_pk_bf16_f32 v111, 0, v111
  v_pk_mul_f32 v[108:109], v[108:109], v[200:201]
  v_pk_mul_f32 v[110:111], v[110:111], v[202:203]
  v_cvt_pk_bf16_f32 v220, v108, v109
  v_cvt_pk_bf16_f32 v221, v110, v111
  s_waitcnt vmcnt(20)
  s_cbranch_vccnz L_kw0_24
  s_waitcnt vmcnt(15)
L_kw0_24:
  buffer_load_dwordx4 v[72:75], v93, s[16:19], s61 offen offset:768 nt
  v_mfma_f32_16x16x16_bf16 v[224:227], v[220:221], v[172:173], v[224:227]
  v_pk_fma_f32 v[108:109], v[12:13], s[92:93], v[204:205] neg_lo:[0,0,1] neg_hi:[0,0,1]
  v_pk_fma_f32 v[110:111], v[14:15], s[92:93], v[206:207] neg_lo:[0,0,1] neg_hi:[0,0,1]
  v_cvt_pk_bf16_f32 v108, 0, v108
  v_cvt_pk_bf16_f32 v109, 0, v109
  v_cvt_pk_bf16_f32 v110, 0, v110
  v_cvt_pk_bf16_f32 v111, 0, v111
  v_pk_mul_f32 v[108:109], v[108:109], v[192:193]
  v_pk_mul_f32 v[110:111], v[110:111], v[194:195]
  v_cvt_pk_bf16_f32 v216, v108, v109
  v_cvt_pk_bf16_f32 v217, v110, v111
  s_waitcnt vmcnt(20)
  buffer_load_dwordx4 v[76:79], v93, s[16:19], s61 offen offset:1024 nt
  v_pk_fma_f32 v[108:109], v[16:17], s[92:93], v[208:209] neg_lo:[0,0,1] neg_hi:[0,0,1]
  v_pk_fma_f32 v[110:111], v[18:19], s[92:93], v[210:211] neg_lo:[0,0,1] neg_hi:[0,0,1]
  v_mov_b32_dpp v144, v224 quad_perm:[0,0,0,0] row_mask:0xf bank_mask:0xf
  v_mov_b32_dpp v145, v226 quad_perm:[2,2,2,2] row_mask:0xf bank_mask:0xf
  v_cvt_pk_bf16_f32 v108, 0, v108
  v_cvt_pk_bf16_f32 v109, 0, v109
  v_add_f32_dpp v144, v225, v144 quad_perm:[1,1,1,1] row_mask:0xf bank_mask:0xf
  v_add_f32_dpp v145, v227, v145 quad_perm:[3,3,3,3] row_mask:0xf bank_mask:0xf
  v_cvt_pk_bf16_f32 v110, 0, v110
  v_cvt_pk_bf16_f32 v111, 0, v111
  v_add_f32 v229, v144, v145
  v_pk_mul_f32 v[108:109], v[108:109], v[196:197]
  v_pk_mul_f32 v[110:111], v[110:111], v[198:199]
  v_cvt_pk_bf16_f32 v218, v108, v109
  v_cvt_pk_bf16_f32 v219, v110, v111
  s_waitcnt vmcnt(20)
  buffer_load_dwordx4 v[80:83], v93, s[16:19], s61 offen offset:1280 nt
  v_mfma_f32_16x16x32_bf16 v[224:227], v[216:219], v[168:171], 0
  v_pk_fma_f32 v[108:109], v[20:21], s[92:93], v[212:213] neg_lo:[0,0,1] neg_hi:[0,0,1]
  v_pk_fma_f32 v[110:111], v[22:23], s[92:93], v[214:215] neg_lo:[0,0,1] neg_hi:[0,0,1]
  v_cvt_pk_bf16_f32 v108, 0, v108
  v_cvt_pk_bf16_f32 v228, 0, v228
  v_cvt_pk_bf16_f32 v109, 0, v109
  v_cvt_pk_bf16_f32 v229, 0, v229
  v_cvt_pk_bf16_f32 v110, 0, v110
  v_pk_mul_f32 v[228:229], v[228:229], s[68:69]
  v_cvt_pk_bf16_f32 v111, 0, v111
  v_cvt_pk_bf16_f32 v123, v228, v229
  v_pk_mul_f32 v[108:109], v[108:109], v[200:201]
  v_pk_mul_f32 v[110:111], v[110:111], v[202:203]
  v_cvt_pk_bf16_f32 v220, v108, v109
  v_cvt_pk_bf16_f32 v221, v110, v111
  s_waitcnt vmcnt(20)
  s_cbranch_vccnz L_kw0_27
  s_waitcnt vmcnt(15)
L_kw0_27:
  buffer_load_dwordx4 v[84:87], v93, s[16:19], s61 offen offset:1536 nt
  v_mfma_f32_16x16x16_bf16 v[224:227], v[220:221], v[172:173], v[224:227]
  v_pk_fma_f32 v[108:109], v[24:25], s[92:93], v[204:205] neg_lo:[0,0,1] neg_hi:[0,0,1]
  v_pk_fma_f32 v[110:111], v[26:27], s[92:93], v[206:207] neg_lo:[0,0,1] neg_hi:[0,0,1]
  v_cvt_pk_bf16_f32 v108, 0, v108
  v_cvt_pk_bf16_f32 v109, 0, v109
  v_cvt_pk_bf16_f32 v110, 0, v110
  v_cvt_pk_bf16_f32 v111, 0, v111
  v_pk_mul_f32 v[108:109], v[108:109], v[192:193]
  v_pk_mul_f32 v[110:111], v[110:111], v[194:195]
  v_cvt_pk_bf16_f32 v216, v108, v109
  v_cvt_pk_bf16_f32 v217, v110, v111
  s_waitcnt vmcnt(20)
  buffer_load_dwordx4 v[88:91], v93, s[16:19], s61 offen offset:1792 nt
  v_pk_fma_f32 v[108:109], v[28:29], s[92:93], v[208:209] neg_lo:[0,0,1] neg_hi:[0,0,1]
  v_pk_fma_f32 v[110:111], v[30:31], s[92:93], v[210:211] neg_lo:[0,0,1] neg_hi:[0,0,1]
  v_mov_b32_dpp v144, v224 quad_perm:[0,0,0,0] row_mask:0xf bank_mask:0xf
  v_mov_b32_dpp v145, v226 quad_perm:[2,2,2,2] row_mask:0xf bank_mask:0xf
  v_cvt_pk_bf16_f32 v108, 0, v108
  v_cvt_pk_bf16_f32 v109, 0, v109
  v_add_f32_dpp v144, v225, v144 quad_perm:[1,1,1,1] row_mask:0xf bank_mask:0xf
  v_add_f32_dpp v145, v227, v145 quad_perm:[3,3,3,3] row_mask:0xf bank_mask:0xf
  v_cvt_pk_bf16_f32 v110, 0, v110
  v_cvt_pk_bf16_f32 v111, 0, v111
  v_add_f32 v228, v144, v145
  v_pk_mul_f32 v[108:109], v[108:109], v[196:197]
  v_pk_mul_f32 v[110:111], v[110:111], v[198:199]
  v_cvt_pk_bf16_f32 v218, v108, v109
  v_cvt_pk_bf16_f32 v219, v110, v111
  s_waitcnt vmcnt(20)
  buffer_load_dwordx4 v[4:7], v93, s[16:19], s61 offen offset:2048 nt
  v_mfma_f32_16x16x32_bf16 v[224:227], v[216:219], v[168:171], 0
  v_pk_fma_f32 v[108:109], v[32:33], s[92:93], v[212:213] neg_lo:[0,0,1] neg_hi:[0,0,1]
  v_pk_fma_f32 v[110:111], v[34:35], s[92:93], v[214:215] neg_lo:[0,0,1] neg_hi:[0,0,1]
  v_cvt_pk_bf16_f32 v108, 0, v108
  v_cvt_pk_bf16_f32 v109, 0, v109
  v_cvt_pk_bf16_f32 v110, 0, v110
  v_cvt_pk_bf16_f32 v111, 0, v111
  v_pk_mul_f32 v[108:109], v[108:109], v[200:201]
  v_pk_mul_f32 v[110:111], v[110:111], v[202:203]
  v_cvt_pk_bf16_f32 v220, v108, v109
  v_cvt_pk_bf16_f32 v221, v110, v111
  s_waitcnt vmcnt(20)
  s_cbranch_vccnz L_kw0_30
  s_waitcnt vmcnt(9)
L_kw0_30:
  buffer_load_dwordx4 v[8:11], v93, s[16:19], s61 offen offset:2304 nt
  v_mfma_f32_16x16x16_bf16 v[224:227], v[220:221], v[172:173], v[224:227]
  v_pk_fma_f32 v[108:109], v[36:37], s[92:93], v[204:205] neg_lo:[0,0,1] neg_hi:[0,0,1]
  v_pk_fma_f32 v[110:111], v[38:39], s[92:93], v[206:207] neg_lo:[0,0,1] neg_hi:[0,0,1]
  v_cvt_pk_bf16_f32 v108, 0, v108
  v_cvt_pk_bf16_f32 v109, 0, v109
  v_cvt_pk_bf16_f32 v110, 0, v110
  v_cvt_pk_bf16_f32 v111, 0, v111
  v_pk_mul_f32 v[108:109], v[108:109], v[192:193]
  v_pk_mul_f32 v[110:111], v[110:111], v[194:195]
  v_cvt_pk_bf16_f32 v216, v108, v109
  v_cvt_pk_bf16_f32 v217, v110, v111
  s_waitcnt vmcnt(20)
  buffer_load_dwordx4 v[12:15], v93, s[16:19], s61 offen offset:2560 nt
  v_pk_fma_f32 v[108:109], v[40:41], s[92:93], v[208:209] neg_lo:[0,0,1] neg_hi:[0,0,1]
  v_pk_fma_f32 v[110:111], v[42:43], s[92:93], v[210:211] neg_lo:[0,0,1] neg_hi:[0,0,1]
  v_mov_b32_dpp v144, v224 quad_perm:[0,0,0,0] row_mask:0xf bank_mask:0xf
  v_mov_b32_dpp v145, v226 quad_perm:[2,2,2,2] row_mask:0xf bank_mask:0xf
  v_cvt_pk_bf16_f32 v108, 0, v108
  v_cvt_pk_bf16_f32 v109, 0, v109
  v_add_f32_dpp v144, v225, v144 quad_perm:[1,1,1,1] row_mask:0xf bank_mask:0xf
  v_add_f32_dpp v145, v227, v145 quad_perm:[3,3,3,3] row_mask:0xf bank_mask:0xf
  v_cvt_pk_bf16_f32 v110, 0, v110
  v_cvt_pk_bf16_f32 v111, 0, v111
  v_add_f32 v229, v144, v145
  v_pk_mul_f32 v[108:109], v[108:109], v[196:197]
  v_pk_mul_f32 v[110:111], v[110:111], v[198:199]
  v_cvt_pk_bf16_f32 v218, v108, v109
  v_cvt_pk_bf16_f32 v219, v110, v111
  s_waitcnt vmcnt(20)
  buffer_load_dwordx4 v[16:19], v93, s[16:19], s61 offen offset:2816 nt
  v_mfma_f32_16x16x32_bf16 v[224:227], v[216:219], v[168:171], 0
  v_pk_fma_f32 v[108:109], v[44:45], s[92:93], v[212:213] neg_lo:[0,0,1] neg_hi:[0,0,1]
  v_pk_fma_f32 v[110:111], v[46:47], s[92:93], v[214:215] neg_lo:[0,0,1] neg_hi:[0,0,1]
  v_cvt_pk_bf16_f32 v108, 0, v108
  v_cvt_pk_bf16_f32 v228, 0, v228
  v_cvt_pk_bf16_f32 v109, 0, v109
  v_cvt_pk_bf16_f32 v229, 0, v229
  v_cvt_pk_bf16_f32 v110, 0, v110
  v_pk_mul_f32 v[228:229], v[228:229], s[68:69]
  v_cvt_pk_bf16_f32 v111, 0, v111
  v_cvt_pk_bf16_f32 v124, v228, v229
  v_pk_mul_f32 v[108:109], v[108:109], v[200:201]
  v_pk_mul_f32 v[110:111], v[110:111], v[202:203]
  v_cvt_pk_bf16_f32 v220, v108, v109
  v_cvt_pk_bf16_f32 v221, v110, v111
  s_mov_b32 s60, s61
  v_mov_b32 v146, s64
  v_mfma_f32_16x16x16_bf16 v[224:227], v[220:221], v[172:173], v[224:227]
  ds_write_b128 v99, v[120:123]
  v_add_u32 v99, 768, v99
  s_nop 5
  v_mov_b32_dpp v144, v224 quad_perm:[0,0,0,0] row_mask:0xf bank_mask:0xf
  v_mov_b32_dpp v145, v226 quad_perm:[2,2,2,2] row_mask:0xf bank_mask:0xf
  s_nop 0
  v_add_f32_dpp v144, v225, v144 quad_perm:[1,1,1,1] row_mask:0xf bank_mask:0xf
  v_add_f32_dpp v145, v227, v145 quad_perm:[3,3,3,3] row_mask:0xf bank_mask:0xf
  v_add_f32 v228, v144, v145
  v_cndmask_b32 v228, v228, v236, s[50:51]
  v_cvt_pk_bf16_f32 v228, 0, v228
  v_cvt_pk_bf16_f32 v229, 0, v229
  v_pk_mul_f32 v[228:229], v[228:229], s[68:69]
  v_cvt_pk_bf16_f32 v125, v228, v229
  ds_write_b64 v100, v[124:125] offset:256
  ds_write_b32 v104, v146
  v_add_u32 v100, 768, v100
  v_add_u32 v144, s85, v2
  v_lshrrev_b32 v145, v144, s91
  v_and_b32 v145, 1, v145
  v_cmp_eq_u32 s[50:51], 1, v145
  s_nop 1
  s_and_b64 s[48:49], s[50:51], s[58:59]
  s_andn2_b64 s[50:51], s[50:51], s[58:59]
  s_mov_b32 s97, s64
  s_add_u32 s64, s64, 2
  ds_read_b32 v106, v104 offset:8
  s_waitcnt vmcnt(14)
  s_cbranch_vccnz L_kw1_0
  s_waitcnt vmcnt(9)
L_kw1_0:
  buffer_load_dwordx4 v[20:23], v93, s[8:11], s60 offen offset:3072 nt
  v_lshlrev_b32 v204, 16, v186
  v_and_b32 v205, s65, v186
  v_lshlrev_b32 v206, 16, v187
  v_and_b32 v207, s65, v187
  v_lshlrev_b32 v192, 16, v180
  v_and_b32 v193, s65, v180
  v_lshlrev_b32 v194, 16, v181
  v_and_b32 v195, s65, v181
  v_pk_mul_f32 v[204:205], v[204:205], s[94:95]
  v_mov_b32 v168, v174
  v_pk_mul_f32 v[206:207], v[206:207], s[94:95]
  v_mov_b32 v169, v175
  v_pk_fma_f32 v[108:109], v[48:49], s[92:93], v[204:205] neg_lo:[0,0,1] neg_hi:[0,0,1]
  v_pk_fma_f32 v[110:111], v[50:51], s[92:93], v[206:207] neg_lo:[0,0,1] neg_hi:[0,0,1]
  v_cvt_pk_bf16_f32 v108, 0, v108
  v_cvt_pk_bf16_f32 v109, 0, v109
  v_cvt_pk_bf16_f32 v110, 0, v110
  v_cvt_pk_bf16_f32 v111, 0, v111
  v_pk_mul_f32 v[108:109], v[108:109], v[192:193]
  v_pk_mul_f32 v[110:111], v[110:111], v[194:195]
  v_cvt_pk_bf16_f32 v216, v108, v109
  v_cvt_pk_bf16_f32 v217, v110, v111
  s_waitcnt lgkmcnt(0)
  v_cmp_lt_u32 vcc, s97, v106
  s_waitcnt vmcnt(14)
  buffer_load_dwordx4 v[24:27], v93, s[8:11], s60 offen offset:3328 nt
  v_lshlrev_b32 v208, 16, v188
  v_and_b32 v209, s65, v188
  v_lshlrev_b32 v210, 16, v189
  v_and_b32 v211, s65, v189
  v_lshlrev_b32 v196, 16, v182
  v_and_b32 v197, s65, v182
  v_lshlrev_b32 v198, 16, v183
  v_and_b32 v199, s65, v183
  v_pk_mul_f32 v[208:209], v[208:209], s[94:95]
  v_mov_b32 v170, v176
  v_pk_mul_f32 v[210:211], v[210:211], s[94:95]
  v_mov_b32 v171, v177
  v_pk_fma_f32 v[108:109], v[52:53], s[92:93], v[208:209] neg_lo:[0,0,1] neg_hi:[0,0,1]
  v_pk_fma_f32 v[110:111], v[54:55], s[92:93], v[210:211] neg_lo:[0,0,1] neg_hi:[0,0,1]
  v_cvt_pk_bf16_f32 v108, 0, v108
  v_cvt_pk_bf16_f32 v109, 0, v109
  v_cvt_pk_bf16_f32 v110, 0, v110
  v_cvt_pk_bf16_f32 v111, 0, v111
  v_pk_mul_f32 v[108:109], v[108:109], v[196:197]
  v_pk_mul_f32 v[110:111], v[110:111], v[198:199]
  v_cvt_pk_bf16_f32 v218, v108, v109
  v_cvt_pk_bf16_f32 v219, v110, v111
  s_waitcnt vmcnt(14)
  buffer_load_dwordx4 v[28:31], v93, s[8:11], s60 offen offset:3584 nt
  v_mfma_f32_16x16x32_bf16 v[224:227], v[216:219], v[168:171], 0
  v_lshlrev_b32 v212, 16, v190
  v_and_b32 v213, s65, v190
  v_lshlrev_b32 v214, 16, v191
  v_and_b32 v215, s65, v191
  v_lshlrev_b32 v200, 16, v184
  v_and_b32 v201, s65, v184
  v_lshlrev_b32 v202, 16, v185
  v_and_b32 v203, s65, v185
  v_pk_mul_f32 v[212:213], v[212:213], s[94:95]
  v_mov_b32 v172, v178
  v_pk_mul_f32 v[214:215], v[214:215], s[94:95]
  v_mov_b32 v173, v179
  v_pk_fma_f32 v[108:109], v[56:57], s[92:93], v[212:213] neg_lo:[0,0,1] neg_hi:[0,0,1]
  v_pk_fma_f32 v[110:111], v[58:59], s[92:93], v[214:215] neg_lo:[0,0,1] neg_hi:[0,0,1]
  v_cvt_pk_bf16_f32 v108, 0, v108
  v_cvt_pk_bf16_f32 v109, 0, v109
  v_cvt_pk_bf16_f32 v110, 0, v110
  v_cvt_pk_bf16_f32 v111, 0, v111
  v_pk_mul_f32 v[108:109], v[108:109], v[200:201]
  v_pk_mul_f32 v[110:111], v[110:111], v[202:203]
  v_cvt_pk_bf16_f32 v220, v108, v109
  v_cvt_pk_bf16_f32 v221, v110, v111
  s_waitcnt vmcnt(14)
  s_cbranch_vccnz L_kw1_3
  s_waitcnt vmcnt(9)
L_kw1_3:
  buffer_load_dwordx4 v[32:35], v94, s[8:11], s60 offen offset:0 nt
  v_mfma_f32_16x16x16_bf16 v[224:227], v[220:221], v[172:173], v[224:227]
  v_pk_fma_f32 v[108:109], v[60:61], s[92:93], v[204:205] neg_lo:[0,0,1] neg_hi:[0,0,1]
  v_pk_fma_f32 v[110:111], v[62:63], s[92:93], v[206:207] neg_lo:[0,0,1] neg_hi:[0,0,1]
  v_cvt_pk_bf16_f32 v108, 0, v108
  v_cvt_pk_bf16_f32 v109, 0, v109
  v_cvt_pk_bf16_f32 v110, 0, v110
  v_cvt_pk_bf16_f32 v111, 0, v111
  v_pk_mul_f32 v[108:109], v[108:109], v[192:193]
  v_pk_mul_f32 v[110:111], v[110:111], v[194:195]
  v_cvt_pk_bf16_f32 v216, v108, v109
  v_cvt_pk_bf16_f32 v217, v110, v111
  s_waitcnt vmcnt(14)
  buffer_load_dwordx4 v[36:39], v94, s[8:11], s60 offen offset:256 nt
  v_pk_fma_f32 v[108:109], v[64:65], s[92:93], v[208:209] neg_lo:[0,0,1] neg_hi:[0,0,1]
  v_pk_fma_f32 v[110:111], v[66:67], s[92:93], v[210:211] neg_lo:[0,0,1] neg_hi:[0,0,1]
  v_mov_b32_dpp v144, v224 quad_perm:[0,0,0,0] row_mask:0xf bank_mask:0xf
  v_mov_b32_dpp v145, v226 quad_perm:[2,2,2,2] row_mask:0xf bank_mask:0xf
  v_cvt_pk_bf16_f32 v108, 0, v108
  v_cvt_pk_bf16_f32 v109, 0, v109
  v_add_f32_dpp v144, v225, v144 quad_perm:[1,1,1,1] row_mask:0xf bank_mask:0xf
  v_add_f32_dpp v145, v227, v145 quad_perm:[3,3,3,3] row_mask:0xf bank_mask:0xf
  v_cvt_pk_bf16_f32 v110, 0, v110
  v_cvt_pk_bf16_f32 v111, 0, v111
  v_add_f32 v228, v144, v145
  v_pk_mul_f32 v[108:109], v[108:109], v[196:197]
  v_pk_mul_f32 v[110:111], v[110:111], v[198:199]
  v_cvt_pk_bf16_f32 v218, v108, v109
  v_cvt_pk_bf16_f32 v219, v110, v111
  s_waitcnt vmcnt(14)
  buffer_load_dwordx4 v[40:43], v94, s[8:11], s60 offen offset:512 nt
  v_mfma_f32_16x16x32_bf16 v[224:227], v[216:219], v[168:171], 0
  v_pk_fma_f32 v[108:109], v[68:69], s[92:93], v[212:213] neg_lo:[0,0,1] neg_hi:[0,0,1]
  v_pk_fma_f32 v[110:111], v[70:71], s[92:93], v[214:215] neg_lo:[0,0,1] neg_hi:[0,0,1]
  v_cvt_pk_bf16_f32 v108, 0, v108
  v_cndmask_b32 v228, v228, v236, s[48:49]
  v_cvt_pk_bf16_f32 v109, 0, v109
  v_cvt_pk_bf16_f32 v110, 0, v110
  v_cvt_pk_bf16_f32 v111, 0, v111
  v_pk_mul_f32 v[108:109], v[108:109], v[200:201]
  v_pk_mul_f32 v[110:111], v[110:111], v[202:203]
  v_cvt_pk_bf16_f32 v220, v108, v109
  v_cvt_pk_bf16_f32 v221, v110, v111
  s_waitcnt vmcnt(14)
  s_cbranch_vccnz L_kw1_6
  s_waitcnt vmcnt(9)
L_kw1_6:
  buffer_load_dwordx4 v[44:47], v94, s[8:11], s60 offen offset:768 nt
  v_mfma_f32_16x16x16_bf16 v[224:227], v[220:221], v[172:173], v[224:227]
  v_pk_fma_f32 v[108:109], v[72:73], s[92:93], v[204:205] neg_lo:[0,0,1] neg_hi:[0,0,1]
  v_pk_fma_f32 v[110:111], v[74:75], s[92:93], v[206:207] neg_lo:[0,0,1] neg_hi:[0,0,1]
  v_cvt_pk_bf16_f32 v108, 0, v108
  v_cvt_pk_bf16_f32 v109, 0, v109
  v_cvt_pk_bf16_f32 v110, 0, v110
  v_cvt_pk_bf16_f32 v111, 0, v111
  v_pk_mul_f32 v[108:109], v[108:109], v[192:193]
  v_pk_mul_f32 v[110:111], v[110:111], v[194:195]
  v_cvt_pk_bf16_f32 v216, v108, v109
  v_cvt_pk_bf16_f32 v217, v110, v111
  s_waitcnt vmcnt(14)
  buffer_load_dwordx4 v[48:51], v94, s[8:11], s60 offen offset:1024 nt
  v_pk_fma_f32 v[108:109], v[76:77], s[92:93], v[208:209] neg_lo:[0,0,1] neg_hi:[0,0,1]
  v_pk_fma_f32 v[110:111], v[78:79], s[92:93], v[210:211] neg_lo:[0,0,1] neg_hi:[0,0,1]
  v_mov_b32_dpp v144, v224 quad_perm:[0,0,0,0] row_mask:0xf bank_mask:0xf
  v_mov_b32_dpp v145, v226 quad_perm:[2,2,2,2] row_mask:0xf bank_mask:0xf
  v_cvt_pk_bf16_f32 v108, 0, v108
  v_cvt_pk_bf16_f32 v109, 0, v109
  v_add_f32_dpp v144, v225, v144 quad_perm:[1,1,1,1] row_mask:0xf bank_mask:0xf
  v_add_f32_dpp v145, v227, v145 quad_perm:[3,3,3,3] row_mask:0xf bank_mask:0xf
  v_cvt_pk_bf16_f32 v110, 0, v110
  v_cvt_pk_bf16_f32 v111, 0, v111
  v_add_f32 v229, v144, v145
  v_pk_mul_f32 v[108:109], v[108:109], v[196:197]
  v_pk_mul_f32 v[110:111], v[110:111], v[198:199]
  v_cvt_pk_bf16_f32 v218, v108, v109
  v_cvt_pk_bf16_f32 v219, v110, v111
  s_waitcnt vmcnt(14)
  buffer_load_dwordx4 v[52:55], v94, s[8:11], s60 offen offset:1280 nt
  v_mfma_f32_16x16x32_bf16 v[224:227], v[216:219], v[168:171], 0
  v_pk_fma_f32 v[108:109], v[80:81], s[92:93], v[212:213] neg_lo:[0,0,1] neg_hi:[0,0,1]
  v_pk_fma_f32 v[110:111], v[82:83], s[92:93], v[214:215] neg_lo:[0,0,1] neg_hi:[0,0,1]
  v_cvt_pk_bf16_f32 v108, 0, v108
  v_cvt_pk_bf16_f32 v228, 0, v228
  v_cvt_pk_bf16_f32 v109, 0, v109
  v_cvt_pk_bf16_f32 v229, 0, v229
  v_cvt_pk_bf16_f32 v110, 0, v110
  v_pk_mul_f32 v[228:229], v[228:229], s[68:69]
  v_cvt_pk_bf16_f32 v111, 0, v111
  v_cvt_pk_bf16_f32 v120, v228, v229
  v_pk_mul_f32 v[108:109], v[108:109], v[200:201]
  v_pk_mul_f32 v[110:111], v[110:111], v[202:203]
  v_cvt_pk_bf16_f32 v220, v108, v109
  v_cvt_pk_bf16_f32 v221, v110, v111
  s_waitcnt vmcnt(14)
  s_cbranch_vccnz L_kw1_9
  s_waitcnt vmcnt(9)
L_kw1_9:
  buffer_load_dwordx4 v[56:59], v94, s[8:11], s60 offen offset:1536 nt
  v_mfma_f32_16x16x16_bf16 v[224:227], v[220:221], v[172:173], v[224:227]
  v_pk_fma_f32 v[108:109], v[84:85], s[92:93], v[204:205] neg_lo:[0,0,1] neg_hi:[0,0,1]
  v_pk_fma_f32 v[110:111], v[86:87], s[92:93], v[206:207] neg_lo:[0,0,1] neg_hi:[0,0,1]
  v_cvt_pk_bf16_f32 v108, 0, v108
  v_cvt_pk_bf16_f32 v109, 0, v109
  v_cvt_pk_bf16_f32 v110, 0, v110
  v_cvt_pk_bf16_f32 v111, 0, v111
  v_pk_mul_f32 v[108:109], v[108:109], v[192:193]
  v_pk_mul_f32 v[110:111], v[110:111], v[194:195]
  v_cvt_pk_bf16_f32 v216, v108, v109
  v_cvt_pk_bf16_f32 v217, v110, v111
  s_waitcnt vmcnt(14)
  buffer_load_dwordx4 v[60:63], v94, s[8:11], s60 offen offset:1792 nt
  v_pk_fma_f32 v[108:109], v[88:89], s[92:93], v[208:209] neg_lo:[0,0,1] neg_hi:[0,0,1]
  v_pk_fma_f32 v[110:111], v[90:91], s[92:93], v[210:211] neg_lo:[0,0,1] neg_hi:[0,0,1]
  v_mov_b32_dpp v144, v224 quad_perm:[0,0,0,0] row_mask:0xf bank_mask:0xf
  v_mov_b32_dpp v145, v226 quad_perm:[2,2,2,2] row_mask:0xf bank_mask:0xf
  v_cvt_pk_bf16_f32 v108, 0, v108
  v_cvt_pk_bf16_f32 v109, 0, v109
  v_add_f32_dpp v144, v225, v144 quad_perm:[1,1,1,1] row_mask:0xf bank_mask:0xf
  v_add_f32_dpp v145, v227, v145 quad_perm:[3,3,3,3] row_mask:0xf bank_mask:0xf
  v_cvt_pk_bf16_f32 v110, 0, v110
  v_cvt_pk_bf16_f32 v111, 0, v111
  v_add_f32 v228, v144, v145
  v_pk_mul_f32 v[108:109], v[108:109], v[196:197]
  v_pk_mul_f32 v[110:111], v[110:111], v[198:199]
  v_cvt_pk_bf16_f32 v218, v108, v109
  v_cvt_pk_bf16_f32 v219, v110, v111
  s_waitcnt vmcnt(14)
  buffer_load_dwordx4 v[64:67], v94, s[8:11], s60 offen offset:2048 nt
  v_mfma_f32_16x16x32_bf16 v[224:227], v[216:219], v[168:171], 0
  v_pk_fma_f32 v[108:109], v[4:5], s[92:93], v[212:213] neg_lo:[0,0,1] neg_hi:[0,0,1]
  v_pk_fma_f32 v[110:111], v[6:7], s[92:93], v[214:215] neg_lo:[0,0,1] neg_hi:[0,0,1]
  v_cvt_pk_bf16_f32 v108, 0, v108
  v_cvt_pk_bf16_f32 v109, 0, v109
  v_cvt_pk_bf16_f32 v110, 0, v110
  v_cvt_pk_bf16_f32 v111, 0, v111
  v_pk_mul_f32 v[108:109], v[108:109], v[200:201]
  v_pk_mul_f32 v[110:111], v[110:111], v[202:203]
  v_cvt_pk_bf16_f32 v220, v108, v109
  v_cvt_pk_bf16_f32 v221, v110, v111
  s_waitcnt vmcnt(14)
  s_cbranch_vccnz L_kw1_12
  s_waitcnt vmcnt(9)
L_kw1_12:
  buffer_load_dwordx4 v[68:71], v94, s[8:11], s60 offen offset:2304 nt
  v_mfma_f32_16x16x16_bf16 v[224:227], v[220:221], v[172:173], v[224:227]
  v_pk_fma_f32 v[108:109], v[8:9], s[92:93], v[204:205] neg_lo:[0,0,1] neg_hi:[0,0,1]
  v_pk_fma_f32 v[110:111], v[10:11], s[92:93], v[206:207] neg_lo:[0,0,1] neg_hi:[0,0,1]
  v_cvt_pk_bf16_f32 v108, 0, v108
  v_cvt_pk_bf16_f32 v109, 0, v109
  v_cvt_pk_bf16_f32 v110, 0, v110
  v_cvt_pk_bf16_f32 v111, 0, v111
  v_pk_mul_f32 v[108:109], v[108:109], v[192:193]
  v_pk_mul_f32 v[110:111], v[110:111], v[194:195]
  v_cvt_pk_bf16_f32 v216, v108, v109
  v_cvt_pk_bf16_f32 v217, v110, v111
  s_waitcnt vmcnt(14)
  buffer_load_dwordx4 v[72:75], v94, s[8:11], s60 offen offset:2560 nt
  v_pk_fma_f32 v[108:109], v[12:13], s[92:93], v[208:209] neg_lo:[0,0,1] neg_hi:[0,0,1]
  v_pk_fma_f32 v[110:111], v[14:15], s[92:93], v[210:211] neg_lo:[0,0,1] neg_hi:[0,0,1]
  v_mov_b32_dpp v144, v224 quad_perm:[0,0,0,0] row_mask:0xf bank_mask:0xf
  v_mov_b32_dpp v145, v226 quad_perm:[2,2,2,2] row_mask:0xf bank_mask:0xf
  v_cvt_pk_bf16_f32 v108, 0, v108
  v_cvt_pk_bf16_f32 v109, 0, v109
  v_add_f32_dpp v144, v225, v144 quad_perm:[1,1,1,1] row_mask:0xf bank_mask:0xf
  v_add_f32_dpp v145, v227, v145 quad_perm:[3,3,3,3] row_mask:0xf bank_mask:0xf
  v_cvt_pk_bf16_f32 v110, 0, v110
  v_cvt_pk_bf16_f32 v111, 0, v111
  v_add_f32 v229, v144, v145
  v_pk_mul_f32 v[108:109], v[108:109], v[196:197]
  v_pk_mul_f32 v[110:111], v[110:111], v[198:199]
  v_cvt_pk_bf16_f32 v218, v108, v109
  v_cvt_pk_bf16_f32 v219, v110, v111
  s_waitcnt vmcnt(14)
  buffer_load_dwordx4 v[76:79], v94, s[8:11], s60 offen offset:2816 nt
  v_mfma_f32_16x16x32_bf16 v[224:227], v[216:219], v[168:171], 0
  v_pk_fma_f32 v[108:109], v[16:17], s[92:93], v[212:213] neg_lo:[0,0,1] neg_hi:[0,0,1]
  v_pk_fma_f32 v[110:111], v[18:19], s[92:93], v[214:215] neg_lo:[0,0,1] neg_hi:[0,0,1]
  v_cvt_pk_bf16_f32 v108, 0, v108
  v_cvt_pk_bf16_f32 v228, 0, v228
  v_cvt_pk_bf16_f32 v109, 0, v109
  v_cvt_pk_bf16_f32 v229, 0, v229
  v_cvt_pk_bf16_f32 v110, 0, v110
  v_pk_mul_f32 v[228:229], v[228:229], s[68:69]
  v_cvt_pk_bf16_f32 v111, 0, v111
  v_cvt_pk_bf16_f32 v121, v228, v229
  v_pk_mul_f32 v[108:109], v[108:109], v[200:201]
  v_pk_mul_f32 v[110:111], v[110:111], v[202:203]
  v_cvt_pk_bf16_f32 v220, v108, v109
  v_cvt_pk_bf16_f32 v221, v110, v111
  s_waitcnt vmcnt(14)
  s_cbranch_vccnz L_kw1_15
  s_waitcnt vmcnt(9)
L_kw1_15:
  buffer_load_dwordx4 v[80:83], v95, s[8:11], s60 offen offset:0 nt
  v_mfma_f32_16x16x16_bf16 v[224:227], v[220:221], v[172:173], v[224:227]
  v_pk_fma_f32 v[108:109], v[20:21], s[92:93], v[204:205] neg_lo:[0,0,1] neg_hi:[0,0,1]
  v_pk_fma_f32 v[110:111], v[22:23], s[92:93], v[206:207] neg_lo:[0,0,1] neg_hi:[0,0,1]
  v_cvt_pk_bf16_f32 v108, 0, v108
  v_cvt_pk_bf16_f32 v109, 0, v109
  v_cvt_pk_bf16_f32 v110, 0, v110
  v_cvt_pk_bf16_f32 v111, 0, v111
  v_pk_mul_f32 v[108:109], v[108:109], v[192:193]
  v_pk_mul_f32 v[110:111], v[110:111], v[194:195]
  v_cvt_pk_bf16_f32 v216, v108, v109
  v_cvt_pk_bf16_f32 v217, v110, v111
  s_waitcnt vmcnt(14)
  buffer_load_dwordx4 v[84:87], v95, s[8:11], s60 offen offset:256 nt
  v_pk_fma_f32 v[108:109], v[24:25], s[92:93], v[208:209] neg_lo:[0,0,1] neg_hi:[0,0,1]
  v_pk_fma_f32 v[110:111], v[26:27], s[92:93], v[210:211] neg_lo:[0,0,1] neg_hi:[0,0,1]
  v_mov_b32_dpp v144, v224 quad_perm:[0,0,0,0] row_mask:0xf bank_mask:0xf
  v_mov_b32_dpp v145, v226 quad_perm:[2,2,2,2] row_mask:0xf bank_mask:0xf
  v_cvt_pk_bf16_f32 v108, 0, v108
  v_cvt_pk_bf16_f32 v109, 0, v109
  v_add_f32_dpp v144, v225, v144 quad_perm:[1,1,1,1] row_mask:0xf bank_mask:0xf
  v_add_f32_dpp v145, v227, v145 quad_perm:[3,3,3,3] row_mask:0xf bank_mask:0xf
  v_cvt_pk_bf16_f32 v110, 0, v110
  v_cvt_pk_bf16_f32 v111, 0, v111
  v_add_f32 v228, v144, v145
  v_pk_mul_f32 v[108:109], v[108:109], v[196:197]
  v_pk_mul_f32 v[110:111], v[110:111], v[198:199]
  v_cvt_pk_bf16_f32 v218, v108, v109
  v_cvt_pk_bf16_f32 v219, v110, v111
  s_waitcnt vmcnt(14)
  buffer_load_dwordx4 v[88:91], v95, s[8:11], s60 offen offset:512 nt
  v_mfma_f32_16x16x32_bf16 v[224:227], v[216:219], v[168:171], 0
  v_pk_fma_f32 v[108:109], v[28:29], s[92:93], v[212:213] neg_lo:[0,0,1] neg_hi:[0,0,1]
  v_pk_fma_f32 v[110:111], v[30:31], s[92:93], v[214:215] neg_lo:[0,0,1] neg_hi:[0,0,1]
  s_cmp_lt_u32 s64, s99
  s_cbranch_scc1 L_k_known1
L_k_spin1:
  v_mov_b32 v144, 61696
  ds_read_b32 v144, v144
  s_waitcnt lgkmcnt(0)
  v_readfirstlane_b32 s96, v144
  s_nop 1
  s_cmp_eq_u32 s96, 0
  s_cbranch_scc1 L_k_spin1
  s_mov_b32 s99, -1
L_k_known1:
  s_lshr_b32 s71, s64, 5
  s_lshr_b32 s85, s96, s71
  s_andn2_b32 s70, s64, 1
  s_or_b32 s70, s70, s4
  s_cmp_lt_u32 s64, 8
  s_cselect_b32 s70, s70, s64
  s_cselect_b32 s85, s64, s85
  s_and_b32 s85, s85, 1
  s_add_u32 s70, s70, s5
  s_mul_i32 s71, s71, 4064
  s_add_u32 s70, s70, s71
  s_mul_hi_u32 s84, s70, s90
  s_lshr_b32 s84, s84, 1
  s_mul_i32 s71, s84, 3
  s_sub_u32 s70, s70, s71
  s_lshl3_add_u32 s85, s70, s85
  s_mul_i32 s61, s84, 196608
  s_lshr_b32 s89, s84, 4
  s_lshl_b32 s70, s85, 5
  v_add_u32 v97, s70, v230
  v_mul_u32_u24 v97, 21846, v97
  v_lshrrev_b32 v97, 16, v97
  v_add_u32 v144, s85, v231
  v_lshrrev_b32 v145, v144, s91
  v_and_b32 v145, 1, v145
  v_cmp_eq_u32 s[54:55], 1, v145
  s_nop 1
  s_and_b64 s[52:53], s[54:55], s[56:57]
  s_andn2_b64 s[54:55], s[54:55], s[56:57]
  v_mul_u32_u24 v144, 43, v144
  v_lshrrev_b32 v144, 8, v144
  v_mul_u32_u24 v144, 384, v144
  v_add_u32 v234, v144, v233
  s_cmp_eq_u32 s89, s88
  s_cbranch_scc1 L_k_sameq1
  s_mul_i32 s70, s89, 1536
  buffer_load_dwordx2 v[174:175], v235, s[36:39], s70 offen offset:0
  buffer_load_dwordx2 v[176:177], v235, s[36:39], s70 offen offset:128
  buffer_load_dwordx2 v[178:179], v235, s[36:39], s70 offen offset:256
  s_mov_b32 s88, s89
L_k_sameq1:
  s_mul_i32 s62, s84, 1536
  buffer_load_dwordx2 v[180:181], v234, s[20:23], s62 offen offset:0
  buffer_load_dwordx2 v[186:187], v234, s[24:27], s62 offen offset:0
  buffer_load_dwordx2 v[182:183], v234, s[20:23], s62 offen offset:128
  buffer_load_dwordx2 v[188:189], v234, s[24:27], s62 offen offset:128
  buffer_load_dwordx2 v[184:185], v234, s[20:23], s62 offen offset:256
  buffer_load_dwordx2 v[190:191], v234, s[24:27], s62 offen offset:256
  v_cvt_pk_bf16_f32 v108, 0, v108
  v_cvt_pk_bf16_f32 v109, 0, v109
  v_cvt_pk_bf16_f32 v110, 0, v110
  v_cvt_pk_bf16_f32 v111, 0, v111
  v_pk_mul_f32 v[108:109], v[108:109], v[200:201]
  v_pk_mul_f32 v[110:111], v[110:111], v[202:203]
  v_cvt_pk_bf16_f32 v220, v108, v109
  v_cvt_pk_bf16_f32 v221, v110, v111
  s_cmp_lt_u32 s64, 96
  s_cbranch_scc1 L_k_keep
  s_lshr_b32 s71, s3, 5
  s_lshr_b32 s85, s96, s71
  s_bfe_u32 s85, s85, 0x10003
  s_add_u32 s70, s3, s5
  s_mul_i32 s71, s71, 4064
  s_add_u32 s70, s70, s71
  s_mul_hi_u32 s84, s70, s90
  s_lshr_b32 s84, s84, 1
  s_mul_i32 s71, s84, 3
  s_sub_u32 s70, s70, s71
  s_lshl3_add_u32 s85, s70, s85
  s_mul_i32 s61, s84, 196608
  s_lshr_b32 s89, s84, 4
  s_lshl_b32 s70, s85, 5
  v_add_u32 v97, s70, v1
  v_mul_u32_u24 v97, 21846, v97
  v_lshrrev_b32 v97, 16, v97
  v_add_u32 v144, s85, v2
  v_lshrrev_b32 v145, v144, s91
  v_and_b32 v145, 1, v145
  v_cmp_eq_u32 s[54:55], 1, v145
  s_nop 1
  s_and_b64 s[52:53], s[54:55], s[58:59]
  s_andn2_b64 s[54:55], s[54:55], s[58:59]
  s_mov_b32 s16, s12
  s_mov_b32 s17, s13
  s_lshl_b32 s62, s84, 9
  v_lshl_add_u32 v98, v97, 1, v96
  buffer_load_short_d16_hi v112, v98, s[32:35], s62 offen
  buffer_load_short_d16_hi v113, v98, s[28:31], s62 offen
  v_mov_b32 v232, v3
L_k_keep:
  v_mad_u32_u24 v92, v97, s63, v232
  v_add_u32 v93, 768, v92
  v_add_u32 v94, 4608, v92
  v_add_u32 v95, 7680, v92
  v_cndmask_b32 v92, v92, v105, s[52:53]
  v_cndmask_b32 v95, v95, v105, s[54:55]
  s_waitcnt vmcnt(20)
  s_cbranch_vccnz L_kw1_18
  s_waitcnt vmcnt(15)
L_kw1_18:
  buffer_load_dwordx4 v[4:7], v92, s[16:19], s61 offen offset:0 nt
  v_mfma_f32_16x16x16_bf16 v[224:227], v[220:221], v[172:173], v[224:227]
  v_pk_fma_f32 v[108:109], v[32:33], s[92:93], v[204:205] neg_lo:[0,0,1] neg_hi:[0,0,1]
  v_pk_fma_f32 v[110:111], v[34:35], s[92:93], v[206:207] neg_lo:[0,0,1] neg_hi:[0,0,1]
  v_cvt_pk_bf16_f32 v108, 0, v108
  v_cvt_pk_bf16_f32 v109, 0, v109
  v_cvt_pk_bf16_f32 v110, 0, v110
  v_cvt_pk_bf16_f32 v111, 0, v111
  v_pk_mul_f32 v[108:109], v[108:109], v[192:193]
  v_pk_mul_f32 v[110:111], v[110:111], v[194:195]
  v_cvt_pk_bf16_f32 v216, v108, v109
  v_cvt_pk_bf16_f32 v217, v110, v111
  s_waitcnt vmcnt(20)
  buffer_load_dwordx4 v[8:11], v92, s[16:19], s61 offen offset:256 nt
  v_pk_fma_f32 v[108:109], v[36:37], s[92:93], v[208:209] neg_lo:[0,0,1] neg_hi:[0,0,1]
  v_pk_fma_f32 v[110:111], v[38:39], s[92:93], v[210:211] neg_lo:[0,0,1] neg_hi:[0,0,1]
  v_mov_b32_dpp v144, v224 quad_perm:[0,0,0,0] row_mask:0xf bank_mask:0xf
  v_mov_b32_dpp v145, v226 quad_perm:[2,2,2,2] row_mask:0xf bank_mask:0xf
  v_cvt_pk_bf16_f32 v108, 0, v108
  v_cvt_pk_bf16_f32 v109, 0, v109
  v_add_f32_dpp v144, v225, v144 quad_perm:[1,1,1,1] row_mask:0xf bank_mask:0xf
  v_add_f32_dpp v145, v227, v145 quad_perm:[3,3,3,3] row_mask:0xf bank_mask:0xf
  v_cvt_pk_bf16_f32 v110, 0, v110
  v_cvt_pk_bf16_f32 v111, 0, v111
  v_add_f32 v229, v144, v145
  v_pk_mul_f32 v[108:109], v[108:109], v[196:197]
  v_pk_mul_f32 v[110:111], v[110:111], v[198:199]
  v_cvt_pk_bf16_f32 v218, v108, v109
  v_cvt_pk_bf16_f32 v219, v110, v111
  s_waitcnt vmcnt(20)
  buffer_load_dwordx4 v[12:15], v92, s[16:19], s61 offen offset:512 nt
  v_mfma_f32_16x16x32_bf16 v[224:227], v[216:219], v[168:171], 0
  v_pk_fma_f32 v[108:109], v[40:41], s[92:93], v[212:213] neg_lo:[0,0,1] neg_hi:[0,0,1]
  v_pk_fma_f32 v[110:111], v[42:43], s[92:93], v[214:215] neg_lo:[0,0,1] neg_hi:[0,0,1]
  v_cvt_pk_bf16_f32 v108, 0, v108
  v_cvt_pk_bf16_f32 v228, 0, v228
  v_cvt_pk_bf16_f32 v109, 0, v109
  v_cvt_pk_bf16_f32 v229, 0, v229
  v_cvt_pk_bf16_f32 v110, 0, v110
  v_pk_mul_f32 v[228:229], v[228:229], s[68:69]
  v_cvt_pk_bf16_f32 v111, 0, v111
  v_cvt_pk_bf16_f32 v122, v228, v229
  v_pk_mul_f32 v[108:109], v[108:109], v[200:201]
  v_pk_mul_f32 v[110:111], v[110:111], v[202:203]
  v_cvt_pk_bf16_f32 v220, v108, v109
  v_cvt_pk_bf16_f32 v221, v110, v111
  s_waitcnt vmcnt(20)
  s_cbranch_vccnz L_kw1_21
  s_waitcnt vmcnt(15)
L_kw1_21:
  buffer_load_dwordx4 v[16:19], v93, s[16:19], s61 offen offset:0 nt
  v_mfma_f32_16x16x16_bf16 v[224:227], v[220:221], v[172:173], v[224:227]
  v_pk_fma_f32 v[108:109], v[44:45], s[92:93], v[204:205] neg_lo:[0,0,1] neg_hi:[0,0,1]
  v_pk_fma_f32 v[110:111], v[46:47], s[92:93], v[206:207] neg_lo:[0,0,1] neg_hi:[0,0,1]
  v_cvt_pk_bf16_f32 v108, 0, v108
  v_cvt_pk_bf16_f32 v109, 0, v109
  v_cvt_pk_bf16_f32 v110, 0, v110
  v_cvt_pk_bf16_f32 v111, 0, v111
  v_pk_mul_f32 v[108:109], v[108:109], v[192:193]
  v_pk_mul_f32 v[110:111], v[110:111], v[194:195]
  v_cvt_pk_bf16_f32 v216, v108, v109
  v_cvt_pk_bf16_f32 v217, v110, v111
  s_waitcnt vmcnt(20)
  buffer_load_dwordx4 v[20:23], v93, s[16:19], s61 offen offset:256 nt
  v_pk_fma_f32 v[108:109], v[48:49], s[92:93], v[208:209] neg_lo:[0,0,1] neg_hi:[0,0,1]
  v_pk_fma_f32 v[110:111], v[50:51], s[92:93], v[210:211] neg_lo:[0,0,1] neg_hi:[0,0,1]
  v_mov_b32_dpp v144, v224 quad_perm:[0,0,0,0] row_mask:0xf bank_mask:0xf
  v_mov_b32_dpp v145, v226 quad_perm:[2,2,2,2] row_mask:0xf bank_mask:0xf
  v_cvt_pk_bf16_f32 v108, 0, v108
  v_cvt_pk_bf16_f32 v109, 0, v109
  v_add_f32_dpp v144, v225, v144 quad_perm:[1,1,1,1] row_mask:0xf bank_mask:0xf
  v_add_f32_dpp v145, v227, v145 quad_perm:[3,3,3,3] row_mask:0xf bank_mask:0xf
  v_cvt_pk_bf16_f32 v110, 0, v110
  v_cvt_pk_bf16_f32 v111, 0, v111
  v_add_f32 v228, v144, v145
  v_pk_mul_f32 v[108:109], v[108:109], v[196:197]
  v_pk_mul_f32 v[110:111], v[110:111], v[198:199]
  v_cvt_pk_bf16_f32 v218, v108, v109
  v_cvt_pk_bf16_f32 v219, v110, v111
  s_waitcnt vmcnt(20)
  buffer_load_dwordx4 v[24:27], v93, s[16:19], s61 offen offset:512 nt
  v_mfma_f32_16x16x32_bf16 v[224:227], v[216:219], v[168:171], 0
  v_pk_fma_f32 v[108:109], v[52:53], s[92:93], v[212:213] neg_lo:[0,0,1] neg_hi:[0,0,1]
  v_pk_fma_f32 v[110:111], v[54:55], s[92:93], v[214:215] neg_lo:[0,0,1] neg_hi:[0,0,1]
  v_cvt_pk_bf16_f32 v108, 0, v108
  v_cvt_pk_bf16_f32 v109, 0, v109
  v_cvt_pk_bf16_f32 v110, 0, v110
  v_cvt_pk_bf16_f32 v111, 0, v111
  v_pk_mul_f32 v[108:109], v[108:109], v[200:201]
  v_pk_mul_f32 v[110:111], v[110:111], v[202:203]
  v_cvt_pk_bf16_f32 v220, v108, v109
  v_cvt_pk_bf16_f32 v221, v110, v111
  s_waitcnt vmcnt(20)
  s_cbranch_vccnz L_kw1_24
  s_waitcnt vmcnt(15)
L_kw1_24:
  buffer_load_dwordx4 v[28:31], v93, s[16:19], s61 offen offset:768 nt
  v_mfma_f32_16x16x16_bf16 v[224:227], v[220:221], v[172:173], v[224:227]
  v_pk_fma_f32 v[108:109], v[56:57], s[92:93], v[204:205] neg_lo:[0,0,1] neg_hi:[0,0,1]
  v_pk_fma_f32 v[110:111], v[58:59], s[92:93], v[206:207] neg_lo:[0,0,1] neg_hi:[0,0,1]
  v_cvt_pk_bf16_f32 v108, 0, v108
  v_cvt_pk_bf16_f32 v109, 0, v109
  v_cvt_pk_bf16_f32 v110, 0, v110
  v_cvt_pk_bf16_f32 v111, 0, v111
  v_pk_mul_f32 v[108:109], v[108:109], v[192:193]
  v_pk_mul_f32 v[110:111], v[110:111], v[194:195]
  v_cvt_pk_bf16_f32 v216, v108, v109
  v_cvt_pk_bf16_f32 v217, v110, v111
  s_waitcnt vmcnt(20)
  buffer_load_dwordx4 v[32:35], v93, s[16:19], s61 offen offset:1024 nt
  v_pk_fma_f32 v[108:109], v[60:61], s[92:93], v[208:209] neg_lo:[0,0,1] neg_hi:[0,0,1]
  v_pk_fma_f32 v[110:111], v[62:63], s[92:93], v[210:211] neg_lo:[0,0,1] neg_hi:[0,0,1]
  v_mov_b32_dpp v144, v224 quad_perm:[0,0,0,0] row_mask:0xf bank_mask:0xf
  v_mov_b32_dpp v145, v226 quad_perm:[2,2,2,2] row_mask:0xf bank_mask:0xf
  v_cvt_pk_bf16_f32 v108, 0, v108
  v_cvt_pk_bf16_f32 v109, 0, v109
  v_add_f32_dpp v144, v225, v144 quad_perm:[1,1,1,1] row_mask:0xf bank_mask:0xf
  v_add_f32_dpp v145, v227, v145 quad_perm:[3,3,3,3] row_mask:0xf bank_mask:0xf
  v_cvt_pk_bf16_f32 v110, 0, v110
  v_cvt_pk_bf16_f32 v111, 0, v111
  v_add_f32 v229, v144, v145
  v_pk_mul_f32 v[108:109], v[108:109], v[196:197]
  v_pk_mul_f32 v[110:111], v[110:111], v[198:199]
  v_cvt_pk_bf16_f32 v218, v108, v109
  v_cvt_pk_bf16_f32 v219, v110, v111
  s_waitcnt vmcnt(20)
  buffer_load_dwordx4 v[36:39], v93, s[16:19], s61 offen offset:1280 nt
  v_mfma_f32_16x16x32_bf16 v[224:227], v[216:219], v[168:171], 0
  v_pk_fma_f32 v[108:109], v[64:65], s[92:93], v[212:213] neg_lo:[0,0,1] neg_hi:[0,0,1]
  v_pk_fma_f32 v[110:111], v[66:67], s[92:93], v[214:215] neg_lo:[0,0,1] neg_hi:[0,0,1]
  v_cvt_pk_bf16_f32 v108, 0, v108
  v_cvt_pk_bf16_f32 v228, 0, v228
  v_cvt_pk_bf16_f32 v109, 0, v109
  v_cvt_pk_bf16_f32 v229, 0, v229
  v_cvt_pk_bf16_f32 v110, 0, v110
  v_pk_mul_f32 v[228:229], v[228:229], s[68:69]
  v_cvt_pk_bf16_f32 v111, 0, v111
  v_cvt_pk_bf16_f32 v123, v228, v229
  v_pk_mul_f32 v[108:109], v[108:109], v[200:201]
  v_pk_mul_f32 v[110:111], v[110:111], v[202:203]
  v_cvt_pk_bf16_f32 v220, v108, v109
  v_cvt_pk_bf16_f32 v221, v110, v111
  s_waitcnt vmcnt(20)
  s_cbranch_vccnz L_kw1_27
  s_waitcnt vmcnt(15)
L_kw1_27:
  buffer_load_dwordx4 v[40:43], v93, s[16:19], s61 offen offset:1536 nt
  v_mfma_f32_16x16x16_bf16 v[224:227], v[220:221], v[172:173], v[224:227]
  v_pk_fma_f32 v[108:109], v[68:69], s[92:93], v[204:205] neg_lo:[0,0,1] neg_hi:[0,0,1]
  v_pk_fma_f32 v[110:111], v[70:71], s[92:93], v[206:207] neg_lo:[0,0,1] neg_hi:[0,0,1]
  v_cvt_pk_bf16_f32 v108, 0, v108
  v_cvt_pk_bf16_f32 v109, 0, v109
  v_cvt_pk_bf16_f32 v110, 0, v110
  v_cvt_pk_bf16_f32 v111, 0, v111
  v_pk_mul_f32 v[108:109], v[108:109], v[192:193]
  v_pk_mul_f32 v[110:111], v[110:111], v[194:195]
  v_cvt_pk_bf16_f32 v216, v108, v109
  v_cvt_pk_bf16_f32 v217, v110, v111
  s_waitcnt vmcnt(20)
  buffer_load_dwordx4 v[44:47], v93, s[16:19], s61 offen offset:1792 nt
  v_pk_fma_f32 v[108:109], v[72:73], s[92:93], v[208:209] neg_lo:[0,0,1] neg_hi:[0,0,1]
  v_pk_fma_f32 v[110:111], v[74:75], s[92:93], v[210:211] neg_lo:[0,0,1] neg_hi:[0,0,1]
  v_mov_b32_dpp v144, v224 quad_perm:[0,0,0,0] row_mask:0xf bank_mask:0xf
  v_mov_b32_dpp v145, v226 quad_perm:[2,2,2,2] row_mask:0xf bank_mask:0xf
  v_cvt_pk_bf16_f32 v108, 0, v108
  v_cvt_pk_bf16_f32 v109, 0, v109
  v_add_f32_dpp v144, v225, v144 quad_perm:[1,1,1,1] row_mask:0xf bank_mask:0xf
  v_add_f32_dpp v145, v227, v145 quad_perm:[3,3,3,3] row_mask:0xf bank_mask:0xf
  v_cvt_pk_bf16_f32 v110, 0, v110
  v_cvt_pk_bf16_f32 v111, 0, v111
  v_add_f32 v228, v144, v145
  v_pk_mul_f32 v[108:109], v[108:109], v[196:197]
  v_pk_mul_f32 v[110:111], v[110:111], v[198:199]
  v_cvt_pk_bf16_f32 v218, v108, v109
  v_cvt_pk_bf16_f32 v219, v110, v111
  s_waitcnt vmcnt(20)
  buffer_load_dwordx4 v[48:51], v93, s[16:19], s61 offen offset:2048 nt
  v_mfma_f32_16x16x32_bf16 v[224:227], v[216:219], v[168:171], 0
  v_pk_fma_f32 v[108:109], v[76:77], s[92:93], v[212:213] neg_lo:[0,0,1] neg_hi:[0,0,1]
  v_pk_fma_f32 v[110:111], v[78:79], s[92:93], v[214:215] neg_lo:[0,0,1] neg_hi:[0,0,1]
  v_cvt_pk_bf16_f32 v108, 0, v108
  v_cvt_pk_bf16_f32 v109, 0, v109
  v_cvt_pk_bf16_f32 v110, 0, v110
  v_cvt_pk_bf16_f32 v111, 0, v111
  v_pk_mul_f32 v[108:109], v[108:109], v[200:201]
  v_pk_mul_f32 v[110:111], v[110:111], v[202:203]
  v_cvt_pk_bf16_f32 v220, v108, v109
  v_cvt_pk_bf16_f32 v221, v110, v111
  s_waitcnt vmcnt(20)
  s_cbranch_vccnz L_kw1_30
  s_waitcnt vmcnt(9)
L_kw1_30:
  buffer_load_dwordx4 v[52:55], v93, s[16:19], s61 offen offset:2304 nt
  v_mfma_f32_16x16x16_bf16 v[224:227], v[220:221], v[172:173], v[224:227]
  v_pk_fma_f32 v[108:109], v[80:81], s[92:93], v[204:205] neg_lo:[0,0,1] neg_hi:[0,0,1]
  v_pk_fma_f32 v[110:111], v[82:83], s[92:93], v[206:207] neg_lo:[0,0,1] neg_hi:[0,0,1]
  v_cvt_pk_bf16_f32 v108, 0, v108
  v_cvt_pk_bf16_f32 v109, 0, v109
  v_cvt_pk_bf16_f32 v110, 0, v110
  v_cvt_pk_bf16_f32 v111, 0, v111
  v_pk_mul_f32 v[108:109], v[108:109], v[192:193]
  v_pk_mul_f32 v[110:111], v[110:111], v[194:195]
  v_cvt_pk_bf16_f32 v216, v108, v109
  v_cvt_pk_bf16_f32 v217, v110, v111
  s_waitcnt vmcnt(20)
  buffer_load_dwordx4 v[56:59], v93, s[16:19], s61 offen offset:2560 nt
  v_pk_fma_f32 v[108:109], v[84:85], s[92:93], v[208:209] neg_lo:[0,0,1] neg_hi:[0,0,1]
  v_pk_fma_f32 v[110:111], v[86:87], s[92:93], v[210:211] neg_lo:[0,0,1] neg_hi:[0,0,1]
  v_mov_b32_dpp v144, v224 quad_perm:[0,0,0,0] row_mask:0xf bank_mask:0xf
  v_mov_b32_dpp v145, v226 quad_perm:[2,2,2,2] row_mask:0xf bank_mask:0xf
  v_cvt_pk_bf16_f32 v108, 0, v108
  v_cvt_pk_bf16_f32 v109, 0, v109
  v_add_f32_dpp v144, v225, v144 quad_perm:[1,1,1,1] row_mask:0xf bank_mask:0xf
  v_add_f32_dpp v145, v227, v145 quad_perm:[3,3,3,3] row_mask:0xf bank_mask:0xf
  v_cvt_pk_bf16_f32 v110, 0, v110
  v_cvt_pk_bf16_f32 v111, 0, v111
  v_add_f32 v229, v144, v145
  v_pk_mul_f32 v[108:109], v[108:109], v[196:197]
  v_pk_mul_f32 v[110:111], v[110:111], v[198:199]
  v_cvt_pk_bf16_f32 v218, v108, v109
  v_cvt_pk_bf16_f32 v219, v110, v111
  s_waitcnt vmcnt(20)
  buffer_load_dwordx4 v[60:63], v93, s[16:19], s61 offen offset:2816 nt
  v_mfma_f32_16x16x32_bf16 v[224:227], v[216:219], v[168:171], 0
  v_pk_fma_f32 v[108:109], v[88:89], s[92:93], v[212:213] neg_lo:[0,0,1] neg_hi:[0,0,1]
  v_pk_fma_f32 v[110:111], v[90:91], s[92:93], v[214:215] neg_lo:[0,0,1] neg_hi:[0,0,1]
  v_cvt_pk_bf16_f32 v108, 0, v108
  v_cvt_pk_bf16_f32 v228, 0, v228
  v_cvt_pk_bf16_f32 v109, 0, v109
  v_cvt_pk_bf16_f32 v229, 0, v229
  v_cvt_pk_bf16_f32 v110, 0, v110
  v_pk_mul_f32 v[228:229], v[228:229], s[68:69]
  v_cvt_pk_bf16_f32 v111, 0, v111
  v_cvt_pk_bf16_f32 v124, v228, v229
  v_pk_mul_f32 v[108:109], v[108:109], v[200:201]
  v_pk_mul_f32 v[110:111], v[110:111], v[202:203]
  v_cvt_pk_bf16_f32 v220, v108, v109
  v_cvt_pk_bf16_f32 v221, v110, v111
  s_mov_b32 s60, s61
  v_mov_b32 v146, s64
  v_mfma_f32_16x16x16_bf16 v[224:227], v[220:221], v[172:173], v[224:227]
  ds_write_b128 v99, v[120:123]
  v_add_u32 v99, 768, v99
  s_nop 5
  v_mov_b32_dpp v144, v224 quad_perm:[0,0,0,0] row_mask:0xf bank_mask:0xf
  v_mov_b32_dpp v145, v226 quad_perm:[2,2,2,2] row_mask:0xf bank_mask:0xf
  s_nop 0
  v_add_f32_dpp v144, v225, v144 quad_perm:[1,1,1,1] row_mask:0xf bank_mask:0xf
  v_add_f32_dpp v145, v227, v145 quad_perm:[3,3,3,3] row_mask:0xf bank_mask:0xf
  v_add_f32 v228, v144, v145
  v_cndmask_b32 v228, v228, v236, s[50:51]
  v_cvt_pk_bf16_f32 v228, 0, v228
  v_cvt_pk_bf16_f32 v229, 0, v229
  v_pk_mul_f32 v[228:229], v[228:229], s[68:69]
  v_cvt_pk_bf16_f32 v125, v228, v229
  ds_write_b64 v100, v[124:125] offset:256
  ds_write_b32 v104, v146
  v_add_u32 v100, 768, v100
  s_cmp_lt_u32 s64, 96
  s_cbranch_scc1 L_k
  v_subrev_u32 v99, 36864, v99
  v_subrev_u32 v100, 36864, v100
  s_mov_b32 s64, s3
  s_mov_b32 s88, s89
  s_mov_b32 s99, 0
  s_mov_b32 s36, s46
  s_and_b32 s37, s47, 0xffff
  s_cmp_lt_u32 s64, s99
  s_cbranch_scc1 L_v0_ok
L_v0_spin:
  v_mov_b32 v144, 61700
  ds_read_b32 v144, v144
  s_waitcnt lgkmcnt(0)
  v_readfirstlane_b32 s99, v144
  s_nop 1
  s_cmp_lt_u32 s64, s99
  s_cbranch_scc0 L_v0_spin
L_v0_ok:
  ds_read_b128 v[120:123], v99
  ds_read_b64 v[124:125], v100 offset:256
  v_mov_b32 v128, 0
  v_mov_b32 v129, 0
  v_mov_b32 v130, 0
  v_mov_b32 v131, 0
  v_mov_b32 v132, 0
  v_mov_b32 v133, 0
  v_mov_b32 v134, 0
  v_mov_b32 v135, 0
  v_mov_b32 v136, 0
  v_mov_b32 v137, 0
  v_mov_b32 v138, 0
  v_mov_b32 v139, 0
  v_mov_b32 v140, 0xff800000
  v_mov_b32 v142, 0x7f800000
  v_mov_b32 v143, 0
L_v0:
  s_add_u32 s97, s64, 96
  v_mov_b32 v146, s97
  s_mov_b32 s86, s84
  s_mov_b32 s87, s85
  ds_write_b32 v104, v146
  s_add_u32 s64, s64, 2
  s_cmp_lt_u32 s64, s99
  s_cbranch_scc1 L_v10_ok
L_v10_spin:
  v_mov_b32 v144, 61700
  ds_read_b32 v144, v144
  s_waitcnt lgkmcnt(0)
  v_readfirstlane_b32 s99, v144
  s_nop 1
  s_cmp_lt_u32 s64, s99
  s_cbranch_scc0 L_v10_spin
L_v10_ok:
  s_lshr_b32 s71, s64, 5
  s_lshr_b32 s85, s96, s71
  s_bfe_u32 s85, s85, 0x10003
  s_add_u32 s70, s64, s5
  s_mul_i32 s71, s71, 4064
  s_add_u32 s70, s70, s71
  s_mul_hi_u32 s84, s70, s90
  s_lshr_b32 s84, s84, 1
  s_mul_i32 s71, s84, 3
  s_sub_u32 s70, s70, s71
  s_lshl3_add_u32 s85, s70, s85
  s_mul_i32 s61, s84, 196608
  s_lshr_b32 s89, s84, 4
  s_lshl_b32 s70, s85, 5
  v_add_u32 v97, s70, v1
  v_mul_u32_u24 v97, 21846, v97
  v_lshrrev_b32 v97, 16, v97
  v_add_u32 v144, s85, v2
  v_lshrrev_b32 v145, v144, s91
  v_and_b32 v145, 1, v145
  v_cmp_eq_u32 s[54:55], 1, v145
  s_nop 1
  s_and_b64 s[52:53], s[54:55], s[58:59]
  s_andn2_b64 s[54:55], s[54:55], s[58:59]
  s_cmp_lt_u32 s64, 96
  s_cselect_b32 s61, s61, 805306368
  ds_read_b32 v106, v104 offset:8
  s_waitcnt vmcnt(14)
  s_cbranch_vccnz L_vw0_0
  s_waitcnt vmcnt(9)
L_vw0_0:
  buffer_load_dwordx4 v[64:67], v93, s[12:15], s60 offen offset:3072 nt
  v_mul_f32 v114, s94, v112
  v_mul_f32 v115, 0x4a800000, v113
  s_nop 0
  v_mov_b32_dpp v116, v114 row_newbcast:0 row_mask:0xf bank_mask:0xf
  v_mov_b32_dpp v117, v115 row_newbcast:0 row_mask:0xf bank_mask:0xf
  v_pk_fma_f32 v[192:193], v[4:5], s[92:93], v[116:117] op_sel_hi:[1,1,0] neg_lo:[0,0,1] neg_hi:[0,0,1]
  v_pk_fma_f32 v[194:195], v[6:7], s[92:93], v[116:117] op_sel_hi:[1,1,0] neg_lo:[0,0,1] neg_hi:[0,0,1]
  v_cvt_pk_bf16_f32 v192, 0, v192
  v_cvt_pk_bf16_f32 v193, 0, v193
  v_cvt_pk_bf16_f32 v194, 0, v194
  v_cvt_pk_bf16_f32 v195, 0, v195
  v_pk_mul_f32 v[192:193], v[192:193], v[116:117] op_sel:[0,1]
  v_pk_mul_f32 v[194:195], v[194:195], v[116:117] op_sel:[0,1]
  s_waitcnt lgkmcnt(0)
  v_cmp_lt_u32 vcc, s97, v106
  s_waitcnt vmcnt(14)
  buffer_load_dwordx4 v[68:71], v93, s[12:15], s60 offen offset:3328 nt
  v_pk_fma_f32 v[196:197], v[8:9], s[92:93], v[116:117] op_sel_hi:[1,1,0] neg_lo:[0,0,1] neg_hi:[0,0,1]
  v_pk_fma_f32 v[198:199], v[10:11], s[92:93], v[116:117] op_sel_hi:[1,1,0] neg_lo:[0,0,1] neg_hi:[0,0,1]
  v_cvt_pk_bf16_f32 v196, 0, v196
  v_lshlrev_b32 v148, 16, v120
  v_cvt_pk_bf16_f32 v197, 0, v197
  v_and_b32 v149, s65, v120
  v_cvt_pk_bf16_f32 v198, 0, v198
  v_lshlrev_b32 v150, 16, v121
  v_cvt_pk_bf16_f32 v199, 0, v199
  v_and_b32 v151, s65, v121
  v_pk_mul_f32 v[196:197], v[196:197], v[116:117] op_sel:[0,1]
  v_lshlrev_b32 v152, 16, v122
  v_pk_mul_f32 v[198:199], v[198:199], v[116:117] op_sel:[0,1]
  s_waitcnt vmcnt(14)
  buffer_load_dwordx4 v[72:75], v93, s[12:15], s60 offen offset:3584 nt
  v_pk_fma_f32 v[200:201], v[12:13], s[92:93], v[116:117] op_sel_hi:[1,1,0] neg_lo:[0,0,1] neg_hi:[0,0,1]
  v_pk_fma_f32 v[202:203], v[14:15], s[92:93], v[116:117] op_sel_hi:[1,1,0] neg_lo:[0,0,1] neg_hi:[0,0,1]
  v_cvt_pk_bf16_f32 v200, 0, v200
  v_and_b32 v153, s65, v122
  v_cvt_pk_bf16_f32 v201, 0, v201
  v_lshlrev_b32 v154, 16, v123
  v_cvt_pk_bf16_f32 v202, 0, v202
  v_and_b32 v155, s65, v123
  v_cvt_pk_bf16_f32 v203, 0, v203
  v_lshlrev_b32 v156, 16, v124
  v_pk_mul_f32 v[200:201], v[200:201], v[116:117] op_sel:[0,1]
  v_and_b32 v157, s65, v124
  v_pk_mul_f32 v[202:203], v[202:203], v[116:117] op_sel:[0,1]
  s_waitcnt vmcnt(14)
  s_cbranch_vccnz L_vw0_3
  s_waitcnt vmcnt(9)
L_vw0_3:
  buffer_load_dwordx4 v[76:79], v94, s[12:15], s60 offen offset:0 nt
  v_mov_b32_dpp v116, v114 row_newbcast:1 row_mask:0xf bank_mask:0xf
  v_mov_b32_dpp v117, v115 row_newbcast:1 row_mask:0xf bank_mask:0xf
  v_pk_fma_f32 v[108:109], v[16:17], s[92:93], v[116:117] op_sel_hi:[1,1,0] neg_lo:[0,0,1] neg_hi:[0,0,1]
  v_pk_fma_f32 v[110:111], v[18:19], s[92:93], v[116:117] op_sel_hi:[1,1,0] neg_lo:[0,0,1] neg_hi:[0,0,1]
  s_lshl_b32 s62, s84, 9
  v_lshl_add_u32 v98, v97, 1, v96
  buffer_load_short_d16_hi v112, v98, s[32:35], s62 offen
  buffer_load_short_d16_hi v113, v98, s[28:31], s62 offen
  v_cvt_pk_bf16_f32 v108, 0, v108
  v_lshlrev_b32 v158, 16, v125
  v_cvt_pk_bf16_f32 v109, 0, v109
  v_add_u32 v99, 768, v99
  v_cvt_pk_bf16_f32 v110, 0, v110
  v_add_u32 v100, 768, v100
  v_cvt_pk_bf16_f32 v111, 0, v111
  v_max3_f32 v144, v148, v149, v150
  v_pk_mul_f32 v[108:109], v[108:109], v[116:117] op_sel:[0,1]
  ds_read_b128 v[120:123], v99
  v_pk_mul_f32 v[110:111], v[110:111], v[116:117] op_sel:[0,1]
  v_cvt_pk_bf16_f32 v204, v192, v108
  v_cvt_pk_bf16_f32 v208, v193, v109
  v_cvt_pk_bf16_f32 v212, v194, v110
  v_cvt_pk_bf16_f32 v216, v195, v111
  s_waitcnt vmcnt(16)
  buffer_load_dwordx4 v[80:83], v94, s[12:15], s60 offen offset:256 nt
  v_pk_fma_f32 v[108:109], v[20:21], s[92:93], v[116:117] op_sel_hi:[1,1,0] neg_lo:[0,0,1] neg_hi:[0,0,1]
  v_pk_fma_f32 v[110:111], v[22:23], s[92:93], v[116:117] op_sel_hi:[1,1,0] neg_lo:[0,0,1] neg_hi:[0,0,1]
  v_cvt_pk_bf16_f32 v108, 0, v108
  ds_read_b64 v[124:125], v100 offset:256
  v_cvt_pk_bf16_f32 v109, 0, v109
  v_max3_f32 v145, v151, v152, v153
  v_cvt_pk_bf16_f32 v110, 0, v110
  v_max3_f32 v144, v144, v154, v155
  v_cvt_pk_bf16_f32 v111, 0, v111
  v_max3_f32 v145, v145, v156, v157
  v_pk_mul_f32 v[108:109], v[108:109], v[116:117] op_sel:[0,1]
  v_max3_f32 v144, v144, v158, v140
  v_pk_mul_f32 v[110:111], v[110:111], v[116:117] op_sel:[0,1]
  v_cvt_pk_bf16_f32 v220, v196, v108
  v_cvt_pk_bf16_f32 v224, v197, v109
  v_cvt_pk_bf16_f32 v228, v198, v110
  v_cvt_pk_bf16_f32 v232, v199, v111
  s_waitcnt vmcnt(16)
  buffer_load_dwordx4 v[84:87], v94, s[12:15], s60 offen offset:512 nt
  v_pk_fma_f32 v[108:109], v[24:25], s[92:93], v[116:117] op_sel_hi:[1,1,0] neg_lo:[0,0,1] neg_hi:[0,0,1]
  v_pk_fma_f32 v[110:111], v[26:27], s[92:93], v[116:117] op_sel_hi:[1,1,0] neg_lo:[0,0,1] neg_hi:[0,0,1]
  v_cvt_pk_bf16_f32 v108, 0, v108
  v_max_f32 v144, v144, v145
  v_cvt_pk_bf16_f32 v109, 0, v109
  v_mov_b32 v145, v144
  v_cvt_pk_bf16_f32 v110, 0, v110
  s_nop 0
  v_permlane32_swap_b32 v144, v145
  v_cvt_pk_bf16_f32 v111, 0, v111
  v_max_f32 v144, v144, v145
  v_pk_mul_f32 v[108:109], v[108:109], v[116:117] op_sel:[0,1]
  v_mov_b32 v145, v144
  v_pk_mul_f32 v[110:111], v[110:111], v[116:117] op_sel:[0,1]
  v_cvt_pk_bf16_f32 v236, v200, v108
  v_cvt_pk_bf16_f32 v240, v201, v109
  v_cvt_pk_bf16_f32 v244, v202, v110
  v_cvt_pk_bf16_f32 v248, v203, v111
  s_waitcnt vmcnt(16)
  s_cbranch_vccnz L_vw0_6
  s_waitcnt vmcnt(11)
L_vw0_6:
  buffer_load_dwordx4 v[88:91], v94, s[12:15], s60 offen offset:768 nt
  v_mov_b32_dpp v116, v114 row_newbcast:2 row_mask:0xf bank_mask:0xf
  v_mov_b32_dpp v117, v115 row_newbcast:2 row_mask:0xf bank_mask:0xf
  v_pk_fma_f32 v[192:193], v[28:29], s[92:93], v[116:117] op_sel_hi:[1,1,0] neg_lo:[0,0,1] neg_hi:[0,0,1]
  v_pk_fma_f32 v[194:195], v[30:31], s[92:93], v[116:117] op_sel_hi:[1,1,0] neg_lo:[0,0,1] neg_hi:[0,0,1]
  v_cvt_pk_bf16_f32 v192, 0, v192
  v_permlane16_swap_b32 v144, v145
  v_cvt_pk_bf16_f32 v193, 0, v193
  v_max_f32 v140, v144, v145
  v_cvt_pk_bf16_f32 v194, 0, v194
  v_mul_f32 v144, s66, v140
  v_cvt_pk_bf16_f32 v195, 0, v195
  v_add_f32 v146, v144, v142
  v_pk_mul_f32 v[192:193], v[192:193], v[116:117] op_sel:[0,1]
  v_sub_f32 v142, 0, v144
  v_pk_mul_f32 v[194:195], v[194:195], v[116:117] op_sel:[0,1]
  s_waitcnt vmcnt(16)
  buffer_load_dwordx4 v[4:7], v94, s[12:15], s60 offen offset:1024 nt
  v_pk_fma_f32 v[196:197], v[32:33], s[92:93], v[116:117] op_sel_hi:[1,1,0] neg_lo:[0,0,1] neg_hi:[0,0,1]
  v_pk_fma_f32 v[198:199], v[34:35], s[92:93], v[116:117] op_sel_hi:[1,1,0] neg_lo:[0,0,1] neg_hi:[0,0,1]
  v_cvt_pk_bf16_f32 v196, 0, v196
  v_exp_f32 v146, -v146
  v_cvt_pk_bf16_f32 v197, 0, v197
  ds_bpermute_b32 v147, v101, v146
  v_cvt_pk_bf16_f32 v198, 0, v198
  v_fma_f32 v148, v148, s66, v142
  v_cvt_pk_bf16_f32 v199, 0, v199
  v_exp_f32 v148, v148
  v_pk_mul_f32 v[196:197], v[196:197], v[116:117] op_sel:[0,1]
  v_fma_f32 v149, v149, s66, v142
  v_pk_mul_f32 v[198:199], v[198:199], v[116:117] op_sel:[0,1]
  s_waitcnt vmcnt(16)
  buffer_load_dwordx4 v[8:11], v94, s[12:15], s60 offen offset:1280 nt
  v_pk_fma_f32 v[200:201], v[36:37], s[92:93], v[116:117] op_sel_hi:[1,1,0] neg_lo:[0,0,1] neg_hi:[0,0,1]
  v_pk_fma_f32 v[202:203], v[38:39], s[92:93], v[116:117] op_sel_hi:[1,1,0] neg_lo:[0,0,1] neg_hi:[0,0,1]
  v_cvt_pk_bf16_f32 v200, 0, v200
  v_exp_f32 v149, v149
  v_cvt_pk_bf16_f32 v201, 0, v201
  v_fma_f32 v150, v150, s66, v142
  v_cvt_pk_bf16_f32 v202, 0, v202
  v_exp_f32 v150, v150
  v_cvt_pk_bf16_f32 v203, 0, v203
  v_fma_f32 v151, v151, s66, v142
  v_pk_mul_f32 v[200:201], v[200:201], v[116:117] op_sel:[0,1]
  v_exp_f32 v151, v151
  v_pk_mul_f32 v[202:203], v[202:203], v[116:117] op_sel:[0,1]
  s_waitcnt vmcnt(16)
  s_cbranch_vccnz L_vw0_9
  s_waitcnt vmcnt(11)
L_vw0_9:
  buffer_load_dwordx4 v[12:15], v94, s[12:15], s60 offen offset:1536 nt
  v_mov_b32_dpp v116, v114 row_newbcast:3 row_mask:0xf bank_mask:0xf
  v_mov_b32_dpp v117, v115 row_newbcast:3 row_mask:0xf bank_mask:0xf
  v_pk_fma_f32 v[108:109], v[40:41], s[92:93], v[116:117] op_sel_hi:[1,1,0] neg_lo:[0,0,1] neg_hi:[0,0,1]
  v_pk_fma_f32 v[110:111], v[42:43], s[92:93], v[116:117] op_sel_hi:[1,1,0] neg_lo:[0,0,1] neg_hi:[0,0,1]
  v_cvt_pk_bf16_f32 v108, 0, v108
  v_fma_f32 v152, v152, s66, v142
  v_cvt_pk_bf16_f32 v109, 0, v109
  v_exp_f32 v152, v152
  v_cvt_pk_bf16_f32 v110, 0, v110
  v_fma_f32 v153, v153, s66, v142
  v_cvt_pk_bf16_f32 v111, 0, v111
  v_exp_f32 v153, v153
  v_pk_mul_f32 v[108:109], v[108:109], v[116:117] op_sel:[0,1]
  v_fma_f32 v154, v154, s66, v142
  v_pk_mul_f32 v[110:111], v[110:111], v[116:117] op_sel:[0,1]
  v_cvt_pk_bf16_f32 v205, v192, v108
  v_cvt_pk_bf16_f32 v209, v193, v109
  v_cvt_pk_bf16_f32 v213, v194, v110
  v_cvt_pk_bf16_f32 v217, v195, v111
  s_waitcnt vmcnt(16)
  buffer_load_dwordx4 v[16:19], v94, s[12:15], s60 offen offset:1792 nt
  v_pk_fma_f32 v[108:109], v[44:45], s[92:93], v[116:117] op_sel_hi:[1,1,0] neg_lo:[0,0,1] neg_hi:[0,0,1]
  v_pk_fma_f32 v[110:111], v[46:47], s[92:93], v[116:117] op_sel_hi:[1,1,0] neg_lo:[0,0,1] neg_hi:[0,0,1]
  v_cvt_pk_bf16_f32 v108, 0, v108
  v_exp_f32 v154, v154
  v_cvt_pk_bf16_f32 v109, 0, v109
  v_fma_f32 v155, v155, s66, v142
  v_cvt_pk_bf16_f32 v110, 0, v110
  v_exp_f32 v155, v155
  v_cvt_pk_bf16_f32 v111, 0, v111
  v_fma_f32 v156, v156, s66, v142
  v_pk_mul_f32 v[108:109], v[108:109], v[116:117] op_sel:[0,1]
  v_exp_f32 v156, v156
  v_pk_mul_f32 v[110:111], v[110:111], v[116:117] op_sel:[0,1]
  v_cvt_pk_bf16_f32 v221, v196, v108
  v_cvt_pk_bf16_f32 v225, v197, v109
  v_cvt_pk_bf16_f32 v229, v198, v110
  v_cvt_pk_bf16_f32 v233, v199, v111
  s_waitcnt vmcnt(16)
  buffer_load_dwordx4 v[20:23], v94, s[12:15], s60 offen offset:2048 nt
  v_pk_fma_f32 v[108:109], v[48:49], s[92:93], v[116:117] op_sel_hi:[1,1,0] neg_lo:[0,0,1] neg_hi:[0,0,1]
  v_pk_fma_f32 v[110:111], v[50:51], s[92:93], v[116:117] op_sel_hi:[1,1,0] neg_lo:[0,0,1] neg_hi:[0,0,1]
  v_cvt_pk_bf16_f32 v108, 0, v108
  v_fma_f32 v157, v157, s66, v142
  v_cvt_pk_bf16_f32 v109, 0, v109
  v_exp_f32 v157, v157
  v_cvt_pk_bf16_f32 v110, 0, v110
  v_fma_f32 v158, v158, s66, v142
  v_cvt_pk_bf16_f32 v111, 0, v111
  v_exp_f32 v158, v158
  v_pk_mul_f32 v[108:109], v[108:109], v[116:117] op_sel:[0,1]
  v_add_f32 v144, v148, v149
  v_pk_mul_f32 v[110:111], v[110:111], v[116:117] op_sel:[0,1]
  v_cvt_pk_bf16_f32 v237, v200, v108
  v_cvt_pk_bf16_f32 v241, v201, v109
  v_cvt_pk_bf16_f32 v245, v202, v110
  v_cvt_pk_bf16_f32 v249, v203, v111
  s_waitcnt vmcnt(16)
  s_cbranch_vccnz L_vw0_12
  s_waitcnt vmcnt(11)
L_vw0_12:
  buffer_load_dwordx4 v[24:27], v94, s[12:15], s60 offen offset:2304 nt
  v_mov_b32_dpp v116, v114 row_newbcast:4 row_mask:0xf bank_mask:0xf
  v_mov_b32_dpp v117, v115 row_newbcast:4 row_mask:0xf bank_mask:0xf
  v_pk_fma_f32 v[192:193], v[52:53], s[92:93], v[116:117] op_sel_hi:[1,1,0] neg_lo:[0,0,1] neg_hi:[0,0,1]
  v_pk_fma_f32 v[194:195], v[54:55], s[92:93], v[116:117] op_sel_hi:[1,1,0] neg_lo:[0,0,1] neg_hi:[0,0,1]
  v_cvt_pk_bf16_f32 v192, 0, v192
  v_add_f32 v145, v150, v151
  v_cvt_pk_bf16_f32 v193, 0, v193
  v_add_f32 v144, v144, v152
  v_cvt_pk_bf16_f32 v194, 0, v194
  v_add_f32 v145, v145, v153
  v_cvt_pk_bf16_f32 v195, 0, v195
  v_add_f32 v144, v144, v154
  v_pk_mul_f32 v[192:193], v[192:193], v[116:117] op_sel:[0,1]
  v_add_f32 v145, v145, v155
  v_pk_mul_f32 v[194:195], v[194:195], v[116:117] op_sel:[0,1]
  s_waitcnt vmcnt(16)
  buffer_load_dwordx4 v[28:31], v94, s[12:15], s60 offen offset:2560 nt
  v_pk_fma_f32 v[196:197], v[56:57], s[92:93], v[116:117] op_sel_hi:[1,1,0] neg_lo:[0,0,1] neg_hi:[0,0,1]
  v_pk_fma_f32 v[198:199], v[58:59], s[92:93], v[116:117] op_sel_hi:[1,1,0] neg_lo:[0,0,1] neg_hi:[0,0,1]
  v_cvt_pk_bf16_f32 v196, 0, v196
  v_add_f32 v144, v144, v156
  v_cvt_pk_bf16_f32 v197, 0, v197
  v_add_f32 v145, v145, v157
  v_cvt_pk_bf16_f32 v198, 0, v198
  v_add_f32 v144, v144, v158
  v_cvt_pk_bf16_f32 v199, 0, v199
  v_add_f32 v144, v144, v145
  v_pk_mul_f32 v[196:197], v[196:197], v[116:117] op_sel:[0,1]
  v_fma_f32 v143, v143, v146, v144
  v_pk_mul_f32 v[198:199], v[198:199], v[116:117] op_sel:[0,1]
  s_waitcnt vmcnt(16)
  buffer_load_dwordx4 v[32:35], v94, s[12:15], s60 offen offset:2816 nt
  v_pk_fma_f32 v[200:201], v[60:61], s[92:93], v[116:117] op_sel_hi:[1,1,0] neg_lo:[0,0,1] neg_hi:[0,0,1]
  v_pk_fma_f32 v[202:203], v[62:63], s[92:93], v[116:117] op_sel_hi:[1,1,0] neg_lo:[0,0,1] neg_hi:[0,0,1]
  v_cvt_pk_bf16_f32 v200, 0, v200
  v_cvt_pk_bf16_f32 v159, v148, v149
  v_cvt_pk_bf16_f32 v201, 0, v201
  v_cvt_pk_bf16_f32 v160, v150, v151
  v_cvt_pk_bf16_f32 v202, 0, v202
  v_cvt_pk_bf16_f32 v161, v152, v153
  v_cvt_pk_bf16_f32 v203, 0, v203
  v_cvt_pk_bf16_f32 v162, v154, v155
  v_pk_mul_f32 v[200:201], v[200:201], v[116:117] op_sel:[0,1]
  v_cvt_pk_bf16_f32 v163, v156, v157
  v_pk_mul_f32 v[202:203], v[202:203], v[116:117] op_sel:[0,1]
  s_waitcnt vmcnt(16)
  s_cbranch_vccnz L_vw0_15
  s_waitcnt vmcnt(9)
L_vw0_15:
  buffer_load_dwordx4 v[36:39], v95, s[12:15], s60 offen offset:0 nt
  v_mov_b32_dpp v116, v114 row_newbcast:5 row_mask:0xf bank_mask:0xf
  v_mov_b32_dpp v117, v115 row_newbcast:5 row_mask:0xf bank_mask:0xf
  v_pk_fma_f32 v[108:109], v[64:65], s[92:93], v[116:117] op_sel_hi:[1,1,0] neg_lo:[0,0,1] neg_hi:[0,0,1]
  v_pk_fma_f32 v[110:111], v[66:67], s[92:93], v[116:117] op_sel_hi:[1,1,0] neg_lo:[0,0,1] neg_hi:[0,0,1]
  v_cvt_pk_bf16_f32 v108, 0, v108
  v_cvt_pk_bf16_f32 v164, v158, 0
  v_cvt_pk_bf16_f32 v109, 0, v109
  v_cndmask_b32 v168, 0, v159, s[72:73]
  v_cvt_pk_bf16_f32 v110, 0, v110
  v_cndmask_b32 v169, 0, v160, s[72:73]
  v_cvt_pk_bf16_f32 v111, 0, v111
  v_cndmask_b32 v170, 0, v161, s[72:73]
  v_pk_mul_f32 v[108:109], v[108:109], v[116:117] op_sel:[0,1]
  v_cndmask_b32 v171, 0, v162, s[72:73]
  v_pk_mul_f32 v[110:111], v[110:111], v[116:117] op_sel:[0,1]
  v_cvt_pk_bf16_f32 v206, v192, v108
  v_cvt_pk_bf16_f32 v210, v193, v109
  v_cvt_pk_bf16_f32 v214, v194, v110
  v_cvt_pk_bf16_f32 v218, v195, v111
  s_waitcnt vmcnt(16)
  buffer_load_dwordx4 v[40:43], v95, s[12:15], s60 offen offset:256 nt
  v_pk_fma_f32 v[108:109], v[68:69], s[92:93], v[116:117] op_sel_hi:[1,1,0] neg_lo:[0,0,1] neg_hi:[0,0,1]
  v_pk_fma_f32 v[110:111], v[70:71], s[92:93], v[116:117] op_sel_hi:[1,1,0] neg_lo:[0,0,1] neg_hi:[0,0,1]
  v_cvt_pk_bf16_f32 v108, 0, v108
  v_cndmask_b32 v172, 0, v159, s[74:75]
  v_cvt_pk_bf16_f32 v109, 0, v109
  v_cndmask_b32 v173, 0, v160, s[74:75]
  v_cvt_pk_bf16_f32 v110, 0, v110
  v_cndmask_b32 v174, 0, v161, s[74:75]
  v_cvt_pk_bf16_f32 v111, 0, v111
  v_cndmask_b32 v175, 0, v162, s[74:75]
  v_pk_mul_f32 v[108:109], v[108:109], v[116:117] op_sel:[0,1]
  v_cndmask_b32 v176, 0, v159, s[76:77]
  v_pk_mul_f32 v[110:111], v[110:111], v[116:117] op_sel:[0,1]
  v_cvt_pk_bf16_f32 v222, v196, v108
  v_cvt_pk_bf16_f32 v226, v197, v109
  v_cvt_pk_bf16_f32 v230, v198, v110
  v_cvt_pk_bf16_f32 v234, v199, v111
  s_waitcnt vmcnt(16)
  buffer_load_dwordx4 v[44:47], v95, s[12:15], s60 offen offset:512 nt
  v_pk_fma_f32 v[108:109], v[72:73], s[92:93], v[116:117] op_sel_hi:[1,1,0] neg_lo:[0,0,1] neg_hi:[0,0,1]
  v_pk_fma_f32 v[110:111], v[74:75], s[92:93], v[116:117] op_sel_hi:[1,1,0] neg_lo:[0,0,1] neg_hi:[0,0,1]
  v_cvt_pk_bf16_f32 v108, 0, v108
  v_cndmask_b32 v177, 0, v160, s[76:77]
  v_cvt_pk_bf16_f32 v109, 0, v109
  v_cndmask_b32 v178, 0, v161, s[76:77]
  v_cvt_pk_bf16_f32 v110, 0, v110
  v_cndmask_b32 v179, 0, v162, s[76:77]
  v_cvt_pk_bf16_f32 v111, 0, v111
  v_cndmask_b32 v180, 0, v159, s[78:79]
  v_pk_mul_f32 v[108:109], v[108:109], v[116:117] op_sel:[0,1]
  v_cndmask_b32 v181, 0, v160, s[78:79]
  v_pk_mul_f32 v[110:111], v[110:111], v[116:117] op_sel:[0,1]
  v_cvt_pk_bf16_f32 v238, v200, v108
  v_cvt_pk_bf16_f32 v242, v201, v109
  v_cvt_pk_bf16_f32 v246, v202, v110
  v_cvt_pk_bf16_f32 v250, v203, v111
  v_mad_u32_u24 v92, v97, s63, v3
  v_add_u32 v93, 768, v92
  v_add_u32 v94, 4608, v92
  v_add_u32 v95, 7680, v92
  v_cndmask_b32 v92, v92, v105, s[52:53]
  v_cndmask_b32 v95, v95, v105, s[54:55]
  s_waitcnt vmcnt(16)
  s_cbranch_vccnz L_vw0_18
  s_waitcnt vmcnt(9)
L_vw0_18:
  buffer_load_dwordx4 v[48:51], v92, s[12:15], s61 offen offset:0 nt
  v_mov_b32_dpp v116, v114 row_newbcast:6 row_mask:0xf bank_mask:0xf
  v_mov_b32_dpp v117, v115 row_newbcast:6 row_mask:0xf bank_mask:0xf
  v_pk_fma_f32 v[192:193], v[76:77], s[92:93], v[116:117] op_sel_hi:[1,1,0] neg_lo:[0,0,1] neg_hi:[0,0,1]
  v_pk_fma_f32 v[194:195], v[78:79], s[92:93], v[116:117] op_sel_hi:[1,1,0] neg_lo:[0,0,1] neg_hi:[0,0,1]
  v_cvt_pk_bf16_f32 v192, 0, v192
  v_cndmask_b32 v182, 0, v161, s[78:79]
  v_cvt_pk_bf16_f32 v193, 0, v193
  v_cndmask_b32 v183, 0, v162, s[78:79]
  v_cvt_pk_bf16_f32 v194, 0, v194
  s_waitcnt lgkmcnt(0)
  v_cvt_pk_bf16_f32 v195, 0, v195
  v_mul_f32 v128, v147, v128
  v_pk_mul_f32 v[192:193], v[192:193], v[116:117] op_sel:[0,1]
  v_mul_f32 v129, v147, v129
  v_pk_mul_f32 v[194:195], v[194:195], v[116:117] op_sel:[0,1]
  s_waitcnt vmcnt(14)
  buffer_load_dwordx4 v[52:55], v92, s[12:15], s61 offen offset:256 nt
  v_pk_fma_f32 v[196:197], v[80:81], s[92:93], v[116:117] op_sel_hi:[1,1,0] neg_lo:[0,0,1] neg_hi:[0,0,1]
  v_pk_fma_f32 v[198:199], v[82:83], s[92:93], v[116:117] op_sel_hi:[1,1,0] neg_lo:[0,0,1] neg_hi:[0,0,1]
  v_cvt_pk_bf16_f32 v196, 0, v196
  v_mul_f32 v130, v147, v130
  v_cvt_pk_bf16_f32 v197, 0, v197
  v_mul_f32 v131, v147, v131
  v_cvt_pk_bf16_f32 v198, 0, v198
  v_mul_f32 v132, v147, v132
  v_cvt_pk_bf16_f32 v199, 0, v199
  v_mul_f32 v133, v147, v133
  v_pk_mul_f32 v[196:197], v[196:197], v[116:117] op_sel:[0,1]
  v_mul_f32 v134, v147, v134
  v_pk_mul_f32 v[198:199], v[198:199], v[116:117] op_sel:[0,1]
  s_waitcnt vmcnt(14)
  buffer_load_dwordx4 v[56:59], v92, s[12:15], s61 offen offset:512 nt
  v_pk_fma_f32 v[200:201], v[84:85], s[92:93], v[116:117] op_sel_hi:[1,1,0] neg_lo:[0,0,1] neg_hi:[0,0,1]
  v_pk_fma_f32 v[202:203], v[86:87], s[92:93], v[116:117] op_sel_hi:[1,1,0] neg_lo:[0,0,1] neg_hi:[0,0,1]
  v_cvt_pk_bf16_f32 v200, 0, v200
  v_mul_f32 v135, v147, v135
  v_cvt_pk_bf16_f32 v201, 0, v201
  v_mul_f32 v136, v147, v136
  v_cvt_pk_bf16_f32 v202, 0, v202
  v_mul_f32 v137, v147, v137
  v_cvt_pk_bf16_f32 v203, 0, v203
  v_mul_f32 v138, v147, v138
  v_pk_mul_f32 v[200:201], v[200:201], v[116:117] op_sel:[0,1]
  v_mul_f32 v139, v147, v139
  v_pk_mul_f32 v[202:203], v[202:203], v[116:117] op_sel:[0,1]
  s_waitcnt vmcnt(14)
  s_cbranch_vccnz L_vw0_21
  s_waitcnt vmcnt(9)
L_vw0_21:
  buffer_load_dwordx4 v[60:63], v93, s[12:15], s61 offen offset:0 nt
  v_mov_b32_dpp v116, v114 row_newbcast:7 row_mask:0xf bank_mask:0xf
  v_mov_b32_dpp v117, v115 row_newbcast:7 row_mask:0xf bank_mask:0xf
  v_pk_fma_f32 v[108:109], v[88:89], s[92:93], v[116:117] op_sel_hi:[1,1,0] neg_lo:[0,0,1] neg_hi:[0,0,1]
  v_pk_fma_f32 v[110:111], v[90:91], s[92:93], v[116:117] op_sel_hi:[1,1,0] neg_lo:[0,0,1] neg_hi:[0,0,1]
  v_cvt_pk_bf16_f32 v108, 0, v108
  v_cvt_pk_bf16_f32 v109, 0, v109
  v_cvt_pk_bf16_f32 v110, 0, v110
  v_cvt_pk_bf16_f32 v111, 0, v111
  v_pk_mul_f32 v[108:109], v[108:109], v[116:117] op_sel:[0,1]
  v_pk_mul_f32 v[110:111], v[110:111], v[116:117] op_sel:[0,1]
  v_cvt_pk_bf16_f32 v207, v192, v108
  v_cvt_pk_bf16_f32 v211, v193, v109
  v_cvt_pk_bf16_f32 v215, v194, v110
  v_cvt_pk_bf16_f32 v219, v195, v111
  v_mfma_f32_16x16x32_bf16 v[128:131], v[168:171], v[204:207], v[128:131]
  v_mfma_f32_16x16x32_bf16 v[128:131], v[172:175], v[208:211], v[128:131]
  v_mfma_f32_16x16x32_bf16 v[128:131], v[176:179], v[212:215], v[128:131]
  v_mfma_f32_16x16x32_bf16 v[128:131], v[180:183], v[216:219], v[128:131]
  s_waitcnt vmcnt(14)
  buffer_load_dwordx4 v[64:67], v93, s[12:15], s61 offen offset:256 nt
  v_pk_fma_f32 v[108:109], v[4:5], s[92:93], v[116:117] op_sel_hi:[1,1,0] neg_lo:[0,0,1] neg_hi:[0,0,1]
  v_pk_fma_f32 v[110:111], v[6:7], s[92:93], v[116:117] op_sel_hi:[1,1,0] neg_lo:[0,0,1] neg_hi:[0,0,1]
  v_cvt_pk_bf16_f32 v108, 0, v108
  v_cvt_pk_bf16_f32 v109, 0, v109
  v_cvt_pk_bf16_f32 v110, 0, v110
  v_cvt_pk_bf16_f32 v111, 0, v111
  v_pk_mul_f32 v[108:109], v[108:109], v[116:117] op_sel:[0,1]
  v_pk_mul_f32 v[110:111], v[110:111], v[116:117] op_sel:[0,1]
  v_cvt_pk_bf16_f32 v223, v196, v108
  v_cvt_pk_bf16_f32 v227, v197, v109
  v_cvt_pk_bf16_f32 v231, v198, v110
  v_cvt_pk_bf16_f32 v235, v199, v111
  v_mfma_f32_16x16x32_bf16 v[132:135], v[168:171], v[220:223], v[132:135]
  v_mfma_f32_16x16x32_bf16 v[132:135], v[172:175], v[224:227], v[132:135]
  v_mfma_f32_16x16x32_bf16 v[132:135], v[176:179], v[228:231], v[132:135]
  v_mfma_f32_16x16x32_bf16 v[132:135], v[180:183], v[232:235], v[132:135]
  s_waitcnt vmcnt(14)
  buffer_load_dwordx4 v[68:71], v93, s[12:15], s61 offen offset:512 nt
  v_pk_fma_f32 v[108:109], v[8:9], s[92:93], v[116:117] op_sel_hi:[1,1,0] neg_lo:[0,0,1] neg_hi:[0,0,1]
  v_pk_fma_f32 v[110:111], v[10:11], s[92:93], v[116:117] op_sel_hi:[1,1,0] neg_lo:[0,0,1] neg_hi:[0,0,1]
  v_cvt_pk_bf16_f32 v108, 0, v108
  v_cvt_pk_bf16_f32 v109, 0, v109
  v_cvt_pk_bf16_f32 v110, 0, v110
  v_cvt_pk_bf16_f32 v111, 0, v111
  v_pk_mul_f32 v[108:109], v[108:109], v[116:117] op_sel:[0,1]
  v_pk_mul_f32 v[110:111], v[110:111], v[116:117] op_sel:[0,1]
  v_cvt_pk_bf16_f32 v239, v200, v108
  v_cvt_pk_bf16_f32 v243, v201, v109
  v_cvt_pk_bf16_f32 v247, v202, v110
  v_cvt_pk_bf16_f32 v251, v203, v111
  v_mfma_f32_16x16x32_bf16 v[136:139], v[168:171], v[236:239], v[136:139]
  v_mfma_f32_16x16x32_bf16 v[136:139], v[172:175], v[240:243], v[136:139]
  v_mfma_f32_16x16x32_bf16 v[136:139], v[176:179], v[244:247], v[136:139]
  v_mfma_f32_16x16x32_bf16 v[136:139], v[180:183], v[248:251], v[136:139]
  s_waitcnt vmcnt(14)
  s_cbranch_vccnz L_vw0_24
  s_waitcnt vmcnt(9)
L_vw0_24:
  buffer_load_dwordx4 v[72:75], v93, s[12:15], s61 offen offset:768 nt
  v_mov_b32_dpp v116, v114 row_newbcast:8 row_mask:0xf bank_mask:0xf
  v_mov_b32_dpp v117, v115 row_newbcast:8 row_mask:0xf bank_mask:0xf
  v_pk_fma_f32 v[192:193], v[12:13], s[92:93], v[116:117] op_sel_hi:[1,1,0] neg_lo:[0,0,1] neg_hi:[0,0,1]
  v_pk_fma_f32 v[194:195], v[14:15], s[92:93], v[116:117] op_sel_hi:[1,1,0] neg_lo:[0,0,1] neg_hi:[0,0,1]
  v_cvt_pk_bf16_f32 v192, 0, v192
  v_cndmask_b32 v184, 0, v163, s[72:73]
  v_cvt_pk_bf16_f32 v193, 0, v193
  v_cndmask_b32 v185, 0, v164, s[72:73]
  v_cvt_pk_bf16_f32 v194, 0, v194
  v_cndmask_b32 v186, 0, v163, s[74:75]
  v_cvt_pk_bf16_f32 v195, 0, v195
  v_cndmask_b32 v187, 0, v164, s[74:75]
  v_pk_mul_f32 v[192:193], v[192:193], v[116:117] op_sel:[0,1]
  v_cndmask_b32 v188, 0, v163, s[76:77]
  v_pk_mul_f32 v[194:195], v[194:195], v[116:117] op_sel:[0,1]
  s_waitcnt vmcnt(14)
  buffer_load_dwordx4 v[76:79], v93, s[12:15], s61 offen offset:1024 nt
  v_pk_fma_f32 v[196:197], v[16:17], s[92:93], v[116:117] op_sel_hi:[1,1,0] neg_lo:[0,0,1] neg_hi:[0,0,1]
  v_pk_fma_f32 v[198:199], v[18:19], s[92:93], v[116:117] op_sel_hi:[1,1,0] neg_lo:[0,0,1] neg_hi:[0,0,1]
  v_cvt_pk_bf16_f32 v196, 0, v196
  v_cndmask_b32 v189, 0, v164, s[76:77]
  v_cvt_pk_bf16_f32 v197, 0, v197
  v_cndmask_b32 v190, 0, v163, s[78:79]
  v_cvt_pk_bf16_f32 v198, 0, v198
  v_cndmask_b32 v191, 0, v164, s[78:79]
  v_cvt_pk_bf16_f32 v199, 0, v199
  v_pk_mul_f32 v[196:197], v[196:197], v[116:117] op_sel:[0,1]
  v_pk_mul_f32 v[198:199], v[198:199], v[116:117] op_sel:[0,1]
  s_waitcnt vmcnt(14)
  buffer_load_dwordx4 v[80:83], v93, s[12:15], s61 offen offset:1280 nt
  v_pk_fma_f32 v[200:201], v[20:21], s[92:93], v[116:117] op_sel_hi:[1,1,0] neg_lo:[0,0,1] neg_hi:[0,0,1]
  v_pk_fma_f32 v[202:203], v[22:23], s[92:93], v[116:117] op_sel_hi:[1,1,0] neg_lo:[0,0,1] neg_hi:[0,0,1]
  v_cvt_pk_bf16_f32 v200, 0, v200
  v_cvt_pk_bf16_f32 v201, 0, v201
  v_cvt_pk_bf16_f32 v202, 0, v202
  v_cvt_pk_bf16_f32 v203, 0, v203
  v_pk_mul_f32 v[200:201], v[200:201], v[116:117] op_sel:[0,1]
  v_pk_mul_f32 v[202:203], v[202:203], v[116:117] op_sel:[0,1]
  s_waitcnt vmcnt(14)
  s_cbranch_vccnz L_vw0_27
  s_waitcnt vmcnt(9)
L_vw0_27:
  buffer_load_dwordx4 v[84:87], v93, s[12:15], s61 offen offset:1536 nt
  v_mov_b32_dpp v116, v114 row_newbcast:9 row_mask:0xf bank_mask:0xf
  v_mov_b32_dpp v117, v115 row_newbcast:9 row_mask:0xf bank_mask:0xf
  v_pk_fma_f32 v[108:109], v[24:25], s[92:93], v[116:117] op_sel_hi:[1,1,0] neg_lo:[0,0,1] neg_hi:[0,0,1]
  v_pk_fma_f32 v[110:111], v[26:27], s[92:93], v[116:117] op_sel_hi:[1,1,0] neg_lo:[0,0,1] neg_hi:[0,0,1]
  v_cvt_pk_bf16_f32 v108, 0, v108
  v_cvt_pk_bf16_f32 v109, 0, v109
  v_cvt_pk_bf16_f32 v110, 0, v110
  v_cvt_pk_bf16_f32 v111, 0, v111
  v_pk_mul_f32 v[108:109], v[108:109], v[116:117] op_sel:[0,1]
  v_pk_mul_f32 v[110:111], v[110:111], v[116:117] op_sel:[0,1]
  v_cvt_pk_bf16_f32 v204, v192, v108
  v_cvt_pk_bf16_f32 v208, v193, v109
  v_cvt_pk_bf16_f32 v212, v194, v110
  v_cvt_pk_bf16_f32 v216, v195, v111
  s_waitcnt vmcnt(14)
  buffer_load_dwordx4 v[88:91], v93, s[12:15], s61 offen offset:1792 nt
  v_pk_fma_f32 v[108:109], v[28:29], s[92:93], v[116:117] op_sel_hi:[1,1,0] neg_lo:[0,0,1] neg_hi:[0,0,1]
  v_pk_fma_f32 v[110:111], v[30:31], s[92:93], v[116:117] op_sel_hi:[1,1,0] neg_lo:[0,0,1] neg_hi:[0,0,1]
  v_cvt_pk_bf16_f32 v108, 0, v108
  v_cvt_pk_bf16_f32 v109, 0, v109
  v_cvt_pk_bf16_f32 v110, 0, v110
  v_cvt_pk_bf16_f32 v111, 0, v111
  v_pk_mul_f32 v[108:109], v[108:109], v[116:117] op_sel:[0,1]
  v_pk_mul_f32 v[110:111], v[110:111], v[116:117] op_sel:[0,1]
  v_cvt_pk_bf16_f32 v220, v196, v108
  v_cvt_pk_bf16_f32 v224, v197, v109
  v_cvt_pk_bf16_f32 v228, v198, v110
  v_cvt_pk_bf16_f32 v232, v199, v111
  s_waitcnt vmcnt(14)
  buffer_load_dwordx4 v[4:7], v93, s[12:15], s61 offen offset:2048 nt
  v_pk_fma_f32 v[108:109], v[32:33], s[92:93], v[116:117] op_sel_hi:[1,1,0] neg_lo:[0,0,1] neg_hi:[0,0,1]
  v_pk_fma_f32 v[110:111], v[34:35], s[92:93], v[116:117] op_sel_hi:[1,1,0] neg_lo:[0,0,1] neg_hi:[0,0,1]
  v_cvt_pk_bf16_f32 v108, 0, v108
  v_cvt_pk_bf16_f32 v109, 0, v109
  v_cvt_pk_bf16_f32 v110, 0, v110
  v_cvt_pk_bf16_f32 v111, 0, v111
  v_pk_mul_f32 v[108:109], v[108:109], v[116:117] op_sel:[0,1]
  v_pk_mul_f32 v[110:111], v[110:111], v[116:117] op_sel:[0,1]
  v_cvt_pk_bf16_f32 v236, v200, v108
  v_cvt_pk_bf16_f32 v240, v201, v109
  v_cvt_pk_bf16_f32 v244, v202, v110
  v_cvt_pk_bf16_f32 v248, v203, v111
  s_waitcnt vmcnt(14)
  s_cbranch_vccnz L_vw0_30
  s_waitcnt vmcnt(9)
L_vw0_30:
  buffer_load_dwordx4 v[8:11], v93, s[12:15], s61 offen offset:2304 nt
  v_mov_b32_dpp v116, v114 row_newbcast:10 row_mask:0xf bank_mask:0xf
  v_mov_b32_dpp v117, v115 row_newbcast:10 row_mask:0xf bank_mask:0xf
  v_pk_fma_f32 v[192:193], v[36:37], s[92:93], v[116:117] op_sel_hi:[1,1,0] neg_lo:[0,0,1] neg_hi:[0,0,1]
  v_pk_fma_f32 v[194:195], v[38:39], s[92:93], v[116:117] op_sel_hi:[1,1,0] neg_lo:[0,0,1] neg_hi:[0,0,1]
  v_cvt_pk_bf16_f32 v192, 0, v192
  v_cvt_pk_bf16_f32 v193, 0, v193
  v_cvt_pk_bf16_f32 v194, 0, v194
  v_cvt_pk_bf16_f32 v195, 0, v195
  v_pk_mul_f32 v[192:193], v[192:193], v[116:117] op_sel:[0,1]
  v_pk_mul_f32 v[194:195], v[194:195], v[116:117] op_sel:[0,1]
  v_cvt_pk_bf16_f32 v205, v192, 0
  v_cvt_pk_bf16_f32 v209, v193, 0
  v_cvt_pk_bf16_f32 v213, v194, 0
  v_cvt_pk_bf16_f32 v217, v195, 0
  v_mfma_f32_16x16x16_bf16 v[128:131], v[184:185], v[204:205], v[128:131]
  v_mfma_f32_16x16x16_bf16 v[128:131], v[186:187], v[208:209], v[128:131]
  v_mfma_f32_16x16x16_bf16 v[128:131], v[188:189], v[212:213], v[128:131]
  v_mfma_f32_16x16x16_bf16 v[128:131], v[190:191], v[216:217], v[128:131]
  s_waitcnt vmcnt(14)
  buffer_load_dwordx4 v[12:15], v93, s[12:15], s61 offen offset:2560 nt
  v_pk_fma_f32 v[196:197], v[40:41], s[92:93], v[116:117] op_sel_hi:[1,1,0] neg_lo:[0,0,1] neg_hi:[0,0,1]
  v_pk_fma_f32 v[198:199], v[42:43], s[92:93], v[116:117] op_sel_hi:[1,1,0] neg_lo:[0,0,1] neg_hi:[0,0,1]
  v_cvt_pk_bf16_f32 v196, 0, v196
  v_cvt_pk_bf16_f32 v197, 0, v197
  v_cvt_pk_bf16_f32 v198, 0, v198
  v_cvt_pk_bf16_f32 v199, 0, v199
  v_pk_mul_f32 v[196:197], v[196:197], v[116:117] op_sel:[0,1]
  v_pk_mul_f32 v[198:199], v[198:199], v[116:117] op_sel:[0,1]
  v_cvt_pk_bf16_f32 v221, v196, 0
  v_cvt_pk_bf16_f32 v225, v197, 0
  v_cvt_pk_bf16_f32 v229, v198, 0
  v_cvt_pk_bf16_f32 v233, v199, 0
  v_mfma_f32_16x16x16_bf16 v[132:135], v[184:185], v[220:221], v[132:135]
  v_mfma_f32_16x16x16_bf16 v[132:135], v[186:187], v[224:225], v[132:135]
  v_mfma_f32_16x16x16_bf16 v[132:135], v[188:189], v[228:229], v[132:135]
  v_mfma_f32_16x16x16_bf16 v[132:135], v[190:191], v[232:233], v[132:135]
  s_waitcnt vmcnt(14)
  buffer_load_dwordx4 v[16:19], v93, s[12:15], s61 offen offset:2816 nt
  v_pk_fma_f32 v[200:201], v[44:45], s[92:93], v[116:117] op_sel_hi:[1,1,0] neg_lo:[0,0,1] neg_hi:[0,0,1]
  v_pk_fma_f32 v[202:203], v[46:47], s[92:93], v[116:117] op_sel_hi:[1,1,0] neg_lo:[0,0,1] neg_hi:[0,0,1]
  v_cvt_pk_bf16_f32 v200, 0, v200
  v_cvt_pk_bf16_f32 v201, 0, v201
  v_cvt_pk_bf16_f32 v202, 0, v202
  v_cvt_pk_bf16_f32 v203, 0, v203
  v_pk_mul_f32 v[200:201], v[200:201], v[116:117] op_sel:[0,1]
  v_pk_mul_f32 v[202:203], v[202:203], v[116:117] op_sel:[0,1]
  v_cvt_pk_bf16_f32 v237, v200, 0
  v_cvt_pk_bf16_f32 v241, v201, 0
  v_cvt_pk_bf16_f32 v245, v202, 0
  v_cvt_pk_bf16_f32 v249, v203, 0
  v_mfma_f32_16x16x16_bf16 v[136:139], v[184:185], v[236:237], v[136:139]
  v_mfma_f32_16x16x16_bf16 v[136:139], v[186:187], v[240:241], v[136:139]
  v_mfma_f32_16x16x16_bf16 v[136:139], v[188:189], v[244:245], v[136:139]
  v_mfma_f32_16x16x16_bf16 v[136:139], v[190:191], v[248:249], v[136:139]
  s_mov_b32 s60, s61
L_v1:
  s_add_u32 s97, s64, 96
  v_mov_b32 v146, s97
  s_mov_b32 s86, s84
  s_mov_b32 s87, s85
  ds_write_b32 v104, v146
  s_add_u32 s64, s64, 2
  s_cmp_lt_u32 s64, s99
  s_cbranch_scc1 L_v11_ok
L_v11_spin:
  v_mov_b32 v144, 61700
  ds_read_b32 v144, v144
  s_waitcnt lgkmcnt(0)
  v_readfirstlane_b32 s99, v144
  s_nop 1
  s_cmp_lt_u32 s64, s99
  s_cbranch_scc0 L_v11_spin
L_v11_ok:
  s_lshr_b32 s71, s64, 5
  s_lshr_b32 s85, s96, s71
  s_bfe_u32 s85, s85, 0x10003
  s_add_u32 s70, s64, s5
  s_mul_i32 s71, s71, 4064
  s_add_u32 s70, s70, s71
  s_mul_hi_u32 s84, s70, s90
  s_lshr_b32 s84, s84, 1
  s_mul_i32 s71, s84, 3
  s_sub_u32 s70, s70, s71
  s_lshl3_add_u32 s85, s70, s85
  s_mul_i32 s61, s84, 196608
  s_lshr_b32 s89, s84, 4
  s_lshl_b32 s70, s85, 5
  v_add_u32 v97, s70, v1
  v_mul_u32_u24 v97, 21846, v97
  v_lshrrev_b32 v97, 16, v97
  v_add_u32 v144, s85, v2
  v_lshrrev_b32 v145, v144, s91
  v_and_b32 v145, 1, v145
  v_cmp_eq_u32 s[54:55], 1, v145
  s_nop 1
  s_and_b64 s[52:53], s[54:55], s[58:59]
  s_andn2_b64 s[54:55], s[54:55], s[58:59]
  s_cmp_lt_u32 s64, 96
  s_cselect_b32 s61, s61, 805306368
  ds_read_b32 v106, v104 offset:8
  s_waitcnt vmcnt(14)
  s_cbranch_vccnz L_vw1_0
  s_waitcnt vmcnt(9)
L_vw1_0:
  buffer_load_dwordx4 v[20:23], v93, s[12:15], s60 offen offset:3072 nt
  v_mul_f32 v114, s94, v112
  v_mul_f32 v115, 0x4a800000, v113
  s_nop 0
  v_mov_b32_dpp v116, v114 row_newbcast:0 row_mask:0xf bank_mask:0xf
  v_mov_b32_dpp v117, v115 row_newbcast:0 row_mask:0xf bank_mask:0xf
  v_pk_fma_f32 v[192:193], v[48:49], s[92:93], v[116:117] op_sel_hi:[1,1,0] neg_lo:[0,0,1] neg_hi:[0,0,1]
  v_pk_fma_f32 v[194:195], v[50:51], s[92:93], v[116:117] op_sel_hi:[1,1,0] neg_lo:[0,0,1] neg_hi:[0,0,1]
  v_cvt_pk_bf16_f32 v192, 0, v192
  v_cvt_pk_bf16_f32 v193, 0, v193
  v_cvt_pk_bf16_f32 v194, 0, v194
  v_cvt_pk_bf16_f32 v195, 0, v195
  v_pk_mul_f32 v[192:193], v[192:193], v[116:117] op_sel:[0,1]
  v_pk_mul_f32 v[194:195], v[194:195], v[116:117] op_sel:[0,1]
  s_waitcnt lgkmcnt(0)
  v_cmp_lt_u32 vcc, s97, v106
  s_waitcnt vmcnt(14)
  buffer_load_dwordx4 v[24:27], v93, s[12:15], s60 offen offset:3328 nt
  v_pk_fma_f32 v[196:197], v[52:53], s[92:93], v[116:117] op_sel_hi:[1,1,0] neg_lo:[0,0,1] neg_hi:[0,0,1]
  v_pk_fma_f32 v[198:199], v[54:55], s[92:93], v[116:117] op_sel_hi:[1,1,0] neg_lo:[0,0,1] neg_hi:[0,0,1]
  v_cvt_pk_bf16_f32 v196, 0, v196
  v_lshlrev_b32 v148, 16, v120
  v_cvt_pk_bf16_f32 v197, 0, v197
  v_and_b32 v149, s65, v120
  v_cvt_pk_bf16_f32 v198, 0, v198
  v_lshlrev_b32 v150, 16, v121
  v_cvt_pk_bf16_f32 v199, 0, v199
  v_and_b32 v151, s65, v121
  v_pk_mul_f32 v[196:197], v[196:197], v[116:117] op_sel:[0,1]
  v_lshlrev_b32 v152, 16, v122
  v_pk_mul_f32 v[198:199], v[198:199], v[116:117] op_sel:[0,1]
  s_waitcnt vmcnt(14)
  buffer_load_dwordx4 v[28:31], v93, s[12:15], s60 offen offset:3584 nt
  v_pk_fma_f32 v[200:201], v[56:57], s[92:93], v[116:117] op_sel_hi:[1,1,0] neg_lo:[0,0,1] neg_hi:[0,0,1]
  v_pk_fma_f32 v[202:203], v[58:59], s[92:93], v[116:117] op_sel_hi:[1,1,0] neg_lo:[0,0,1] neg_hi:[0,0,1]
  v_cvt_pk_bf16_f32 v200, 0, v200
  v_and_b32 v153, s65, v122
  v_cvt_pk_bf16_f32 v201, 0, v201
  v_lshlrev_b32 v154, 16, v123
  v_cvt_pk_bf16_f32 v202, 0, v202
  v_and_b32 v155, s65, v123
  v_cvt_pk_bf16_f32 v203, 0, v203
  v_lshlrev_b32 v156, 16, v124
  v_pk_mul_f32 v[200:201], v[200:201], v[116:117] op_sel:[0,1]
  v_and_b32 v157, s65, v124
  v_pk_mul_f32 v[202:203], v[202:203], v[116:117] op_sel:[0,1]
  s_waitcnt vmcnt(14)
  s_cbranch_vccnz L_vw1_3
  s_waitcnt vmcnt(9)
L_vw1_3:
  buffer_load_dwordx4 v[32:35], v94, s[12:15], s60 offen offset:0 nt
  v_mov_b32_dpp v116, v114 row_newbcast:1 row_mask:0xf bank_mask:0xf
  v_mov_b32_dpp v117, v115 row_newbcast:1 row_mask:0xf bank_mask:0xf
  v_pk_fma_f32 v[108:109], v[60:61], s[92:93], v[116:117] op_sel_hi:[1,1,0] neg_lo:[0,0,1] neg_hi:[0,0,1]
  v_pk_fma_f32 v[110:111], v[62:63], s[92:93], v[116:117] op_sel_hi:[1,1,0] neg_lo:[0,0,1] neg_hi:[0,0,1]
  s_lshl_b32 s62, s84, 9
  v_lshl_add_u32 v98, v97, 1, v96
  buffer_load_short_d16_hi v112, v98, s[32:35], s62 offen
  buffer_load_short_d16_hi v113, v98, s[28:31], s62 offen
  v_cvt_pk_bf16_f32 v108, 0, v108
  v_lshlrev_b32 v158, 16, v125
  v_cvt_pk_bf16_f32 v109, 0, v109
  v_add_u32 v99, 768, v99
  v_cvt_pk_bf16_f32 v110, 0, v110
  v_add_u32 v100, 768, v100
  v_cvt_pk_bf16_f32 v111, 0, v111
  v_max3_f32 v144, v148, v149, v150
  v_pk_mul_f32 v[108:109], v[108:109], v[116:117] op_sel:[0,1]
  ds_read_b128 v[120:123], v99
  v_pk_mul_f32 v[110:111], v[110:111], v[116:117] op_sel:[0,1]
  v_cvt_pk_bf16_f32 v204, v192, v108
  v_cvt_pk_bf16_f32 v208, v193, v109
  v_cvt_pk_bf16_f32 v212, v194, v110
  v_cvt_pk_bf16_f32 v216, v195, v111
  s_waitcnt vmcnt(16)
  buffer_load_dwordx4 v[36:39], v94, s[12:15], s60 offen offset:256 nt
  v_pk_fma_f32 v[108:109], v[64:65], s[92:93], v[116:117] op_sel_hi:[1,1,0] neg_lo:[0,0,1] neg_hi:[0,0,1]
  v_pk_fma_f32 v[110:111], v[66:67], s[92:93], v[116:117] op_sel_hi:[1,1,0] neg_lo:[0,0,1] neg_hi:[0,0,1]
  v_cvt_pk_bf16_f32 v108, 0, v108
  ds_read_b64 v[124:125], v100 offset:256
  v_cvt_pk_bf16_f32 v109, 0, v109
  v_max3_f32 v145, v151, v152, v153
  v_cvt_pk_bf16_f32 v110, 0, v110
  v_max3_f32 v144, v144, v154, v155
  v_cvt_pk_bf16_f32 v111, 0, v111
  v_max3_f32 v145, v145, v156, v157
  v_pk_mul_f32 v[108:109], v[108:109], v[116:117] op_sel:[0,1]
  v_max3_f32 v144, v144, v158, v140
  v_pk_mul_f32 v[110:111], v[110:111], v[116:117] op_sel:[0,1]
  v_cvt_pk_bf16_f32 v220, v196, v108
  v_cvt_pk_bf16_f32 v224, v197, v109
  v_cvt_pk_bf16_f32 v228, v198, v110
  v_cvt_pk_bf16_f32 v232, v199, v111
  s_waitcnt vmcnt(16)
  buffer_load_dwordx4 v[40:43], v94, s[12:15], s60 offen offset:512 nt
  v_pk_fma_f32 v[108:109], v[68:69], s[92:93], v[116:117] op_sel_hi:[1,1,0] neg_lo:[0,0,1] neg_hi:[0,0,1]
  v_pk_fma_f32 v[110:111], v[70:71], s[92:93], v[116:117] op_sel_hi:[1,1,0] neg_lo:[0,0,1] neg_hi:[0,0,1]
  v_cvt_pk_bf16_f32 v108, 0, v108
  v_max_f32 v144, v144, v145
  v_cvt_pk_bf16_f32 v109, 0, v109
  v_mov_b32 v145, v144
  v_cvt_pk_bf16_f32 v110, 0, v110
  s_nop 0
  v_permlane32_swap_b32 v144, v145
  v_cvt_pk_bf16_f32 v111, 0, v111
  v_max_f32 v144, v144, v145
  v_pk_mul_f32 v[108:109], v[108:109], v[116:117] op_sel:[0,1]
  v_mov_b32 v145, v144
  v_pk_mul_f32 v[110:111], v[110:111], v[116:117] op_sel:[0,1]
  v_cvt_pk_bf16_f32 v236, v200, v108
  v_cvt_pk_bf16_f32 v240, v201, v109
  v_cvt_pk_bf16_f32 v244, v202, v110
  v_cvt_pk_bf16_f32 v248, v203, v111
  s_waitcnt vmcnt(16)
  s_cbranch_vccnz L_vw1_6
  s_waitcnt vmcnt(11)
L_vw1_6:
  buffer_load_dwordx4 v[44:47], v94, s[12:15], s60 offen offset:768 nt
  v_mov_b32_dpp v116, v114 row_newbcast:2 row_mask:0xf bank_mask:0xf
  v_mov_b32_dpp v117, v115 row_newbcast:2 row_mask:0xf bank_mask:0xf
  v_pk_fma_f32 v[192:193], v[72:73], s[92:93], v[116:117] op_sel_hi:[1,1,0] neg_lo:[0,0,1] neg_hi:[0,0,1]
  v_pk_fma_f32 v[194:195], v[74:75], s[92:93], v[116:117] op_sel_hi:[1,1,0] neg_lo:[0,0,1] neg_hi:[0,0,1]
  v_cvt_pk_bf16_f32 v192, 0, v192
  v_permlane16_swap_b32 v144, v145
  v_cvt_pk_bf16_f32 v193, 0, v193
  v_max_f32 v140, v144, v145
  v_cvt_pk_bf16_f32 v194, 0, v194
  v_mul_f32 v144, s66, v140
  v_cvt_pk_bf16_f32 v195, 0, v195
  v_add_f32 v146, v144, v142
  v_pk_mul_f32 v[192:193], v[192:193], v[116:117] op_sel:[0,1]
  v_sub_f32 v142, 0, v144
  v_pk_mul_f32 v[194:195], v[194:195], v[116:117] op_sel:[0,1]
  s_waitcnt vmcnt(16)
  buffer_load_dwordx4 v[48:51], v94, s[12:15], s60 offen offset:1024 nt
  v_pk_fma_f32 v[196:197], v[76:77], s[92:93], v[116:117] op_sel_hi:[1,1,0] neg_lo:[0,0,1] neg_hi:[0,0,1]
  v_pk_fma_f32 v[198:199], v[78:79], s[92:93], v[116:117] op_sel_hi:[1,1,0] neg_lo:[0,0,1] neg_hi:[0,0,1]
  v_cvt_pk_bf16_f32 v196, 0, v196
  v_exp_f32 v146, -v146
  v_cvt_pk_bf16_f32 v197, 0, v197
  ds_bpermute_b32 v147, v101, v146
  v_cvt_pk_bf16_f32 v198, 0, v198
  v_fma_f32 v148, v148, s66, v142
  v_cvt_pk_bf16_f32 v199, 0, v199
  v_exp_f32 v148, v148
  v_pk_mul_f32 v[196:197], v[196:197], v[116:117] op_sel:[0,1]
  v_fma_f32 v149, v149, s66, v142
  v_pk_mul_f32 v[198:199], v[198:199], v[116:117] op_sel:[0,1]
  s_waitcnt vmcnt(16)
  buffer_load_dwordx4 v[52:55], v94, s[12:15], s60 offen offset:1280 nt
  v_pk_fma_f32 v[200:201], v[80:81], s[92:93], v[116:117] op_sel_hi:[1,1,0] neg_lo:[0,0,1] neg_hi:[0,0,1]
  v_pk_fma_f32 v[202:203], v[82:83], s[92:93], v[116:117] op_sel_hi:[1,1,0] neg_lo:[0,0,1] neg_hi:[0,0,1]
  v_cvt_pk_bf16_f32 v200, 0, v200
  v_exp_f32 v149, v149
  v_cvt_pk_bf16_f32 v201, 0, v201
  v_fma_f32 v150, v150, s66, v142
  v_cvt_pk_bf16_f32 v202, 0, v202
  v_exp_f32 v150, v150
  v_cvt_pk_bf16_f32 v203, 0, v203
  v_fma_f32 v151, v151, s66, v142
  v_pk_mul_f32 v[200:201], v[200:201], v[116:117] op_sel:[0,1]
  v_exp_f32 v151, v151
  v_pk_mul_f32 v[202:203], v[202:203], v[116:117] op_sel:[0,1]
  s_waitcnt vmcnt(16)
  s_cbranch_vccnz L_vw1_9
  s_waitcnt vmcnt(11)
L_vw1_9:
  buffer_load_dwordx4 v[56:59], v94, s[12:15], s60 offen offset:1536 nt
  v_mov_b32_dpp v116, v114 row_newbcast:3 row_mask:0xf bank_mask:0xf
  v_mov_b32_dpp v117, v115 row_newbcast:3 row_mask:0xf bank_mask:0xf
  v_pk_fma_f32 v[108:109], v[84:85], s[92:93], v[116:117] op_sel_hi:[1,1,0] neg_lo:[0,0,1] neg_hi:[0,0,1]
  v_pk_fma_f32 v[110:111], v[86:87], s[92:93], v[116:117] op_sel_hi:[1,1,0] neg_lo:[0,0,1] neg_hi:[0,0,1]
  v_cvt_pk_bf16_f32 v108, 0, v108
  v_fma_f32 v152, v152, s66, v142
  v_cvt_pk_bf16_f32 v109, 0, v109
  v_exp_f32 v152, v152
  v_cvt_pk_bf16_f32 v110, 0, v110
  v_fma_f32 v153, v153, s66, v142
  v_cvt_pk_bf16_f32 v111, 0, v111
  v_exp_f32 v153, v153
  v_pk_mul_f32 v[108:109], v[108:109], v[116:117] op_sel:[0,1]
  v_fma_f32 v154, v154, s66, v142
  v_pk_mul_f32 v[110:111], v[110:111], v[116:117] op_sel:[0,1]
  v_cvt_pk_bf16_f32 v205, v192, v108
  v_cvt_pk_bf16_f32 v209, v193, v109
  v_cvt_pk_bf16_f32 v213, v194, v110
  v_cvt_pk_bf16_f32 v217, v195, v111
  s_waitcnt vmcnt(16)
  buffer_load_dwordx4 v[60:63], v94, s[12:15], s60 offen offset:1792 nt
  v_pk_fma_f32 v[108:109], v[88:89], s[92:93], v[116:117] op_sel_hi:[1,1,0] neg_lo:[0,0,1] neg_hi:[0,0,1]
  v_pk_fma_f32 v[110:111], v[90:91], s[92:93], v[116:117] op_sel_hi:[1,1,0] neg_lo:[0,0,1] neg_hi:[0,0,1]
  v_cvt_pk_bf16_f32 v108, 0, v108
  v_exp_f32 v154, v154
  v_cvt_pk_bf16_f32 v109, 0, v109
  v_fma_f32 v155, v155, s66, v142
  v_cvt_pk_bf16_f32 v110, 0, v110
  v_exp_f32 v155, v155
  v_cvt_pk_bf16_f32 v111, 0, v111
  v_fma_f32 v156, v156, s66, v142
  v_pk_mul_f32 v[108:109], v[108:109], v[116:117] op_sel:[0,1]
  v_exp_f32 v156, v156
  v_pk_mul_f32 v[110:111], v[110:111], v[116:117] op_sel:[0,1]
  v_cvt_pk_bf16_f32 v221, v196, v108
  v_cvt_pk_bf16_f32 v225, v197, v109
  v_cvt_pk_bf16_f32 v229, v198, v110
  v_cvt_pk_bf16_f32 v233, v199, v111
  s_waitcnt vmcnt(16)
  buffer_load_dwordx4 v[64:67], v94, s[12:15], s60 offen offset:2048 nt
  v_pk_fma_f32 v[108:109], v[4:5], s[92:93], v[116:117] op_sel_hi:[1,1,0] neg_lo:[0,0,1] neg_hi:[0,0,1]
  v_pk_fma_f32 v[110:111], v[6:7], s[92:93], v[116:117] op_sel_hi:[1,1,0] neg_lo:[0,0,1] neg_hi:[0,0,1]
  v_cvt_pk_bf16_f32 v108, 0, v108
  v_fma_f32 v157, v157, s66, v142
  v_cvt_pk_bf16_f32 v109, 0, v109
  v_exp_f32 v157, v157
  v_cvt_pk_bf16_f32 v110, 0, v110
  v_fma_f32 v158, v158, s66, v142
  v_cvt_pk_bf16_f32 v111, 0, v111
  v_exp_f32 v158, v158
  v_pk_mul_f32 v[108:109], v[108:109], v[116:117] op_sel:[0,1]
  v_add_f32 v144, v148, v149
  v_pk_mul_f32 v[110:111], v[110:111], v[116:117] op_sel:[0,1]
  v_cvt_pk_bf16_f32 v237, v200, v108
  v_cvt_pk_bf16_f32 v241, v201, v109
  v_cvt_pk_bf16_f32 v245, v202, v110
  v_cvt_pk_bf16_f32 v249, v203, v111
  s_waitcnt vmcnt(16)
  s_cbranch_vccnz L_vw1_12
  s_waitcnt vmcnt(11)
L_vw1_12:
  buffer_load_dwordx4 v[68:71], v94, s[12:15], s60 offen offset:2304 nt
  v_mov_b32_dpp v116, v114 row_newbcast:4 row_mask:0xf bank_mask:0xf
  v_mov_b32_dpp v117, v115 row_newbcast:4 row_mask:0xf bank_mask:0xf
  v_pk_fma_f32 v[192:193], v[8:9], s[92:93], v[116:117] op_sel_hi:[1,1,0] neg_lo:[0,0,1] neg_hi:[0,0,1]
  v_pk_fma_f32 v[194:195], v[10:11], s[92:93], v[116:117] op_sel_hi:[1,1,0] neg_lo:[0,0,1] neg_hi:[0,0,1]
  v_cvt_pk_bf16_f32 v192, 0, v192
  v_add_f32 v145, v150, v151
  v_cvt_pk_bf16_f32 v193, 0, v193
  v_add_f32 v144, v144, v152
  v_cvt_pk_bf16_f32 v194, 0, v194
  v_add_f32 v145, v145, v153
  v_cvt_pk_bf16_f32 v195, 0, v195
  v_add_f32 v144, v144, v154
  v_pk_mul_f32 v[192:193], v[192:193], v[116:117] op_sel:[0,1]
  v_add_f32 v145, v145, v155
  v_pk_mul_f32 v[194:195], v[194:195], v[116:117] op_sel:[0,1]
  s_waitcnt vmcnt(16)
  buffer_load_dwordx4 v[72:75], v94, s[12:15], s60 offen offset:2560 nt
  v_pk_fma_f32 v[196:197], v[12:13], s[92:93], v[116:117] op_sel_hi:[1,1,0] neg_lo:[0,0,1] neg_hi:[0,0,1]
  v_pk_fma_f32 v[198:199], v[14:15], s[92:93], v[116:117] op_sel_hi:[1,1,0] neg_lo:[0,0,1] neg_hi:[0,0,1]
  v_cvt_pk_bf16_f32 v196, 0, v196
  v_add_f32 v144, v144, v156
  v_cvt_pk_bf16_f32 v197, 0, v197
  v_add_f32 v145, v145, v157
  v_cvt_pk_bf16_f32 v198, 0, v198
  v_add_f32 v144, v144, v158
  v_cvt_pk_bf16_f32 v199, 0, v199
  v_add_f32 v144, v144, v145
  v_pk_mul_f32 v[196:197], v[196:197], v[116:117] op_sel:[0,1]
  v_fma_f32 v143, v143, v146, v144
  v_pk_mul_f32 v[198:199], v[198:199], v[116:117] op_sel:[0,1]
  s_waitcnt vmcnt(16)
  buffer_load_dwordx4 v[76:79], v94, s[12:15], s60 offen offset:2816 nt
  v_pk_fma_f32 v[200:201], v[16:17], s[92:93], v[116:117] op_sel_hi:[1,1,0] neg_lo:[0,0,1] neg_hi:[0,0,1]
  v_pk_fma_f32 v[202:203], v[18:19], s[92:93], v[116:117] op_sel_hi:[1,1,0] neg_lo:[0,0,1] neg_hi:[0,0,1]
  v_cvt_pk_bf16_f32 v200, 0, v200
  v_cvt_pk_bf16_f32 v159, v148, v149
  v_cvt_pk_bf16_f32 v201, 0, v201
  v_cvt_pk_bf16_f32 v160, v150, v151
  v_cvt_pk_bf16_f32 v202, 0, v202
  v_cvt_pk_bf16_f32 v161, v152, v153
  v_cvt_pk_bf16_f32 v203, 0, v203
  v_cvt_pk_bf16_f32 v162, v154, v155
  v_pk_mul_f32 v[200:201], v[200:201], v[116:117] op_sel:[0,1]
  v_cvt_pk_bf16_f32 v163, v156, v157
  v_pk_mul_f32 v[202:203], v[202:203], v[116:117] op_sel:[0,1]
  s_waitcnt vmcnt(16)
  s_cbranch_vccnz L_vw1_15
  s_waitcnt vmcnt(9)
L_vw1_15:
  buffer_load_dwordx4 v[80:83], v95, s[12:15], s60 offen offset:0 nt
  v_mov_b32_dpp v116, v114 row_newbcast:5 row_mask:0xf bank_mask:0xf
  v_mov_b32_dpp v117, v115 row_newbcast:5 row_mask:0xf bank_mask:0xf
  v_pk_fma_f32 v[108:109], v[20:21], s[92:93], v[116:117] op_sel_hi:[1,1,0] neg_lo:[0,0,1] neg_hi:[0,0,1]
  v_pk_fma_f32 v[110:111], v[22:23], s[92:93], v[116:117] op_sel_hi:[1,1,0] neg_lo:[0,0,1] neg_hi:[0,0,1]
  v_cvt_pk_bf16_f32 v108, 0, v108
  v_cvt_pk_bf16_f32 v164, v158, 0
  v_cvt_pk_bf16_f32 v109, 0, v109
  v_cndmask_b32 v168, 0, v159, s[72:73]
  v_cvt_pk_bf16_f32 v110, 0, v110
  v_cndmask_b32 v169, 0, v160, s[72:73]
  v_cvt_pk_bf16_f32 v111, 0, v111
  v_cndmask_b32 v170, 0, v161, s[72:73]
  v_pk_mul_f32 v[108:109], v[108:109], v[116:117] op_sel:[0,1]
  v_cndmask_b32 v171, 0, v162, s[72:73]
  v_pk_mul_f32 v[110:111], v[110:111], v[116:117] op_sel:[0,1]
  v_cvt_pk_bf16_f32 v206, v192, v108
  v_cvt_pk_bf16_f32 v210, v193, v109
  v_cvt_pk_bf16_f32 v214, v194, v110
  v_cvt_pk_bf16_f32 v218, v195, v111
  s_waitcnt vmcnt(16)
  buffer_load_dwordx4 v[84:87], v95, s[12:15], s60 offen offset:256 nt
  v_pk_fma_f32 v[108:109], v[24:25], s[92:93], v[116:117] op_sel_hi:[1,1,0] neg_lo:[0,0,1] neg_hi:[0,0,1]
  v_pk_fma_f32 v[110:111], v[26:27], s[92:93], v[116:117] op_sel_hi:[1,1,0] neg_lo:[0,0,1] neg_hi:[0,0,1]
  v_cvt_pk_bf16_f32 v108, 0, v108
  v_cndmask_b32 v172, 0, v159, s[74:75]
  v_cvt_pk_bf16_f32 v109, 0, v109
  v_cndmask_b32 v173, 0, v160, s[74:75]
  v_cvt_pk_bf16_f32 v110, 0, v110
  v_cndmask_b32 v174, 0, v161, s[74:75]
  v_cvt_pk_bf16_f32 v111, 0, v111
  v_cndmask_b32 v175, 0, v162, s[74:75]
  v_pk_mul_f32 v[108:109], v[108:109], v[116:117] op_sel:[0,1]
  v_cndmask_b32 v176, 0, v159, s[76:77]
  v_pk_mul_f32 v[110:111], v[110:111], v[116:117] op_sel:[0,1]
  v_cvt_pk_bf16_f32 v222, v196, v108
  v_cvt_pk_bf16_f32 v226, v197, v109
  v_cvt_pk_bf16_f32 v230, v198, v110
  v_cvt_pk_bf16_f32 v234, v199, v111
  s_waitcnt vmcnt(16)
  buffer_load_dwordx4 v[88:91], v95, s[12:15], s60 offen offset:512 nt
  v_pk_fma_f32 v[108:109], v[28:29], s[92:93], v[116:117] op_sel_hi:[1,1,0] neg_lo:[0,0,1] neg_hi:[0,0,1]
  v_pk_fma_f32 v[110:111], v[30:31], s[92:93], v[116:117] op_sel_hi:[1,1,0] neg_lo:[0,0,1] neg_hi:[0,0,1]
  v_cvt_pk_bf16_f32 v108, 0, v108
  v_cndmask_b32 v177, 0, v160, s[76:77]
  v_cvt_pk_bf16_f32 v109, 0, v109
  v_cndmask_b32 v178, 0, v161, s[76:77]
  v_cvt_pk_bf16_f32 v110, 0, v110
  v_cndmask_b32 v179, 0, v162, s[76:77]
  v_cvt_pk_bf16_f32 v111, 0, v111
  v_cndmask_b32 v180, 0, v159, s[78:79]
  v_pk_mul_f32 v[108:109], v[108:109], v[116:117] op_sel:[0,1]
  v_cndmask_b32 v181, 0, v160, s[78:79]
  v_pk_mul_f32 v[110:111], v[110:111], v[116:117] op_sel:[0,1]
  v_cvt_pk_bf16_f32 v238, v200, v108
  v_cvt_pk_bf16_f32 v242, v201, v109
  v_cvt_pk_bf16_f32 v246, v202, v110
  v_cvt_pk_bf16_f32 v250, v203, v111
  v_mad_u32_u24 v92, v97, s63, v3
  v_add_u32 v93, 768, v92
  v_add_u32 v94, 4608, v92
  v_add_u32 v95, 7680, v92
  v_cndmask_b32 v92, v92, v105, s[52:53]
  v_cndmask_b32 v95, v95, v105, s[54:55]
  s_waitcnt vmcnt(16)
  s_cbranch_vccnz L_vw1_18
  s_waitcnt vmcnt(9)
L_vw1_18:
  buffer_load_dwordx4 v[4:7], v92, s[12:15], s61 offen offset:0 nt
  v_mov_b32_dpp v116, v114 row_newbcast:6 row_mask:0xf bank_mask:0xf
  v_mov_b32_dpp v117, v115 row_newbcast:6 row_mask:0xf bank_mask:0xf
  v_pk_fma_f32 v[192:193], v[32:33], s[92:93], v[116:117] op_sel_hi:[1,1,0] neg_lo:[0,0,1] neg_hi:[0,0,1]
  v_pk_fma_f32 v[194:195], v[34:35], s[92:93], v[116:117] op_sel_hi:[1,1,0] neg_lo:[0,0,1] neg_hi:[0,0,1]
  v_cvt_pk_bf16_f32 v192, 0, v192
  v_cndmask_b32 v182, 0, v161, s[78:79]
  v_cvt_pk_bf16_f32 v193, 0, v193
  v_cndmask_b32 v183, 0, v162, s[78:79]
  v_cvt_pk_bf16_f32 v194, 0, v194
  s_waitcnt lgkmcnt(0)
  v_cvt_pk_bf16_f32 v195, 0, v195
  v_mul_f32 v128, v147, v128
  v_pk_mul_f32 v[192:193], v[192:193], v[116:117] op_sel:[0,1]
  v_mul_f32 v129, v147, v129
  v_pk_mul_f32 v[194:195], v[194:195], v[116:117] op_sel:[0,1]
  s_waitcnt vmcnt(14)
  buffer_load_dwordx4 v[8:11], v92, s[12:15], s61 offen offset:256 nt
  v_pk_fma_f32 v[196:197], v[36:37], s[92:93], v[116:117] op_sel_hi:[1,1,0] neg_lo:[0,0,1] neg_hi:[0,0,1]
  v_pk_fma_f32 v[198:199], v[38:39], s[92:93], v[116:117] op_sel_hi:[1,1,0] neg_lo:[0,0,1] neg_hi:[0,0,1]
  v_cvt_pk_bf16_f32 v196, 0, v196
  v_mul_f32 v130, v147, v130
  v_cvt_pk_bf16_f32 v197, 0, v197
  v_mul_f32 v131, v147, v131
  v_cvt_pk_bf16_f32 v198, 0, v198
  v_mul_f32 v132, v147, v132
  v_cvt_pk_bf16_f32 v199, 0, v199
  v_mul_f32 v133, v147, v133
  v_pk_mul_f32 v[196:197], v[196:197], v[116:117] op_sel:[0,1]
  v_mul_f32 v134, v147, v134
  v_pk_mul_f32 v[198:199], v[198:199], v[116:117] op_sel:[0,1]
  s_waitcnt vmcnt(14)
  buffer_load_dwordx4 v[12:15], v92, s[12:15], s61 offen offset:512 nt
  v_pk_fma_f32 v[200:201], v[40:41], s[92:93], v[116:117] op_sel_hi:[1,1,0] neg_lo:[0,0,1] neg_hi:[0,0,1]
  v_pk_fma_f32 v[202:203], v[42:43], s[92:93], v[116:117] op_sel_hi:[1,1,0] neg_lo:[0,0,1] neg_hi:[0,0,1]
  v_cvt_pk_bf16_f32 v200, 0, v200
  v_mul_f32 v135, v147, v135
  v_cvt_pk_bf16_f32 v201, 0, v201
  v_mul_f32 v136, v147, v136
  v_cvt_pk_bf16_f32 v202, 0, v202
  v_mul_f32 v137, v147, v137
  v_cvt_pk_bf16_f32 v203, 0, v203
  v_mul_f32 v138, v147, v138
  v_pk_mul_f32 v[200:201], v[200:201], v[116:117] op_sel:[0,1]
  v_mul_f32 v139, v147, v139
  v_pk_mul_f32 v[202:203], v[202:203], v[116:117] op_sel:[0,1]
  s_waitcnt vmcnt(14)
  s_cbranch_vccnz L_vw1_21
  s_waitcnt vmcnt(9)
L_vw1_21:
  buffer_load_dwordx4 v[16:19], v93, s[12:15], s61 offen offset:0 nt
  v_mov_b32_dpp v116, v114 row_newbcast:7 row_mask:0xf bank_mask:0xf
  v_mov_b32_dpp v117, v115 row_newbcast:7 row_mask:0xf bank_mask:0xf
  v_pk_fma_f32 v[108:109], v[44:45], s[92:93], v[116:117] op_sel_hi:[1,1,0] neg_lo:[0,0,1] neg_hi:[0,0,1]
  v_pk_fma_f32 v[110:111], v[46:47], s[92:93], v[116:117] op_sel_hi:[1,1,0] neg_lo:[0,0,1] neg_hi:[0,0,1]
  v_cvt_pk_bf16_f32 v108, 0, v108
  v_cvt_pk_bf16_f32 v109, 0, v109
  v_cvt_pk_bf16_f32 v110, 0, v110
  v_cvt_pk_bf16_f32 v111, 0, v111
  v_pk_mul_f32 v[108:109], v[108:109], v[116:117] op_sel:[0,1]
  v_pk_mul_f32 v[110:111], v[110:111], v[116:117] op_sel:[0,1]
  v_cvt_pk_bf16_f32 v207, v192, v108
  v_cvt_pk_bf16_f32 v211, v193, v109
  v_cvt_pk_bf16_f32 v215, v194, v110
  v_cvt_pk_bf16_f32 v219, v195, v111
  v_mfma_f32_16x16x32_bf16 v[128:131], v[168:171], v[204:207], v[128:131]
  v_mfma_f32_16x16x32_bf16 v[128:131], v[172:175], v[208:211], v[128:131]
  v_mfma_f32_16x16x32_bf16 v[128:131], v[176:179], v[212:215], v[128:131]
  v_mfma_f32_16x16x32_bf16 v[128:131], v[180:183], v[216:219], v[128:131]
  s_waitcnt vmcnt(14)
  buffer_load_dwordx4 v[20:23], v93, s[12:15], s61 offen offset:256 nt
  v_pk_fma_f32 v[108:109], v[48:49], s[92:93], v[116:117] op_sel_hi:[1,1,0] neg_lo:[0,0,1] neg_hi:[0,0,1]
  v_pk_fma_f32 v[110:111], v[50:51], s[92:93], v[116:117] op_sel_hi:[1,1,0] neg_lo:[0,0,1] neg_hi:[0,0,1]
  v_cvt_pk_bf16_f32 v108, 0, v108
  v_cvt_pk_bf16_f32 v109, 0, v109
  v_cvt_pk_bf16_f32 v110, 0, v110
  v_cvt_pk_bf16_f32 v111, 0, v111
  v_pk_mul_f32 v[108:109], v[108:109], v[116:117] op_sel:[0,1]
  v_pk_mul_f32 v[110:111], v[110:111], v[116:117] op_sel:[0,1]
  v_cvt_pk_bf16_f32 v223, v196, v108
  v_cvt_pk_bf16_f32 v227, v197, v109
  v_cvt_pk_bf16_f32 v231, v198, v110
  v_cvt_pk_bf16_f32 v235, v199, v111
  v_mfma_f32_16x16x32_bf16 v[132:135], v[168:171], v[220:223], v[132:135]
  v_mfma_f32_16x16x32_bf16 v[132:135], v[172:175], v[224:227], v[132:135]
  v_mfma_f32_16x16x32_bf16 v[132:135], v[176:179], v[228:231], v[132:135]
  v_mfma_f32_16x16x32_bf16 v[132:135], v[180:183], v[232:235], v[132:135]
  s_waitcnt vmcnt(14)
  buffer_load_dwordx4 v[24:27], v93, s[12:15], s61 offen offset:512 nt
  v_pk_fma_f32 v[108:109], v[52:53], s[92:93], v[116:117] op_sel_hi:[1,1,0] neg_lo:[0,0,1] neg_hi:[0,0,1]
  v_pk_fma_f32 v[110:111], v[54:55], s[92:93], v[116:117] op_sel_hi:[1,1,0] neg_lo:[0,0,1] neg_hi:[0,0,1]
  v_cvt_pk_bf16_f32 v108, 0, v108
  v_cvt_pk_bf16_f32 v109, 0, v109
  v_cvt_pk_bf16_f32 v110, 0, v110
  v_cvt_pk_bf16_f32 v111, 0, v111
  v_pk_mul_f32 v[108:109], v[108:109], v[116:117] op_sel:[0,1]
  v_pk_mul_f32 v[110:111], v[110:111], v[116:117] op_sel:[0,1]
  v_cvt_pk_bf16_f32 v239, v200, v108
  v_cvt_pk_bf16_f32 v243, v201, v109
  v_cvt_pk_bf16_f32 v247, v202, v110
  v_cvt_pk_bf16_f32 v251, v203, v111
  v_mfma_f32_16x16x32_bf16 v[136:139], v[168:171], v[236:239], v[136:139]
  v_mfma_f32_16x16x32_bf16 v[136:139], v[172:175], v[240:243], v[136:139]
  v_mfma_f32_16x16x32_bf16 v[136:139], v[176:179], v[244:247], v[136:139]
  v_mfma_f32_16x16x32_bf16 v[136:139], v[180:183], v[248:251], v[136:139]
  s_waitcnt vmcnt(14)
  s_cbranch_vccnz L_vw1_24
  s_waitcnt vmcnt(9)
L_vw1_24:
  buffer_load_dwordx4 v[28:31], v93, s[12:15], s61 offen offset:768 nt
  v_mov_b32_dpp v116, v114 row_newbcast:8 row_mask:0xf bank_mask:0xf
  v_mov_b32_dpp v117, v115 row_newbcast:8 row_mask:0xf bank_mask:0xf
  v_pk_fma_f32 v[192:193], v[56:57], s[92:93], v[116:117] op_sel_hi:[1,1,0] neg_lo:[0,0,1] neg_hi:[0,0,1]
  v_pk_fma_f32 v[194:195], v[58:59], s[92:93], v[116:117] op_sel_hi:[1,1,0] neg_lo:[0,0,1] neg_hi:[0,0,1]
  v_cvt_pk_bf16_f32 v192, 0, v192
  v_cndmask_b32 v184, 0, v163, s[72:73]
  v_cvt_pk_bf16_f32 v193, 0, v193
  v_cndmask_b32 v185, 0, v164, s[72:73]
  v_cvt_pk_bf16_f32 v194, 0, v194
  v_cndmask_b32 v186, 0, v163, s[74:75]
  v_cvt_pk_bf16_f32 v195, 0, v195
  v_cndmask_b32 v187, 0, v164, s[74:75]
  v_pk_mul_f32 v[192:193], v[192:193], v[116:117] op_sel:[0,1]
  v_cndmask_b32 v188, 0, v163, s[76:77]
  v_pk_mul_f32 v[194:195], v[194:195], v[116:117] op_sel:[0,1]
  s_waitcnt vmcnt(14)
  buffer_load_dwordx4 v[32:35], v93, s[12:15], s61 offen offset:1024 nt
  v_pk_fma_f32 v[196:197], v[60:61], s[92:93], v[116:117] op_sel_hi:[1,1,0] neg_lo:[0,0,1] neg_hi:[0,0,1]
  v_pk_fma_f32 v[198:199], v[62:63], s[92:93], v[116:117] op_sel_hi:[1,1,0] neg_lo:[0,0,1] neg_hi:[0,0,1]
  v_cvt_pk_bf16_f32 v196, 0, v196
  v_cndmask_b32 v189, 0, v164, s[76:77]
  v_cvt_pk_bf16_f32 v197, 0, v197
  v_cndmask_b32 v190, 0, v163, s[78:79]
  v_cvt_pk_bf16_f32 v198, 0, v198
  v_cndmask_b32 v191, 0, v164, s[78:79]
  v_cvt_pk_bf16_f32 v199, 0, v199
  v_pk_mul_f32 v[196:197], v[196:197], v[116:117] op_sel:[0,1]
  v_pk_mul_f32 v[198:199], v[198:199], v[116:117] op_sel:[0,1]
  s_waitcnt vmcnt(14)
  buffer_load_dwordx4 v[36:39], v93, s[12:15], s61 offen offset:1280 nt
  v_pk_fma_f32 v[200:201], v[64:65], s[92:93], v[116:117] op_sel_hi:[1,1,0] neg_lo:[0,0,1] neg_hi:[0,0,1]
  v_pk_fma_f32 v[202:203], v[66:67], s[92:93], v[116:117] op_sel_hi:[1,1,0] neg_lo:[0,0,1] neg_hi:[0,0,1]
  v_cvt_pk_bf16_f32 v200, 0, v200
  v_cvt_pk_bf16_f32 v201, 0, v201
  v_cvt_pk_bf16_f32 v202, 0, v202
  v_cvt_pk_bf16_f32 v203, 0, v203
  v_pk_mul_f32 v[200:201], v[200:201], v[116:117] op_sel:[0,1]
  v_pk_mul_f32 v[202:203], v[202:203], v[116:117] op_sel:[0,1]
  s_waitcnt vmcnt(14)
  s_cbranch_vccnz L_vw1_27
  s_waitcnt vmcnt(9)
L_vw1_27:
  buffer_load_dwordx4 v[40:43], v93, s[12:15], s61 offen offset:1536 nt
  v_mov_b32_dpp v116, v114 row_newbcast:9 row_mask:0xf bank_mask:0xf
  v_mov_b32_dpp v117, v115 row_newbcast:9 row_mask:0xf bank_mask:0xf
  v_pk_fma_f32 v[108:109], v[68:69], s[92:93], v[116:117] op_sel_hi:[1,1,0] neg_lo:[0,0,1] neg_hi:[0,0,1]
  v_pk_fma_f32 v[110:111], v[70:71], s[92:93], v[116:117] op_sel_hi:[1,1,0] neg_lo:[0,0,1] neg_hi:[0,0,1]
  v_cvt_pk_bf16_f32 v108, 0, v108
  v_cvt_pk_bf16_f32 v109, 0, v109
  v_cvt_pk_bf16_f32 v110, 0, v110
  v_cvt_pk_bf16_f32 v111, 0, v111
  v_pk_mul_f32 v[108:109], v[108:109], v[116:117] op_sel:[0,1]
  v_pk_mul_f32 v[110:111], v[110:111], v[116:117] op_sel:[0,1]
  v_cvt_pk_bf16_f32 v204, v192, v108
  v_cvt_pk_bf16_f32 v208, v193, v109
  v_cvt_pk_bf16_f32 v212, v194, v110
  v_cvt_pk_bf16_f32 v216, v195, v111
  s_waitcnt vmcnt(14)
  buffer_load_dwordx4 v[44:47], v93, s[12:15], s61 offen offset:1792 nt
  v_pk_fma_f32 v[108:109], v[72:73], s[92:93], v[116:117] op_sel_hi:[1,1,0] neg_lo:[0,0,1] neg_hi:[0,0,1]
  v_pk_fma_f32 v[110:111], v[74:75], s[92:93], v[116:117] op_sel_hi:[1,1,0] neg_lo:[0,0,1] neg_hi:[0,0,1]
  v_cvt_pk_bf16_f32 v108, 0, v108
  v_cvt_pk_bf16_f32 v109, 0, v109
  v_cvt_pk_bf16_f32 v110, 0, v110
  v_cvt_pk_bf16_f32 v111, 0, v111
  v_pk_mul_f32 v[108:109], v[108:109], v[116:117] op_sel:[0,1]
  v_pk_mul_f32 v[110:111], v[110:111], v[116:117] op_sel:[0,1]
  v_cvt_pk_bf16_f32 v220, v196, v108
  v_cvt_pk_bf16_f32 v224, v197, v109
  v_cvt_pk_bf16_f32 v228, v198, v110
  v_cvt_pk_bf16_f32 v232, v199, v111
  s_waitcnt vmcnt(14)
  buffer_load_dwordx4 v[48:51], v93, s[12:15], s61 offen offset:2048 nt
  v_pk_fma_f32 v[108:109], v[76:77], s[92:93], v[116:117] op_sel_hi:[1,1,0] neg_lo:[0,0,1] neg_hi:[0,0,1]
  v_pk_fma_f32 v[110:111], v[78:79], s[92:93], v[116:117] op_sel_hi:[1,1,0] neg_lo:[0,0,1] neg_hi:[0,0,1]
  v_cvt_pk_bf16_f32 v108, 0, v108
  v_cvt_pk_bf16_f32 v109, 0, v109
  v_cvt_pk_bf16_f32 v110, 0, v110
  v_cvt_pk_bf16_f32 v111, 0, v111
  v_pk_mul_f32 v[108:109], v[108:109], v[116:117] op_sel:[0,1]
  v_pk_mul_f32 v[110:111], v[110:111], v[116:117] op_sel:[0,1]
  v_cvt_pk_bf16_f32 v236, v200, v108
  v_cvt_pk_bf16_f32 v240, v201, v109
  v_cvt_pk_bf16_f32 v244, v202, v110
  v_cvt_pk_bf16_f32 v248, v203, v111
  s_waitcnt vmcnt(14)
  s_cbranch_vccnz L_vw1_30
  s_waitcnt vmcnt(9)
L_vw1_30:
  buffer_load_dwordx4 v[52:55], v93, s[12:15], s61 offen offset:2304 nt
  v_mov_b32_dpp v116, v114 row_newbcast:10 row_mask:0xf bank_mask:0xf
  v_mov_b32_dpp v117, v115 row_newbcast:10 row_mask:0xf bank_mask:0xf
  v_pk_fma_f32 v[192:193], v[80:81], s[92:93], v[116:117] op_sel_hi:[1,1,0] neg_lo:[0,0,1] neg_hi:[0,0,1]
  v_pk_fma_f32 v[194:195], v[82:83], s[92:93], v[116:117] op_sel_hi:[1,1,0] neg_lo:[0,0,1] neg_hi:[0,0,1]
  v_cvt_pk_bf16_f32 v192, 0, v192
  v_cvt_pk_bf16_f32 v193, 0, v193
  v_cvt_pk_bf16_f32 v194, 0, v194
  v_cvt_pk_bf16_f32 v195, 0, v195
  v_pk_mul_f32 v[192:193], v[192:193], v[116:117] op_sel:[0,1]
  v_pk_mul_f32 v[194:195], v[194:195], v[116:117] op_sel:[0,1]
  v_cvt_pk_bf16_f32 v205, v192, 0
  v_cvt_pk_bf16_f32 v209, v193, 0
  v_cvt_pk_bf16_f32 v213, v194, 0
  v_cvt_pk_bf16_f32 v217, v195, 0
  v_mfma_f32_16x16x16_bf16 v[128:131], v[184:185], v[204:205], v[128:131]
  v_mfma_f32_16x16x16_bf16 v[128:131], v[186:187], v[208:209], v[128:131]
  v_mfma_f32_16x16x16_bf16 v[128:131], v[188:189], v[212:213], v[128:131]
  v_mfma_f32_16x16x16_bf16 v[128:131], v[190:191], v[216:217], v[128:131]
  s_waitcnt vmcnt(14)
  buffer_load_dwordx4 v[56:59], v93, s[12:15], s61 offen offset:2560 nt
  v_pk_fma_f32 v[196:197], v[84:85], s[92:93], v[116:117] op_sel_hi:[1,1,0] neg_lo:[0,0,1] neg_hi:[0,0,1]
  v_pk_fma_f32 v[198:199], v[86:87], s[92:93], v[116:117] op_sel_hi:[1,1,0] neg_lo:[0,0,1] neg_hi:[0,0,1]
  v_cvt_pk_bf16_f32 v196, 0, v196
  v_cvt_pk_bf16_f32 v197, 0, v197
  v_cvt_pk_bf16_f32 v198, 0, v198
  v_cvt_pk_bf16_f32 v199, 0, v199
  v_pk_mul_f32 v[196:197], v[196:197], v[116:117] op_sel:[0,1]
  v_pk_mul_f32 v[198:199], v[198:199], v[116:117] op_sel:[0,1]
  v_cvt_pk_bf16_f32 v221, v196, 0
  v_cvt_pk_bf16_f32 v225, v197, 0
  v_cvt_pk_bf16_f32 v229, v198, 0
  v_cvt_pk_bf16_f32 v233, v199, 0
  v_mfma_f32_16x16x16_bf16 v[132:135], v[184:185], v[220:221], v[132:135]
  v_mfma_f32_16x16x16_bf16 v[132:135], v[186:187], v[224:225], v[132:135]
  v_mfma_f32_16x16x16_bf16 v[132:135], v[188:189], v[228:229], v[132:135]
  v_mfma_f32_16x16x16_bf16 v[132:135], v[190:191], v[232:233], v[132:135]
  s_waitcnt vmcnt(14)
  buffer_load_dwordx4 v[60:63], v93, s[12:15], s61 offen offset:2816 nt
  v_pk_fma_f32 v[200:201], v[88:89], s[92:93], v[116:117] op_sel_hi:[1,1,0] neg_lo:[0,0,1] neg_hi:[0,0,1]
  v_pk_fma_f32 v[202:203], v[90:91], s[92:93], v[116:117] op_sel_hi:[1,1,0] neg_lo:[0,0,1] neg_hi:[0,0,1]
  v_cvt_pk_bf16_f32 v200, 0, v200
  v_cvt_pk_bf16_f32 v201, 0, v201
  v_cvt_pk_bf16_f32 v202, 0, v202
  v_cvt_pk_bf16_f32 v203, 0, v203
  v_pk_mul_f32 v[200:201], v[200:201], v[116:117] op_sel:[0,1]
  v_pk_mul_f32 v[202:203], v[202:203], v[116:117] op_sel:[0,1]
  v_cvt_pk_bf16_f32 v237, v200, 0
  v_cvt_pk_bf16_f32 v241, v201, 0
  v_cvt_pk_bf16_f32 v245, v202, 0
  v_cvt_pk_bf16_f32 v249, v203, 0
  v_mfma_f32_16x16x16_bf16 v[136:139], v[184:185], v[236:237], v[136:139]
  v_mfma_f32_16x16x16_bf16 v[136:139], v[186:187], v[240:241], v[136:139]
  v_mfma_f32_16x16x16_bf16 v[136:139], v[188:189], v[244:245], v[136:139]
  v_mfma_f32_16x16x16_bf16 v[136:139], v[190:191], v[248:249], v[136:139]
  s_mov_b32 s60, s61
  s_cmp_ge_u32 s64, 96
  s_cbranch_scc1 L_v_done
  s_cmp_eq_u32 s89, s88
  s_cbranch_scc1 L_v0
  s_mov_b32 s88, s89
  v_mov_b32 v145, v143
  s_nop 1
  v_permlane32_swap_b32 v143, v145
  v_add_f32 v143, v143, v145
  v_mov_b32 v145, v143
  s_nop 1
  v_permlane16_swap_b32 v143, v145
  v_add_f32 v143, v143, v145
  ds_write_b64 v103, v[142:143]
  ds_write_b128 v102, v[128:131] offset:0
  ds_write_b128 v102, v[132:135] offset:1024
  ds_write_b128 v102, v[136:139] offset:2048
  s_and_b32 s70, s86, 15
  s_cmp_ge_u32 s70, 12
  s_cselect_b32 s70, 2, 0
  s_and_b32 s71, s87, 1
  s_add_u32 s70, s70, s71
  s_lshr_b32 s71, s86, 4
  s_lshl2_add_u32 s70, s71, s70
  s_add_u32 s71, s3, 0
  s_cmp_eq_u32 s100, s71
  s_cselect_b32 s44, s70, s44
  s_add_u32 s71, s3, 2
  s_cmp_eq_u32 s100, s71
  s_cselect_b32 s45, s70, s45
  s_add_u32 s100, s100, 1
  s_waitcnt lgkmcnt(0)
  v_add_u32 v102, 6208, v102
  v_add_u32 v103, 6208, v103
  v_mov_b32 v128, 0
  v_mov_b32 v129, 0
  v_mov_b32 v130, 0
  v_mov_b32 v131, 0
  v_mov_b32 v132, 0
  v_mov_b32 v133, 0
  v_mov_b32 v134, 0
  v_mov_b32 v135, 0
  v_mov_b32 v136, 0
  v_mov_b32 v137, 0
  v_mov_b32 v138, 0
  v_mov_b32 v139, 0
  v_mov_b32 v140, 0xff800000
  v_mov_b32 v142, 0x7f800000
  v_mov_b32 v143, 0
  s_branch L_v0
L_v_done:
  v_mov_b32 v144, 61704
  ds_read_b32 v140, v144
  v_lshlrev_b32 v147, 4, v0
  s_mul_i32 s70, s3, 6208
  v_add_u32 v148, s70, v147
  s_add_u32 s70, s70, 43008
  v_lshrrev_b32 v146, 1, v101
  v_add_u32 v149, s70, v146
  v_add_u32 v150, 12416, v149
  v_mov_b32 v145, v143
  s_nop 1
  v_permlane32_swap_b32 v143, v145
  v_add_f32 v143, v143, v145
  v_mov_b32 v145, v143
  s_nop 1
  v_permlane16_swap_b32 v143, v145
  v_add_f32 v143, v143, v145
  ds_write_b64 v103, v[142:143]
  ds_write_b128 v102, v[128:131] offset:0
  ds_write_b128 v102, v[132:135] offset:1024
  ds_write_b128 v102, v[136:139] offset:2048
  s_and_b32 s70, s86, 15
  s_cmp_ge_u32 s70, 12
  s_cselect_b32 s70, 2, 0
  s_and_b32 s71, s87, 1
  s_add_u32 s70, s70, s71
  s_lshr_b32 s71, s86, 4
  s_lshl2_add_u32 s70, s71, s70
  s_add_u32 s71, s3, 0
  s_cmp_eq_u32 s100, s71
  s_cselect_b32 s44, s70, s44
  s_add_u32 s71, s3, 2
  s_cmp_eq_u32 s100, s71
  s_cselect_b32 s45, s70, s45
  s_add_u32 s100, s100, 1
  s_waitcnt lgkmcnt(0)
  s_waitcnt vmcnt(0)
  s_barrier
  ds_read2_b64 v[4:7], v149 offset1:4
  ds_read_b128 v[168:171], v148 offset:36864
  ds_read_b128 v[172:175], v148 offset:37888
  ds_read_b128 v[176:179], v148 offset:38912
  ds_read_b128 v[180:183], v148 offset:39936
  ds_read_b128 v[184:187], v148 offset:40960
  ds_read_b128 v[188:191], v148 offset:41984
  ds_read2_b64 v[8:11], v150 offset1:4
  ds_read_b128 v[192:195], v148 offset:49280
  ds_read_b128 v[196:199], v148 offset:50304
  ds_read_b128 v[200:203], v148 offset:51328
  ds_read_b128 v[204:207], v148 offset:52352
  ds_read_b128 v[208:211], v148 offset:53376
  ds_read_b128 v[212:215], v148 offset:54400
  s_mov_b32 s100, -1
  s_add_u32 s97, s4, 1
  s_waitcnt lgkmcnt(7)
  v_min_f32 v28, v4, v6
  v_sub_f32 v4, v28, v4
  v_sub_f32 v6, v28, v6
  v_exp_f32 v4, v4
  v_exp_f32 v6, v6
  v_mul_f32 v12, v4, v168
  v_fma_f32 v12, v6, v180, v12
  v_mul_f32 v13, v4, v169
  v_fma_f32 v13, v6, v181, v13
  v_mul_f32 v14, v4, v170
  v_fma_f32 v14, v6, v182, v14
  v_mul_f32 v16, v4, v171
  v_fma_f32 v16, v6, v183, v16
  v_mul_f32 v17, v4, v172
  v_fma_f32 v17, v6, v184, v17
  v_mul_f32 v18, v4, v173
  v_fma_f32 v18, v6, v185, v18
  v_mul_f32 v20, v4, v174
  v_fma_f32 v20, v6, v186, v20
  v_mul_f32 v21, v4, v175
  v_fma_f32 v21, v6, v187, v21
  v_mul_f32 v22, v4, v176
  v_fma_f32 v22, v6, v188, v22
  v_mul_f32 v24, v4, v177
  v_fma_f32 v24, v6, v189, v24
  v_mul_f32 v25, v4, v178
  v_fma_f32 v25, v6, v190, v25
  v_mul_f32 v26, v4, v179
  v_fma_f32 v26, v6, v191, v26
  v_mul_f32 v29, v4, v5
  v_fma_f32 v29, v6, v7, v29
  s_bfe_u32 s70, s44, 0x20001
  s_cmp_eq_u32 s70, s97
  s_cbranch_scc1 L_own0
  v_mov_b32 v15, v140
  v_mov_b32 v19, v140
  v_mov_b32 v23, v140
  v_mov_b32 v27, v140
  v_mov_b32 v31, v140
  s_mul_i32 s70, s44, 5120
  s_add_u32 s70, s70, 1048576
  s_add_u32 s71, s70, 4096
  buffer_store_dwordx4 v[12:15], v147, s[40:43], s70 offen offset:0 sc1
  buffer_store_dwordx4 v[16:19], v147, s[40:43], s70 offen offset:1024 sc1
  buffer_store_dwordx4 v[20:23], v147, s[40:43], s70 offen offset:2048 sc1
  buffer_store_dwordx4 v[24:27], v147, s[40:43], s70 offen offset:3072 sc1
  buffer_store_dwordx4 v[28:31], v147, s[40:43], s71 offen offset:0 sc1
  s_branch L_pub0
L_own0:
  v_mov_b32 v52, v12
  v_mov_b32 v53, v13
  v_mov_b32 v54, v14
  v_mov_b32 v56, v16
  v_mov_b32 v57, v17
  v_mov_b32 v58, v18
  v_mov_b32 v60, v20
  v_mov_b32 v61, v21
  v_mov_b32 v62, v22
  v_mov_b32 v64, v24
  v_mov_b32 v65, v25
  v_mov_b32 v66, v26
  v_mov_b32 v68, v28
  v_mov_b32 v69, v29
  s_mov_b32 s100, s44
L_pub0:
  s_waitcnt lgkmcnt(0)
  v_min_f32 v48, v8, v10
  v_sub_f32 v8, v48, v8
  v_sub_f32 v10, v48, v10
  v_exp_f32 v8, v8
  v_exp_f32 v10, v10
  v_mul_f32 v32, v8, v192
  v_fma_f32 v32, v10, v204, v32
  v_mul_f32 v33, v8, v193
  v_fma_f32 v33, v10, v205, v33
  v_mul_f32 v34, v8, v194
  v_fma_f32 v34, v10, v206, v34
  v_mul_f32 v36, v8, v195
  v_fma_f32 v36, v10, v207, v36
  v_mul_f32 v37, v8, v196
  v_fma_f32 v37, v10, v208, v37
  v_mul_f32 v38, v8, v197
  v_fma_f32 v38, v10, v209, v38
  v_mul_f32 v40, v8, v198
  v_fma_f32 v40, v10, v210, v40
  v_mul_f32 v41, v8, v199
  v_fma_f32 v41, v10, v211, v41
  v_mul_f32 v42, v8, v200
  v_fma_f32 v42, v10, v212, v42
  v_mul_f32 v44, v8, v201
  v_fma_f32 v44, v10, v213, v44
  v_mul_f32 v45, v8, v202
  v_fma_f32 v45, v10, v214, v45
  v_mul_f32 v46, v8, v203
  v_fma_f32 v46, v10, v215, v46
  v_mul_f32 v49, v8, v9
  v_fma_f32 v49, v10, v11, v49
  s_bfe_u32 s70, s45, 0x20001
  s_cmp_eq_u32 s70, s97
  s_cbranch_scc1 L_own1
  v_mov_b32 v35, v140
  v_mov_b32 v39, v140
  v_mov_b32 v43, v140
  v_mov_b32 v47, v140
  v_mov_b32 v51, v140
  s_mul_i32 s70, s45, 5120
  s_add_u32 s70, s70, 1048576
  s_add_u32 s71, s70, 4096
  buffer_store_dwordx4 v[32:35], v147, s[40:43], s70 offen offset:0 sc1
  buffer_store_dwordx4 v[36:39], v147, s[40:43], s70 offen offset:1024 sc1
  buffer_store_dwordx4 v[40:43], v147, s[40:43], s70 offen offset:2048 sc1
  buffer_store_dwordx4 v[44:47], v147, s[40:43], s70 offen offset:3072 sc1
  buffer_store_dwordx4 v[48:51], v147, s[40:43], s71 offen offset:0 sc1
  s_branch L_pub1
L_own1:
  v_mov_b32 v52, v32
  v_mov_b32 v53, v33
  v_mov_b32 v54, v34
  v_mov_b32 v56, v36
  v_mov_b32 v57, v37
  v_mov_b32 v58, v38
  v_mov_b32 v60, v40
  v_mov_b32 v61, v41
  v_mov_b32 v62, v42
  v_mov_b32 v64, v44
  v_mov_b32 v65, v45
  v_mov_b32 v66, v46
  v_mov_b32 v68, v48
  v_mov_b32 v69, v49
  s_mov_b32 s100, s45
L_pub1:
  s_cmp_eq_u32 s100, -1
  s_cbranch_scc1 L_fin
  s_xor_b32 s84, s100, 1
  s_andn2_b32 s86, s100, 1
  s_xor_b32 s86, s86, 2
  s_add_u32 s88, s86, 1
  s_mul_i32 s84, s84, 5120
  s_add_u32 s84, s84, 1048576
  s_add_u32 s85, s84, 4096
  s_mul_i32 s86, s86, 5120
  s_add_u32 s86, s86, 1048576
  s_add_u32 s87, s86, 4096
  s_mul_i32 s88, s88, 5120
  s_add_u32 s88, s88, 1048576
  s_add_u32 s89, s88, 4096
  s_mov_b32 s64, 0
  s_mov_b32 s90, 7
L_gather:
  s_bitcmp0_b32 s90, 0
  s_cbranch_scc1 L_have0
  buffer_load_dwordx4 v[168:171], v147, s[40:43], s84 offen offset:0 sc1
  buffer_load_dwordx4 v[172:175], v147, s[40:43], s84 offen offset:1024 sc1
  buffer_load_dwordx4 v[176:179], v147, s[40:43], s84 offen offset:2048 sc1
  buffer_load_dwordx4 v[180:183], v147, s[40:43], s84 offen offset:3072 sc1
  buffer_load_dwordx4 v[184:187], v147, s[40:43], s85 offen offset:0 sc1
L_have0:
  s_bitcmp0_b32 s90, 1
  s_cbranch_scc1 L_have1
  buffer_load_dwordx4 v[188:191], v147, s[40:43], s86 offen offset:0 sc1
  buffer_load_dwordx4 v[192:195], v147, s[40:43], s86 offen offset:1024 sc1
  buffer_load_dwordx4 v[196:199], v147, s[40:43], s86 offen offset:2048 sc1
  buffer_load_dwordx4 v[200:203], v147, s[40:43], s86 offen offset:3072 sc1
  buffer_load_dwordx4 v[204:207], v147, s[40:43], s87 offen offset:0 sc1
L_have1:
  s_bitcmp0_b32 s90, 2
  s_cbranch_scc1 L_have2
  buffer_load_dwordx4 v[208:211], v147, s[40:43], s88 offen offset:0 sc1
  buffer_load_dwordx4 v[212:215], v147, s[40:43], s88 offen offset:1024 sc1
  buffer_load_dwordx4 v[216:219], v147, s[40:43], s88 offen offset:2048 sc1
  buffer_load_dwordx4 v[220:223], v147, s[40:43], s88 offen offset:3072 sc1
  buffer_load_dwordx4 v[224:227], v147, s[40:43], s89 offen offset:0 sc1
L_have2:
  s_mov_b32 s90, 0
  s_waitcnt vmcnt(0)
  v_min3_u32 v144, v171, v175, v179
  v_max3_u32 v145, v171, v175, v179
  v_min3_u32 v144, v144, v183, v187
  v_max3_u32 v145, v145, v183, v187
  v_cmp_ne_u32 s[70:71], v140, v144
  v_cmp_ne_u32 vcc, v140, v145
  s_nop 1
  s_or_b64 s[70:71], s[70:71], vcc
  s_cselect_b32 s70, 1, 0
  s_or_b32 s90, s90, s70
  v_min3_u32 v144, v191, v195, v199
  v_max3_u32 v145, v191, v195, v199
  v_min3_u32 v144, v144, v203, v207
  v_max3_u32 v145, v145, v203, v207
  v_cmp_ne_u32 s[70:71], v140, v144
  v_cmp_ne_u32 vcc, v140, v145
  s_nop 1
  s_or_b64 s[70:71], s[70:71], vcc
  s_cselect_b32 s70, 2, 0
  s_or_b32 s90, s90, s70
  v_min3_u32 v144, v211, v215, v219
  v_max3_u32 v145, v211, v215, v219
  v_min3_u32 v144, v144, v223, v227
  v_max3_u32 v145, v145, v223, v227
  v_cmp_ne_u32 s[70:71], v140, v144
  v_cmp_ne_u32 vcc, v140, v145
  s_nop 1
  s_or_b64 s[70:71], s[70:71], vcc
  s_cselect_b32 s70, 4, 0
  s_or_b32 s90, s90, s70
  s_cbranch_scc0 L_gathered
  s_add_u32 s64, s64, 1
  s_cmp_lt_u32 s64, 20000
  s_cbranch_scc1 L_gather
  s_endpgm
L_gathered:
  v_min_f32 v144, v68, v184
  v_min3_f32 v144, v144, v204, v224
  v_sub_f32 v68, v144, v68
  v_sub_f32 v184, v144, v184
  v_sub_f32 v204, v144, v204
  v_sub_f32 v224, v144, v224
  v_exp_f32 v68, v68
  v_exp_f32 v184, v184
  v_exp_f32 v204, v204
  v_exp_f32 v224, v224
  v_mul_u32_u24 v146, 24, v101
  v_and_b32 v144, 15, v0
  v_lshl_add_u32 v146, v144, 3, v146
  s_lshr_b32 s70, s100, 2
  s_mul_i32 s70, s70, 1536
  v_mul_f32 v69, v68, v69
  v_mul_f32 v185, v184, v185
  v_mul_f32 v205, v204, v205
  v_mul_f32 v225, v224, v225
  v_add_f32 v69, v69, v185
  v_add_f32 v205, v205, v225
  v_add_f32 v69, v69, v205
  v_rcp_f32 v145, v69
  v_mul_f32 v52, v68, v52
  v_mul_f32 v168, v184, v168
  v_mul_f32 v188, v204, v188
  v_mul_f32 v208, v224, v208
  v_add_f32 v52, v52, v168
  v_add_f32 v188, v188, v208
  v_add_f32 v52, v52, v188
  v_mul_f32 v52, v145, v52
  v_mul_f32 v53, v68, v53
  v_mul_f32 v169, v184, v169
  v_mul_f32 v189, v204, v189
  v_mul_f32 v209, v224, v209
  v_add_f32 v53, v53, v169
  v_add_f32 v189, v189, v209
  v_add_f32 v53, v53, v189
  v_mul_f32 v53, v145, v53
  v_mul_f32 v54, v68, v54
  v_mul_f32 v170, v184, v170
  v_mul_f32 v190, v204, v190
  v_mul_f32 v210, v224, v210
  v_add_f32 v54, v54, v170
  v_add_f32 v190, v190, v210
  v_add_f32 v54, v54, v190
  v_mul_f32 v54, v145, v54
  v_mul_f32 v56, v68, v56
  v_mul_f32 v172, v184, v172
  v_mul_f32 v192, v204, v192
  v_mul_f32 v212, v224, v212
  v_add_f32 v56, v56, v172
  v_add_f32 v192, v192, v212
  v_add_f32 v56, v56, v192
  v_mul_f32 v56, v145, v56
  v_cvt_pk_bf16_f32 v128, v52, v53
  v_cvt_pk_bf16_f32 v129, v54, v56
  buffer_store_dwordx2 v[128:129], v146, s[36:39], s70 offen offset:0
  v_mul_f32 v57, v68, v57
  v_mul_f32 v173, v184, v173
  v_mul_f32 v193, v204, v193
  v_mul_f32 v213, v224, v213
  v_add_f32 v57, v57, v173
  v_add_f32 v193, v193, v213
  v_add_f32 v57, v57, v193
  v_mul_f32 v57, v145, v57
  v_mul_f32 v58, v68, v58
  v_mul_f32 v174, v184, v174
  v_mul_f32 v194, v204, v194
  v_mul_f32 v214, v224, v214
  v_add_f32 v58, v58, v174
  v_add_f32 v194, v194, v214
  v_add_f32 v58, v58, v194
  v_mul_f32 v58, v145, v58
  v_mul_f32 v60, v68, v60
  v_mul_f32 v176, v184, v176
  v_mul_f32 v196, v204, v196
  v_mul_f32 v216, v224, v216
  v_add_f32 v60, v60, v176
  v_add_f32 v196, v196, v216
  v_add_f32 v60, v60, v196
  v_mul_f32 v60, v145, v60
  v_mul_f32 v61, v68, v61
  v_mul_f32 v177, v184, v177
  v_mul_f32 v197, v204, v197
  v_mul_f32 v217, v224, v217
  v_add_f32 v61, v61, v177
  v_add_f32 v197, v197, v217
  v_add_f32 v61, v61, v197
  v_mul_f32 v61, v145, v61
  v_cvt_pk_bf16_f32 v130, v57, v58
  v_cvt_pk_bf16_f32 v131, v60, v61
  buffer_store_dwordx2 v[130:131], v146, s[36:39], s70 offen offset:128
  v_mul_f32 v62, v68, v62
  v_mul_f32 v178, v184, v178
  v_mul_f32 v198, v204, v198
  v_mul_f32 v218, v224, v218
  v_add_f32 v62, v62, v178
  v_add_f32 v198, v198, v218
  v_add_f32 v62, v62, v198
  v_mul_f32 v62, v145, v62
  v_mul_f32 v64, v68, v64
  v_mul_f32 v180, v184, v180
  v_mul_f32 v200, v204, v200
  v_mul_f32 v220, v224, v220
  v_add_f32 v64, v64, v180
  v_add_f32 v200, v200, v220
  v_add_f32 v64, v64, v200
  v_mul_f32 v64, v145, v64
  v_mul_f32 v65, v68, v65
  v_mul_f32 v181, v184, v181
  v_mul_f32 v201, v204, v201
  v_mul_f32 v221, v224, v221
  v_add_f32 v65, v65, v181
  v_add_f32 v201, v201, v221
  v_add_f32 v65, v65, v201
  v_mul_f32 v65, v145, v65
  v_mul_f32 v66, v68, v66
  v_mul_f32 v182, v184, v182
  v_mul_f32 v202, v204, v202
  v_mul_f32 v222, v224, v222
  v_add_f32 v66, v66, v182
  v_add_f32 v202, v202, v222
  v_add_f32 v66, v66, v202
  v_mul_f32 v66, v145, v66
  v_cvt_pk_bf16_f32 v132, v62, v64
  v_cvt_pk_bf16_f32 v133, v65, v66
  buffer_store_dwordx2 v[132:133], v146, s[36:39], s70 offen offset:256
L_fin:
L_end:
  s_endpgm
L_helper:
  v_lshlrev_b32 v1, 2, v0
  v_add_u32 v1, 61696, v1
  v_mov_b32 v2, 0
  s_mov_b64 exec, 0xff
  ds_write_b32 v1, v2
  s_mov_b64 exec, -1
  s_waitcnt lgkmcnt(0)
  s_mov_b32 s8, s46
  s_and_b32 s9, s47, 0xffff
  s_mov_b32 s36, s44
  s_and_b32 s37, s45, 0xffff
  s_mov_b32 s16, s46
  s_and_b32 s17, s47, 0xffff
  s_mov_b32 s12, s48
  s_and_b32 s13, s49, 0xffff
  s_mov_b32 s40, s82
  s_and_b32 s41, s83, 0xffff
  s_barrier
  s_memrealtime s[72:73]
  s_getpc_b64 s[54:55]
L_h_pc:
  s_add_u32 s86, s54, L_h_cp - L_h_pc
  s_addc_u32 s87, s55, 0
  s_sub_u32 s54, s54, L_h_pc - L_k
  s_subb_u32 s55, s55, 0
  s_and_b32 s54, s54, -16
  s_lshr_b32 s70, s2, 3
  s_lshl_b32 s70, s70, 10
  v_lshl_add_u32 v106, v0, 4, s70
  v_mov_b32 v107, s55
  v_add_co_u32 v106, vcc, s54, v106
  s_nop 1
  v_addc_co_u32 v107, vcc, 0, v107, vcc
  s_lshr_b32 s70, s2, 3
  s_cmp_lt_u32 s70, (L_code_end - L_k) / 1024
  s_cbranch_scc0 L_h_cta
  global_load_dwordx4 v[108:111], v[106:107], off
L_h_cta:
  s_lshr_b32 s70, s2, 4
  s_and_b32 s70, s70, 8
  s_and_b32 s71, s2, 7
  s_add_u32 s70, s70, s71
  s_lshl_b32 s70, s70, 4
  v_lshl_add_u32 v104, v0, 3, s70
  v_and_b32 v105, 31, v0
  v_lshlrev_b32 v105, 3, v105
  v_and_b32 v112, 1, v0
  v_lshlrev_b32 v112, 2, v112
  v_add_u32 v112, 61712, v112
  v_mov_b32 v113, 0
  v_lshlrev_b32 v3, 4, v0
  s_mov_b32 s76, 12
  s_mov_b32 s77, 7340032
  s_getreg_b32 s50, hwreg(HW_REG_XCC_ID)
  s_bfe_u32 s50, s50, 0x10002
  s_bfe_u32 s52, s2, 0x30003
  s_cmp_eq_u32 s52, 7
  s_cbranch_scc1 L_h_voted
  s_lshr_b32 s70, s2, 6
  s_xor_b32 s70, s70, s2
  s_and_b32 s70, s70, 3
  s_cbranch_scc1 L_h_voted
  s_cmp_eq_u32 s52, 6
  s_cbranch_scc0 L_h_probe
  s_xor_b32 s48, s50, s4
  s_and_b32 s52, s2, 3
  s_lshl2_add_u32 s52, s52, 36
  s_branch L_h_vote
L_h_probe:
  s_cmp_ge_u32 s52, 3
  s_cselect_b32 s16, s12, s8
  s_cselect_b32 s17, s13, s9
  s_cselect_b32 s70, 3, 0
  s_sub_u32 s70, s52, s70
  s_lshl_b32 s70, s70, 28
  s_add_u32 s44, s5, s4
  s_lshl_b32 s44, s44, 16
  s_add_u32 s44, s44, s70
  s_add_u32 s44, s44, 0x1c0000
  s_mul_i32 s70, s2, 0x2a95
  s_and_b32 s70, s70, 0x7f80
  s_add_u32 s44, s44, s70
  s_add_u32 s70, s44, 0x8000
  s_buffer_load_dword s58, s[16:19], s70
  s_mov_b32 s45, -1
  s_mov_b32 s46, -1
  s_mul_i32 s52, s52, 6
L_h_progp:
  s_sleep 2
  ds_read_b32 v8, v112
  s_waitcnt lgkmcnt(0)
  v_cmp_gt_u32 vcc, 1, v8
  s_nop 1
  s_cmp_lg_u32 vcc_lo, 0
  s_cbranch_scc1 L_h_progp
  s_xor_b32 s70, s44, 0
  s_memtime s[54:55]
  s_waitcnt lgkmcnt(0)
  s_buffer_load_dword s58, s[16:19], s70
  s_waitcnt lgkmcnt(0)
  s_memtime s[56:57]
  s_waitcnt lgkmcnt(0)
  s_sub_u32 s56, s56, s54
  s_min_u32 s45, s45, s56
  s_xor_b32 s70, s44, 8192
  s_memtime s[54:55]
  s_waitcnt lgkmcnt(0)
  s_buffer_load_dword s58, s[16:19], s70
  s_waitcnt lgkmcnt(0)
  s_memtime s[56:57]
  s_waitcnt lgkmcnt(0)
  s_sub_u32 s56, s56, s54
  s_min_u32 s46, s46, s56
  s_xor_b32 s70, s44, 25472
  s_memtime s[54:55]
  s_waitcnt lgkmcnt(0)
  s_buffer_load_dword s58, s[16:19], s70
  s_waitcnt lgkmcnt(0)
  s_memtime s[56:57]
  s_waitcnt lgkmcnt(0)
  s_sub_u32 s56, s56, s54
  s_min_u32 s46, s46, s56
  s_xor_b32 s70, s44, 17280
  s_memtime s[54:55]
  s_waitcnt lgkmcnt(0)
  s_buffer_load_dword s58, s[16:19], s70
  s_waitcnt lgkmcnt(0)
  s_memtime s[56:57]
  s_waitcnt lgkmcnt(0)
  s_sub_u32 s56, s56, s54
  s_min_u32 s45, s45, s56
  s_xor_b32 s70, s44, 5888
  s_memtime s[54:55]
  s_waitcnt lgkmcnt(0)
  s_buffer_load_dword s58, s[16:19], s70
  s_waitcnt lgkmcnt(0)
  s_memtime s[56:57]
  s_waitcnt lgkmcnt(0)
  s_sub_u32 s56, s56, s54
  s_min_u32 s45, s45, s56
  s_xor_b32 s70, s44, 14080
  s_memtime s[54:55]
  s_waitcnt lgkmcnt(0)
  s_buffer_load_dword s58, s[16:19], s70
  s_waitcnt lgkmcnt(0)
  s_memtime s[56:57]
  s_waitcnt lgkmcnt(0)
  s_sub_u32 s56, s56, s54
  s_min_u32 s46, s46, s56
  s_cmp_lt_u32 s46, s45
  s_cselect_b32 s48, 1, 0
  s_lshr_b32 s70, s44, 13
  s_xor_b32 s70, s70, s2
  s_xor_b32 s70, s70, s50
  s_and_b32 s70, s70, 1
  s_xor_b32 s48, s48, s70
L_h_vote:
  s_mov_b32 s49, 0
  s_lshl_b64 s[48:49], s[48:49], s52
  s_or_b32 s49, s49, 0x1000000
  s_atomic_add_x2 s[48:49], s[80:81], 0
L_h_voted:
  s_waitcnt lgkmcnt(0)
  s_cmp_lg_u32 s2, 56
  s_cbranch_scc1 L_h_nonce
  s_lshl_b64 s[54:55], s[72:73], 2
  s_atomic_add_x2 s[54:55], s[80:81], 8
  s_waitcnt lgkmcnt(0)
L_h_nonce:
L_h_progv:
  s_sleep 8
  ds_read_b32 v8, v112
  s_waitcnt lgkmcnt(0)
  v_cmp_gt_u32 vcc, 6, v8
  s_nop 1
  s_cmp_lg_u32 vcc_lo, 0
  s_cbranch_scc1 L_h_progv
  s_load_dwordx2 s[48:49], s[80:81], 0
  s_mov_b32 s59, 0
L_h_votes:
  s_waitcnt lgkmcnt(0)
  s_lshr_b32 s70, s49, 24
  s_cmp_eq_u32 s70, 56
  s_cbranch_scc1 L_h_votes_done
  s_add_u32 s59, s59, 1
  s_cmp_gt_u32 s59, 2000
  s_cbranch_scc1 L_h_votes_done
  s_sleep 64
  s_mov_b64 s[48:49], 0
  s_atomic_or_x2 s[48:49], s[80:81], 0 glc
  s_branch L_h_votes
L_h_votes_done:
  s_mov_b32 s96, 0x80
  s_bfe_u64 s[54:55], s[48:49], 0x60000
  s_cmp_gt_u32 s54, 4
  s_cselect_b32 s56, 1, 0
  s_or_b32 s96, s96, s56
  s_bfe_u64 s[54:55], s[48:49], 0x60006
  s_cmp_gt_u32 s54, 4
  s_cselect_b32 s56, 2, 0
  s_or_b32 s96, s96, s56
  s_bfe_u64 s[54:55], s[48:49], 0x6000c
  s_cmp_gt_u32 s54, 4
  s_cselect_b32 s56, 4, 0
  s_or_b32 s96, s96, s56
  s_bfe_u64 s[54:55], s[48:49], 0x60012
  s_cmp_gt_u32 s54, 4
  s_cselect_b32 s56, 8, 0
  s_or_b32 s96, s96, s56
  s_bfe_u64 s[54:55], s[48:49], 0x60018
  s_cmp_gt_u32 s54, 4
  s_cselect_b32 s56, 16, 0
  s_or_b32 s96, s96, s56
  s_bfe_u64 s[54:55], s[48:49], 0x6001e
  s_cmp_gt_u32 s54, 4
  s_cselect_b32 s56, 32, 0
  s_or_b32 s96, s96, s56
  s_and_b32 s70, s2, 3
  s_lshl2_add_u32 s70, s70, 5
  s_lshr_b32 s54, s49, s70
  s_xor_b32 s54, s54, s2
  s_xor_b32 s54, s54, s4
  s_and_b32 s54, s54, 1
  s_mul_i32 s54, s54, 63
  s_xor_b32 s96, s96, s54
  v_mov_b32 v1, 61696
  v_mov_b32 v5, s96
  ds_write_b32 v1, v5
  s_load_dwordx2 s[74:75], s[80:81], 8
  s_mov_b32 s59, 0
L_h_getnonce:
  s_waitcnt lgkmcnt(0)
  s_cmp_lg_u64 s[74:75], 0
  s_cbranch_scc1 L_h_gotnonce
  s_add_u32 s59, s59, 1
  s_cmp_gt_u32 s59, 2000
  s_cbranch_scc1 L_h_gotnonce
  s_sleep 64
  s_atomic_or_x2 s[74:75], s[80:81], 8 glc
  s_branch L_h_getnonce
L_h_gotnonce:
  s_lshr_b64 s[54:55], s[74:75], 2
  v_mov_b32 v1, 61704
  v_mov_b32 v5, s54
  ds_write_b32 v1, v5
  s_lshl_b32 s62, s2, 8
  s_add_u32 s62, s62, 7405568
  s_xor_b32 s63, s62, 1024
  s_lshr_b32 s58, s96, 3
  s_xor_b32 s58, s58, s96
  s_lshr_b32 s70, s5, 4
  s_lshr_b32 s44, s70, 5
  s_lshl_b32 s44, s44, 21
  s_add_u32 s44, s44, 8388608
  s_and_b32 s64, s70, 31
  s_add_u32 s70, s64, s4
  s_lshl_b32 s70, s70, 10
  s_add_u32 s60, s44, s70
  s_xor_b32 s61, s60, 1024
  s_mov_b32 s78, 60
  s_swappc_b64 s[84:85], s[86:87]
L_h_proga:
  s_sleep 4
  ds_read_b32 v8, v112
  s_waitcnt lgkmcnt(0)
  v_cmp_gt_u32 vcc, 64, v8
  s_nop 1
  s_cmp_lg_u32 vcc_lo, 0
  s_cbranch_scc1 L_h_proga
  ds_read_b128 v[8:11], v3 offset:0
  ds_read_b128 v[12:15], v3 offset:1024
  ds_read_b128 v[16:19], v3 offset:2048
  s_waitcnt lgkmcnt(0)
  s_xor_b32 s70, s60, 0
  buffer_store_dwordx4 v[8:11], v3, s[40:43], s70 offen sc1
  s_xor_b32 s70, s60, 32768
  buffer_store_dwordx4 v[12:15], v3, s[40:43], s70 offen sc1
  s_xor_b32 s70, s60, 65536
  buffer_store_dwordx4 v[16:19], v3, s[40:43], s70 offen sc1
  s_bitcmp0_b32 s58, 0
  s_cbranch_scc1 L_h_e0
  ds_read_b128 v[20:23], v3 offset:3072
  ds_read_b128 v[24:27], v3 offset:4096
  ds_read_b128 v[28:31], v3 offset:5120
  ds_read_b128 v[32:35], v3 offset:6144
  ds_read_b128 v[36:39], v3 offset:7168
  ds_read_b128 v[40:43], v3 offset:8192
  ds_read_b128 v[44:47], v3 offset:9216
  ds_read_b128 v[48:51], v3 offset:10240
  ds_read_b128 v[52:55], v3 offset:11264
  s_waitcnt lgkmcnt(0)
  s_xor_b32 s70, s60, 98304
  buffer_store_dwordx4 v[20:23], v3, s[40:43], s70 offen sc1
  s_xor_b32 s70, s60, 132096
  buffer_store_dwordx4 v[24:27], v3, s[40:43], s70 offen sc1
  s_xor_b32 s70, s60, 164864
  buffer_store_dwordx4 v[28:31], v3, s[40:43], s70 offen sc1
  s_xor_b32 s70, s60, 197632
  buffer_store_dwordx4 v[32:35], v3, s[40:43], s70 offen sc1
  s_xor_b32 s70, s60, 230400
  buffer_store_dwordx4 v[36:39], v3, s[40:43], s70 offen sc1
  s_xor_b32 s70, s60, 264192
  buffer_store_dwordx4 v[40:43], v3, s[40:43], s70 offen sc1
  s_xor_b32 s70, s60, 296960
  buffer_store_dwordx4 v[44:47], v3, s[40:43], s70 offen sc1
  s_xor_b32 s70, s60, 329728
  buffer_store_dwordx4 v[48:51], v3, s[40:43], s70 offen sc1
  s_xor_b32 s70, s60, 362496
  buffer_store_dwordx4 v[52:55], v3, s[40:43], s70 offen sc1
L_h_e0:
  s_bitcmp0_b32 s58, 1
  s_cbranch_scc1 L_h_e1
  ds_read_b128 v[56:59], v3 offset:12288
  ds_read_b128 v[60:63], v3 offset:13312
  ds_read_b128 v[64:67], v3 offset:14336
  ds_read_b128 v[68:71], v3 offset:15360
  ds_read_b128 v[72:75], v3 offset:16384
  ds_read_b128 v[76:79], v3 offset:17408
  ds_read_b128 v[80:83], v3 offset:18432
  ds_read_b128 v[84:87], v3 offset:19456
  ds_read_b128 v[88:91], v3 offset:20480
  ds_read_b128 v[92:95], v3 offset:21504
  ds_read_b128 v[96:99], v3 offset:22528
  ds_read_b128 v[100:103], v3 offset:23552
  s_waitcnt lgkmcnt(0)
  s_xor_b32 s70, s60, 396288
  buffer_store_dwordx4 v[56:59], v3, s[40:43], s70 offen sc1
  s_xor_b32 s70, s60, 429056
  buffer_store_dwordx4 v[60:63], v3, s[40:43], s70 offen sc1
  s_xor_b32 s70, s60, 461824
  buffer_store_dwordx4 v[64:67], v3, s[40:43], s70 offen sc1
  s_xor_b32 s70, s60, 494592
  buffer_store_dwordx4 v[68:71], v3, s[40:43], s70 offen sc1
  s_xor_b32 s70, s60, 541696
  buffer_store_dwordx4 v[72:75], v3, s[40:43], s70 offen sc1
  s_xor_b32 s70, s60, 574464
  buffer_store_dwordx4 v[76:79], v3, s[40:43], s70 offen sc1
  s_xor_b32 s70, s60, 607232
  buffer_store_dwordx4 v[80:83], v3, s[40:43], s70 offen sc1
  s_xor_b32 s70, s60, 640000
  buffer_store_dwordx4 v[84:87], v3, s[40:43], s70 offen sc1
  s_xor_b32 s70, s60, 671744
  buffer_store_dwordx4 v[88:91], v3, s[40:43], s70 offen sc1
  s_xor_b32 s70, s60, 704512
  buffer_store_dwordx4 v[92:95], v3, s[40:43], s70 offen sc1
  s_xor_b32 s70, s60, 737280
  buffer_store_dwordx4 v[96:99], v3, s[40:43], s70 offen sc1
  s_xor_b32 s70, s60, 770048
  buffer_store_dwordx4 v[100:103], v3, s[40:43], s70 offen sc1
L_h_e1:
  s_add_u32 s54, s74, 1
  v_mov_b32 v5, 0
  s_waitcnt vmcnt(0)
  v_mov_b32 v8, s54
  v_mov_b32 v9, s75
  s_mov_b64 exec, 1
  buffer_store_dwordx2 v[8:9], v5, s[40:43], s62 offen sc1
  s_mov_b32 s59, 0
L_h_flaga:
  buffer_load_dwordx2 v[10:11], v5, s[40:43], s63 offen sc1
  s_waitcnt vmcnt(0)
  v_readfirstlane_b32 s56, v10
  v_readfirstlane_b32 s57, v11
  s_nop 0
  s_sub_u32 s56, s56, s54
  s_xor_b32 s57, s57, s75
  s_lshr_b32 s56, s56, 1
  s_or_b32 s56, s56, s57
  s_cbranch_scc0 L_h_flaga_done
  s_add_u32 s59, s59, 1
  s_cmp_gt_u32 s59, 10000
  s_cbranch_scc1 L_h_flaga_done
  s_sleep 8
  s_branch L_h_flaga
L_h_flaga_done:
  s_mov_b64 exec, -1
  s_bfe_u32 s54, s96, 0x10003
  s_mul_i32 s54, s54, 384
  v_lshrrev_b32 v4, 3, v0
  v_add_u32 v5, 0, v4
  v_mul_u32_u24 v5, 21846, v5
  v_bfe_u32 v5, v5, 16, 1
  v_mul_u32_u24 v6, 384, v5
  v_sub_u32 v6, v3, v6
  v_add_u32 v6, s54, v6
  v_add_u32 v6, 0, v6
  v_add_u32 v5, s64, v5
  v_lshrrev_b32 v2, 12, v6
  v_xor_b32 v5, v5, v2
  v_lshrrev_b32 v2, 10, v6
  v_lshl_add_u32 v5, v2, 5, v5
  v_and_b32 v6, 1023, v6
  v_lshl_add_u32 v5, v5, 10, v6
  buffer_load_dwordx4 v[8:11], v5, s[40:43], s44 offen sc1
  v_add_u32 v5, 8, v4
  v_mul_u32_u24 v5, 21846, v5
  v_bfe_u32 v5, v5, 16, 1
  v_mul_u32_u24 v6, 384, v5
  v_sub_u32 v6, v3, v6
  v_add_u32 v6, s54, v6
  v_add_u32 v6, 1024, v6
  v_add_u32 v5, s64, v5
  v_lshrrev_b32 v2, 12, v6
  v_xor_b32 v5, v5, v2
  v_lshrrev_b32 v2, 10, v6
  v_lshl_add_u32 v5, v2, 5, v5
  v_and_b32 v6, 1023, v6
  v_lshl_add_u32 v5, v5, 10, v6
  buffer_load_dwordx4 v[12:15], v5, s[40:43], s44 offen sc1
  v_add_u32 v5, 16, v4
  v_mul_u32_u24 v5, 21846, v5
  v_bfe_u32 v5, v5, 16, 1
  v_mul_u32_u24 v6, 384, v5
  v_sub_u32 v6, v3, v6
  v_add_u32 v6, s54, v6
  v_add_u32 v6, 2048, v6
  v_add_u32 v5, s64, v5
  v_lshrrev_b32 v2, 12, v6
  v_xor_b32 v5, v5, v2
  v_lshrrev_b32 v2, 10, v6
  v_lshl_add_u32 v5, v2, 5, v5
  v_and_b32 v6, 1023, v6
  v_lshl_add_u32 v5, v5, 10, v6
  buffer_load_dwordx4 v[16:19], v5, s[40:43], s44 offen sc1
  s_bitcmp0_b32 s58, 0
  s_cbranch_scc1 L_h_i0
  s_xor_b32 s70, s61, 98304
  buffer_load_dwordx4 v[20:23], v3, s[40:43], s70 offen sc1
  s_xor_b32 s70, s61, 132096
  buffer_load_dwordx4 v[24:27], v3, s[40:43], s70 offen sc1
  s_xor_b32 s70, s61, 164864
  buffer_load_dwordx4 v[28:31], v3, s[40:43], s70 offen sc1
  s_xor_b32 s70, s61, 197632
  buffer_load_dwordx4 v[32:35], v3, s[40:43], s70 offen sc1
  s_xor_b32 s70, s61, 230400
  buffer_load_dwordx4 v[36:39], v3, s[40:43], s70 offen sc1
  s_xor_b32 s70, s61, 264192
  buffer_load_dwordx4 v[40:43], v3, s[40:43], s70 offen sc1
  s_xor_b32 s70, s61, 296960
  buffer_load_dwordx4 v[44:47], v3, s[40:43], s70 offen sc1
  s_xor_b32 s70, s61, 329728
  buffer_load_dwordx4 v[48:51], v3, s[40:43], s70 offen sc1
  s_xor_b32 s70, s61, 362496
  buffer_load_dwordx4 v[52:55], v3, s[40:43], s70 offen sc1
  s_waitcnt vmcnt(0)
  ds_write_b128 v3, v[20:23] offset:3072
  ds_write_b128 v3, v[24:27] offset:4096
  ds_write_b128 v3, v[28:31] offset:5120
  ds_write_b128 v3, v[32:35] offset:6144
  ds_write_b128 v3, v[36:39] offset:7168
  ds_write_b128 v3, v[40:43] offset:8192
  ds_write_b128 v3, v[44:47] offset:9216
  ds_write_b128 v3, v[48:51] offset:10240
  ds_write_b128 v3, v[52:55] offset:11264
L_h_i0:
  s_bitcmp0_b32 s58, 1
  s_cbranch_scc1 L_h_i1
  s_xor_b32 s70, s61, 396288
  buffer_load_dwordx4 v[56:59], v3, s[40:43], s70 offen sc1
  s_xor_b32 s70, s61, 429056
  buffer_load_dwordx4 v[60:63], v3, s[40:43], s70 offen sc1
  s_xor_b32 s70, s61, 461824
  buffer_load_dwordx4 v[64:67], v3, s[40:43], s70 offen sc1
  s_xor_b32 s70, s61, 494592
  buffer_load_dwordx4 v[68:71], v3, s[40:43], s70 offen sc1
  s_xor_b32 s70, s61, 541696
  buffer_load_dwordx4 v[72:75], v3, s[40:43], s70 offen sc1
  s_xor_b32 s70, s61, 574464
  buffer_load_dwordx4 v[76:79], v3, s[40:43], s70 offen sc1
  s_xor_b32 s70, s61, 607232
  buffer_load_dwordx4 v[80:83], v3, s[40:43], s70 offen sc1
  s_xor_b32 s70, s61, 640000
  buffer_load_dwordx4 v[84:87], v3, s[40:43], s70 offen sc1
  s_xor_b32 s70, s61, 671744
  buffer_load_dwordx4 v[88:91], v3, s[40:43], s70 offen sc1
  s_xor_b32 s70, s61, 704512
  buffer_load_dwordx4 v[92:95], v3, s[40:43], s70 offen sc1
  s_xor_b32 s70, s61, 737280
  buffer_load_dwordx4 v[96:99], v3, s[40:43], s70 offen sc1
  s_xor_b32 s70, s61, 770048
  buffer_load_dwordx4 v[100:103], v3, s[40:43], s70 offen sc1
  s_waitcnt vmcnt(0)
  ds_write_b128 v3, v[56:59] offset:12288
  ds_write_b128 v3, v[60:63] offset:13312
  ds_write_b128 v3, v[64:67] offset:14336
  ds_write_b128 v3, v[68:71] offset:15360
  ds_write_b128 v3, v[72:75] offset:16384
  ds_write_b128 v3, v[76:79] offset:17408
  ds_write_b128 v3, v[80:83] offset:18432
  ds_write_b128 v3, v[84:87] offset:19456
  ds_write_b128 v3, v[88:91] offset:20480
  ds_write_b128 v3, v[92:95] offset:21504
  ds_write_b128 v3, v[96:99] offset:22528
  ds_write_b128 v3, v[100:103] offset:23552
L_h_i1:
  s_waitcnt vmcnt(0)
  ds_write_b128 v3, v[8:11] offset:0
  ds_write_b128 v3, v[12:15] offset:1024
  ds_write_b128 v3, v[16:19] offset:2048
  s_bitcmp0_b32 s58, 2
  s_cselect_b32 s70, 255, 64
  v_mov_b32 v1, 61700
  v_mov_b32 v5, s70
  ds_write_b32 v1, v5
  s_mov_b32 s78, 92
  s_swappc_b64 s[84:85], s[86:87]
  s_bitcmp0_b32 s58, 2
  s_cbranch_scc1 L_h_all
L_h_progb:
  s_sleep 4
  ds_read_b32 v8, v112
  s_waitcnt lgkmcnt(0)
  v_cmp_gt_u32 vcc, 96, v8
  s_nop 1
  s_cmp_lg_u32 vcc_lo, 0
  s_cbranch_scc1 L_h_progb
  ds_read_b128 v[8:11], v3 offset:24576
  ds_read_b128 v[12:15], v3 offset:25600
  ds_read_b128 v[16:19], v3 offset:26624
  ds_read_b128 v[20:23], v3 offset:27648
  ds_read_b128 v[24:27], v3 offset:28672
  ds_read_b128 v[28:31], v3 offset:29696
  ds_read_b128 v[32:35], v3 offset:30720
  ds_read_b128 v[36:39], v3 offset:31744
  ds_read_b128 v[40:43], v3 offset:32768
  ds_read_b128 v[44:47], v3 offset:33792
  ds_read_b128 v[48:51], v3 offset:34816
  ds_read_b128 v[52:55], v3 offset:35840
  s_waitcnt lgkmcnt(0)
  s_xor_b32 s70, s60, 805888
  buffer_store_dwordx4 v[8:11], v3, s[40:43], s70 offen sc1
  s_xor_b32 s70, s60, 838656
  buffer_store_dwordx4 v[12:15], v3, s[40:43], s70 offen sc1
  s_xor_b32 s70, s60, 871424
  buffer_store_dwordx4 v[16:19], v3, s[40:43], s70 offen sc1
  s_xor_b32 s70, s60, 904192
  buffer_store_dwordx4 v[20:23], v3, s[40:43], s70 offen sc1
  s_xor_b32 s70, s60, 935936
  buffer_store_dwordx4 v[24:27], v3, s[40:43], s70 offen sc1
  s_xor_b32 s70, s60, 968704
  buffer_store_dwordx4 v[28:31], v3, s[40:43], s70 offen sc1
  s_xor_b32 s70, s60, 1001472
  buffer_store_dwordx4 v[32:35], v3, s[40:43], s70 offen sc1
  s_xor_b32 s70, s60, 1034240
  buffer_store_dwordx4 v[36:39], v3, s[40:43], s70 offen sc1
  s_xor_b32 s70, s60, 1052672
  buffer_store_dwordx4 v[40:43], v3, s[40:43], s70 offen sc1
  s_xor_b32 s70, s60, 1085440
  buffer_store_dwordx4 v[44:47], v3, s[40:43], s70 offen sc1
  s_xor_b32 s70, s60, 1118208
  buffer_store_dwordx4 v[48:51], v3, s[40:43], s70 offen sc1
  s_xor_b32 s70, s60, 1150976
  buffer_store_dwordx4 v[52:55], v3, s[40:43], s70 offen sc1
  s_add_u32 s54, s74, 2
  v_mov_b32 v5, 0
  s_waitcnt vmcnt(0)
  v_mov_b32 v8, s54
  v_mov_b32 v9, s75
  s_mov_b64 exec, 1
  buffer_store_dwordx2 v[8:9], v5, s[40:43], s62 offen sc1
  s_mov_b32 s59, 0
L_h_flagb:
  buffer_load_dwordx2 v[10:11], v5, s[40:43], s63 offen sc1
  s_waitcnt vmcnt(0)
  v_readfirstlane_b32 s56, v10
  v_readfirstlane_b32 s57, v11
  s_nop 0
  s_sub_u32 s56, s56, s54
  s_xor_b32 s57, s57, s75
  s_lshr_b32 s56, s56, 1
  s_or_b32 s56, s56, s57
  s_cbranch_scc0 L_h_flagb_done
  s_add_u32 s59, s59, 1
  s_cmp_gt_u32 s59, 10000
  s_cbranch_scc1 L_h_flagb_done
  s_sleep 8
  s_branch L_h_flagb
L_h_flagb_done:
  s_mov_b64 exec, -1
  s_xor_b32 s70, s61, 805888
  buffer_load_dwordx4 v[8:11], v3, s[40:43], s70 offen sc1
  s_xor_b32 s70, s61, 838656
  buffer_load_dwordx4 v[12:15], v3, s[40:43], s70 offen sc1
  s_xor_b32 s70, s61, 871424
  buffer_load_dwordx4 v[16:19], v3, s[40:43], s70 offen sc1
  s_xor_b32 s70, s61, 904192
  buffer_load_dwordx4 v[20:23], v3, s[40:43], s70 offen sc1
  s_xor_b32 s70, s61, 935936
  buffer_load_dwordx4 v[24:27], v3, s[40:43], s70 offen sc1
  s_xor_b32 s70, s61, 968704
  buffer_load_dwordx4 v[28:31], v3, s[40:43], s70 offen sc1
  s_xor_b32 s70, s61, 1001472
  buffer_load_dwordx4 v[32:35], v3, s[40:43], s70 offen sc1
  s_xor_b32 s70, s61, 1034240
  buffer_load_dwordx4 v[36:39], v3, s[40:43], s70 offen sc1
  s_xor_b32 s70, s61, 1052672
  buffer_load_dwordx4 v[40:43], v3, s[40:43], s70 offen sc1
  s_xor_b32 s70, s61, 1085440
  buffer_load_dwordx4 v[44:47], v3, s[40:43], s70 offen sc1
  s_xor_b32 s70, s61, 1118208
  buffer_load_dwordx4 v[48:51], v3, s[40:43], s70 offen sc1
  s_xor_b32 s70, s61, 1150976
  buffer_load_dwordx4 v[52:55], v3, s[40:43], s70 offen sc1
  s_waitcnt vmcnt(0)
  ds_write_b128 v3, v[8:11] offset:24576
  ds_write_b128 v3, v[12:15] offset:25600
  ds_write_b128 v3, v[16:19] offset:26624
  ds_write_b128 v3, v[20:23] offset:27648
  ds_write_b128 v3, v[24:27] offset:28672
  ds_write_b128 v3, v[28:31] offset:29696
  ds_write_b128 v3, v[32:35] offset:30720
  ds_write_b128 v3, v[36:39] offset:31744
  ds_write_b128 v3, v[40:43] offset:32768
  ds_write_b128 v3, v[44:47] offset:33792
  ds_write_b128 v3, v[48:51] offset:34816
  ds_write_b128 v3, v[52:55] offset:35840
  v_mov_b32 v1, 61700
  v_mov_b32 v5, 255
  ds_write_b32 v1, v5
L_h_all:
  s_mov_b32 s78, 182
  s_swappc_b64 s[84:85], s[86:87]
L_h_progt:
  s_sleep 4
  ds_read_b32 v8, v112
  s_waitcnt lgkmcnt(0)
  v_cmp_gt_u32 vcc, 188, v8
  s_nop 1
  s_cmp_lg_u32 vcc_lo, 0
  s_cbranch_scc1 L_h_progt
  v_mov_b32 v8, 255
  ds_write_b32 v112, v8 offset:8
  s_waitcnt lgkmcnt(0)
  s_endpgm
L_h_cp:
  s_cmp_gt_u32 s76, s78
  s_cbranch_scc0 L_h_cpgo
  s_setpc_b64 s[84:85]
L_h_cpgo:
  ds_read_b32 v8, v112
  s_memrealtime s[54:55]
  s_waitcnt lgkmcnt(0)
  v_mov_b32 v114, s54
  v_mov_b32 v115, s55
  v_cmp_gt_u32 vcc, s76, v8
  s_nop 1
  s_cmp_eq_u32 vcc_lo, 0
  s_cbranch_scc1 L_h_cpnext
L_h_cpm:
  s_sleep 2
  ds_read_b32 v8, v112
  s_memrealtime s[54:55]
  s_waitcnt lgkmcnt(0)
  v_mov_b32 v10, s54
  v_mov_b32 v11, s55
  v_cndmask_b32 v114, v114, v10, vcc
  v_cndmask_b32 v115, v115, v11, vcc
  v_cmp_gt_u32 vcc, s76, v8
  s_nop 1
  s_cmp_lg_u32 vcc_lo, 0
  s_cbranch_scc1 L_h_cpm
  s_and_b32 s70, s2, 0x78
  s_cbranch_scc1 L_h_np
  s_mov_b64 exec, 3
  buffer_store_dwordx2 v[114:115], v104, s[40:43], s77 offen sc1
  s_mov_b64 exec, -1
L_h_np:
  s_add_u32 s50, s76, 4
L_h_progc:
  s_sleep 4
  ds_read_b32 v8, v112
  s_waitcnt lgkmcnt(0)
  v_cmp_gt_u32 vcc, s50, v8
  s_nop 1
  s_cmp_lg_u32 vcc_lo, 0
  s_cbranch_scc1 L_h_progc
  buffer_load_dwordx2 v[8:9], v105, s[40:43], s77 offen
  v_mov_b32 v10, s73
  s_waitcnt vmcnt(0)
  ds_read_b32 v12, v112
  v_subrev_co_u32 v8, vcc, s72, v8
  s_nop 1
  v_subb_co_u32 v9, vcc, v9, v10, vcc
  v_lshrrev_b32 v10, 24, v8
  v_or_b32 v9, v9, v10
  v_cmp_eq_u32 vcc, 0, v9
  s_nop 1
  v_cndmask_b32 v8, 0, v8, vcc
  s_bcnt1_i32_b32 s56, vcc_lo
  s_nop 0
  v_add_u32_dpp v8, v8, v8 row_ror:8 row_mask:0xf bank_mask:0xf
  s_nop 1
  v_add_u32_dpp v8, v8, v8 row_ror:4 row_mask:0xf bank_mask:0xf
  s_nop 1
  v_add_u32_dpp v8, v8, v8 row_ror:2 row_mask:0xf bank_mask:0xf
  s_nop 1
  v_add_u32_dpp v8, v8, v8 row_ror:1 row_mask:0xf bank_mask:0xf
  s_nop 0
  v_readlane_b32 s54, v8, 0
  v_readlane_b32 s70, v8, 16
  v_subrev_u32 v8, s72, v114
  v_mul_lo_u32 v8, v8, s56
  s_add_u32 s54, s54, s70
  s_max_u32 s56, s56, 1
  v_subrev_u32 v8, s54, v8
  v_cvt_f32_u32 v9, s56
  v_cvt_f32_i32 v8, v8
  v_rcp_f32 v9, v9
  s_nop 0
  v_mul_f32 v8, v8, v9
  v_cvt_i32_f32 v8, v8
  s_waitcnt lgkmcnt(0)
  v_add_u32 v12, 2, v12
  v_min_u32 v9, v113, v12
  v_subrev_u32 v9, s76, v9
  v_max_i32 v9, 0, v9
  v_lshrrev_b32 v9, 1, v9
  v_mul_u32_u24 v9, 28, v9
  v_sub_u32 v8, v8, v9
  v_add_u32 v9, 14, v8
  v_max_i32 v9, 0, v9
  v_min_i32 v9, 2000, v9
  v_mul_u32_u24 v9, 2340, v9
  v_lshrrev_b32 v9, 16, v9
  v_cmp_ne_u32 vcc, 0, v9
  v_lshl_add_u32 v9, v9, 1, v12
  s_nop 0
  v_cndmask_b32 v113, 0, v9, vcc
  ds_write_b32 v112, v113 offset:8
L_h_cpnext:
  s_add_u32 s76, s76, 8
  s_add_u32 s77, s77, 256
  s_branch L_h_cp
L_code_end:
.section .rodata,"a"
.p2align 6
.amdhsa_kernel standalone__kv_cache_quant_int4_int2_kv_with_per_channel_or_per_token_scales__sampling_kernel
  .amdhsa_next_free_vgpr 256
  .amdhsa_next_free_sgpr 102
  .amdhsa_accum_offset 256
  .amdhsa_group_segment_fixed_size 0
  .amdhsa_kernarg_size 80
  .amdhsa_user_sgpr_count 2
  .amdhsa_user_sgpr_kernarg_segment_ptr 1
  .amdhsa_system_sgpr_workgroup_id_x 1
  .amdhsa_float_denorm_mode_32 3
.end_amdhsa_kernel
```

```asm
; @launch grid=(256,1,1) block=(192,1,1) lds=62464
.amdgcn_target "amdgcn-amd-amdhsa--gfx950"
.text
.globl standalone__kv_cache_quant_int4_int2_kv_with_per_channel_or_per_token_scales__sampling_kernel
.p2align 8
.type standalone__kv_cache_quant_int4_int2_kv_with_per_channel_or_per_token_scales__sampling_kernel,@function
standalone__kv_cache_quant_int4_int2_kv_with_per_channel_or_per_token_scales__sampling_kernel:
  s_cmp_ge_u32 s2, 256
  s_cbranch_scc1 L_end
  s_load_dwordx16 s[44:59], s[0:1], 0
  s_load_dwordx4 s[80:83], s[0:1], 64
  v_lshrrev_b32 v1, 6, v0
  v_and_b32 v0, 63, v0
  v_readfirstlane_b32 s3, v1
  s_bfe_u32 s4, s2, 0x10002
  s_lshr_b32 s5, s2, 3
  s_lshl_b32 s5, s5, 2
  s_and_b32 s70, s2, 3
  s_add_u32 s5, s5, s70
  s_lshl_b32 s5, s5, 5
  s_mov_b32 s22, 6291456
  s_mov_b32 s23, 0x20000
  s_mov_b32 s26, 6291456
  s_mov_b32 s27, 0x20000
  s_mov_b32 s30, 2097152
  s_mov_b32 s31, 0x20000
  s_mov_b32 s34, 2097152
  s_mov_b32 s35, 0x20000
  s_mov_b32 s10, 805306368
  s_mov_b32 s11, 0x20000
  s_mov_b32 s38, 393216
  s_mov_b32 s39, 0x20000
  s_mov_b32 s18, 805306368
  s_mov_b32 s19, 0x20000
  s_mov_b32 s14, 805306368
  s_mov_b32 s15, 0x20000
  s_mov_b32 s42, 25165824
  s_mov_b32 s43, 0x20000
  s_cmp_eq_u32 s3, 2
  s_cbranch_scc1 L_helper
  v_and_b32 v108, 3, v0
  v_bfe_u32 v109, v0, 2, 2
  v_lshrrev_b32 v110, 4, v0
  v_and_b32 v111, 15, v0
  v_lshlrev_b32 v144, 4, v108
  v_lshl_add_u32 v144, v110, 6, v144
  v_lshrrev_b32 v233, 1, v144
  v_and_b32 v231, 2, v109
  v_lshlrev_b32 v230, 5, v231
  v_add_u32 v230, 129, v230
  v_and_b32 v145, 1, v109
  v_lshl_add_u32 v231, v145, 2, v231
  v_mul_u32_u24 v145, 33024, v145
  v_add_u32 v232, v144, v145
  v_subrev_u32 v232, 33024, v232
  v_mul_u32_u24 v145, 384, v109
  v_add_u32 v235, v145, v233
  v_mov_b32 v105, 2147483632
  s_mov_b32 s90, 0xaaaaaaab
  s_mov_b32 s91, 0x492492
  s_movk_i32 s63, 768
  s_mov_b32 s64, s3
  s_mov_b32 s99, 8
  s_mov_b32 s96, 0
  v_lshlrev_b32 v114, 4, v0
  s_lshl1_add_u32 s70, s2, s3
  s_mul_i32 s88, s70, 4096
  s_mul_i32 s86, s70, 12288
  s_waitcnt lgkmcnt(0)
  s_mov_b32 s20, s50
  s_and_b32 s21, s51, 0xffff
  s_mov_b32 s24, s52
  s_and_b32 s25, s53, 0xffff
  s_mov_b32 s28, s54
  s_and_b32 s29, s55, 0xffff
  s_mov_b32 s32, s56
  s_and_b32 s33, s57, 0xffff
  buffer_load_dwordx4 v[128:131], v114, s[20:23], s86 offen offset:0
  buffer_load_dwordx4 v[128:131], v114, s[24:27], s86 offen offset:0
  buffer_load_dwordx4 v[128:131], v114, s[28:31], s88 offen offset:0
  buffer_load_dwordx4 v[128:131], v114, s[32:35], s88 offen offset:0
  buffer_load_dwordx4 v[128:131], v114, s[20:23], s86 offen offset:1024
  buffer_load_dwordx4 v[128:131], v114, s[24:27], s86 offen offset:1024
  buffer_load_dwordx4 v[128:131], v114, s[28:31], s88 offen offset:1024
  buffer_load_dwordx4 v[128:131], v114, s[32:35], s88 offen offset:1024
  s_mov_b32 s8, s46
  s_and_b32 s9, s47, 0xffff
  s_mov_b32 s36, s44
  s_and_b32 s37, s45, 0xffff
  s_mov_b32 s16, s46
  s_and_b32 s17, s47, 0xffff
  s_mov_b32 s12, s48
  s_and_b32 s13, s49, 0xffff
  s_mov_b32 s40, s82
  s_and_b32 s41, s83, 0xffff
  s_mov_b64 s[46:47], s[58:59]
  s_mov_b32 s56, 0x0f0f0f0f
  s_mov_b32 s57, 0x0f0f0f0f
  s_mov_b32 s58, 0xffff
  s_mov_b32 s59, 0xffff
  s_lshr_b32 s71, s64, 5
  s_lshr_b32 s85, s96, s71
  s_andn2_b32 s70, s64, 1
  s_or_b32 s70, s70, s4
  s_cmp_lt_u32 s64, 8
  s_cselect_b32 s70, s70, s64
  s_cselect_b32 s85, s64, s85
  s_and_b32 s85, s85, 1
  s_and_b32 s70, s70, 31
  s_lshl_b32 s71, s71, 12
  s_add_u32 s70, s70, s5
  s_add_u32 s70, s70, s71
  s_mul_hi_u32 s84, s70, s90
  s_lshr_b32 s84, s84, 1
  s_mul_i32 s71, s84, 3
  s_sub_u32 s70, s70, s71
  s_lshl3_add_u32 s85, s70, s85
  s_mul_i32 s61, s84, 196608
  s_lshr_b32 s89, s84, 4
  s_lshl_b32 s70, s85, 5
  v_add_u32 v97, s70, v230
  v_mul_u32_u24 v97, 21846, v97
  v_lshrrev_b32 v97, 16, v97
  v_add_u32 v144, s85, v231
  v_lshrrev_b32 v145, v144, s91
  v_and_b32 v145, 1, v145
  v_cmp_eq_u32 s[54:55], 1, v145
  s_nop 1
  s_and_b64 s[52:53], s[54:55], s[56:57]
  s_andn2_b64 s[54:55], s[54:55], s[56:57]
  v_mul_u32_u24 v144, 43, v144
  v_lshrrev_b32 v144, 8, v144
  v_mul_u32_u24 v144, 384, v144
  v_add_u32 v234, v144, v233
  v_mad_u32_u24 v92, v97, s63, v232
  v_add_u32 v93, 768, v92
  v_add_u32 v94, 4608, v92
  v_add_u32 v95, 7680, v92
  v_cndmask_b32 v92, v92, v105, s[52:53]
  v_cndmask_b32 v95, v95, v105, s[54:55]
  s_mov_b32 s60, s61
  s_mul_i32 s70, s89, 1536
  buffer_load_dwordx2 v[174:175], v235, s[36:39], s70 offen offset:0
  buffer_load_dwordx2 v[176:177], v235, s[36:39], s70 offen offset:128
  buffer_load_dwordx2 v[178:179], v235, s[36:39], s70 offen offset:256
  buffer_load_dwordx4 v[4:7], v92, s[8:11], s60 offen offset:0 nt
  buffer_load_dwordx4 v[128:131], v114, s[20:23], s86 offen offset:2048
  buffer_load_dwordx4 v[128:131], v114, s[24:27], s86 offen offset:2048
  buffer_load_dwordx4 v[128:131], v114, s[28:31], s88 offen offset:2048
  buffer_load_dwordx4 v[128:131], v114, s[32:35], s88 offen offset:2048
  buffer_load_dwordx4 v[128:131], v114, s[20:23], s86 offen offset:3072
  buffer_load_dwordx4 v[128:131], v114, s[24:27], s86 offen offset:3072
  buffer_load_dwordx4 v[128:131], v114, s[28:31], s88 offen offset:3072
  buffer_load_dwordx4 v[128:131], v114, s[32:35], s88 offen offset:3072
  s_barrier
  s_mov_b64 vcc, 0
  v_lshlrev_b32 v144, 4, v111
  v_and_b32 v2, 2, v110
  v_lshlrev_b32 v1, 5, v2
  v_add_u32 v1, 129, v1
  v_and_b32 v145, 1, v110
  v_lshl_add_u32 v2, v145, 2, v2
  v_mul_u32_u24 v145, 33024, v145
  v_add_u32 v3, v144, v145
  v_subrev_u32 v3, 33024, v3
  v_and_b32 v145, 1, v110
  v_mul_u32_u24 v145, 86, v145
  v_lshl_add_u32 v96, v111, 1, v145
  v_subrev_u32 v96, 86, v96
  v_lshlrev_b32 v101, 4, v110
  v_lshrrev_b32 v144, 2, v0
  s_mul_i32 s70, s3, 384
  v_lshl_add_u32 v99, v144, 4, s70
  v_lshl_add_u32 v100, v144, 3, s70
  s_mul_i32 s70, s3, 3072
  s_add_u32 s70, s70, 36864
  v_lshl_add_u32 v102, v0, 4, s70
  s_lshl_b32 s70, s3, 5
  s_add_u32 s70, s70, 43008
  v_lshl_add_u32 v103, v109, 3, s70
  s_lshl2_add_u32 s70, s3, 61712
  v_mov_b32 v104, s70
  v_mov_b32 v112, 0
  v_mov_b32 v113, 0
  v_mov_b32 v236, 0xff800000
  v_mov_b32 v146, 1
  s_mov_b32 s65, 0xffff0000
  s_mov_b32 s66, 0x3fb8aa3b
  s_mov_b32 s68, 0x4893cd3a
  s_mov_b32 s92, 0x7f000000
  s_mov_b32 s94, 0x34800000
  s_mov_b32 s44, 0
  s_mov_b32 s69, 0x4893cd3a
  s_mov_b32 s93, 0x7f000000
  s_mov_b32 s95, 0x34800000
  s_mov_b32 s45, 0
  s_mov_b32 s72, 0x11111111
  s_mov_b32 s73, 0x11111111
  s_mov_b32 s74, 0x22222222
  s_mov_b32 s75, 0x22222222
  s_mov_b32 s76, 0x44444444
  s_mov_b32 s77, 0x44444444
  s_mov_b32 s78, 0x88888888
  s_mov_b32 s79, 0x88888888
  s_mov_b32 s100, 0
  s_add_u32 s86, s86, 4096
  s_waitcnt vmcnt(15)
  buffer_load_dwordx4 v[128:131], v114, s[20:23], s86 offen offset:0
  s_waitcnt vmcnt(15)
  buffer_load_dwordx4 v[128:131], v114, s[24:27], s86 offen offset:0
  s_waitcnt vmcnt(15)
  buffer_load_dwordx4 v[128:131], v114, s[20:23], s86 offen offset:1024
  s_waitcnt vmcnt(15)
  buffer_load_dwordx4 v[128:131], v114, s[24:27], s86 offen offset:1024
  s_waitcnt vmcnt(15)
  buffer_load_dwordx4 v[128:131], v114, s[20:23], s86 offen offset:2048
  s_waitcnt vmcnt(15)
  buffer_load_dwordx4 v[128:131], v114, s[24:27], s86 offen offset:2048
  s_waitcnt vmcnt(15)
  buffer_load_dwordx4 v[128:131], v114, s[20:23], s86 offen offset:3072
  s_waitcnt vmcnt(15)
  buffer_load_dwordx4 v[128:131], v114, s[24:27], s86 offen offset:3072
  s_add_u32 s86, s86, 4096
  s_waitcnt vmcnt(15)
  buffer_load_dwordx4 v[128:131], v114, s[20:23], s86 offen offset:0
  s_waitcnt vmcnt(15)
  buffer_load_dwordx4 v[128:131], v114, s[24:27], s86 offen offset:0
  s_waitcnt vmcnt(15)
  buffer_load_dwordx4 v[128:131], v114, s[20:23], s86 offen offset:1024
  s_waitcnt vmcnt(15)
  buffer_load_dwordx4 v[128:131], v114, s[24:27], s86 offen offset:1024
  s_waitcnt vmcnt(15)
  buffer_load_dwordx4 v[128:131], v114, s[20:23], s86 offen offset:2048
  s_waitcnt vmcnt(15)
  buffer_load_dwordx4 v[128:131], v114, s[24:27], s86 offen offset:2048
  s_waitcnt vmcnt(15)
  buffer_load_dwordx4 v[128:131], v114, s[20:23], s86 offen offset:3072
  s_waitcnt vmcnt(15)
  buffer_load_dwordx4 v[128:131], v114, s[24:27], s86 offen offset:3072
  s_mov_b32 s88, s89
  s_mul_i32 s62, s84, 1536
  buffer_load_dwordx2 v[180:181], v234, s[20:23], s62 offen offset:0
  buffer_load_dwordx2 v[186:187], v234, s[24:27], s62 offen offset:0
  buffer_load_dwordx2 v[182:183], v234, s[20:23], s62 offen offset:128
  buffer_load_dwordx2 v[188:189], v234, s[24:27], s62 offen offset:128
  buffer_load_dwordx2 v[184:185], v234, s[20:23], s62 offen offset:256
  buffer_load_dwordx2 v[190:191], v234, s[24:27], s62 offen offset:256
  s_waitcnt vmcnt(15)
  buffer_load_dwordx4 v[8:11], v92, s[8:11], s60 offen offset:256 nt
  s_waitcnt vmcnt(15)
  buffer_load_dwordx4 v[12:15], v92, s[8:11], s60 offen offset:512 nt
  s_waitcnt vmcnt(15)
  buffer_load_dwordx4 v[16:19], v93, s[8:11], s60 offen offset:0 nt
  s_waitcnt vmcnt(15)
  buffer_load_dwordx4 v[20:23], v93, s[8:11], s60 offen offset:256 nt
  s_waitcnt vmcnt(15)
  buffer_load_dwordx4 v[24:27], v93, s[8:11], s60 offen offset:512 nt
  s_waitcnt vmcnt(15)
  buffer_load_dwordx4 v[28:31], v93, s[8:11], s60 offen offset:768 nt
  s_waitcnt vmcnt(15)
  buffer_load_dwordx4 v[32:35], v93, s[8:11], s60 offen offset:1024 nt
  s_waitcnt vmcnt(15)
  buffer_load_dwordx4 v[36:39], v93, s[8:11], s60 offen offset:1280 nt
  s_waitcnt vmcnt(15)
  buffer_load_dwordx4 v[40:43], v93, s[8:11], s60 offen offset:1536 nt
  s_waitcnt vmcnt(15)
  buffer_load_dwordx4 v[44:47], v93, s[8:11], s60 offen offset:1792 nt
  s_waitcnt vmcnt(16)
  buffer_load_dwordx4 v[48:51], v93, s[8:11], s60 offen offset:2048 nt
  s_waitcnt vmcnt(17)
  buffer_load_dwordx4 v[52:55], v93, s[8:11], s60 offen offset:2304 nt
  s_waitcnt vmcnt(18)
  buffer_load_dwordx4 v[56:59], v93, s[8:11], s60 offen offset:2560 nt
  s_waitcnt vmcnt(19)
  buffer_load_dwordx4 v[60:63], v93, s[8:11], s60 offen offset:2816 nt
  s_waitcnt vmcnt(14)
  ds_write_b32 v104, v146
L_k:
  v_add_u32 v144, s85, v2
  v_lshrrev_b32 v145, v144, s91
  v_and_b32 v145, 1, v145
  v_cmp_eq_u32 s[50:51], 1, v145
  s_nop 1
  s_and_b64 s[48:49], s[50:51], s[58:59]
  s_andn2_b64 s[50:51], s[50:51], s[58:59]
  s_mov_b32 s97, s64
  s_add_u32 s64, s64, 2
  ds_read_b32 v106, v104 offset:8
  s_waitcnt vmcnt(14)
  s_cbranch_vccnz L_kw0_0
  s_waitcnt vmcnt(9)
L_kw0_0:
  buffer_load_dwordx4 v[64:67], v93, s[8:11], s60 offen offset:3072 nt
  v_lshlrev_b32 v204, 16, v186
  v_and_b32 v205, s65, v186
  v_lshlrev_b32 v206, 16, v187
  v_and_b32 v207, s65, v187
  v_lshlrev_b32 v192, 16, v180
  v_and_b32 v193, s65, v180
  v_lshlrev_b32 v194, 16, v181
  v_and_b32 v195, s65, v181
  v_pk_mul_f32 v[204:205], v[204:205], s[94:95]
  v_mov_b32 v168, v174
  v_pk_mul_f32 v[206:207], v[206:207], s[94:95]
  v_mov_b32 v169, v175
  v_pk_fma_f32 v[108:109], v[4:5], s[92:93], v[204:205] neg_lo:[0,0,1] neg_hi:[0,0,1]
  v_pk_fma_f32 v[110:111], v[6:7], s[92:93], v[206:207] neg_lo:[0,0,1] neg_hi:[0,0,1]
  v_cvt_pk_bf16_f32 v108, 0, v108
  v_cvt_pk_bf16_f32 v109, 0, v109
  v_cvt_pk_bf16_f32 v110, 0, v110
  v_cvt_pk_bf16_f32 v111, 0, v111
  v_pk_mul_f32 v[108:109], v[108:109], v[192:193]
  v_pk_mul_f32 v[110:111], v[110:111], v[194:195]
  v_cvt_pk_bf16_f32 v216, v108, v109
  v_cvt_pk_bf16_f32 v217, v110, v111
  s_waitcnt lgkmcnt(0)
  v_cmp_lt_u32 vcc, s97, v106
  s_waitcnt vmcnt(14)
  buffer_load_dwordx4 v[68:71], v93, s[8:11], s60 offen offset:3328 nt
  v_lshlrev_b32 v208, 16, v188
  v_and_b32 v209, s65, v188
  v_lshlrev_b32 v210, 16, v189
  v_and_b32 v211, s65, v189
  v_lshlrev_b32 v196, 16, v182
  v_and_b32 v197, s65, v182
  v_lshlrev_b32 v198, 16, v183
  v_and_b32 v199, s65, v183
  v_pk_mul_f32 v[208:209], v[208:209], s[94:95]
  v_mov_b32 v170, v176
  v_pk_mul_f32 v[210:211], v[210:211], s[94:95]
  v_mov_b32 v171, v177
  v_pk_fma_f32 v[108:109], v[8:9], s[92:93], v[208:209] neg_lo:[0,0,1] neg_hi:[0,0,1]
  v_pk_fma_f32 v[110:111], v[10:11], s[92:93], v[210:211] neg_lo:[0,0,1] neg_hi:[0,0,1]
  v_cvt_pk_bf16_f32 v108, 0, v108
  v_cvt_pk_bf16_f32 v109, 0, v109
  v_cvt_pk_bf16_f32 v110, 0, v110
  v_cvt_pk_bf16_f32 v111, 0, v111
  v_pk_mul_f32 v[108:109], v[108:109], v[196:197]
  v_pk_mul_f32 v[110:111], v[110:111], v[198:199]
  v_cvt_pk_bf16_f32 v218, v108, v109
  v_cvt_pk_bf16_f32 v219, v110, v111
  s_waitcnt vmcnt(14)
  buffer_load_dwordx4 v[72:75], v93, s[8:11], s60 offen offset:3584 nt
  v_mfma_f32_16x16x32_bf16 v[224:227], v[216:219], v[168:171], 0
  v_lshlrev_b32 v212, 16, v190
  v_and_b32 v213, s65, v190
  v_lshlrev_b32 v214, 16, v191
  v_and_b32 v215, s65, v191
  v_lshlrev_b32 v200, 16, v184
  v_and_b32 v201, s65, v184
  v_lshlrev_b32 v202, 16, v185
  v_and_b32 v203, s65, v185
  v_pk_mul_f32 v[212:213], v[212:213], s[94:95]
  v_mov_b32 v172, v178
  v_pk_mul_f32 v[214:215], v[214:215], s[94:95]
  v_mov_b32 v173, v179
  v_pk_fma_f32 v[108:109], v[12:13], s[92:93], v[212:213] neg_lo:[0,0,1] neg_hi:[0,0,1]
  v_pk_fma_f32 v[110:111], v[14:15], s[92:93], v[214:215] neg_lo:[0,0,1] neg_hi:[0,0,1]
  v_cvt_pk_bf16_f32 v108, 0, v108
  v_cvt_pk_bf16_f32 v109, 0, v109
  v_cvt_pk_bf16_f32 v110, 0, v110
  v_cvt_pk_bf16_f32 v111, 0, v111
  v_pk_mul_f32 v[108:109], v[108:109], v[200:201]
  v_pk_mul_f32 v[110:111], v[110:111], v[202:203]
  v_cvt_pk_bf16_f32 v220, v108, v109
  v_cvt_pk_bf16_f32 v221, v110, v111
  s_waitcnt vmcnt(14)
  s_cbranch_vccnz L_kw0_3
  s_waitcnt vmcnt(9)
L_kw0_3:
  buffer_load_dwordx4 v[76:79], v94, s[8:11], s60 offen offset:0 nt
  v_mfma_f32_16x16x16_bf16 v[224:227], v[220:221], v[172:173], v[224:227]
  v_pk_fma_f32 v[108:109], v[16:17], s[92:93], v[204:205] neg_lo:[0,0,1] neg_hi:[0,0,1]
  v_pk_fma_f32 v[110:111], v[18:19], s[92:93], v[206:207] neg_lo:[0,0,1] neg_hi:[0,0,1]
  v_cvt_pk_bf16_f32 v108, 0, v108
  v_cvt_pk_bf16_f32 v109, 0, v109
  v_cvt_pk_bf16_f32 v110, 0, v110
  v_cvt_pk_bf16_f32 v111, 0, v111
  v_pk_mul_f32 v[108:109], v[108:109], v[192:193]
  v_pk_mul_f32 v[110:111], v[110:111], v[194:195]
  v_cvt_pk_bf16_f32 v216, v108, v109
  v_cvt_pk_bf16_f32 v217, v110, v111
  s_waitcnt vmcnt(14)
  buffer_load_dwordx4 v[80:83], v94, s[8:11], s60 offen offset:256 nt
  v_pk_fma_f32 v[108:109], v[20:21], s[92:93], v[208:209] neg_lo:[0,0,1] neg_hi:[0,0,1]
  v_pk_fma_f32 v[110:111], v[22:23], s[92:93], v[210:211] neg_lo:[0,0,1] neg_hi:[0,0,1]
  v_mov_b32_dpp v144, v224 quad_perm:[0,0,0,0] row_mask:0xf bank_mask:0xf
  v_mov_b32_dpp v145, v226 quad_perm:[2,2,2,2] row_mask:0xf bank_mask:0xf
  v_cvt_pk_bf16_f32 v108, 0, v108
  v_cvt_pk_bf16_f32 v109, 0, v109
  v_add_f32_dpp v144, v225, v144 quad_perm:[1,1,1,1] row_mask:0xf bank_mask:0xf
  v_add_f32_dpp v145, v227, v145 quad_perm:[3,3,3,3] row_mask:0xf bank_mask:0xf
  v_cvt_pk_bf16_f32 v110, 0, v110
  v_cvt_pk_bf16_f32 v111, 0, v111
  v_add_f32 v228, v144, v145
  v_pk_mul_f32 v[108:109], v[108:109], v[196:197]
  v_pk_mul_f32 v[110:111], v[110:111], v[198:199]
  v_cvt_pk_bf16_f32 v218, v108, v109
  v_cvt_pk_bf16_f32 v219, v110, v111
  s_waitcnt vmcnt(14)
  buffer_load_dwordx4 v[84:87], v94, s[8:11], s60 offen offset:512 nt
  v_mfma_f32_16x16x32_bf16 v[224:227], v[216:219], v[168:171], 0
  v_pk_fma_f32 v[108:109], v[24:25], s[92:93], v[212:213] neg_lo:[0,0,1] neg_hi:[0,0,1]
  v_pk_fma_f32 v[110:111], v[26:27], s[92:93], v[214:215] neg_lo:[0,0,1] neg_hi:[0,0,1]
  v_cvt_pk_bf16_f32 v108, 0, v108
  v_cndmask_b32 v228, v228, v236, s[48:49]
  v_cvt_pk_bf16_f32 v109, 0, v109
  v_cvt_pk_bf16_f32 v110, 0, v110
  v_cvt_pk_bf16_f32 v111, 0, v111
  v_pk_mul_f32 v[108:109], v[108:109], v[200:201]
  v_pk_mul_f32 v[110:111], v[110:111], v[202:203]
  v_cvt_pk_bf16_f32 v220, v108, v109
  v_cvt_pk_bf16_f32 v221, v110, v111
  s_waitcnt vmcnt(14)
  s_cbranch_vccnz L_kw0_6
  s_waitcnt vmcnt(9)
L_kw0_6:
  buffer_load_dwordx4 v[88:91], v94, s[8:11], s60 offen offset:768 nt
  v_mfma_f32_16x16x16_bf16 v[224:227], v[220:221], v[172:173], v[224:227]
  v_pk_fma_f32 v[108:109], v[28:29], s[92:93], v[204:205] neg_lo:[0,0,1] neg_hi:[0,0,1]
  v_pk_fma_f32 v[110:111], v[30:31], s[92:93], v[206:207] neg_lo:[0,0,1] neg_hi:[0,0,1]
  v_cvt_pk_bf16_f32 v108, 0, v108
  v_cvt_pk_bf16_f32 v109, 0, v109
  v_cvt_pk_bf16_f32 v110, 0, v110
  v_cvt_pk_bf16_f32 v111, 0, v111
  v_pk_mul_f32 v[108:109], v[108:109], v[192:193]
  v_pk_mul_f32 v[110:111], v[110:111], v[194:195]
  v_cvt_pk_bf16_f32 v216, v108, v109
  v_cvt_pk_bf16_f32 v217, v110, v111
  s_waitcnt vmcnt(14)
  buffer_load_dwordx4 v[4:7], v94, s[8:11], s60 offen offset:1024 nt
  v_pk_fma_f32 v[108:109], v[32:33], s[92:93], v[208:209] neg_lo:[0,0,1] neg_hi:[0,0,1]
  v_pk_fma_f32 v[110:111], v[34:35], s[92:93], v[210:211] neg_lo:[0,0,1] neg_hi:[0,0,1]
  v_mov_b32_dpp v144, v224 quad_perm:[0,0,0,0] row_mask:0xf bank_mask:0xf
  v_mov_b32_dpp v145, v226 quad_perm:[2,2,2,2] row_mask:0xf bank_mask:0xf
  v_cvt_pk_bf16_f32 v108, 0, v108
  v_cvt_pk_bf16_f32 v109, 0, v109
  v_add_f32_dpp v144, v225, v144 quad_perm:[1,1,1,1] row_mask:0xf bank_mask:0xf
  v_add_f32_dpp v145, v227, v145 quad_perm:[3,3,3,3] row_mask:0xf bank_mask:0xf
  v_cvt_pk_bf16_f32 v110, 0, v110
  v_cvt_pk_bf16_f32 v111, 0, v111
  v_add_f32 v229, v144, v145
  v_pk_mul_f32 v[108:109], v[108:109], v[196:197]
  v_pk_mul_f32 v[110:111], v[110:111], v[198:199]
  v_cvt_pk_bf16_f32 v218, v108, v109
  v_cvt_pk_bf16_f32 v219, v110, v111
  s_waitcnt vmcnt(14)
  buffer_load_dwordx4 v[8:11], v94, s[8:11], s60 offen offset:1280 nt
  v_mfma_f32_16x16x32_bf16 v[224:227], v[216:219], v[168:171], 0
  v_pk_fma_f32 v[108:109], v[36:37], s[92:93], v[212:213] neg_lo:[0,0,1] neg_hi:[0,0,1]
  v_pk_fma_f32 v[110:111], v[38:39], s[92:93], v[214:215] neg_lo:[0,0,1] neg_hi:[0,0,1]
  v_cvt_pk_bf16_f32 v108, 0, v108
  v_cvt_pk_bf16_f32 v228, 0, v228
  v_cvt_pk_bf16_f32 v109, 0, v109
  v_cvt_pk_bf16_f32 v229, 0, v229
  v_cvt_pk_bf16_f32 v110, 0, v110
  v_pk_mul_f32 v[228:229], v[228:229], s[68:69]
  v_cvt_pk_bf16_f32 v111, 0, v111
  v_cvt_pk_bf16_f32 v120, v228, v229
  v_pk_mul_f32 v[108:109], v[108:109], v[200:201]
  v_pk_mul_f32 v[110:111], v[110:111], v[202:203]
  v_cvt_pk_bf16_f32 v220, v108, v109
  v_cvt_pk_bf16_f32 v221, v110, v111
  s_waitcnt vmcnt(14)
  s_cbranch_vccnz L_kw0_9
  s_waitcnt vmcnt(9)
L_kw0_9:
  buffer_load_dwordx4 v[12:15], v94, s[8:11], s60 offen offset:1536 nt
  v_mfma_f32_16x16x16_bf16 v[224:227], v[220:221], v[172:173], v[224:227]
  v_pk_fma_f32 v[108:109], v[40:41], s[92:93], v[204:205] neg_lo:[0,0,1] neg_hi:[0,0,1]
  v_pk_fma_f32 v[110:111], v[42:43], s[92:93], v[206:207] neg_lo:[0,0,1] neg_hi:[0,0,1]
  v_cvt_pk_bf16_f32 v108, 0, v108
  v_cvt_pk_bf16_f32 v109, 0, v109
  v_cvt_pk_bf16_f32 v110, 0, v110
  v_cvt_pk_bf16_f32 v111, 0, v111
  v_pk_mul_f32 v[108:109], v[108:109], v[192:193]
  v_pk_mul_f32 v[110:111], v[110:111], v[194:195]
  v_cvt_pk_bf16_f32 v216, v108, v109
  v_cvt_pk_bf16_f32 v217, v110, v111
  s_waitcnt vmcnt(14)
  buffer_load_dwordx4 v[16:19], v94, s[8:11], s60 offen offset:1792 nt
  v_pk_fma_f32 v[108:109], v[44:45], s[92:93], v[208:209] neg_lo:[0,0,1] neg_hi:[0,0,1]
  v_pk_fma_f32 v[110:111], v[46:47], s[92:93], v[210:211] neg_lo:[0,0,1] neg_hi:[0,0,1]
  v_mov_b32_dpp v144, v224 quad_perm:[0,0,0,0] row_mask:0xf bank_mask:0xf
  v_mov_b32_dpp v145, v226 quad_perm:[2,2,2,2] row_mask:0xf bank_mask:0xf
  v_cvt_pk_bf16_f32 v108, 0, v108
  v_cvt_pk_bf16_f32 v109, 0, v109
  v_add_f32_dpp v144, v225, v144 quad_perm:[1,1,1,1] row_mask:0xf bank_mask:0xf
  v_add_f32_dpp v145, v227, v145 quad_perm:[3,3,3,3] row_mask:0xf bank_mask:0xf
  v_cvt_pk_bf16_f32 v110, 0, v110
  v_cvt_pk_bf16_f32 v111, 0, v111
  v_add_f32 v228, v144, v145
  v_pk_mul_f32 v[108:109], v[108:109], v[196:197]
  v_pk_mul_f32 v[110:111], v[110:111], v[198:199]
  v_cvt_pk_bf16_f32 v218, v108, v109
  v_cvt_pk_bf16_f32 v219, v110, v111
  s_waitcnt vmcnt(14)
  buffer_load_dwordx4 v[20:23], v94, s[8:11], s60 offen offset:2048 nt
  v_mfma_f32_16x16x32_bf16 v[224:227], v[216:219], v[168:171], 0
  v_pk_fma_f32 v[108:109], v[48:49], s[92:93], v[212:213] neg_lo:[0,0,1] neg_hi:[0,0,1]
  v_pk_fma_f32 v[110:111], v[50:51], s[92:93], v[214:215] neg_lo:[0,0,1] neg_hi:[0,0,1]
  v_cvt_pk_bf16_f32 v108, 0, v108
  v_cvt_pk_bf16_f32 v109, 0, v109
  v_cvt_pk_bf16_f32 v110, 0, v110
  v_cvt_pk_bf16_f32 v111, 0, v111
  v_pk_mul_f32 v[108:109], v[108:109], v[200:201]
  v_pk_mul_f32 v[110:111], v[110:111], v[202:203]
  v_cvt_pk_bf16_f32 v220, v108, v109
  v_cvt_pk_bf16_f32 v221, v110, v111
  s_waitcnt vmcnt(14)
  s_cbranch_vccnz L_kw0_12
  s_waitcnt vmcnt(9)
L_kw0_12:
  buffer_load_dwordx4 v[24:27], v94, s[8:11], s60 offen offset:2304 nt
  v_mfma_f32_16x16x16_bf16 v[224:227], v[220:221], v[172:173], v[224:227]
  v_pk_fma_f32 v[108:109], v[52:53], s[92:93], v[204:205] neg_lo:[0,0,1] neg_hi:[0,0,1]
  v_pk_fma_f32 v[110:111], v[54:55], s[92:93], v[206:207] neg_lo:[0,0,1] neg_hi:[0,0,1]
  v_cvt_pk_bf16_f32 v108, 0, v108
  v_cvt_pk_bf16_f32 v109, 0, v109
  v_cvt_pk_bf16_f32 v110, 0, v110
  v_cvt_pk_bf16_f32 v111, 0, v111
  v_pk_mul_f32 v[108:109], v[108:109], v[192:193]
  v_pk_mul_f32 v[110:111], v[110:111], v[194:195]
  v_cvt_pk_bf16_f32 v216, v108, v109
  v_cvt_pk_bf16_f32 v217, v110, v111
  s_waitcnt vmcnt(14)
  buffer_load_dwordx4 v[28:31], v94, s[8:11], s60 offen offset:2560 nt
  v_pk_fma_f32 v[108:109], v[56:57], s[92:93], v[208:209] neg_lo:[0,0,1] neg_hi:[0,0,1]
  v_pk_fma_f32 v[110:111], v[58:59], s[92:93], v[210:211] neg_lo:[0,0,1] neg_hi:[0,0,1]
  v_mov_b32_dpp v144, v224 quad_perm:[0,0,0,0] row_mask:0xf bank_mask:0xf
  v_mov_b32_dpp v145, v226 quad_perm:[2,2,2,2] row_mask:0xf bank_mask:0xf
  v_cvt_pk_bf16_f32 v108, 0, v108
  v_cvt_pk_bf16_f32 v109, 0, v109
  v_add_f32_dpp v144, v225, v144 quad_perm:[1,1,1,1] row_mask:0xf bank_mask:0xf
  v_add_f32_dpp v145, v227, v145 quad_perm:[3,3,3,3] row_mask:0xf bank_mask:0xf
  v_cvt_pk_bf16_f32 v110, 0, v110
  v_cvt_pk_bf16_f32 v111, 0, v111
  v_add_f32 v229, v144, v145
  v_pk_mul_f32 v[108:109], v[108:109], v[196:197]
  v_pk_mul_f32 v[110:111], v[110:111], v[198:199]
  v_cvt_pk_bf16_f32 v218, v108, v109
  v_cvt_pk_bf16_f32 v219, v110, v111
  s_waitcnt vmcnt(14)
  buffer_load_dwordx4 v[32:35], v94, s[8:11], s60 offen offset:2816 nt
  v_mfma_f32_16x16x32_bf16 v[224:227], v[216:219], v[168:171], 0
  v_pk_fma_f32 v[108:109], v[60:61], s[92:93], v[212:213] neg_lo:[0,0,1] neg_hi:[0,0,1]
  v_pk_fma_f32 v[110:111], v[62:63], s[92:93], v[214:215] neg_lo:[0,0,1] neg_hi:[0,0,1]
  v_cvt_pk_bf16_f32 v108, 0, v108
  v_cvt_pk_bf16_f32 v228, 0, v228
  v_cvt_pk_bf16_f32 v109, 0, v109
  v_cvt_pk_bf16_f32 v229, 0, v229
  v_cvt_pk_bf16_f32 v110, 0, v110
  v_pk_mul_f32 v[228:229], v[228:229], s[68:69]
  v_cvt_pk_bf16_f32 v111, 0, v111
  v_cvt_pk_bf16_f32 v121, v228, v229
  v_pk_mul_f32 v[108:109], v[108:109], v[200:201]
  v_pk_mul_f32 v[110:111], v[110:111], v[202:203]
  v_cvt_pk_bf16_f32 v220, v108, v109
  v_cvt_pk_bf16_f32 v221, v110, v111
  s_waitcnt vmcnt(14)
  s_cbranch_vccnz L_kw0_15
  s_waitcnt vmcnt(9)
L_kw0_15:
  buffer_load_dwordx4 v[36:39], v95, s[8:11], s60 offen offset:0 nt
  v_mfma_f32_16x16x16_bf16 v[224:227], v[220:221], v[172:173], v[224:227]
  v_pk_fma_f32 v[108:109], v[64:65], s[92:93], v[204:205] neg_lo:[0,0,1] neg_hi:[0,0,1]
  v_pk_fma_f32 v[110:111], v[66:67], s[92:93], v[206:207] neg_lo:[0,0,1] neg_hi:[0,0,1]
  v_cvt_pk_bf16_f32 v108, 0, v108
  v_cvt_pk_bf16_f32 v109, 0, v109
  v_cvt_pk_bf16_f32 v110, 0, v110
  v_cvt_pk_bf16_f32 v111, 0, v111
  v_pk_mul_f32 v[108:109], v[108:109], v[192:193]
  v_pk_mul_f32 v[110:111], v[110:111], v[194:195]
  v_cvt_pk_bf16_f32 v216, v108, v109
  v_cvt_pk_bf16_f32 v217, v110, v111
  s_waitcnt vmcnt(14)
  buffer_load_dwordx4 v[40:43], v95, s[8:11], s60 offen offset:256 nt
  v_pk_fma_f32 v[108:109], v[68:69], s[92:93], v[208:209] neg_lo:[0,0,1] neg_hi:[0,0,1]
  v_pk_fma_f32 v[110:111], v[70:71], s[92:93], v[210:211] neg_lo:[0,0,1] neg_hi:[0,0,1]
  v_mov_b32_dpp v144, v224 quad_perm:[0,0,0,0] row_mask:0xf bank_mask:0xf
  v_mov_b32_dpp v145, v226 quad_perm:[2,2,2,2] row_mask:0xf bank_mask:0xf
  v_cvt_pk_bf16_f32 v108, 0, v108
  v_cvt_pk_bf16_f32 v109, 0, v109
  v_add_f32_dpp v144, v225, v144 quad_perm:[1,1,1,1] row_mask:0xf bank_mask:0xf
  v_add_f32_dpp v145, v227, v145 quad_perm:[3,3,3,3] row_mask:0xf bank_mask:0xf
  v_cvt_pk_bf16_f32 v110, 0, v110
  v_cvt_pk_bf16_f32 v111, 0, v111
  v_add_f32 v228, v144, v145
  v_pk_mul_f32 v[108:109], v[108:109], v[196:197]
  v_pk_mul_f32 v[110:111], v[110:111], v[198:199]
  v_cvt_pk_bf16_f32 v218, v108, v109
  v_cvt_pk_bf16_f32 v219, v110, v111
  s_waitcnt vmcnt(14)
  buffer_load_dwordx4 v[44:47], v95, s[8:11], s60 offen offset:512 nt
  v_mfma_f32_16x16x32_bf16 v[224:227], v[216:219], v[168:171], 0
  v_pk_fma_f32 v[108:109], v[72:73], s[92:93], v[212:213] neg_lo:[0,0,1] neg_hi:[0,0,1]
  v_pk_fma_f32 v[110:111], v[74:75], s[92:93], v[214:215] neg_lo:[0,0,1] neg_hi:[0,0,1]
  s_cmp_lt_u32 s64, s99
  s_cbranch_scc1 L_k_known0
L_k_spin0:
  v_mov_b32 v144, 61696
  ds_read_b32 v144, v144
  s_waitcnt lgkmcnt(0)
  v_readfirstlane_b32 s96, v144
  s_nop 1
  s_cmp_eq_u32 s96, 0
  s_cbranch_scc1 L_k_spin0
  s_mov_b32 s99, -1
L_k_known0:
  s_lshr_b32 s71, s64, 5
  s_lshr_b32 s85, s96, s71
  s_andn2_b32 s70, s64, 1
  s_or_b32 s70, s70, s4
  s_cmp_lt_u32 s64, 8
  s_cselect_b32 s70, s70, s64
  s_cselect_b32 s85, s64, s85
  s_and_b32 s85, s85, 1
  s_and_b32 s70, s70, 31
  s_lshl_b32 s71, s71, 12
  s_add_u32 s70, s70, s5
  s_add_u32 s70, s70, s71
  s_mul_hi_u32 s84, s70, s90
  s_lshr_b32 s84, s84, 1
  s_mul_i32 s71, s84, 3
  s_sub_u32 s70, s70, s71
  s_lshl3_add_u32 s85, s70, s85
  s_mul_i32 s61, s84, 196608
  s_lshr_b32 s89, s84, 4
  s_lshl_b32 s70, s85, 5
  v_add_u32 v97, s70, v230
  v_mul_u32_u24 v97, 21846, v97
  v_lshrrev_b32 v97, 16, v97
  v_add_u32 v144, s85, v231
  v_lshrrev_b32 v145, v144, s91
  v_and_b32 v145, 1, v145
  v_cmp_eq_u32 s[54:55], 1, v145
  s_nop 1
  s_and_b64 s[52:53], s[54:55], s[56:57]
  s_andn2_b64 s[54:55], s[54:55], s[56:57]
  v_mul_u32_u24 v144, 43, v144
  v_lshrrev_b32 v144, 8, v144
  v_mul_u32_u24 v144, 384, v144
  v_add_u32 v234, v144, v233
  s_cmp_eq_u32 s89, s88
  s_cbranch_scc1 L_k_sameq0
  s_mul_i32 s70, s89, 1536
  buffer_load_dwordx2 v[174:175], v235, s[36:39], s70 offen offset:0
  buffer_load_dwordx2 v[176:177], v235, s[36:39], s70 offen offset:128
  buffer_load_dwordx2 v[178:179], v235, s[36:39], s70 offen offset:256
  s_mov_b32 s88, s89
L_k_sameq0:
  s_mul_i32 s62, s84, 1536
  buffer_load_dwordx2 v[180:181], v234, s[20:23], s62 offen offset:0
  buffer_load_dwordx2 v[186:187], v234, s[24:27], s62 offen offset:0
  buffer_load_dwordx2 v[182:183], v234, s[20:23], s62 offen offset:128
  buffer_load_dwordx2 v[188:189], v234, s[24:27], s62 offen offset:128
  buffer_load_dwordx2 v[184:185], v234, s[20:23], s62 offen offset:256
  buffer_load_dwordx2 v[190:191], v234, s[24:27], s62 offen offset:256
  v_cvt_pk_bf16_f32 v108, 0, v108
  v_cvt_pk_bf16_f32 v109, 0, v109
  v_cvt_pk_bf16_f32 v110, 0, v110
  v_cvt_pk_bf16_f32 v111, 0, v111
  v_pk_mul_f32 v[108:109], v[108:109], v[200:201]
  v_pk_mul_f32 v[110:111], v[110:111], v[202:203]
  v_cvt_pk_bf16_f32 v220, v108, v109
  v_cvt_pk_bf16_f32 v221, v110, v111
  v_mad_u32_u24 v92, v97, s63, v232
  v_add_u32 v93, 768, v92
  v_add_u32 v94, 4608, v92
  v_add_u32 v95, 7680, v92
  v_cndmask_b32 v92, v92, v105, s[52:53]
  v_cndmask_b32 v95, v95, v105, s[54:55]
  s_waitcnt vmcnt(20)
  s_cbranch_vccnz L_kw0_18
  s_waitcnt vmcnt(15)
L_kw0_18:
  buffer_load_dwordx4 v[48:51], v92, s[16:19], s61 offen offset:0 nt
  v_mfma_f32_16x16x16_bf16 v[224:227], v[220:221], v[172:173], v[224:227]
  v_pk_fma_f32 v[108:109], v[76:77], s[92:93], v[204:205] neg_lo:[0,0,1] neg_hi:[0,0,1]
  v_pk_fma_f32 v[110:111], v[78:79], s[92:93], v[206:207] neg_lo:[0,0,1] neg_hi:[0,0,1]
  v_cvt_pk_bf16_f32 v108, 0, v108
  v_cvt_pk_bf16_f32 v109, 0, v109
  v_cvt_pk_bf16_f32 v110, 0, v110
  v_cvt_pk_bf16_f32 v111, 0, v111
  v_pk_mul_f32 v[108:109], v[108:109], v[192:193]
  v_pk_mul_f32 v[110:111], v[110:111], v[194:195]
  v_cvt_pk_bf16_f32 v216, v108, v109
  v_cvt_pk_bf16_f32 v217, v110, v111
  s_waitcnt vmcnt(20)
  buffer_load_dwordx4 v[52:55], v92, s[16:19], s61 offen offset:256 nt
  v_pk_fma_f32 v[108:109], v[80:81], s[92:93], v[208:209] neg_lo:[0,0,1] neg_hi:[0,0,1]
  v_pk_fma_f32 v[110:111], v[82:83], s[92:93], v[210:211] neg_lo:[0,0,1] neg_hi:[0,0,1]
  v_mov_b32_dpp v144, v224 quad_perm:[0,0,0,0] row_mask:0xf bank_mask:0xf
  v_mov_b32_dpp v145, v226 quad_perm:[2,2,2,2] row_mask:0xf bank_mask:0xf
  v_cvt_pk_bf16_f32 v108, 0, v108
  v_cvt_pk_bf16_f32 v109, 0, v109
  v_add_f32_dpp v144, v225, v144 quad_perm:[1,1,1,1] row_mask:0xf bank_mask:0xf
  v_add_f32_dpp v145, v227, v145 quad_perm:[3,3,3,3] row_mask:0xf bank_mask:0xf
  v_cvt_pk_bf16_f32 v110, 0, v110
  v_cvt_pk_bf16_f32 v111, 0, v111
  v_add_f32 v229, v144, v145
  v_pk_mul_f32 v[108:109], v[108:109], v[196:197]
  v_pk_mul_f32 v[110:111], v[110:111], v[198:199]
  v_cvt_pk_bf16_f32 v218, v108, v109
  v_cvt_pk_bf16_f32 v219, v110, v111
  s_waitcnt vmcnt(20)
  buffer_load_dwordx4 v[56:59], v92, s[16:19], s61 offen offset:512 nt
  v_mfma_f32_16x16x32_bf16 v[224:227], v[216:219], v[168:171], 0
  v_pk_fma_f32 v[108:109], v[84:85], s[92:93], v[212:213] neg_lo:[0,0,1] neg_hi:[0,0,1]
  v_pk_fma_f32 v[110:111], v[86:87], s[92:93], v[214:215] neg_lo:[0,0,1] neg_hi:[0,0,1]
  v_cvt_pk_bf16_f32 v108, 0, v108
  v_cvt_pk_bf16_f32 v228, 0, v228
  v_cvt_pk_bf16_f32 v109, 0, v109
  v_cvt_pk_bf16_f32 v229, 0, v229
  v_cvt_pk_bf16_f32 v110, 0, v110
  v_pk_mul_f32 v[228:229], v[228:229], s[68:69]
  v_cvt_pk_bf16_f32 v111, 0, v111
  v_cvt_pk_bf16_f32 v122, v228, v229
  v_pk_mul_f32 v[108:109], v[108:109], v[200:201]
  v_pk_mul_f32 v[110:111], v[110:111], v[202:203]
  v_cvt_pk_bf16_f32 v220, v108, v109
  v_cvt_pk_bf16_f32 v221, v110, v111
  s_waitcnt vmcnt(20)
  s_cbranch_vccnz L_kw0_21
  s_waitcnt vmcnt(15)
L_kw0_21:
  buffer_load_dwordx4 v[60:63], v93, s[16:19], s61 offen offset:0 nt
  v_mfma_f32_16x16x16_bf16 v[224:227], v[220:221], v[172:173], v[224:227]
  v_pk_fma_f32 v[108:109], v[88:89], s[92:93], v[204:205] neg_lo:[0,0,1] neg_hi:[0,0,1]
  v_pk_fma_f32 v[110:111], v[90:91], s[92:93], v[206:207] neg_lo:[0,0,1] neg_hi:[0,0,1]
  v_cvt_pk_bf16_f32 v108, 0, v108
  v_cvt_pk_bf16_f32 v109, 0, v109
  v_cvt_pk_bf16_f32 v110, 0, v110
  v_cvt_pk_bf16_f32 v111, 0, v111
  v_pk_mul_f32 v[108:109], v[108:109], v[192:193]
  v_pk_mul_f32 v[110:111], v[110:111], v[194:195]
  v_cvt_pk_bf16_f32 v216, v108, v109
  v_cvt_pk_bf16_f32 v217, v110, v111
  s_waitcnt vmcnt(20)
  buffer_load_dwordx4 v[64:67], v93, s[16:19], s61 offen offset:256 nt
  v_pk_fma_f32 v[108:109], v[4:5], s[92:93], v[208:209] neg_lo:[0,0,1] neg_hi:[0,0,1]
  v_pk_fma_f32 v[110:111], v[6:7], s[92:93], v[210:211] neg_lo:[0,0,1] neg_hi:[0,0,1]
  v_mov_b32_dpp v144, v224 quad_perm:[0,0,0,0] row_mask:0xf bank_mask:0xf
  v_mov_b32_dpp v145, v226 quad_perm:[2,2,2,2] row_mask:0xf bank_mask:0xf
  v_cvt_pk_bf16_f32 v108, 0, v108
  v_cvt_pk_bf16_f32 v109, 0, v109
  v_add_f32_dpp v144, v225, v144 quad_perm:[1,1,1,1] row_mask:0xf bank_mask:0xf
  v_add_f32_dpp v145, v227, v145 quad_perm:[3,3,3,3] row_mask:0xf bank_mask:0xf
  v_cvt_pk_bf16_f32 v110, 0, v110
  v_cvt_pk_bf16_f32 v111, 0, v111
  v_add_f32 v228, v144, v145
  v_pk_mul_f32 v[108:109], v[108:109], v[196:197]
  v_pk_mul_f32 v[110:111], v[110:111], v[198:199]
  v_cvt_pk_bf16_f32 v218, v108, v109
  v_cvt_pk_bf16_f32 v219, v110, v111
  s_waitcnt vmcnt(20)
  buffer_load_dwordx4 v[68:71], v93, s[16:19], s61 offen offset:512 nt
  v_mfma_f32_16x16x32_bf16 v[224:227], v[216:219], v[168:171], 0
  v_pk_fma_f32 v[108:109], v[8:9], s[92:93], v[212:213] neg_lo:[0,0,1] neg_hi:[0,0,1]
  v_pk_fma_f32 v[110:111], v[10:11], s[92:93], v[214:215] neg_lo:[0,0,1] neg_hi:[0,0,1]
  v_cvt_pk_bf16_f32 v108, 0, v108
  v_cvt_pk_bf16_f32 v109, 0, v109
  v_cvt_pk_bf16_f32 v110, 0, v110
  v_cvt_pk_bf16_f32 v111, 0, v111
  v_pk_mul_f32 v[108:109], v[108:109], v[200:201]
  v_pk_mul_f32 v[110:111], v[110:111], v[202:203]
  v_cvt_pk_bf16_f32 v220, v108, v109
  v_cvt_pk_bf16_f32 v221, v110, v111
  s_waitcnt vmcnt(20)
  s_cbranch_vccnz L_kw0_24
  s_waitcnt vmcnt(15)
L_kw0_24:
  buffer_load_dwordx4 v[72:75], v93, s[16:19], s61 offen offset:768 nt
  v_mfma_f32_16x16x16_bf16 v[224:227], v[220:221], v[172:173], v[224:227]
  v_pk_fma_f32 v[108:109], v[12:13], s[92:93], v[204:205] neg_lo:[0,0,1] neg_hi:[0,0,1]
  v_pk_fma_f32 v[110:111], v[14:15], s[92:93], v[206:207] neg_lo:[0,0,1] neg_hi:[0,0,1]
  v_cvt_pk_bf16_f32 v108, 0, v108
  v_cvt_pk_bf16_f32 v109, 0, v109
  v_cvt_pk_bf16_f32 v110, 0, v110
  v_cvt_pk_bf16_f32 v111, 0, v111
  v_pk_mul_f32 v[108:109], v[108:109], v[192:193]
  v_pk_mul_f32 v[110:111], v[110:111], v[194:195]
  v_cvt_pk_bf16_f32 v216, v108, v109
  v_cvt_pk_bf16_f32 v217, v110, v111
  s_waitcnt vmcnt(20)
  buffer_load_dwordx4 v[76:79], v93, s[16:19], s61 offen offset:1024 nt
  v_pk_fma_f32 v[108:109], v[16:17], s[92:93], v[208:209] neg_lo:[0,0,1] neg_hi:[0,0,1]
  v_pk_fma_f32 v[110:111], v[18:19], s[92:93], v[210:211] neg_lo:[0,0,1] neg_hi:[0,0,1]
  v_mov_b32_dpp v144, v224 quad_perm:[0,0,0,0] row_mask:0xf bank_mask:0xf
  v_mov_b32_dpp v145, v226 quad_perm:[2,2,2,2] row_mask:0xf bank_mask:0xf
  v_cvt_pk_bf16_f32 v108, 0, v108
  v_cvt_pk_bf16_f32 v109, 0, v109
  v_add_f32_dpp v144, v225, v144 quad_perm:[1,1,1,1] row_mask:0xf bank_mask:0xf
  v_add_f32_dpp v145, v227, v145 quad_perm:[3,3,3,3] row_mask:0xf bank_mask:0xf
  v_cvt_pk_bf16_f32 v110, 0, v110
  v_cvt_pk_bf16_f32 v111, 0, v111
  v_add_f32 v229, v144, v145
  v_pk_mul_f32 v[108:109], v[108:109], v[196:197]
  v_pk_mul_f32 v[110:111], v[110:111], v[198:199]
  v_cvt_pk_bf16_f32 v218, v108, v109
  v_cvt_pk_bf16_f32 v219, v110, v111
  s_waitcnt vmcnt(20)
  buffer_load_dwordx4 v[80:83], v93, s[16:19], s61 offen offset:1280 nt
  v_mfma_f32_16x16x32_bf16 v[224:227], v[216:219], v[168:171], 0
  v_pk_fma_f32 v[108:109], v[20:21], s[92:93], v[212:213] neg_lo:[0,0,1] neg_hi:[0,0,1]
  v_pk_fma_f32 v[110:111], v[22:23], s[92:93], v[214:215] neg_lo:[0,0,1] neg_hi:[0,0,1]
  v_cvt_pk_bf16_f32 v108, 0, v108
  v_cvt_pk_bf16_f32 v228, 0, v228
  v_cvt_pk_bf16_f32 v109, 0, v109
  v_cvt_pk_bf16_f32 v229, 0, v229
  v_cvt_pk_bf16_f32 v110, 0, v110
  v_pk_mul_f32 v[228:229], v[228:229], s[68:69]
  v_cvt_pk_bf16_f32 v111, 0, v111
  v_cvt_pk_bf16_f32 v123, v228, v229
  v_pk_mul_f32 v[108:109], v[108:109], v[200:201]
  v_pk_mul_f32 v[110:111], v[110:111], v[202:203]
  v_cvt_pk_bf16_f32 v220, v108, v109
  v_cvt_pk_bf16_f32 v221, v110, v111
  s_waitcnt vmcnt(20)
  s_cbranch_vccnz L_kw0_27
  s_waitcnt vmcnt(15)
L_kw0_27:
  buffer_load_dwordx4 v[84:87], v93, s[16:19], s61 offen offset:1536 nt
  v_mfma_f32_16x16x16_bf16 v[224:227], v[220:221], v[172:173], v[224:227]
  v_pk_fma_f32 v[108:109], v[24:25], s[92:93], v[204:205] neg_lo:[0,0,1] neg_hi:[0,0,1]
  v_pk_fma_f32 v[110:111], v[26:27], s[92:93], v[206:207] neg_lo:[0,0,1] neg_hi:[0,0,1]
  v_cvt_pk_bf16_f32 v108, 0, v108
  v_cvt_pk_bf16_f32 v109, 0, v109
  v_cvt_pk_bf16_f32 v110, 0, v110
  v_cvt_pk_bf16_f32 v111, 0, v111
  v_pk_mul_f32 v[108:109], v[108:109], v[192:193]
  v_pk_mul_f32 v[110:111], v[110:111], v[194:195]
  v_cvt_pk_bf16_f32 v216, v108, v109
  v_cvt_pk_bf16_f32 v217, v110, v111
  s_waitcnt vmcnt(20)
  buffer_load_dwordx4 v[88:91], v93, s[16:19], s61 offen offset:1792 nt
  v_pk_fma_f32 v[108:109], v[28:29], s[92:93], v[208:209] neg_lo:[0,0,1] neg_hi:[0,0,1]
  v_pk_fma_f32 v[110:111], v[30:31], s[92:93], v[210:211] neg_lo:[0,0,1] neg_hi:[0,0,1]
  v_mov_b32_dpp v144, v224 quad_perm:[0,0,0,0] row_mask:0xf bank_mask:0xf
  v_mov_b32_dpp v145, v226 quad_perm:[2,2,2,2] row_mask:0xf bank_mask:0xf
  v_cvt_pk_bf16_f32 v108, 0, v108
  v_cvt_pk_bf16_f32 v109, 0, v109
  v_add_f32_dpp v144, v225, v144 quad_perm:[1,1,1,1] row_mask:0xf bank_mask:0xf
  v_add_f32_dpp v145, v227, v145 quad_perm:[3,3,3,3] row_mask:0xf bank_mask:0xf
  v_cvt_pk_bf16_f32 v110, 0, v110
  v_cvt_pk_bf16_f32 v111, 0, v111
  v_add_f32 v228, v144, v145
  v_pk_mul_f32 v[108:109], v[108:109], v[196:197]
  v_pk_mul_f32 v[110:111], v[110:111], v[198:199]
  v_cvt_pk_bf16_f32 v218, v108, v109
  v_cvt_pk_bf16_f32 v219, v110, v111
  s_waitcnt vmcnt(20)
  buffer_load_dwordx4 v[4:7], v93, s[16:19], s61 offen offset:2048 nt
  v_mfma_f32_16x16x32_bf16 v[224:227], v[216:219], v[168:171], 0
  v_pk_fma_f32 v[108:109], v[32:33], s[92:93], v[212:213] neg_lo:[0,0,1] neg_hi:[0,0,1]
  v_pk_fma_f32 v[110:111], v[34:35], s[92:93], v[214:215] neg_lo:[0,0,1] neg_hi:[0,0,1]
  v_cvt_pk_bf16_f32 v108, 0, v108
  v_cvt_pk_bf16_f32 v109, 0, v109
  v_cvt_pk_bf16_f32 v110, 0, v110
  v_cvt_pk_bf16_f32 v111, 0, v111
  v_pk_mul_f32 v[108:109], v[108:109], v[200:201]
  v_pk_mul_f32 v[110:111], v[110:111], v[202:203]
  v_cvt_pk_bf16_f32 v220, v108, v109
  v_cvt_pk_bf16_f32 v221, v110, v111
  s_waitcnt vmcnt(20)
  s_cbranch_vccnz L_kw0_30
  s_waitcnt vmcnt(9)
L_kw0_30:
  buffer_load_dwordx4 v[8:11], v93, s[16:19], s61 offen offset:2304 nt
  v_mfma_f32_16x16x16_bf16 v[224:227], v[220:221], v[172:173], v[224:227]
  v_pk_fma_f32 v[108:109], v[36:37], s[92:93], v[204:205] neg_lo:[0,0,1] neg_hi:[0,0,1]
  v_pk_fma_f32 v[110:111], v[38:39], s[92:93], v[206:207] neg_lo:[0,0,1] neg_hi:[0,0,1]
  v_cvt_pk_bf16_f32 v108, 0, v108
  v_cvt_pk_bf16_f32 v109, 0, v109
  v_cvt_pk_bf16_f32 v110, 0, v110
  v_cvt_pk_bf16_f32 v111, 0, v111
  v_pk_mul_f32 v[108:109], v[108:109], v[192:193]
  v_pk_mul_f32 v[110:111], v[110:111], v[194:195]
  v_cvt_pk_bf16_f32 v216, v108, v109
  v_cvt_pk_bf16_f32 v217, v110, v111
  s_waitcnt vmcnt(20)
  buffer_load_dwordx4 v[12:15], v93, s[16:19], s61 offen offset:2560 nt
  v_pk_fma_f32 v[108:109], v[40:41], s[92:93], v[208:209] neg_lo:[0,0,1] neg_hi:[0,0,1]
  v_pk_fma_f32 v[110:111], v[42:43], s[92:93], v[210:211] neg_lo:[0,0,1] neg_hi:[0,0,1]
  v_mov_b32_dpp v144, v224 quad_perm:[0,0,0,0] row_mask:0xf bank_mask:0xf
  v_mov_b32_dpp v145, v226 quad_perm:[2,2,2,2] row_mask:0xf bank_mask:0xf
  v_cvt_pk_bf16_f32 v108, 0, v108
  v_cvt_pk_bf16_f32 v109, 0, v109
  v_add_f32_dpp v144, v225, v144 quad_perm:[1,1,1,1] row_mask:0xf bank_mask:0xf
  v_add_f32_dpp v145, v227, v145 quad_perm:[3,3,3,3] row_mask:0xf bank_mask:0xf
  v_cvt_pk_bf16_f32 v110, 0, v110
  v_cvt_pk_bf16_f32 v111, 0, v111
  v_add_f32 v229, v144, v145
  v_pk_mul_f32 v[108:109], v[108:109], v[196:197]
  v_pk_mul_f32 v[110:111], v[110:111], v[198:199]
  v_cvt_pk_bf16_f32 v218, v108, v109
  v_cvt_pk_bf16_f32 v219, v110, v111
  s_waitcnt vmcnt(20)
  buffer_load_dwordx4 v[16:19], v93, s[16:19], s61 offen offset:2816 nt
  v_mfma_f32_16x16x32_bf16 v[224:227], v[216:219], v[168:171], 0
  v_pk_fma_f32 v[108:109], v[44:45], s[92:93], v[212:213] neg_lo:[0,0,1] neg_hi:[0,0,1]
  v_pk_fma_f32 v[110:111], v[46:47], s[92:93], v[214:215] neg_lo:[0,0,1] neg_hi:[0,0,1]
  v_cvt_pk_bf16_f32 v108, 0, v108
  v_cvt_pk_bf16_f32 v228, 0, v228
  v_cvt_pk_bf16_f32 v109, 0, v109
  v_cvt_pk_bf16_f32 v229, 0, v229
  v_cvt_pk_bf16_f32 v110, 0, v110
  v_pk_mul_f32 v[228:229], v[228:229], s[68:69]
  v_cvt_pk_bf16_f32 v111, 0, v111
  v_cvt_pk_bf16_f32 v124, v228, v229
  v_pk_mul_f32 v[108:109], v[108:109], v[200:201]
  v_pk_mul_f32 v[110:111], v[110:111], v[202:203]
  v_cvt_pk_bf16_f32 v220, v108, v109
  v_cvt_pk_bf16_f32 v221, v110, v111
  s_mov_b32 s60, s61
  v_mov_b32 v146, s64
  v_mfma_f32_16x16x16_bf16 v[224:227], v[220:221], v[172:173], v[224:227]
  ds_write_b128 v99, v[120:123]
  v_add_u32 v99, 768, v99
  s_nop 5
  v_mov_b32_dpp v144, v224 quad_perm:[0,0,0,0] row_mask:0xf bank_mask:0xf
  v_mov_b32_dpp v145, v226 quad_perm:[2,2,2,2] row_mask:0xf bank_mask:0xf
  s_nop 0
  v_add_f32_dpp v144, v225, v144 quad_perm:[1,1,1,1] row_mask:0xf bank_mask:0xf
  v_add_f32_dpp v145, v227, v145 quad_perm:[3,3,3,3] row_mask:0xf bank_mask:0xf
  v_add_f32 v228, v144, v145
  v_cndmask_b32 v228, v228, v236, s[50:51]
  v_cvt_pk_bf16_f32 v228, 0, v228
  v_cvt_pk_bf16_f32 v229, 0, v229
  v_pk_mul_f32 v[228:229], v[228:229], s[68:69]
  v_cvt_pk_bf16_f32 v125, v228, v229
  ds_write_b64 v100, v[124:125] offset:256
  ds_write_b32 v104, v146
  v_add_u32 v100, 768, v100
  v_add_u32 v144, s85, v2
  v_lshrrev_b32 v145, v144, s91
  v_and_b32 v145, 1, v145
  v_cmp_eq_u32 s[50:51], 1, v145
  s_nop 1
  s_and_b64 s[48:49], s[50:51], s[58:59]
  s_andn2_b64 s[50:51], s[50:51], s[58:59]
  s_mov_b32 s97, s64
  s_add_u32 s64, s64, 2
  ds_read_b32 v106, v104 offset:8
  s_waitcnt vmcnt(14)
  s_cbranch_vccnz L_kw1_0
  s_waitcnt vmcnt(9)
L_kw1_0:
  buffer_load_dwordx4 v[20:23], v93, s[8:11], s60 offen offset:3072 nt
  v_lshlrev_b32 v204, 16, v186
  v_and_b32 v205, s65, v186
  v_lshlrev_b32 v206, 16, v187
  v_and_b32 v207, s65, v187
  v_lshlrev_b32 v192, 16, v180
  v_and_b32 v193, s65, v180
  v_lshlrev_b32 v194, 16, v181
  v_and_b32 v195, s65, v181
  v_pk_mul_f32 v[204:205], v[204:205], s[94:95]
  v_mov_b32 v168, v174
  v_pk_mul_f32 v[206:207], v[206:207], s[94:95]
  v_mov_b32 v169, v175
  v_pk_fma_f32 v[108:109], v[48:49], s[92:93], v[204:205] neg_lo:[0,0,1] neg_hi:[0,0,1]
  v_pk_fma_f32 v[110:111], v[50:51], s[92:93], v[206:207] neg_lo:[0,0,1] neg_hi:[0,0,1]
  v_cvt_pk_bf16_f32 v108, 0, v108
  v_cvt_pk_bf16_f32 v109, 0, v109
  v_cvt_pk_bf16_f32 v110, 0, v110
  v_cvt_pk_bf16_f32 v111, 0, v111
  v_pk_mul_f32 v[108:109], v[108:109], v[192:193]
  v_pk_mul_f32 v[110:111], v[110:111], v[194:195]
  v_cvt_pk_bf16_f32 v216, v108, v109
  v_cvt_pk_bf16_f32 v217, v110, v111
  s_waitcnt lgkmcnt(0)
  v_cmp_lt_u32 vcc, s97, v106
  s_waitcnt vmcnt(14)
  buffer_load_dwordx4 v[24:27], v93, s[8:11], s60 offen offset:3328 nt
  v_lshlrev_b32 v208, 16, v188
  v_and_b32 v209, s65, v188
  v_lshlrev_b32 v210, 16, v189
  v_and_b32 v211, s65, v189
  v_lshlrev_b32 v196, 16, v182
  v_and_b32 v197, s65, v182
  v_lshlrev_b32 v198, 16, v183
  v_and_b32 v199, s65, v183
  v_pk_mul_f32 v[208:209], v[208:209], s[94:95]
  v_mov_b32 v170, v176
  v_pk_mul_f32 v[210:211], v[210:211], s[94:95]
  v_mov_b32 v171, v177
  v_pk_fma_f32 v[108:109], v[52:53], s[92:93], v[208:209] neg_lo:[0,0,1] neg_hi:[0,0,1]
  v_pk_fma_f32 v[110:111], v[54:55], s[92:93], v[210:211] neg_lo:[0,0,1] neg_hi:[0,0,1]
  v_cvt_pk_bf16_f32 v108, 0, v108
  v_cvt_pk_bf16_f32 v109, 0, v109
  v_cvt_pk_bf16_f32 v110, 0, v110
  v_cvt_pk_bf16_f32 v111, 0, v111
  v_pk_mul_f32 v[108:109], v[108:109], v[196:197]
  v_pk_mul_f32 v[110:111], v[110:111], v[198:199]
  v_cvt_pk_bf16_f32 v218, v108, v109
  v_cvt_pk_bf16_f32 v219, v110, v111
  s_waitcnt vmcnt(14)
  buffer_load_dwordx4 v[28:31], v93, s[8:11], s60 offen offset:3584 nt
  v_mfma_f32_16x16x32_bf16 v[224:227], v[216:219], v[168:171], 0
  v_lshlrev_b32 v212, 16, v190
  v_and_b32 v213, s65, v190
  v_lshlrev_b32 v214, 16, v191
  v_and_b32 v215, s65, v191
  v_lshlrev_b32 v200, 16, v184
  v_and_b32 v201, s65, v184
  v_lshlrev_b32 v202, 16, v185
  v_and_b32 v203, s65, v185
  v_pk_mul_f32 v[212:213], v[212:213], s[94:95]
  v_mov_b32 v172, v178
  v_pk_mul_f32 v[214:215], v[214:215], s[94:95]
  v_mov_b32 v173, v179
  v_pk_fma_f32 v[108:109], v[56:57], s[92:93], v[212:213] neg_lo:[0,0,1] neg_hi:[0,0,1]
  v_pk_fma_f32 v[110:111], v[58:59], s[92:93], v[214:215] neg_lo:[0,0,1] neg_hi:[0,0,1]
  v_cvt_pk_bf16_f32 v108, 0, v108
  v_cvt_pk_bf16_f32 v109, 0, v109
  v_cvt_pk_bf16_f32 v110, 0, v110
  v_cvt_pk_bf16_f32 v111, 0, v111
  v_pk_mul_f32 v[108:109], v[108:109], v[200:201]
  v_pk_mul_f32 v[110:111], v[110:111], v[202:203]
  v_cvt_pk_bf16_f32 v220, v108, v109
  v_cvt_pk_bf16_f32 v221, v110, v111
  s_waitcnt vmcnt(14)
  s_cbranch_vccnz L_kw1_3
  s_waitcnt vmcnt(9)
L_kw1_3:
  buffer_load_dwordx4 v[32:35], v94, s[8:11], s60 offen offset:0 nt
  v_mfma_f32_16x16x16_bf16 v[224:227], v[220:221], v[172:173], v[224:227]
  v_pk_fma_f32 v[108:109], v[60:61], s[92:93], v[204:205] neg_lo:[0,0,1] neg_hi:[0,0,1]
  v_pk_fma_f32 v[110:111], v[62:63], s[92:93], v[206:207] neg_lo:[0,0,1] neg_hi:[0,0,1]
  v_cvt_pk_bf16_f32 v108, 0, v108
  v_cvt_pk_bf16_f32 v109, 0, v109
  v_cvt_pk_bf16_f32 v110, 0, v110
  v_cvt_pk_bf16_f32 v111, 0, v111
  v_pk_mul_f32 v[108:109], v[108:109], v[192:193]
  v_pk_mul_f32 v[110:111], v[110:111], v[194:195]
  v_cvt_pk_bf16_f32 v216, v108, v109
  v_cvt_pk_bf16_f32 v217, v110, v111
  s_waitcnt vmcnt(14)
  buffer_load_dwordx4 v[36:39], v94, s[8:11], s60 offen offset:256 nt
  v_pk_fma_f32 v[108:109], v[64:65], s[92:93], v[208:209] neg_lo:[0,0,1] neg_hi:[0,0,1]
  v_pk_fma_f32 v[110:111], v[66:67], s[92:93], v[210:211] neg_lo:[0,0,1] neg_hi:[0,0,1]
  v_mov_b32_dpp v144, v224 quad_perm:[0,0,0,0] row_mask:0xf bank_mask:0xf
  v_mov_b32_dpp v145, v226 quad_perm:[2,2,2,2] row_mask:0xf bank_mask:0xf
  v_cvt_pk_bf16_f32 v108, 0, v108
  v_cvt_pk_bf16_f32 v109, 0, v109
  v_add_f32_dpp v144, v225, v144 quad_perm:[1,1,1,1] row_mask:0xf bank_mask:0xf
  v_add_f32_dpp v145, v227, v145 quad_perm:[3,3,3,3] row_mask:0xf bank_mask:0xf
  v_cvt_pk_bf16_f32 v110, 0, v110
  v_cvt_pk_bf16_f32 v111, 0, v111
  v_add_f32 v228, v144, v145
  v_pk_mul_f32 v[108:109], v[108:109], v[196:197]
  v_pk_mul_f32 v[110:111], v[110:111], v[198:199]
  v_cvt_pk_bf16_f32 v218, v108, v109
  v_cvt_pk_bf16_f32 v219, v110, v111
  s_waitcnt vmcnt(14)
  buffer_load_dwordx4 v[40:43], v94, s[8:11], s60 offen offset:512 nt
  v_mfma_f32_16x16x32_bf16 v[224:227], v[216:219], v[168:171], 0
  v_pk_fma_f32 v[108:109], v[68:69], s[92:93], v[212:213] neg_lo:[0,0,1] neg_hi:[0,0,1]
  v_pk_fma_f32 v[110:111], v[70:71], s[92:93], v[214:215] neg_lo:[0,0,1] neg_hi:[0,0,1]
  v_cvt_pk_bf16_f32 v108, 0, v108
  v_cndmask_b32 v228, v228, v236, s[48:49]
  v_cvt_pk_bf16_f32 v109, 0, v109
  v_cvt_pk_bf16_f32 v110, 0, v110
  v_cvt_pk_bf16_f32 v111, 0, v111
  v_pk_mul_f32 v[108:109], v[108:109], v[200:201]
  v_pk_mul_f32 v[110:111], v[110:111], v[202:203]
  v_cvt_pk_bf16_f32 v220, v108, v109
  v_cvt_pk_bf16_f32 v221, v110, v111
  s_waitcnt vmcnt(14)
  s_cbranch_vccnz L_kw1_6
  s_waitcnt vmcnt(9)
L_kw1_6:
  buffer_load_dwordx4 v[44:47], v94, s[8:11], s60 offen offset:768 nt
  v_mfma_f32_16x16x16_bf16 v[224:227], v[220:221], v[172:173], v[224:227]
  v_pk_fma_f32 v[108:109], v[72:73], s[92:93], v[204:205] neg_lo:[0,0,1] neg_hi:[0,0,1]
  v_pk_fma_f32 v[110:111], v[74:75], s[92:93], v[206:207] neg_lo:[0,0,1] neg_hi:[0,0,1]
  v_cvt_pk_bf16_f32 v108, 0, v108
  v_cvt_pk_bf16_f32 v109, 0, v109
  v_cvt_pk_bf16_f32 v110, 0, v110
  v_cvt_pk_bf16_f32 v111, 0, v111
  v_pk_mul_f32 v[108:109], v[108:109], v[192:193]
  v_pk_mul_f32 v[110:111], v[110:111], v[194:195]
  v_cvt_pk_bf16_f32 v216, v108, v109
  v_cvt_pk_bf16_f32 v217, v110, v111
  s_waitcnt vmcnt(14)
  buffer_load_dwordx4 v[48:51], v94, s[8:11], s60 offen offset:1024 nt
  v_pk_fma_f32 v[108:109], v[76:77], s[92:93], v[208:209] neg_lo:[0,0,1] neg_hi:[0,0,1]
  v_pk_fma_f32 v[110:111], v[78:79], s[92:93], v[210:211] neg_lo:[0,0,1] neg_hi:[0,0,1]
  v_mov_b32_dpp v144, v224 quad_perm:[0,0,0,0] row_mask:0xf bank_mask:0xf
  v_mov_b32_dpp v145, v226 quad_perm:[2,2,2,2] row_mask:0xf bank_mask:0xf
  v_cvt_pk_bf16_f32 v108, 0, v108
  v_cvt_pk_bf16_f32 v109, 0, v109
  v_add_f32_dpp v144, v225, v144 quad_perm:[1,1,1,1] row_mask:0xf bank_mask:0xf
  v_add_f32_dpp v145, v227, v145 quad_perm:[3,3,3,3] row_mask:0xf bank_mask:0xf
  v_cvt_pk_bf16_f32 v110, 0, v110
  v_cvt_pk_bf16_f32 v111, 0, v111
  v_add_f32 v229, v144, v145
  v_pk_mul_f32 v[108:109], v[108:109], v[196:197]
  v_pk_mul_f32 v[110:111], v[110:111], v[198:199]
  v_cvt_pk_bf16_f32 v218, v108, v109
  v_cvt_pk_bf16_f32 v219, v110, v111
  s_waitcnt vmcnt(14)
  buffer_load_dwordx4 v[52:55], v94, s[8:11], s60 offen offset:1280 nt
  v_mfma_f32_16x16x32_bf16 v[224:227], v[216:219], v[168:171], 0
  v_pk_fma_f32 v[108:109], v[80:81], s[92:93], v[212:213] neg_lo:[0,0,1] neg_hi:[0,0,1]
  v_pk_fma_f32 v[110:111], v[82:83], s[92:93], v[214:215] neg_lo:[0,0,1] neg_hi:[0,0,1]
  v_cvt_pk_bf16_f32 v108, 0, v108
  v_cvt_pk_bf16_f32 v228, 0, v228
  v_cvt_pk_bf16_f32 v109, 0, v109
  v_cvt_pk_bf16_f32 v229, 0, v229
  v_cvt_pk_bf16_f32 v110, 0, v110
  v_pk_mul_f32 v[228:229], v[228:229], s[68:69]
  v_cvt_pk_bf16_f32 v111, 0, v111
  v_cvt_pk_bf16_f32 v120, v228, v229
  v_pk_mul_f32 v[108:109], v[108:109], v[200:201]
  v_pk_mul_f32 v[110:111], v[110:111], v[202:203]
  v_cvt_pk_bf16_f32 v220, v108, v109
  v_cvt_pk_bf16_f32 v221, v110, v111
  s_waitcnt vmcnt(14)
  s_cbranch_vccnz L_kw1_9
  s_waitcnt vmcnt(9)
L_kw1_9:
  buffer_load_dwordx4 v[56:59], v94, s[8:11], s60 offen offset:1536 nt
  v_mfma_f32_16x16x16_bf16 v[224:227], v[220:221], v[172:173], v[224:227]
  v_pk_fma_f32 v[108:109], v[84:85], s[92:93], v[204:205] neg_lo:[0,0,1] neg_hi:[0,0,1]
  v_pk_fma_f32 v[110:111], v[86:87], s[92:93], v[206:207] neg_lo:[0,0,1] neg_hi:[0,0,1]
  v_cvt_pk_bf16_f32 v108, 0, v108
  v_cvt_pk_bf16_f32 v109, 0, v109
  v_cvt_pk_bf16_f32 v110, 0, v110
  v_cvt_pk_bf16_f32 v111, 0, v111
  v_pk_mul_f32 v[108:109], v[108:109], v[192:193]
  v_pk_mul_f32 v[110:111], v[110:111], v[194:195]
  v_cvt_pk_bf16_f32 v216, v108, v109
  v_cvt_pk_bf16_f32 v217, v110, v111
  s_waitcnt vmcnt(14)
  buffer_load_dwordx4 v[60:63], v94, s[8:11], s60 offen offset:1792 nt
  v_pk_fma_f32 v[108:109], v[88:89], s[92:93], v[208:209] neg_lo:[0,0,1] neg_hi:[0,0,1]
  v_pk_fma_f32 v[110:111], v[90:91], s[92:93], v[210:211] neg_lo:[0,0,1] neg_hi:[0,0,1]
  v_mov_b32_dpp v144, v224 quad_perm:[0,0,0,0] row_mask:0xf bank_mask:0xf
  v_mov_b32_dpp v145, v226 quad_perm:[2,2,2,2] row_mask:0xf bank_mask:0xf
  v_cvt_pk_bf16_f32 v108, 0, v108
  v_cvt_pk_bf16_f32 v109, 0, v109
  v_add_f32_dpp v144, v225, v144 quad_perm:[1,1,1,1] row_mask:0xf bank_mask:0xf
  v_add_f32_dpp v145, v227, v145 quad_perm:[3,3,3,3] row_mask:0xf bank_mask:0xf
  v_cvt_pk_bf16_f32 v110, 0, v110
  v_cvt_pk_bf16_f32 v111, 0, v111
  v_add_f32 v228, v144, v145
  v_pk_mul_f32 v[108:109], v[108:109], v[196:197]
  v_pk_mul_f32 v[110:111], v[110:111], v[198:199]
  v_cvt_pk_bf16_f32 v218, v108, v109
  v_cvt_pk_bf16_f32 v219, v110, v111
  s_waitcnt vmcnt(14)
  buffer_load_dwordx4 v[64:67], v94, s[8:11], s60 offen offset:2048 nt
  v_mfma_f32_16x16x32_bf16 v[224:227], v[216:219], v[168:171], 0
  v_pk_fma_f32 v[108:109], v[4:5], s[92:93], v[212:213] neg_lo:[0,0,1] neg_hi:[0,0,1]
  v_pk_fma_f32 v[110:111], v[6:7], s[92:93], v[214:215] neg_lo:[0,0,1] neg_hi:[0,0,1]
  v_cvt_pk_bf16_f32 v108, 0, v108
  v_cvt_pk_bf16_f32 v109, 0, v109
  v_cvt_pk_bf16_f32 v110, 0, v110
  v_cvt_pk_bf16_f32 v111, 0, v111
  v_pk_mul_f32 v[108:109], v[108:109], v[200:201]
  v_pk_mul_f32 v[110:111], v[110:111], v[202:203]
  v_cvt_pk_bf16_f32 v220, v108, v109
  v_cvt_pk_bf16_f32 v221, v110, v111
  s_waitcnt vmcnt(14)
  s_cbranch_vccnz L_kw1_12
  s_waitcnt vmcnt(9)
L_kw1_12:
  buffer_load_dwordx4 v[68:71], v94, s[8:11], s60 offen offset:2304 nt
  v_mfma_f32_16x16x16_bf16 v[224:227], v[220:221], v[172:173], v[224:227]
  v_pk_fma_f32 v[108:109], v[8:9], s[92:93], v[204:205] neg_lo:[0,0,1] neg_hi:[0,0,1]
  v_pk_fma_f32 v[110:111], v[10:11], s[92:93], v[206:207] neg_lo:[0,0,1] neg_hi:[0,0,1]
  v_cvt_pk_bf16_f32 v108, 0, v108
  v_cvt_pk_bf16_f32 v109, 0, v109
  v_cvt_pk_bf16_f32 v110, 0, v110
  v_cvt_pk_bf16_f32 v111, 0, v111
  v_pk_mul_f32 v[108:109], v[108:109], v[192:193]
  v_pk_mul_f32 v[110:111], v[110:111], v[194:195]
  v_cvt_pk_bf16_f32 v216, v108, v109
  v_cvt_pk_bf16_f32 v217, v110, v111
  s_waitcnt vmcnt(14)
  buffer_load_dwordx4 v[72:75], v94, s[8:11], s60 offen offset:2560 nt
  v_pk_fma_f32 v[108:109], v[12:13], s[92:93], v[208:209] neg_lo:[0,0,1] neg_hi:[0,0,1]
  v_pk_fma_f32 v[110:111], v[14:15], s[92:93], v[210:211] neg_lo:[0,0,1] neg_hi:[0,0,1]
  v_mov_b32_dpp v144, v224 quad_perm:[0,0,0,0] row_mask:0xf bank_mask:0xf
  v_mov_b32_dpp v145, v226 quad_perm:[2,2,2,2] row_mask:0xf bank_mask:0xf
  v_cvt_pk_bf16_f32 v108, 0, v108
  v_cvt_pk_bf16_f32 v109, 0, v109
  v_add_f32_dpp v144, v225, v144 quad_perm:[1,1,1,1] row_mask:0xf bank_mask:0xf
  v_add_f32_dpp v145, v227, v145 quad_perm:[3,3,3,3] row_mask:0xf bank_mask:0xf
  v_cvt_pk_bf16_f32 v110, 0, v110
  v_cvt_pk_bf16_f32 v111, 0, v111
  v_add_f32 v229, v144, v145
  v_pk_mul_f32 v[108:109], v[108:109], v[196:197]
  v_pk_mul_f32 v[110:111], v[110:111], v[198:199]
  v_cvt_pk_bf16_f32 v218, v108, v109
  v_cvt_pk_bf16_f32 v219, v110, v111
  s_waitcnt vmcnt(14)
  buffer_load_dwordx4 v[76:79], v94, s[8:11], s60 offen offset:2816 nt
  v_mfma_f32_16x16x32_bf16 v[224:227], v[216:219], v[168:171], 0
  v_pk_fma_f32 v[108:109], v[16:17], s[92:93], v[212:213] neg_lo:[0,0,1] neg_hi:[0,0,1]
  v_pk_fma_f32 v[110:111], v[18:19], s[92:93], v[214:215] neg_lo:[0,0,1] neg_hi:[0,0,1]
  v_cvt_pk_bf16_f32 v108, 0, v108
  v_cvt_pk_bf16_f32 v228, 0, v228
  v_cvt_pk_bf16_f32 v109, 0, v109
  v_cvt_pk_bf16_f32 v229, 0, v229
  v_cvt_pk_bf16_f32 v110, 0, v110
  v_pk_mul_f32 v[228:229], v[228:229], s[68:69]
  v_cvt_pk_bf16_f32 v111, 0, v111
  v_cvt_pk_bf16_f32 v121, v228, v229
  v_pk_mul_f32 v[108:109], v[108:109], v[200:201]
  v_pk_mul_f32 v[110:111], v[110:111], v[202:203]
  v_cvt_pk_bf16_f32 v220, v108, v109
  v_cvt_pk_bf16_f32 v221, v110, v111
  s_waitcnt vmcnt(14)
  s_cbranch_vccnz L_kw1_15
  s_waitcnt vmcnt(9)
L_kw1_15:
  buffer_load_dwordx4 v[80:83], v95, s[8:11], s60 offen offset:0 nt
  v_mfma_f32_16x16x16_bf16 v[224:227], v[220:221], v[172:173], v[224:227]
  v_pk_fma_f32 v[108:109], v[20:21], s[92:93], v[204:205] neg_lo:[0,0,1] neg_hi:[0,0,1]
  v_pk_fma_f32 v[110:111], v[22:23], s[92:93], v[206:207] neg_lo:[0,0,1] neg_hi:[0,0,1]
  v_cvt_pk_bf16_f32 v108, 0, v108
  v_cvt_pk_bf16_f32 v109, 0, v109
  v_cvt_pk_bf16_f32 v110, 0, v110
  v_cvt_pk_bf16_f32 v111, 0, v111
  v_pk_mul_f32 v[108:109], v[108:109], v[192:193]
  v_pk_mul_f32 v[110:111], v[110:111], v[194:195]
  v_cvt_pk_bf16_f32 v216, v108, v109
  v_cvt_pk_bf16_f32 v217, v110, v111
  s_waitcnt vmcnt(14)
  buffer_load_dwordx4 v[84:87], v95, s[8:11], s60 offen offset:256 nt
  v_pk_fma_f32 v[108:109], v[24:25], s[92:93], v[208:209] neg_lo:[0,0,1] neg_hi:[0,0,1]
  v_pk_fma_f32 v[110:111], v[26:27], s[92:93], v[210:211] neg_lo:[0,0,1] neg_hi:[0,0,1]
  v_mov_b32_dpp v144, v224 quad_perm:[0,0,0,0] row_mask:0xf bank_mask:0xf
  v_mov_b32_dpp v145, v226 quad_perm:[2,2,2,2] row_mask:0xf bank_mask:0xf
  v_cvt_pk_bf16_f32 v108, 0, v108
  v_cvt_pk_bf16_f32 v109, 0, v109
  v_add_f32_dpp v144, v225, v144 quad_perm:[1,1,1,1] row_mask:0xf bank_mask:0xf
  v_add_f32_dpp v145, v227, v145 quad_perm:[3,3,3,3] row_mask:0xf bank_mask:0xf
  v_cvt_pk_bf16_f32 v110, 0, v110
  v_cvt_pk_bf16_f32 v111, 0, v111
  v_add_f32 v228, v144, v145
  v_pk_mul_f32 v[108:109], v[108:109], v[196:197]
  v_pk_mul_f32 v[110:111], v[110:111], v[198:199]
  v_cvt_pk_bf16_f32 v218, v108, v109
  v_cvt_pk_bf16_f32 v219, v110, v111
  s_waitcnt vmcnt(14)
  buffer_load_dwordx4 v[88:91], v95, s[8:11], s60 offen offset:512 nt
  v_mfma_f32_16x16x32_bf16 v[224:227], v[216:219], v[168:171], 0
  v_pk_fma_f32 v[108:109], v[28:29], s[92:93], v[212:213] neg_lo:[0,0,1] neg_hi:[0,0,1]
  v_pk_fma_f32 v[110:111], v[30:31], s[92:93], v[214:215] neg_lo:[0,0,1] neg_hi:[0,0,1]
  s_cmp_lt_u32 s64, s99
  s_cbranch_scc1 L_k_known1
L_k_spin1:
  v_mov_b32 v144, 61696
  ds_read_b32 v144, v144
  s_waitcnt lgkmcnt(0)
  v_readfirstlane_b32 s96, v144
  s_nop 1
  s_cmp_eq_u32 s96, 0
  s_cbranch_scc1 L_k_spin1
  s_mov_b32 s99, -1
L_k_known1:
  s_lshr_b32 s71, s64, 5
  s_lshr_b32 s85, s96, s71
  s_andn2_b32 s70, s64, 1
  s_or_b32 s70, s70, s4
  s_cmp_lt_u32 s64, 8
  s_cselect_b32 s70, s70, s64
  s_cselect_b32 s85, s64, s85
  s_and_b32 s85, s85, 1
  s_and_b32 s70, s70, 31
  s_lshl_b32 s71, s71, 12
  s_add_u32 s70, s70, s5
  s_add_u32 s70, s70, s71
  s_mul_hi_u32 s84, s70, s90
  s_lshr_b32 s84, s84, 1
  s_mul_i32 s71, s84, 3
  s_sub_u32 s70, s70, s71
  s_lshl3_add_u32 s85, s70, s85
  s_mul_i32 s61, s84, 196608
  s_lshr_b32 s89, s84, 4
  s_lshl_b32 s70, s85, 5
  v_add_u32 v97, s70, v230
  v_mul_u32_u24 v97, 21846, v97
  v_lshrrev_b32 v97, 16, v97
  v_add_u32 v144, s85, v231
  v_lshrrev_b32 v145, v144, s91
  v_and_b32 v145, 1, v145
  v_cmp_eq_u32 s[54:55], 1, v145
  s_nop 1
  s_and_b64 s[52:53], s[54:55], s[56:57]
  s_andn2_b64 s[54:55], s[54:55], s[56:57]
  v_mul_u32_u24 v144, 43, v144
  v_lshrrev_b32 v144, 8, v144
  v_mul_u32_u24 v144, 384, v144
  v_add_u32 v234, v144, v233
  s_cmp_eq_u32 s89, s88
  s_cbranch_scc1 L_k_sameq1
  s_mul_i32 s70, s89, 1536
  buffer_load_dwordx2 v[174:175], v235, s[36:39], s70 offen offset:0
  buffer_load_dwordx2 v[176:177], v235, s[36:39], s70 offen offset:128
  buffer_load_dwordx2 v[178:179], v235, s[36:39], s70 offen offset:256
  s_mov_b32 s88, s89
L_k_sameq1:
  s_mul_i32 s62, s84, 1536
  buffer_load_dwordx2 v[180:181], v234, s[20:23], s62 offen offset:0
  buffer_load_dwordx2 v[186:187], v234, s[24:27], s62 offen offset:0
  buffer_load_dwordx2 v[182:183], v234, s[20:23], s62 offen offset:128
  buffer_load_dwordx2 v[188:189], v234, s[24:27], s62 offen offset:128
  buffer_load_dwordx2 v[184:185], v234, s[20:23], s62 offen offset:256
  buffer_load_dwordx2 v[190:191], v234, s[24:27], s62 offen offset:256
  v_cvt_pk_bf16_f32 v108, 0, v108
  v_cvt_pk_bf16_f32 v109, 0, v109
  v_cvt_pk_bf16_f32 v110, 0, v110
  v_cvt_pk_bf16_f32 v111, 0, v111
  v_pk_mul_f32 v[108:109], v[108:109], v[200:201]
  v_pk_mul_f32 v[110:111], v[110:111], v[202:203]
  v_cvt_pk_bf16_f32 v220, v108, v109
  v_cvt_pk_bf16_f32 v221, v110, v111
  s_cmp_lt_u32 s64, 96
  s_cbranch_scc1 L_k_keep
  s_lshr_b32 s71, s3, 5
  s_lshr_b32 s85, s96, s71
  s_bfe_u32 s85, s85, 0x10003
  s_and_b32 s70, s3, 31
  s_lshl_b32 s71, s71, 12
  s_add_u32 s70, s70, s5
  s_add_u32 s70, s70, s71
  s_mul_hi_u32 s84, s70, s90
  s_lshr_b32 s84, s84, 1
  s_mul_i32 s71, s84, 3
  s_sub_u32 s70, s70, s71
  s_lshl3_add_u32 s85, s70, s85
  s_mul_i32 s61, s84, 196608
  s_lshr_b32 s89, s84, 4
  s_lshl_b32 s70, s85, 5
  v_add_u32 v97, s70, v1
  v_mul_u32_u24 v97, 21846, v97
  v_lshrrev_b32 v97, 16, v97
  v_add_u32 v144, s85, v2
  v_lshrrev_b32 v145, v144, s91
  v_and_b32 v145, 1, v145
  v_cmp_eq_u32 s[54:55], 1, v145
  s_nop 1
  s_and_b64 s[52:53], s[54:55], s[58:59]
  s_andn2_b64 s[54:55], s[54:55], s[58:59]
  s_mov_b32 s16, s12
  s_mov_b32 s17, s13
  s_lshl_b32 s62, s84, 9
  v_lshl_add_u32 v98, v97, 1, v96
  buffer_load_short_d16_hi v112, v98, s[32:35], s62 offen
  buffer_load_short_d16_hi v113, v98, s[28:31], s62 offen
  v_mov_b32 v232, v3
L_k_keep:
  v_mad_u32_u24 v92, v97, s63, v232
  v_add_u32 v93, 768, v92
  v_add_u32 v94, 4608, v92
  v_add_u32 v95, 7680, v92
  v_cndmask_b32 v92, v92, v105, s[52:53]
  v_cndmask_b32 v95, v95, v105, s[54:55]
  s_waitcnt vmcnt(20)
  s_cbranch_vccnz L_kw1_18
  s_waitcnt vmcnt(15)
L_kw1_18:
  buffer_load_dwordx4 v[4:7], v92, s[16:19], s61 offen offset:0 nt
  v_mfma_f32_16x16x16_bf16 v[224:227], v[220:221], v[172:173], v[224:227]
  v_pk_fma_f32 v[108:109], v[32:33], s[92:93], v[204:205] neg_lo:[0,0,1] neg_hi:[0,0,1]
  v_pk_fma_f32 v[110:111], v[34:35], s[92:93], v[206:207] neg_lo:[0,0,1] neg_hi:[0,0,1]
  v_cvt_pk_bf16_f32 v108, 0, v108
  v_cvt_pk_bf16_f32 v109, 0, v109
  v_cvt_pk_bf16_f32 v110, 0, v110
  v_cvt_pk_bf16_f32 v111, 0, v111
  v_pk_mul_f32 v[108:109], v[108:109], v[192:193]
  v_pk_mul_f32 v[110:111], v[110:111], v[194:195]
  v_cvt_pk_bf16_f32 v216, v108, v109
  v_cvt_pk_bf16_f32 v217, v110, v111
  s_waitcnt vmcnt(20)
  buffer_load_dwordx4 v[8:11], v92, s[16:19], s61 offen offset:256 nt
  v_pk_fma_f32 v[108:109], v[36:37], s[92:93], v[208:209] neg_lo:[0,0,1] neg_hi:[0,0,1]
  v_pk_fma_f32 v[110:111], v[38:39], s[92:93], v[210:211] neg_lo:[0,0,1] neg_hi:[0,0,1]
  v_mov_b32_dpp v144, v224 quad_perm:[0,0,0,0] row_mask:0xf bank_mask:0xf
  v_mov_b32_dpp v145, v226 quad_perm:[2,2,2,2] row_mask:0xf bank_mask:0xf
  v_cvt_pk_bf16_f32 v108, 0, v108
  v_cvt_pk_bf16_f32 v109, 0, v109
  v_add_f32_dpp v144, v225, v144 quad_perm:[1,1,1,1] row_mask:0xf bank_mask:0xf
  v_add_f32_dpp v145, v227, v145 quad_perm:[3,3,3,3] row_mask:0xf bank_mask:0xf
  v_cvt_pk_bf16_f32 v110, 0, v110
  v_cvt_pk_bf16_f32 v111, 0, v111
  v_add_f32 v229, v144, v145
  v_pk_mul_f32 v[108:109], v[108:109], v[196:197]
  v_pk_mul_f32 v[110:111], v[110:111], v[198:199]
  v_cvt_pk_bf16_f32 v218, v108, v109
  v_cvt_pk_bf16_f32 v219, v110, v111
  s_waitcnt vmcnt(20)
  buffer_load_dwordx4 v[12:15], v92, s[16:19], s61 offen offset:512 nt
  v_mfma_f32_16x16x32_bf16 v[224:227], v[216:219], v[168:171], 0
  v_pk_fma_f32 v[108:109], v[40:41], s[92:93], v[212:213] neg_lo:[0,0,1] neg_hi:[0,0,1]
  v_pk_fma_f32 v[110:111], v[42:43], s[92:93], v[214:215] neg_lo:[0,0,1] neg_hi:[0,0,1]
  v_cvt_pk_bf16_f32 v108, 0, v108
  v_cvt_pk_bf16_f32 v228, 0, v228
  v_cvt_pk_bf16_f32 v109, 0, v109
  v_cvt_pk_bf16_f32 v229, 0, v229
  v_cvt_pk_bf16_f32 v110, 0, v110
  v_pk_mul_f32 v[228:229], v[228:229], s[68:69]
  v_cvt_pk_bf16_f32 v111, 0, v111
  v_cvt_pk_bf16_f32 v122, v228, v229
  v_pk_mul_f32 v[108:109], v[108:109], v[200:201]
  v_pk_mul_f32 v[110:111], v[110:111], v[202:203]
  v_cvt_pk_bf16_f32 v220, v108, v109
  v_cvt_pk_bf16_f32 v221, v110, v111
  s_waitcnt vmcnt(20)
  s_cbranch_vccnz L_kw1_21
  s_waitcnt vmcnt(15)
L_kw1_21:
  buffer_load_dwordx4 v[16:19], v93, s[16:19], s61 offen offset:0 nt
  v_mfma_f32_16x16x16_bf16 v[224:227], v[220:221], v[172:173], v[224:227]
  v_pk_fma_f32 v[108:109], v[44:45], s[92:93], v[204:205] neg_lo:[0,0,1] neg_hi:[0,0,1]
  v_pk_fma_f32 v[110:111], v[46:47], s[92:93], v[206:207] neg_lo:[0,0,1] neg_hi:[0,0,1]
  v_cvt_pk_bf16_f32 v108, 0, v108
  v_cvt_pk_bf16_f32 v109, 0, v109
  v_cvt_pk_bf16_f32 v110, 0, v110
  v_cvt_pk_bf16_f32 v111, 0, v111
  v_pk_mul_f32 v[108:109], v[108:109], v[192:193]
  v_pk_mul_f32 v[110:111], v[110:111], v[194:195]
  v_cvt_pk_bf16_f32 v216, v108, v109
  v_cvt_pk_bf16_f32 v217, v110, v111
  s_waitcnt vmcnt(20)
  buffer_load_dwordx4 v[20:23], v93, s[16:19], s61 offen offset:256 nt
  v_pk_fma_f32 v[108:109], v[48:49], s[92:93], v[208:209] neg_lo:[0,0,1] neg_hi:[0,0,1]
  v_pk_fma_f32 v[110:111], v[50:51], s[92:93], v[210:211] neg_lo:[0,0,1] neg_hi:[0,0,1]
  v_mov_b32_dpp v144, v224 quad_perm:[0,0,0,0] row_mask:0xf bank_mask:0xf
  v_mov_b32_dpp v145, v226 quad_perm:[2,2,2,2] row_mask:0xf bank_mask:0xf
  v_cvt_pk_bf16_f32 v108, 0, v108
  v_cvt_pk_bf16_f32 v109, 0, v109
  v_add_f32_dpp v144, v225, v144 quad_perm:[1,1,1,1] row_mask:0xf bank_mask:0xf
  v_add_f32_dpp v145, v227, v145 quad_perm:[3,3,3,3] row_mask:0xf bank_mask:0xf
  v_cvt_pk_bf16_f32 v110, 0, v110
  v_cvt_pk_bf16_f32 v111, 0, v111
  v_add_f32 v228, v144, v145
  v_pk_mul_f32 v[108:109], v[108:109], v[196:197]
  v_pk_mul_f32 v[110:111], v[110:111], v[198:199]
  v_cvt_pk_bf16_f32 v218, v108, v109
  v_cvt_pk_bf16_f32 v219, v110, v111
  s_waitcnt vmcnt(20)
  buffer_load_dwordx4 v[24:27], v93, s[16:19], s61 offen offset:512 nt
  v_mfma_f32_16x16x32_bf16 v[224:227], v[216:219], v[168:171], 0
  v_pk_fma_f32 v[108:109], v[52:53], s[92:93], v[212:213] neg_lo:[0,0,1] neg_hi:[0,0,1]
  v_pk_fma_f32 v[110:111], v[54:55], s[92:93], v[214:215] neg_lo:[0,0,1] neg_hi:[0,0,1]
  v_cvt_pk_bf16_f32 v108, 0, v108
  v_cvt_pk_bf16_f32 v109, 0, v109
  v_cvt_pk_bf16_f32 v110, 0, v110
  v_cvt_pk_bf16_f32 v111, 0, v111
  v_pk_mul_f32 v[108:109], v[108:109], v[200:201]
  v_pk_mul_f32 v[110:111], v[110:111], v[202:203]
  v_cvt_pk_bf16_f32 v220, v108, v109
  v_cvt_pk_bf16_f32 v221, v110, v111
  s_waitcnt vmcnt(20)
  s_cbranch_vccnz L_kw1_24
  s_waitcnt vmcnt(15)
L_kw1_24:
  buffer_load_dwordx4 v[28:31], v93, s[16:19], s61 offen offset:768 nt
  v_mfma_f32_16x16x16_bf16 v[224:227], v[220:221], v[172:173], v[224:227]
  v_pk_fma_f32 v[108:109], v[56:57], s[92:93], v[204:205] neg_lo:[0,0,1] neg_hi:[0,0,1]
  v_pk_fma_f32 v[110:111], v[58:59], s[92:93], v[206:207] neg_lo:[0,0,1] neg_hi:[0,0,1]
  v_cvt_pk_bf16_f32 v108, 0, v108
  v_cvt_pk_bf16_f32 v109, 0, v109
  v_cvt_pk_bf16_f32 v110, 0, v110
  v_cvt_pk_bf16_f32 v111, 0, v111
  v_pk_mul_f32 v[108:109], v[108:109], v[192:193]
  v_pk_mul_f32 v[110:111], v[110:111], v[194:195]
  v_cvt_pk_bf16_f32 v216, v108, v109
  v_cvt_pk_bf16_f32 v217, v110, v111
  s_waitcnt vmcnt(20)
  buffer_load_dwordx4 v[32:35], v93, s[16:19], s61 offen offset:1024 nt
  v_pk_fma_f32 v[108:109], v[60:61], s[92:93], v[208:209] neg_lo:[0,0,1] neg_hi:[0,0,1]
  v_pk_fma_f32 v[110:111], v[62:63], s[92:93], v[210:211] neg_lo:[0,0,1] neg_hi:[0,0,1]
  v_mov_b32_dpp v144, v224 quad_perm:[0,0,0,0] row_mask:0xf bank_mask:0xf
  v_mov_b32_dpp v145, v226 quad_perm:[2,2,2,2] row_mask:0xf bank_mask:0xf
  v_cvt_pk_bf16_f32 v108, 0, v108
  v_cvt_pk_bf16_f32 v109, 0, v109
  v_add_f32_dpp v144, v225, v144 quad_perm:[1,1,1,1] row_mask:0xf bank_mask:0xf
  v_add_f32_dpp v145, v227, v145 quad_perm:[3,3,3,3] row_mask:0xf bank_mask:0xf
  v_cvt_pk_bf16_f32 v110, 0, v110
  v_cvt_pk_bf16_f32 v111, 0, v111
  v_add_f32 v229, v144, v145
  v_pk_mul_f32 v[108:109], v[108:109], v[196:197]
  v_pk_mul_f32 v[110:111], v[110:111], v[198:199]
  v_cvt_pk_bf16_f32 v218, v108, v109
  v_cvt_pk_bf16_f32 v219, v110, v111
  s_waitcnt vmcnt(20)
  buffer_load_dwordx4 v[36:39], v93, s[16:19], s61 offen offset:1280 nt
  v_mfma_f32_16x16x32_bf16 v[224:227], v[216:219], v[168:171], 0
  v_pk_fma_f32 v[108:109], v[64:65], s[92:93], v[212:213] neg_lo:[0,0,1] neg_hi:[0,0,1]
  v_pk_fma_f32 v[110:111], v[66:67], s[92:93], v[214:215] neg_lo:[0,0,1] neg_hi:[0,0,1]
  v_cvt_pk_bf16_f32 v108, 0, v108
  v_cvt_pk_bf16_f32 v228, 0, v228
  v_cvt_pk_bf16_f32 v109, 0, v109
  v_cvt_pk_bf16_f32 v229, 0, v229
  v_cvt_pk_bf16_f32 v110, 0, v110
  v_pk_mul_f32 v[228:229], v[228:229], s[68:69]
  v_cvt_pk_bf16_f32 v111, 0, v111
  v_cvt_pk_bf16_f32 v123, v228, v229
  v_pk_mul_f32 v[108:109], v[108:109], v[200:201]
  v_pk_mul_f32 v[110:111], v[110:111], v[202:203]
  v_cvt_pk_bf16_f32 v220, v108, v109
  v_cvt_pk_bf16_f32 v221, v110, v111
  s_waitcnt vmcnt(20)
  s_cbranch_vccnz L_kw1_27
  s_waitcnt vmcnt(15)
L_kw1_27:
  buffer_load_dwordx4 v[40:43], v93, s[16:19], s61 offen offset:1536 nt
  v_mfma_f32_16x16x16_bf16 v[224:227], v[220:221], v[172:173], v[224:227]
  v_pk_fma_f32 v[108:109], v[68:69], s[92:93], v[204:205] neg_lo:[0,0,1] neg_hi:[0,0,1]
  v_pk_fma_f32 v[110:111], v[70:71], s[92:93], v[206:207] neg_lo:[0,0,1] neg_hi:[0,0,1]
  v_cvt_pk_bf16_f32 v108, 0, v108
  v_cvt_pk_bf16_f32 v109, 0, v109
  v_cvt_pk_bf16_f32 v110, 0, v110
  v_cvt_pk_bf16_f32 v111, 0, v111
  v_pk_mul_f32 v[108:109], v[108:109], v[192:193]
  v_pk_mul_f32 v[110:111], v[110:111], v[194:195]
  v_cvt_pk_bf16_f32 v216, v108, v109
  v_cvt_pk_bf16_f32 v217, v110, v111
  s_waitcnt vmcnt(20)
  buffer_load_dwordx4 v[44:47], v93, s[16:19], s61 offen offset:1792 nt
  v_pk_fma_f32 v[108:109], v[72:73], s[92:93], v[208:209] neg_lo:[0,0,1] neg_hi:[0,0,1]
  v_pk_fma_f32 v[110:111], v[74:75], s[92:93], v[210:211] neg_lo:[0,0,1] neg_hi:[0,0,1]
  v_mov_b32_dpp v144, v224 quad_perm:[0,0,0,0] row_mask:0xf bank_mask:0xf
  v_mov_b32_dpp v145, v226 quad_perm:[2,2,2,2] row_mask:0xf bank_mask:0xf
  v_cvt_pk_bf16_f32 v108, 0, v108
  v_cvt_pk_bf16_f32 v109, 0, v109
  v_add_f32_dpp v144, v225, v144 quad_perm:[1,1,1,1] row_mask:0xf bank_mask:0xf
  v_add_f32_dpp v145, v227, v145 quad_perm:[3,3,3,3] row_mask:0xf bank_mask:0xf
  v_cvt_pk_bf16_f32 v110, 0, v110
  v_cvt_pk_bf16_f32 v111, 0, v111
  v_add_f32 v228, v144, v145
  v_pk_mul_f32 v[108:109], v[108:109], v[196:197]
  v_pk_mul_f32 v[110:111], v[110:111], v[198:199]
  v_cvt_pk_bf16_f32 v218, v108, v109
  v_cvt_pk_bf16_f32 v219, v110, v111
  s_waitcnt vmcnt(20)
  buffer_load_dwordx4 v[48:51], v93, s[16:19], s61 offen offset:2048 nt
  v_mfma_f32_16x16x32_bf16 v[224:227], v[216:219], v[168:171], 0
  v_pk_fma_f32 v[108:109], v[76:77], s[92:93], v[212:213] neg_lo:[0,0,1] neg_hi:[0,0,1]
  v_pk_fma_f32 v[110:111], v[78:79], s[92:93], v[214:215] neg_lo:[0,0,1] neg_hi:[0,0,1]
  v_cvt_pk_bf16_f32 v108, 0, v108
  v_cvt_pk_bf16_f32 v109, 0, v109
  v_cvt_pk_bf16_f32 v110, 0, v110
  v_cvt_pk_bf16_f32 v111, 0, v111
  v_pk_mul_f32 v[108:109], v[108:109], v[200:201]
  v_pk_mul_f32 v[110:111], v[110:111], v[202:203]
  v_cvt_pk_bf16_f32 v220, v108, v109
  v_cvt_pk_bf16_f32 v221, v110, v111
  s_waitcnt vmcnt(20)
  s_cbranch_vccnz L_kw1_30
  s_waitcnt vmcnt(9)
L_kw1_30:
  buffer_load_dwordx4 v[52:55], v93, s[16:19], s61 offen offset:2304 nt
  v_mfma_f32_16x16x16_bf16 v[224:227], v[220:221], v[172:173], v[224:227]
  v_pk_fma_f32 v[108:109], v[80:81], s[92:93], v[204:205] neg_lo:[0,0,1] neg_hi:[0,0,1]
  v_pk_fma_f32 v[110:111], v[82:83], s[92:93], v[206:207] neg_lo:[0,0,1] neg_hi:[0,0,1]
  v_cvt_pk_bf16_f32 v108, 0, v108
  v_cvt_pk_bf16_f32 v109, 0, v109
  v_cvt_pk_bf16_f32 v110, 0, v110
  v_cvt_pk_bf16_f32 v111, 0, v111
  v_pk_mul_f32 v[108:109], v[108:109], v[192:193]
  v_pk_mul_f32 v[110:111], v[110:111], v[194:195]
  v_cvt_pk_bf16_f32 v216, v108, v109
  v_cvt_pk_bf16_f32 v217, v110, v111
  s_waitcnt vmcnt(20)
  buffer_load_dwordx4 v[56:59], v93, s[16:19], s61 offen offset:2560 nt
  v_pk_fma_f32 v[108:109], v[84:85], s[92:93], v[208:209] neg_lo:[0,0,1] neg_hi:[0,0,1]
  v_pk_fma_f32 v[110:111], v[86:87], s[92:93], v[210:211] neg_lo:[0,0,1] neg_hi:[0,0,1]
  v_mov_b32_dpp v144, v224 quad_perm:[0,0,0,0] row_mask:0xf bank_mask:0xf
  v_mov_b32_dpp v145, v226 quad_perm:[2,2,2,2] row_mask:0xf bank_mask:0xf
  v_cvt_pk_bf16_f32 v108, 0, v108
  v_cvt_pk_bf16_f32 v109, 0, v109
  v_add_f32_dpp v144, v225, v144 quad_perm:[1,1,1,1] row_mask:0xf bank_mask:0xf
  v_add_f32_dpp v145, v227, v145 quad_perm:[3,3,3,3] row_mask:0xf bank_mask:0xf
  v_cvt_pk_bf16_f32 v110, 0, v110
  v_cvt_pk_bf16_f32 v111, 0, v111
  v_add_f32 v229, v144, v145
  v_pk_mul_f32 v[108:109], v[108:109], v[196:197]
  v_pk_mul_f32 v[110:111], v[110:111], v[198:199]
  v_cvt_pk_bf16_f32 v218, v108, v109
  v_cvt_pk_bf16_f32 v219, v110, v111
  s_waitcnt vmcnt(20)
  buffer_load_dwordx4 v[60:63], v93, s[16:19], s61 offen offset:2816 nt
  v_mfma_f32_16x16x32_bf16 v[224:227], v[216:219], v[168:171], 0
  v_pk_fma_f32 v[108:109], v[88:89], s[92:93], v[212:213] neg_lo:[0,0,1] neg_hi:[0,0,1]
  v_pk_fma_f32 v[110:111], v[90:91], s[92:93], v[214:215] neg_lo:[0,0,1] neg_hi:[0,0,1]
  v_cvt_pk_bf16_f32 v108, 0, v108
  v_cvt_pk_bf16_f32 v228, 0, v228
  v_cvt_pk_bf16_f32 v109, 0, v109
  v_cvt_pk_bf16_f32 v229, 0, v229
  v_cvt_pk_bf16_f32 v110, 0, v110
  v_pk_mul_f32 v[228:229], v[228:229], s[68:69]
  v_cvt_pk_bf16_f32 v111, 0, v111
  v_cvt_pk_bf16_f32 v124, v228, v229
  v_pk_mul_f32 v[108:109], v[108:109], v[200:201]
  v_pk_mul_f32 v[110:111], v[110:111], v[202:203]
  v_cvt_pk_bf16_f32 v220, v108, v109
  v_cvt_pk_bf16_f32 v221, v110, v111
  s_mov_b32 s60, s61
  v_mov_b32 v146, s64
  v_mfma_f32_16x16x16_bf16 v[224:227], v[220:221], v[172:173], v[224:227]
  ds_write_b128 v99, v[120:123]
  v_add_u32 v99, 768, v99
  s_nop 5
  v_mov_b32_dpp v144, v224 quad_perm:[0,0,0,0] row_mask:0xf bank_mask:0xf
  v_mov_b32_dpp v145, v226 quad_perm:[2,2,2,2] row_mask:0xf bank_mask:0xf
  s_nop 0
  v_add_f32_dpp v144, v225, v144 quad_perm:[1,1,1,1] row_mask:0xf bank_mask:0xf
  v_add_f32_dpp v145, v227, v145 quad_perm:[3,3,3,3] row_mask:0xf bank_mask:0xf
  v_add_f32 v228, v144, v145
  v_cndmask_b32 v228, v228, v236, s[50:51]
  v_cvt_pk_bf16_f32 v228, 0, v228
  v_cvt_pk_bf16_f32 v229, 0, v229
  v_pk_mul_f32 v[228:229], v[228:229], s[68:69]
  v_cvt_pk_bf16_f32 v125, v228, v229
  ds_write_b64 v100, v[124:125] offset:256
  ds_write_b32 v104, v146
  v_add_u32 v100, 768, v100
  s_cmp_lt_u32 s64, 96
  s_cbranch_scc1 L_k
  v_subrev_u32 v99, 36864, v99
  v_subrev_u32 v100, 36864, v100
  s_mov_b32 s64, s3
  s_mov_b32 s88, s89
  s_mov_b32 s99, 0
  s_mov_b32 s36, s46
  s_and_b32 s37, s47, 0xffff
  s_cmp_lt_u32 s64, s99
  s_cbranch_scc1 L_v0_ok
L_v0_spin:
  v_mov_b32 v144, 61700
  ds_read_b32 v144, v144
  s_waitcnt lgkmcnt(0)
  v_readfirstlane_b32 s99, v144
  s_nop 1
  s_cmp_lt_u32 s64, s99
  s_cbranch_scc0 L_v0_spin
L_v0_ok:
  ds_read_b128 v[120:123], v99
  ds_read_b64 v[124:125], v100 offset:256
  v_mov_b32 v128, 0
  v_mov_b32 v129, 0
  v_mov_b32 v130, 0
  v_mov_b32 v131, 0
  v_mov_b32 v132, 0
  v_mov_b32 v133, 0
  v_mov_b32 v134, 0
  v_mov_b32 v135, 0
  v_mov_b32 v136, 0
  v_mov_b32 v137, 0
  v_mov_b32 v138, 0
  v_mov_b32 v139, 0
  v_mov_b32 v140, 0xff800000
  v_mov_b32 v142, 0x7f800000
  v_mov_b32 v143, 0
L_v0:
  s_add_u32 s97, s64, 96
  v_mov_b32 v146, s97
  s_mov_b32 s86, s84
  s_mov_b32 s87, s85
  ds_write_b32 v104, v146
  s_add_u32 s64, s64, 2
  s_cmp_lt_u32 s64, s99
  s_cbranch_scc1 L_v10_ok
L_v10_spin:
  v_mov_b32 v144, 61700
  ds_read_b32 v144, v144
  s_waitcnt lgkmcnt(0)
  v_readfirstlane_b32 s99, v144
  s_nop 1
  s_cmp_lt_u32 s64, s99
  s_cbranch_scc0 L_v10_spin
L_v10_ok:
  s_lshr_b32 s71, s64, 5
  s_lshr_b32 s85, s96, s71
  s_bfe_u32 s85, s85, 0x10003
  s_and_b32 s70, s64, 31
  s_lshl_b32 s71, s71, 12
  s_add_u32 s70, s70, s5
  s_add_u32 s70, s70, s71
  s_mul_hi_u32 s84, s70, s90
  s_lshr_b32 s84, s84, 1
  s_mul_i32 s71, s84, 3
  s_sub_u32 s70, s70, s71
  s_lshl3_add_u32 s85, s70, s85
  s_mul_i32 s61, s84, 196608
  s_lshr_b32 s89, s84, 4
  s_lshl_b32 s70, s85, 5
  v_add_u32 v97, s70, v1
  v_mul_u32_u24 v97, 21846, v97
  v_lshrrev_b32 v97, 16, v97
  v_add_u32 v144, s85, v2
  v_lshrrev_b32 v145, v144, s91
  v_and_b32 v145, 1, v145
  v_cmp_eq_u32 s[54:55], 1, v145
  s_nop 1
  s_and_b64 s[52:53], s[54:55], s[58:59]
  s_andn2_b64 s[54:55], s[54:55], s[58:59]
  s_cmp_lt_u32 s64, 96
  s_cselect_b32 s61, s61, 805306368
  ds_read_b32 v106, v104 offset:8
  s_waitcnt vmcnt(14)
  s_cbranch_vccnz L_vw0_0
  s_waitcnt vmcnt(9)
L_vw0_0:
  buffer_load_dwordx4 v[64:67], v93, s[12:15], s60 offen offset:3072 nt
  v_mul_f32 v114, s94, v112
  v_mul_f32 v115, 0x4a800000, v113
  s_nop 0
  v_mov_b32_dpp v116, v114 row_newbcast:0 row_mask:0xf bank_mask:0xf
  v_mov_b32_dpp v117, v115 row_newbcast:0 row_mask:0xf bank_mask:0xf
  v_pk_fma_f32 v[192:193], v[4:5], s[92:93], v[116:117] op_sel_hi:[1,1,0] neg_lo:[0,0,1] neg_hi:[0,0,1]
  v_pk_fma_f32 v[194:195], v[6:7], s[92:93], v[116:117] op_sel_hi:[1,1,0] neg_lo:[0,0,1] neg_hi:[0,0,1]
  v_cvt_pk_bf16_f32 v192, 0, v192
  v_cvt_pk_bf16_f32 v193, 0, v193
  v_cvt_pk_bf16_f32 v194, 0, v194
  v_cvt_pk_bf16_f32 v195, 0, v195
  v_pk_mul_f32 v[192:193], v[192:193], v[116:117] op_sel:[0,1]
  v_pk_mul_f32 v[194:195], v[194:195], v[116:117] op_sel:[0,1]
  s_waitcnt lgkmcnt(0)
  v_cmp_lt_u32 vcc, s97, v106
  s_waitcnt vmcnt(14)
  buffer_load_dwordx4 v[68:71], v93, s[12:15], s60 offen offset:3328 nt
  v_pk_fma_f32 v[196:197], v[8:9], s[92:93], v[116:117] op_sel_hi:[1,1,0] neg_lo:[0,0,1] neg_hi:[0,0,1]
  v_pk_fma_f32 v[198:199], v[10:11], s[92:93], v[116:117] op_sel_hi:[1,1,0] neg_lo:[0,0,1] neg_hi:[0,0,1]
  v_cvt_pk_bf16_f32 v196, 0, v196
  v_lshlrev_b32 v148, 16, v120
  v_cvt_pk_bf16_f32 v197, 0, v197
  v_and_b32 v149, s65, v120
  v_cvt_pk_bf16_f32 v198, 0, v198
  v_lshlrev_b32 v150, 16, v121
  v_cvt_pk_bf16_f32 v199, 0, v199
  v_and_b32 v151, s65, v121
  v_pk_mul_f32 v[196:197], v[196:197], v[116:117] op_sel:[0,1]
  v_lshlrev_b32 v152, 16, v122
  v_pk_mul_f32 v[198:199], v[198:199], v[116:117] op_sel:[0,1]
  s_waitcnt vmcnt(14)
  buffer_load_dwordx4 v[72:75], v93, s[12:15], s60 offen offset:3584 nt
  v_pk_fma_f32 v[200:201], v[12:13], s[92:93], v[116:117] op_sel_hi:[1,1,0] neg_lo:[0,0,1] neg_hi:[0,0,1]
  v_pk_fma_f32 v[202:203], v[14:15], s[92:93], v[116:117] op_sel_hi:[1,1,0] neg_lo:[0,0,1] neg_hi:[0,0,1]
  v_cvt_pk_bf16_f32 v200, 0, v200
  v_and_b32 v153, s65, v122
  v_cvt_pk_bf16_f32 v201, 0, v201
  v_lshlrev_b32 v154, 16, v123
  v_cvt_pk_bf16_f32 v202, 0, v202
  v_and_b32 v155, s65, v123
  v_cvt_pk_bf16_f32 v203, 0, v203
  v_lshlrev_b32 v156, 16, v124
  v_pk_mul_f32 v[200:201], v[200:201], v[116:117] op_sel:[0,1]
  v_and_b32 v157, s65, v124
  v_pk_mul_f32 v[202:203], v[202:203], v[116:117] op_sel:[0,1]
  s_waitcnt vmcnt(14)
  s_cbranch_vccnz L_vw0_3
  s_waitcnt vmcnt(9)
L_vw0_3:
  buffer_load_dwordx4 v[76:79], v94, s[12:15], s60 offen offset:0 nt
  v_mov_b32_dpp v116, v114 row_newbcast:1 row_mask:0xf bank_mask:0xf
  v_mov_b32_dpp v117, v115 row_newbcast:1 row_mask:0xf bank_mask:0xf
  v_pk_fma_f32 v[108:109], v[16:17], s[92:93], v[116:117] op_sel_hi:[1,1,0] neg_lo:[0,0,1] neg_hi:[0,0,1]
  v_pk_fma_f32 v[110:111], v[18:19], s[92:93], v[116:117] op_sel_hi:[1,1,0] neg_lo:[0,0,1] neg_hi:[0,0,1]
  s_lshl_b32 s62, s84, 9
  v_lshl_add_u32 v98, v97, 1, v96
  buffer_load_short_d16_hi v112, v98, s[32:35], s62 offen
  buffer_load_short_d16_hi v113, v98, s[28:31], s62 offen
  v_cvt_pk_bf16_f32 v108, 0, v108
  v_lshlrev_b32 v158, 16, v125
  v_cvt_pk_bf16_f32 v109, 0, v109
  v_add_u32 v99, 768, v99
  v_cvt_pk_bf16_f32 v110, 0, v110
  v_add_u32 v100, 768, v100
  v_cvt_pk_bf16_f32 v111, 0, v111
  v_max3_f32 v144, v148, v149, v150
  v_pk_mul_f32 v[108:109], v[108:109], v[116:117] op_sel:[0,1]
  ds_read_b128 v[120:123], v99
  v_pk_mul_f32 v[110:111], v[110:111], v[116:117] op_sel:[0,1]
  v_cvt_pk_bf16_f32 v204, v192, v108
  v_cvt_pk_bf16_f32 v208, v193, v109
  v_cvt_pk_bf16_f32 v212, v194, v110
  v_cvt_pk_bf16_f32 v216, v195, v111
  s_waitcnt vmcnt(16)
  buffer_load_dwordx4 v[80:83], v94, s[12:15], s60 offen offset:256 nt
  v_pk_fma_f32 v[108:109], v[20:21], s[92:93], v[116:117] op_sel_hi:[1,1,0] neg_lo:[0,0,1] neg_hi:[0,0,1]
  v_pk_fma_f32 v[110:111], v[22:23], s[92:93], v[116:117] op_sel_hi:[1,1,0] neg_lo:[0,0,1] neg_hi:[0,0,1]
  v_cvt_pk_bf16_f32 v108, 0, v108
  ds_read_b64 v[124:125], v100 offset:256
  v_cvt_pk_bf16_f32 v109, 0, v109
  v_max3_f32 v145, v151, v152, v153
  v_cvt_pk_bf16_f32 v110, 0, v110
  v_max3_f32 v144, v144, v154, v155
  v_cvt_pk_bf16_f32 v111, 0, v111
  v_max3_f32 v145, v145, v156, v157
  v_pk_mul_f32 v[108:109], v[108:109], v[116:117] op_sel:[0,1]
  v_max3_f32 v144, v144, v158, v140
  v_pk_mul_f32 v[110:111], v[110:111], v[116:117] op_sel:[0,1]
  v_cvt_pk_bf16_f32 v220, v196, v108
  v_cvt_pk_bf16_f32 v224, v197, v109
  v_cvt_pk_bf16_f32 v228, v198, v110
  v_cvt_pk_bf16_f32 v232, v199, v111
  s_waitcnt vmcnt(16)
  buffer_load_dwordx4 v[84:87], v94, s[12:15], s60 offen offset:512 nt
  v_pk_fma_f32 v[108:109], v[24:25], s[92:93], v[116:117] op_sel_hi:[1,1,0] neg_lo:[0,0,1] neg_hi:[0,0,1]
  v_pk_fma_f32 v[110:111], v[26:27], s[92:93], v[116:117] op_sel_hi:[1,1,0] neg_lo:[0,0,1] neg_hi:[0,0,1]
  v_cvt_pk_bf16_f32 v108, 0, v108
  v_max_f32 v144, v144, v145
  v_cvt_pk_bf16_f32 v109, 0, v109
  v_mov_b32 v145, v144
  v_cvt_pk_bf16_f32 v110, 0, v110
  s_nop 0
  v_permlane32_swap_b32 v144, v145
  v_cvt_pk_bf16_f32 v111, 0, v111
  v_max_f32 v144, v144, v145
  v_pk_mul_f32 v[108:109], v[108:109], v[116:117] op_sel:[0,1]
  v_mov_b32 v145, v144
  v_pk_mul_f32 v[110:111], v[110:111], v[116:117] op_sel:[0,1]
  v_cvt_pk_bf16_f32 v236, v200, v108
  v_cvt_pk_bf16_f32 v240, v201, v109
  v_cvt_pk_bf16_f32 v244, v202, v110
  v_cvt_pk_bf16_f32 v248, v203, v111
  s_waitcnt vmcnt(16)
  s_cbranch_vccnz L_vw0_6
  s_waitcnt vmcnt(11)
L_vw0_6:
  buffer_load_dwordx4 v[88:91], v94, s[12:15], s60 offen offset:768 nt
  v_mov_b32_dpp v116, v114 row_newbcast:2 row_mask:0xf bank_mask:0xf
  v_mov_b32_dpp v117, v115 row_newbcast:2 row_mask:0xf bank_mask:0xf
  v_pk_fma_f32 v[192:193], v[28:29], s[92:93], v[116:117] op_sel_hi:[1,1,0] neg_lo:[0,0,1] neg_hi:[0,0,1]
  v_pk_fma_f32 v[194:195], v[30:31], s[92:93], v[116:117] op_sel_hi:[1,1,0] neg_lo:[0,0,1] neg_hi:[0,0,1]
  v_cvt_pk_bf16_f32 v192, 0, v192
  v_permlane16_swap_b32 v144, v145
  v_cvt_pk_bf16_f32 v193, 0, v193
  v_max_f32 v140, v144, v145
  v_cvt_pk_bf16_f32 v194, 0, v194
  v_mul_f32 v144, s66, v140
  v_cvt_pk_bf16_f32 v195, 0, v195
  v_add_f32 v146, v144, v142
  v_pk_mul_f32 v[192:193], v[192:193], v[116:117] op_sel:[0,1]
  v_sub_f32 v142, 0, v144
  v_pk_mul_f32 v[194:195], v[194:195], v[116:117] op_sel:[0,1]
  s_waitcnt vmcnt(16)
  buffer_load_dwordx4 v[4:7], v94, s[12:15], s60 offen offset:1024 nt
  v_pk_fma_f32 v[196:197], v[32:33], s[92:93], v[116:117] op_sel_hi:[1,1,0] neg_lo:[0,0,1] neg_hi:[0,0,1]
  v_pk_fma_f32 v[198:199], v[34:35], s[92:93], v[116:117] op_sel_hi:[1,1,0] neg_lo:[0,0,1] neg_hi:[0,0,1]
  v_cvt_pk_bf16_f32 v196, 0, v196
  v_exp_f32 v146, -v146
  v_cvt_pk_bf16_f32 v197, 0, v197
  ds_bpermute_b32 v147, v101, v146
  v_cvt_pk_bf16_f32 v198, 0, v198
  v_fma_f32 v148, v148, s66, v142
  v_cvt_pk_bf16_f32 v199, 0, v199
  v_exp_f32 v148, v148
  v_pk_mul_f32 v[196:197], v[196:197], v[116:117] op_sel:[0,1]
  v_fma_f32 v149, v149, s66, v142
  v_pk_mul_f32 v[198:199], v[198:199], v[116:117] op_sel:[0,1]
  s_waitcnt vmcnt(16)
  buffer_load_dwordx4 v[8:11], v94, s[12:15], s60 offen offset:1280 nt
  v_pk_fma_f32 v[200:201], v[36:37], s[92:93], v[116:117] op_sel_hi:[1,1,0] neg_lo:[0,0,1] neg_hi:[0,0,1]
  v_pk_fma_f32 v[202:203], v[38:39], s[92:93], v[116:117] op_sel_hi:[1,1,0] neg_lo:[0,0,1] neg_hi:[0,0,1]
  v_cvt_pk_bf16_f32 v200, 0, v200
  v_exp_f32 v149, v149
  v_cvt_pk_bf16_f32 v201, 0, v201
  v_fma_f32 v150, v150, s66, v142
  v_cvt_pk_bf16_f32 v202, 0, v202
  v_exp_f32 v150, v150
  v_cvt_pk_bf16_f32 v203, 0, v203
  v_fma_f32 v151, v151, s66, v142
  v_pk_mul_f32 v[200:201], v[200:201], v[116:117] op_sel:[0,1]
  v_exp_f32 v151, v151
  v_pk_mul_f32 v[202:203], v[202:203], v[116:117] op_sel:[0,1]
  s_waitcnt vmcnt(16)
  s_cbranch_vccnz L_vw0_9
  s_waitcnt vmcnt(11)
L_vw0_9:
  buffer_load_dwordx4 v[12:15], v94, s[12:15], s60 offen offset:1536 nt
  v_mov_b32_dpp v116, v114 row_newbcast:3 row_mask:0xf bank_mask:0xf
  v_mov_b32_dpp v117, v115 row_newbcast:3 row_mask:0xf bank_mask:0xf
  v_pk_fma_f32 v[108:109], v[40:41], s[92:93], v[116:117] op_sel_hi:[1,1,0] neg_lo:[0,0,1] neg_hi:[0,0,1]
  v_pk_fma_f32 v[110:111], v[42:43], s[92:93], v[116:117] op_sel_hi:[1,1,0] neg_lo:[0,0,1] neg_hi:[0,0,1]
  v_cvt_pk_bf16_f32 v108, 0, v108
  v_fma_f32 v152, v152, s66, v142
  v_cvt_pk_bf16_f32 v109, 0, v109
  v_exp_f32 v152, v152
  v_cvt_pk_bf16_f32 v110, 0, v110
  v_fma_f32 v153, v153, s66, v142
  v_cvt_pk_bf16_f32 v111, 0, v111
  v_exp_f32 v153, v153
  v_pk_mul_f32 v[108:109], v[108:109], v[116:117] op_sel:[0,1]
  v_fma_f32 v154, v154, s66, v142
  v_pk_mul_f32 v[110:111], v[110:111], v[116:117] op_sel:[0,1]
  v_cvt_pk_bf16_f32 v205, v192, v108
  v_cvt_pk_bf16_f32 v209, v193, v109
  v_cvt_pk_bf16_f32 v213, v194, v110
  v_cvt_pk_bf16_f32 v217, v195, v111
  s_waitcnt vmcnt(16)
  buffer_load_dwordx4 v[16:19], v94, s[12:15], s60 offen offset:1792 nt
  v_pk_fma_f32 v[108:109], v[44:45], s[92:93], v[116:117] op_sel_hi:[1,1,0] neg_lo:[0,0,1] neg_hi:[0,0,1]
  v_pk_fma_f32 v[110:111], v[46:47], s[92:93], v[116:117] op_sel_hi:[1,1,0] neg_lo:[0,0,1] neg_hi:[0,0,1]
  v_cvt_pk_bf16_f32 v108, 0, v108
  v_exp_f32 v154, v154
  v_cvt_pk_bf16_f32 v109, 0, v109
  v_fma_f32 v155, v155, s66, v142
  v_cvt_pk_bf16_f32 v110, 0, v110
  v_exp_f32 v155, v155
  v_cvt_pk_bf16_f32 v111, 0, v111
  v_fma_f32 v156, v156, s66, v142
  v_pk_mul_f32 v[108:109], v[108:109], v[116:117] op_sel:[0,1]
  v_exp_f32 v156, v156
  v_pk_mul_f32 v[110:111], v[110:111], v[116:117] op_sel:[0,1]
  v_cvt_pk_bf16_f32 v221, v196, v108
  v_cvt_pk_bf16_f32 v225, v197, v109
  v_cvt_pk_bf16_f32 v229, v198, v110
  v_cvt_pk_bf16_f32 v233, v199, v111
  s_waitcnt vmcnt(16)
  buffer_load_dwordx4 v[20:23], v94, s[12:15], s60 offen offset:2048 nt
  v_pk_fma_f32 v[108:109], v[48:49], s[92:93], v[116:117] op_sel_hi:[1,1,0] neg_lo:[0,0,1] neg_hi:[0,0,1]
  v_pk_fma_f32 v[110:111], v[50:51], s[92:93], v[116:117] op_sel_hi:[1,1,0] neg_lo:[0,0,1] neg_hi:[0,0,1]
  v_cvt_pk_bf16_f32 v108, 0, v108
  v_fma_f32 v157, v157, s66, v142
  v_cvt_pk_bf16_f32 v109, 0, v109
  v_exp_f32 v157, v157
  v_cvt_pk_bf16_f32 v110, 0, v110
  v_fma_f32 v158, v158, s66, v142
  v_cvt_pk_bf16_f32 v111, 0, v111
  v_exp_f32 v158, v158
  v_pk_mul_f32 v[108:109], v[108:109], v[116:117] op_sel:[0,1]
  v_add_f32 v144, v148, v149
  v_pk_mul_f32 v[110:111], v[110:111], v[116:117] op_sel:[0,1]
  v_cvt_pk_bf16_f32 v237, v200, v108
  v_cvt_pk_bf16_f32 v241, v201, v109
  v_cvt_pk_bf16_f32 v245, v202, v110
  v_cvt_pk_bf16_f32 v249, v203, v111
  s_waitcnt vmcnt(16)
  s_cbranch_vccnz L_vw0_12
  s_waitcnt vmcnt(11)
L_vw0_12:
  buffer_load_dwordx4 v[24:27], v94, s[12:15], s60 offen offset:2304 nt
  v_mov_b32_dpp v116, v114 row_newbcast:4 row_mask:0xf bank_mask:0xf
  v_mov_b32_dpp v117, v115 row_newbcast:4 row_mask:0xf bank_mask:0xf
  v_pk_fma_f32 v[192:193], v[52:53], s[92:93], v[116:117] op_sel_hi:[1,1,0] neg_lo:[0,0,1] neg_hi:[0,0,1]
  v_pk_fma_f32 v[194:195], v[54:55], s[92:93], v[116:117] op_sel_hi:[1,1,0] neg_lo:[0,0,1] neg_hi:[0,0,1]
  v_cvt_pk_bf16_f32 v192, 0, v192
  v_add_f32 v145, v150, v151
  v_cvt_pk_bf16_f32 v193, 0, v193
  v_add_f32 v144, v144, v152
  v_cvt_pk_bf16_f32 v194, 0, v194
  v_add_f32 v145, v145, v153
  v_cvt_pk_bf16_f32 v195, 0, v195
  v_add_f32 v144, v144, v154
  v_pk_mul_f32 v[192:193], v[192:193], v[116:117] op_sel:[0,1]
  v_add_f32 v145, v145, v155
  v_pk_mul_f32 v[194:195], v[194:195], v[116:117] op_sel:[0,1]
  s_waitcnt vmcnt(16)
  buffer_load_dwordx4 v[28:31], v94, s[12:15], s60 offen offset:2560 nt
  v_pk_fma_f32 v[196:197], v[56:57], s[92:93], v[116:117] op_sel_hi:[1,1,0] neg_lo:[0,0,1] neg_hi:[0,0,1]
  v_pk_fma_f32 v[198:199], v[58:59], s[92:93], v[116:117] op_sel_hi:[1,1,0] neg_lo:[0,0,1] neg_hi:[0,0,1]
  v_cvt_pk_bf16_f32 v196, 0, v196
  v_add_f32 v144, v144, v156
  v_cvt_pk_bf16_f32 v197, 0, v197
  v_add_f32 v145, v145, v157
  v_cvt_pk_bf16_f32 v198, 0, v198
  v_add_f32 v144, v144, v158
  v_cvt_pk_bf16_f32 v199, 0, v199
  v_add_f32 v144, v144, v145
  v_pk_mul_f32 v[196:197], v[196:197], v[116:117] op_sel:[0,1]
  v_fma_f32 v143, v143, v146, v144
  v_pk_mul_f32 v[198:199], v[198:199], v[116:117] op_sel:[0,1]
  s_waitcnt vmcnt(16)
  buffer_load_dwordx4 v[32:35], v94, s[12:15], s60 offen offset:2816 nt
  v_pk_fma_f32 v[200:201], v[60:61], s[92:93], v[116:117] op_sel_hi:[1,1,0] neg_lo:[0,0,1] neg_hi:[0,0,1]
  v_pk_fma_f32 v[202:203], v[62:63], s[92:93], v[116:117] op_sel_hi:[1,1,0] neg_lo:[0,0,1] neg_hi:[0,0,1]
  v_cvt_pk_bf16_f32 v200, 0, v200
  v_cvt_pk_bf16_f32 v159, v148, v149
  v_cvt_pk_bf16_f32 v201, 0, v201
  v_cvt_pk_bf16_f32 v160, v150, v151
  v_cvt_pk_bf16_f32 v202, 0, v202
  v_cvt_pk_bf16_f32 v161, v152, v153
  v_cvt_pk_bf16_f32 v203, 0, v203
  v_cvt_pk_bf16_f32 v162, v154, v155
  v_pk_mul_f32 v[200:201], v[200:201], v[116:117] op_sel:[0,1]
  v_cvt_pk_bf16_f32 v163, v156, v157
  v_pk_mul_f32 v[202:203], v[202:203], v[116:117] op_sel:[0,1]
  s_waitcnt vmcnt(16)
  s_cbranch_vccnz L_vw0_15
  s_waitcnt vmcnt(9)
L_vw0_15:
  buffer_load_dwordx4 v[36:39], v95, s[12:15], s60 offen offset:0 nt
  v_mov_b32_dpp v116, v114 row_newbcast:5 row_mask:0xf bank_mask:0xf
  v_mov_b32_dpp v117, v115 row_newbcast:5 row_mask:0xf bank_mask:0xf
  v_pk_fma_f32 v[108:109], v[64:65], s[92:93], v[116:117] op_sel_hi:[1,1,0] neg_lo:[0,0,1] neg_hi:[0,0,1]
  v_pk_fma_f32 v[110:111], v[66:67], s[92:93], v[116:117] op_sel_hi:[1,1,0] neg_lo:[0,0,1] neg_hi:[0,0,1]
  v_cvt_pk_bf16_f32 v108, 0, v108
  v_cvt_pk_bf16_f32 v164, v158, 0
  v_cvt_pk_bf16_f32 v109, 0, v109
  v_cndmask_b32 v168, 0, v159, s[72:73]
  v_cvt_pk_bf16_f32 v110, 0, v110
  v_cndmask_b32 v169, 0, v160, s[72:73]
  v_cvt_pk_bf16_f32 v111, 0, v111
  v_cndmask_b32 v170, 0, v161, s[72:73]
  v_pk_mul_f32 v[108:109], v[108:109], v[116:117] op_sel:[0,1]
  v_cndmask_b32 v171, 0, v162, s[72:73]
  v_pk_mul_f32 v[110:111], v[110:111], v[116:117] op_sel:[0,1]
  v_cvt_pk_bf16_f32 v206, v192, v108
  v_cvt_pk_bf16_f32 v210, v193, v109
  v_cvt_pk_bf16_f32 v214, v194, v110
  v_cvt_pk_bf16_f32 v218, v195, v111
  s_waitcnt vmcnt(16)
  buffer_load_dwordx4 v[40:43], v95, s[12:15], s60 offen offset:256 nt
  v_pk_fma_f32 v[108:109], v[68:69], s[92:93], v[116:117] op_sel_hi:[1,1,0] neg_lo:[0,0,1] neg_hi:[0,0,1]
  v_pk_fma_f32 v[110:111], v[70:71], s[92:93], v[116:117] op_sel_hi:[1,1,0] neg_lo:[0,0,1] neg_hi:[0,0,1]
  v_cvt_pk_bf16_f32 v108, 0, v108
  v_cndmask_b32 v172, 0, v159, s[74:75]
  v_cvt_pk_bf16_f32 v109, 0, v109
  v_cndmask_b32 v173, 0, v160, s[74:75]
  v_cvt_pk_bf16_f32 v110, 0, v110
  v_cndmask_b32 v174, 0, v161, s[74:75]
  v_cvt_pk_bf16_f32 v111, 0, v111
  v_cndmask_b32 v175, 0, v162, s[74:75]
  v_pk_mul_f32 v[108:109], v[108:109], v[116:117] op_sel:[0,1]
  v_cndmask_b32 v176, 0, v159, s[76:77]
  v_pk_mul_f32 v[110:111], v[110:111], v[116:117] op_sel:[0,1]
  v_cvt_pk_bf16_f32 v222, v196, v108
  v_cvt_pk_bf16_f32 v226, v197, v109
  v_cvt_pk_bf16_f32 v230, v198, v110
  v_cvt_pk_bf16_f32 v234, v199, v111
  s_waitcnt vmcnt(16)
  buffer_load_dwordx4 v[44:47], v95, s[12:15], s60 offen offset:512 nt
  v_pk_fma_f32 v[108:109], v[72:73], s[92:93], v[116:117] op_sel_hi:[1,1,0] neg_lo:[0,0,1] neg_hi:[0,0,1]
  v_pk_fma_f32 v[110:111], v[74:75], s[92:93], v[116:117] op_sel_hi:[1,1,0] neg_lo:[0,0,1] neg_hi:[0,0,1]
  v_cvt_pk_bf16_f32 v108, 0, v108
  v_cndmask_b32 v177, 0, v160, s[76:77]
  v_cvt_pk_bf16_f32 v109, 0, v109
  v_cndmask_b32 v178, 0, v161, s[76:77]
  v_cvt_pk_bf16_f32 v110, 0, v110
  v_cndmask_b32 v179, 0, v162, s[76:77]
  v_cvt_pk_bf16_f32 v111, 0, v111
  v_cndmask_b32 v180, 0, v159, s[78:79]
  v_pk_mul_f32 v[108:109], v[108:109], v[116:117] op_sel:[0,1]
  v_cndmask_b32 v181, 0, v160, s[78:79]
  v_pk_mul_f32 v[110:111], v[110:111], v[116:117] op_sel:[0,1]
  v_cvt_pk_bf16_f32 v238, v200, v108
  v_cvt_pk_bf16_f32 v242, v201, v109
  v_cvt_pk_bf16_f32 v246, v202, v110
  v_cvt_pk_bf16_f32 v250, v203, v111
  v_mad_u32_u24 v92, v97, s63, v3
  v_add_u32 v93, 768, v92
  v_add_u32 v94, 4608, v92
  v_add_u32 v95, 7680, v92
  v_cndmask_b32 v92, v92, v105, s[52:53]
  v_cndmask_b32 v95, v95, v105, s[54:55]
  s_waitcnt vmcnt(16)
  s_cbranch_vccnz L_vw0_18
  s_waitcnt vmcnt(9)
L_vw0_18:
  buffer_load_dwordx4 v[48:51], v92, s[12:15], s61 offen offset:0 nt
  v_mov_b32_dpp v116, v114 row_newbcast:6 row_mask:0xf bank_mask:0xf
  v_mov_b32_dpp v117, v115 row_newbcast:6 row_mask:0xf bank_mask:0xf
  v_pk_fma_f32 v[192:193], v[76:77], s[92:93], v[116:117] op_sel_hi:[1,1,0] neg_lo:[0,0,1] neg_hi:[0,0,1]
  v_pk_fma_f32 v[194:195], v[78:79], s[92:93], v[116:117] op_sel_hi:[1,1,0] neg_lo:[0,0,1] neg_hi:[0,0,1]
  v_cvt_pk_bf16_f32 v192, 0, v192
  v_cndmask_b32 v182, 0, v161, s[78:79]
  v_cvt_pk_bf16_f32 v193, 0, v193
  v_cndmask_b32 v183, 0, v162, s[78:79]
  v_cvt_pk_bf16_f32 v194, 0, v194
  s_waitcnt lgkmcnt(0)
  v_cvt_pk_bf16_f32 v195, 0, v195
  v_mul_f32 v128, v147, v128
  v_pk_mul_f32 v[192:193], v[192:193], v[116:117] op_sel:[0,1]
  v_mul_f32 v129, v147, v129
  v_pk_mul_f32 v[194:195], v[194:195], v[116:117] op_sel:[0,1]
  s_waitcnt vmcnt(14)
  buffer_load_dwordx4 v[52:55], v92, s[12:15], s61 offen offset:256 nt
  v_pk_fma_f32 v[196:197], v[80:81], s[92:93], v[116:117] op_sel_hi:[1,1,0] neg_lo:[0,0,1] neg_hi:[0,0,1]
  v_pk_fma_f32 v[198:199], v[82:83], s[92:93], v[116:117] op_sel_hi:[1,1,0] neg_lo:[0,0,1] neg_hi:[0,0,1]
  v_cvt_pk_bf16_f32 v196, 0, v196
  v_mul_f32 v130, v147, v130
  v_cvt_pk_bf16_f32 v197, 0, v197
  v_mul_f32 v131, v147, v131
  v_cvt_pk_bf16_f32 v198, 0, v198
  v_mul_f32 v132, v147, v132
  v_cvt_pk_bf16_f32 v199, 0, v199
  v_mul_f32 v133, v147, v133
  v_pk_mul_f32 v[196:197], v[196:197], v[116:117] op_sel:[0,1]
  v_mul_f32 v134, v147, v134
  v_pk_mul_f32 v[198:199], v[198:199], v[116:117] op_sel:[0,1]
  s_waitcnt vmcnt(14)
  buffer_load_dwordx4 v[56:59], v92, s[12:15], s61 offen offset:512 nt
  v_pk_fma_f32 v[200:201], v[84:85], s[92:93], v[116:117] op_sel_hi:[1,1,0] neg_lo:[0,0,1] neg_hi:[0,0,1]
  v_pk_fma_f32 v[202:203], v[86:87], s[92:93], v[116:117] op_sel_hi:[1,1,0] neg_lo:[0,0,1] neg_hi:[0,0,1]
  v_cvt_pk_bf16_f32 v200, 0, v200
  v_mul_f32 v135, v147, v135
  v_cvt_pk_bf16_f32 v201, 0, v201
  v_mul_f32 v136, v147, v136
  v_cvt_pk_bf16_f32 v202, 0, v202
  v_mul_f32 v137, v147, v137
  v_cvt_pk_bf16_f32 v203, 0, v203
  v_mul_f32 v138, v147, v138
  v_pk_mul_f32 v[200:201], v[200:201], v[116:117] op_sel:[0,1]
  v_mul_f32 v139, v147, v139
  v_pk_mul_f32 v[202:203], v[202:203], v[116:117] op_sel:[0,1]
  s_waitcnt vmcnt(14)
  s_cbranch_vccnz L_vw0_21
  s_waitcnt vmcnt(9)
L_vw0_21:
  buffer_load_dwordx4 v[60:63], v93, s[12:15], s61 offen offset:0 nt
  v_mov_b32_dpp v116, v114 row_newbcast:7 row_mask:0xf bank_mask:0xf
  v_mov_b32_dpp v117, v115 row_newbcast:7 row_mask:0xf bank_mask:0xf
  v_pk_fma_f32 v[108:109], v[88:89], s[92:93], v[116:117] op_sel_hi:[1,1,0] neg_lo:[0,0,1] neg_hi:[0,0,1]
  v_pk_fma_f32 v[110:111], v[90:91], s[92:93], v[116:117] op_sel_hi:[1,1,0] neg_lo:[0,0,1] neg_hi:[0,0,1]
  v_cvt_pk_bf16_f32 v108, 0, v108
  v_cvt_pk_bf16_f32 v109, 0, v109
  v_cvt_pk_bf16_f32 v110, 0, v110
  v_cvt_pk_bf16_f32 v111, 0, v111
  v_pk_mul_f32 v[108:109], v[108:109], v[116:117] op_sel:[0,1]
  v_pk_mul_f32 v[110:111], v[110:111], v[116:117] op_sel:[0,1]
  v_cvt_pk_bf16_f32 v207, v192, v108
  v_cvt_pk_bf16_f32 v211, v193, v109
  v_cvt_pk_bf16_f32 v215, v194, v110
  v_cvt_pk_bf16_f32 v219, v195, v111
  v_mfma_f32_16x16x32_bf16 v[128:131], v[168:171], v[204:207], v[128:131]
  v_mfma_f32_16x16x32_bf16 v[128:131], v[172:175], v[208:211], v[128:131]
  v_mfma_f32_16x16x32_bf16 v[128:131], v[176:179], v[212:215], v[128:131]
  v_mfma_f32_16x16x32_bf16 v[128:131], v[180:183], v[216:219], v[128:131]
  s_waitcnt vmcnt(14)
  buffer_load_dwordx4 v[64:67], v93, s[12:15], s61 offen offset:256 nt
  v_pk_fma_f32 v[108:109], v[4:5], s[92:93], v[116:117] op_sel_hi:[1,1,0] neg_lo:[0,0,1] neg_hi:[0,0,1]
  v_pk_fma_f32 v[110:111], v[6:7], s[92:93], v[116:117] op_sel_hi:[1,1,0] neg_lo:[0,0,1] neg_hi:[0,0,1]
  v_cvt_pk_bf16_f32 v108, 0, v108
  v_cvt_pk_bf16_f32 v109, 0, v109
  v_cvt_pk_bf16_f32 v110, 0, v110
  v_cvt_pk_bf16_f32 v111, 0, v111
  v_pk_mul_f32 v[108:109], v[108:109], v[116:117] op_sel:[0,1]
  v_pk_mul_f32 v[110:111], v[110:111], v[116:117] op_sel:[0,1]
  v_cvt_pk_bf16_f32 v223, v196, v108
  v_cvt_pk_bf16_f32 v227, v197, v109
  v_cvt_pk_bf16_f32 v231, v198, v110
  v_cvt_pk_bf16_f32 v235, v199, v111
  v_mfma_f32_16x16x32_bf16 v[132:135], v[168:171], v[220:223], v[132:135]
  v_mfma_f32_16x16x32_bf16 v[132:135], v[172:175], v[224:227], v[132:135]
  v_mfma_f32_16x16x32_bf16 v[132:135], v[176:179], v[228:231], v[132:135]
  v_mfma_f32_16x16x32_bf16 v[132:135], v[180:183], v[232:235], v[132:135]
  s_waitcnt vmcnt(14)
  buffer_load_dwordx4 v[68:71], v93, s[12:15], s61 offen offset:512 nt
  v_pk_fma_f32 v[108:109], v[8:9], s[92:93], v[116:117] op_sel_hi:[1,1,0] neg_lo:[0,0,1] neg_hi:[0,0,1]
  v_pk_fma_f32 v[110:111], v[10:11], s[92:93], v[116:117] op_sel_hi:[1,1,0] neg_lo:[0,0,1] neg_hi:[0,0,1]
  v_cvt_pk_bf16_f32 v108, 0, v108
  v_cvt_pk_bf16_f32 v109, 0, v109
  v_cvt_pk_bf16_f32 v110, 0, v110
  v_cvt_pk_bf16_f32 v111, 0, v111
  v_pk_mul_f32 v[108:109], v[108:109], v[116:117] op_sel:[0,1]
  v_pk_mul_f32 v[110:111], v[110:111], v[116:117] op_sel:[0,1]
  v_cvt_pk_bf16_f32 v239, v200, v108
  v_cvt_pk_bf16_f32 v243, v201, v109
  v_cvt_pk_bf16_f32 v247, v202, v110
  v_cvt_pk_bf16_f32 v251, v203, v111
  v_mfma_f32_16x16x32_bf16 v[136:139], v[168:171], v[236:239], v[136:139]
  v_mfma_f32_16x16x32_bf16 v[136:139], v[172:175], v[240:243], v[136:139]
  v_mfma_f32_16x16x32_bf16 v[136:139], v[176:179], v[244:247], v[136:139]
  v_mfma_f32_16x16x32_bf16 v[136:139], v[180:183], v[248:251], v[136:139]
  s_waitcnt vmcnt(14)
  s_cbranch_vccnz L_vw0_24
  s_waitcnt vmcnt(9)
L_vw0_24:
  buffer_load_dwordx4 v[72:75], v93, s[12:15], s61 offen offset:768 nt
  v_mov_b32_dpp v116, v114 row_newbcast:8 row_mask:0xf bank_mask:0xf
  v_mov_b32_dpp v117, v115 row_newbcast:8 row_mask:0xf bank_mask:0xf
  v_pk_fma_f32 v[192:193], v[12:13], s[92:93], v[116:117] op_sel_hi:[1,1,0] neg_lo:[0,0,1] neg_hi:[0,0,1]
  v_pk_fma_f32 v[194:195], v[14:15], s[92:93], v[116:117] op_sel_hi:[1,1,0] neg_lo:[0,0,1] neg_hi:[0,0,1]
  v_cvt_pk_bf16_f32 v192, 0, v192
  v_cndmask_b32 v184, 0, v163, s[72:73]
  v_cvt_pk_bf16_f32 v193, 0, v193
  v_cndmask_b32 v185, 0, v164, s[72:73]
  v_cvt_pk_bf16_f32 v194, 0, v194
  v_cndmask_b32 v186, 0, v163, s[74:75]
  v_cvt_pk_bf16_f32 v195, 0, v195
  v_cndmask_b32 v187, 0, v164, s[74:75]
  v_pk_mul_f32 v[192:193], v[192:193], v[116:117] op_sel:[0,1]
  v_cndmask_b32 v188, 0, v163, s[76:77]
  v_pk_mul_f32 v[194:195], v[194:195], v[116:117] op_sel:[0,1]
  s_waitcnt vmcnt(14)
  buffer_load_dwordx4 v[76:79], v93, s[12:15], s61 offen offset:1024 nt
  v_pk_fma_f32 v[196:197], v[16:17], s[92:93], v[116:117] op_sel_hi:[1,1,0] neg_lo:[0,0,1] neg_hi:[0,0,1]
  v_pk_fma_f32 v[198:199], v[18:19], s[92:93], v[116:117] op_sel_hi:[1,1,0] neg_lo:[0,0,1] neg_hi:[0,0,1]
  v_cvt_pk_bf16_f32 v196, 0, v196
  v_cndmask_b32 v189, 0, v164, s[76:77]
  v_cvt_pk_bf16_f32 v197, 0, v197
  v_cndmask_b32 v190, 0, v163, s[78:79]
  v_cvt_pk_bf16_f32 v198, 0, v198
  v_cndmask_b32 v191, 0, v164, s[78:79]
  v_cvt_pk_bf16_f32 v199, 0, v199
  v_pk_mul_f32 v[196:197], v[196:197], v[116:117] op_sel:[0,1]
  v_pk_mul_f32 v[198:199], v[198:199], v[116:117] op_sel:[0,1]
  s_waitcnt vmcnt(14)
  buffer_load_dwordx4 v[80:83], v93, s[12:15], s61 offen offset:1280 nt
  v_pk_fma_f32 v[200:201], v[20:21], s[92:93], v[116:117] op_sel_hi:[1,1,0] neg_lo:[0,0,1] neg_hi:[0,0,1]
  v_pk_fma_f32 v[202:203], v[22:23], s[92:93], v[116:117] op_sel_hi:[1,1,0] neg_lo:[0,0,1] neg_hi:[0,0,1]
  v_cvt_pk_bf16_f32 v200, 0, v200
  v_cvt_pk_bf16_f32 v201, 0, v201
  v_cvt_pk_bf16_f32 v202, 0, v202
  v_cvt_pk_bf16_f32 v203, 0, v203
  v_pk_mul_f32 v[200:201], v[200:201], v[116:117] op_sel:[0,1]
  v_pk_mul_f32 v[202:203], v[202:203], v[116:117] op_sel:[0,1]
  s_waitcnt vmcnt(14)
  s_cbranch_vccnz L_vw0_27
  s_waitcnt vmcnt(9)
L_vw0_27:
  buffer_load_dwordx4 v[84:87], v93, s[12:15], s61 offen offset:1536 nt
  v_mov_b32_dpp v116, v114 row_newbcast:9 row_mask:0xf bank_mask:0xf
  v_mov_b32_dpp v117, v115 row_newbcast:9 row_mask:0xf bank_mask:0xf
  v_pk_fma_f32 v[108:109], v[24:25], s[92:93], v[116:117] op_sel_hi:[1,1,0] neg_lo:[0,0,1] neg_hi:[0,0,1]
  v_pk_fma_f32 v[110:111], v[26:27], s[92:93], v[116:117] op_sel_hi:[1,1,0] neg_lo:[0,0,1] neg_hi:[0,0,1]
  v_cvt_pk_bf16_f32 v108, 0, v108
  v_cvt_pk_bf16_f32 v109, 0, v109
  v_cvt_pk_bf16_f32 v110, 0, v110
  v_cvt_pk_bf16_f32 v111, 0, v111
  v_pk_mul_f32 v[108:109], v[108:109], v[116:117] op_sel:[0,1]
  v_pk_mul_f32 v[110:111], v[110:111], v[116:117] op_sel:[0,1]
  v_cvt_pk_bf16_f32 v204, v192, v108
  v_cvt_pk_bf16_f32 v208, v193, v109
  v_cvt_pk_bf16_f32 v212, v194, v110
  v_cvt_pk_bf16_f32 v216, v195, v111
  s_waitcnt vmcnt(14)
  buffer_load_dwordx4 v[88:91], v93, s[12:15], s61 offen offset:1792 nt
  v_pk_fma_f32 v[108:109], v[28:29], s[92:93], v[116:117] op_sel_hi:[1,1,0] neg_lo:[0,0,1] neg_hi:[0,0,1]
  v_pk_fma_f32 v[110:111], v[30:31], s[92:93], v[116:117] op_sel_hi:[1,1,0] neg_lo:[0,0,1] neg_hi:[0,0,1]
  v_cvt_pk_bf16_f32 v108, 0, v108
  v_cvt_pk_bf16_f32 v109, 0, v109
  v_cvt_pk_bf16_f32 v110, 0, v110
  v_cvt_pk_bf16_f32 v111, 0, v111
  v_pk_mul_f32 v[108:109], v[108:109], v[116:117] op_sel:[0,1]
  v_pk_mul_f32 v[110:111], v[110:111], v[116:117] op_sel:[0,1]
  v_cvt_pk_bf16_f32 v220, v196, v108
  v_cvt_pk_bf16_f32 v224, v197, v109
  v_cvt_pk_bf16_f32 v228, v198, v110
  v_cvt_pk_bf16_f32 v232, v199, v111
  s_waitcnt vmcnt(14)
  buffer_load_dwordx4 v[4:7], v93, s[12:15], s61 offen offset:2048 nt
  v_pk_fma_f32 v[108:109], v[32:33], s[92:93], v[116:117] op_sel_hi:[1,1,0] neg_lo:[0,0,1] neg_hi:[0,0,1]
  v_pk_fma_f32 v[110:111], v[34:35], s[92:93], v[116:117] op_sel_hi:[1,1,0] neg_lo:[0,0,1] neg_hi:[0,0,1]
  v_cvt_pk_bf16_f32 v108, 0, v108
  v_cvt_pk_bf16_f32 v109, 0, v109
  v_cvt_pk_bf16_f32 v110, 0, v110
  v_cvt_pk_bf16_f32 v111, 0, v111
  v_pk_mul_f32 v[108:109], v[108:109], v[116:117] op_sel:[0,1]
  v_pk_mul_f32 v[110:111], v[110:111], v[116:117] op_sel:[0,1]
  v_cvt_pk_bf16_f32 v236, v200, v108
  v_cvt_pk_bf16_f32 v240, v201, v109
  v_cvt_pk_bf16_f32 v244, v202, v110
  v_cvt_pk_bf16_f32 v248, v203, v111
  s_waitcnt vmcnt(14)
  s_cbranch_vccnz L_vw0_30
  s_waitcnt vmcnt(9)
L_vw0_30:
  buffer_load_dwordx4 v[8:11], v93, s[12:15], s61 offen offset:2304 nt
  v_mov_b32_dpp v116, v114 row_newbcast:10 row_mask:0xf bank_mask:0xf
  v_mov_b32_dpp v117, v115 row_newbcast:10 row_mask:0xf bank_mask:0xf
  v_pk_fma_f32 v[192:193], v[36:37], s[92:93], v[116:117] op_sel_hi:[1,1,0] neg_lo:[0,0,1] neg_hi:[0,0,1]
  v_pk_fma_f32 v[194:195], v[38:39], s[92:93], v[116:117] op_sel_hi:[1,1,0] neg_lo:[0,0,1] neg_hi:[0,0,1]
  v_cvt_pk_bf16_f32 v192, 0, v192
  v_cvt_pk_bf16_f32 v193, 0, v193
  v_cvt_pk_bf16_f32 v194, 0, v194
  v_cvt_pk_bf16_f32 v195, 0, v195
  v_pk_mul_f32 v[192:193], v[192:193], v[116:117] op_sel:[0,1]
  v_pk_mul_f32 v[194:195], v[194:195], v[116:117] op_sel:[0,1]
  v_cvt_pk_bf16_f32 v205, v192, 0
  v_cvt_pk_bf16_f32 v209, v193, 0
  v_cvt_pk_bf16_f32 v213, v194, 0
  v_cvt_pk_bf16_f32 v217, v195, 0
  v_mfma_f32_16x16x16_bf16 v[128:131], v[184:185], v[204:205], v[128:131]
  v_mfma_f32_16x16x16_bf16 v[128:131], v[186:187], v[208:209], v[128:131]
  v_mfma_f32_16x16x16_bf16 v[128:131], v[188:189], v[212:213], v[128:131]
  v_mfma_f32_16x16x16_bf16 v[128:131], v[190:191], v[216:217], v[128:131]
  s_waitcnt vmcnt(14)
  buffer_load_dwordx4 v[12:15], v93, s[12:15], s61 offen offset:2560 nt
  v_pk_fma_f32 v[196:197], v[40:41], s[92:93], v[116:117] op_sel_hi:[1,1,0] neg_lo:[0,0,1] neg_hi:[0,0,1]
  v_pk_fma_f32 v[198:199], v[42:43], s[92:93], v[116:117] op_sel_hi:[1,1,0] neg_lo:[0,0,1] neg_hi:[0,0,1]
  v_cvt_pk_bf16_f32 v196, 0, v196
  v_cvt_pk_bf16_f32 v197, 0, v197
  v_cvt_pk_bf16_f32 v198, 0, v198
  v_cvt_pk_bf16_f32 v199, 0, v199
  v_pk_mul_f32 v[196:197], v[196:197], v[116:117] op_sel:[0,1]
  v_pk_mul_f32 v[198:199], v[198:199], v[116:117] op_sel:[0,1]
  v_cvt_pk_bf16_f32 v221, v196, 0
  v_cvt_pk_bf16_f32 v225, v197, 0
  v_cvt_pk_bf16_f32 v229, v198, 0
  v_cvt_pk_bf16_f32 v233, v199, 0
  v_mfma_f32_16x16x16_bf16 v[132:135], v[184:185], v[220:221], v[132:135]
  v_mfma_f32_16x16x16_bf16 v[132:135], v[186:187], v[224:225], v[132:135]
  v_mfma_f32_16x16x16_bf16 v[132:135], v[188:189], v[228:229], v[132:135]
  v_mfma_f32_16x16x16_bf16 v[132:135], v[190:191], v[232:233], v[132:135]
  s_waitcnt vmcnt(14)
  buffer_load_dwordx4 v[16:19], v93, s[12:15], s61 offen offset:2816 nt
  v_pk_fma_f32 v[200:201], v[44:45], s[92:93], v[116:117] op_sel_hi:[1,1,0] neg_lo:[0,0,1] neg_hi:[0,0,1]
  v_pk_fma_f32 v[202:203], v[46:47], s[92:93], v[116:117] op_sel_hi:[1,1,0] neg_lo:[0,0,1] neg_hi:[0,0,1]
  v_cvt_pk_bf16_f32 v200, 0, v200
  v_cvt_pk_bf16_f32 v201, 0, v201
  v_cvt_pk_bf16_f32 v202, 0, v202
  v_cvt_pk_bf16_f32 v203, 0, v203
  v_pk_mul_f32 v[200:201], v[200:201], v[116:117] op_sel:[0,1]
  v_pk_mul_f32 v[202:203], v[202:203], v[116:117] op_sel:[0,1]
  v_cvt_pk_bf16_f32 v237, v200, 0
  v_cvt_pk_bf16_f32 v241, v201, 0
  v_cvt_pk_bf16_f32 v245, v202, 0
  v_cvt_pk_bf16_f32 v249, v203, 0
  v_mfma_f32_16x16x16_bf16 v[136:139], v[184:185], v[236:237], v[136:139]
  v_mfma_f32_16x16x16_bf16 v[136:139], v[186:187], v[240:241], v[136:139]
  v_mfma_f32_16x16x16_bf16 v[136:139], v[188:189], v[244:245], v[136:139]
  v_mfma_f32_16x16x16_bf16 v[136:139], v[190:191], v[248:249], v[136:139]
  s_mov_b32 s60, s61
L_v1:
  s_add_u32 s97, s64, 96
  v_mov_b32 v146, s97
  s_mov_b32 s86, s84
  s_mov_b32 s87, s85
  ds_write_b32 v104, v146
  s_add_u32 s64, s64, 2
  s_cmp_lt_u32 s64, s99
  s_cbranch_scc1 L_v11_ok
L_v11_spin:
  v_mov_b32 v144, 61700
  ds_read_b32 v144, v144
  s_waitcnt lgkmcnt(0)
  v_readfirstlane_b32 s99, v144
  s_nop 1
  s_cmp_lt_u32 s64, s99
  s_cbranch_scc0 L_v11_spin
L_v11_ok:
  s_lshr_b32 s71, s64, 5
  s_lshr_b32 s85, s96, s71
  s_bfe_u32 s85, s85, 0x10003
  s_and_b32 s70, s64, 31
  s_lshl_b32 s71, s71, 12
  s_add_u32 s70, s70, s5
  s_add_u32 s70, s70, s71
  s_mul_hi_u32 s84, s70, s90
  s_lshr_b32 s84, s84, 1
  s_mul_i32 s71, s84, 3
  s_sub_u32 s70, s70, s71
  s_lshl3_add_u32 s85, s70, s85
  s_mul_i32 s61, s84, 196608
  s_lshr_b32 s89, s84, 4
  s_lshl_b32 s70, s85, 5
  v_add_u32 v97, s70, v1
  v_mul_u32_u24 v97, 21846, v97
  v_lshrrev_b32 v97, 16, v97
  v_add_u32 v144, s85, v2
  v_lshrrev_b32 v145, v144, s91
  v_and_b32 v145, 1, v145
  v_cmp_eq_u32 s[54:55], 1, v145
  s_nop 1
  s_and_b64 s[52:53], s[54:55], s[58:59]
  s_andn2_b64 s[54:55], s[54:55], s[58:59]
  s_cmp_lt_u32 s64, 96
  s_cselect_b32 s61, s61, 805306368
  ds_read_b32 v106, v104 offset:8
  s_waitcnt vmcnt(14)
  s_cbranch_vccnz L_vw1_0
  s_waitcnt vmcnt(9)
L_vw1_0:
  buffer_load_dwordx4 v[20:23], v93, s[12:15], s60 offen offset:3072 nt
  v_mul_f32 v114, s94, v112
  v_mul_f32 v115, 0x4a800000, v113
  s_nop 0
  v_mov_b32_dpp v116, v114 row_newbcast:0 row_mask:0xf bank_mask:0xf
  v_mov_b32_dpp v117, v115 row_newbcast:0 row_mask:0xf bank_mask:0xf
  v_pk_fma_f32 v[192:193], v[48:49], s[92:93], v[116:117] op_sel_hi:[1,1,0] neg_lo:[0,0,1] neg_hi:[0,0,1]
  v_pk_fma_f32 v[194:195], v[50:51], s[92:93], v[116:117] op_sel_hi:[1,1,0] neg_lo:[0,0,1] neg_hi:[0,0,1]
  v_cvt_pk_bf16_f32 v192, 0, v192
  v_cvt_pk_bf16_f32 v193, 0, v193
  v_cvt_pk_bf16_f32 v194, 0, v194
  v_cvt_pk_bf16_f32 v195, 0, v195
  v_pk_mul_f32 v[192:193], v[192:193], v[116:117] op_sel:[0,1]
  v_pk_mul_f32 v[194:195], v[194:195], v[116:117] op_sel:[0,1]
  s_waitcnt lgkmcnt(0)
  v_cmp_lt_u32 vcc, s97, v106
  s_waitcnt vmcnt(14)
  buffer_load_dwordx4 v[24:27], v93, s[12:15], s60 offen offset:3328 nt
  v_pk_fma_f32 v[196:197], v[52:53], s[92:93], v[116:117] op_sel_hi:[1,1,0] neg_lo:[0,0,1] neg_hi:[0,0,1]
  v_pk_fma_f32 v[198:199], v[54:55], s[92:93], v[116:117] op_sel_hi:[1,1,0] neg_lo:[0,0,1] neg_hi:[0,0,1]
  v_cvt_pk_bf16_f32 v196, 0, v196
  v_lshlrev_b32 v148, 16, v120
  v_cvt_pk_bf16_f32 v197, 0, v197
  v_and_b32 v149, s65, v120
  v_cvt_pk_bf16_f32 v198, 0, v198
  v_lshlrev_b32 v150, 16, v121
  v_cvt_pk_bf16_f32 v199, 0, v199
  v_and_b32 v151, s65, v121
  v_pk_mul_f32 v[196:197], v[196:197], v[116:117] op_sel:[0,1]
  v_lshlrev_b32 v152, 16, v122
  v_pk_mul_f32 v[198:199], v[198:199], v[116:117] op_sel:[0,1]
  s_waitcnt vmcnt(14)
  buffer_load_dwordx4 v[28:31], v93, s[12:15], s60 offen offset:3584 nt
  v_pk_fma_f32 v[200:201], v[56:57], s[92:93], v[116:117] op_sel_hi:[1,1,0] neg_lo:[0,0,1] neg_hi:[0,0,1]
  v_pk_fma_f32 v[202:203], v[58:59], s[92:93], v[116:117] op_sel_hi:[1,1,0] neg_lo:[0,0,1] neg_hi:[0,0,1]
  v_cvt_pk_bf16_f32 v200, 0, v200
  v_and_b32 v153, s65, v122
  v_cvt_pk_bf16_f32 v201, 0, v201
  v_lshlrev_b32 v154, 16, v123
  v_cvt_pk_bf16_f32 v202, 0, v202
  v_and_b32 v155, s65, v123
  v_cvt_pk_bf16_f32 v203, 0, v203
  v_lshlrev_b32 v156, 16, v124
  v_pk_mul_f32 v[200:201], v[200:201], v[116:117] op_sel:[0,1]
  v_and_b32 v157, s65, v124
  v_pk_mul_f32 v[202:203], v[202:203], v[116:117] op_sel:[0,1]
  s_waitcnt vmcnt(14)
  s_cbranch_vccnz L_vw1_3
  s_waitcnt vmcnt(9)
L_vw1_3:
  buffer_load_dwordx4 v[32:35], v94, s[12:15], s60 offen offset:0 nt
  v_mov_b32_dpp v116, v114 row_newbcast:1 row_mask:0xf bank_mask:0xf
  v_mov_b32_dpp v117, v115 row_newbcast:1 row_mask:0xf bank_mask:0xf
  v_pk_fma_f32 v[108:109], v[60:61], s[92:93], v[116:117] op_sel_hi:[1,1,0] neg_lo:[0,0,1] neg_hi:[0,0,1]
  v_pk_fma_f32 v[110:111], v[62:63], s[92:93], v[116:117] op_sel_hi:[1,1,0] neg_lo:[0,0,1] neg_hi:[0,0,1]
  s_lshl_b32 s62, s84, 9
  v_lshl_add_u32 v98, v97, 1, v96
  buffer_load_short_d16_hi v112, v98, s[32:35], s62 offen
  buffer_load_short_d16_hi v113, v98, s[28:31], s62 offen
  v_cvt_pk_bf16_f32 v108, 0, v108
  v_lshlrev_b32 v158, 16, v125
  v_cvt_pk_bf16_f32 v109, 0, v109
  v_add_u32 v99, 768, v99
  v_cvt_pk_bf16_f32 v110, 0, v110
  v_add_u32 v100, 768, v100
  v_cvt_pk_bf16_f32 v111, 0, v111
  v_max3_f32 v144, v148, v149, v150
  v_pk_mul_f32 v[108:109], v[108:109], v[116:117] op_sel:[0,1]
  ds_read_b128 v[120:123], v99
  v_pk_mul_f32 v[110:111], v[110:111], v[116:117] op_sel:[0,1]
  v_cvt_pk_bf16_f32 v204, v192, v108
  v_cvt_pk_bf16_f32 v208, v193, v109
  v_cvt_pk_bf16_f32 v212, v194, v110
  v_cvt_pk_bf16_f32 v216, v195, v111
  s_waitcnt vmcnt(16)
  buffer_load_dwordx4 v[36:39], v94, s[12:15], s60 offen offset:256 nt
  v_pk_fma_f32 v[108:109], v[64:65], s[92:93], v[116:117] op_sel_hi:[1,1,0] neg_lo:[0,0,1] neg_hi:[0,0,1]
  v_pk_fma_f32 v[110:111], v[66:67], s[92:93], v[116:117] op_sel_hi:[1,1,0] neg_lo:[0,0,1] neg_hi:[0,0,1]
  v_cvt_pk_bf16_f32 v108, 0, v108
  ds_read_b64 v[124:125], v100 offset:256
  v_cvt_pk_bf16_f32 v109, 0, v109
  v_max3_f32 v145, v151, v152, v153
  v_cvt_pk_bf16_f32 v110, 0, v110
  v_max3_f32 v144, v144, v154, v155
  v_cvt_pk_bf16_f32 v111, 0, v111
  v_max3_f32 v145, v145, v156, v157
  v_pk_mul_f32 v[108:109], v[108:109], v[116:117] op_sel:[0,1]
  v_max3_f32 v144, v144, v158, v140
  v_pk_mul_f32 v[110:111], v[110:111], v[116:117] op_sel:[0,1]
  v_cvt_pk_bf16_f32 v220, v196, v108
  v_cvt_pk_bf16_f32 v224, v197, v109
  v_cvt_pk_bf16_f32 v228, v198, v110
  v_cvt_pk_bf16_f32 v232, v199, v111
  s_waitcnt vmcnt(16)
  buffer_load_dwordx4 v[40:43], v94, s[12:15], s60 offen offset:512 nt
  v_pk_fma_f32 v[108:109], v[68:69], s[92:93], v[116:117] op_sel_hi:[1,1,0] neg_lo:[0,0,1] neg_hi:[0,0,1]
  v_pk_fma_f32 v[110:111], v[70:71], s[92:93], v[116:117] op_sel_hi:[1,1,0] neg_lo:[0,0,1] neg_hi:[0,0,1]
  v_cvt_pk_bf16_f32 v108, 0, v108
  v_max_f32 v144, v144, v145
  v_cvt_pk_bf16_f32 v109, 0, v109
  v_mov_b32 v145, v144
  v_cvt_pk_bf16_f32 v110, 0, v110
  s_nop 0
  v_permlane32_swap_b32 v144, v145
  v_cvt_pk_bf16_f32 v111, 0, v111
  v_max_f32 v144, v144, v145
  v_pk_mul_f32 v[108:109], v[108:109], v[116:117] op_sel:[0,1]
  v_mov_b32 v145, v144
  v_pk_mul_f32 v[110:111], v[110:111], v[116:117] op_sel:[0,1]
  v_cvt_pk_bf16_f32 v236, v200, v108
  v_cvt_pk_bf16_f32 v240, v201, v109
  v_cvt_pk_bf16_f32 v244, v202, v110
  v_cvt_pk_bf16_f32 v248, v203, v111
  s_waitcnt vmcnt(16)
  s_cbranch_vccnz L_vw1_6
  s_waitcnt vmcnt(11)
L_vw1_6:
  buffer_load_dwordx4 v[44:47], v94, s[12:15], s60 offen offset:768 nt
  v_mov_b32_dpp v116, v114 row_newbcast:2 row_mask:0xf bank_mask:0xf
  v_mov_b32_dpp v117, v115 row_newbcast:2 row_mask:0xf bank_mask:0xf
  v_pk_fma_f32 v[192:193], v[72:73], s[92:93], v[116:117] op_sel_hi:[1,1,0] neg_lo:[0,0,1] neg_hi:[0,0,1]
  v_pk_fma_f32 v[194:195], v[74:75], s[92:93], v[116:117] op_sel_hi:[1,1,0] neg_lo:[0,0,1] neg_hi:[0,0,1]
  v_cvt_pk_bf16_f32 v192, 0, v192
  v_permlane16_swap_b32 v144, v145
  v_cvt_pk_bf16_f32 v193, 0, v193
  v_max_f32 v140, v144, v145
  v_cvt_pk_bf16_f32 v194, 0, v194
  v_mul_f32 v144, s66, v140
  v_cvt_pk_bf16_f32 v195, 0, v195
  v_add_f32 v146, v144, v142
  v_pk_mul_f32 v[192:193], v[192:193], v[116:117] op_sel:[0,1]
  v_sub_f32 v142, 0, v144
  v_pk_mul_f32 v[194:195], v[194:195], v[116:117] op_sel:[0,1]
  s_waitcnt vmcnt(16)
  buffer_load_dwordx4 v[48:51], v94, s[12:15], s60 offen offset:1024 nt
  v_pk_fma_f32 v[196:197], v[76:77], s[92:93], v[116:117] op_sel_hi:[1,1,0] neg_lo:[0,0,1] neg_hi:[0,0,1]
  v_pk_fma_f32 v[198:199], v[78:79], s[92:93], v[116:117] op_sel_hi:[1,1,0] neg_lo:[0,0,1] neg_hi:[0,0,1]
  v_cvt_pk_bf16_f32 v196, 0, v196
  v_exp_f32 v146, -v146
  v_cvt_pk_bf16_f32 v197, 0, v197
  ds_bpermute_b32 v147, v101, v146
  v_cvt_pk_bf16_f32 v198, 0, v198
  v_fma_f32 v148, v148, s66, v142
  v_cvt_pk_bf16_f32 v199, 0, v199
  v_exp_f32 v148, v148
  v_pk_mul_f32 v[196:197], v[196:197], v[116:117] op_sel:[0,1]
  v_fma_f32 v149, v149, s66, v142
  v_pk_mul_f32 v[198:199], v[198:199], v[116:117] op_sel:[0,1]
  s_waitcnt vmcnt(16)
  buffer_load_dwordx4 v[52:55], v94, s[12:15], s60 offen offset:1280 nt
  v_pk_fma_f32 v[200:201], v[80:81], s[92:93], v[116:117] op_sel_hi:[1,1,0] neg_lo:[0,0,1] neg_hi:[0,0,1]
  v_pk_fma_f32 v[202:203], v[82:83], s[92:93], v[116:117] op_sel_hi:[1,1,0] neg_lo:[0,0,1] neg_hi:[0,0,1]
  v_cvt_pk_bf16_f32 v200, 0, v200
  v_exp_f32 v149, v149
  v_cvt_pk_bf16_f32 v201, 0, v201
  v_fma_f32 v150, v150, s66, v142
  v_cvt_pk_bf16_f32 v202, 0, v202
  v_exp_f32 v150, v150
  v_cvt_pk_bf16_f32 v203, 0, v203
  v_fma_f32 v151, v151, s66, v142
  v_pk_mul_f32 v[200:201], v[200:201], v[116:117] op_sel:[0,1]
  v_exp_f32 v151, v151
  v_pk_mul_f32 v[202:203], v[202:203], v[116:117] op_sel:[0,1]
  s_waitcnt vmcnt(16)
  s_cbranch_vccnz L_vw1_9
  s_waitcnt vmcnt(11)
L_vw1_9:
  buffer_load_dwordx4 v[56:59], v94, s[12:15], s60 offen offset:1536 nt
  v_mov_b32_dpp v116, v114 row_newbcast:3 row_mask:0xf bank_mask:0xf
  v_mov_b32_dpp v117, v115 row_newbcast:3 row_mask:0xf bank_mask:0xf
  v_pk_fma_f32 v[108:109], v[84:85], s[92:93], v[116:117] op_sel_hi:[1,1,0] neg_lo:[0,0,1] neg_hi:[0,0,1]
  v_pk_fma_f32 v[110:111], v[86:87], s[92:93], v[116:117] op_sel_hi:[1,1,0] neg_lo:[0,0,1] neg_hi:[0,0,1]
  v_cvt_pk_bf16_f32 v108, 0, v108
  v_fma_f32 v152, v152, s66, v142
  v_cvt_pk_bf16_f32 v109, 0, v109
  v_exp_f32 v152, v152
  v_cvt_pk_bf16_f32 v110, 0, v110
  v_fma_f32 v153, v153, s66, v142
  v_cvt_pk_bf16_f32 v111, 0, v111
  v_exp_f32 v153, v153
  v_pk_mul_f32 v[108:109], v[108:109], v[116:117] op_sel:[0,1]
  v_fma_f32 v154, v154, s66, v142
  v_pk_mul_f32 v[110:111], v[110:111], v[116:117] op_sel:[0,1]
  v_cvt_pk_bf16_f32 v205, v192, v108
  v_cvt_pk_bf16_f32 v209, v193, v109
  v_cvt_pk_bf16_f32 v213, v194, v110
  v_cvt_pk_bf16_f32 v217, v195, v111
  s_waitcnt vmcnt(16)
  buffer_load_dwordx4 v[60:63], v94, s[12:15], s60 offen offset:1792 nt
  v_pk_fma_f32 v[108:109], v[88:89], s[92:93], v[116:117] op_sel_hi:[1,1,0] neg_lo:[0,0,1] neg_hi:[0,0,1]
  v_pk_fma_f32 v[110:111], v[90:91], s[92:93], v[116:117] op_sel_hi:[1,1,0] neg_lo:[0,0,1] neg_hi:[0,0,1]
  v_cvt_pk_bf16_f32 v108, 0, v108
  v_exp_f32 v154, v154
  v_cvt_pk_bf16_f32 v109, 0, v109
  v_fma_f32 v155, v155, s66, v142
  v_cvt_pk_bf16_f32 v110, 0, v110
  v_exp_f32 v155, v155
  v_cvt_pk_bf16_f32 v111, 0, v111
  v_fma_f32 v156, v156, s66, v142
  v_pk_mul_f32 v[108:109], v[108:109], v[116:117] op_sel:[0,1]
  v_exp_f32 v156, v156
  v_pk_mul_f32 v[110:111], v[110:111], v[116:117] op_sel:[0,1]
  v_cvt_pk_bf16_f32 v221, v196, v108
  v_cvt_pk_bf16_f32 v225, v197, v109
  v_cvt_pk_bf16_f32 v229, v198, v110
  v_cvt_pk_bf16_f32 v233, v199, v111
  s_waitcnt vmcnt(16)
  buffer_load_dwordx4 v[64:67], v94, s[12:15], s60 offen offset:2048 nt
  v_pk_fma_f32 v[108:109], v[4:5], s[92:93], v[116:117] op_sel_hi:[1,1,0] neg_lo:[0,0,1] neg_hi:[0,0,1]
  v_pk_fma_f32 v[110:111], v[6:7], s[92:93], v[116:117] op_sel_hi:[1,1,0] neg_lo:[0,0,1] neg_hi:[0,0,1]
  v_cvt_pk_bf16_f32 v108, 0, v108
  v_fma_f32 v157, v157, s66, v142
  v_cvt_pk_bf16_f32 v109, 0, v109
  v_exp_f32 v157, v157
  v_cvt_pk_bf16_f32 v110, 0, v110
  v_fma_f32 v158, v158, s66, v142
  v_cvt_pk_bf16_f32 v111, 0, v111
  v_exp_f32 v158, v158
  v_pk_mul_f32 v[108:109], v[108:109], v[116:117] op_sel:[0,1]
  v_add_f32 v144, v148, v149
  v_pk_mul_f32 v[110:111], v[110:111], v[116:117] op_sel:[0,1]
  v_cvt_pk_bf16_f32 v237, v200, v108
  v_cvt_pk_bf16_f32 v241, v201, v109
  v_cvt_pk_bf16_f32 v245, v202, v110
  v_cvt_pk_bf16_f32 v249, v203, v111
  s_waitcnt vmcnt(16)
  s_cbranch_vccnz L_vw1_12
  s_waitcnt vmcnt(11)
L_vw1_12:
  buffer_load_dwordx4 v[68:71], v94, s[12:15], s60 offen offset:2304 nt
  v_mov_b32_dpp v116, v114 row_newbcast:4 row_mask:0xf bank_mask:0xf
  v_mov_b32_dpp v117, v115 row_newbcast:4 row_mask:0xf bank_mask:0xf
  v_pk_fma_f32 v[192:193], v[8:9], s[92:93], v[116:117] op_sel_hi:[1,1,0] neg_lo:[0,0,1] neg_hi:[0,0,1]
  v_pk_fma_f32 v[194:195], v[10:11], s[92:93], v[116:117] op_sel_hi:[1,1,0] neg_lo:[0,0,1] neg_hi:[0,0,1]
  v_cvt_pk_bf16_f32 v192, 0, v192
  v_add_f32 v145, v150, v151
  v_cvt_pk_bf16_f32 v193, 0, v193
  v_add_f32 v144, v144, v152
  v_cvt_pk_bf16_f32 v194, 0, v194
  v_add_f32 v145, v145, v153
  v_cvt_pk_bf16_f32 v195, 0, v195
  v_add_f32 v144, v144, v154
  v_pk_mul_f32 v[192:193], v[192:193], v[116:117] op_sel:[0,1]
  v_add_f32 v145, v145, v155
  v_pk_mul_f32 v[194:195], v[194:195], v[116:117] op_sel:[0,1]
  s_waitcnt vmcnt(16)
  buffer_load_dwordx4 v[72:75], v94, s[12:15], s60 offen offset:2560 nt
  v_pk_fma_f32 v[196:197], v[12:13], s[92:93], v[116:117] op_sel_hi:[1,1,0] neg_lo:[0,0,1] neg_hi:[0,0,1]
  v_pk_fma_f32 v[198:199], v[14:15], s[92:93], v[116:117] op_sel_hi:[1,1,0] neg_lo:[0,0,1] neg_hi:[0,0,1]
  v_cvt_pk_bf16_f32 v196, 0, v196
  v_add_f32 v144, v144, v156
  v_cvt_pk_bf16_f32 v197, 0, v197
  v_add_f32 v145, v145, v157
  v_cvt_pk_bf16_f32 v198, 0, v198
  v_add_f32 v144, v144, v158
  v_cvt_pk_bf16_f32 v199, 0, v199
  v_add_f32 v144, v144, v145
  v_pk_mul_f32 v[196:197], v[196:197], v[116:117] op_sel:[0,1]
  v_fma_f32 v143, v143, v146, v144
  v_pk_mul_f32 v[198:199], v[198:199], v[116:117] op_sel:[0,1]
  s_waitcnt vmcnt(16)
  buffer_load_dwordx4 v[76:79], v94, s[12:15], s60 offen offset:2816 nt
  v_pk_fma_f32 v[200:201], v[16:17], s[92:93], v[116:117] op_sel_hi:[1,1,0] neg_lo:[0,0,1] neg_hi:[0,0,1]
  v_pk_fma_f32 v[202:203], v[18:19], s[92:93], v[116:117] op_sel_hi:[1,1,0] neg_lo:[0,0,1] neg_hi:[0,0,1]
  v_cvt_pk_bf16_f32 v200, 0, v200
  v_cvt_pk_bf16_f32 v159, v148, v149
  v_cvt_pk_bf16_f32 v201, 0, v201
  v_cvt_pk_bf16_f32 v160, v150, v151
  v_cvt_pk_bf16_f32 v202, 0, v202
  v_cvt_pk_bf16_f32 v161, v152, v153
  v_cvt_pk_bf16_f32 v203, 0, v203
  v_cvt_pk_bf16_f32 v162, v154, v155
  v_pk_mul_f32 v[200:201], v[200:201], v[116:117] op_sel:[0,1]
  v_cvt_pk_bf16_f32 v163, v156, v157
  v_pk_mul_f32 v[202:203], v[202:203], v[116:117] op_sel:[0,1]
  s_waitcnt vmcnt(16)
  s_cbranch_vccnz L_vw1_15
  s_waitcnt vmcnt(9)
L_vw1_15:
  buffer_load_dwordx4 v[80:83], v95, s[12:15], s60 offen offset:0 nt
  v_mov_b32_dpp v116, v114 row_newbcast:5 row_mask:0xf bank_mask:0xf
  v_mov_b32_dpp v117, v115 row_newbcast:5 row_mask:0xf bank_mask:0xf
  v_pk_fma_f32 v[108:109], v[20:21], s[92:93], v[116:117] op_sel_hi:[1,1,0] neg_lo:[0,0,1] neg_hi:[0,0,1]
  v_pk_fma_f32 v[110:111], v[22:23], s[92:93], v[116:117] op_sel_hi:[1,1,0] neg_lo:[0,0,1] neg_hi:[0,0,1]
  v_cvt_pk_bf16_f32 v108, 0, v108
  v_cvt_pk_bf16_f32 v164, v158, 0
  v_cvt_pk_bf16_f32 v109, 0, v109
  v_cndmask_b32 v168, 0, v159, s[72:73]
  v_cvt_pk_bf16_f32 v110, 0, v110
  v_cndmask_b32 v169, 0, v160, s[72:73]
  v_cvt_pk_bf16_f32 v111, 0, v111
  v_cndmask_b32 v170, 0, v161, s[72:73]
  v_pk_mul_f32 v[108:109], v[108:109], v[116:117] op_sel:[0,1]
  v_cndmask_b32 v171, 0, v162, s[72:73]
  v_pk_mul_f32 v[110:111], v[110:111], v[116:117] op_sel:[0,1]
  v_cvt_pk_bf16_f32 v206, v192, v108
  v_cvt_pk_bf16_f32 v210, v193, v109
  v_cvt_pk_bf16_f32 v214, v194, v110
  v_cvt_pk_bf16_f32 v218, v195, v111
  s_waitcnt vmcnt(16)
  buffer_load_dwordx4 v[84:87], v95, s[12:15], s60 offen offset:256 nt
  v_pk_fma_f32 v[108:109], v[24:25], s[92:93], v[116:117] op_sel_hi:[1,1,0] neg_lo:[0,0,1] neg_hi:[0,0,1]
  v_pk_fma_f32 v[110:111], v[26:27], s[92:93], v[116:117] op_sel_hi:[1,1,0] neg_lo:[0,0,1] neg_hi:[0,0,1]
  v_cvt_pk_bf16_f32 v108, 0, v108
  v_cndmask_b32 v172, 0, v159, s[74:75]
  v_cvt_pk_bf16_f32 v109, 0, v109
  v_cndmask_b32 v173, 0, v160, s[74:75]
  v_cvt_pk_bf16_f32 v110, 0, v110
  v_cndmask_b32 v174, 0, v161, s[74:75]
  v_cvt_pk_bf16_f32 v111, 0, v111
  v_cndmask_b32 v175, 0, v162, s[74:75]
  v_pk_mul_f32 v[108:109], v[108:109], v[116:117] op_sel:[0,1]
  v_cndmask_b32 v176, 0, v159, s[76:77]
  v_pk_mul_f32 v[110:111], v[110:111], v[116:117] op_sel:[0,1]
  v_cvt_pk_bf16_f32 v222, v196, v108
  v_cvt_pk_bf16_f32 v226, v197, v109
  v_cvt_pk_bf16_f32 v230, v198, v110
  v_cvt_pk_bf16_f32 v234, v199, v111
  s_waitcnt vmcnt(16)
  buffer_load_dwordx4 v[88:91], v95, s[12:15], s60 offen offset:512 nt
  v_pk_fma_f32 v[108:109], v[28:29], s[92:93], v[116:117] op_sel_hi:[1,1,0] neg_lo:[0,0,1] neg_hi:[0,0,1]
  v_pk_fma_f32 v[110:111], v[30:31], s[92:93], v[116:117] op_sel_hi:[1,1,0] neg_lo:[0,0,1] neg_hi:[0,0,1]
  v_cvt_pk_bf16_f32 v108, 0, v108
  v_cndmask_b32 v177, 0, v160, s[76:77]
  v_cvt_pk_bf16_f32 v109, 0, v109
  v_cndmask_b32 v178, 0, v161, s[76:77]
  v_cvt_pk_bf16_f32 v110, 0, v110
  v_cndmask_b32 v179, 0, v162, s[76:77]
  v_cvt_pk_bf16_f32 v111, 0, v111
  v_cndmask_b32 v180, 0, v159, s[78:79]
  v_pk_mul_f32 v[108:109], v[108:109], v[116:117] op_sel:[0,1]
  v_cndmask_b32 v181, 0, v160, s[78:79]
  v_pk_mul_f32 v[110:111], v[110:111], v[116:117] op_sel:[0,1]
  v_cvt_pk_bf16_f32 v238, v200, v108
  v_cvt_pk_bf16_f32 v242, v201, v109
  v_cvt_pk_bf16_f32 v246, v202, v110
  v_cvt_pk_bf16_f32 v250, v203, v111
  v_mad_u32_u24 v92, v97, s63, v3
  v_add_u32 v93, 768, v92
  v_add_u32 v94, 4608, v92
  v_add_u32 v95, 7680, v92
  v_cndmask_b32 v92, v92, v105, s[52:53]
  v_cndmask_b32 v95, v95, v105, s[54:55]
  s_waitcnt vmcnt(16)
  s_cbranch_vccnz L_vw1_18
  s_waitcnt vmcnt(9)
L_vw1_18:
  buffer_load_dwordx4 v[4:7], v92, s[12:15], s61 offen offset:0 nt
  v_mov_b32_dpp v116, v114 row_newbcast:6 row_mask:0xf bank_mask:0xf
  v_mov_b32_dpp v117, v115 row_newbcast:6 row_mask:0xf bank_mask:0xf
  v_pk_fma_f32 v[192:193], v[32:33], s[92:93], v[116:117] op_sel_hi:[1,1,0] neg_lo:[0,0,1] neg_hi:[0,0,1]
  v_pk_fma_f32 v[194:195], v[34:35], s[92:93], v[116:117] op_sel_hi:[1,1,0] neg_lo:[0,0,1] neg_hi:[0,0,1]
  v_cvt_pk_bf16_f32 v192, 0, v192
  v_cndmask_b32 v182, 0, v161, s[78:79]
  v_cvt_pk_bf16_f32 v193, 0, v193
  v_cndmask_b32 v183, 0, v162, s[78:79]
  v_cvt_pk_bf16_f32 v194, 0, v194
  s_waitcnt lgkmcnt(0)
  v_cvt_pk_bf16_f32 v195, 0, v195
  v_mul_f32 v128, v147, v128
  v_pk_mul_f32 v[192:193], v[192:193], v[116:117] op_sel:[0,1]
  v_mul_f32 v129, v147, v129
  v_pk_mul_f32 v[194:195], v[194:195], v[116:117] op_sel:[0,1]
  s_waitcnt vmcnt(14)
  buffer_load_dwordx4 v[8:11], v92, s[12:15], s61 offen offset:256 nt
  v_pk_fma_f32 v[196:197], v[36:37], s[92:93], v[116:117] op_sel_hi:[1,1,0] neg_lo:[0,0,1] neg_hi:[0,0,1]
  v_pk_fma_f32 v[198:199], v[38:39], s[92:93], v[116:117] op_sel_hi:[1,1,0] neg_lo:[0,0,1] neg_hi:[0,0,1]
  v_cvt_pk_bf16_f32 v196, 0, v196
  v_mul_f32 v130, v147, v130
  v_cvt_pk_bf16_f32 v197, 0, v197
  v_mul_f32 v131, v147, v131
  v_cvt_pk_bf16_f32 v198, 0, v198
  v_mul_f32 v132, v147, v132
  v_cvt_pk_bf16_f32 v199, 0, v199
  v_mul_f32 v133, v147, v133
  v_pk_mul_f32 v[196:197], v[196:197], v[116:117] op_sel:[0,1]
  v_mul_f32 v134, v147, v134
  v_pk_mul_f32 v[198:199], v[198:199], v[116:117] op_sel:[0,1]
  s_waitcnt vmcnt(14)
  buffer_load_dwordx4 v[12:15], v92, s[12:15], s61 offen offset:512 nt
  v_pk_fma_f32 v[200:201], v[40:41], s[92:93], v[116:117] op_sel_hi:[1,1,0] neg_lo:[0,0,1] neg_hi:[0,0,1]
  v_pk_fma_f32 v[202:203], v[42:43], s[92:93], v[116:117] op_sel_hi:[1,1,0] neg_lo:[0,0,1] neg_hi:[0,0,1]
  v_cvt_pk_bf16_f32 v200, 0, v200
  v_mul_f32 v135, v147, v135
  v_cvt_pk_bf16_f32 v201, 0, v201
  v_mul_f32 v136, v147, v136
  v_cvt_pk_bf16_f32 v202, 0, v202
  v_mul_f32 v137, v147, v137
  v_cvt_pk_bf16_f32 v203, 0, v203
  v_mul_f32 v138, v147, v138
  v_pk_mul_f32 v[200:201], v[200:201], v[116:117] op_sel:[0,1]
  v_mul_f32 v139, v147, v139
  v_pk_mul_f32 v[202:203], v[202:203], v[116:117] op_sel:[0,1]
  s_waitcnt vmcnt(14)
  s_cbranch_vccnz L_vw1_21
  s_waitcnt vmcnt(9)
L_vw1_21:
  buffer_load_dwordx4 v[16:19], v93, s[12:15], s61 offen offset:0 nt
  v_mov_b32_dpp v116, v114 row_newbcast:7 row_mask:0xf bank_mask:0xf
  v_mov_b32_dpp v117, v115 row_newbcast:7 row_mask:0xf bank_mask:0xf
  v_pk_fma_f32 v[108:109], v[44:45], s[92:93], v[116:117] op_sel_hi:[1,1,0] neg_lo:[0,0,1] neg_hi:[0,0,1]
  v_pk_fma_f32 v[110:111], v[46:47], s[92:93], v[116:117] op_sel_hi:[1,1,0] neg_lo:[0,0,1] neg_hi:[0,0,1]
  v_cvt_pk_bf16_f32 v108, 0, v108
  v_cvt_pk_bf16_f32 v109, 0, v109
  v_cvt_pk_bf16_f32 v110, 0, v110
  v_cvt_pk_bf16_f32 v111, 0, v111
  v_pk_mul_f32 v[108:109], v[108:109], v[116:117] op_sel:[0,1]
  v_pk_mul_f32 v[110:111], v[110:111], v[116:117] op_sel:[0,1]
  v_cvt_pk_bf16_f32 v207, v192, v108
  v_cvt_pk_bf16_f32 v211, v193, v109
  v_cvt_pk_bf16_f32 v215, v194, v110
  v_cvt_pk_bf16_f32 v219, v195, v111
  v_mfma_f32_16x16x32_bf16 v[128:131], v[168:171], v[204:207], v[128:131]
  v_mfma_f32_16x16x32_bf16 v[128:131], v[172:175], v[208:211], v[128:131]
  v_mfma_f32_16x16x32_bf16 v[128:131], v[176:179], v[212:215], v[128:131]
  v_mfma_f32_16x16x32_bf16 v[128:131], v[180:183], v[216:219], v[128:131]
  s_waitcnt vmcnt(14)
  buffer_load_dwordx4 v[20:23], v93, s[12:15], s61 offen offset:256 nt
  v_pk_fma_f32 v[108:109], v[48:49], s[92:93], v[116:117] op_sel_hi:[1,1,0] neg_lo:[0,0,1] neg_hi:[0,0,1]
  v_pk_fma_f32 v[110:111], v[50:51], s[92:93], v[116:117] op_sel_hi:[1,1,0] neg_lo:[0,0,1] neg_hi:[0,0,1]
  v_cvt_pk_bf16_f32 v108, 0, v108
  v_cvt_pk_bf16_f32 v109, 0, v109
  v_cvt_pk_bf16_f32 v110, 0, v110
  v_cvt_pk_bf16_f32 v111, 0, v111
  v_pk_mul_f32 v[108:109], v[108:109], v[116:117] op_sel:[0,1]
  v_pk_mul_f32 v[110:111], v[110:111], v[116:117] op_sel:[0,1]
  v_cvt_pk_bf16_f32 v223, v196, v108
  v_cvt_pk_bf16_f32 v227, v197, v109
  v_cvt_pk_bf16_f32 v231, v198, v110
  v_cvt_pk_bf16_f32 v235, v199, v111
  v_mfma_f32_16x16x32_bf16 v[132:135], v[168:171], v[220:223], v[132:135]
  v_mfma_f32_16x16x32_bf16 v[132:135], v[172:175], v[224:227], v[132:135]
  v_mfma_f32_16x16x32_bf16 v[132:135], v[176:179], v[228:231], v[132:135]
  v_mfma_f32_16x16x32_bf16 v[132:135], v[180:183], v[232:235], v[132:135]
  s_waitcnt vmcnt(14)
  buffer_load_dwordx4 v[24:27], v93, s[12:15], s61 offen offset:512 nt
  v_pk_fma_f32 v[108:109], v[52:53], s[92:93], v[116:117] op_sel_hi:[1,1,0] neg_lo:[0,0,1] neg_hi:[0,0,1]
  v_pk_fma_f32 v[110:111], v[54:55], s[92:93], v[116:117] op_sel_hi:[1,1,0] neg_lo:[0,0,1] neg_hi:[0,0,1]
  v_cvt_pk_bf16_f32 v108, 0, v108
  v_cvt_pk_bf16_f32 v109, 0, v109
  v_cvt_pk_bf16_f32 v110, 0, v110
  v_cvt_pk_bf16_f32 v111, 0, v111
  v_pk_mul_f32 v[108:109], v[108:109], v[116:117] op_sel:[0,1]
  v_pk_mul_f32 v[110:111], v[110:111], v[116:117] op_sel:[0,1]
  v_cvt_pk_bf16_f32 v239, v200, v108
  v_cvt_pk_bf16_f32 v243, v201, v109
  v_cvt_pk_bf16_f32 v247, v202, v110
  v_cvt_pk_bf16_f32 v251, v203, v111
  v_mfma_f32_16x16x32_bf16 v[136:139], v[168:171], v[236:239], v[136:139]
  v_mfma_f32_16x16x32_bf16 v[136:139], v[172:175], v[240:243], v[136:139]
  v_mfma_f32_16x16x32_bf16 v[136:139], v[176:179], v[244:247], v[136:139]
  v_mfma_f32_16x16x32_bf16 v[136:139], v[180:183], v[248:251], v[136:139]
  s_waitcnt vmcnt(14)
  s_cbranch_vccnz L_vw1_24
  s_waitcnt vmcnt(9)
L_vw1_24:
  buffer_load_dwordx4 v[28:31], v93, s[12:15], s61 offen offset:768 nt
  v_mov_b32_dpp v116, v114 row_newbcast:8 row_mask:0xf bank_mask:0xf
  v_mov_b32_dpp v117, v115 row_newbcast:8 row_mask:0xf bank_mask:0xf
  v_pk_fma_f32 v[192:193], v[56:57], s[92:93], v[116:117] op_sel_hi:[1,1,0] neg_lo:[0,0,1] neg_hi:[0,0,1]
  v_pk_fma_f32 v[194:195], v[58:59], s[92:93], v[116:117] op_sel_hi:[1,1,0] neg_lo:[0,0,1] neg_hi:[0,0,1]
  v_cvt_pk_bf16_f32 v192, 0, v192
  v_cndmask_b32 v184, 0, v163, s[72:73]
  v_cvt_pk_bf16_f32 v193, 0, v193
  v_cndmask_b32 v185, 0, v164, s[72:73]
  v_cvt_pk_bf16_f32 v194, 0, v194
  v_cndmask_b32 v186, 0, v163, s[74:75]
  v_cvt_pk_bf16_f32 v195, 0, v195
  v_cndmask_b32 v187, 0, v164, s[74:75]
  v_pk_mul_f32 v[192:193], v[192:193], v[116:117] op_sel:[0,1]
  v_cndmask_b32 v188, 0, v163, s[76:77]
  v_pk_mul_f32 v[194:195], v[194:195], v[116:117] op_sel:[0,1]
  s_waitcnt vmcnt(14)
  buffer_load_dwordx4 v[32:35], v93, s[12:15], s61 offen offset:1024 nt
  v_pk_fma_f32 v[196:197], v[60:61], s[92:93], v[116:117] op_sel_hi:[1,1,0] neg_lo:[0,0,1] neg_hi:[0,0,1]
  v_pk_fma_f32 v[198:199], v[62:63], s[92:93], v[116:117] op_sel_hi:[1,1,0] neg_lo:[0,0,1] neg_hi:[0,0,1]
  v_cvt_pk_bf16_f32 v196, 0, v196
  v_cndmask_b32 v189, 0, v164, s[76:77]
  v_cvt_pk_bf16_f32 v197, 0, v197
  v_cndmask_b32 v190, 0, v163, s[78:79]
  v_cvt_pk_bf16_f32 v198, 0, v198
  v_cndmask_b32 v191, 0, v164, s[78:79]
  v_cvt_pk_bf16_f32 v199, 0, v199
  v_pk_mul_f32 v[196:197], v[196:197], v[116:117] op_sel:[0,1]
  v_pk_mul_f32 v[198:199], v[198:199], v[116:117] op_sel:[0,1]
  s_waitcnt vmcnt(14)
  buffer_load_dwordx4 v[36:39], v93, s[12:15], s61 offen offset:1280 nt
  v_pk_fma_f32 v[200:201], v[64:65], s[92:93], v[116:117] op_sel_hi:[1,1,0] neg_lo:[0,0,1] neg_hi:[0,0,1]
  v_pk_fma_f32 v[202:203], v[66:67], s[92:93], v[116:117] op_sel_hi:[1,1,0] neg_lo:[0,0,1] neg_hi:[0,0,1]
  v_cvt_pk_bf16_f32 v200, 0, v200
  v_cvt_pk_bf16_f32 v201, 0, v201
  v_cvt_pk_bf16_f32 v202, 0, v202
  v_cvt_pk_bf16_f32 v203, 0, v203
  v_pk_mul_f32 v[200:201], v[200:201], v[116:117] op_sel:[0,1]
  v_pk_mul_f32 v[202:203], v[202:203], v[116:117] op_sel:[0,1]
  s_waitcnt vmcnt(14)
  s_cbranch_vccnz L_vw1_27
  s_waitcnt vmcnt(9)
L_vw1_27:
  buffer_load_dwordx4 v[40:43], v93, s[12:15], s61 offen offset:1536 nt
  v_mov_b32_dpp v116, v114 row_newbcast:9 row_mask:0xf bank_mask:0xf
  v_mov_b32_dpp v117, v115 row_newbcast:9 row_mask:0xf bank_mask:0xf
  v_pk_fma_f32 v[108:109], v[68:69], s[92:93], v[116:117] op_sel_hi:[1,1,0] neg_lo:[0,0,1] neg_hi:[0,0,1]
  v_pk_fma_f32 v[110:111], v[70:71], s[92:93], v[116:117] op_sel_hi:[1,1,0] neg_lo:[0,0,1] neg_hi:[0,0,1]
  v_cvt_pk_bf16_f32 v108, 0, v108
  v_cvt_pk_bf16_f32 v109, 0, v109
  v_cvt_pk_bf16_f32 v110, 0, v110
  v_cvt_pk_bf16_f32 v111, 0, v111
  v_pk_mul_f32 v[108:109], v[108:109], v[116:117] op_sel:[0,1]
  v_pk_mul_f32 v[110:111], v[110:111], v[116:117] op_sel:[0,1]
  v_cvt_pk_bf16_f32 v204, v192, v108
  v_cvt_pk_bf16_f32 v208, v193, v109
  v_cvt_pk_bf16_f32 v212, v194, v110
  v_cvt_pk_bf16_f32 v216, v195, v111
  s_waitcnt vmcnt(14)
  buffer_load_dwordx4 v[44:47], v93, s[12:15], s61 offen offset:1792 nt
  v_pk_fma_f32 v[108:109], v[72:73], s[92:93], v[116:117] op_sel_hi:[1,1,0] neg_lo:[0,0,1] neg_hi:[0,0,1]
  v_pk_fma_f32 v[110:111], v[74:75], s[92:93], v[116:117] op_sel_hi:[1,1,0] neg_lo:[0,0,1] neg_hi:[0,0,1]
  v_cvt_pk_bf16_f32 v108, 0, v108
  v_cvt_pk_bf16_f32 v109, 0, v109
  v_cvt_pk_bf16_f32 v110, 0, v110
  v_cvt_pk_bf16_f32 v111, 0, v111
  v_pk_mul_f32 v[108:109], v[108:109], v[116:117] op_sel:[0,1]
  v_pk_mul_f32 v[110:111], v[110:111], v[116:117] op_sel:[0,1]
  v_cvt_pk_bf16_f32 v220, v196, v108
  v_cvt_pk_bf16_f32 v224, v197, v109
  v_cvt_pk_bf16_f32 v228, v198, v110
  v_cvt_pk_bf16_f32 v232, v199, v111
  s_waitcnt vmcnt(14)
  buffer_load_dwordx4 v[48:51], v93, s[12:15], s61 offen offset:2048 nt
  v_pk_fma_f32 v[108:109], v[76:77], s[92:93], v[116:117] op_sel_hi:[1,1,0] neg_lo:[0,0,1] neg_hi:[0,0,1]
  v_pk_fma_f32 v[110:111], v[78:79], s[92:93], v[116:117] op_sel_hi:[1,1,0] neg_lo:[0,0,1] neg_hi:[0,0,1]
  v_cvt_pk_bf16_f32 v108, 0, v108
  v_cvt_pk_bf16_f32 v109, 0, v109
  v_cvt_pk_bf16_f32 v110, 0, v110
  v_cvt_pk_bf16_f32 v111, 0, v111
  v_pk_mul_f32 v[108:109], v[108:109], v[116:117] op_sel:[0,1]
  v_pk_mul_f32 v[110:111], v[110:111], v[116:117] op_sel:[0,1]
  v_cvt_pk_bf16_f32 v236, v200, v108
  v_cvt_pk_bf16_f32 v240, v201, v109
  v_cvt_pk_bf16_f32 v244, v202, v110
  v_cvt_pk_bf16_f32 v248, v203, v111
  s_waitcnt vmcnt(14)
  s_cbranch_vccnz L_vw1_30
  s_waitcnt vmcnt(9)
L_vw1_30:
  buffer_load_dwordx4 v[52:55], v93, s[12:15], s61 offen offset:2304 nt
  v_mov_b32_dpp v116, v114 row_newbcast:10 row_mask:0xf bank_mask:0xf
  v_mov_b32_dpp v117, v115 row_newbcast:10 row_mask:0xf bank_mask:0xf
  v_pk_fma_f32 v[192:193], v[80:81], s[92:93], v[116:117] op_sel_hi:[1,1,0] neg_lo:[0,0,1] neg_hi:[0,0,1]
  v_pk_fma_f32 v[194:195], v[82:83], s[92:93], v[116:117] op_sel_hi:[1,1,0] neg_lo:[0,0,1] neg_hi:[0,0,1]
  v_cvt_pk_bf16_f32 v192, 0, v192
  v_cvt_pk_bf16_f32 v193, 0, v193
  v_cvt_pk_bf16_f32 v194, 0, v194
  v_cvt_pk_bf16_f32 v195, 0, v195
  v_pk_mul_f32 v[192:193], v[192:193], v[116:117] op_sel:[0,1]
  v_pk_mul_f32 v[194:195], v[194:195], v[116:117] op_sel:[0,1]
  v_cvt_pk_bf16_f32 v205, v192, 0
  v_cvt_pk_bf16_f32 v209, v193, 0
  v_cvt_pk_bf16_f32 v213, v194, 0
  v_cvt_pk_bf16_f32 v217, v195, 0
  v_mfma_f32_16x16x16_bf16 v[128:131], v[184:185], v[204:205], v[128:131]
  v_mfma_f32_16x16x16_bf16 v[128:131], v[186:187], v[208:209], v[128:131]
  v_mfma_f32_16x16x16_bf16 v[128:131], v[188:189], v[212:213], v[128:131]
  v_mfma_f32_16x16x16_bf16 v[128:131], v[190:191], v[216:217], v[128:131]
  s_waitcnt vmcnt(14)
  buffer_load_dwordx4 v[56:59], v93, s[12:15], s61 offen offset:2560 nt
  v_pk_fma_f32 v[196:197], v[84:85], s[92:93], v[116:117] op_sel_hi:[1,1,0] neg_lo:[0,0,1] neg_hi:[0,0,1]
  v_pk_fma_f32 v[198:199], v[86:87], s[92:93], v[116:117] op_sel_hi:[1,1,0] neg_lo:[0,0,1] neg_hi:[0,0,1]
  v_cvt_pk_bf16_f32 v196, 0, v196
  v_cvt_pk_bf16_f32 v197, 0, v197
  v_cvt_pk_bf16_f32 v198, 0, v198
  v_cvt_pk_bf16_f32 v199, 0, v199
  v_pk_mul_f32 v[196:197], v[196:197], v[116:117] op_sel:[0,1]
  v_pk_mul_f32 v[198:199], v[198:199], v[116:117] op_sel:[0,1]
  v_cvt_pk_bf16_f32 v221, v196, 0
  v_cvt_pk_bf16_f32 v225, v197, 0
  v_cvt_pk_bf16_f32 v229, v198, 0
  v_cvt_pk_bf16_f32 v233, v199, 0
  v_mfma_f32_16x16x16_bf16 v[132:135], v[184:185], v[220:221], v[132:135]
  v_mfma_f32_16x16x16_bf16 v[132:135], v[186:187], v[224:225], v[132:135]
  v_mfma_f32_16x16x16_bf16 v[132:135], v[188:189], v[228:229], v[132:135]
  v_mfma_f32_16x16x16_bf16 v[132:135], v[190:191], v[232:233], v[132:135]
  s_waitcnt vmcnt(14)
  buffer_load_dwordx4 v[60:63], v93, s[12:15], s61 offen offset:2816 nt
  v_pk_fma_f32 v[200:201], v[88:89], s[92:93], v[116:117] op_sel_hi:[1,1,0] neg_lo:[0,0,1] neg_hi:[0,0,1]
  v_pk_fma_f32 v[202:203], v[90:91], s[92:93], v[116:117] op_sel_hi:[1,1,0] neg_lo:[0,0,1] neg_hi:[0,0,1]
  v_cvt_pk_bf16_f32 v200, 0, v200
  v_cvt_pk_bf16_f32 v201, 0, v201
  v_cvt_pk_bf16_f32 v202, 0, v202
  v_cvt_pk_bf16_f32 v203, 0, v203
  v_pk_mul_f32 v[200:201], v[200:201], v[116:117] op_sel:[0,1]
  v_pk_mul_f32 v[202:203], v[202:203], v[116:117] op_sel:[0,1]
  v_cvt_pk_bf16_f32 v237, v200, 0
  v_cvt_pk_bf16_f32 v241, v201, 0
  v_cvt_pk_bf16_f32 v245, v202, 0
  v_cvt_pk_bf16_f32 v249, v203, 0
  v_mfma_f32_16x16x16_bf16 v[136:139], v[184:185], v[236:237], v[136:139]
  v_mfma_f32_16x16x16_bf16 v[136:139], v[186:187], v[240:241], v[136:139]
  v_mfma_f32_16x16x16_bf16 v[136:139], v[188:189], v[244:245], v[136:139]
  v_mfma_f32_16x16x16_bf16 v[136:139], v[190:191], v[248:249], v[136:139]
  s_mov_b32 s60, s61
  s_cmp_ge_u32 s64, 96
  s_cbranch_scc1 L_v_done
  s_cmp_eq_u32 s89, s88
  s_cbranch_scc1 L_v0
  s_mov_b32 s88, s89
  v_mov_b32 v145, v143
  s_nop 1
  v_permlane32_swap_b32 v143, v145
  v_add_f32 v143, v143, v145
  v_mov_b32 v145, v143
  s_nop 1
  v_permlane16_swap_b32 v143, v145
  v_add_f32 v143, v143, v145
  ds_write_b64 v103, v[142:143]
  ds_write_b128 v102, v[128:131] offset:0
  ds_write_b128 v102, v[132:135] offset:1024
  ds_write_b128 v102, v[136:139] offset:2048
  s_and_b32 s70, s86, 15
  s_cmp_ge_u32 s70, 12
  s_cselect_b32 s70, 2, 0
  s_and_b32 s71, s87, 1
  s_add_u32 s70, s70, s71
  s_lshr_b32 s71, s86, 4
  s_lshl2_add_u32 s70, s71, s70
  s_add_u32 s71, s3, 0
  s_cmp_eq_u32 s100, s71
  s_cselect_b32 s44, s70, s44
  s_add_u32 s71, s3, 2
  s_cmp_eq_u32 s100, s71
  s_cselect_b32 s45, s70, s45
  s_add_u32 s100, s100, 1
  s_waitcnt lgkmcnt(0)
  v_add_u32 v102, 6208, v102
  v_add_u32 v103, 6208, v103
  v_mov_b32 v128, 0
  v_mov_b32 v129, 0
  v_mov_b32 v130, 0
  v_mov_b32 v131, 0
  v_mov_b32 v132, 0
  v_mov_b32 v133, 0
  v_mov_b32 v134, 0
  v_mov_b32 v135, 0
  v_mov_b32 v136, 0
  v_mov_b32 v137, 0
  v_mov_b32 v138, 0
  v_mov_b32 v139, 0
  v_mov_b32 v140, 0xff800000
  v_mov_b32 v142, 0x7f800000
  v_mov_b32 v143, 0
  s_branch L_v0
L_v_done:
  v_mov_b32 v144, 61704
  ds_read_b32 v140, v144
  v_lshlrev_b32 v147, 4, v0
  s_mul_i32 s70, s3, 6208
  v_add_u32 v148, s70, v147
  s_add_u32 s70, s70, 43008
  v_lshrrev_b32 v146, 1, v101
  v_add_u32 v149, s70, v146
  v_add_u32 v150, 12416, v149
  v_mov_b32 v145, v143
  s_nop 1
  v_permlane32_swap_b32 v143, v145
  v_add_f32 v143, v143, v145
  v_mov_b32 v145, v143
  s_nop 1
  v_permlane16_swap_b32 v143, v145
  v_add_f32 v143, v143, v145
  ds_write_b64 v103, v[142:143]
  ds_write_b128 v102, v[128:131] offset:0
  ds_write_b128 v102, v[132:135] offset:1024
  ds_write_b128 v102, v[136:139] offset:2048
  s_and_b32 s70, s86, 15
  s_cmp_ge_u32 s70, 12
  s_cselect_b32 s70, 2, 0
  s_and_b32 s71, s87, 1
  s_add_u32 s70, s70, s71
  s_lshr_b32 s71, s86, 4
  s_lshl2_add_u32 s70, s71, s70
  s_add_u32 s71, s3, 0
  s_cmp_eq_u32 s100, s71
  s_cselect_b32 s44, s70, s44
  s_add_u32 s71, s3, 2
  s_cmp_eq_u32 s100, s71
  s_cselect_b32 s45, s70, s45
  s_add_u32 s100, s100, 1
  s_waitcnt lgkmcnt(0)
  s_waitcnt vmcnt(0)
  s_barrier
  ds_read2_b64 v[4:7], v149 offset1:4
  ds_read_b128 v[168:171], v148 offset:36864
  ds_read_b128 v[172:175], v148 offset:37888
  ds_read_b128 v[176:179], v148 offset:38912
  ds_read_b128 v[180:183], v148 offset:39936
  ds_read_b128 v[184:187], v148 offset:40960
  ds_read_b128 v[188:191], v148 offset:41984
  ds_read2_b64 v[8:11], v150 offset1:4
  ds_read_b128 v[192:195], v148 offset:49280
  ds_read_b128 v[196:199], v148 offset:50304
  ds_read_b128 v[200:203], v148 offset:51328
  ds_read_b128 v[204:207], v148 offset:52352
  ds_read_b128 v[208:211], v148 offset:53376
  ds_read_b128 v[212:215], v148 offset:54400
  s_mov_b32 s100, -1
  s_add_u32 s97, s4, 1
  s_waitcnt lgkmcnt(7)
  v_min_f32 v28, v4, v6
  v_sub_f32 v4, v28, v4
  v_sub_f32 v6, v28, v6
  v_exp_f32 v4, v4
  v_exp_f32 v6, v6
  v_mul_f32 v12, v4, v168
  v_fma_f32 v12, v6, v180, v12
  v_mul_f32 v13, v4, v169
  v_fma_f32 v13, v6, v181, v13
  v_mul_f32 v14, v4, v170
  v_fma_f32 v14, v6, v182, v14
  v_mul_f32 v16, v4, v171
  v_fma_f32 v16, v6, v183, v16
  v_mul_f32 v17, v4, v172
  v_fma_f32 v17, v6, v184, v17
  v_mul_f32 v18, v4, v173
  v_fma_f32 v18, v6, v185, v18
  v_mul_f32 v20, v4, v174
  v_fma_f32 v20, v6, v186, v20
  v_mul_f32 v21, v4, v175
  v_fma_f32 v21, v6, v187, v21
  v_mul_f32 v22, v4, v176
  v_fma_f32 v22, v6, v188, v22
  v_mul_f32 v24, v4, v177
  v_fma_f32 v24, v6, v189, v24
  v_mul_f32 v25, v4, v178
  v_fma_f32 v25, v6, v190, v25
  v_mul_f32 v26, v4, v179
  v_fma_f32 v26, v6, v191, v26
  v_mul_f32 v29, v4, v5
  v_fma_f32 v29, v6, v7, v29
  s_bfe_u32 s70, s44, 0x20001
  s_cmp_eq_u32 s70, s97
  s_cbranch_scc1 L_own0
  v_mov_b32 v15, v140
  v_mov_b32 v19, v140
  v_mov_b32 v23, v140
  v_mov_b32 v27, v140
  v_mov_b32 v31, v140
  s_mul_i32 s70, s44, 5120
  s_add_u32 s70, s70, 1048576
  s_add_u32 s71, s70, 4096
  buffer_store_dwordx4 v[12:15], v147, s[40:43], s70 offen offset:0 sc1
  buffer_store_dwordx4 v[16:19], v147, s[40:43], s70 offen offset:1024 sc1
  buffer_store_dwordx4 v[20:23], v147, s[40:43], s70 offen offset:2048 sc1
  buffer_store_dwordx4 v[24:27], v147, s[40:43], s70 offen offset:3072 sc1
  buffer_store_dwordx4 v[28:31], v147, s[40:43], s71 offen offset:0 sc1
  s_branch L_pub0
L_own0:
  v_mov_b32 v52, v12
  v_mov_b32 v53, v13
  v_mov_b32 v54, v14
  v_mov_b32 v56, v16
  v_mov_b32 v57, v17
  v_mov_b32 v58, v18
  v_mov_b32 v60, v20
  v_mov_b32 v61, v21
  v_mov_b32 v62, v22
  v_mov_b32 v64, v24
  v_mov_b32 v65, v25
  v_mov_b32 v66, v26
  v_mov_b32 v68, v28
  v_mov_b32 v69, v29
  s_mov_b32 s100, s44
L_pub0:
  s_waitcnt lgkmcnt(0)
  v_min_f32 v48, v8, v10
  v_sub_f32 v8, v48, v8
  v_sub_f32 v10, v48, v10
  v_exp_f32 v8, v8
  v_exp_f32 v10, v10
  v_mul_f32 v32, v8, v192
  v_fma_f32 v32, v10, v204, v32
  v_mul_f32 v33, v8, v193
  v_fma_f32 v33, v10, v205, v33
  v_mul_f32 v34, v8, v194
  v_fma_f32 v34, v10, v206, v34
  v_mul_f32 v36, v8, v195
  v_fma_f32 v36, v10, v207, v36
  v_mul_f32 v37, v8, v196
  v_fma_f32 v37, v10, v208, v37
  v_mul_f32 v38, v8, v197
  v_fma_f32 v38, v10, v209, v38
  v_mul_f32 v40, v8, v198
  v_fma_f32 v40, v10, v210, v40
  v_mul_f32 v41, v8, v199
  v_fma_f32 v41, v10, v211, v41
  v_mul_f32 v42, v8, v200
  v_fma_f32 v42, v10, v212, v42
  v_mul_f32 v44, v8, v201
  v_fma_f32 v44, v10, v213, v44
  v_mul_f32 v45, v8, v202
  v_fma_f32 v45, v10, v214, v45
  v_mul_f32 v46, v8, v203
  v_fma_f32 v46, v10, v215, v46
  v_mul_f32 v49, v8, v9
  v_fma_f32 v49, v10, v11, v49
  s_bfe_u32 s70, s45, 0x20001
  s_cmp_eq_u32 s70, s97
  s_cbranch_scc1 L_own1
  v_mov_b32 v35, v140
  v_mov_b32 v39, v140
  v_mov_b32 v43, v140
  v_mov_b32 v47, v140
  v_mov_b32 v51, v140
  s_mul_i32 s70, s45, 5120
  s_add_u32 s70, s70, 1048576
  s_add_u32 s71, s70, 4096
  buffer_store_dwordx4 v[32:35], v147, s[40:43], s70 offen offset:0 sc1
  buffer_store_dwordx4 v[36:39], v147, s[40:43], s70 offen offset:1024 sc1
  buffer_store_dwordx4 v[40:43], v147, s[40:43], s70 offen offset:2048 sc1
  buffer_store_dwordx4 v[44:47], v147, s[40:43], s70 offen offset:3072 sc1
  buffer_store_dwordx4 v[48:51], v147, s[40:43], s71 offen offset:0 sc1
  s_branch L_pub1
L_own1:
  v_mov_b32 v52, v32
  v_mov_b32 v53, v33
  v_mov_b32 v54, v34
  v_mov_b32 v56, v36
  v_mov_b32 v57, v37
  v_mov_b32 v58, v38
  v_mov_b32 v60, v40
  v_mov_b32 v61, v41
  v_mov_b32 v62, v42
  v_mov_b32 v64, v44
  v_mov_b32 v65, v45
  v_mov_b32 v66, v46
  v_mov_b32 v68, v48
  v_mov_b32 v69, v49
  s_mov_b32 s100, s45
L_pub1:
  s_cmp_eq_u32 s100, -1
  s_cbranch_scc1 L_fin
  s_xor_b32 s84, s100, 1
  s_andn2_b32 s86, s100, 1
  s_xor_b32 s86, s86, 2
  s_add_u32 s88, s86, 1
  s_mul_i32 s84, s84, 5120
  s_add_u32 s84, s84, 1048576
  s_add_u32 s85, s84, 4096
  s_mul_i32 s86, s86, 5120
  s_add_u32 s86, s86, 1048576
  s_add_u32 s87, s86, 4096
  s_mul_i32 s88, s88, 5120
  s_add_u32 s88, s88, 1048576
  s_add_u32 s89, s88, 4096
  s_mov_b32 s64, 0
  s_mov_b32 s90, 7
L_gather:
  s_bitcmp0_b32 s90, 0
  s_cbranch_scc1 L_have0
  buffer_load_dwordx4 v[168:171], v147, s[40:43], s84 offen offset:0 sc1
  buffer_load_dwordx4 v[172:175], v147, s[40:43], s84 offen offset:1024 sc1
  buffer_load_dwordx4 v[176:179], v147, s[40:43], s84 offen offset:2048 sc1
  buffer_load_dwordx4 v[180:183], v147, s[40:43], s84 offen offset:3072 sc1
  buffer_load_dwordx4 v[184:187], v147, s[40:43], s85 offen offset:0 sc1
L_have0:
  s_bitcmp0_b32 s90, 1
  s_cbranch_scc1 L_have1
  buffer_load_dwordx4 v[188:191], v147, s[40:43], s86 offen offset:0 sc1
  buffer_load_dwordx4 v[192:195], v147, s[40:43], s86 offen offset:1024 sc1
  buffer_load_dwordx4 v[196:199], v147, s[40:43], s86 offen offset:2048 sc1
  buffer_load_dwordx4 v[200:203], v147, s[40:43], s86 offen offset:3072 sc1
  buffer_load_dwordx4 v[204:207], v147, s[40:43], s87 offen offset:0 sc1
L_have1:
  s_bitcmp0_b32 s90, 2
  s_cbranch_scc1 L_have2
  buffer_load_dwordx4 v[208:211], v147, s[40:43], s88 offen offset:0 sc1
  buffer_load_dwordx4 v[212:215], v147, s[40:43], s88 offen offset:1024 sc1
  buffer_load_dwordx4 v[216:219], v147, s[40:43], s88 offen offset:2048 sc1
  buffer_load_dwordx4 v[220:223], v147, s[40:43], s88 offen offset:3072 sc1
  buffer_load_dwordx4 v[224:227], v147, s[40:43], s89 offen offset:0 sc1
L_have2:
  s_mov_b32 s90, 0
  s_waitcnt vmcnt(0)
  v_min3_u32 v144, v171, v175, v179
  v_max3_u32 v145, v171, v175, v179
  v_min3_u32 v144, v144, v183, v187
  v_max3_u32 v145, v145, v183, v187
  v_cmp_ne_u32 s[70:71], v140, v144
  v_cmp_ne_u32 vcc, v140, v145
  s_nop 1
  s_or_b64 s[70:71], s[70:71], vcc
  s_cselect_b32 s70, 1, 0
  s_or_b32 s90, s90, s70
  v_min3_u32 v144, v191, v195, v199
  v_max3_u32 v145, v191, v195, v199
  v_min3_u32 v144, v144, v203, v207
  v_max3_u32 v145, v145, v203, v207
  v_cmp_ne_u32 s[70:71], v140, v144
  v_cmp_ne_u32 vcc, v140, v145
  s_nop 1
  s_or_b64 s[70:71], s[70:71], vcc
  s_cselect_b32 s70, 2, 0
  s_or_b32 s90, s90, s70
  v_min3_u32 v144, v211, v215, v219
  v_max3_u32 v145, v211, v215, v219
  v_min3_u32 v144, v144, v223, v227
  v_max3_u32 v145, v145, v223, v227
  v_cmp_ne_u32 s[70:71], v140, v144
  v_cmp_ne_u32 vcc, v140, v145
  s_nop 1
  s_or_b64 s[70:71], s[70:71], vcc
  s_cselect_b32 s70, 4, 0
  s_or_b32 s90, s90, s70
  s_cbranch_scc0 L_gathered
  s_add_u32 s64, s64, 1
  s_cmp_lt_u32 s64, 20000
  s_cbranch_scc1 L_gather
  s_endpgm
L_gathered:
  v_min_f32 v144, v68, v184
  v_min3_f32 v144, v144, v204, v224
  v_sub_f32 v68, v144, v68
  v_sub_f32 v184, v144, v184
  v_sub_f32 v204, v144, v204
  v_sub_f32 v224, v144, v224
  v_exp_f32 v68, v68
  v_exp_f32 v184, v184
  v_exp_f32 v204, v204
  v_exp_f32 v224, v224
  v_mul_u32_u24 v146, 24, v101
  v_and_b32 v144, 15, v0
  v_lshl_add_u32 v146, v144, 3, v146
  s_lshr_b32 s70, s100, 2
  s_mul_i32 s70, s70, 1536
  v_mul_f32 v69, v68, v69
  v_mul_f32 v185, v184, v185
  v_mul_f32 v205, v204, v205
  v_mul_f32 v225, v224, v225
  v_add_f32 v69, v69, v185
  v_add_f32 v205, v205, v225
  v_add_f32 v69, v69, v205
  v_rcp_f32 v145, v69
  v_mul_f32 v52, v68, v52
  v_mul_f32 v168, v184, v168
  v_mul_f32 v188, v204, v188
  v_mul_f32 v208, v224, v208
  v_add_f32 v52, v52, v168
  v_add_f32 v188, v188, v208
  v_add_f32 v52, v52, v188
  v_mul_f32 v52, v145, v52
  v_mul_f32 v53, v68, v53
  v_mul_f32 v169, v184, v169
  v_mul_f32 v189, v204, v189
  v_mul_f32 v209, v224, v209
  v_add_f32 v53, v53, v169
  v_add_f32 v189, v189, v209
  v_add_f32 v53, v53, v189
  v_mul_f32 v53, v145, v53
  v_mul_f32 v54, v68, v54
  v_mul_f32 v170, v184, v170
  v_mul_f32 v190, v204, v190
  v_mul_f32 v210, v224, v210
  v_add_f32 v54, v54, v170
  v_add_f32 v190, v190, v210
  v_add_f32 v54, v54, v190
  v_mul_f32 v54, v145, v54
  v_mul_f32 v56, v68, v56
  v_mul_f32 v172, v184, v172
  v_mul_f32 v192, v204, v192
  v_mul_f32 v212, v224, v212
  v_add_f32 v56, v56, v172
  v_add_f32 v192, v192, v212
  v_add_f32 v56, v56, v192
  v_mul_f32 v56, v145, v56
  v_cvt_pk_bf16_f32 v128, v52, v53
  v_cvt_pk_bf16_f32 v129, v54, v56
  buffer_store_dwordx2 v[128:129], v146, s[36:39], s70 offen offset:0
  v_mul_f32 v57, v68, v57
  v_mul_f32 v173, v184, v173
  v_mul_f32 v193, v204, v193
  v_mul_f32 v213, v224, v213
  v_add_f32 v57, v57, v173
  v_add_f32 v193, v193, v213
  v_add_f32 v57, v57, v193
  v_mul_f32 v57, v145, v57
  v_mul_f32 v58, v68, v58
  v_mul_f32 v174, v184, v174
  v_mul_f32 v194, v204, v194
  v_mul_f32 v214, v224, v214
  v_add_f32 v58, v58, v174
  v_add_f32 v194, v194, v214
  v_add_f32 v58, v58, v194
  v_mul_f32 v58, v145, v58
  v_mul_f32 v60, v68, v60
  v_mul_f32 v176, v184, v176
  v_mul_f32 v196, v204, v196
  v_mul_f32 v216, v224, v216
  v_add_f32 v60, v60, v176
  v_add_f32 v196, v196, v216
  v_add_f32 v60, v60, v196
  v_mul_f32 v60, v145, v60
  v_mul_f32 v61, v68, v61
  v_mul_f32 v177, v184, v177
  v_mul_f32 v197, v204, v197
  v_mul_f32 v217, v224, v217
  v_add_f32 v61, v61, v177
  v_add_f32 v197, v197, v217
  v_add_f32 v61, v61, v197
  v_mul_f32 v61, v145, v61
  v_cvt_pk_bf16_f32 v130, v57, v58
  v_cvt_pk_bf16_f32 v131, v60, v61
  buffer_store_dwordx2 v[130:131], v146, s[36:39], s70 offen offset:128
  v_mul_f32 v62, v68, v62
  v_mul_f32 v178, v184, v178
  v_mul_f32 v198, v204, v198
  v_mul_f32 v218, v224, v218
  v_add_f32 v62, v62, v178
  v_add_f32 v198, v198, v218
  v_add_f32 v62, v62, v198
  v_mul_f32 v62, v145, v62
  v_mul_f32 v64, v68, v64
  v_mul_f32 v180, v184, v180
  v_mul_f32 v200, v204, v200
  v_mul_f32 v220, v224, v220
  v_add_f32 v64, v64, v180
  v_add_f32 v200, v200, v220
  v_add_f32 v64, v64, v200
  v_mul_f32 v64, v145, v64
  v_mul_f32 v65, v68, v65
  v_mul_f32 v181, v184, v181
  v_mul_f32 v201, v204, v201
  v_mul_f32 v221, v224, v221
  v_add_f32 v65, v65, v181
  v_add_f32 v201, v201, v221
  v_add_f32 v65, v65, v201
  v_mul_f32 v65, v145, v65
  v_mul_f32 v66, v68, v66
  v_mul_f32 v182, v184, v182
  v_mul_f32 v202, v204, v202
  v_mul_f32 v222, v224, v222
  v_add_f32 v66, v66, v182
  v_add_f32 v202, v202, v222
  v_add_f32 v66, v66, v202
  v_mul_f32 v66, v145, v66
  v_cvt_pk_bf16_f32 v132, v62, v64
  v_cvt_pk_bf16_f32 v133, v65, v66
  buffer_store_dwordx2 v[132:133], v146, s[36:39], s70 offen offset:256
L_fin:
L_end:
  s_endpgm
L_helper:
  v_lshlrev_b32 v1, 2, v0
  v_add_u32 v1, 61696, v1
  v_mov_b32 v2, 0
  s_mov_b64 exec, 0xff
  ds_write_b32 v1, v2
  s_mov_b64 exec, -1
  s_waitcnt lgkmcnt(0)
  s_mov_b32 s8, s46
  s_and_b32 s9, s47, 0xffff
  s_mov_b32 s36, s44
  s_and_b32 s37, s45, 0xffff
  s_mov_b32 s16, s46
  s_and_b32 s17, s47, 0xffff
  s_mov_b32 s12, s48
  s_and_b32 s13, s49, 0xffff
  s_mov_b32 s40, s82
  s_and_b32 s41, s83, 0xffff
  s_barrier
  s_memrealtime s[72:73]
  s_getpc_b64 s[54:55]
L_h_pc:
  s_add_u32 s86, s54, L_h_cp - L_h_pc
  s_addc_u32 s87, s55, 0
  s_sub_u32 s54, s54, L_h_pc - L_k
  s_subb_u32 s55, s55, 0
  s_and_b32 s54, s54, -16
  s_lshr_b32 s70, s2, 3
  s_lshl_b32 s70, s70, 10
  v_lshl_add_u32 v106, v0, 4, s70
  v_mov_b32 v107, s55
  v_add_co_u32 v106, vcc, s54, v106
  s_nop 1
  v_addc_co_u32 v107, vcc, 0, v107, vcc
  s_lshr_b32 s70, s2, 3
  s_cmp_lt_u32 s70, (L_code_end - L_k) / 1024
  s_cbranch_scc0 L_h_cta
  global_load_dwordx4 v[108:111], v[106:107], off
L_h_cta:
  s_lshr_b32 s70, s2, 4
  s_and_b32 s70, s70, 8
  s_and_b32 s71, s2, 7
  s_add_u32 s70, s70, s71
  s_lshl_b32 s70, s70, 4
  v_lshl_add_u32 v104, v0, 3, s70
  v_and_b32 v105, 31, v0
  v_lshlrev_b32 v105, 3, v105
  v_and_b32 v112, 1, v0
  v_lshlrev_b32 v112, 2, v112
  v_add_u32 v112, 61712, v112
  v_mov_b32 v113, 0
  v_lshlrev_b32 v3, 4, v0
  s_mov_b32 s76, 12
  s_mov_b32 s77, 7340032
  s_getreg_b32 s50, hwreg(HW_REG_XCC_ID)
  s_bfe_u32 s50, s50, 0x10002
  s_bfe_u32 s52, s2, 0x30003
  s_cmp_eq_u32 s52, 7
  s_cbranch_scc1 L_h_voted
  s_lshr_b32 s70, s2, 6
  s_xor_b32 s70, s70, s2
  s_and_b32 s70, s70, 3
  s_cbranch_scc1 L_h_voted
  s_cmp_eq_u32 s52, 6
  s_cbranch_scc0 L_h_probe
  s_xor_b32 s48, s50, s4
  s_and_b32 s52, s2, 3
  s_lshl2_add_u32 s52, s52, 36
  s_branch L_h_vote
L_h_probe:
  s_cmp_ge_u32 s52, 3
  s_cselect_b32 s16, s12, s8
  s_cselect_b32 s17, s13, s9
  s_cselect_b32 s70, 3, 0
  s_sub_u32 s70, s52, s70
  s_lshl_b32 s70, s70, 28
  s_add_u32 s44, s5, s4
  s_lshl_b32 s44, s44, 16
  s_add_u32 s44, s44, s70
  s_add_u32 s44, s44, 0x1c0000
  s_mul_i32 s70, s2, 0x2a95
  s_and_b32 s70, s70, 0x7f80
  s_add_u32 s44, s44, s70
  s_add_u32 s70, s44, 0x8000
  s_buffer_load_dword s58, s[16:19], s70
  s_mov_b32 s45, -1
  s_mov_b32 s46, -1
  s_mul_i32 s52, s52, 6
L_h_progp:
  s_sleep 2
  ds_read_b32 v8, v112
  s_waitcnt lgkmcnt(0)
  v_cmp_gt_u32 vcc, 1, v8
  s_nop 1
  s_cmp_lg_u32 vcc_lo, 0
  s_cbranch_scc1 L_h_progp
  s_xor_b32 s70, s44, 0
  s_memtime s[54:55]
  s_waitcnt lgkmcnt(0)
  s_buffer_load_dword s58, s[16:19], s70
  s_waitcnt lgkmcnt(0)
  s_memtime s[56:57]
  s_waitcnt lgkmcnt(0)
  s_sub_u32 s56, s56, s54
  s_min_u32 s45, s45, s56
  s_xor_b32 s70, s44, 8192
  s_memtime s[54:55]
  s_waitcnt lgkmcnt(0)
  s_buffer_load_dword s58, s[16:19], s70
  s_waitcnt lgkmcnt(0)
  s_memtime s[56:57]
  s_waitcnt lgkmcnt(0)
  s_sub_u32 s56, s56, s54
  s_min_u32 s46, s46, s56
  s_xor_b32 s70, s44, 25472
  s_memtime s[54:55]
  s_waitcnt lgkmcnt(0)
  s_buffer_load_dword s58, s[16:19], s70
  s_waitcnt lgkmcnt(0)
  s_memtime s[56:57]
  s_waitcnt lgkmcnt(0)
  s_sub_u32 s56, s56, s54
  s_min_u32 s46, s46, s56
  s_xor_b32 s70, s44, 17280
  s_memtime s[54:55]
  s_waitcnt lgkmcnt(0)
  s_buffer_load_dword s58, s[16:19], s70
  s_waitcnt lgkmcnt(0)
  s_memtime s[56:57]
  s_waitcnt lgkmcnt(0)
  s_sub_u32 s56, s56, s54
  s_min_u32 s45, s45, s56
  s_xor_b32 s70, s44, 5888
  s_memtime s[54:55]
  s_waitcnt lgkmcnt(0)
  s_buffer_load_dword s58, s[16:19], s70
  s_waitcnt lgkmcnt(0)
  s_memtime s[56:57]
  s_waitcnt lgkmcnt(0)
  s_sub_u32 s56, s56, s54
  s_min_u32 s45, s45, s56
  s_xor_b32 s70, s44, 14080
  s_memtime s[54:55]
  s_waitcnt lgkmcnt(0)
  s_buffer_load_dword s58, s[16:19], s70
  s_waitcnt lgkmcnt(0)
  s_memtime s[56:57]
  s_waitcnt lgkmcnt(0)
  s_sub_u32 s56, s56, s54
  s_min_u32 s46, s46, s56
  s_cmp_lt_u32 s46, s45
  s_cselect_b32 s48, 1, 0
  s_lshr_b32 s70, s44, 13
  s_xor_b32 s70, s70, s2
  s_xor_b32 s70, s70, s50
  s_and_b32 s70, s70, 1
  s_xor_b32 s48, s48, s70
L_h_vote:
  s_mov_b32 s49, 0
  s_lshl_b64 s[48:49], s[48:49], s52
  s_or_b32 s49, s49, 0x1000000
  s_atomic_add_x2 s[48:49], s[80:81], 0
L_h_voted:
  s_waitcnt lgkmcnt(0)
  s_cmp_lg_u32 s2, 56
  s_cbranch_scc1 L_h_nonce
  s_lshl_b64 s[54:55], s[72:73], 2
  s_atomic_add_x2 s[54:55], s[80:81], 8
  s_waitcnt lgkmcnt(0)
L_h_nonce:
L_h_progv:
  s_sleep 8
  ds_read_b32 v8, v112
  s_waitcnt lgkmcnt(0)
  v_cmp_gt_u32 vcc, 6, v8
  s_nop 1
  s_cmp_lg_u32 vcc_lo, 0
  s_cbranch_scc1 L_h_progv
  s_load_dwordx2 s[48:49], s[80:81], 0
  s_mov_b32 s59, 0
L_h_votes:
  s_waitcnt lgkmcnt(0)
  s_lshr_b32 s70, s49, 24
  s_cmp_eq_u32 s70, 56
  s_cbranch_scc1 L_h_votes_done
  s_add_u32 s59, s59, 1
  s_cmp_gt_u32 s59, 2000
  s_cbranch_scc1 L_h_votes_done
  s_sleep 64
  s_mov_b64 s[48:49], 0
  s_atomic_or_x2 s[48:49], s[80:81], 0 glc
  s_branch L_h_votes
L_h_votes_done:
  s_mov_b32 s96, 0x80
  s_bfe_u64 s[54:55], s[48:49], 0x60000
  s_cmp_gt_u32 s54, 4
  s_cselect_b32 s56, 1, 0
  s_or_b32 s96, s96, s56
  s_bfe_u64 s[54:55], s[48:49], 0x60006
  s_cmp_gt_u32 s54, 4
  s_cselect_b32 s56, 2, 0
  s_or_b32 s96, s96, s56
  s_bfe_u64 s[54:55], s[48:49], 0x6000c
  s_cmp_gt_u32 s54, 4
  s_cselect_b32 s56, 4, 0
  s_or_b32 s96, s96, s56
  s_bfe_u64 s[54:55], s[48:49], 0x60012
  s_cmp_gt_u32 s54, 4
  s_cselect_b32 s56, 8, 0
  s_or_b32 s96, s96, s56
  s_bfe_u64 s[54:55], s[48:49], 0x60018
  s_cmp_gt_u32 s54, 4
  s_cselect_b32 s56, 16, 0
  s_or_b32 s96, s96, s56
  s_bfe_u64 s[54:55], s[48:49], 0x6001e
  s_cmp_gt_u32 s54, 4
  s_cselect_b32 s56, 32, 0
  s_or_b32 s96, s96, s56
  s_and_b32 s70, s2, 3
  s_lshl2_add_u32 s70, s70, 5
  s_lshr_b32 s54, s49, s70
  s_xor_b32 s54, s54, s2
  s_xor_b32 s54, s54, s4
  s_and_b32 s54, s54, 1
  s_mul_i32 s54, s54, 63
  s_xor_b32 s96, s96, s54
  v_mov_b32 v1, 61696
  v_mov_b32 v5, s96
  ds_write_b32 v1, v5
  s_load_dwordx2 s[74:75], s[80:81], 8
  s_mov_b32 s59, 0
L_h_getnonce:
  s_waitcnt lgkmcnt(0)
  s_cmp_lg_u64 s[74:75], 0
  s_cbranch_scc1 L_h_gotnonce
  s_add_u32 s59, s59, 1
  s_cmp_gt_u32 s59, 2000
  s_cbranch_scc1 L_h_gotnonce
  s_sleep 64
  s_atomic_or_x2 s[74:75], s[80:81], 8 glc
  s_branch L_h_getnonce
L_h_gotnonce:
  s_lshr_b64 s[54:55], s[74:75], 2
  v_mov_b32 v1, 61704
  v_mov_b32 v5, s54
  ds_write_b32 v1, v5
  s_lshl_b32 s62, s2, 8
  s_add_u32 s62, s62, 7405568
  s_xor_b32 s63, s62, 1024
  s_lshr_b32 s58, s96, 3
  s_xor_b32 s58, s58, s96
  s_lshr_b32 s70, s5, 4
  s_lshr_b32 s44, s70, 5
  s_lshl_b32 s44, s44, 21
  s_add_u32 s44, s44, 8388608
  s_and_b32 s64, s70, 31
  s_add_u32 s70, s64, s4
  s_lshl_b32 s70, s70, 10
  s_add_u32 s60, s44, s70
  s_xor_b32 s61, s60, 1024
  s_mov_b32 s78, 60
  s_swappc_b64 s[84:85], s[86:87]
L_h_proga:
  s_sleep 4
  ds_read_b32 v8, v112
  s_waitcnt lgkmcnt(0)
  v_cmp_gt_u32 vcc, 64, v8
  s_nop 1
  s_cmp_lg_u32 vcc_lo, 0
  s_cbranch_scc1 L_h_proga
  ds_read_b128 v[8:11], v3 offset:0
  ds_read_b128 v[12:15], v3 offset:1024
  ds_read_b128 v[16:19], v3 offset:2048
  s_waitcnt lgkmcnt(0)
  s_xor_b32 s70, s60, 0
  buffer_store_dwordx4 v[8:11], v3, s[40:43], s70 offen sc1
  s_xor_b32 s70, s60, 32768
  buffer_store_dwordx4 v[12:15], v3, s[40:43], s70 offen sc1
  s_xor_b32 s70, s60, 65536
  buffer_store_dwordx4 v[16:19], v3, s[40:43], s70 offen sc1
  s_bitcmp0_b32 s58, 0
  s_cbranch_scc1 L_h_e0
  ds_read_b128 v[20:23], v3 offset:3072
  ds_read_b128 v[24:27], v3 offset:4096
  ds_read_b128 v[28:31], v3 offset:5120
  ds_read_b128 v[32:35], v3 offset:6144
  ds_read_b128 v[36:39], v3 offset:7168
  ds_read_b128 v[40:43], v3 offset:8192
  ds_read_b128 v[44:47], v3 offset:9216
  ds_read_b128 v[48:51], v3 offset:10240
  ds_read_b128 v[52:55], v3 offset:11264
  s_waitcnt lgkmcnt(0)
  s_xor_b32 s70, s60, 98304
  buffer_store_dwordx4 v[20:23], v3, s[40:43], s70 offen sc1
  s_xor_b32 s70, s60, 132096
  buffer_store_dwordx4 v[24:27], v3, s[40:43], s70 offen sc1
  s_xor_b32 s70, s60, 164864
  buffer_store_dwordx4 v[28:31], v3, s[40:43], s70 offen sc1
  s_xor_b32 s70, s60, 197632
  buffer_store_dwordx4 v[32:35], v3, s[40:43], s70 offen sc1
  s_xor_b32 s70, s60, 230400
  buffer_store_dwordx4 v[36:39], v3, s[40:43], s70 offen sc1
  s_xor_b32 s70, s60, 264192
  buffer_store_dwordx4 v[40:43], v3, s[40:43], s70 offen sc1
  s_xor_b32 s70, s60, 296960
  buffer_store_dwordx4 v[44:47], v3, s[40:43], s70 offen sc1
  s_xor_b32 s70, s60, 329728
  buffer_store_dwordx4 v[48:51], v3, s[40:43], s70 offen sc1
  s_xor_b32 s70, s60, 362496
  buffer_store_dwordx4 v[52:55], v3, s[40:43], s70 offen sc1
L_h_e0:
  s_bitcmp0_b32 s58, 1
  s_cbranch_scc1 L_h_e1
  ds_read_b128 v[56:59], v3 offset:12288
  ds_read_b128 v[60:63], v3 offset:13312
  ds_read_b128 v[64:67], v3 offset:14336
  ds_read_b128 v[68:71], v3 offset:15360
  ds_read_b128 v[72:75], v3 offset:16384
  ds_read_b128 v[76:79], v3 offset:17408
  ds_read_b128 v[80:83], v3 offset:18432
  ds_read_b128 v[84:87], v3 offset:19456
  ds_read_b128 v[88:91], v3 offset:20480
  ds_read_b128 v[92:95], v3 offset:21504
  ds_read_b128 v[96:99], v3 offset:22528
  ds_read_b128 v[100:103], v3 offset:23552
  s_waitcnt lgkmcnt(0)
  s_xor_b32 s70, s60, 396288
  buffer_store_dwordx4 v[56:59], v3, s[40:43], s70 offen sc1
  s_xor_b32 s70, s60, 429056
  buffer_store_dwordx4 v[60:63], v3, s[40:43], s70 offen sc1
  s_xor_b32 s70, s60, 461824
  buffer_store_dwordx4 v[64:67], v3, s[40:43], s70 offen sc1
  s_xor_b32 s70, s60, 494592
  buffer_store_dwordx4 v[68:71], v3, s[40:43], s70 offen sc1
  s_xor_b32 s70, s60, 541696
  buffer_store_dwordx4 v[72:75], v3, s[40:43], s70 offen sc1
  s_xor_b32 s70, s60, 574464
  buffer_store_dwordx4 v[76:79], v3, s[40:43], s70 offen sc1
  s_xor_b32 s70, s60, 607232
  buffer_store_dwordx4 v[80:83], v3, s[40:43], s70 offen sc1
  s_xor_b32 s70, s60, 640000
  buffer_store_dwordx4 v[84:87], v3, s[40:43], s70 offen sc1
  s_xor_b32 s70, s60, 671744
  buffer_store_dwordx4 v[88:91], v3, s[40:43], s70 offen sc1
  s_xor_b32 s70, s60, 704512
  buffer_store_dwordx4 v[92:95], v3, s[40:43], s70 offen sc1
  s_xor_b32 s70, s60, 737280
  buffer_store_dwordx4 v[96:99], v3, s[40:43], s70 offen sc1
  s_xor_b32 s70, s60, 770048
  buffer_store_dwordx4 v[100:103], v3, s[40:43], s70 offen sc1
L_h_e1:
  s_add_u32 s54, s74, 1
  v_mov_b32 v5, 0
  s_waitcnt vmcnt(0)
  v_mov_b32 v8, s54
  v_mov_b32 v9, s75
  s_mov_b64 exec, 1
  buffer_store_dwordx2 v[8:9], v5, s[40:43], s62 offen sc1
  s_mov_b32 s59, 0
L_h_flaga:
  buffer_load_dwordx2 v[10:11], v5, s[40:43], s63 offen sc1
  s_waitcnt vmcnt(0)
  v_readfirstlane_b32 s56, v10
  v_readfirstlane_b32 s57, v11
  s_nop 0
  s_sub_u32 s56, s56, s54
  s_xor_b32 s57, s57, s75
  s_lshr_b32 s56, s56, 1
  s_or_b32 s56, s56, s57
  s_cbranch_scc0 L_h_flaga_done
  s_add_u32 s59, s59, 1
  s_cmp_gt_u32 s59, 10000
  s_cbranch_scc1 L_h_flaga_done
  s_sleep 8
  s_branch L_h_flaga
L_h_flaga_done:
  s_mov_b64 exec, -1
  s_bfe_u32 s54, s96, 0x10003
  s_mul_i32 s54, s54, 384
  v_lshrrev_b32 v4, 3, v0
  v_add_u32 v5, 0, v4
  v_mul_u32_u24 v5, 21846, v5
  v_bfe_u32 v5, v5, 16, 1
  v_mul_u32_u24 v6, 384, v5
  v_sub_u32 v6, v3, v6
  v_add_u32 v6, s54, v6
  v_add_u32 v6, 0, v6
  v_add_u32 v5, s64, v5
  v_lshrrev_b32 v2, 12, v6
  v_xor_b32 v5, v5, v2
  v_lshrrev_b32 v2, 10, v6
  v_lshl_add_u32 v5, v2, 5, v5
  v_and_b32 v6, 1023, v6
  v_lshl_add_u32 v5, v5, 10, v6
  buffer_load_dwordx4 v[8:11], v5, s[40:43], s44 offen sc1
  v_add_u32 v5, 8, v4
  v_mul_u32_u24 v5, 21846, v5
  v_bfe_u32 v5, v5, 16, 1
  v_mul_u32_u24 v6, 384, v5
  v_sub_u32 v6, v3, v6
  v_add_u32 v6, s54, v6
  v_add_u32 v6, 1024, v6
  v_add_u32 v5, s64, v5
  v_lshrrev_b32 v2, 12, v6
  v_xor_b32 v5, v5, v2
  v_lshrrev_b32 v2, 10, v6
  v_lshl_add_u32 v5, v2, 5, v5
  v_and_b32 v6, 1023, v6
  v_lshl_add_u32 v5, v5, 10, v6
  buffer_load_dwordx4 v[12:15], v5, s[40:43], s44 offen sc1
  v_add_u32 v5, 16, v4
  v_mul_u32_u24 v5, 21846, v5
  v_bfe_u32 v5, v5, 16, 1
  v_mul_u32_u24 v6, 384, v5
  v_sub_u32 v6, v3, v6
  v_add_u32 v6, s54, v6
  v_add_u32 v6, 2048, v6
  v_add_u32 v5, s64, v5
  v_lshrrev_b32 v2, 12, v6
  v_xor_b32 v5, v5, v2
  v_lshrrev_b32 v2, 10, v6
  v_lshl_add_u32 v5, v2, 5, v5
  v_and_b32 v6, 1023, v6
  v_lshl_add_u32 v5, v5, 10, v6
  buffer_load_dwordx4 v[16:19], v5, s[40:43], s44 offen sc1
  s_bitcmp0_b32 s58, 0
  s_cbranch_scc1 L_h_i0
  s_xor_b32 s70, s61, 98304
  buffer_load_dwordx4 v[20:23], v3, s[40:43], s70 offen sc1
  s_xor_b32 s70, s61, 132096
  buffer_load_dwordx4 v[24:27], v3, s[40:43], s70 offen sc1
  s_xor_b32 s70, s61, 164864
  buffer_load_dwordx4 v[28:31], v3, s[40:43], s70 offen sc1
  s_xor_b32 s70, s61, 197632
  buffer_load_dwordx4 v[32:35], v3, s[40:43], s70 offen sc1
  s_xor_b32 s70, s61, 230400
  buffer_load_dwordx4 v[36:39], v3, s[40:43], s70 offen sc1
  s_xor_b32 s70, s61, 264192
  buffer_load_dwordx4 v[40:43], v3, s[40:43], s70 offen sc1
  s_xor_b32 s70, s61, 296960
  buffer_load_dwordx4 v[44:47], v3, s[40:43], s70 offen sc1
  s_xor_b32 s70, s61, 329728
  buffer_load_dwordx4 v[48:51], v3, s[40:43], s70 offen sc1
  s_xor_b32 s70, s61, 362496
  buffer_load_dwordx4 v[52:55], v3, s[40:43], s70 offen sc1
  s_waitcnt vmcnt(0)
  ds_write_b128 v3, v[20:23] offset:3072
  ds_write_b128 v3, v[24:27] offset:4096
  ds_write_b128 v3, v[28:31] offset:5120
  ds_write_b128 v3, v[32:35] offset:6144
  ds_write_b128 v3, v[36:39] offset:7168
  ds_write_b128 v3, v[40:43] offset:8192
  ds_write_b128 v3, v[44:47] offset:9216
  ds_write_b128 v3, v[48:51] offset:10240
  ds_write_b128 v3, v[52:55] offset:11264
L_h_i0:
  s_bitcmp0_b32 s58, 1
  s_cbranch_scc1 L_h_i1
  s_xor_b32 s70, s61, 396288
  buffer_load_dwordx4 v[56:59], v3, s[40:43], s70 offen sc1
  s_xor_b32 s70, s61, 429056
  buffer_load_dwordx4 v[60:63], v3, s[40:43], s70 offen sc1
  s_xor_b32 s70, s61, 461824
  buffer_load_dwordx4 v[64:67], v3, s[40:43], s70 offen sc1
  s_xor_b32 s70, s61, 494592
  buffer_load_dwordx4 v[68:71], v3, s[40:43], s70 offen sc1
  s_xor_b32 s70, s61, 541696
  buffer_load_dwordx4 v[72:75], v3, s[40:43], s70 offen sc1
  s_xor_b32 s70, s61, 574464
  buffer_load_dwordx4 v[76:79], v3, s[40:43], s70 offen sc1
  s_xor_b32 s70, s61, 607232
  buffer_load_dwordx4 v[80:83], v3, s[40:43], s70 offen sc1
  s_xor_b32 s70, s61, 640000
  buffer_load_dwordx4 v[84:87], v3, s[40:43], s70 offen sc1
  s_xor_b32 s70, s61, 671744
  buffer_load_dwordx4 v[88:91], v3, s[40:43], s70 offen sc1
  s_xor_b32 s70, s61, 704512
  buffer_load_dwordx4 v[92:95], v3, s[40:43], s70 offen sc1
  s_xor_b32 s70, s61, 737280
  buffer_load_dwordx4 v[96:99], v3, s[40:43], s70 offen sc1
  s_xor_b32 s70, s61, 770048
  buffer_load_dwordx4 v[100:103], v3, s[40:43], s70 offen sc1
  s_waitcnt vmcnt(0)
  ds_write_b128 v3, v[56:59] offset:12288
  ds_write_b128 v3, v[60:63] offset:13312
  ds_write_b128 v3, v[64:67] offset:14336
  ds_write_b128 v3, v[68:71] offset:15360
  ds_write_b128 v3, v[72:75] offset:16384
  ds_write_b128 v3, v[76:79] offset:17408
  ds_write_b128 v3, v[80:83] offset:18432
  ds_write_b128 v3, v[84:87] offset:19456
  ds_write_b128 v3, v[88:91] offset:20480
  ds_write_b128 v3, v[92:95] offset:21504
  ds_write_b128 v3, v[96:99] offset:22528
  ds_write_b128 v3, v[100:103] offset:23552
L_h_i1:
  s_waitcnt vmcnt(0)
  ds_write_b128 v3, v[8:11] offset:0
  ds_write_b128 v3, v[12:15] offset:1024
  ds_write_b128 v3, v[16:19] offset:2048
  s_bitcmp0_b32 s58, 2
  s_cselect_b32 s70, 255, 64
  v_mov_b32 v1, 61700
  v_mov_b32 v5, s70
  ds_write_b32 v1, v5
  s_mov_b32 s78, 92
  s_swappc_b64 s[84:85], s[86:87]
  s_bitcmp0_b32 s58, 2
  s_cbranch_scc1 L_h_all
L_h_progb:
  s_sleep 4
  ds_read_b32 v8, v112
  s_waitcnt lgkmcnt(0)
  v_cmp_gt_u32 vcc, 96, v8
  s_nop 1
  s_cmp_lg_u32 vcc_lo, 0
  s_cbranch_scc1 L_h_progb
  ds_read_b128 v[8:11], v3 offset:24576
  ds_read_b128 v[12:15], v3 offset:25600
  ds_read_b128 v[16:19], v3 offset:26624
  ds_read_b128 v[20:23], v3 offset:27648
  ds_read_b128 v[24:27], v3 offset:28672
  ds_read_b128 v[28:31], v3 offset:29696
  ds_read_b128 v[32:35], v3 offset:30720
  ds_read_b128 v[36:39], v3 offset:31744
  ds_read_b128 v[40:43], v3 offset:32768
  ds_read_b128 v[44:47], v3 offset:33792
  ds_read_b128 v[48:51], v3 offset:34816
  ds_read_b128 v[52:55], v3 offset:35840
  s_waitcnt lgkmcnt(0)
  s_xor_b32 s70, s60, 805888
  buffer_store_dwordx4 v[8:11], v3, s[40:43], s70 offen sc1
  s_xor_b32 s70, s60, 838656
  buffer_store_dwordx4 v[12:15], v3, s[40:43], s70 offen sc1
  s_xor_b32 s70, s60, 871424
  buffer_store_dwordx4 v[16:19], v3, s[40:43], s70 offen sc1
  s_xor_b32 s70, s60, 904192
  buffer_store_dwordx4 v[20:23], v3, s[40:43], s70 offen sc1
  s_xor_b32 s70, s60, 935936
  buffer_store_dwordx4 v[24:27], v3, s[40:43], s70 offen sc1
  s_xor_b32 s70, s60, 968704
  buffer_store_dwordx4 v[28:31], v3, s[40:43], s70 offen sc1
  s_xor_b32 s70, s60, 1001472
  buffer_store_dwordx4 v[32:35], v3, s[40:43], s70 offen sc1
  s_xor_b32 s70, s60, 1034240
  buffer_store_dwordx4 v[36:39], v3, s[40:43], s70 offen sc1
  s_xor_b32 s70, s60, 1052672
  buffer_store_dwordx4 v[40:43], v3, s[40:43], s70 offen sc1
  s_xor_b32 s70, s60, 1085440
  buffer_store_dwordx4 v[44:47], v3, s[40:43], s70 offen sc1
  s_xor_b32 s70, s60, 1118208
  buffer_store_dwordx4 v[48:51], v3, s[40:43], s70 offen sc1
  s_xor_b32 s70, s60, 1150976
  buffer_store_dwordx4 v[52:55], v3, s[40:43], s70 offen sc1
  s_add_u32 s54, s74, 2
  v_mov_b32 v5, 0
  s_waitcnt vmcnt(0)
  v_mov_b32 v8, s54
  v_mov_b32 v9, s75
  s_mov_b64 exec, 1
  buffer_store_dwordx2 v[8:9], v5, s[40:43], s62 offen sc1
  s_mov_b32 s59, 0
L_h_flagb:
  buffer_load_dwordx2 v[10:11], v5, s[40:43], s63 offen sc1
  s_waitcnt vmcnt(0)
  v_readfirstlane_b32 s56, v10
  v_readfirstlane_b32 s57, v11
  s_nop 0
  s_sub_u32 s56, s56, s54
  s_xor_b32 s57, s57, s75
  s_lshr_b32 s56, s56, 1
  s_or_b32 s56, s56, s57
  s_cbranch_scc0 L_h_flagb_done
  s_add_u32 s59, s59, 1
  s_cmp_gt_u32 s59, 10000
  s_cbranch_scc1 L_h_flagb_done
  s_sleep 8
  s_branch L_h_flagb
L_h_flagb_done:
  s_mov_b64 exec, -1
  s_xor_b32 s70, s61, 805888
  buffer_load_dwordx4 v[8:11], v3, s[40:43], s70 offen sc1
  s_xor_b32 s70, s61, 838656
  buffer_load_dwordx4 v[12:15], v3, s[40:43], s70 offen sc1
  s_xor_b32 s70, s61, 871424
  buffer_load_dwordx4 v[16:19], v3, s[40:43], s70 offen sc1
  s_xor_b32 s70, s61, 904192
  buffer_load_dwordx4 v[20:23], v3, s[40:43], s70 offen sc1
  s_xor_b32 s70, s61, 935936
  buffer_load_dwordx4 v[24:27], v3, s[40:43], s70 offen sc1
  s_xor_b32 s70, s61, 968704
  buffer_load_dwordx4 v[28:31], v3, s[40:43], s70 offen sc1
  s_xor_b32 s70, s61, 1001472
  buffer_load_dwordx4 v[32:35], v3, s[40:43], s70 offen sc1
  s_xor_b32 s70, s61, 1034240
  buffer_load_dwordx4 v[36:39], v3, s[40:43], s70 offen sc1
  s_xor_b32 s70, s61, 1052672
  buffer_load_dwordx4 v[40:43], v3, s[40:43], s70 offen sc1
  s_xor_b32 s70, s61, 1085440
  buffer_load_dwordx4 v[44:47], v3, s[40:43], s70 offen sc1
  s_xor_b32 s70, s61, 1118208
  buffer_load_dwordx4 v[48:51], v3, s[40:43], s70 offen sc1
  s_xor_b32 s70, s61, 1150976
  buffer_load_dwordx4 v[52:55], v3, s[40:43], s70 offen sc1
  s_waitcnt vmcnt(0)
  ds_write_b128 v3, v[8:11] offset:24576
  ds_write_b128 v3, v[12:15] offset:25600
  ds_write_b128 v3, v[16:19] offset:26624
  ds_write_b128 v3, v[20:23] offset:27648
  ds_write_b128 v3, v[24:27] offset:28672
  ds_write_b128 v3, v[28:31] offset:29696
  ds_write_b128 v3, v[32:35] offset:30720
  ds_write_b128 v3, v[36:39] offset:31744
  ds_write_b128 v3, v[40:43] offset:32768
  ds_write_b128 v3, v[44:47] offset:33792
  ds_write_b128 v3, v[48:51] offset:34816
  ds_write_b128 v3, v[52:55] offset:35840
  v_mov_b32 v1, 61700
  v_mov_b32 v5, 255
  ds_write_b32 v1, v5
L_h_all:
  s_mov_b32 s78, 182
  s_swappc_b64 s[84:85], s[86:87]
L_h_progt:
  s_sleep 4
  ds_read_b32 v8, v112
  s_waitcnt lgkmcnt(0)
  v_cmp_gt_u32 vcc, 188, v8
  s_nop 1
  s_cmp_lg_u32 vcc_lo, 0
  s_cbranch_scc1 L_h_progt
  v_mov_b32 v8, 255
  ds_write_b32 v112, v8 offset:8
  s_waitcnt lgkmcnt(0)
  s_endpgm
L_h_cp:
  s_cmp_gt_u32 s76, s78
  s_cbranch_scc0 L_h_cpgo
  s_setpc_b64 s[84:85]
L_h_cpgo:
  ds_read_b32 v8, v112
  s_waitcnt lgkmcnt(0)
  v_cmp_gt_u32 vcc, s76, v8
  s_nop 1
  s_cmp_eq_u32 vcc_lo, 0
  s_cbranch_scc1 L_h_cpnext
L_h_first:
  s_sleep 2
  ds_read_b32 v8, v112
  s_waitcnt lgkmcnt(0)
  v_cmp_gt_u32 s[48:49], s76, v8
  s_nop 1
  s_cmp_eq_u32 s48, -1
  s_cbranch_scc1 L_h_first
  s_memrealtime s[54:55]
L_h_progm:
  s_sleep 2
  ds_read_b32 v8, v112
  s_waitcnt lgkmcnt(0)
  v_cmp_gt_u32 vcc, s76, v8
  s_nop 1
  s_cmp_lg_u32 vcc_lo, 0
  s_cbranch_scc1 L_h_progm
  s_memrealtime s[56:57]
  v_mov_b32 v114, s54
  v_mov_b32 v115, s55
  s_mov_b64 exec, s[48:49]
  s_waitcnt lgkmcnt(0)
  v_mov_b32 v114, s56
  v_mov_b32 v115, s57
  s_mov_b64 exec, -1
  s_and_b32 s70, s2, 0x78
  s_cbranch_scc1 L_h_np
  s_mov_b64 exec, 3
  buffer_store_dwordx2 v[114:115], v104, s[40:43], s77 offen sc1
  s_mov_b64 exec, -1
L_h_np:
  s_add_u32 s50, s76, 4
L_h_progc:
  s_sleep 4
  ds_read_b32 v8, v112
  s_waitcnt lgkmcnt(0)
  v_cmp_gt_u32 vcc, s50, v8
  s_nop 1
  s_cmp_lg_u32 vcc_lo, 0
  s_cbranch_scc1 L_h_progc
  buffer_load_dwordx2 v[8:9], v105, s[40:43], s77 offen
  v_mov_b32 v10, s73
  s_waitcnt vmcnt(0)
  ds_read_b32 v12, v112
  v_subrev_co_u32 v8, vcc, s72, v8
  s_nop 1
  v_subb_co_u32 v9, vcc, v9, v10, vcc
  v_lshrrev_b32 v10, 24, v8
  v_or_b32 v9, v9, v10
  v_cmp_eq_u32 vcc, 0, v9
  s_nop 1
  v_cndmask_b32 v8, 0, v8, vcc
  s_bcnt1_i32_b32 s56, vcc_lo
  s_nop 0
  v_add_u32_dpp v8, v8, v8 row_ror:8 row_mask:0xf bank_mask:0xf
  s_nop 1
  v_add_u32_dpp v8, v8, v8 row_ror:4 row_mask:0xf bank_mask:0xf
  s_nop 1
  v_add_u32_dpp v8, v8, v8 row_ror:2 row_mask:0xf bank_mask:0xf
  s_nop 1
  v_add_u32_dpp v8, v8, v8 row_ror:1 row_mask:0xf bank_mask:0xf
  s_nop 0
  v_readlane_b32 s54, v8, 0
  v_readlane_b32 s70, v8, 16
  v_subrev_u32 v8, s72, v114
  v_mul_lo_u32 v8, v8, s56
  s_add_u32 s54, s54, s70
  s_max_u32 s56, s56, 1
  v_subrev_u32 v8, s54, v8
  v_cvt_f32_u32 v9, s56
  v_cvt_f32_i32 v8, v8
  v_rcp_f32 v9, v9
  s_nop 0
  v_mul_f32 v8, v8, v9
  v_cvt_i32_f32 v8, v8
  s_waitcnt lgkmcnt(0)
  v_add_u32 v12, 2, v12
  v_min_u32 v9, v113, v12
  v_subrev_u32 v9, s76, v9
  v_max_i32 v9, 0, v9
  v_lshrrev_b32 v9, 1, v9
  v_mul_u32_u24 v9, 28, v9
  v_sub_u32 v8, v8, v9
  v_add_u32 v9, 14, v8
  v_max_i32 v9, 0, v9
  v_min_i32 v9, 2000, v9
  v_mul_u32_u24 v9, 2340, v9
  v_lshrrev_b32 v9, 16, v9
  v_cmp_ne_u32 vcc, 0, v9
  v_lshl_add_u32 v9, v9, 1, v12
  s_nop 0
  v_cndmask_b32 v113, 0, v9, vcc
  ds_write_b32 v112, v113 offset:8
L_h_cpnext:
  s_add_u32 s76, s76, 8
  s_add_u32 s77, s77, 256
  s_branch L_h_cp
L_code_end:
.section .rodata,"a"
.p2align 6
.amdhsa_kernel standalone__kv_cache_quant_int4_int2_kv_with_per_channel_or_per_token_scales__sampling_kernel
  .amdhsa_next_free_vgpr 256
  .amdhsa_next_free_sgpr 102
  .amdhsa_accum_offset 256
  .amdhsa_group_segment_fixed_size 0
  .amdhsa_kernarg_size 80
  .amdhsa_user_sgpr_count 2
  .amdhsa_user_sgpr_kernarg_segment_ptr 1
  .amdhsa_system_sgpr_workgroup_id_x 1
  .amdhsa_float_denorm_mode_32 3
.end_amdhsa_kernel
```

```asm
; @launch grid=(256,1,1) block=(192,1,1) lds=62464
.amdgcn_target "amdgcn-amd-amdhsa--gfx950"
.text
.globl standalone__kv_cache_quant_int4_int2_kv_with_per_channel_or_per_token_scales__sampling_kernel
.p2align 8
.type standalone__kv_cache_quant_int4_int2_kv_with_per_channel_or_per_token_scales__sampling_kernel,@function
standalone__kv_cache_quant_int4_int2_kv_with_per_channel_or_per_token_scales__sampling_kernel:
  s_cmp_ge_u32 s2, 256
  s_cbranch_scc1 L_end
  s_load_dwordx16 s[44:59], s[0:1], 0
  s_load_dwordx4 s[80:83], s[0:1], 64
  v_lshrrev_b32 v1, 6, v0
  v_and_b32 v0, 63, v0
  v_readfirstlane_b32 s3, v1
  s_bfe_u32 s4, s2, 0x10002
  s_lshr_b32 s5, s2, 3
  s_lshl_b32 s5, s5, 2
  s_and_b32 s70, s2, 3
  s_add_u32 s5, s5, s70
  s_lshl_b32 s5, s5, 5
  s_mov_b32 s22, 6291456
  s_mov_b32 s23, 0x20000
  s_mov_b32 s26, 6291456
  s_mov_b32 s27, 0x20000
  s_mov_b32 s30, 2097152
  s_mov_b32 s31, 0x20000
  s_mov_b32 s34, 2097152
  s_mov_b32 s35, 0x20000
  s_mov_b32 s10, 805306368
  s_mov_b32 s11, 0x20000
  s_mov_b32 s38, 393216
  s_mov_b32 s39, 0x20000
  s_mov_b32 s18, 805306368
  s_mov_b32 s19, 0x20000
  s_mov_b32 s14, 805306368
  s_mov_b32 s15, 0x20000
  s_mov_b32 s42, 25165824
  s_mov_b32 s43, 0x20000
  s_cmp_eq_u32 s3, 2
  s_cbranch_scc1 L_helper
  v_and_b32 v108, 3, v0
  v_bfe_u32 v109, v0, 2, 2
  v_lshrrev_b32 v110, 4, v0
  v_and_b32 v111, 15, v0
  v_lshlrev_b32 v144, 4, v108
  v_lshl_add_u32 v144, v110, 6, v144
  v_lshrrev_b32 v233, 1, v144
  v_and_b32 v231, 2, v109
  v_lshlrev_b32 v230, 5, v231
  v_add_u32 v230, 129, v230
  v_and_b32 v145, 1, v109
  v_lshl_add_u32 v231, v145, 2, v231
  v_mul_u32_u24 v145, 33024, v145
  v_add_u32 v232, v144, v145
  v_subrev_u32 v232, 33024, v232
  v_mul_u32_u24 v145, 384, v109
  v_add_u32 v235, v145, v233
  v_mov_b32 v105, 2147483632
  s_mov_b32 s90, 0xaaaaaaab
  s_mov_b32 s91, 0x492492
  s_movk_i32 s63, 768
  s_mov_b32 s64, s3
  s_mov_b32 s99, 8
  s_mov_b32 s96, 0
  v_lshlrev_b32 v114, 4, v0
  s_lshl1_add_u32 s70, s2, s3
  s_mul_i32 s88, s70, 4096
  s_mul_i32 s86, s70, 12288
  s_waitcnt lgkmcnt(0)
  s_mov_b32 s20, s50
  s_and_b32 s21, s51, 0xffff
  s_mov_b32 s24, s52
  s_and_b32 s25, s53, 0xffff
  s_mov_b32 s28, s54
  s_and_b32 s29, s55, 0xffff
  s_mov_b32 s32, s56
  s_and_b32 s33, s57, 0xffff
  buffer_load_dwordx4 v[128:131], v114, s[20:23], s86 offen offset:0
  buffer_load_dwordx4 v[128:131], v114, s[24:27], s86 offen offset:0
  buffer_load_dwordx4 v[128:131], v114, s[28:31], s88 offen offset:0
  buffer_load_dwordx4 v[128:131], v114, s[32:35], s88 offen offset:0
  buffer_load_dwordx4 v[128:131], v114, s[20:23], s86 offen offset:1024
  buffer_load_dwordx4 v[128:131], v114, s[24:27], s86 offen offset:1024
  buffer_load_dwordx4 v[128:131], v114, s[28:31], s88 offen offset:1024
  buffer_load_dwordx4 v[128:131], v114, s[32:35], s88 offen offset:1024
  s_mov_b32 s8, s46
  s_and_b32 s9, s47, 0xffff
  s_mov_b32 s36, s44
  s_and_b32 s37, s45, 0xffff
  s_mov_b32 s16, s46
  s_and_b32 s17, s47, 0xffff
  s_mov_b32 s12, s48
  s_and_b32 s13, s49, 0xffff
  s_mov_b32 s40, s82
  s_and_b32 s41, s83, 0xffff
  s_mov_b64 s[46:47], s[58:59]
  s_mov_b32 s56, 0x0f0f0f0f
  s_mov_b32 s57, 0x0f0f0f0f
  s_mov_b32 s58, 0xffff
  s_mov_b32 s59, 0xffff
  s_lshr_b32 s71, s64, 4
  s_andn2_b32 s71, s71, 1
  s_lshr_b32 s71, 0x12, s71
  s_and_b32 s71, s71, 3
  s_lshr_b32 s85, s96, s71
  s_andn2_b32 s70, s64, 1
  s_or_b32 s70, s70, s4
  s_cmp_lt_u32 s64, 8
  s_cselect_b32 s70, s70, s64
  s_cselect_b32 s85, s64, s85
  s_and_b32 s85, s85, 1
  s_and_b32 s70, s70, 31
  s_lshl_b32 s71, s71, 12
  s_add_u32 s70, s70, s5
  s_add_u32 s70, s70, s71
  s_mul_hi_u32 s84, s70, s90
  s_lshr_b32 s84, s84, 1
  s_mul_i32 s71, s84, 3
  s_sub_u32 s70, s70, s71
  s_lshl3_add_u32 s85, s70, s85
  s_mul_i32 s61, s84, 196608
  s_lshr_b32 s89, s84, 4
  s_lshl_b32 s70, s85, 5
  v_add_u32 v97, s70, v230
  v_mul_u32_u24 v97, 21846, v97
  v_lshrrev_b32 v97, 16, v97
  v_add_u32 v144, s85, v231
  v_lshrrev_b32 v145, v144, s91
  v_and_b32 v145, 1, v145
  v_cmp_eq_u32 s[54:55], 1, v145
  s_nop 1
  s_and_b64 s[52:53], s[54:55], s[56:57]
  s_andn2_b64 s[54:55], s[54:55], s[56:57]
  v_mul_u32_u24 v144, 43, v144
  v_lshrrev_b32 v144, 8, v144
  v_mul_u32_u24 v144, 384, v144
  v_add_u32 v234, v144, v233
  v_mad_u32_u24 v92, v97, s63, v232
  v_add_u32 v93, 768, v92
  v_add_u32 v94, 4608, v92
  v_add_u32 v95, 7680, v92
  v_cndmask_b32 v92, v92, v105, s[52:53]
  v_cndmask_b32 v95, v95, v105, s[54:55]
  s_mov_b32 s60, s61
  s_mul_i32 s70, s89, 1536
  buffer_load_dwordx2 v[174:175], v235, s[36:39], s70 offen offset:0
  buffer_load_dwordx2 v[176:177], v235, s[36:39], s70 offen offset:128
  buffer_load_dwordx2 v[178:179], v235, s[36:39], s70 offen offset:256
  buffer_load_dwordx4 v[4:7], v92, s[8:11], s60 offen offset:0 nt
  buffer_load_dwordx4 v[128:131], v114, s[20:23], s86 offen offset:2048
  buffer_load_dwordx4 v[128:131], v114, s[24:27], s86 offen offset:2048
  buffer_load_dwordx4 v[128:131], v114, s[28:31], s88 offen offset:2048
  buffer_load_dwordx4 v[128:131], v114, s[32:35], s88 offen offset:2048
  buffer_load_dwordx4 v[128:131], v114, s[20:23], s86 offen offset:3072
  buffer_load_dwordx4 v[128:131], v114, s[24:27], s86 offen offset:3072
  buffer_load_dwordx4 v[128:131], v114, s[28:31], s88 offen offset:3072
  buffer_load_dwordx4 v[128:131], v114, s[32:35], s88 offen offset:3072
  s_barrier
  s_mov_b64 vcc, 0
  v_lshlrev_b32 v144, 4, v111
  v_and_b32 v2, 2, v110
  v_lshlrev_b32 v1, 5, v2
  v_add_u32 v1, 129, v1
  v_and_b32 v145, 1, v110
  v_lshl_add_u32 v2, v145, 2, v2
  v_mul_u32_u24 v145, 33024, v145
  v_add_u32 v3, v144, v145
  v_subrev_u32 v3, 33024, v3
  v_and_b32 v145, 1, v110
  v_mul_u32_u24 v145, 86, v145
  v_lshl_add_u32 v96, v111, 1, v145
  v_subrev_u32 v96, 86, v96
  v_lshlrev_b32 v101, 4, v110
  v_lshrrev_b32 v144, 2, v0
  s_mul_i32 s70, s3, 384
  v_lshl_add_u32 v99, v144, 4, s70
  v_lshl_add_u32 v100, v144, 3, s70
  s_mul_i32 s70, s3, 3072
  s_add_u32 s70, s70, 36864
  v_lshl_add_u32 v102, v0, 4, s70
  s_lshl_b32 s70, s3, 5
  s_add_u32 s70, s70, 43008
  v_lshl_add_u32 v103, v109, 3, s70
  s_lshl2_add_u32 s70, s3, 61712
  v_mov_b32 v104, s70
  v_mov_b32 v112, 0
  v_mov_b32 v113, 0
  v_mov_b32 v236, 0xff800000
  v_mov_b32 v146, 1
  s_mov_b32 s65, 0xffff0000
  s_mov_b32 s66, 0x3fb8aa3b
  s_mov_b32 s68, 0x4893cd3a
  s_mov_b32 s92, 0x7f000000
  s_mov_b32 s94, 0x34800000
  s_mov_b32 s44, 0
  s_mov_b32 s69, 0x4893cd3a
  s_mov_b32 s93, 0x7f000000
  s_mov_b32 s95, 0x34800000
  s_mov_b32 s45, 0
  s_mov_b32 s72, 0x11111111
  s_mov_b32 s73, 0x11111111
  s_mov_b32 s74, 0x22222222
  s_mov_b32 s75, 0x22222222
  s_mov_b32 s76, 0x44444444
  s_mov_b32 s77, 0x44444444
  s_mov_b32 s78, 0x88888888
  s_mov_b32 s79, 0x88888888
  s_mov_b32 s100, 0
  s_add_u32 s86, s86, 4096
  s_waitcnt vmcnt(15)
  buffer_load_dwordx4 v[128:131], v114, s[20:23], s86 offen offset:0
  s_waitcnt vmcnt(15)
  buffer_load_dwordx4 v[128:131], v114, s[24:27], s86 offen offset:0
  s_waitcnt vmcnt(15)
  buffer_load_dwordx4 v[128:131], v114, s[20:23], s86 offen offset:1024
  s_waitcnt vmcnt(15)
  buffer_load_dwordx4 v[128:131], v114, s[24:27], s86 offen offset:1024
  s_waitcnt vmcnt(15)
  buffer_load_dwordx4 v[128:131], v114, s[20:23], s86 offen offset:2048
  s_waitcnt vmcnt(15)
  buffer_load_dwordx4 v[128:131], v114, s[24:27], s86 offen offset:2048
  s_waitcnt vmcnt(15)
  buffer_load_dwordx4 v[128:131], v114, s[20:23], s86 offen offset:3072
  s_waitcnt vmcnt(15)
  buffer_load_dwordx4 v[128:131], v114, s[24:27], s86 offen offset:3072
  s_add_u32 s86, s86, 4096
  s_waitcnt vmcnt(15)
  buffer_load_dwordx4 v[128:131], v114, s[20:23], s86 offen offset:0
  s_waitcnt vmcnt(15)
  buffer_load_dwordx4 v[128:131], v114, s[24:27], s86 offen offset:0
  s_waitcnt vmcnt(15)
  buffer_load_dwordx4 v[128:131], v114, s[20:23], s86 offen offset:1024
  s_waitcnt vmcnt(15)
  buffer_load_dwordx4 v[128:131], v114, s[24:27], s86 offen offset:1024
  s_waitcnt vmcnt(15)
  buffer_load_dwordx4 v[128:131], v114, s[20:23], s86 offen offset:2048
  s_waitcnt vmcnt(15)
  buffer_load_dwordx4 v[128:131], v114, s[24:27], s86 offen offset:2048
  s_waitcnt vmcnt(15)
  buffer_load_dwordx4 v[128:131], v114, s[20:23], s86 offen offset:3072
  s_waitcnt vmcnt(15)
  buffer_load_dwordx4 v[128:131], v114, s[24:27], s86 offen offset:3072
  s_mov_b32 s88, s89
  s_mul_i32 s62, s84, 1536
  buffer_load_dwordx2 v[180:181], v234, s[20:23], s62 offen offset:0
  buffer_load_dwordx2 v[186:187], v234, s[24:27], s62 offen offset:0
  buffer_load_dwordx2 v[182:183], v234, s[20:23], s62 offen offset:128
  buffer_load_dwordx2 v[188:189], v234, s[24:27], s62 offen offset:128
  buffer_load_dwordx2 v[184:185], v234, s[20:23], s62 offen offset:256
  buffer_load_dwordx2 v[190:191], v234, s[24:27], s62 offen offset:256
  s_waitcnt vmcnt(15)
  buffer_load_dwordx4 v[8:11], v92, s[8:11], s60 offen offset:256 nt
  s_waitcnt vmcnt(15)
  buffer_load_dwordx4 v[12:15], v92, s[8:11], s60 offen offset:512 nt
  s_waitcnt vmcnt(15)
  buffer_load_dwordx4 v[16:19], v93, s[8:11], s60 offen offset:0 nt
  s_waitcnt vmcnt(15)
  buffer_load_dwordx4 v[20:23], v93, s[8:11], s60 offen offset:256 nt
  s_waitcnt vmcnt(15)
  buffer_load_dwordx4 v[24:27], v93, s[8:11], s60 offen offset:512 nt
  s_waitcnt vmcnt(15)
  buffer_load_dwordx4 v[28:31], v93, s[8:11], s60 offen offset:768 nt
  s_waitcnt vmcnt(15)
  buffer_load_dwordx4 v[32:35], v93, s[8:11], s60 offen offset:1024 nt
  s_waitcnt vmcnt(15)
  buffer_load_dwordx4 v[36:39], v93, s[8:11], s60 offen offset:1280 nt
  s_waitcnt vmcnt(15)
  buffer_load_dwordx4 v[40:43], v93, s[8:11], s60 offen offset:1536 nt
  s_waitcnt vmcnt(15)
  buffer_load_dwordx4 v[44:47], v93, s[8:11], s60 offen offset:1792 nt
  s_waitcnt vmcnt(16)
  buffer_load_dwordx4 v[48:51], v93, s[8:11], s60 offen offset:2048 nt
  s_waitcnt vmcnt(17)
  buffer_load_dwordx4 v[52:55], v93, s[8:11], s60 offen offset:2304 nt
  s_waitcnt vmcnt(18)
  buffer_load_dwordx4 v[56:59], v93, s[8:11], s60 offen offset:2560 nt
  s_waitcnt vmcnt(19)
  buffer_load_dwordx4 v[60:63], v93, s[8:11], s60 offen offset:2816 nt
  s_waitcnt vmcnt(14)
  ds_write_b32 v104, v146
L_k:
  v_add_u32 v144, s85, v2
  v_lshrrev_b32 v145, v144, s91
  v_and_b32 v145, 1, v145
  v_cmp_eq_u32 s[50:51], 1, v145
  s_nop 1
  s_and_b64 s[48:49], s[50:51], s[58:59]
  s_andn2_b64 s[50:51], s[50:51], s[58:59]
  s_mov_b32 s97, s64
  s_add_u32 s64, s64, 2
  ds_read_b32 v106, v104 offset:8
  s_waitcnt vmcnt(14)
  s_cbranch_vccnz L_kw0_0
  s_waitcnt vmcnt(9)
L_kw0_0:
  buffer_load_dwordx4 v[64:67], v93, s[8:11], s60 offen offset:3072 nt
  v_lshlrev_b32 v204, 16, v186
  v_and_b32 v205, s65, v186
  v_lshlrev_b32 v206, 16, v187
  v_and_b32 v207, s65, v187
  v_lshlrev_b32 v192, 16, v180
  v_and_b32 v193, s65, v180
  v_lshlrev_b32 v194, 16, v181
  v_and_b32 v195, s65, v181
  v_pk_mul_f32 v[204:205], v[204:205], s[94:95]
  v_mov_b32 v168, v174
  v_pk_mul_f32 v[206:207], v[206:207], s[94:95]
  v_mov_b32 v169, v175
  v_pk_fma_f32 v[108:109], v[4:5], s[92:93], v[204:205] neg_lo:[0,0,1] neg_hi:[0,0,1]
  v_pk_fma_f32 v[110:111], v[6:7], s[92:93], v[206:207] neg_lo:[0,0,1] neg_hi:[0,0,1]
  v_cvt_pk_bf16_f32 v108, 0, v108
  v_cvt_pk_bf16_f32 v109, 0, v109
  v_cvt_pk_bf16_f32 v110, 0, v110
  v_cvt_pk_bf16_f32 v111, 0, v111
  v_pk_mul_f32 v[108:109], v[108:109], v[192:193]
  v_pk_mul_f32 v[110:111], v[110:111], v[194:195]
  v_cvt_pk_bf16_f32 v216, v108, v109
  v_cvt_pk_bf16_f32 v217, v110, v111
  s_waitcnt lgkmcnt(0)
  v_cmp_lt_u32 vcc, s97, v106
  s_waitcnt vmcnt(14)
  buffer_load_dwordx4 v[68:71], v93, s[8:11], s60 offen offset:3328 nt
  v_lshlrev_b32 v208, 16, v188
  v_and_b32 v209, s65, v188
  v_lshlrev_b32 v210, 16, v189
  v_and_b32 v211, s65, v189
  v_lshlrev_b32 v196, 16, v182
  v_and_b32 v197, s65, v182
  v_lshlrev_b32 v198, 16, v183
  v_and_b32 v199, s65, v183
  v_pk_mul_f32 v[208:209], v[208:209], s[94:95]
  v_mov_b32 v170, v176
  v_pk_mul_f32 v[210:211], v[210:211], s[94:95]
  v_mov_b32 v171, v177
  v_pk_fma_f32 v[108:109], v[8:9], s[92:93], v[208:209] neg_lo:[0,0,1] neg_hi:[0,0,1]
  v_pk_fma_f32 v[110:111], v[10:11], s[92:93], v[210:211] neg_lo:[0,0,1] neg_hi:[0,0,1]
  v_cvt_pk_bf16_f32 v108, 0, v108
  v_cvt_pk_bf16_f32 v109, 0, v109
  v_cvt_pk_bf16_f32 v110, 0, v110
  v_cvt_pk_bf16_f32 v111, 0, v111
  v_pk_mul_f32 v[108:109], v[108:109], v[196:197]
  v_pk_mul_f32 v[110:111], v[110:111], v[198:199]
  v_cvt_pk_bf16_f32 v218, v108, v109
  v_cvt_pk_bf16_f32 v219, v110, v111
  s_waitcnt vmcnt(14)
  buffer_load_dwordx4 v[72:75], v93, s[8:11], s60 offen offset:3584 nt
  v_mfma_f32_16x16x32_bf16 v[224:227], v[216:219], v[168:171], 0
  v_lshlrev_b32 v212, 16, v190
  v_and_b32 v213, s65, v190
  v_lshlrev_b32 v214, 16, v191
  v_and_b32 v215, s65, v191
  v_lshlrev_b32 v200, 16, v184
  v_and_b32 v201, s65, v184
  v_lshlrev_b32 v202, 16, v185
  v_and_b32 v203, s65, v185
  v_pk_mul_f32 v[212:213], v[212:213], s[94:95]
  v_mov_b32 v172, v178
  v_pk_mul_f32 v[214:215], v[214:215], s[94:95]
  v_mov_b32 v173, v179
  v_pk_fma_f32 v[108:109], v[12:13], s[92:93], v[212:213] neg_lo:[0,0,1] neg_hi:[0,0,1]
  v_pk_fma_f32 v[110:111], v[14:15], s[92:93], v[214:215] neg_lo:[0,0,1] neg_hi:[0,0,1]
  v_cvt_pk_bf16_f32 v108, 0, v108
  v_cvt_pk_bf16_f32 v109, 0, v109
  v_cvt_pk_bf16_f32 v110, 0, v110
  v_cvt_pk_bf16_f32 v111, 0, v111
  v_pk_mul_f32 v[108:109], v[108:109], v[200:201]
  v_pk_mul_f32 v[110:111], v[110:111], v[202:203]
  v_cvt_pk_bf16_f32 v220, v108, v109
  v_cvt_pk_bf16_f32 v221, v110, v111
  s_waitcnt vmcnt(14)
  s_cbranch_vccnz L_kw0_3
  s_waitcnt vmcnt(9)
L_kw0_3:
  buffer_load_dwordx4 v[76:79], v94, s[8:11], s60 offen offset:0 nt
  v_mfma_f32_16x16x16_bf16 v[224:227], v[220:221], v[172:173], v[224:227]
  v_pk_fma_f32 v[108:109], v[16:17], s[92:93], v[204:205] neg_lo:[0,0,1] neg_hi:[0,0,1]
  v_pk_fma_f32 v[110:111], v[18:19], s[92:93], v[206:207] neg_lo:[0,0,1] neg_hi:[0,0,1]
  v_cvt_pk_bf16_f32 v108, 0, v108
  v_cvt_pk_bf16_f32 v109, 0, v109
  v_cvt_pk_bf16_f32 v110, 0, v110
  v_cvt_pk_bf16_f32 v111, 0, v111
  v_pk_mul_f32 v[108:109], v[108:109], v[192:193]
  v_pk_mul_f32 v[110:111], v[110:111], v[194:195]
  v_cvt_pk_bf16_f32 v216, v108, v109
  v_cvt_pk_bf16_f32 v217, v110, v111
  s_waitcnt vmcnt(14)
  buffer_load_dwordx4 v[80:83], v94, s[8:11], s60 offen offset:256 nt
  v_pk_fma_f32 v[108:109], v[20:21], s[92:93], v[208:209] neg_lo:[0,0,1] neg_hi:[0,0,1]
  v_pk_fma_f32 v[110:111], v[22:23], s[92:93], v[210:211] neg_lo:[0,0,1] neg_hi:[0,0,1]
  v_mov_b32_dpp v144, v224 quad_perm:[0,0,0,0] row_mask:0xf bank_mask:0xf
  v_mov_b32_dpp v145, v226 quad_perm:[2,2,2,2] row_mask:0xf bank_mask:0xf
  v_cvt_pk_bf16_f32 v108, 0, v108
  v_cvt_pk_bf16_f32 v109, 0, v109
  v_add_f32_dpp v144, v225, v144 quad_perm:[1,1,1,1] row_mask:0xf bank_mask:0xf
  v_add_f32_dpp v145, v227, v145 quad_perm:[3,3,3,3] row_mask:0xf bank_mask:0xf
  v_cvt_pk_bf16_f32 v110, 0, v110
  v_cvt_pk_bf16_f32 v111, 0, v111
  v_add_f32 v228, v144, v145
  v_pk_mul_f32 v[108:109], v[108:109], v[196:197]
  v_pk_mul_f32 v[110:111], v[110:111], v[198:199]
  v_cvt_pk_bf16_f32 v218, v108, v109
  v_cvt_pk_bf16_f32 v219, v110, v111
  s_waitcnt vmcnt(14)
  buffer_load_dwordx4 v[84:87], v94, s[8:11], s60 offen offset:512 nt
  v_mfma_f32_16x16x32_bf16 v[224:227], v[216:219], v[168:171], 0
  v_pk_fma_f32 v[108:109], v[24:25], s[92:93], v[212:213] neg_lo:[0,0,1] neg_hi:[0,0,1]
  v_pk_fma_f32 v[110:111], v[26:27], s[92:93], v[214:215] neg_lo:[0,0,1] neg_hi:[0,0,1]
  v_cvt_pk_bf16_f32 v108, 0, v108
  v_cndmask_b32 v228, v228, v236, s[48:49]
  v_cvt_pk_bf16_f32 v109, 0, v109
  v_cvt_pk_bf16_f32 v110, 0, v110
  v_cvt_pk_bf16_f32 v111, 0, v111
  v_pk_mul_f32 v[108:109], v[108:109], v[200:201]
  v_pk_mul_f32 v[110:111], v[110:111], v[202:203]
  v_cvt_pk_bf16_f32 v220, v108, v109
  v_cvt_pk_bf16_f32 v221, v110, v111
  s_waitcnt vmcnt(14)
  s_cbranch_vccnz L_kw0_6
  s_waitcnt vmcnt(9)
L_kw0_6:
  buffer_load_dwordx4 v[88:91], v94, s[8:11], s60 offen offset:768 nt
  v_mfma_f32_16x16x16_bf16 v[224:227], v[220:221], v[172:173], v[224:227]
  v_pk_fma_f32 v[108:109], v[28:29], s[92:93], v[204:205] neg_lo:[0,0,1] neg_hi:[0,0,1]
  v_pk_fma_f32 v[110:111], v[30:31], s[92:93], v[206:207] neg_lo:[0,0,1] neg_hi:[0,0,1]
  v_cvt_pk_bf16_f32 v108, 0, v108
  v_cvt_pk_bf16_f32 v109, 0, v109
  v_cvt_pk_bf16_f32 v110, 0, v110
  v_cvt_pk_bf16_f32 v111, 0, v111
  v_pk_mul_f32 v[108:109], v[108:109], v[192:193]
  v_pk_mul_f32 v[110:111], v[110:111], v[194:195]
  v_cvt_pk_bf16_f32 v216, v108, v109
  v_cvt_pk_bf16_f32 v217, v110, v111
  s_waitcnt vmcnt(14)
  buffer_load_dwordx4 v[4:7], v94, s[8:11], s60 offen offset:1024 nt
  v_pk_fma_f32 v[108:109], v[32:33], s[92:93], v[208:209] neg_lo:[0,0,1] neg_hi:[0,0,1]
  v_pk_fma_f32 v[110:111], v[34:35], s[92:93], v[210:211] neg_lo:[0,0,1] neg_hi:[0,0,1]
  v_mov_b32_dpp v144, v224 quad_perm:[0,0,0,0] row_mask:0xf bank_mask:0xf
  v_mov_b32_dpp v145, v226 quad_perm:[2,2,2,2] row_mask:0xf bank_mask:0xf
  v_cvt_pk_bf16_f32 v108, 0, v108
  v_cvt_pk_bf16_f32 v109, 0, v109
  v_add_f32_dpp v144, v225, v144 quad_perm:[1,1,1,1] row_mask:0xf bank_mask:0xf
  v_add_f32_dpp v145, v227, v145 quad_perm:[3,3,3,3] row_mask:0xf bank_mask:0xf
  v_cvt_pk_bf16_f32 v110, 0, v110
  v_cvt_pk_bf16_f32 v111, 0, v111
  v_add_f32 v229, v144, v145
  v_pk_mul_f32 v[108:109], v[108:109], v[196:197]
  v_pk_mul_f32 v[110:111], v[110:111], v[198:199]
  v_cvt_pk_bf16_f32 v218, v108, v109
  v_cvt_pk_bf16_f32 v219, v110, v111
  s_waitcnt vmcnt(14)
  buffer_load_dwordx4 v[8:11], v94, s[8:11], s60 offen offset:1280 nt
  v_mfma_f32_16x16x32_bf16 v[224:227], v[216:219], v[168:171], 0
  v_pk_fma_f32 v[108:109], v[36:37], s[92:93], v[212:213] neg_lo:[0,0,1] neg_hi:[0,0,1]
  v_pk_fma_f32 v[110:111], v[38:39], s[92:93], v[214:215] neg_lo:[0,0,1] neg_hi:[0,0,1]
  v_cvt_pk_bf16_f32 v108, 0, v108
  v_cvt_pk_bf16_f32 v228, 0, v228
  v_cvt_pk_bf16_f32 v109, 0, v109
  v_cvt_pk_bf16_f32 v229, 0, v229
  v_cvt_pk_bf16_f32 v110, 0, v110
  v_pk_mul_f32 v[228:229], v[228:229], s[68:69]
  v_cvt_pk_bf16_f32 v111, 0, v111
  v_cvt_pk_bf16_f32 v120, v228, v229
  v_pk_mul_f32 v[108:109], v[108:109], v[200:201]
  v_pk_mul_f32 v[110:111], v[110:111], v[202:203]
  v_cvt_pk_bf16_f32 v220, v108, v109
  v_cvt_pk_bf16_f32 v221, v110, v111
  s_waitcnt vmcnt(14)
  s_cbranch_vccnz L_kw0_9
  s_waitcnt vmcnt(9)
L_kw0_9:
  buffer_load_dwordx4 v[12:15], v94, s[8:11], s60 offen offset:1536 nt
  v_mfma_f32_16x16x16_bf16 v[224:227], v[220:221], v[172:173], v[224:227]
  v_pk_fma_f32 v[108:109], v[40:41], s[92:93], v[204:205] neg_lo:[0,0,1] neg_hi:[0,0,1]
  v_pk_fma_f32 v[110:111], v[42:43], s[92:93], v[206:207] neg_lo:[0,0,1] neg_hi:[0,0,1]
  v_cvt_pk_bf16_f32 v108, 0, v108
  v_cvt_pk_bf16_f32 v109, 0, v109
  v_cvt_pk_bf16_f32 v110, 0, v110
  v_cvt_pk_bf16_f32 v111, 0, v111
  v_pk_mul_f32 v[108:109], v[108:109], v[192:193]
  v_pk_mul_f32 v[110:111], v[110:111], v[194:195]
  v_cvt_pk_bf16_f32 v216, v108, v109
  v_cvt_pk_bf16_f32 v217, v110, v111
  s_waitcnt vmcnt(14)
  buffer_load_dwordx4 v[16:19], v94, s[8:11], s60 offen offset:1792 nt
  v_pk_fma_f32 v[108:109], v[44:45], s[92:93], v[208:209] neg_lo:[0,0,1] neg_hi:[0,0,1]
  v_pk_fma_f32 v[110:111], v[46:47], s[92:93], v[210:211] neg_lo:[0,0,1] neg_hi:[0,0,1]
  v_mov_b32_dpp v144, v224 quad_perm:[0,0,0,0] row_mask:0xf bank_mask:0xf
  v_mov_b32_dpp v145, v226 quad_perm:[2,2,2,2] row_mask:0xf bank_mask:0xf
  v_cvt_pk_bf16_f32 v108, 0, v108
  v_cvt_pk_bf16_f32 v109, 0, v109
  v_add_f32_dpp v144, v225, v144 quad_perm:[1,1,1,1] row_mask:0xf bank_mask:0xf
  v_add_f32_dpp v145, v227, v145 quad_perm:[3,3,3,3] row_mask:0xf bank_mask:0xf
  v_cvt_pk_bf16_f32 v110, 0, v110
  v_cvt_pk_bf16_f32 v111, 0, v111
  v_add_f32 v228, v144, v145
  v_pk_mul_f32 v[108:109], v[108:109], v[196:197]
  v_pk_mul_f32 v[110:111], v[110:111], v[198:199]
  v_cvt_pk_bf16_f32 v218, v108, v109
  v_cvt_pk_bf16_f32 v219, v110, v111
  s_waitcnt vmcnt(14)
  buffer_load_dwordx4 v[20:23], v94, s[8:11], s60 offen offset:2048 nt
  v_mfma_f32_16x16x32_bf16 v[224:227], v[216:219], v[168:171], 0
  v_pk_fma_f32 v[108:109], v[48:49], s[92:93], v[212:213] neg_lo:[0,0,1] neg_hi:[0,0,1]
  v_pk_fma_f32 v[110:111], v[50:51], s[92:93], v[214:215] neg_lo:[0,0,1] neg_hi:[0,0,1]
  v_cvt_pk_bf16_f32 v108, 0, v108
  v_cvt_pk_bf16_f32 v109, 0, v109
  v_cvt_pk_bf16_f32 v110, 0, v110
  v_cvt_pk_bf16_f32 v111, 0, v111
  v_pk_mul_f32 v[108:109], v[108:109], v[200:201]
  v_pk_mul_f32 v[110:111], v[110:111], v[202:203]
  v_cvt_pk_bf16_f32 v220, v108, v109
  v_cvt_pk_bf16_f32 v221, v110, v111
  s_waitcnt vmcnt(14)
  s_cbranch_vccnz L_kw0_12
  s_waitcnt vmcnt(9)
L_kw0_12:
  buffer_load_dwordx4 v[24:27], v94, s[8:11], s60 offen offset:2304 nt
  v_mfma_f32_16x16x16_bf16 v[224:227], v[220:221], v[172:173], v[224:227]
  v_pk_fma_f32 v[108:109], v[52:53], s[92:93], v[204:205] neg_lo:[0,0,1] neg_hi:[0,0,1]
  v_pk_fma_f32 v[110:111], v[54:55], s[92:93], v[206:207] neg_lo:[0,0,1] neg_hi:[0,0,1]
  v_cvt_pk_bf16_f32 v108, 0, v108
  v_cvt_pk_bf16_f32 v109, 0, v109
  v_cvt_pk_bf16_f32 v110, 0, v110
  v_cvt_pk_bf16_f32 v111, 0, v111
  v_pk_mul_f32 v[108:109], v[108:109], v[192:193]
  v_pk_mul_f32 v[110:111], v[110:111], v[194:195]
  v_cvt_pk_bf16_f32 v216, v108, v109
  v_cvt_pk_bf16_f32 v217, v110, v111
  s_waitcnt vmcnt(14)
  buffer_load_dwordx4 v[28:31], v94, s[8:11], s60 offen offset:2560 nt
  v_pk_fma_f32 v[108:109], v[56:57], s[92:93], v[208:209] neg_lo:[0,0,1] neg_hi:[0,0,1]
  v_pk_fma_f32 v[110:111], v[58:59], s[92:93], v[210:211] neg_lo:[0,0,1] neg_hi:[0,0,1]
  v_mov_b32_dpp v144, v224 quad_perm:[0,0,0,0] row_mask:0xf bank_mask:0xf
  v_mov_b32_dpp v145, v226 quad_perm:[2,2,2,2] row_mask:0xf bank_mask:0xf
  v_cvt_pk_bf16_f32 v108, 0, v108
  v_cvt_pk_bf16_f32 v109, 0, v109
  v_add_f32_dpp v144, v225, v144 quad_perm:[1,1,1,1] row_mask:0xf bank_mask:0xf
  v_add_f32_dpp v145, v227, v145 quad_perm:[3,3,3,3] row_mask:0xf bank_mask:0xf
  v_cvt_pk_bf16_f32 v110, 0, v110
  v_cvt_pk_bf16_f32 v111, 0, v111
  v_add_f32 v229, v144, v145
  v_pk_mul_f32 v[108:109], v[108:109], v[196:197]
  v_pk_mul_f32 v[110:111], v[110:111], v[198:199]
  v_cvt_pk_bf16_f32 v218, v108, v109
  v_cvt_pk_bf16_f32 v219, v110, v111
  s_waitcnt vmcnt(14)
  buffer_load_dwordx4 v[32:35], v94, s[8:11], s60 offen offset:2816 nt
  v_mfma_f32_16x16x32_bf16 v[224:227], v[216:219], v[168:171], 0
  v_pk_fma_f32 v[108:109], v[60:61], s[92:93], v[212:213] neg_lo:[0,0,1] neg_hi:[0,0,1]
  v_pk_fma_f32 v[110:111], v[62:63], s[92:93], v[214:215] neg_lo:[0,0,1] neg_hi:[0,0,1]
  v_cvt_pk_bf16_f32 v108, 0, v108
  v_cvt_pk_bf16_f32 v228, 0, v228
  v_cvt_pk_bf16_f32 v109, 0, v109
  v_cvt_pk_bf16_f32 v229, 0, v229
  v_cvt_pk_bf16_f32 v110, 0, v110
  v_pk_mul_f32 v[228:229], v[228:229], s[68:69]
  v_cvt_pk_bf16_f32 v111, 0, v111
  v_cvt_pk_bf16_f32 v121, v228, v229
  v_pk_mul_f32 v[108:109], v[108:109], v[200:201]
  v_pk_mul_f32 v[110:111], v[110:111], v[202:203]
  v_cvt_pk_bf16_f32 v220, v108, v109
  v_cvt_pk_bf16_f32 v221, v110, v111
  s_waitcnt vmcnt(14)
  s_cbranch_vccnz L_kw0_15
  s_waitcnt vmcnt(9)
L_kw0_15:
  buffer_load_dwordx4 v[36:39], v95, s[8:11], s60 offen offset:0 nt
  v_mfma_f32_16x16x16_bf16 v[224:227], v[220:221], v[172:173], v[224:227]
  v_pk_fma_f32 v[108:109], v[64:65], s[92:93], v[204:205] neg_lo:[0,0,1] neg_hi:[0,0,1]
  v_pk_fma_f32 v[110:111], v[66:67], s[92:93], v[206:207] neg_lo:[0,0,1] neg_hi:[0,0,1]
  v_cvt_pk_bf16_f32 v108, 0, v108
  v_cvt_pk_bf16_f32 v109, 0, v109
  v_cvt_pk_bf16_f32 v110, 0, v110
  v_cvt_pk_bf16_f32 v111, 0, v111
  v_pk_mul_f32 v[108:109], v[108:109], v[192:193]
  v_pk_mul_f32 v[110:111], v[110:111], v[194:195]
  v_cvt_pk_bf16_f32 v216, v108, v109
  v_cvt_pk_bf16_f32 v217, v110, v111
  s_waitcnt vmcnt(14)
  buffer_load_dwordx4 v[40:43], v95, s[8:11], s60 offen offset:256 nt
  v_pk_fma_f32 v[108:109], v[68:69], s[92:93], v[208:209] neg_lo:[0,0,1] neg_hi:[0,0,1]
  v_pk_fma_f32 v[110:111], v[70:71], s[92:93], v[210:211] neg_lo:[0,0,1] neg_hi:[0,0,1]
  v_mov_b32_dpp v144, v224 quad_perm:[0,0,0,0] row_mask:0xf bank_mask:0xf
  v_mov_b32_dpp v145, v226 quad_perm:[2,2,2,2] row_mask:0xf bank_mask:0xf
  v_cvt_pk_bf16_f32 v108, 0, v108
  v_cvt_pk_bf16_f32 v109, 0, v109
  v_add_f32_dpp v144, v225, v144 quad_perm:[1,1,1,1] row_mask:0xf bank_mask:0xf
  v_add_f32_dpp v145, v227, v145 quad_perm:[3,3,3,3] row_mask:0xf bank_mask:0xf
  v_cvt_pk_bf16_f32 v110, 0, v110
  v_cvt_pk_bf16_f32 v111, 0, v111
  v_add_f32 v228, v144, v145
  v_pk_mul_f32 v[108:109], v[108:109], v[196:197]
  v_pk_mul_f32 v[110:111], v[110:111], v[198:199]
  v_cvt_pk_bf16_f32 v218, v108, v109
  v_cvt_pk_bf16_f32 v219, v110, v111
  s_waitcnt vmcnt(14)
  buffer_load_dwordx4 v[44:47], v95, s[8:11], s60 offen offset:512 nt
  v_mfma_f32_16x16x32_bf16 v[224:227], v[216:219], v[168:171], 0
  v_pk_fma_f32 v[108:109], v[72:73], s[92:93], v[212:213] neg_lo:[0,0,1] neg_hi:[0,0,1]
  v_pk_fma_f32 v[110:111], v[74:75], s[92:93], v[214:215] neg_lo:[0,0,1] neg_hi:[0,0,1]
  s_cmp_lt_u32 s64, s99
  s_cbranch_scc1 L_k_known0
L_k_spin0:
  v_mov_b32 v144, 61696
  ds_read_b32 v144, v144
  s_waitcnt lgkmcnt(0)
  v_readfirstlane_b32 s96, v144
  s_nop 1
  s_cmp_eq_u32 s96, 0
  s_cbranch_scc1 L_k_spin0
  s_mov_b32 s99, -1
L_k_known0:
  s_lshr_b32 s71, s64, 4
  s_andn2_b32 s71, s71, 1
  s_lshr_b32 s71, 0x12, s71
  s_and_b32 s71, s71, 3
  s_lshr_b32 s85, s96, s71
  s_andn2_b32 s70, s64, 1
  s_or_b32 s70, s70, s4
  s_cmp_lt_u32 s64, 8
  s_cselect_b32 s70, s70, s64
  s_cselect_b32 s85, s64, s85
  s_and_b32 s85, s85, 1
  s_and_b32 s70, s70, 31
  s_lshl_b32 s71, s71, 12
  s_add_u32 s70, s70, s5
  s_add_u32 s70, s70, s71
  s_mul_hi_u32 s84, s70, s90
  s_lshr_b32 s84, s84, 1
  s_mul_i32 s71, s84, 3
  s_sub_u32 s70, s70, s71
  s_lshl3_add_u32 s85, s70, s85
  s_mul_i32 s61, s84, 196608
  s_lshr_b32 s89, s84, 4
  s_lshl_b32 s70, s85, 5
  v_add_u32 v97, s70, v230
  v_mul_u32_u24 v97, 21846, v97
  v_lshrrev_b32 v97, 16, v97
  v_add_u32 v144, s85, v231
  v_lshrrev_b32 v145, v144, s91
  v_and_b32 v145, 1, v145
  v_cmp_eq_u32 s[54:55], 1, v145
  s_nop 1
  s_and_b64 s[52:53], s[54:55], s[56:57]
  s_andn2_b64 s[54:55], s[54:55], s[56:57]
  v_mul_u32_u24 v144, 43, v144
  v_lshrrev_b32 v144, 8, v144
  v_mul_u32_u24 v144, 384, v144
  v_add_u32 v234, v144, v233
  s_cmp_eq_u32 s89, s88
  s_cbranch_scc1 L_k_sameq0
  s_mul_i32 s70, s89, 1536
  buffer_load_dwordx2 v[174:175], v235, s[36:39], s70 offen offset:0
  buffer_load_dwordx2 v[176:177], v235, s[36:39], s70 offen offset:128
  buffer_load_dwordx2 v[178:179], v235, s[36:39], s70 offen offset:256
  s_mov_b32 s88, s89
L_k_sameq0:
  s_mul_i32 s62, s84, 1536
  buffer_load_dwordx2 v[180:181], v234, s[20:23], s62 offen offset:0
  buffer_load_dwordx2 v[186:187], v234, s[24:27], s62 offen offset:0
  buffer_load_dwordx2 v[182:183], v234, s[20:23], s62 offen offset:128
  buffer_load_dwordx2 v[188:189], v234, s[24:27], s62 offen offset:128
  buffer_load_dwordx2 v[184:185], v234, s[20:23], s62 offen offset:256
  buffer_load_dwordx2 v[190:191], v234, s[24:27], s62 offen offset:256
  v_cvt_pk_bf16_f32 v108, 0, v108
  v_cvt_pk_bf16_f32 v109, 0, v109
  v_cvt_pk_bf16_f32 v110, 0, v110
  v_cvt_pk_bf16_f32 v111, 0, v111
  v_pk_mul_f32 v[108:109], v[108:109], v[200:201]
  v_pk_mul_f32 v[110:111], v[110:111], v[202:203]
  v_cvt_pk_bf16_f32 v220, v108, v109
  v_cvt_pk_bf16_f32 v221, v110, v111
  v_mad_u32_u24 v92, v97, s63, v232
  v_add_u32 v93, 768, v92
  v_add_u32 v94, 4608, v92
  v_add_u32 v95, 7680, v92
  v_cndmask_b32 v92, v92, v105, s[52:53]
  v_cndmask_b32 v95, v95, v105, s[54:55]
  s_waitcnt vmcnt(20)
  s_cbranch_vccnz L_kw0_18
  s_waitcnt vmcnt(15)
L_kw0_18:
  buffer_load_dwordx4 v[48:51], v92, s[16:19], s61 offen offset:0 nt
  v_mfma_f32_16x16x16_bf16 v[224:227], v[220:221], v[172:173], v[224:227]
  v_pk_fma_f32 v[108:109], v[76:77], s[92:93], v[204:205] neg_lo:[0,0,1] neg_hi:[0,0,1]
  v_pk_fma_f32 v[110:111], v[78:79], s[92:93], v[206:207] neg_lo:[0,0,1] neg_hi:[0,0,1]
  v_cvt_pk_bf16_f32 v108, 0, v108
  v_cvt_pk_bf16_f32 v109, 0, v109
  v_cvt_pk_bf16_f32 v110, 0, v110
  v_cvt_pk_bf16_f32 v111, 0, v111
  v_pk_mul_f32 v[108:109], v[108:109], v[192:193]
  v_pk_mul_f32 v[110:111], v[110:111], v[194:195]
  v_cvt_pk_bf16_f32 v216, v108, v109
  v_cvt_pk_bf16_f32 v217, v110, v111
  s_waitcnt vmcnt(20)
  buffer_load_dwordx4 v[52:55], v92, s[16:19], s61 offen offset:256 nt
  v_pk_fma_f32 v[108:109], v[80:81], s[92:93], v[208:209] neg_lo:[0,0,1] neg_hi:[0,0,1]
  v_pk_fma_f32 v[110:111], v[82:83], s[92:93], v[210:211] neg_lo:[0,0,1] neg_hi:[0,0,1]
  v_mov_b32_dpp v144, v224 quad_perm:[0,0,0,0] row_mask:0xf bank_mask:0xf
  v_mov_b32_dpp v145, v226 quad_perm:[2,2,2,2] row_mask:0xf bank_mask:0xf
  v_cvt_pk_bf16_f32 v108, 0, v108
  v_cvt_pk_bf16_f32 v109, 0, v109
  v_add_f32_dpp v144, v225, v144 quad_perm:[1,1,1,1] row_mask:0xf bank_mask:0xf
  v_add_f32_dpp v145, v227, v145 quad_perm:[3,3,3,3] row_mask:0xf bank_mask:0xf
  v_cvt_pk_bf16_f32 v110, 0, v110
  v_cvt_pk_bf16_f32 v111, 0, v111
  v_add_f32 v229, v144, v145
  v_pk_mul_f32 v[108:109], v[108:109], v[196:197]
  v_pk_mul_f32 v[110:111], v[110:111], v[198:199]
  v_cvt_pk_bf16_f32 v218, v108, v109
  v_cvt_pk_bf16_f32 v219, v110, v111
  s_waitcnt vmcnt(20)
  buffer_load_dwordx4 v[56:59], v92, s[16:19], s61 offen offset:512 nt
  v_mfma_f32_16x16x32_bf16 v[224:227], v[216:219], v[168:171], 0
  v_pk_fma_f32 v[108:109], v[84:85], s[92:93], v[212:213] neg_lo:[0,0,1] neg_hi:[0,0,1]
  v_pk_fma_f32 v[110:111], v[86:87], s[92:93], v[214:215] neg_lo:[0,0,1] neg_hi:[0,0,1]
  v_cvt_pk_bf16_f32 v108, 0, v108
  v_cvt_pk_bf16_f32 v228, 0, v228
  v_cvt_pk_bf16_f32 v109, 0, v109
  v_cvt_pk_bf16_f32 v229, 0, v229
  v_cvt_pk_bf16_f32 v110, 0, v110
  v_pk_mul_f32 v[228:229], v[228:229], s[68:69]
  v_cvt_pk_bf16_f32 v111, 0, v111
  v_cvt_pk_bf16_f32 v122, v228, v229
  v_pk_mul_f32 v[108:109], v[108:109], v[200:201]
  v_pk_mul_f32 v[110:111], v[110:111], v[202:203]
  v_cvt_pk_bf16_f32 v220, v108, v109
  v_cvt_pk_bf16_f32 v221, v110, v111
  s_waitcnt vmcnt(20)
  s_cbranch_vccnz L_kw0_21
  s_waitcnt vmcnt(15)
L_kw0_21:
  buffer_load_dwordx4 v[60:63], v93, s[16:19], s61 offen offset:0 nt
  v_mfma_f32_16x16x16_bf16 v[224:227], v[220:221], v[172:173], v[224:227]
  v_pk_fma_f32 v[108:109], v[88:89], s[92:93], v[204:205] neg_lo:[0,0,1] neg_hi:[0,0,1]
  v_pk_fma_f32 v[110:111], v[90:91], s[92:93], v[206:207] neg_lo:[0,0,1] neg_hi:[0,0,1]
  v_cvt_pk_bf16_f32 v108, 0, v108
  v_cvt_pk_bf16_f32 v109, 0, v109
  v_cvt_pk_bf16_f32 v110, 0, v110
  v_cvt_pk_bf16_f32 v111, 0, v111
  v_pk_mul_f32 v[108:109], v[108:109], v[192:193]
  v_pk_mul_f32 v[110:111], v[110:111], v[194:195]
  v_cvt_pk_bf16_f32 v216, v108, v109
  v_cvt_pk_bf16_f32 v217, v110, v111
  s_waitcnt vmcnt(20)
  buffer_load_dwordx4 v[64:67], v93, s[16:19], s61 offen offset:256 nt
  v_pk_fma_f32 v[108:109], v[4:5], s[92:93], v[208:209] neg_lo:[0,0,1] neg_hi:[0,0,1]
  v_pk_fma_f32 v[110:111], v[6:7], s[92:93], v[210:211] neg_lo:[0,0,1] neg_hi:[0,0,1]
  v_mov_b32_dpp v144, v224 quad_perm:[0,0,0,0] row_mask:0xf bank_mask:0xf
  v_mov_b32_dpp v145, v226 quad_perm:[2,2,2,2] row_mask:0xf bank_mask:0xf
  v_cvt_pk_bf16_f32 v108, 0, v108
  v_cvt_pk_bf16_f32 v109, 0, v109
  v_add_f32_dpp v144, v225, v144 quad_perm:[1,1,1,1] row_mask:0xf bank_mask:0xf
  v_add_f32_dpp v145, v227, v145 quad_perm:[3,3,3,3] row_mask:0xf bank_mask:0xf
  v_cvt_pk_bf16_f32 v110, 0, v110
  v_cvt_pk_bf16_f32 v111, 0, v111
  v_add_f32 v228, v144, v145
  v_pk_mul_f32 v[108:109], v[108:109], v[196:197]
  v_pk_mul_f32 v[110:111], v[110:111], v[198:199]
  v_cvt_pk_bf16_f32 v218, v108, v109
  v_cvt_pk_bf16_f32 v219, v110, v111
  s_waitcnt vmcnt(20)
  buffer_load_dwordx4 v[68:71], v93, s[16:19], s61 offen offset:512 nt
  v_mfma_f32_16x16x32_bf16 v[224:227], v[216:219], v[168:171], 0
  v_pk_fma_f32 v[108:109], v[8:9], s[92:93], v[212:213] neg_lo:[0,0,1] neg_hi:[0,0,1]
  v_pk_fma_f32 v[110:111], v[10:11], s[92:93], v[214:215] neg_lo:[0,0,1] neg_hi:[0,0,1]
  v_cvt_pk_bf16_f32 v108, 0, v108
  v_cvt_pk_bf16_f32 v109, 0, v109
  v_cvt_pk_bf16_f32 v110, 0, v110
  v_cvt_pk_bf16_f32 v111, 0, v111
  v_pk_mul_f32 v[108:109], v[108:109], v[200:201]
  v_pk_mul_f32 v[110:111], v[110:111], v[202:203]
  v_cvt_pk_bf16_f32 v220, v108, v109
  v_cvt_pk_bf16_f32 v221, v110, v111
  s_waitcnt vmcnt(20)
  s_cbranch_vccnz L_kw0_24
  s_waitcnt vmcnt(15)
L_kw0_24:
  buffer_load_dwordx4 v[72:75], v93, s[16:19], s61 offen offset:768 nt
  v_mfma_f32_16x16x16_bf16 v[224:227], v[220:221], v[172:173], v[224:227]
  v_pk_fma_f32 v[108:109], v[12:13], s[92:93], v[204:205] neg_lo:[0,0,1] neg_hi:[0,0,1]
  v_pk_fma_f32 v[110:111], v[14:15], s[92:93], v[206:207] neg_lo:[0,0,1] neg_hi:[0,0,1]
  v_cvt_pk_bf16_f32 v108, 0, v108
  v_cvt_pk_bf16_f32 v109, 0, v109
  v_cvt_pk_bf16_f32 v110, 0, v110
  v_cvt_pk_bf16_f32 v111, 0, v111
  v_pk_mul_f32 v[108:109], v[108:109], v[192:193]
  v_pk_mul_f32 v[110:111], v[110:111], v[194:195]
  v_cvt_pk_bf16_f32 v216, v108, v109
  v_cvt_pk_bf16_f32 v217, v110, v111
  s_waitcnt vmcnt(20)
  buffer_load_dwordx4 v[76:79], v93, s[16:19], s61 offen offset:1024 nt
  v_pk_fma_f32 v[108:109], v[16:17], s[92:93], v[208:209] neg_lo:[0,0,1] neg_hi:[0,0,1]
  v_pk_fma_f32 v[110:111], v[18:19], s[92:93], v[210:211] neg_lo:[0,0,1] neg_hi:[0,0,1]
  v_mov_b32_dpp v144, v224 quad_perm:[0,0,0,0] row_mask:0xf bank_mask:0xf
  v_mov_b32_dpp v145, v226 quad_perm:[2,2,2,2] row_mask:0xf bank_mask:0xf
  v_cvt_pk_bf16_f32 v108, 0, v108
  v_cvt_pk_bf16_f32 v109, 0, v109
  v_add_f32_dpp v144, v225, v144 quad_perm:[1,1,1,1] row_mask:0xf bank_mask:0xf
  v_add_f32_dpp v145, v227, v145 quad_perm:[3,3,3,3] row_mask:0xf bank_mask:0xf
  v_cvt_pk_bf16_f32 v110, 0, v110
  v_cvt_pk_bf16_f32 v111, 0, v111
  v_add_f32 v229, v144, v145
  v_pk_mul_f32 v[108:109], v[108:109], v[196:197]
  v_pk_mul_f32 v[110:111], v[110:111], v[198:199]
  v_cvt_pk_bf16_f32 v218, v108, v109
  v_cvt_pk_bf16_f32 v219, v110, v111
  s_waitcnt vmcnt(20)
  buffer_load_dwordx4 v[80:83], v93, s[16:19], s61 offen offset:1280 nt
  v_mfma_f32_16x16x32_bf16 v[224:227], v[216:219], v[168:171], 0
  v_pk_fma_f32 v[108:109], v[20:21], s[92:93], v[212:213] neg_lo:[0,0,1] neg_hi:[0,0,1]
  v_pk_fma_f32 v[110:111], v[22:23], s[92:93], v[214:215] neg_lo:[0,0,1] neg_hi:[0,0,1]
  v_cvt_pk_bf16_f32 v108, 0, v108
  v_cvt_pk_bf16_f32 v228, 0, v228
  v_cvt_pk_bf16_f32 v109, 0, v109
  v_cvt_pk_bf16_f32 v229, 0, v229
  v_cvt_pk_bf16_f32 v110, 0, v110
  v_pk_mul_f32 v[228:229], v[228:229], s[68:69]
  v_cvt_pk_bf16_f32 v111, 0, v111
  v_cvt_pk_bf16_f32 v123, v228, v229
  v_pk_mul_f32 v[108:109], v[108:109], v[200:201]
  v_pk_mul_f32 v[110:111], v[110:111], v[202:203]
  v_cvt_pk_bf16_f32 v220, v108, v109
  v_cvt_pk_bf16_f32 v221, v110, v111
  s_waitcnt vmcnt(20)
  s_cbranch_vccnz L_kw0_27
  s_waitcnt vmcnt(15)
L_kw0_27:
  buffer_load_dwordx4 v[84:87], v93, s[16:19], s61 offen offset:1536 nt
  v_mfma_f32_16x16x16_bf16 v[224:227], v[220:221], v[172:173], v[224:227]
  v_pk_fma_f32 v[108:109], v[24:25], s[92:93], v[204:205] neg_lo:[0,0,1] neg_hi:[0,0,1]
  v_pk_fma_f32 v[110:111], v[26:27], s[92:93], v[206:207] neg_lo:[0,0,1] neg_hi:[0,0,1]
  v_cvt_pk_bf16_f32 v108, 0, v108
  v_cvt_pk_bf16_f32 v109, 0, v109
  v_cvt_pk_bf16_f32 v110, 0, v110
  v_cvt_pk_bf16_f32 v111, 0, v111
  v_pk_mul_f32 v[108:109], v[108:109], v[192:193]
  v_pk_mul_f32 v[110:111], v[110:111], v[194:195]
  v_cvt_pk_bf16_f32 v216, v108, v109
  v_cvt_pk_bf16_f32 v217, v110, v111
  s_waitcnt vmcnt(20)
  buffer_load_dwordx4 v[88:91], v93, s[16:19], s61 offen offset:1792 nt
  v_pk_fma_f32 v[108:109], v[28:29], s[92:93], v[208:209] neg_lo:[0,0,1] neg_hi:[0,0,1]
  v_pk_fma_f32 v[110:111], v[30:31], s[92:93], v[210:211] neg_lo:[0,0,1] neg_hi:[0,0,1]
  v_mov_b32_dpp v144, v224 quad_perm:[0,0,0,0] row_mask:0xf bank_mask:0xf
  v_mov_b32_dpp v145, v226 quad_perm:[2,2,2,2] row_mask:0xf bank_mask:0xf
  v_cvt_pk_bf16_f32 v108, 0, v108
  v_cvt_pk_bf16_f32 v109, 0, v109
  v_add_f32_dpp v144, v225, v144 quad_perm:[1,1,1,1] row_mask:0xf bank_mask:0xf
  v_add_f32_dpp v145, v227, v145 quad_perm:[3,3,3,3] row_mask:0xf bank_mask:0xf
  v_cvt_pk_bf16_f32 v110, 0, v110
  v_cvt_pk_bf16_f32 v111, 0, v111
  v_add_f32 v228, v144, v145
  v_pk_mul_f32 v[108:109], v[108:109], v[196:197]
  v_pk_mul_f32 v[110:111], v[110:111], v[198:199]
  v_cvt_pk_bf16_f32 v218, v108, v109
  v_cvt_pk_bf16_f32 v219, v110, v111
  s_waitcnt vmcnt(20)
  buffer_load_dwordx4 v[4:7], v93, s[16:19], s61 offen offset:2048 nt
  v_mfma_f32_16x16x32_bf16 v[224:227], v[216:219], v[168:171], 0
  v_pk_fma_f32 v[108:109], v[32:33], s[92:93], v[212:213] neg_lo:[0,0,1] neg_hi:[0,0,1]
  v_pk_fma_f32 v[110:111], v[34:35], s[92:93], v[214:215] neg_lo:[0,0,1] neg_hi:[0,0,1]
  v_cvt_pk_bf16_f32 v108, 0, v108
  v_cvt_pk_bf16_f32 v109, 0, v109
  v_cvt_pk_bf16_f32 v110, 0, v110
  v_cvt_pk_bf16_f32 v111, 0, v111
  v_pk_mul_f32 v[108:109], v[108:109], v[200:201]
  v_pk_mul_f32 v[110:111], v[110:111], v[202:203]
  v_cvt_pk_bf16_f32 v220, v108, v109
  v_cvt_pk_bf16_f32 v221, v110, v111
  s_waitcnt vmcnt(20)
  s_cbranch_vccnz L_kw0_30
  s_waitcnt vmcnt(9)
L_kw0_30:
  buffer_load_dwordx4 v[8:11], v93, s[16:19], s61 offen offset:2304 nt
  v_mfma_f32_16x16x16_bf16 v[224:227], v[220:221], v[172:173], v[224:227]
  v_pk_fma_f32 v[108:109], v[36:37], s[92:93], v[204:205] neg_lo:[0,0,1] neg_hi:[0,0,1]
  v_pk_fma_f32 v[110:111], v[38:39], s[92:93], v[206:207] neg_lo:[0,0,1] neg_hi:[0,0,1]
  v_cvt_pk_bf16_f32 v108, 0, v108
  v_cvt_pk_bf16_f32 v109, 0, v109
  v_cvt_pk_bf16_f32 v110, 0, v110
  v_cvt_pk_bf16_f32 v111, 0, v111
  v_pk_mul_f32 v[108:109], v[108:109], v[192:193]
  v_pk_mul_f32 v[110:111], v[110:111], v[194:195]
  v_cvt_pk_bf16_f32 v216, v108, v109
  v_cvt_pk_bf16_f32 v217, v110, v111
  s_waitcnt vmcnt(20)
  buffer_load_dwordx4 v[12:15], v93, s[16:19], s61 offen offset:2560 nt
  v_pk_fma_f32 v[108:109], v[40:41], s[92:93], v[208:209] neg_lo:[0,0,1] neg_hi:[0,0,1]
  v_pk_fma_f32 v[110:111], v[42:43], s[92:93], v[210:211] neg_lo:[0,0,1] neg_hi:[0,0,1]
  v_mov_b32_dpp v144, v224 quad_perm:[0,0,0,0] row_mask:0xf bank_mask:0xf
  v_mov_b32_dpp v145, v226 quad_perm:[2,2,2,2] row_mask:0xf bank_mask:0xf
  v_cvt_pk_bf16_f32 v108, 0, v108
  v_cvt_pk_bf16_f32 v109, 0, v109
  v_add_f32_dpp v144, v225, v144 quad_perm:[1,1,1,1] row_mask:0xf bank_mask:0xf
  v_add_f32_dpp v145, v227, v145 quad_perm:[3,3,3,3] row_mask:0xf bank_mask:0xf
  v_cvt_pk_bf16_f32 v110, 0, v110
  v_cvt_pk_bf16_f32 v111, 0, v111
  v_add_f32 v229, v144, v145
  v_pk_mul_f32 v[108:109], v[108:109], v[196:197]
  v_pk_mul_f32 v[110:111], v[110:111], v[198:199]
  v_cvt_pk_bf16_f32 v218, v108, v109
  v_cvt_pk_bf16_f32 v219, v110, v111
  s_waitcnt vmcnt(20)
  buffer_load_dwordx4 v[16:19], v93, s[16:19], s61 offen offset:2816 nt
  v_mfma_f32_16x16x32_bf16 v[224:227], v[216:219], v[168:171], 0
  v_pk_fma_f32 v[108:109], v[44:45], s[92:93], v[212:213] neg_lo:[0,0,1] neg_hi:[0,0,1]
  v_pk_fma_f32 v[110:111], v[46:47], s[92:93], v[214:215] neg_lo:[0,0,1] neg_hi:[0,0,1]
  v_cvt_pk_bf16_f32 v108, 0, v108
  v_cvt_pk_bf16_f32 v228, 0, v228
  v_cvt_pk_bf16_f32 v109, 0, v109
  v_cvt_pk_bf16_f32 v229, 0, v229
  v_cvt_pk_bf16_f32 v110, 0, v110
  v_pk_mul_f32 v[228:229], v[228:229], s[68:69]
  v_cvt_pk_bf16_f32 v111, 0, v111
  v_cvt_pk_bf16_f32 v124, v228, v229
  v_pk_mul_f32 v[108:109], v[108:109], v[200:201]
  v_pk_mul_f32 v[110:111], v[110:111], v[202:203]
  v_cvt_pk_bf16_f32 v220, v108, v109
  v_cvt_pk_bf16_f32 v221, v110, v111
  s_mov_b32 s60, s61
  v_mov_b32 v146, s64
  v_mfma_f32_16x16x16_bf16 v[224:227], v[220:221], v[172:173], v[224:227]
  ds_write_b128 v99, v[120:123]
  v_add_u32 v99, 768, v99
  s_nop 5
  v_mov_b32_dpp v144, v224 quad_perm:[0,0,0,0] row_mask:0xf bank_mask:0xf
  v_mov_b32_dpp v145, v226 quad_perm:[2,2,2,2] row_mask:0xf bank_mask:0xf
  s_nop 0
  v_add_f32_dpp v144, v225, v144 quad_perm:[1,1,1,1] row_mask:0xf bank_mask:0xf
  v_add_f32_dpp v145, v227, v145 quad_perm:[3,3,3,3] row_mask:0xf bank_mask:0xf
  v_add_f32 v228, v144, v145
  v_cndmask_b32 v228, v228, v236, s[50:51]
  v_cvt_pk_bf16_f32 v228, 0, v228
  v_cvt_pk_bf16_f32 v229, 0, v229
  v_pk_mul_f32 v[228:229], v[228:229], s[68:69]
  v_cvt_pk_bf16_f32 v125, v228, v229
  ds_write_b64 v100, v[124:125] offset:256
  ds_write_b32 v104, v146
  v_add_u32 v100, 768, v100
  v_add_u32 v144, s85, v2
  v_lshrrev_b32 v145, v144, s91
  v_and_b32 v145, 1, v145
  v_cmp_eq_u32 s[50:51], 1, v145
  s_nop 1
  s_and_b64 s[48:49], s[50:51], s[58:59]
  s_andn2_b64 s[50:51], s[50:51], s[58:59]
  s_mov_b32 s97, s64
  s_add_u32 s64, s64, 2
  ds_read_b32 v106, v104 offset:8
  s_waitcnt vmcnt(14)
  s_cbranch_vccnz L_kw1_0
  s_waitcnt vmcnt(9)
L_kw1_0:
  buffer_load_dwordx4 v[20:23], v93, s[8:11], s60 offen offset:3072 nt
  v_lshlrev_b32 v204, 16, v186
  v_and_b32 v205, s65, v186
  v_lshlrev_b32 v206, 16, v187
  v_and_b32 v207, s65, v187
  v_lshlrev_b32 v192, 16, v180
  v_and_b32 v193, s65, v180
  v_lshlrev_b32 v194, 16, v181
  v_and_b32 v195, s65, v181
  v_pk_mul_f32 v[204:205], v[204:205], s[94:95]
  v_mov_b32 v168, v174
  v_pk_mul_f32 v[206:207], v[206:207], s[94:95]
  v_mov_b32 v169, v175
  v_pk_fma_f32 v[108:109], v[48:49], s[92:93], v[204:205] neg_lo:[0,0,1] neg_hi:[0,0,1]
  v_pk_fma_f32 v[110:111], v[50:51], s[92:93], v[206:207] neg_lo:[0,0,1] neg_hi:[0,0,1]
  v_cvt_pk_bf16_f32 v108, 0, v108
  v_cvt_pk_bf16_f32 v109, 0, v109
  v_cvt_pk_bf16_f32 v110, 0, v110
  v_cvt_pk_bf16_f32 v111, 0, v111
  v_pk_mul_f32 v[108:109], v[108:109], v[192:193]
  v_pk_mul_f32 v[110:111], v[110:111], v[194:195]
  v_cvt_pk_bf16_f32 v216, v108, v109
  v_cvt_pk_bf16_f32 v217, v110, v111
  s_waitcnt lgkmcnt(0)
  v_cmp_lt_u32 vcc, s97, v106
  s_waitcnt vmcnt(14)
  buffer_load_dwordx4 v[24:27], v93, s[8:11], s60 offen offset:3328 nt
  v_lshlrev_b32 v208, 16, v188
  v_and_b32 v209, s65, v188
  v_lshlrev_b32 v210, 16, v189
  v_and_b32 v211, s65, v189
  v_lshlrev_b32 v196, 16, v182
  v_and_b32 v197, s65, v182
  v_lshlrev_b32 v198, 16, v183
  v_and_b32 v199, s65, v183
  v_pk_mul_f32 v[208:209], v[208:209], s[94:95]
  v_mov_b32 v170, v176
  v_pk_mul_f32 v[210:211], v[210:211], s[94:95]
  v_mov_b32 v171, v177
  v_pk_fma_f32 v[108:109], v[52:53], s[92:93], v[208:209] neg_lo:[0,0,1] neg_hi:[0,0,1]
  v_pk_fma_f32 v[110:111], v[54:55], s[92:93], v[210:211] neg_lo:[0,0,1] neg_hi:[0,0,1]
  v_cvt_pk_bf16_f32 v108, 0, v108
  v_cvt_pk_bf16_f32 v109, 0, v109
  v_cvt_pk_bf16_f32 v110, 0, v110
  v_cvt_pk_bf16_f32 v111, 0, v111
  v_pk_mul_f32 v[108:109], v[108:109], v[196:197]
  v_pk_mul_f32 v[110:111], v[110:111], v[198:199]
  v_cvt_pk_bf16_f32 v218, v108, v109
  v_cvt_pk_bf16_f32 v219, v110, v111
  s_waitcnt vmcnt(14)
  buffer_load_dwordx4 v[28:31], v93, s[8:11], s60 offen offset:3584 nt
  v_mfma_f32_16x16x32_bf16 v[224:227], v[216:219], v[168:171], 0
  v_lshlrev_b32 v212, 16, v190
  v_and_b32 v213, s65, v190
  v_lshlrev_b32 v214, 16, v191
  v_and_b32 v215, s65, v191
  v_lshlrev_b32 v200, 16, v184
  v_and_b32 v201, s65, v184
  v_lshlrev_b32 v202, 16, v185
  v_and_b32 v203, s65, v185
  v_pk_mul_f32 v[212:213], v[212:213], s[94:95]
  v_mov_b32 v172, v178
  v_pk_mul_f32 v[214:215], v[214:215], s[94:95]
  v_mov_b32 v173, v179
  v_pk_fma_f32 v[108:109], v[56:57], s[92:93], v[212:213] neg_lo:[0,0,1] neg_hi:[0,0,1]
  v_pk_fma_f32 v[110:111], v[58:59], s[92:93], v[214:215] neg_lo:[0,0,1] neg_hi:[0,0,1]
  v_cvt_pk_bf16_f32 v108, 0, v108
  v_cvt_pk_bf16_f32 v109, 0, v109
  v_cvt_pk_bf16_f32 v110, 0, v110
  v_cvt_pk_bf16_f32 v111, 0, v111
  v_pk_mul_f32 v[108:109], v[108:109], v[200:201]
  v_pk_mul_f32 v[110:111], v[110:111], v[202:203]
  v_cvt_pk_bf16_f32 v220, v108, v109
  v_cvt_pk_bf16_f32 v221, v110, v111
  s_waitcnt vmcnt(14)
  s_cbranch_vccnz L_kw1_3
  s_waitcnt vmcnt(9)
L_kw1_3:
  buffer_load_dwordx4 v[32:35], v94, s[8:11], s60 offen offset:0 nt
  v_mfma_f32_16x16x16_bf16 v[224:227], v[220:221], v[172:173], v[224:227]
  v_pk_fma_f32 v[108:109], v[60:61], s[92:93], v[204:205] neg_lo:[0,0,1] neg_hi:[0,0,1]
  v_pk_fma_f32 v[110:111], v[62:63], s[92:93], v[206:207] neg_lo:[0,0,1] neg_hi:[0,0,1]
  v_cvt_pk_bf16_f32 v108, 0, v108
  v_cvt_pk_bf16_f32 v109, 0, v109
  v_cvt_pk_bf16_f32 v110, 0, v110
  v_cvt_pk_bf16_f32 v111, 0, v111
  v_pk_mul_f32 v[108:109], v[108:109], v[192:193]
  v_pk_mul_f32 v[110:111], v[110:111], v[194:195]
  v_cvt_pk_bf16_f32 v216, v108, v109
  v_cvt_pk_bf16_f32 v217, v110, v111
  s_waitcnt vmcnt(14)
  buffer_load_dwordx4 v[36:39], v94, s[8:11], s60 offen offset:256 nt
  v_pk_fma_f32 v[108:109], v[64:65], s[92:93], v[208:209] neg_lo:[0,0,1] neg_hi:[0,0,1]
  v_pk_fma_f32 v[110:111], v[66:67], s[92:93], v[210:211] neg_lo:[0,0,1] neg_hi:[0,0,1]
  v_mov_b32_dpp v144, v224 quad_perm:[0,0,0,0] row_mask:0xf bank_mask:0xf
  v_mov_b32_dpp v145, v226 quad_perm:[2,2,2,2] row_mask:0xf bank_mask:0xf
  v_cvt_pk_bf16_f32 v108, 0, v108
  v_cvt_pk_bf16_f32 v109, 0, v109
  v_add_f32_dpp v144, v225, v144 quad_perm:[1,1,1,1] row_mask:0xf bank_mask:0xf
  v_add_f32_dpp v145, v227, v145 quad_perm:[3,3,3,3] row_mask:0xf bank_mask:0xf
  v_cvt_pk_bf16_f32 v110, 0, v110
  v_cvt_pk_bf16_f32 v111, 0, v111
  v_add_f32 v228, v144, v145
  v_pk_mul_f32 v[108:109], v[108:109], v[196:197]
  v_pk_mul_f32 v[110:111], v[110:111], v[198:199]
  v_cvt_pk_bf16_f32 v218, v108, v109
  v_cvt_pk_bf16_f32 v219, v110, v111
  s_waitcnt vmcnt(14)
  buffer_load_dwordx4 v[40:43], v94, s[8:11], s60 offen offset:512 nt
  v_mfma_f32_16x16x32_bf16 v[224:227], v[216:219], v[168:171], 0
  v_pk_fma_f32 v[108:109], v[68:69], s[92:93], v[212:213] neg_lo:[0,0,1] neg_hi:[0,0,1]
  v_pk_fma_f32 v[110:111], v[70:71], s[92:93], v[214:215] neg_lo:[0,0,1] neg_hi:[0,0,1]
  v_cvt_pk_bf16_f32 v108, 0, v108
  v_cndmask_b32 v228, v228, v236, s[48:49]
  v_cvt_pk_bf16_f32 v109, 0, v109
  v_cvt_pk_bf16_f32 v110, 0, v110
  v_cvt_pk_bf16_f32 v111, 0, v111
  v_pk_mul_f32 v[108:109], v[108:109], v[200:201]
  v_pk_mul_f32 v[110:111], v[110:111], v[202:203]
  v_cvt_pk_bf16_f32 v220, v108, v109
  v_cvt_pk_bf16_f32 v221, v110, v111
  s_waitcnt vmcnt(14)
  s_cbranch_vccnz L_kw1_6
  s_waitcnt vmcnt(9)
L_kw1_6:
  buffer_load_dwordx4 v[44:47], v94, s[8:11], s60 offen offset:768 nt
  v_mfma_f32_16x16x16_bf16 v[224:227], v[220:221], v[172:173], v[224:227]
  v_pk_fma_f32 v[108:109], v[72:73], s[92:93], v[204:205] neg_lo:[0,0,1] neg_hi:[0,0,1]
  v_pk_fma_f32 v[110:111], v[74:75], s[92:93], v[206:207] neg_lo:[0,0,1] neg_hi:[0,0,1]
  v_cvt_pk_bf16_f32 v108, 0, v108
  v_cvt_pk_bf16_f32 v109, 0, v109
  v_cvt_pk_bf16_f32 v110, 0, v110
  v_cvt_pk_bf16_f32 v111, 0, v111
  v_pk_mul_f32 v[108:109], v[108:109], v[192:193]
  v_pk_mul_f32 v[110:111], v[110:111], v[194:195]
  v_cvt_pk_bf16_f32 v216, v108, v109
  v_cvt_pk_bf16_f32 v217, v110, v111
  s_waitcnt vmcnt(14)
  buffer_load_dwordx4 v[48:51], v94, s[8:11], s60 offen offset:1024 nt
  v_pk_fma_f32 v[108:109], v[76:77], s[92:93], v[208:209] neg_lo:[0,0,1] neg_hi:[0,0,1]
  v_pk_fma_f32 v[110:111], v[78:79], s[92:93], v[210:211] neg_lo:[0,0,1] neg_hi:[0,0,1]
  v_mov_b32_dpp v144, v224 quad_perm:[0,0,0,0] row_mask:0xf bank_mask:0xf
  v_mov_b32_dpp v145, v226 quad_perm:[2,2,2,2] row_mask:0xf bank_mask:0xf
  v_cvt_pk_bf16_f32 v108, 0, v108
  v_cvt_pk_bf16_f32 v109, 0, v109
  v_add_f32_dpp v144, v225, v144 quad_perm:[1,1,1,1] row_mask:0xf bank_mask:0xf
  v_add_f32_dpp v145, v227, v145 quad_perm:[3,3,3,3] row_mask:0xf bank_mask:0xf
  v_cvt_pk_bf16_f32 v110, 0, v110
  v_cvt_pk_bf16_f32 v111, 0, v111
  v_add_f32 v229, v144, v145
  v_pk_mul_f32 v[108:109], v[108:109], v[196:197]
  v_pk_mul_f32 v[110:111], v[110:111], v[198:199]
  v_cvt_pk_bf16_f32 v218, v108, v109
  v_cvt_pk_bf16_f32 v219, v110, v111
  s_waitcnt vmcnt(14)
  buffer_load_dwordx4 v[52:55], v94, s[8:11], s60 offen offset:1280 nt
  v_mfma_f32_16x16x32_bf16 v[224:227], v[216:219], v[168:171], 0
  v_pk_fma_f32 v[108:109], v[80:81], s[92:93], v[212:213] neg_lo:[0,0,1] neg_hi:[0,0,1]
  v_pk_fma_f32 v[110:111], v[82:83], s[92:93], v[214:215] neg_lo:[0,0,1] neg_hi:[0,0,1]
  v_cvt_pk_bf16_f32 v108, 0, v108
  v_cvt_pk_bf16_f32 v228, 0, v228
  v_cvt_pk_bf16_f32 v109, 0, v109
  v_cvt_pk_bf16_f32 v229, 0, v229
  v_cvt_pk_bf16_f32 v110, 0, v110
  v_pk_mul_f32 v[228:229], v[228:229], s[68:69]
  v_cvt_pk_bf16_f32 v111, 0, v111
  v_cvt_pk_bf16_f32 v120, v228, v229
  v_pk_mul_f32 v[108:109], v[108:109], v[200:201]
  v_pk_mul_f32 v[110:111], v[110:111], v[202:203]
  v_cvt_pk_bf16_f32 v220, v108, v109
  v_cvt_pk_bf16_f32 v221, v110, v111
  s_waitcnt vmcnt(14)
  s_cbranch_vccnz L_kw1_9
  s_waitcnt vmcnt(9)
L_kw1_9:
  buffer_load_dwordx4 v[56:59], v94, s[8:11], s60 offen offset:1536 nt
  v_mfma_f32_16x16x16_bf16 v[224:227], v[220:221], v[172:173], v[224:227]
  v_pk_fma_f32 v[108:109], v[84:85], s[92:93], v[204:205] neg_lo:[0,0,1] neg_hi:[0,0,1]
  v_pk_fma_f32 v[110:111], v[86:87], s[92:93], v[206:207] neg_lo:[0,0,1] neg_hi:[0,0,1]
  v_cvt_pk_bf16_f32 v108, 0, v108
  v_cvt_pk_bf16_f32 v109, 0, v109
  v_cvt_pk_bf16_f32 v110, 0, v110
  v_cvt_pk_bf16_f32 v111, 0, v111
  v_pk_mul_f32 v[108:109], v[108:109], v[192:193]
  v_pk_mul_f32 v[110:111], v[110:111], v[194:195]
  v_cvt_pk_bf16_f32 v216, v108, v109
  v_cvt_pk_bf16_f32 v217, v110, v111
  s_waitcnt vmcnt(14)
  buffer_load_dwordx4 v[60:63], v94, s[8:11], s60 offen offset:1792 nt
  v_pk_fma_f32 v[108:109], v[88:89], s[92:93], v[208:209] neg_lo:[0,0,1] neg_hi:[0,0,1]
  v_pk_fma_f32 v[110:111], v[90:91], s[92:93], v[210:211] neg_lo:[0,0,1] neg_hi:[0,0,1]
  v_mov_b32_dpp v144, v224 quad_perm:[0,0,0,0] row_mask:0xf bank_mask:0xf
  v_mov_b32_dpp v145, v226 quad_perm:[2,2,2,2] row_mask:0xf bank_mask:0xf
  v_cvt_pk_bf16_f32 v108, 0, v108
  v_cvt_pk_bf16_f32 v109, 0, v109
  v_add_f32_dpp v144, v225, v144 quad_perm:[1,1,1,1] row_mask:0xf bank_mask:0xf
  v_add_f32_dpp v145, v227, v145 quad_perm:[3,3,3,3] row_mask:0xf bank_mask:0xf
  v_cvt_pk_bf16_f32 v110, 0, v110
  v_cvt_pk_bf16_f32 v111, 0, v111
  v_add_f32 v228, v144, v145
  v_pk_mul_f32 v[108:109], v[108:109], v[196:197]
  v_pk_mul_f32 v[110:111], v[110:111], v[198:199]
  v_cvt_pk_bf16_f32 v218, v108, v109
  v_cvt_pk_bf16_f32 v219, v110, v111
  s_waitcnt vmcnt(14)
  buffer_load_dwordx4 v[64:67], v94, s[8:11], s60 offen offset:2048 nt
  v_mfma_f32_16x16x32_bf16 v[224:227], v[216:219], v[168:171], 0
  v_pk_fma_f32 v[108:109], v[4:5], s[92:93], v[212:213] neg_lo:[0,0,1] neg_hi:[0,0,1]
  v_pk_fma_f32 v[110:111], v[6:7], s[92:93], v[214:215] neg_lo:[0,0,1] neg_hi:[0,0,1]
  v_cvt_pk_bf16_f32 v108, 0, v108
  v_cvt_pk_bf16_f32 v109, 0, v109
  v_cvt_pk_bf16_f32 v110, 0, v110
  v_cvt_pk_bf16_f32 v111, 0, v111
  v_pk_mul_f32 v[108:109], v[108:109], v[200:201]
  v_pk_mul_f32 v[110:111], v[110:111], v[202:203]
  v_cvt_pk_bf16_f32 v220, v108, v109
  v_cvt_pk_bf16_f32 v221, v110, v111
  s_waitcnt vmcnt(14)
  s_cbranch_vccnz L_kw1_12
  s_waitcnt vmcnt(9)
L_kw1_12:
  buffer_load_dwordx4 v[68:71], v94, s[8:11], s60 offen offset:2304 nt
  v_mfma_f32_16x16x16_bf16 v[224:227], v[220:221], v[172:173], v[224:227]
  v_pk_fma_f32 v[108:109], v[8:9], s[92:93], v[204:205] neg_lo:[0,0,1] neg_hi:[0,0,1]
  v_pk_fma_f32 v[110:111], v[10:11], s[92:93], v[206:207] neg_lo:[0,0,1] neg_hi:[0,0,1]
  v_cvt_pk_bf16_f32 v108, 0, v108
  v_cvt_pk_bf16_f32 v109, 0, v109
  v_cvt_pk_bf16_f32 v110, 0, v110
  v_cvt_pk_bf16_f32 v111, 0, v111
  v_pk_mul_f32 v[108:109], v[108:109], v[192:193]
  v_pk_mul_f32 v[110:111], v[110:111], v[194:195]
  v_cvt_pk_bf16_f32 v216, v108, v109
  v_cvt_pk_bf16_f32 v217, v110, v111
  s_waitcnt vmcnt(14)
  buffer_load_dwordx4 v[72:75], v94, s[8:11], s60 offen offset:2560 nt
  v_pk_fma_f32 v[108:109], v[12:13], s[92:93], v[208:209] neg_lo:[0,0,1] neg_hi:[0,0,1]
  v_pk_fma_f32 v[110:111], v[14:15], s[92:93], v[210:211] neg_lo:[0,0,1] neg_hi:[0,0,1]
  v_mov_b32_dpp v144, v224 quad_perm:[0,0,0,0] row_mask:0xf bank_mask:0xf
  v_mov_b32_dpp v145, v226 quad_perm:[2,2,2,2] row_mask:0xf bank_mask:0xf
  v_cvt_pk_bf16_f32 v108, 0, v108
  v_cvt_pk_bf16_f32 v109, 0, v109
  v_add_f32_dpp v144, v225, v144 quad_perm:[1,1,1,1] row_mask:0xf bank_mask:0xf
  v_add_f32_dpp v145, v227, v145 quad_perm:[3,3,3,3] row_mask:0xf bank_mask:0xf
  v_cvt_pk_bf16_f32 v110, 0, v110
  v_cvt_pk_bf16_f32 v111, 0, v111
  v_add_f32 v229, v144, v145
  v_pk_mul_f32 v[108:109], v[108:109], v[196:197]
  v_pk_mul_f32 v[110:111], v[110:111], v[198:199]
  v_cvt_pk_bf16_f32 v218, v108, v109
  v_cvt_pk_bf16_f32 v219, v110, v111
  s_waitcnt vmcnt(14)
  buffer_load_dwordx4 v[76:79], v94, s[8:11], s60 offen offset:2816 nt
  v_mfma_f32_16x16x32_bf16 v[224:227], v[216:219], v[168:171], 0
  v_pk_fma_f32 v[108:109], v[16:17], s[92:93], v[212:213] neg_lo:[0,0,1] neg_hi:[0,0,1]
  v_pk_fma_f32 v[110:111], v[18:19], s[92:93], v[214:215] neg_lo:[0,0,1] neg_hi:[0,0,1]
  v_cvt_pk_bf16_f32 v108, 0, v108
  v_cvt_pk_bf16_f32 v228, 0, v228
  v_cvt_pk_bf16_f32 v109, 0, v109
  v_cvt_pk_bf16_f32 v229, 0, v229
  v_cvt_pk_bf16_f32 v110, 0, v110
  v_pk_mul_f32 v[228:229], v[228:229], s[68:69]
  v_cvt_pk_bf16_f32 v111, 0, v111
  v_cvt_pk_bf16_f32 v121, v228, v229
  v_pk_mul_f32 v[108:109], v[108:109], v[200:201]
  v_pk_mul_f32 v[110:111], v[110:111], v[202:203]
  v_cvt_pk_bf16_f32 v220, v108, v109
  v_cvt_pk_bf16_f32 v221, v110, v111
  s_waitcnt vmcnt(14)
  s_cbranch_vccnz L_kw1_15
  s_waitcnt vmcnt(9)
L_kw1_15:
  buffer_load_dwordx4 v[80:83], v95, s[8:11], s60 offen offset:0 nt
  v_mfma_f32_16x16x16_bf16 v[224:227], v[220:221], v[172:173], v[224:227]
  v_pk_fma_f32 v[108:109], v[20:21], s[92:93], v[204:205] neg_lo:[0,0,1] neg_hi:[0,0,1]
  v_pk_fma_f32 v[110:111], v[22:23], s[92:93], v[206:207] neg_lo:[0,0,1] neg_hi:[0,0,1]
  v_cvt_pk_bf16_f32 v108, 0, v108
  v_cvt_pk_bf16_f32 v109, 0, v109
  v_cvt_pk_bf16_f32 v110, 0, v110
  v_cvt_pk_bf16_f32 v111, 0, v111
  v_pk_mul_f32 v[108:109], v[108:109], v[192:193]
  v_pk_mul_f32 v[110:111], v[110:111], v[194:195]
  v_cvt_pk_bf16_f32 v216, v108, v109
  v_cvt_pk_bf16_f32 v217, v110, v111
  s_waitcnt vmcnt(14)
  buffer_load_dwordx4 v[84:87], v95, s[8:11], s60 offen offset:256 nt
  v_pk_fma_f32 v[108:109], v[24:25], s[92:93], v[208:209] neg_lo:[0,0,1] neg_hi:[0,0,1]
  v_pk_fma_f32 v[110:111], v[26:27], s[92:93], v[210:211] neg_lo:[0,0,1] neg_hi:[0,0,1]
  v_mov_b32_dpp v144, v224 quad_perm:[0,0,0,0] row_mask:0xf bank_mask:0xf
  v_mov_b32_dpp v145, v226 quad_perm:[2,2,2,2] row_mask:0xf bank_mask:0xf
  v_cvt_pk_bf16_f32 v108, 0, v108
  v_cvt_pk_bf16_f32 v109, 0, v109
  v_add_f32_dpp v144, v225, v144 quad_perm:[1,1,1,1] row_mask:0xf bank_mask:0xf
  v_add_f32_dpp v145, v227, v145 quad_perm:[3,3,3,3] row_mask:0xf bank_mask:0xf
  v_cvt_pk_bf16_f32 v110, 0, v110
  v_cvt_pk_bf16_f32 v111, 0, v111
  v_add_f32 v228, v144, v145
  v_pk_mul_f32 v[108:109], v[108:109], v[196:197]
  v_pk_mul_f32 v[110:111], v[110:111], v[198:199]
  v_cvt_pk_bf16_f32 v218, v108, v109
  v_cvt_pk_bf16_f32 v219, v110, v111
  s_waitcnt vmcnt(14)
  buffer_load_dwordx4 v[88:91], v95, s[8:11], s60 offen offset:512 nt
  v_mfma_f32_16x16x32_bf16 v[224:227], v[216:219], v[168:171], 0
  v_pk_fma_f32 v[108:109], v[28:29], s[92:93], v[212:213] neg_lo:[0,0,1] neg_hi:[0,0,1]
  v_pk_fma_f32 v[110:111], v[30:31], s[92:93], v[214:215] neg_lo:[0,0,1] neg_hi:[0,0,1]
  s_cmp_lt_u32 s64, s99
  s_cbranch_scc1 L_k_known1
L_k_spin1:
  v_mov_b32 v144, 61696
  ds_read_b32 v144, v144
  s_waitcnt lgkmcnt(0)
  v_readfirstlane_b32 s96, v144
  s_nop 1
  s_cmp_eq_u32 s96, 0
  s_cbranch_scc1 L_k_spin1
  s_mov_b32 s99, -1
L_k_known1:
  s_lshr_b32 s71, s64, 4
  s_andn2_b32 s71, s71, 1
  s_lshr_b32 s71, 0x12, s71
  s_and_b32 s71, s71, 3
  s_lshr_b32 s85, s96, s71
  s_andn2_b32 s70, s64, 1
  s_or_b32 s70, s70, s4
  s_cmp_lt_u32 s64, 8
  s_cselect_b32 s70, s70, s64
  s_cselect_b32 s85, s64, s85
  s_and_b32 s85, s85, 1
  s_and_b32 s70, s70, 31
  s_lshl_b32 s71, s71, 12
  s_add_u32 s70, s70, s5
  s_add_u32 s70, s70, s71
  s_mul_hi_u32 s84, s70, s90
  s_lshr_b32 s84, s84, 1
  s_mul_i32 s71, s84, 3
  s_sub_u32 s70, s70, s71
  s_lshl3_add_u32 s85, s70, s85
  s_mul_i32 s61, s84, 196608
  s_lshr_b32 s89, s84, 4
  s_lshl_b32 s70, s85, 5
  v_add_u32 v97, s70, v230
  v_mul_u32_u24 v97, 21846, v97
  v_lshrrev_b32 v97, 16, v97
  v_add_u32 v144, s85, v231
  v_lshrrev_b32 v145, v144, s91
  v_and_b32 v145, 1, v145
  v_cmp_eq_u32 s[54:55], 1, v145
  s_nop 1
  s_and_b64 s[52:53], s[54:55], s[56:57]
  s_andn2_b64 s[54:55], s[54:55], s[56:57]
  v_mul_u32_u24 v144, 43, v144
  v_lshrrev_b32 v144, 8, v144
  v_mul_u32_u24 v144, 384, v144
  v_add_u32 v234, v144, v233
  s_cmp_eq_u32 s89, s88
  s_cbranch_scc1 L_k_sameq1
  s_mul_i32 s70, s89, 1536
  buffer_load_dwordx2 v[174:175], v235, s[36:39], s70 offen offset:0
  buffer_load_dwordx2 v[176:177], v235, s[36:39], s70 offen offset:128
  buffer_load_dwordx2 v[178:179], v235, s[36:39], s70 offen offset:256
  s_mov_b32 s88, s89
L_k_sameq1:
  s_mul_i32 s62, s84, 1536
  buffer_load_dwordx2 v[180:181], v234, s[20:23], s62 offen offset:0
  buffer_load_dwordx2 v[186:187], v234, s[24:27], s62 offen offset:0
  buffer_load_dwordx2 v[182:183], v234, s[20:23], s62 offen offset:128
  buffer_load_dwordx2 v[188:189], v234, s[24:27], s62 offen offset:128
  buffer_load_dwordx2 v[184:185], v234, s[20:23], s62 offen offset:256
  buffer_load_dwordx2 v[190:191], v234, s[24:27], s62 offen offset:256
  v_cvt_pk_bf16_f32 v108, 0, v108
  v_cvt_pk_bf16_f32 v109, 0, v109
  v_cvt_pk_bf16_f32 v110, 0, v110
  v_cvt_pk_bf16_f32 v111, 0, v111
  v_pk_mul_f32 v[108:109], v[108:109], v[200:201]
  v_pk_mul_f32 v[110:111], v[110:111], v[202:203]
  v_cvt_pk_bf16_f32 v220, v108, v109
  v_cvt_pk_bf16_f32 v221, v110, v111
  s_cmp_lt_u32 s64, 96
  s_cbranch_scc1 L_k_keep
  s_lshr_b32 s71, s3, 5
  s_lshr_b32 s85, s96, s71
  s_bfe_u32 s85, s85, 0x10003
  s_and_b32 s70, s3, 31
  s_lshl_b32 s71, s71, 12
  s_add_u32 s70, s70, s5
  s_add_u32 s70, s70, s71
  s_mul_hi_u32 s84, s70, s90
  s_lshr_b32 s84, s84, 1
  s_mul_i32 s71, s84, 3
  s_sub_u32 s70, s70, s71
  s_lshl3_add_u32 s85, s70, s85
  s_mul_i32 s61, s84, 196608
  s_lshr_b32 s89, s84, 4
  s_lshl_b32 s70, s85, 5
  v_add_u32 v97, s70, v1
  v_mul_u32_u24 v97, 21846, v97
  v_lshrrev_b32 v97, 16, v97
  v_add_u32 v144, s85, v2
  v_lshrrev_b32 v145, v144, s91
  v_and_b32 v145, 1, v145
  v_cmp_eq_u32 s[54:55], 1, v145
  s_nop 1
  s_and_b64 s[52:53], s[54:55], s[58:59]
  s_andn2_b64 s[54:55], s[54:55], s[58:59]
  s_mov_b32 s16, s12
  s_mov_b32 s17, s13
  s_lshl_b32 s62, s84, 9
  v_lshl_add_u32 v98, v97, 1, v96
  buffer_load_short_d16_hi v112, v98, s[32:35], s62 offen
  buffer_load_short_d16_hi v113, v98, s[28:31], s62 offen
  v_mov_b32 v232, v3
L_k_keep:
  v_mad_u32_u24 v92, v97, s63, v232
  v_add_u32 v93, 768, v92
  v_add_u32 v94, 4608, v92
  v_add_u32 v95, 7680, v92
  v_cndmask_b32 v92, v92, v105, s[52:53]
  v_cndmask_b32 v95, v95, v105, s[54:55]
  s_waitcnt vmcnt(20)
  s_cbranch_vccnz L_kw1_18
  s_waitcnt vmcnt(15)
L_kw1_18:
  buffer_load_dwordx4 v[4:7], v92, s[16:19], s61 offen offset:0 nt
  v_mfma_f32_16x16x16_bf16 v[224:227], v[220:221], v[172:173], v[224:227]
  v_pk_fma_f32 v[108:109], v[32:33], s[92:93], v[204:205] neg_lo:[0,0,1] neg_hi:[0,0,1]
  v_pk_fma_f32 v[110:111], v[34:35], s[92:93], v[206:207] neg_lo:[0,0,1] neg_hi:[0,0,1]
  v_cvt_pk_bf16_f32 v108, 0, v108
  v_cvt_pk_bf16_f32 v109, 0, v109
  v_cvt_pk_bf16_f32 v110, 0, v110
  v_cvt_pk_bf16_f32 v111, 0, v111
  v_pk_mul_f32 v[108:109], v[108:109], v[192:193]
  v_pk_mul_f32 v[110:111], v[110:111], v[194:195]
  v_cvt_pk_bf16_f32 v216, v108, v109
  v_cvt_pk_bf16_f32 v217, v110, v111
  s_waitcnt vmcnt(20)
  buffer_load_dwordx4 v[8:11], v92, s[16:19], s61 offen offset:256 nt
  v_pk_fma_f32 v[108:109], v[36:37], s[92:93], v[208:209] neg_lo:[0,0,1] neg_hi:[0,0,1]
  v_pk_fma_f32 v[110:111], v[38:39], s[92:93], v[210:211] neg_lo:[0,0,1] neg_hi:[0,0,1]
  v_mov_b32_dpp v144, v224 quad_perm:[0,0,0,0] row_mask:0xf bank_mask:0xf
  v_mov_b32_dpp v145, v226 quad_perm:[2,2,2,2] row_mask:0xf bank_mask:0xf
  v_cvt_pk_bf16_f32 v108, 0, v108
  v_cvt_pk_bf16_f32 v109, 0, v109
  v_add_f32_dpp v144, v225, v144 quad_perm:[1,1,1,1] row_mask:0xf bank_mask:0xf
  v_add_f32_dpp v145, v227, v145 quad_perm:[3,3,3,3] row_mask:0xf bank_mask:0xf
  v_cvt_pk_bf16_f32 v110, 0, v110
  v_cvt_pk_bf16_f32 v111, 0, v111
  v_add_f32 v229, v144, v145
  v_pk_mul_f32 v[108:109], v[108:109], v[196:197]
  v_pk_mul_f32 v[110:111], v[110:111], v[198:199]
  v_cvt_pk_bf16_f32 v218, v108, v109
  v_cvt_pk_bf16_f32 v219, v110, v111
  s_waitcnt vmcnt(20)
  buffer_load_dwordx4 v[12:15], v92, s[16:19], s61 offen offset:512 nt
  v_mfma_f32_16x16x32_bf16 v[224:227], v[216:219], v[168:171], 0
  v_pk_fma_f32 v[108:109], v[40:41], s[92:93], v[212:213] neg_lo:[0,0,1] neg_hi:[0,0,1]
  v_pk_fma_f32 v[110:111], v[42:43], s[92:93], v[214:215] neg_lo:[0,0,1] neg_hi:[0,0,1]
  v_cvt_pk_bf16_f32 v108, 0, v108
  v_cvt_pk_bf16_f32 v228, 0, v228
  v_cvt_pk_bf16_f32 v109, 0, v109
  v_cvt_pk_bf16_f32 v229, 0, v229
  v_cvt_pk_bf16_f32 v110, 0, v110
  v_pk_mul_f32 v[228:229], v[228:229], s[68:69]
  v_cvt_pk_bf16_f32 v111, 0, v111
  v_cvt_pk_bf16_f32 v122, v228, v229
  v_pk_mul_f32 v[108:109], v[108:109], v[200:201]
  v_pk_mul_f32 v[110:111], v[110:111], v[202:203]
  v_cvt_pk_bf16_f32 v220, v108, v109
  v_cvt_pk_bf16_f32 v221, v110, v111
  s_waitcnt vmcnt(20)
  s_cbranch_vccnz L_kw1_21
  s_waitcnt vmcnt(15)
L_kw1_21:
  buffer_load_dwordx4 v[16:19], v93, s[16:19], s61 offen offset:0 nt
  v_mfma_f32_16x16x16_bf16 v[224:227], v[220:221], v[172:173], v[224:227]
  v_pk_fma_f32 v[108:109], v[44:45], s[92:93], v[204:205] neg_lo:[0,0,1] neg_hi:[0,0,1]
  v_pk_fma_f32 v[110:111], v[46:47], s[92:93], v[206:207] neg_lo:[0,0,1] neg_hi:[0,0,1]
  v_cvt_pk_bf16_f32 v108, 0, v108
  v_cvt_pk_bf16_f32 v109, 0, v109
  v_cvt_pk_bf16_f32 v110, 0, v110
  v_cvt_pk_bf16_f32 v111, 0, v111
  v_pk_mul_f32 v[108:109], v[108:109], v[192:193]
  v_pk_mul_f32 v[110:111], v[110:111], v[194:195]
  v_cvt_pk_bf16_f32 v216, v108, v109
  v_cvt_pk_bf16_f32 v217, v110, v111
  s_waitcnt vmcnt(20)
  buffer_load_dwordx4 v[20:23], v93, s[16:19], s61 offen offset:256 nt
  v_pk_fma_f32 v[108:109], v[48:49], s[92:93], v[208:209] neg_lo:[0,0,1] neg_hi:[0,0,1]
  v_pk_fma_f32 v[110:111], v[50:51], s[92:93], v[210:211] neg_lo:[0,0,1] neg_hi:[0,0,1]
  v_mov_b32_dpp v144, v224 quad_perm:[0,0,0,0] row_mask:0xf bank_mask:0xf
  v_mov_b32_dpp v145, v226 quad_perm:[2,2,2,2] row_mask:0xf bank_mask:0xf
  v_cvt_pk_bf16_f32 v108, 0, v108
  v_cvt_pk_bf16_f32 v109, 0, v109
  v_add_f32_dpp v144, v225, v144 quad_perm:[1,1,1,1] row_mask:0xf bank_mask:0xf
  v_add_f32_dpp v145, v227, v145 quad_perm:[3,3,3,3] row_mask:0xf bank_mask:0xf
  v_cvt_pk_bf16_f32 v110, 0, v110
  v_cvt_pk_bf16_f32 v111, 0, v111
  v_add_f32 v228, v144, v145
  v_pk_mul_f32 v[108:109], v[108:109], v[196:197]
  v_pk_mul_f32 v[110:111], v[110:111], v[198:199]
  v_cvt_pk_bf16_f32 v218, v108, v109
  v_cvt_pk_bf16_f32 v219, v110, v111
  s_waitcnt vmcnt(20)
  buffer_load_dwordx4 v[24:27], v93, s[16:19], s61 offen offset:512 nt
  v_mfma_f32_16x16x32_bf16 v[224:227], v[216:219], v[168:171], 0
  v_pk_fma_f32 v[108:109], v[52:53], s[92:93], v[212:213] neg_lo:[0,0,1] neg_hi:[0,0,1]
  v_pk_fma_f32 v[110:111], v[54:55], s[92:93], v[214:215] neg_lo:[0,0,1] neg_hi:[0,0,1]
  v_cvt_pk_bf16_f32 v108, 0, v108
  v_cvt_pk_bf16_f32 v109, 0, v109
  v_cvt_pk_bf16_f32 v110, 0, v110
  v_cvt_pk_bf16_f32 v111, 0, v111
  v_pk_mul_f32 v[108:109], v[108:109], v[200:201]
  v_pk_mul_f32 v[110:111], v[110:111], v[202:203]
  v_cvt_pk_bf16_f32 v220, v108, v109
  v_cvt_pk_bf16_f32 v221, v110, v111
  s_waitcnt vmcnt(20)
  s_cbranch_vccnz L_kw1_24
  s_waitcnt vmcnt(15)
L_kw1_24:
  buffer_load_dwordx4 v[28:31], v93, s[16:19], s61 offen offset:768 nt
  v_mfma_f32_16x16x16_bf16 v[224:227], v[220:221], v[172:173], v[224:227]
  v_pk_fma_f32 v[108:109], v[56:57], s[92:93], v[204:205] neg_lo:[0,0,1] neg_hi:[0,0,1]
  v_pk_fma_f32 v[110:111], v[58:59], s[92:93], v[206:207] neg_lo:[0,0,1] neg_hi:[0,0,1]
  v_cvt_pk_bf16_f32 v108, 0, v108
  v_cvt_pk_bf16_f32 v109, 0, v109
  v_cvt_pk_bf16_f32 v110, 0, v110
  v_cvt_pk_bf16_f32 v111, 0, v111
  v_pk_mul_f32 v[108:109], v[108:109], v[192:193]
  v_pk_mul_f32 v[110:111], v[110:111], v[194:195]
  v_cvt_pk_bf16_f32 v216, v108, v109
  v_cvt_pk_bf16_f32 v217, v110, v111
  s_waitcnt vmcnt(20)
  buffer_load_dwordx4 v[32:35], v93, s[16:19], s61 offen offset:1024 nt
  v_pk_fma_f32 v[108:109], v[60:61], s[92:93], v[208:209] neg_lo:[0,0,1] neg_hi:[0,0,1]
  v_pk_fma_f32 v[110:111], v[62:63], s[92:93], v[210:211] neg_lo:[0,0,1] neg_hi:[0,0,1]
  v_mov_b32_dpp v144, v224 quad_perm:[0,0,0,0] row_mask:0xf bank_mask:0xf
  v_mov_b32_dpp v145, v226 quad_perm:[2,2,2,2] row_mask:0xf bank_mask:0xf
  v_cvt_pk_bf16_f32 v108, 0, v108
  v_cvt_pk_bf16_f32 v109, 0, v109
  v_add_f32_dpp v144, v225, v144 quad_perm:[1,1,1,1] row_mask:0xf bank_mask:0xf
  v_add_f32_dpp v145, v227, v145 quad_perm:[3,3,3,3] row_mask:0xf bank_mask:0xf
  v_cvt_pk_bf16_f32 v110, 0, v110
  v_cvt_pk_bf16_f32 v111, 0, v111
  v_add_f32 v229, v144, v145
  v_pk_mul_f32 v[108:109], v[108:109], v[196:197]
  v_pk_mul_f32 v[110:111], v[110:111], v[198:199]
  v_cvt_pk_bf16_f32 v218, v108, v109
  v_cvt_pk_bf16_f32 v219, v110, v111
  s_waitcnt vmcnt(20)
  buffer_load_dwordx4 v[36:39], v93, s[16:19], s61 offen offset:1280 nt
  v_mfma_f32_16x16x32_bf16 v[224:227], v[216:219], v[168:171], 0
  v_pk_fma_f32 v[108:109], v[64:65], s[92:93], v[212:213] neg_lo:[0,0,1] neg_hi:[0,0,1]
  v_pk_fma_f32 v[110:111], v[66:67], s[92:93], v[214:215] neg_lo:[0,0,1] neg_hi:[0,0,1]
  v_cvt_pk_bf16_f32 v108, 0, v108
  v_cvt_pk_bf16_f32 v228, 0, v228
  v_cvt_pk_bf16_f32 v109, 0, v109
  v_cvt_pk_bf16_f32 v229, 0, v229
  v_cvt_pk_bf16_f32 v110, 0, v110
  v_pk_mul_f32 v[228:229], v[228:229], s[68:69]
  v_cvt_pk_bf16_f32 v111, 0, v111
  v_cvt_pk_bf16_f32 v123, v228, v229
  v_pk_mul_f32 v[108:109], v[108:109], v[200:201]
  v_pk_mul_f32 v[110:111], v[110:111], v[202:203]
  v_cvt_pk_bf16_f32 v220, v108, v109
  v_cvt_pk_bf16_f32 v221, v110, v111
  s_waitcnt vmcnt(20)
  s_cbranch_vccnz L_kw1_27
  s_waitcnt vmcnt(15)
L_kw1_27:
  buffer_load_dwordx4 v[40:43], v93, s[16:19], s61 offen offset:1536 nt
  v_mfma_f32_16x16x16_bf16 v[224:227], v[220:221], v[172:173], v[224:227]
  v_pk_fma_f32 v[108:109], v[68:69], s[92:93], v[204:205] neg_lo:[0,0,1] neg_hi:[0,0,1]
  v_pk_fma_f32 v[110:111], v[70:71], s[92:93], v[206:207] neg_lo:[0,0,1] neg_hi:[0,0,1]
  v_cvt_pk_bf16_f32 v108, 0, v108
  v_cvt_pk_bf16_f32 v109, 0, v109
  v_cvt_pk_bf16_f32 v110, 0, v110
  v_cvt_pk_bf16_f32 v111, 0, v111
  v_pk_mul_f32 v[108:109], v[108:109], v[192:193]
  v_pk_mul_f32 v[110:111], v[110:111], v[194:195]
  v_cvt_pk_bf16_f32 v216, v108, v109
  v_cvt_pk_bf16_f32 v217, v110, v111
  s_waitcnt vmcnt(20)
  buffer_load_dwordx4 v[44:47], v93, s[16:19], s61 offen offset:1792 nt
  v_pk_fma_f32 v[108:109], v[72:73], s[92:93], v[208:209] neg_lo:[0,0,1] neg_hi:[0,0,1]
  v_pk_fma_f32 v[110:111], v[74:75], s[92:93], v[210:211] neg_lo:[0,0,1] neg_hi:[0,0,1]
  v_mov_b32_dpp v144, v224 quad_perm:[0,0,0,0] row_mask:0xf bank_mask:0xf
  v_mov_b32_dpp v145, v226 quad_perm:[2,2,2,2] row_mask:0xf bank_mask:0xf
  v_cvt_pk_bf16_f32 v108, 0, v108
  v_cvt_pk_bf16_f32 v109, 0, v109
  v_add_f32_dpp v144, v225, v144 quad_perm:[1,1,1,1] row_mask:0xf bank_mask:0xf
  v_add_f32_dpp v145, v227, v145 quad_perm:[3,3,3,3] row_mask:0xf bank_mask:0xf
  v_cvt_pk_bf16_f32 v110, 0, v110
  v_cvt_pk_bf16_f32 v111, 0, v111
  v_add_f32 v228, v144, v145
  v_pk_mul_f32 v[108:109], v[108:109], v[196:197]
  v_pk_mul_f32 v[110:111], v[110:111], v[198:199]
  v_cvt_pk_bf16_f32 v218, v108, v109
  v_cvt_pk_bf16_f32 v219, v110, v111
  s_waitcnt vmcnt(20)
  buffer_load_dwordx4 v[48:51], v93, s[16:19], s61 offen offset:2048 nt
  v_mfma_f32_16x16x32_bf16 v[224:227], v[216:219], v[168:171], 0
  v_pk_fma_f32 v[108:109], v[76:77], s[92:93], v[212:213] neg_lo:[0,0,1] neg_hi:[0,0,1]
  v_pk_fma_f32 v[110:111], v[78:79], s[92:93], v[214:215] neg_lo:[0,0,1] neg_hi:[0,0,1]
  v_cvt_pk_bf16_f32 v108, 0, v108
  v_cvt_pk_bf16_f32 v109, 0, v109
  v_cvt_pk_bf16_f32 v110, 0, v110
  v_cvt_pk_bf16_f32 v111, 0, v111
  v_pk_mul_f32 v[108:109], v[108:109], v[200:201]
  v_pk_mul_f32 v[110:111], v[110:111], v[202:203]
  v_cvt_pk_bf16_f32 v220, v108, v109
  v_cvt_pk_bf16_f32 v221, v110, v111
  s_waitcnt vmcnt(20)
  s_cbranch_vccnz L_kw1_30
  s_waitcnt vmcnt(9)
L_kw1_30:
  buffer_load_dwordx4 v[52:55], v93, s[16:19], s61 offen offset:2304 nt
  v_mfma_f32_16x16x16_bf16 v[224:227], v[220:221], v[172:173], v[224:227]
  v_pk_fma_f32 v[108:109], v[80:81], s[92:93], v[204:205] neg_lo:[0,0,1] neg_hi:[0,0,1]
  v_pk_fma_f32 v[110:111], v[82:83], s[92:93], v[206:207] neg_lo:[0,0,1] neg_hi:[0,0,1]
  v_cvt_pk_bf16_f32 v108, 0, v108
  v_cvt_pk_bf16_f32 v109, 0, v109
  v_cvt_pk_bf16_f32 v110, 0, v110
  v_cvt_pk_bf16_f32 v111, 0, v111
  v_pk_mul_f32 v[108:109], v[108:109], v[192:193]
  v_pk_mul_f32 v[110:111], v[110:111], v[194:195]
  v_cvt_pk_bf16_f32 v216, v108, v109
  v_cvt_pk_bf16_f32 v217, v110, v111
  s_waitcnt vmcnt(20)
  buffer_load_dwordx4 v[56:59], v93, s[16:19], s61 offen offset:2560 nt
  v_pk_fma_f32 v[108:109], v[84:85], s[92:93], v[208:209] neg_lo:[0,0,1] neg_hi:[0,0,1]
  v_pk_fma_f32 v[110:111], v[86:87], s[92:93], v[210:211] neg_lo:[0,0,1] neg_hi:[0,0,1]
  v_mov_b32_dpp v144, v224 quad_perm:[0,0,0,0] row_mask:0xf bank_mask:0xf
  v_mov_b32_dpp v145, v226 quad_perm:[2,2,2,2] row_mask:0xf bank_mask:0xf
  v_cvt_pk_bf16_f32 v108, 0, v108
  v_cvt_pk_bf16_f32 v109, 0, v109
  v_add_f32_dpp v144, v225, v144 quad_perm:[1,1,1,1] row_mask:0xf bank_mask:0xf
  v_add_f32_dpp v145, v227, v145 quad_perm:[3,3,3,3] row_mask:0xf bank_mask:0xf
  v_cvt_pk_bf16_f32 v110, 0, v110
  v_cvt_pk_bf16_f32 v111, 0, v111
  v_add_f32 v229, v144, v145
  v_pk_mul_f32 v[108:109], v[108:109], v[196:197]
  v_pk_mul_f32 v[110:111], v[110:111], v[198:199]
  v_cvt_pk_bf16_f32 v218, v108, v109
  v_cvt_pk_bf16_f32 v219, v110, v111
  s_waitcnt vmcnt(20)
  buffer_load_dwordx4 v[60:63], v93, s[16:19], s61 offen offset:2816 nt
  v_mfma_f32_16x16x32_bf16 v[224:227], v[216:219], v[168:171], 0
  v_pk_fma_f32 v[108:109], v[88:89], s[92:93], v[212:213] neg_lo:[0,0,1] neg_hi:[0,0,1]
  v_pk_fma_f32 v[110:111], v[90:91], s[92:93], v[214:215] neg_lo:[0,0,1] neg_hi:[0,0,1]
  v_cvt_pk_bf16_f32 v108, 0, v108
  v_cvt_pk_bf16_f32 v228, 0, v228
  v_cvt_pk_bf16_f32 v109, 0, v109
  v_cvt_pk_bf16_f32 v229, 0, v229
  v_cvt_pk_bf16_f32 v110, 0, v110
  v_pk_mul_f32 v[228:229], v[228:229], s[68:69]
  v_cvt_pk_bf16_f32 v111, 0, v111
  v_cvt_pk_bf16_f32 v124, v228, v229
  v_pk_mul_f32 v[108:109], v[108:109], v[200:201]
  v_pk_mul_f32 v[110:111], v[110:111], v[202:203]
  v_cvt_pk_bf16_f32 v220, v108, v109
  v_cvt_pk_bf16_f32 v221, v110, v111
  s_mov_b32 s60, s61
  v_mov_b32 v146, s64
  v_mfma_f32_16x16x16_bf16 v[224:227], v[220:221], v[172:173], v[224:227]
  ds_write_b128 v99, v[120:123]
  v_add_u32 v99, 768, v99
  s_nop 5
  v_mov_b32_dpp v144, v224 quad_perm:[0,0,0,0] row_mask:0xf bank_mask:0xf
  v_mov_b32_dpp v145, v226 quad_perm:[2,2,2,2] row_mask:0xf bank_mask:0xf
  s_nop 0
  v_add_f32_dpp v144, v225, v144 quad_perm:[1,1,1,1] row_mask:0xf bank_mask:0xf
  v_add_f32_dpp v145, v227, v145 quad_perm:[3,3,3,3] row_mask:0xf bank_mask:0xf
  v_add_f32 v228, v144, v145
  v_cndmask_b32 v228, v228, v236, s[50:51]
  v_cvt_pk_bf16_f32 v228, 0, v228
  v_cvt_pk_bf16_f32 v229, 0, v229
  v_pk_mul_f32 v[228:229], v[228:229], s[68:69]
  v_cvt_pk_bf16_f32 v125, v228, v229
  ds_write_b64 v100, v[124:125] offset:256
  ds_write_b32 v104, v146
  v_add_u32 v100, 768, v100
  s_cmp_lt_u32 s64, 96
  s_cbranch_scc1 L_k
  v_subrev_u32 v99, 24576, v99
  v_subrev_u32 v100, 24576, v100
  s_mov_b32 s64, s3
  s_mov_b32 s88, s89
  s_mov_b32 s99, 0
  s_mov_b32 s36, s46
  s_and_b32 s37, s47, 0xffff
  s_cmp_lt_u32 s64, s99
  s_cbranch_scc1 L_v0_ok
L_v0_spin:
  v_mov_b32 v144, 61700
  ds_read_b32 v144, v144
  s_waitcnt lgkmcnt(0)
  v_readfirstlane_b32 s99, v144
  s_nop 1
  s_cmp_lt_u32 s64, s99
  s_cbranch_scc0 L_v0_spin
L_v0_ok:
  ds_read_b128 v[120:123], v99
  ds_read_b64 v[124:125], v100 offset:256
  v_mov_b32 v128, 0
  v_mov_b32 v129, 0
  v_mov_b32 v130, 0
  v_mov_b32 v131, 0
  v_mov_b32 v132, 0
  v_mov_b32 v133, 0
  v_mov_b32 v134, 0
  v_mov_b32 v135, 0
  v_mov_b32 v136, 0
  v_mov_b32 v137, 0
  v_mov_b32 v138, 0
  v_mov_b32 v139, 0
  v_mov_b32 v140, 0xff800000
  v_mov_b32 v142, 0x7f800000
  v_mov_b32 v143, 0
L_v0:
  s_add_u32 s97, s64, 96
  v_mov_b32 v146, s97
  s_mov_b32 s86, s84
  s_mov_b32 s87, s85
  ds_write_b32 v104, v146
  s_add_u32 s64, s64, 2
  s_cmp_lt_u32 s64, s99
  s_cbranch_scc1 L_v10_ok
L_v10_spin:
  v_mov_b32 v144, 61700
  ds_read_b32 v144, v144
  s_waitcnt lgkmcnt(0)
  v_readfirstlane_b32 s99, v144
  s_nop 1
  s_cmp_lt_u32 s64, s99
  s_cbranch_scc0 L_v10_spin
L_v10_ok:
  s_lshr_b32 s71, s64, 5
  s_lshr_b32 s85, s96, s71
  s_bfe_u32 s85, s85, 0x10003
  s_and_b32 s70, s64, 31
  s_lshl_b32 s71, s71, 12
  s_add_u32 s70, s70, s5
  s_add_u32 s70, s70, s71
  s_mul_hi_u32 s84, s70, s90
  s_lshr_b32 s84, s84, 1
  s_mul_i32 s71, s84, 3
  s_sub_u32 s70, s70, s71
  s_lshl3_add_u32 s85, s70, s85
  s_mul_i32 s61, s84, 196608
  s_lshr_b32 s89, s84, 4
  s_lshl_b32 s70, s85, 5
  v_add_u32 v97, s70, v1
  v_mul_u32_u24 v97, 21846, v97
  v_lshrrev_b32 v97, 16, v97
  v_add_u32 v144, s85, v2
  v_lshrrev_b32 v145, v144, s91
  v_and_b32 v145, 1, v145
  v_cmp_eq_u32 s[54:55], 1, v145
  s_nop 1
  s_and_b64 s[52:53], s[54:55], s[58:59]
  s_andn2_b64 s[54:55], s[54:55], s[58:59]
  s_cmp_lt_u32 s64, 96
  s_cselect_b32 s61, s61, 805306368
  ds_read_b32 v106, v104 offset:8
  s_waitcnt vmcnt(14)
  s_cbranch_vccnz L_vw0_0
  s_waitcnt vmcnt(9)
L_vw0_0:
  buffer_load_dwordx4 v[64:67], v93, s[12:15], s60 offen offset:3072 nt
  v_mul_f32 v114, s94, v112
  v_mul_f32 v115, 0x4a800000, v113
  s_nop 0
  v_mov_b32_dpp v116, v114 row_newbcast:0 row_mask:0xf bank_mask:0xf
  v_mov_b32_dpp v117, v115 row_newbcast:0 row_mask:0xf bank_mask:0xf
  v_pk_fma_f32 v[192:193], v[4:5], s[92:93], v[116:117] op_sel_hi:[1,1,0] neg_lo:[0,0,1] neg_hi:[0,0,1]
  v_pk_fma_f32 v[194:195], v[6:7], s[92:93], v[116:117] op_sel_hi:[1,1,0] neg_lo:[0,0,1] neg_hi:[0,0,1]
  v_cvt_pk_bf16_f32 v192, 0, v192
  v_cvt_pk_bf16_f32 v193, 0, v193
  v_cvt_pk_bf16_f32 v194, 0, v194
  v_cvt_pk_bf16_f32 v195, 0, v195
  v_pk_mul_f32 v[192:193], v[192:193], v[116:117] op_sel:[0,1]
  v_pk_mul_f32 v[194:195], v[194:195], v[116:117] op_sel:[0,1]
  s_waitcnt lgkmcnt(0)
  v_cmp_lt_u32 vcc, s97, v106
  s_waitcnt vmcnt(14)
  buffer_load_dwordx4 v[68:71], v93, s[12:15], s60 offen offset:3328 nt
  v_pk_fma_f32 v[196:197], v[8:9], s[92:93], v[116:117] op_sel_hi:[1,1,0] neg_lo:[0,0,1] neg_hi:[0,0,1]
  v_pk_fma_f32 v[198:199], v[10:11], s[92:93], v[116:117] op_sel_hi:[1,1,0] neg_lo:[0,0,1] neg_hi:[0,0,1]
  v_cvt_pk_bf16_f32 v196, 0, v196
  v_lshlrev_b32 v148, 16, v120
  v_cvt_pk_bf16_f32 v197, 0, v197
  v_and_b32 v149, s65, v120
  v_cvt_pk_bf16_f32 v198, 0, v198
  v_lshlrev_b32 v150, 16, v121
  v_cvt_pk_bf16_f32 v199, 0, v199
  v_and_b32 v151, s65, v121
  v_pk_mul_f32 v[196:197], v[196:197], v[116:117] op_sel:[0,1]
  v_lshlrev_b32 v152, 16, v122
  v_pk_mul_f32 v[198:199], v[198:199], v[116:117] op_sel:[0,1]
  s_waitcnt vmcnt(14)
  buffer_load_dwordx4 v[72:75], v93, s[12:15], s60 offen offset:3584 nt
  v_pk_fma_f32 v[200:201], v[12:13], s[92:93], v[116:117] op_sel_hi:[1,1,0] neg_lo:[0,0,1] neg_hi:[0,0,1]
  v_pk_fma_f32 v[202:203], v[14:15], s[92:93], v[116:117] op_sel_hi:[1,1,0] neg_lo:[0,0,1] neg_hi:[0,0,1]
  v_cvt_pk_bf16_f32 v200, 0, v200
  v_and_b32 v153, s65, v122
  v_cvt_pk_bf16_f32 v201, 0, v201
  v_lshlrev_b32 v154, 16, v123
  v_cvt_pk_bf16_f32 v202, 0, v202
  v_and_b32 v155, s65, v123
  v_cvt_pk_bf16_f32 v203, 0, v203
  v_lshlrev_b32 v156, 16, v124
  v_pk_mul_f32 v[200:201], v[200:201], v[116:117] op_sel:[0,1]
  v_and_b32 v157, s65, v124
  v_pk_mul_f32 v[202:203], v[202:203], v[116:117] op_sel:[0,1]
  s_waitcnt vmcnt(14)
  s_cbranch_vccnz L_vw0_3
  s_waitcnt vmcnt(9)
L_vw0_3:
  buffer_load_dwordx4 v[76:79], v94, s[12:15], s60 offen offset:0 nt
  v_mov_b32_dpp v116, v114 row_newbcast:1 row_mask:0xf bank_mask:0xf
  v_mov_b32_dpp v117, v115 row_newbcast:1 row_mask:0xf bank_mask:0xf
  v_pk_fma_f32 v[108:109], v[16:17], s[92:93], v[116:117] op_sel_hi:[1,1,0] neg_lo:[0,0,1] neg_hi:[0,0,1]
  v_pk_fma_f32 v[110:111], v[18:19], s[92:93], v[116:117] op_sel_hi:[1,1,0] neg_lo:[0,0,1] neg_hi:[0,0,1]
  s_lshl_b32 s62, s84, 9
  v_lshl_add_u32 v98, v97, 1, v96
  buffer_load_short_d16_hi v112, v98, s[32:35], s62 offen
  buffer_load_short_d16_hi v113, v98, s[28:31], s62 offen
  v_cvt_pk_bf16_f32 v108, 0, v108
  v_lshlrev_b32 v158, 16, v125
  v_cvt_pk_bf16_f32 v109, 0, v109
  v_add_u32 v99, 768, v99
  v_cvt_pk_bf16_f32 v110, 0, v110
  v_add_u32 v100, 768, v100
  v_cvt_pk_bf16_f32 v111, 0, v111
  v_max3_f32 v144, v148, v149, v150
  v_pk_mul_f32 v[108:109], v[108:109], v[116:117] op_sel:[0,1]
  ds_read_b128 v[120:123], v99
  v_pk_mul_f32 v[110:111], v[110:111], v[116:117] op_sel:[0,1]
  v_cvt_pk_bf16_f32 v204, v192, v108
  v_cvt_pk_bf16_f32 v208, v193, v109
  v_cvt_pk_bf16_f32 v212, v194, v110
  v_cvt_pk_bf16_f32 v216, v195, v111
  s_waitcnt vmcnt(16)
  buffer_load_dwordx4 v[80:83], v94, s[12:15], s60 offen offset:256 nt
  v_pk_fma_f32 v[108:109], v[20:21], s[92:93], v[116:117] op_sel_hi:[1,1,0] neg_lo:[0,0,1] neg_hi:[0,0,1]
  v_pk_fma_f32 v[110:111], v[22:23], s[92:93], v[116:117] op_sel_hi:[1,1,0] neg_lo:[0,0,1] neg_hi:[0,0,1]
  v_cvt_pk_bf16_f32 v108, 0, v108
  ds_read_b64 v[124:125], v100 offset:256
  v_cvt_pk_bf16_f32 v109, 0, v109
  v_max3_f32 v145, v151, v152, v153
  v_cvt_pk_bf16_f32 v110, 0, v110
  v_max3_f32 v144, v144, v154, v155
  v_cvt_pk_bf16_f32 v111, 0, v111
  v_max3_f32 v145, v145, v156, v157
  v_pk_mul_f32 v[108:109], v[108:109], v[116:117] op_sel:[0,1]
  v_max3_f32 v144, v144, v158, v140
  v_pk_mul_f32 v[110:111], v[110:111], v[116:117] op_sel:[0,1]
  v_cvt_pk_bf16_f32 v220, v196, v108
  v_cvt_pk_bf16_f32 v224, v197, v109
  v_cvt_pk_bf16_f32 v228, v198, v110
  v_cvt_pk_bf16_f32 v232, v199, v111
  s_waitcnt vmcnt(16)
  buffer_load_dwordx4 v[84:87], v94, s[12:15], s60 offen offset:512 nt
  v_pk_fma_f32 v[108:109], v[24:25], s[92:93], v[116:117] op_sel_hi:[1,1,0] neg_lo:[0,0,1] neg_hi:[0,0,1]
  v_pk_fma_f32 v[110:111], v[26:27], s[92:93], v[116:117] op_sel_hi:[1,1,0] neg_lo:[0,0,1] neg_hi:[0,0,1]
  v_cvt_pk_bf16_f32 v108, 0, v108
  v_max_f32 v144, v144, v145
  v_cvt_pk_bf16_f32 v109, 0, v109
  v_mov_b32 v145, v144
  v_cvt_pk_bf16_f32 v110, 0, v110
  s_nop 0
  v_permlane32_swap_b32 v144, v145
  v_cvt_pk_bf16_f32 v111, 0, v111
  v_max_f32 v144, v144, v145
  v_pk_mul_f32 v[108:109], v[108:109], v[116:117] op_sel:[0,1]
  v_mov_b32 v145, v144
  v_pk_mul_f32 v[110:111], v[110:111], v[116:117] op_sel:[0,1]
  v_cvt_pk_bf16_f32 v236, v200, v108
  v_cvt_pk_bf16_f32 v240, v201, v109
  v_cvt_pk_bf16_f32 v244, v202, v110
  v_cvt_pk_bf16_f32 v248, v203, v111
  s_waitcnt vmcnt(16)
  s_cbranch_vccnz L_vw0_6
  s_waitcnt vmcnt(11)
L_vw0_6:
  buffer_load_dwordx4 v[88:91], v94, s[12:15], s60 offen offset:768 nt
  v_mov_b32_dpp v116, v114 row_newbcast:2 row_mask:0xf bank_mask:0xf
  v_mov_b32_dpp v117, v115 row_newbcast:2 row_mask:0xf bank_mask:0xf
  v_pk_fma_f32 v[192:193], v[28:29], s[92:93], v[116:117] op_sel_hi:[1,1,0] neg_lo:[0,0,1] neg_hi:[0,0,1]
  v_pk_fma_f32 v[194:195], v[30:31], s[92:93], v[116:117] op_sel_hi:[1,1,0] neg_lo:[0,0,1] neg_hi:[0,0,1]
  v_cvt_pk_bf16_f32 v192, 0, v192
  v_permlane16_swap_b32 v144, v145
  v_cvt_pk_bf16_f32 v193, 0, v193
  v_max_f32 v140, v144, v145
  v_cvt_pk_bf16_f32 v194, 0, v194
  v_mul_f32 v144, s66, v140
  v_cvt_pk_bf16_f32 v195, 0, v195
  v_add_f32 v146, v144, v142
  v_pk_mul_f32 v[192:193], v[192:193], v[116:117] op_sel:[0,1]
  v_sub_f32 v142, 0, v144
  v_pk_mul_f32 v[194:195], v[194:195], v[116:117] op_sel:[0,1]
  s_waitcnt vmcnt(16)
  buffer_load_dwordx4 v[4:7], v94, s[12:15], s60 offen offset:1024 nt
  v_pk_fma_f32 v[196:197], v[32:33], s[92:93], v[116:117] op_sel_hi:[1,1,0] neg_lo:[0,0,1] neg_hi:[0,0,1]
  v_pk_fma_f32 v[198:199], v[34:35], s[92:93], v[116:117] op_sel_hi:[1,1,0] neg_lo:[0,0,1] neg_hi:[0,0,1]
  v_cvt_pk_bf16_f32 v196, 0, v196
  v_exp_f32 v146, -v146
  v_cvt_pk_bf16_f32 v197, 0, v197
  ds_bpermute_b32 v147, v101, v146
  v_cvt_pk_bf16_f32 v198, 0, v198
  v_fma_f32 v148, v148, s66, v142
  v_cvt_pk_bf16_f32 v199, 0, v199
  v_exp_f32 v148, v148
  v_pk_mul_f32 v[196:197], v[196:197], v[116:117] op_sel:[0,1]
  v_fma_f32 v149, v149, s66, v142
  v_pk_mul_f32 v[198:199], v[198:199], v[116:117] op_sel:[0,1]
  s_waitcnt vmcnt(16)
  buffer_load_dwordx4 v[8:11], v94, s[12:15], s60 offen offset:1280 nt
  v_pk_fma_f32 v[200:201], v[36:37], s[92:93], v[116:117] op_sel_hi:[1,1,0] neg_lo:[0,0,1] neg_hi:[0,0,1]
  v_pk_fma_f32 v[202:203], v[38:39], s[92:93], v[116:117] op_sel_hi:[1,1,0] neg_lo:[0,0,1] neg_hi:[0,0,1]
  v_cvt_pk_bf16_f32 v200, 0, v200
  v_exp_f32 v149, v149
  v_cvt_pk_bf16_f32 v201, 0, v201
  v_fma_f32 v150, v150, s66, v142
  v_cvt_pk_bf16_f32 v202, 0, v202
  v_exp_f32 v150, v150
  v_cvt_pk_bf16_f32 v203, 0, v203
  v_fma_f32 v151, v151, s66, v142
  v_pk_mul_f32 v[200:201], v[200:201], v[116:117] op_sel:[0,1]
  v_exp_f32 v151, v151
  v_pk_mul_f32 v[202:203], v[202:203], v[116:117] op_sel:[0,1]
  s_waitcnt vmcnt(16)
  s_cbranch_vccnz L_vw0_9
  s_waitcnt vmcnt(11)
L_vw0_9:
  buffer_load_dwordx4 v[12:15], v94, s[12:15], s60 offen offset:1536 nt
  v_mov_b32_dpp v116, v114 row_newbcast:3 row_mask:0xf bank_mask:0xf
  v_mov_b32_dpp v117, v115 row_newbcast:3 row_mask:0xf bank_mask:0xf
  v_pk_fma_f32 v[108:109], v[40:41], s[92:93], v[116:117] op_sel_hi:[1,1,0] neg_lo:[0,0,1] neg_hi:[0,0,1]
  v_pk_fma_f32 v[110:111], v[42:43], s[92:93], v[116:117] op_sel_hi:[1,1,0] neg_lo:[0,0,1] neg_hi:[0,0,1]
  v_cvt_pk_bf16_f32 v108, 0, v108
  v_fma_f32 v152, v152, s66, v142
  v_cvt_pk_bf16_f32 v109, 0, v109
  v_exp_f32 v152, v152
  v_cvt_pk_bf16_f32 v110, 0, v110
  v_fma_f32 v153, v153, s66, v142
  v_cvt_pk_bf16_f32 v111, 0, v111
  v_exp_f32 v153, v153
  v_pk_mul_f32 v[108:109], v[108:109], v[116:117] op_sel:[0,1]
  v_fma_f32 v154, v154, s66, v142
  v_pk_mul_f32 v[110:111], v[110:111], v[116:117] op_sel:[0,1]
  v_cvt_pk_bf16_f32 v205, v192, v108
  v_cvt_pk_bf16_f32 v209, v193, v109
  v_cvt_pk_bf16_f32 v213, v194, v110
  v_cvt_pk_bf16_f32 v217, v195, v111
  s_waitcnt vmcnt(16)
  buffer_load_dwordx4 v[16:19], v94, s[12:15], s60 offen offset:1792 nt
  v_pk_fma_f32 v[108:109], v[44:45], s[92:93], v[116:117] op_sel_hi:[1,1,0] neg_lo:[0,0,1] neg_hi:[0,0,1]
  v_pk_fma_f32 v[110:111], v[46:47], s[92:93], v[116:117] op_sel_hi:[1,1,0] neg_lo:[0,0,1] neg_hi:[0,0,1]
  v_cvt_pk_bf16_f32 v108, 0, v108
  v_exp_f32 v154, v154
  v_cvt_pk_bf16_f32 v109, 0, v109
  v_fma_f32 v155, v155, s66, v142
  v_cvt_pk_bf16_f32 v110, 0, v110
  v_exp_f32 v155, v155
  v_cvt_pk_bf16_f32 v111, 0, v111
  v_fma_f32 v156, v156, s66, v142
  v_pk_mul_f32 v[108:109], v[108:109], v[116:117] op_sel:[0,1]
  v_exp_f32 v156, v156
  v_pk_mul_f32 v[110:111], v[110:111], v[116:117] op_sel:[0,1]
  v_cvt_pk_bf16_f32 v221, v196, v108
  v_cvt_pk_bf16_f32 v225, v197, v109
  v_cvt_pk_bf16_f32 v229, v198, v110
  v_cvt_pk_bf16_f32 v233, v199, v111
  s_waitcnt vmcnt(16)
  buffer_load_dwordx4 v[20:23], v94, s[12:15], s60 offen offset:2048 nt
  v_pk_fma_f32 v[108:109], v[48:49], s[92:93], v[116:117] op_sel_hi:[1,1,0] neg_lo:[0,0,1] neg_hi:[0,0,1]
  v_pk_fma_f32 v[110:111], v[50:51], s[92:93], v[116:117] op_sel_hi:[1,1,0] neg_lo:[0,0,1] neg_hi:[0,0,1]
  v_cvt_pk_bf16_f32 v108, 0, v108
  v_fma_f32 v157, v157, s66, v142
  v_cvt_pk_bf16_f32 v109, 0, v109
  v_exp_f32 v157, v157
  v_cvt_pk_bf16_f32 v110, 0, v110
  v_fma_f32 v158, v158, s66, v142
  v_cvt_pk_bf16_f32 v111, 0, v111
  v_exp_f32 v158, v158
  v_pk_mul_f32 v[108:109], v[108:109], v[116:117] op_sel:[0,1]
  v_add_f32 v144, v148, v149
  v_pk_mul_f32 v[110:111], v[110:111], v[116:117] op_sel:[0,1]
  v_cvt_pk_bf16_f32 v237, v200, v108
  v_cvt_pk_bf16_f32 v241, v201, v109
  v_cvt_pk_bf16_f32 v245, v202, v110
  v_cvt_pk_bf16_f32 v249, v203, v111
  s_waitcnt vmcnt(16)
  s_cbranch_vccnz L_vw0_12
  s_waitcnt vmcnt(11)
L_vw0_12:
  buffer_load_dwordx4 v[24:27], v94, s[12:15], s60 offen offset:2304 nt
  v_mov_b32_dpp v116, v114 row_newbcast:4 row_mask:0xf bank_mask:0xf
  v_mov_b32_dpp v117, v115 row_newbcast:4 row_mask:0xf bank_mask:0xf
  v_pk_fma_f32 v[192:193], v[52:53], s[92:93], v[116:117] op_sel_hi:[1,1,0] neg_lo:[0,0,1] neg_hi:[0,0,1]
  v_pk_fma_f32 v[194:195], v[54:55], s[92:93], v[116:117] op_sel_hi:[1,1,0] neg_lo:[0,0,1] neg_hi:[0,0,1]
  v_cvt_pk_bf16_f32 v192, 0, v192
  v_add_f32 v145, v150, v151
  v_cvt_pk_bf16_f32 v193, 0, v193
  v_add_f32 v144, v144, v152
  v_cvt_pk_bf16_f32 v194, 0, v194
  v_add_f32 v145, v145, v153
  v_cvt_pk_bf16_f32 v195, 0, v195
  v_add_f32 v144, v144, v154
  v_pk_mul_f32 v[192:193], v[192:193], v[116:117] op_sel:[0,1]
  v_add_f32 v145, v145, v155
  v_pk_mul_f32 v[194:195], v[194:195], v[116:117] op_sel:[0,1]
  s_waitcnt vmcnt(16)
  buffer_load_dwordx4 v[28:31], v94, s[12:15], s60 offen offset:2560 nt
  v_pk_fma_f32 v[196:197], v[56:57], s[92:93], v[116:117] op_sel_hi:[1,1,0] neg_lo:[0,0,1] neg_hi:[0,0,1]
  v_pk_fma_f32 v[198:199], v[58:59], s[92:93], v[116:117] op_sel_hi:[1,1,0] neg_lo:[0,0,1] neg_hi:[0,0,1]
  v_cvt_pk_bf16_f32 v196, 0, v196
  v_add_f32 v144, v144, v156
  v_cvt_pk_bf16_f32 v197, 0, v197
  v_add_f32 v145, v145, v157
  v_cvt_pk_bf16_f32 v198, 0, v198
  v_add_f32 v144, v144, v158
  v_cvt_pk_bf16_f32 v199, 0, v199
  v_add_f32 v144, v144, v145
  v_pk_mul_f32 v[196:197], v[196:197], v[116:117] op_sel:[0,1]
  v_fma_f32 v143, v143, v146, v144
  v_pk_mul_f32 v[198:199], v[198:199], v[116:117] op_sel:[0,1]
  s_waitcnt vmcnt(16)
  buffer_load_dwordx4 v[32:35], v94, s[12:15], s60 offen offset:2816 nt
  v_pk_fma_f32 v[200:201], v[60:61], s[92:93], v[116:117] op_sel_hi:[1,1,0] neg_lo:[0,0,1] neg_hi:[0,0,1]
  v_pk_fma_f32 v[202:203], v[62:63], s[92:93], v[116:117] op_sel_hi:[1,1,0] neg_lo:[0,0,1] neg_hi:[0,0,1]
  v_cvt_pk_bf16_f32 v200, 0, v200
  v_cvt_pk_bf16_f32 v159, v148, v149
  v_cvt_pk_bf16_f32 v201, 0, v201
  v_cvt_pk_bf16_f32 v160, v150, v151
  v_cvt_pk_bf16_f32 v202, 0, v202
  v_cvt_pk_bf16_f32 v161, v152, v153
  v_cvt_pk_bf16_f32 v203, 0, v203
  v_cvt_pk_bf16_f32 v162, v154, v155
  v_pk_mul_f32 v[200:201], v[200:201], v[116:117] op_sel:[0,1]
  v_cvt_pk_bf16_f32 v163, v156, v157
  v_pk_mul_f32 v[202:203], v[202:203], v[116:117] op_sel:[0,1]
  s_waitcnt vmcnt(16)
  s_cbranch_vccnz L_vw0_15
  s_waitcnt vmcnt(9)
L_vw0_15:
  buffer_load_dwordx4 v[36:39], v95, s[12:15], s60 offen offset:0 nt
  v_mov_b32_dpp v116, v114 row_newbcast:5 row_mask:0xf bank_mask:0xf
  v_mov_b32_dpp v117, v115 row_newbcast:5 row_mask:0xf bank_mask:0xf
  v_pk_fma_f32 v[108:109], v[64:65], s[92:93], v[116:117] op_sel_hi:[1,1,0] neg_lo:[0,0,1] neg_hi:[0,0,1]
  v_pk_fma_f32 v[110:111], v[66:67], s[92:93], v[116:117] op_sel_hi:[1,1,0] neg_lo:[0,0,1] neg_hi:[0,0,1]
  v_cvt_pk_bf16_f32 v108, 0, v108
  v_cvt_pk_bf16_f32 v164, v158, 0
  v_cvt_pk_bf16_f32 v109, 0, v109
  v_cndmask_b32 v168, 0, v159, s[72:73]
  v_cvt_pk_bf16_f32 v110, 0, v110
  v_cndmask_b32 v169, 0, v160, s[72:73]
  v_cvt_pk_bf16_f32 v111, 0, v111
  v_cndmask_b32 v170, 0, v161, s[72:73]
  v_pk_mul_f32 v[108:109], v[108:109], v[116:117] op_sel:[0,1]
  v_cndmask_b32 v171, 0, v162, s[72:73]
  v_pk_mul_f32 v[110:111], v[110:111], v[116:117] op_sel:[0,1]
  v_cvt_pk_bf16_f32 v206, v192, v108
  v_cvt_pk_bf16_f32 v210, v193, v109
  v_cvt_pk_bf16_f32 v214, v194, v110
  v_cvt_pk_bf16_f32 v218, v195, v111
  s_waitcnt vmcnt(16)
  buffer_load_dwordx4 v[40:43], v95, s[12:15], s60 offen offset:256 nt
  v_pk_fma_f32 v[108:109], v[68:69], s[92:93], v[116:117] op_sel_hi:[1,1,0] neg_lo:[0,0,1] neg_hi:[0,0,1]
  v_pk_fma_f32 v[110:111], v[70:71], s[92:93], v[116:117] op_sel_hi:[1,1,0] neg_lo:[0,0,1] neg_hi:[0,0,1]
  v_cvt_pk_bf16_f32 v108, 0, v108
  v_cndmask_b32 v172, 0, v159, s[74:75]
  v_cvt_pk_bf16_f32 v109, 0, v109
  v_cndmask_b32 v173, 0, v160, s[74:75]
  v_cvt_pk_bf16_f32 v110, 0, v110
  v_cndmask_b32 v174, 0, v161, s[74:75]
  v_cvt_pk_bf16_f32 v111, 0, v111
  v_cndmask_b32 v175, 0, v162, s[74:75]
  v_pk_mul_f32 v[108:109], v[108:109], v[116:117] op_sel:[0,1]
  v_cndmask_b32 v176, 0, v159, s[76:77]
  v_pk_mul_f32 v[110:111], v[110:111], v[116:117] op_sel:[0,1]
  v_cvt_pk_bf16_f32 v222, v196, v108
  v_cvt_pk_bf16_f32 v226, v197, v109
  v_cvt_pk_bf16_f32 v230, v198, v110
  v_cvt_pk_bf16_f32 v234, v199, v111
  s_waitcnt vmcnt(16)
  buffer_load_dwordx4 v[44:47], v95, s[12:15], s60 offen offset:512 nt
  v_pk_fma_f32 v[108:109], v[72:73], s[92:93], v[116:117] op_sel_hi:[1,1,0] neg_lo:[0,0,1] neg_hi:[0,0,1]
  v_pk_fma_f32 v[110:111], v[74:75], s[92:93], v[116:117] op_sel_hi:[1,1,0] neg_lo:[0,0,1] neg_hi:[0,0,1]
  v_cvt_pk_bf16_f32 v108, 0, v108
  v_cndmask_b32 v177, 0, v160, s[76:77]
  v_cvt_pk_bf16_f32 v109, 0, v109
  v_cndmask_b32 v178, 0, v161, s[76:77]
  v_cvt_pk_bf16_f32 v110, 0, v110
  v_cndmask_b32 v179, 0, v162, s[76:77]
  v_cvt_pk_bf16_f32 v111, 0, v111
  v_cndmask_b32 v180, 0, v159, s[78:79]
  v_pk_mul_f32 v[108:109], v[108:109], v[116:117] op_sel:[0,1]
  v_cndmask_b32 v181, 0, v160, s[78:79]
  v_pk_mul_f32 v[110:111], v[110:111], v[116:117] op_sel:[0,1]
  v_cvt_pk_bf16_f32 v238, v200, v108
  v_cvt_pk_bf16_f32 v242, v201, v109
  v_cvt_pk_bf16_f32 v246, v202, v110
  v_cvt_pk_bf16_f32 v250, v203, v111
  v_mad_u32_u24 v92, v97, s63, v3
  v_add_u32 v93, 768, v92
  v_add_u32 v94, 4608, v92
  v_add_u32 v95, 7680, v92
  v_cndmask_b32 v92, v92, v105, s[52:53]
  v_cndmask_b32 v95, v95, v105, s[54:55]
  s_waitcnt vmcnt(16)
  s_cbranch_vccnz L_vw0_18
  s_waitcnt vmcnt(9)
L_vw0_18:
  buffer_load_dwordx4 v[48:51], v92, s[12:15], s61 offen offset:0 nt
  v_mov_b32_dpp v116, v114 row_newbcast:6 row_mask:0xf bank_mask:0xf
  v_mov_b32_dpp v117, v115 row_newbcast:6 row_mask:0xf bank_mask:0xf
  v_pk_fma_f32 v[192:193], v[76:77], s[92:93], v[116:117] op_sel_hi:[1,1,0] neg_lo:[0,0,1] neg_hi:[0,0,1]
  v_pk_fma_f32 v[194:195], v[78:79], s[92:93], v[116:117] op_sel_hi:[1,1,0] neg_lo:[0,0,1] neg_hi:[0,0,1]
  v_cvt_pk_bf16_f32 v192, 0, v192
  v_cndmask_b32 v182, 0, v161, s[78:79]
  v_cvt_pk_bf16_f32 v193, 0, v193
  v_cndmask_b32 v183, 0, v162, s[78:79]
  v_cvt_pk_bf16_f32 v194, 0, v194
  s_waitcnt lgkmcnt(0)
  v_cvt_pk_bf16_f32 v195, 0, v195
  v_mul_f32 v128, v147, v128
  v_pk_mul_f32 v[192:193], v[192:193], v[116:117] op_sel:[0,1]
  v_mul_f32 v129, v147, v129
  v_pk_mul_f32 v[194:195], v[194:195], v[116:117] op_sel:[0,1]
  s_waitcnt vmcnt(14)
  buffer_load_dwordx4 v[52:55], v92, s[12:15], s61 offen offset:256 nt
  v_pk_fma_f32 v[196:197], v[80:81], s[92:93], v[116:117] op_sel_hi:[1,1,0] neg_lo:[0,0,1] neg_hi:[0,0,1]
  v_pk_fma_f32 v[198:199], v[82:83], s[92:93], v[116:117] op_sel_hi:[1,1,0] neg_lo:[0,0,1] neg_hi:[0,0,1]
  v_cvt_pk_bf16_f32 v196, 0, v196
  v_mul_f32 v130, v147, v130
  v_cvt_pk_bf16_f32 v197, 0, v197
  v_mul_f32 v131, v147, v131
  v_cvt_pk_bf16_f32 v198, 0, v198
  v_mul_f32 v132, v147, v132
  v_cvt_pk_bf16_f32 v199, 0, v199
  v_mul_f32 v133, v147, v133
  v_pk_mul_f32 v[196:197], v[196:197], v[116:117] op_sel:[0,1]
  v_mul_f32 v134, v147, v134
  v_pk_mul_f32 v[198:199], v[198:199], v[116:117] op_sel:[0,1]
  s_waitcnt vmcnt(14)
  buffer_load_dwordx4 v[56:59], v92, s[12:15], s61 offen offset:512 nt
  v_pk_fma_f32 v[200:201], v[84:85], s[92:93], v[116:117] op_sel_hi:[1,1,0] neg_lo:[0,0,1] neg_hi:[0,0,1]
  v_pk_fma_f32 v[202:203], v[86:87], s[92:93], v[116:117] op_sel_hi:[1,1,0] neg_lo:[0,0,1] neg_hi:[0,0,1]
  v_cvt_pk_bf16_f32 v200, 0, v200
  v_mul_f32 v135, v147, v135
  v_cvt_pk_bf16_f32 v201, 0, v201
  v_mul_f32 v136, v147, v136
  v_cvt_pk_bf16_f32 v202, 0, v202
  v_mul_f32 v137, v147, v137
  v_cvt_pk_bf16_f32 v203, 0, v203
  v_mul_f32 v138, v147, v138
  v_pk_mul_f32 v[200:201], v[200:201], v[116:117] op_sel:[0,1]
  v_mul_f32 v139, v147, v139
  v_pk_mul_f32 v[202:203], v[202:203], v[116:117] op_sel:[0,1]
  s_waitcnt vmcnt(14)
  s_cbranch_vccnz L_vw0_21
  s_waitcnt vmcnt(9)
L_vw0_21:
  buffer_load_dwordx4 v[60:63], v93, s[12:15], s61 offen offset:0 nt
  v_mov_b32_dpp v116, v114 row_newbcast:7 row_mask:0xf bank_mask:0xf
  v_mov_b32_dpp v117, v115 row_newbcast:7 row_mask:0xf bank_mask:0xf
  v_pk_fma_f32 v[108:109], v[88:89], s[92:93], v[116:117] op_sel_hi:[1,1,0] neg_lo:[0,0,1] neg_hi:[0,0,1]
  v_pk_fma_f32 v[110:111], v[90:91], s[92:93], v[116:117] op_sel_hi:[1,1,0] neg_lo:[0,0,1] neg_hi:[0,0,1]
  v_cvt_pk_bf16_f32 v108, 0, v108
  v_cvt_pk_bf16_f32 v109, 0, v109
  v_cvt_pk_bf16_f32 v110, 0, v110
  v_cvt_pk_bf16_f32 v111, 0, v111
  v_pk_mul_f32 v[108:109], v[108:109], v[116:117] op_sel:[0,1]
  v_pk_mul_f32 v[110:111], v[110:111], v[116:117] op_sel:[0,1]
  v_cvt_pk_bf16_f32 v207, v192, v108
  v_cvt_pk_bf16_f32 v211, v193, v109
  v_cvt_pk_bf16_f32 v215, v194, v110
  v_cvt_pk_bf16_f32 v219, v195, v111
  v_mfma_f32_16x16x32_bf16 v[128:131], v[168:171], v[204:207], v[128:131]
  v_mfma_f32_16x16x32_bf16 v[128:131], v[172:175], v[208:211], v[128:131]
  v_mfma_f32_16x16x32_bf16 v[128:131], v[176:179], v[212:215], v[128:131]
  v_mfma_f32_16x16x32_bf16 v[128:131], v[180:183], v[216:219], v[128:131]
  s_waitcnt vmcnt(14)
  buffer_load_dwordx4 v[64:67], v93, s[12:15], s61 offen offset:256 nt
  v_pk_fma_f32 v[108:109], v[4:5], s[92:93], v[116:117] op_sel_hi:[1,1,0] neg_lo:[0,0,1] neg_hi:[0,0,1]
  v_pk_fma_f32 v[110:111], v[6:7], s[92:93], v[116:117] op_sel_hi:[1,1,0] neg_lo:[0,0,1] neg_hi:[0,0,1]
  v_cvt_pk_bf16_f32 v108, 0, v108
  v_cvt_pk_bf16_f32 v109, 0, v109
  v_cvt_pk_bf16_f32 v110, 0, v110
  v_cvt_pk_bf16_f32 v111, 0, v111
  v_pk_mul_f32 v[108:109], v[108:109], v[116:117] op_sel:[0,1]
  v_pk_mul_f32 v[110:111], v[110:111], v[116:117] op_sel:[0,1]
  v_cvt_pk_bf16_f32 v223, v196, v108
  v_cvt_pk_bf16_f32 v227, v197, v109
  v_cvt_pk_bf16_f32 v231, v198, v110
  v_cvt_pk_bf16_f32 v235, v199, v111
  v_mfma_f32_16x16x32_bf16 v[132:135], v[168:171], v[220:223], v[132:135]
  v_mfma_f32_16x16x32_bf16 v[132:135], v[172:175], v[224:227], v[132:135]
  v_mfma_f32_16x16x32_bf16 v[132:135], v[176:179], v[228:231], v[132:135]
  v_mfma_f32_16x16x32_bf16 v[132:135], v[180:183], v[232:235], v[132:135]
  s_waitcnt vmcnt(14)
  buffer_load_dwordx4 v[68:71], v93, s[12:15], s61 offen offset:512 nt
  v_pk_fma_f32 v[108:109], v[8:9], s[92:93], v[116:117] op_sel_hi:[1,1,0] neg_lo:[0,0,1] neg_hi:[0,0,1]
  v_pk_fma_f32 v[110:111], v[10:11], s[92:93], v[116:117] op_sel_hi:[1,1,0] neg_lo:[0,0,1] neg_hi:[0,0,1]
  v_cvt_pk_bf16_f32 v108, 0, v108
  v_cvt_pk_bf16_f32 v109, 0, v109
  v_cvt_pk_bf16_f32 v110, 0, v110
  v_cvt_pk_bf16_f32 v111, 0, v111
  v_pk_mul_f32 v[108:109], v[108:109], v[116:117] op_sel:[0,1]
  v_pk_mul_f32 v[110:111], v[110:111], v[116:117] op_sel:[0,1]
  v_cvt_pk_bf16_f32 v239, v200, v108
  v_cvt_pk_bf16_f32 v243, v201, v109
  v_cvt_pk_bf16_f32 v247, v202, v110
  v_cvt_pk_bf16_f32 v251, v203, v111
  v_mfma_f32_16x16x32_bf16 v[136:139], v[168:171], v[236:239], v[136:139]
  v_mfma_f32_16x16x32_bf16 v[136:139], v[172:175], v[240:243], v[136:139]
  v_mfma_f32_16x16x32_bf16 v[136:139], v[176:179], v[244:247], v[136:139]
  v_mfma_f32_16x16x32_bf16 v[136:139], v[180:183], v[248:251], v[136:139]
  s_waitcnt vmcnt(14)
  s_cbranch_vccnz L_vw0_24
  s_waitcnt vmcnt(9)
L_vw0_24:
  buffer_load_dwordx4 v[72:75], v93, s[12:15], s61 offen offset:768 nt
  v_mov_b32_dpp v116, v114 row_newbcast:8 row_mask:0xf bank_mask:0xf
  v_mov_b32_dpp v117, v115 row_newbcast:8 row_mask:0xf bank_mask:0xf
  v_pk_fma_f32 v[192:193], v[12:13], s[92:93], v[116:117] op_sel_hi:[1,1,0] neg_lo:[0,0,1] neg_hi:[0,0,1]
  v_pk_fma_f32 v[194:195], v[14:15], s[92:93], v[116:117] op_sel_hi:[1,1,0] neg_lo:[0,0,1] neg_hi:[0,0,1]
  v_cvt_pk_bf16_f32 v192, 0, v192
  v_cndmask_b32 v184, 0, v163, s[72:73]
  v_cvt_pk_bf16_f32 v193, 0, v193
  v_cndmask_b32 v185, 0, v164, s[72:73]
  v_cvt_pk_bf16_f32 v194, 0, v194
  v_cndmask_b32 v186, 0, v163, s[74:75]
  v_cvt_pk_bf16_f32 v195, 0, v195
  v_cndmask_b32 v187, 0, v164, s[74:75]
  v_pk_mul_f32 v[192:193], v[192:193], v[116:117] op_sel:[0,1]
  v_cndmask_b32 v188, 0, v163, s[76:77]
  v_pk_mul_f32 v[194:195], v[194:195], v[116:117] op_sel:[0,1]
  s_waitcnt vmcnt(14)
  buffer_load_dwordx4 v[76:79], v93, s[12:15], s61 offen offset:1024 nt
  v_pk_fma_f32 v[196:197], v[16:17], s[92:93], v[116:117] op_sel_hi:[1,1,0] neg_lo:[0,0,1] neg_hi:[0,0,1]
  v_pk_fma_f32 v[198:199], v[18:19], s[92:93], v[116:117] op_sel_hi:[1,1,0] neg_lo:[0,0,1] neg_hi:[0,0,1]
  v_cvt_pk_bf16_f32 v196, 0, v196
  v_cndmask_b32 v189, 0, v164, s[76:77]
  v_cvt_pk_bf16_f32 v197, 0, v197
  v_cndmask_b32 v190, 0, v163, s[78:79]
  v_cvt_pk_bf16_f32 v198, 0, v198
  v_cndmask_b32 v191, 0, v164, s[78:79]
  v_cvt_pk_bf16_f32 v199, 0, v199
  v_pk_mul_f32 v[196:197], v[196:197], v[116:117] op_sel:[0,1]
  v_pk_mul_f32 v[198:199], v[198:199], v[116:117] op_sel:[0,1]
  s_waitcnt vmcnt(14)
  buffer_load_dwordx4 v[80:83], v93, s[12:15], s61 offen offset:1280 nt
  v_pk_fma_f32 v[200:201], v[20:21], s[92:93], v[116:117] op_sel_hi:[1,1,0] neg_lo:[0,0,1] neg_hi:[0,0,1]
  v_pk_fma_f32 v[202:203], v[22:23], s[92:93], v[116:117] op_sel_hi:[1,1,0] neg_lo:[0,0,1] neg_hi:[0,0,1]
  v_cvt_pk_bf16_f32 v200, 0, v200
  v_cvt_pk_bf16_f32 v201, 0, v201
  v_cvt_pk_bf16_f32 v202, 0, v202
  v_cvt_pk_bf16_f32 v203, 0, v203
  v_pk_mul_f32 v[200:201], v[200:201], v[116:117] op_sel:[0,1]
  v_pk_mul_f32 v[202:203], v[202:203], v[116:117] op_sel:[0,1]
  s_waitcnt vmcnt(14)
  s_cbranch_vccnz L_vw0_27
  s_waitcnt vmcnt(9)
L_vw0_27:
  buffer_load_dwordx4 v[84:87], v93, s[12:15], s61 offen offset:1536 nt
  v_mov_b32_dpp v116, v114 row_newbcast:9 row_mask:0xf bank_mask:0xf
  v_mov_b32_dpp v117, v115 row_newbcast:9 row_mask:0xf bank_mask:0xf
  v_pk_fma_f32 v[108:109], v[24:25], s[92:93], v[116:117] op_sel_hi:[1,1,0] neg_lo:[0,0,1] neg_hi:[0,0,1]
  v_pk_fma_f32 v[110:111], v[26:27], s[92:93], v[116:117] op_sel_hi:[1,1,0] neg_lo:[0,0,1] neg_hi:[0,0,1]
  v_cvt_pk_bf16_f32 v108, 0, v108
  v_cvt_pk_bf16_f32 v109, 0, v109
  v_cvt_pk_bf16_f32 v110, 0, v110
  v_cvt_pk_bf16_f32 v111, 0, v111
  v_pk_mul_f32 v[108:109], v[108:109], v[116:117] op_sel:[0,1]
  v_pk_mul_f32 v[110:111], v[110:111], v[116:117] op_sel:[0,1]
  v_cvt_pk_bf16_f32 v204, v192, v108
  v_cvt_pk_bf16_f32 v208, v193, v109
  v_cvt_pk_bf16_f32 v212, v194, v110
  v_cvt_pk_bf16_f32 v216, v195, v111
  s_waitcnt vmcnt(14)
  buffer_load_dwordx4 v[88:91], v93, s[12:15], s61 offen offset:1792 nt
  v_pk_fma_f32 v[108:109], v[28:29], s[92:93], v[116:117] op_sel_hi:[1,1,0] neg_lo:[0,0,1] neg_hi:[0,0,1]
  v_pk_fma_f32 v[110:111], v[30:31], s[92:93], v[116:117] op_sel_hi:[1,1,0] neg_lo:[0,0,1] neg_hi:[0,0,1]
  v_cvt_pk_bf16_f32 v108, 0, v108
  v_cvt_pk_bf16_f32 v109, 0, v109
  v_cvt_pk_bf16_f32 v110, 0, v110
  v_cvt_pk_bf16_f32 v111, 0, v111
  v_pk_mul_f32 v[108:109], v[108:109], v[116:117] op_sel:[0,1]
  v_pk_mul_f32 v[110:111], v[110:111], v[116:117] op_sel:[0,1]
  v_cvt_pk_bf16_f32 v220, v196, v108
  v_cvt_pk_bf16_f32 v224, v197, v109
  v_cvt_pk_bf16_f32 v228, v198, v110
  v_cvt_pk_bf16_f32 v232, v199, v111
  s_waitcnt vmcnt(14)
  buffer_load_dwordx4 v[4:7], v93, s[12:15], s61 offen offset:2048 nt
  v_pk_fma_f32 v[108:109], v[32:33], s[92:93], v[116:117] op_sel_hi:[1,1,0] neg_lo:[0,0,1] neg_hi:[0,0,1]
  v_pk_fma_f32 v[110:111], v[34:35], s[92:93], v[116:117] op_sel_hi:[1,1,0] neg_lo:[0,0,1] neg_hi:[0,0,1]
  v_cvt_pk_bf16_f32 v108, 0, v108
  v_cvt_pk_bf16_f32 v109, 0, v109
  v_cvt_pk_bf16_f32 v110, 0, v110
  v_cvt_pk_bf16_f32 v111, 0, v111
  v_pk_mul_f32 v[108:109], v[108:109], v[116:117] op_sel:[0,1]
  v_pk_mul_f32 v[110:111], v[110:111], v[116:117] op_sel:[0,1]
  v_cvt_pk_bf16_f32 v236, v200, v108
  v_cvt_pk_bf16_f32 v240, v201, v109
  v_cvt_pk_bf16_f32 v244, v202, v110
  v_cvt_pk_bf16_f32 v248, v203, v111
  s_waitcnt vmcnt(14)
  s_cbranch_vccnz L_vw0_30
  s_waitcnt vmcnt(9)
L_vw0_30:
  buffer_load_dwordx4 v[8:11], v93, s[12:15], s61 offen offset:2304 nt
  v_mov_b32_dpp v116, v114 row_newbcast:10 row_mask:0xf bank_mask:0xf
  v_mov_b32_dpp v117, v115 row_newbcast:10 row_mask:0xf bank_mask:0xf
  v_pk_fma_f32 v[192:193], v[36:37], s[92:93], v[116:117] op_sel_hi:[1,1,0] neg_lo:[0,0,1] neg_hi:[0,0,1]
  v_pk_fma_f32 v[194:195], v[38:39], s[92:93], v[116:117] op_sel_hi:[1,1,0] neg_lo:[0,0,1] neg_hi:[0,0,1]
  v_cvt_pk_bf16_f32 v192, 0, v192
  v_cvt_pk_bf16_f32 v193, 0, v193
  v_cvt_pk_bf16_f32 v194, 0, v194
  v_cvt_pk_bf16_f32 v195, 0, v195
  v_pk_mul_f32 v[192:193], v[192:193], v[116:117] op_sel:[0,1]
  v_pk_mul_f32 v[194:195], v[194:195], v[116:117] op_sel:[0,1]
  v_cvt_pk_bf16_f32 v205, v192, 0
  v_cvt_pk_bf16_f32 v209, v193, 0
  v_cvt_pk_bf16_f32 v213, v194, 0
  v_cvt_pk_bf16_f32 v217, v195, 0
  v_mfma_f32_16x16x16_bf16 v[128:131], v[184:185], v[204:205], v[128:131]
  v_mfma_f32_16x16x16_bf16 v[128:131], v[186:187], v[208:209], v[128:131]
  v_mfma_f32_16x16x16_bf16 v[128:131], v[188:189], v[212:213], v[128:131]
  v_mfma_f32_16x16x16_bf16 v[128:131], v[190:191], v[216:217], v[128:131]
  s_waitcnt vmcnt(14)
  buffer_load_dwordx4 v[12:15], v93, s[12:15], s61 offen offset:2560 nt
  v_pk_fma_f32 v[196:197], v[40:41], s[92:93], v[116:117] op_sel_hi:[1,1,0] neg_lo:[0,0,1] neg_hi:[0,0,1]
  v_pk_fma_f32 v[198:199], v[42:43], s[92:93], v[116:117] op_sel_hi:[1,1,0] neg_lo:[0,0,1] neg_hi:[0,0,1]
  v_cvt_pk_bf16_f32 v196, 0, v196
  v_cvt_pk_bf16_f32 v197, 0, v197
  v_cvt_pk_bf16_f32 v198, 0, v198
  v_cvt_pk_bf16_f32 v199, 0, v199
  v_pk_mul_f32 v[196:197], v[196:197], v[116:117] op_sel:[0,1]
  v_pk_mul_f32 v[198:199], v[198:199], v[116:117] op_sel:[0,1]
  v_cvt_pk_bf16_f32 v221, v196, 0
  v_cvt_pk_bf16_f32 v225, v197, 0
  v_cvt_pk_bf16_f32 v229, v198, 0
  v_cvt_pk_bf16_f32 v233, v199, 0
  v_mfma_f32_16x16x16_bf16 v[132:135], v[184:185], v[220:221], v[132:135]
  v_mfma_f32_16x16x16_bf16 v[132:135], v[186:187], v[224:225], v[132:135]
  v_mfma_f32_16x16x16_bf16 v[132:135], v[188:189], v[228:229], v[132:135]
  v_mfma_f32_16x16x16_bf16 v[132:135], v[190:191], v[232:233], v[132:135]
  s_waitcnt vmcnt(14)
  buffer_load_dwordx4 v[16:19], v93, s[12:15], s61 offen offset:2816 nt
  v_pk_fma_f32 v[200:201], v[44:45], s[92:93], v[116:117] op_sel_hi:[1,1,0] neg_lo:[0,0,1] neg_hi:[0,0,1]
  v_pk_fma_f32 v[202:203], v[46:47], s[92:93], v[116:117] op_sel_hi:[1,1,0] neg_lo:[0,0,1] neg_hi:[0,0,1]
  v_cvt_pk_bf16_f32 v200, 0, v200
  v_cvt_pk_bf16_f32 v201, 0, v201
  v_cvt_pk_bf16_f32 v202, 0, v202
  v_cvt_pk_bf16_f32 v203, 0, v203
  v_pk_mul_f32 v[200:201], v[200:201], v[116:117] op_sel:[0,1]
  v_pk_mul_f32 v[202:203], v[202:203], v[116:117] op_sel:[0,1]
  v_cvt_pk_bf16_f32 v237, v200, 0
  v_cvt_pk_bf16_f32 v241, v201, 0
  v_cvt_pk_bf16_f32 v245, v202, 0
  v_cvt_pk_bf16_f32 v249, v203, 0
  v_mfma_f32_16x16x16_bf16 v[136:139], v[184:185], v[236:237], v[136:139]
  v_mfma_f32_16x16x16_bf16 v[136:139], v[186:187], v[240:241], v[136:139]
  v_mfma_f32_16x16x16_bf16 v[136:139], v[188:189], v[244:245], v[136:139]
  v_mfma_f32_16x16x16_bf16 v[136:139], v[190:191], v[248:249], v[136:139]
  s_mov_b32 s60, s61
L_v1:
  s_add_u32 s97, s64, 96
  v_mov_b32 v146, s97
  s_mov_b32 s86, s84
  s_mov_b32 s87, s85
  ds_write_b32 v104, v146
  s_add_u32 s64, s64, 2
  s_cmp_lt_u32 s64, s99
  s_cbranch_scc1 L_v11_ok
L_v11_spin:
  v_mov_b32 v144, 61700
  ds_read_b32 v144, v144
  s_waitcnt lgkmcnt(0)
  v_readfirstlane_b32 s99, v144
  s_nop 1
  s_cmp_lt_u32 s64, s99
  s_cbranch_scc0 L_v11_spin
L_v11_ok:
  s_lshr_b32 s71, s64, 5
  s_lshr_b32 s85, s96, s71
  s_bfe_u32 s85, s85, 0x10003
  s_and_b32 s70, s64, 31
  s_lshl_b32 s71, s71, 12
  s_add_u32 s70, s70, s5
  s_add_u32 s70, s70, s71
  s_mul_hi_u32 s84, s70, s90
  s_lshr_b32 s84, s84, 1
  s_mul_i32 s71, s84, 3
  s_sub_u32 s70, s70, s71
  s_lshl3_add_u32 s85, s70, s85
  s_mul_i32 s61, s84, 196608
  s_lshr_b32 s89, s84, 4
  s_lshl_b32 s70, s85, 5
  v_add_u32 v97, s70, v1
  v_mul_u32_u24 v97, 21846, v97
  v_lshrrev_b32 v97, 16, v97
  v_add_u32 v144, s85, v2
  v_lshrrev_b32 v145, v144, s91
  v_and_b32 v145, 1, v145
  v_cmp_eq_u32 s[54:55], 1, v145
  s_nop 1
  s_and_b64 s[52:53], s[54:55], s[58:59]
  s_andn2_b64 s[54:55], s[54:55], s[58:59]
  s_cmp_lt_u32 s64, 96
  s_cselect_b32 s61, s61, 805306368
  s_lshr_b32 s70, s64, 1
  s_cmp_eq_u32 s70, 32
  s_cselect_b32 s48, -36096, s63
  ds_read_b32 v106, v104 offset:8
  s_waitcnt vmcnt(14)
  s_cbranch_vccnz L_vw1_0
  s_waitcnt vmcnt(9)
L_vw1_0:
  buffer_load_dwordx4 v[20:23], v93, s[12:15], s60 offen offset:3072 nt
  v_mul_f32 v114, s94, v112
  v_mul_f32 v115, 0x4a800000, v113
  s_nop 0
  v_mov_b32_dpp v116, v114 row_newbcast:0 row_mask:0xf bank_mask:0xf
  v_mov_b32_dpp v117, v115 row_newbcast:0 row_mask:0xf bank_mask:0xf
  v_pk_fma_f32 v[192:193], v[48:49], s[92:93], v[116:117] op_sel_hi:[1,1,0] neg_lo:[0,0,1] neg_hi:[0,0,1]
  v_pk_fma_f32 v[194:195], v[50:51], s[92:93], v[116:117] op_sel_hi:[1,1,0] neg_lo:[0,0,1] neg_hi:[0,0,1]
  v_cvt_pk_bf16_f32 v192, 0, v192
  v_cvt_pk_bf16_f32 v193, 0, v193
  v_cvt_pk_bf16_f32 v194, 0, v194
  v_cvt_pk_bf16_f32 v195, 0, v195
  v_pk_mul_f32 v[192:193], v[192:193], v[116:117] op_sel:[0,1]
  v_pk_mul_f32 v[194:195], v[194:195], v[116:117] op_sel:[0,1]
  s_waitcnt lgkmcnt(0)
  v_cmp_lt_u32 vcc, s97, v106
  s_waitcnt vmcnt(14)
  buffer_load_dwordx4 v[24:27], v93, s[12:15], s60 offen offset:3328 nt
  v_pk_fma_f32 v[196:197], v[52:53], s[92:93], v[116:117] op_sel_hi:[1,1,0] neg_lo:[0,0,1] neg_hi:[0,0,1]
  v_pk_fma_f32 v[198:199], v[54:55], s[92:93], v[116:117] op_sel_hi:[1,1,0] neg_lo:[0,0,1] neg_hi:[0,0,1]
  v_cvt_pk_bf16_f32 v196, 0, v196
  v_lshlrev_b32 v148, 16, v120
  v_cvt_pk_bf16_f32 v197, 0, v197
  v_and_b32 v149, s65, v120
  v_cvt_pk_bf16_f32 v198, 0, v198
  v_lshlrev_b32 v150, 16, v121
  v_cvt_pk_bf16_f32 v199, 0, v199
  v_and_b32 v151, s65, v121
  v_pk_mul_f32 v[196:197], v[196:197], v[116:117] op_sel:[0,1]
  v_lshlrev_b32 v152, 16, v122
  v_pk_mul_f32 v[198:199], v[198:199], v[116:117] op_sel:[0,1]
  s_waitcnt vmcnt(14)
  buffer_load_dwordx4 v[28:31], v93, s[12:15], s60 offen offset:3584 nt
  v_pk_fma_f32 v[200:201], v[56:57], s[92:93], v[116:117] op_sel_hi:[1,1,0] neg_lo:[0,0,1] neg_hi:[0,0,1]
  v_pk_fma_f32 v[202:203], v[58:59], s[92:93], v[116:117] op_sel_hi:[1,1,0] neg_lo:[0,0,1] neg_hi:[0,0,1]
  v_cvt_pk_bf16_f32 v200, 0, v200
  v_and_b32 v153, s65, v122
  v_cvt_pk_bf16_f32 v201, 0, v201
  v_lshlrev_b32 v154, 16, v123
  v_cvt_pk_bf16_f32 v202, 0, v202
  v_and_b32 v155, s65, v123
  v_cvt_pk_bf16_f32 v203, 0, v203
  v_lshlrev_b32 v156, 16, v124
  v_pk_mul_f32 v[200:201], v[200:201], v[116:117] op_sel:[0,1]
  v_and_b32 v157, s65, v124
  v_pk_mul_f32 v[202:203], v[202:203], v[116:117] op_sel:[0,1]
  s_waitcnt vmcnt(14)
  s_cbranch_vccnz L_vw1_3
  s_waitcnt vmcnt(9)
L_vw1_3:
  buffer_load_dwordx4 v[32:35], v94, s[12:15], s60 offen offset:0 nt
  v_mov_b32_dpp v116, v114 row_newbcast:1 row_mask:0xf bank_mask:0xf
  v_mov_b32_dpp v117, v115 row_newbcast:1 row_mask:0xf bank_mask:0xf
  v_pk_fma_f32 v[108:109], v[60:61], s[92:93], v[116:117] op_sel_hi:[1,1,0] neg_lo:[0,0,1] neg_hi:[0,0,1]
  v_pk_fma_f32 v[110:111], v[62:63], s[92:93], v[116:117] op_sel_hi:[1,1,0] neg_lo:[0,0,1] neg_hi:[0,0,1]
  s_lshl_b32 s62, s84, 9
  v_lshl_add_u32 v98, v97, 1, v96
  buffer_load_short_d16_hi v112, v98, s[32:35], s62 offen
  buffer_load_short_d16_hi v113, v98, s[28:31], s62 offen
  v_cvt_pk_bf16_f32 v108, 0, v108
  v_lshlrev_b32 v158, 16, v125
  v_cvt_pk_bf16_f32 v109, 0, v109
  v_add_u32 v99, s48, v99
  v_cvt_pk_bf16_f32 v110, 0, v110
  v_add_u32 v100, s48, v100
  v_cvt_pk_bf16_f32 v111, 0, v111
  v_max3_f32 v144, v148, v149, v150
  v_pk_mul_f32 v[108:109], v[108:109], v[116:117] op_sel:[0,1]
  ds_read_b128 v[120:123], v99
  v_pk_mul_f32 v[110:111], v[110:111], v[116:117] op_sel:[0,1]
  v_cvt_pk_bf16_f32 v204, v192, v108
  v_cvt_pk_bf16_f32 v208, v193, v109
  v_cvt_pk_bf16_f32 v212, v194, v110
  v_cvt_pk_bf16_f32 v216, v195, v111
  s_waitcnt vmcnt(16)
  buffer_load_dwordx4 v[36:39], v94, s[12:15], s60 offen offset:256 nt
  v_pk_fma_f32 v[108:109], v[64:65], s[92:93], v[116:117] op_sel_hi:[1,1,0] neg_lo:[0,0,1] neg_hi:[0,0,1]
  v_pk_fma_f32 v[110:111], v[66:67], s[92:93], v[116:117] op_sel_hi:[1,1,0] neg_lo:[0,0,1] neg_hi:[0,0,1]
  v_cvt_pk_bf16_f32 v108, 0, v108
  ds_read_b64 v[124:125], v100 offset:256
  v_cvt_pk_bf16_f32 v109, 0, v109
  v_max3_f32 v145, v151, v152, v153
  v_cvt_pk_bf16_f32 v110, 0, v110
  v_max3_f32 v144, v144, v154, v155
  v_cvt_pk_bf16_f32 v111, 0, v111
  v_max3_f32 v145, v145, v156, v157
  v_pk_mul_f32 v[108:109], v[108:109], v[116:117] op_sel:[0,1]
  v_max3_f32 v144, v144, v158, v140
  v_pk_mul_f32 v[110:111], v[110:111], v[116:117] op_sel:[0,1]
  v_cvt_pk_bf16_f32 v220, v196, v108
  v_cvt_pk_bf16_f32 v224, v197, v109
  v_cvt_pk_bf16_f32 v228, v198, v110
  v_cvt_pk_bf16_f32 v232, v199, v111
  s_waitcnt vmcnt(16)
  buffer_load_dwordx4 v[40:43], v94, s[12:15], s60 offen offset:512 nt
  v_pk_fma_f32 v[108:109], v[68:69], s[92:93], v[116:117] op_sel_hi:[1,1,0] neg_lo:[0,0,1] neg_hi:[0,0,1]
  v_pk_fma_f32 v[110:111], v[70:71], s[92:93], v[116:117] op_sel_hi:[1,1,0] neg_lo:[0,0,1] neg_hi:[0,0,1]
  v_cvt_pk_bf16_f32 v108, 0, v108
  v_max_f32 v144, v144, v145
  v_cvt_pk_bf16_f32 v109, 0, v109
  v_mov_b32 v145, v144
  v_cvt_pk_bf16_f32 v110, 0, v110
  s_nop 0
  v_permlane32_swap_b32 v144, v145
  v_cvt_pk_bf16_f32 v111, 0, v111
  v_max_f32 v144, v144, v145
  v_pk_mul_f32 v[108:109], v[108:109], v[116:117] op_sel:[0,1]
  v_mov_b32 v145, v144
  v_pk_mul_f32 v[110:111], v[110:111], v[116:117] op_sel:[0,1]
  v_cvt_pk_bf16_f32 v236, v200, v108
  v_cvt_pk_bf16_f32 v240, v201, v109
  v_cvt_pk_bf16_f32 v244, v202, v110
  v_cvt_pk_bf16_f32 v248, v203, v111
  s_waitcnt vmcnt(16)
  s_cbranch_vccnz L_vw1_6
  s_waitcnt vmcnt(11)
L_vw1_6:
  buffer_load_dwordx4 v[44:47], v94, s[12:15], s60 offen offset:768 nt
  v_mov_b32_dpp v116, v114 row_newbcast:2 row_mask:0xf bank_mask:0xf
  v_mov_b32_dpp v117, v115 row_newbcast:2 row_mask:0xf bank_mask:0xf
  v_pk_fma_f32 v[192:193], v[72:73], s[92:93], v[116:117] op_sel_hi:[1,1,0] neg_lo:[0,0,1] neg_hi:[0,0,1]
  v_pk_fma_f32 v[194:195], v[74:75], s[92:93], v[116:117] op_sel_hi:[1,1,0] neg_lo:[0,0,1] neg_hi:[0,0,1]
  v_cvt_pk_bf16_f32 v192, 0, v192
  v_permlane16_swap_b32 v144, v145
  v_cvt_pk_bf16_f32 v193, 0, v193
  v_max_f32 v140, v144, v145
  v_cvt_pk_bf16_f32 v194, 0, v194
  v_mul_f32 v144, s66, v140
  v_cvt_pk_bf16_f32 v195, 0, v195
  v_add_f32 v146, v144, v142
  v_pk_mul_f32 v[192:193], v[192:193], v[116:117] op_sel:[0,1]
  v_sub_f32 v142, 0, v144
  v_pk_mul_f32 v[194:195], v[194:195], v[116:117] op_sel:[0,1]
  s_waitcnt vmcnt(16)
  buffer_load_dwordx4 v[48:51], v94, s[12:15], s60 offen offset:1024 nt
  v_pk_fma_f32 v[196:197], v[76:77], s[92:93], v[116:117] op_sel_hi:[1,1,0] neg_lo:[0,0,1] neg_hi:[0,0,1]
  v_pk_fma_f32 v[198:199], v[78:79], s[92:93], v[116:117] op_sel_hi:[1,1,0] neg_lo:[0,0,1] neg_hi:[0,0,1]
  v_cvt_pk_bf16_f32 v196, 0, v196
  v_exp_f32 v146, -v146
  v_cvt_pk_bf16_f32 v197, 0, v197
  ds_bpermute_b32 v147, v101, v146
  v_cvt_pk_bf16_f32 v198, 0, v198
  v_fma_f32 v148, v148, s66, v142
  v_cvt_pk_bf16_f32 v199, 0, v199
  v_exp_f32 v148, v148
  v_pk_mul_f32 v[196:197], v[196:197], v[116:117] op_sel:[0,1]
  v_fma_f32 v149, v149, s66, v142
  v_pk_mul_f32 v[198:199], v[198:199], v[116:117] op_sel:[0,1]
  s_waitcnt vmcnt(16)
  buffer_load_dwordx4 v[52:55], v94, s[12:15], s60 offen offset:1280 nt
  v_pk_fma_f32 v[200:201], v[80:81], s[92:93], v[116:117] op_sel_hi:[1,1,0] neg_lo:[0,0,1] neg_hi:[0,0,1]
  v_pk_fma_f32 v[202:203], v[82:83], s[92:93], v[116:117] op_sel_hi:[1,1,0] neg_lo:[0,0,1] neg_hi:[0,0,1]
  v_cvt_pk_bf16_f32 v200, 0, v200
  v_exp_f32 v149, v149
  v_cvt_pk_bf16_f32 v201, 0, v201
  v_fma_f32 v150, v150, s66, v142
  v_cvt_pk_bf16_f32 v202, 0, v202
  v_exp_f32 v150, v150
  v_cvt_pk_bf16_f32 v203, 0, v203
  v_fma_f32 v151, v151, s66, v142
  v_pk_mul_f32 v[200:201], v[200:201], v[116:117] op_sel:[0,1]
  v_exp_f32 v151, v151
  v_pk_mul_f32 v[202:203], v[202:203], v[116:117] op_sel:[0,1]
  s_waitcnt vmcnt(16)
  s_cbranch_vccnz L_vw1_9
  s_waitcnt vmcnt(11)
L_vw1_9:
  buffer_load_dwordx4 v[56:59], v94, s[12:15], s60 offen offset:1536 nt
  v_mov_b32_dpp v116, v114 row_newbcast:3 row_mask:0xf bank_mask:0xf
  v_mov_b32_dpp v117, v115 row_newbcast:3 row_mask:0xf bank_mask:0xf
  v_pk_fma_f32 v[108:109], v[84:85], s[92:93], v[116:117] op_sel_hi:[1,1,0] neg_lo:[0,0,1] neg_hi:[0,0,1]
  v_pk_fma_f32 v[110:111], v[86:87], s[92:93], v[116:117] op_sel_hi:[1,1,0] neg_lo:[0,0,1] neg_hi:[0,0,1]
  v_cvt_pk_bf16_f32 v108, 0, v108
  v_fma_f32 v152, v152, s66, v142
  v_cvt_pk_bf16_f32 v109, 0, v109
  v_exp_f32 v152, v152
  v_cvt_pk_bf16_f32 v110, 0, v110
  v_fma_f32 v153, v153, s66, v142
  v_cvt_pk_bf16_f32 v111, 0, v111
  v_exp_f32 v153, v153
  v_pk_mul_f32 v[108:109], v[108:109], v[116:117] op_sel:[0,1]
  v_fma_f32 v154, v154, s66, v142
  v_pk_mul_f32 v[110:111], v[110:111], v[116:117] op_sel:[0,1]
  v_cvt_pk_bf16_f32 v205, v192, v108
  v_cvt_pk_bf16_f32 v209, v193, v109
  v_cvt_pk_bf16_f32 v213, v194, v110
  v_cvt_pk_bf16_f32 v217, v195, v111
  s_waitcnt vmcnt(16)
  buffer_load_dwordx4 v[60:63], v94, s[12:15], s60 offen offset:1792 nt
  v_pk_fma_f32 v[108:109], v[88:89], s[92:93], v[116:117] op_sel_hi:[1,1,0] neg_lo:[0,0,1] neg_hi:[0,0,1]
  v_pk_fma_f32 v[110:111], v[90:91], s[92:93], v[116:117] op_sel_hi:[1,1,0] neg_lo:[0,0,1] neg_hi:[0,0,1]
  v_cvt_pk_bf16_f32 v108, 0, v108
  v_exp_f32 v154, v154
  v_cvt_pk_bf16_f32 v109, 0, v109
  v_fma_f32 v155, v155, s66, v142
  v_cvt_pk_bf16_f32 v110, 0, v110
  v_exp_f32 v155, v155
  v_cvt_pk_bf16_f32 v111, 0, v111
  v_fma_f32 v156, v156, s66, v142
  v_pk_mul_f32 v[108:109], v[108:109], v[116:117] op_sel:[0,1]
  v_exp_f32 v156, v156
  v_pk_mul_f32 v[110:111], v[110:111], v[116:117] op_sel:[0,1]
  v_cvt_pk_bf16_f32 v221, v196, v108
  v_cvt_pk_bf16_f32 v225, v197, v109
  v_cvt_pk_bf16_f32 v229, v198, v110
  v_cvt_pk_bf16_f32 v233, v199, v111
  s_waitcnt vmcnt(16)
  buffer_load_dwordx4 v[64:67], v94, s[12:15], s60 offen offset:2048 nt
  v_pk_fma_f32 v[108:109], v[4:5], s[92:93], v[116:117] op_sel_hi:[1,1,0] neg_lo:[0,0,1] neg_hi:[0,0,1]
  v_pk_fma_f32 v[110:111], v[6:7], s[92:93], v[116:117] op_sel_hi:[1,1,0] neg_lo:[0,0,1] neg_hi:[0,0,1]
  v_cvt_pk_bf16_f32 v108, 0, v108
  v_fma_f32 v157, v157, s66, v142
  v_cvt_pk_bf16_f32 v109, 0, v109
  v_exp_f32 v157, v157
  v_cvt_pk_bf16_f32 v110, 0, v110
  v_fma_f32 v158, v158, s66, v142
  v_cvt_pk_bf16_f32 v111, 0, v111
  v_exp_f32 v158, v158
  v_pk_mul_f32 v[108:109], v[108:109], v[116:117] op_sel:[0,1]
  v_add_f32 v144, v148, v149
  v_pk_mul_f32 v[110:111], v[110:111], v[116:117] op_sel:[0,1]
  v_cvt_pk_bf16_f32 v237, v200, v108
  v_cvt_pk_bf16_f32 v241, v201, v109
  v_cvt_pk_bf16_f32 v245, v202, v110
  v_cvt_pk_bf16_f32 v249, v203, v111
  s_waitcnt vmcnt(16)
  s_cbranch_vccnz L_vw1_12
  s_waitcnt vmcnt(11)
L_vw1_12:
  buffer_load_dwordx4 v[68:71], v94, s[12:15], s60 offen offset:2304 nt
  v_mov_b32_dpp v116, v114 row_newbcast:4 row_mask:0xf bank_mask:0xf
  v_mov_b32_dpp v117, v115 row_newbcast:4 row_mask:0xf bank_mask:0xf
  v_pk_fma_f32 v[192:193], v[8:9], s[92:93], v[116:117] op_sel_hi:[1,1,0] neg_lo:[0,0,1] neg_hi:[0,0,1]
  v_pk_fma_f32 v[194:195], v[10:11], s[92:93], v[116:117] op_sel_hi:[1,1,0] neg_lo:[0,0,1] neg_hi:[0,0,1]
  v_cvt_pk_bf16_f32 v192, 0, v192
  v_add_f32 v145, v150, v151
  v_cvt_pk_bf16_f32 v193, 0, v193
  v_add_f32 v144, v144, v152
  v_cvt_pk_bf16_f32 v194, 0, v194
  v_add_f32 v145, v145, v153
  v_cvt_pk_bf16_f32 v195, 0, v195
  v_add_f32 v144, v144, v154
  v_pk_mul_f32 v[192:193], v[192:193], v[116:117] op_sel:[0,1]
  v_add_f32 v145, v145, v155
  v_pk_mul_f32 v[194:195], v[194:195], v[116:117] op_sel:[0,1]
  s_waitcnt vmcnt(16)
  buffer_load_dwordx4 v[72:75], v94, s[12:15], s60 offen offset:2560 nt
  v_pk_fma_f32 v[196:197], v[12:13], s[92:93], v[116:117] op_sel_hi:[1,1,0] neg_lo:[0,0,1] neg_hi:[0,0,1]
  v_pk_fma_f32 v[198:199], v[14:15], s[92:93], v[116:117] op_sel_hi:[1,1,0] neg_lo:[0,0,1] neg_hi:[0,0,1]
  v_cvt_pk_bf16_f32 v196, 0, v196
  v_add_f32 v144, v144, v156
  v_cvt_pk_bf16_f32 v197, 0, v197
  v_add_f32 v145, v145, v157
  v_cvt_pk_bf16_f32 v198, 0, v198
  v_add_f32 v144, v144, v158
  v_cvt_pk_bf16_f32 v199, 0, v199
  v_add_f32 v144, v144, v145
  v_pk_mul_f32 v[196:197], v[196:197], v[116:117] op_sel:[0,1]
  v_fma_f32 v143, v143, v146, v144
  v_pk_mul_f32 v[198:199], v[198:199], v[116:117] op_sel:[0,1]
  s_waitcnt vmcnt(16)
  buffer_load_dwordx4 v[76:79], v94, s[12:15], s60 offen offset:2816 nt
  v_pk_fma_f32 v[200:201], v[16:17], s[92:93], v[116:117] op_sel_hi:[1,1,0] neg_lo:[0,0,1] neg_hi:[0,0,1]
  v_pk_fma_f32 v[202:203], v[18:19], s[92:93], v[116:117] op_sel_hi:[1,1,0] neg_lo:[0,0,1] neg_hi:[0,0,1]
  v_cvt_pk_bf16_f32 v200, 0, v200
  v_cvt_pk_bf16_f32 v159, v148, v149
  v_cvt_pk_bf16_f32 v201, 0, v201
  v_cvt_pk_bf16_f32 v160, v150, v151
  v_cvt_pk_bf16_f32 v202, 0, v202
  v_cvt_pk_bf16_f32 v161, v152, v153
  v_cvt_pk_bf16_f32 v203, 0, v203
  v_cvt_pk_bf16_f32 v162, v154, v155
  v_pk_mul_f32 v[200:201], v[200:201], v[116:117] op_sel:[0,1]
  v_cvt_pk_bf16_f32 v163, v156, v157
  v_pk_mul_f32 v[202:203], v[202:203], v[116:117] op_sel:[0,1]
  s_waitcnt vmcnt(16)
  s_cbranch_vccnz L_vw1_15
  s_waitcnt vmcnt(9)
L_vw1_15:
  buffer_load_dwordx4 v[80:83], v95, s[12:15], s60 offen offset:0 nt
  v_mov_b32_dpp v116, v114 row_newbcast:5 row_mask:0xf bank_mask:0xf
  v_mov_b32_dpp v117, v115 row_newbcast:5 row_mask:0xf bank_mask:0xf
  v_pk_fma_f32 v[108:109], v[20:21], s[92:93], v[116:117] op_sel_hi:[1,1,0] neg_lo:[0,0,1] neg_hi:[0,0,1]
  v_pk_fma_f32 v[110:111], v[22:23], s[92:93], v[116:117] op_sel_hi:[1,1,0] neg_lo:[0,0,1] neg_hi:[0,0,1]
  v_cvt_pk_bf16_f32 v108, 0, v108
  v_cvt_pk_bf16_f32 v164, v158, 0
  v_cvt_pk_bf16_f32 v109, 0, v109
  v_cndmask_b32 v168, 0, v159, s[72:73]
  v_cvt_pk_bf16_f32 v110, 0, v110
  v_cndmask_b32 v169, 0, v160, s[72:73]
  v_cvt_pk_bf16_f32 v111, 0, v111
  v_cndmask_b32 v170, 0, v161, s[72:73]
  v_pk_mul_f32 v[108:109], v[108:109], v[116:117] op_sel:[0,1]
  v_cndmask_b32 v171, 0, v162, s[72:73]
  v_pk_mul_f32 v[110:111], v[110:111], v[116:117] op_sel:[0,1]
  v_cvt_pk_bf16_f32 v206, v192, v108
  v_cvt_pk_bf16_f32 v210, v193, v109
  v_cvt_pk_bf16_f32 v214, v194, v110
  v_cvt_pk_bf16_f32 v218, v195, v111
  s_waitcnt vmcnt(16)
  buffer_load_dwordx4 v[84:87], v95, s[12:15], s60 offen offset:256 nt
  v_pk_fma_f32 v[108:109], v[24:25], s[92:93], v[116:117] op_sel_hi:[1,1,0] neg_lo:[0,0,1] neg_hi:[0,0,1]
  v_pk_fma_f32 v[110:111], v[26:27], s[92:93], v[116:117] op_sel_hi:[1,1,0] neg_lo:[0,0,1] neg_hi:[0,0,1]
  v_cvt_pk_bf16_f32 v108, 0, v108
  v_cndmask_b32 v172, 0, v159, s[74:75]
  v_cvt_pk_bf16_f32 v109, 0, v109
  v_cndmask_b32 v173, 0, v160, s[74:75]
  v_cvt_pk_bf16_f32 v110, 0, v110
  v_cndmask_b32 v174, 0, v161, s[74:75]
  v_cvt_pk_bf16_f32 v111, 0, v111
  v_cndmask_b32 v175, 0, v162, s[74:75]
  v_pk_mul_f32 v[108:109], v[108:109], v[116:117] op_sel:[0,1]
  v_cndmask_b32 v176, 0, v159, s[76:77]
  v_pk_mul_f32 v[110:111], v[110:111], v[116:117] op_sel:[0,1]
  v_cvt_pk_bf16_f32 v222, v196, v108
  v_cvt_pk_bf16_f32 v226, v197, v109
  v_cvt_pk_bf16_f32 v230, v198, v110
  v_cvt_pk_bf16_f32 v234, v199, v111
  s_waitcnt vmcnt(16)
  buffer_load_dwordx4 v[88:91], v95, s[12:15], s60 offen offset:512 nt
  v_pk_fma_f32 v[108:109], v[28:29], s[92:93], v[116:117] op_sel_hi:[1,1,0] neg_lo:[0,0,1] neg_hi:[0,0,1]
  v_pk_fma_f32 v[110:111], v[30:31], s[92:93], v[116:117] op_sel_hi:[1,1,0] neg_lo:[0,0,1] neg_hi:[0,0,1]
  v_cvt_pk_bf16_f32 v108, 0, v108
  v_cndmask_b32 v177, 0, v160, s[76:77]
  v_cvt_pk_bf16_f32 v109, 0, v109
  v_cndmask_b32 v178, 0, v161, s[76:77]
  v_cvt_pk_bf16_f32 v110, 0, v110
  v_cndmask_b32 v179, 0, v162, s[76:77]
  v_cvt_pk_bf16_f32 v111, 0, v111
  v_cndmask_b32 v180, 0, v159, s[78:79]
  v_pk_mul_f32 v[108:109], v[108:109], v[116:117] op_sel:[0,1]
  v_cndmask_b32 v181, 0, v160, s[78:79]
  v_pk_mul_f32 v[110:111], v[110:111], v[116:117] op_sel:[0,1]
  v_cvt_pk_bf16_f32 v238, v200, v108
  v_cvt_pk_bf16_f32 v242, v201, v109
  v_cvt_pk_bf16_f32 v246, v202, v110
  v_cvt_pk_bf16_f32 v250, v203, v111
  v_mad_u32_u24 v92, v97, s63, v3
  v_add_u32 v93, 768, v92
  v_add_u32 v94, 4608, v92
  v_add_u32 v95, 7680, v92
  v_cndmask_b32 v92, v92, v105, s[52:53]
  v_cndmask_b32 v95, v95, v105, s[54:55]
  s_waitcnt vmcnt(16)
  s_cbranch_vccnz L_vw1_18
  s_waitcnt vmcnt(9)
L_vw1_18:
  buffer_load_dwordx4 v[4:7], v92, s[12:15], s61 offen offset:0 nt
  v_mov_b32_dpp v116, v114 row_newbcast:6 row_mask:0xf bank_mask:0xf
  v_mov_b32_dpp v117, v115 row_newbcast:6 row_mask:0xf bank_mask:0xf
  v_pk_fma_f32 v[192:193], v[32:33], s[92:93], v[116:117] op_sel_hi:[1,1,0] neg_lo:[0,0,1] neg_hi:[0,0,1]
  v_pk_fma_f32 v[194:195], v[34:35], s[92:93], v[116:117] op_sel_hi:[1,1,0] neg_lo:[0,0,1] neg_hi:[0,0,1]
  v_cvt_pk_bf16_f32 v192, 0, v192
  v_cndmask_b32 v182, 0, v161, s[78:79]
  v_cvt_pk_bf16_f32 v193, 0, v193
  v_cndmask_b32 v183, 0, v162, s[78:79]
  v_cvt_pk_bf16_f32 v194, 0, v194
  s_waitcnt lgkmcnt(0)
  v_cvt_pk_bf16_f32 v195, 0, v195
  v_mul_f32 v128, v147, v128
  v_pk_mul_f32 v[192:193], v[192:193], v[116:117] op_sel:[0,1]
  v_mul_f32 v129, v147, v129
  v_pk_mul_f32 v[194:195], v[194:195], v[116:117] op_sel:[0,1]
  s_waitcnt vmcnt(14)
  buffer_load_dwordx4 v[8:11], v92, s[12:15], s61 offen offset:256 nt
  v_pk_fma_f32 v[196:197], v[36:37], s[92:93], v[116:117] op_sel_hi:[1,1,0] neg_lo:[0,0,1] neg_hi:[0,0,1]
  v_pk_fma_f32 v[198:199], v[38:39], s[92:93], v[116:117] op_sel_hi:[1,1,0] neg_lo:[0,0,1] neg_hi:[0,0,1]
  v_cvt_pk_bf16_f32 v196, 0, v196
  v_mul_f32 v130, v147, v130
  v_cvt_pk_bf16_f32 v197, 0, v197
  v_mul_f32 v131, v147, v131
  v_cvt_pk_bf16_f32 v198, 0, v198
  v_mul_f32 v132, v147, v132
  v_cvt_pk_bf16_f32 v199, 0, v199
  v_mul_f32 v133, v147, v133
  v_pk_mul_f32 v[196:197], v[196:197], v[116:117] op_sel:[0,1]
  v_mul_f32 v134, v147, v134
  v_pk_mul_f32 v[198:199], v[198:199], v[116:117] op_sel:[0,1]
  s_waitcnt vmcnt(14)
  buffer_load_dwordx4 v[12:15], v92, s[12:15], s61 offen offset:512 nt
  v_pk_fma_f32 v[200:201], v[40:41], s[92:93], v[116:117] op_sel_hi:[1,1,0] neg_lo:[0,0,1] neg_hi:[0,0,1]
  v_pk_fma_f32 v[202:203], v[42:43], s[92:93], v[116:117] op_sel_hi:[1,1,0] neg_lo:[0,0,1] neg_hi:[0,0,1]
  v_cvt_pk_bf16_f32 v200, 0, v200
  v_mul_f32 v135, v147, v135
  v_cvt_pk_bf16_f32 v201, 0, v201
  v_mul_f32 v136, v147, v136
  v_cvt_pk_bf16_f32 v202, 0, v202
  v_mul_f32 v137, v147, v137
  v_cvt_pk_bf16_f32 v203, 0, v203
  v_mul_f32 v138, v147, v138
  v_pk_mul_f32 v[200:201], v[200:201], v[116:117] op_sel:[0,1]
  v_mul_f32 v139, v147, v139
  v_pk_mul_f32 v[202:203], v[202:203], v[116:117] op_sel:[0,1]
  s_waitcnt vmcnt(14)
  s_cbranch_vccnz L_vw1_21
  s_waitcnt vmcnt(9)
L_vw1_21:
  buffer_load_dwordx4 v[16:19], v93, s[12:15], s61 offen offset:0 nt
  v_mov_b32_dpp v116, v114 row_newbcast:7 row_mask:0xf bank_mask:0xf
  v_mov_b32_dpp v117, v115 row_newbcast:7 row_mask:0xf bank_mask:0xf
  v_pk_fma_f32 v[108:109], v[44:45], s[92:93], v[116:117] op_sel_hi:[1,1,0] neg_lo:[0,0,1] neg_hi:[0,0,1]
  v_pk_fma_f32 v[110:111], v[46:47], s[92:93], v[116:117] op_sel_hi:[1,1,0] neg_lo:[0,0,1] neg_hi:[0,0,1]
  v_cvt_pk_bf16_f32 v108, 0, v108
  v_cvt_pk_bf16_f32 v109, 0, v109
  v_cvt_pk_bf16_f32 v110, 0, v110
  v_cvt_pk_bf16_f32 v111, 0, v111
  v_pk_mul_f32 v[108:109], v[108:109], v[116:117] op_sel:[0,1]
  v_pk_mul_f32 v[110:111], v[110:111], v[116:117] op_sel:[0,1]
  v_cvt_pk_bf16_f32 v207, v192, v108
  v_cvt_pk_bf16_f32 v211, v193, v109
  v_cvt_pk_bf16_f32 v215, v194, v110
  v_cvt_pk_bf16_f32 v219, v195, v111
  v_mfma_f32_16x16x32_bf16 v[128:131], v[168:171], v[204:207], v[128:131]
  v_mfma_f32_16x16x32_bf16 v[128:131], v[172:175], v[208:211], v[128:131]
  v_mfma_f32_16x16x32_bf16 v[128:131], v[176:179], v[212:215], v[128:131]
  v_mfma_f32_16x16x32_bf16 v[128:131], v[180:183], v[216:219], v[128:131]
  s_waitcnt vmcnt(14)
  buffer_load_dwordx4 v[20:23], v93, s[12:15], s61 offen offset:256 nt
  v_pk_fma_f32 v[108:109], v[48:49], s[92:93], v[116:117] op_sel_hi:[1,1,0] neg_lo:[0,0,1] neg_hi:[0,0,1]
  v_pk_fma_f32 v[110:111], v[50:51], s[92:93], v[116:117] op_sel_hi:[1,1,0] neg_lo:[0,0,1] neg_hi:[0,0,1]
  v_cvt_pk_bf16_f32 v108, 0, v108
  v_cvt_pk_bf16_f32 v109, 0, v109
  v_cvt_pk_bf16_f32 v110, 0, v110
  v_cvt_pk_bf16_f32 v111, 0, v111
  v_pk_mul_f32 v[108:109], v[108:109], v[116:117] op_sel:[0,1]
  v_pk_mul_f32 v[110:111], v[110:111], v[116:117] op_sel:[0,1]
  v_cvt_pk_bf16_f32 v223, v196, v108
  v_cvt_pk_bf16_f32 v227, v197, v109
  v_cvt_pk_bf16_f32 v231, v198, v110
  v_cvt_pk_bf16_f32 v235, v199, v111
  v_mfma_f32_16x16x32_bf16 v[132:135], v[168:171], v[220:223], v[132:135]
  v_mfma_f32_16x16x32_bf16 v[132:135], v[172:175], v[224:227], v[132:135]
  v_mfma_f32_16x16x32_bf16 v[132:135], v[176:179], v[228:231], v[132:135]
  v_mfma_f32_16x16x32_bf16 v[132:135], v[180:183], v[232:235], v[132:135]
  s_waitcnt vmcnt(14)
  buffer_load_dwordx4 v[24:27], v93, s[12:15], s61 offen offset:512 nt
  v_pk_fma_f32 v[108:109], v[52:53], s[92:93], v[116:117] op_sel_hi:[1,1,0] neg_lo:[0,0,1] neg_hi:[0,0,1]
  v_pk_fma_f32 v[110:111], v[54:55], s[92:93], v[116:117] op_sel_hi:[1,1,0] neg_lo:[0,0,1] neg_hi:[0,0,1]
  v_cvt_pk_bf16_f32 v108, 0, v108
  v_cvt_pk_bf16_f32 v109, 0, v109
  v_cvt_pk_bf16_f32 v110, 0, v110
  v_cvt_pk_bf16_f32 v111, 0, v111
  v_pk_mul_f32 v[108:109], v[108:109], v[116:117] op_sel:[0,1]
  v_pk_mul_f32 v[110:111], v[110:111], v[116:117] op_sel:[0,1]
  v_cvt_pk_bf16_f32 v239, v200, v108
  v_cvt_pk_bf16_f32 v243, v201, v109
  v_cvt_pk_bf16_f32 v247, v202, v110
  v_cvt_pk_bf16_f32 v251, v203, v111
  v_mfma_f32_16x16x32_bf16 v[136:139], v[168:171], v[236:239], v[136:139]
  v_mfma_f32_16x16x32_bf16 v[136:139], v[172:175], v[240:243], v[136:139]
  v_mfma_f32_16x16x32_bf16 v[136:139], v[176:179], v[244:247], v[136:139]
  v_mfma_f32_16x16x32_bf16 v[136:139], v[180:183], v[248:251], v[136:139]
  s_waitcnt vmcnt(14)
  s_cbranch_vccnz L_vw1_24
  s_waitcnt vmcnt(9)
L_vw1_24:
  buffer_load_dwordx4 v[28:31], v93, s[12:15], s61 offen offset:768 nt
  v_mov_b32_dpp v116, v114 row_newbcast:8 row_mask:0xf bank_mask:0xf
  v_mov_b32_dpp v117, v115 row_newbcast:8 row_mask:0xf bank_mask:0xf
  v_pk_fma_f32 v[192:193], v[56:57], s[92:93], v[116:117] op_sel_hi:[1,1,0] neg_lo:[0,0,1] neg_hi:[0,0,1]
  v_pk_fma_f32 v[194:195], v[58:59], s[92:93], v[116:117] op_sel_hi:[1,1,0] neg_lo:[0,0,1] neg_hi:[0,0,1]
  v_cvt_pk_bf16_f32 v192, 0, v192
  v_cndmask_b32 v184, 0, v163, s[72:73]
  v_cvt_pk_bf16_f32 v193, 0, v193
  v_cndmask_b32 v185, 0, v164, s[72:73]
  v_cvt_pk_bf16_f32 v194, 0, v194
  v_cndmask_b32 v186, 0, v163, s[74:75]
  v_cvt_pk_bf16_f32 v195, 0, v195
  v_cndmask_b32 v187, 0, v164, s[74:75]
  v_pk_mul_f32 v[192:193], v[192:193], v[116:117] op_sel:[0,1]
  v_cndmask_b32 v188, 0, v163, s[76:77]
  v_pk_mul_f32 v[194:195], v[194:195], v[116:117] op_sel:[0,1]
  s_waitcnt vmcnt(14)
  buffer_load_dwordx4 v[32:35], v93, s[12:15], s61 offen offset:1024 nt
  v_pk_fma_f32 v[196:197], v[60:61], s[92:93], v[116:117] op_sel_hi:[1,1,0] neg_lo:[0,0,1] neg_hi:[0,0,1]
  v_pk_fma_f32 v[198:199], v[62:63], s[92:93], v[116:117] op_sel_hi:[1,1,0] neg_lo:[0,0,1] neg_hi:[0,0,1]
  v_cvt_pk_bf16_f32 v196, 0, v196
  v_cndmask_b32 v189, 0, v164, s[76:77]
  v_cvt_pk_bf16_f32 v197, 0, v197
  v_cndmask_b32 v190, 0, v163, s[78:79]
  v_cvt_pk_bf16_f32 v198, 0, v198
  v_cndmask_b32 v191, 0, v164, s[78:79]
  v_cvt_pk_bf16_f32 v199, 0, v199
  v_pk_mul_f32 v[196:197], v[196:197], v[116:117] op_sel:[0,1]
  v_pk_mul_f32 v[198:199], v[198:199], v[116:117] op_sel:[0,1]
  s_waitcnt vmcnt(14)
  buffer_load_dwordx4 v[36:39], v93, s[12:15], s61 offen offset:1280 nt
  v_pk_fma_f32 v[200:201], v[64:65], s[92:93], v[116:117] op_sel_hi:[1,1,0] neg_lo:[0,0,1] neg_hi:[0,0,1]
  v_pk_fma_f32 v[202:203], v[66:67], s[92:93], v[116:117] op_sel_hi:[1,1,0] neg_lo:[0,0,1] neg_hi:[0,0,1]
  v_cvt_pk_bf16_f32 v200, 0, v200
  v_cvt_pk_bf16_f32 v201, 0, v201
  v_cvt_pk_bf16_f32 v202, 0, v202
  v_cvt_pk_bf16_f32 v203, 0, v203
  v_pk_mul_f32 v[200:201], v[200:201], v[116:117] op_sel:[0,1]
  v_pk_mul_f32 v[202:203], v[202:203], v[116:117] op_sel:[0,1]
  s_waitcnt vmcnt(14)
  s_cbranch_vccnz L_vw1_27
  s_waitcnt vmcnt(9)
L_vw1_27:
  buffer_load_dwordx4 v[40:43], v93, s[12:15], s61 offen offset:1536 nt
  v_mov_b32_dpp v116, v114 row_newbcast:9 row_mask:0xf bank_mask:0xf
  v_mov_b32_dpp v117, v115 row_newbcast:9 row_mask:0xf bank_mask:0xf
  v_pk_fma_f32 v[108:109], v[68:69], s[92:93], v[116:117] op_sel_hi:[1,1,0] neg_lo:[0,0,1] neg_hi:[0,0,1]
  v_pk_fma_f32 v[110:111], v[70:71], s[92:93], v[116:117] op_sel_hi:[1,1,0] neg_lo:[0,0,1] neg_hi:[0,0,1]
  v_cvt_pk_bf16_f32 v108, 0, v108
  v_cvt_pk_bf16_f32 v109, 0, v109
  v_cvt_pk_bf16_f32 v110, 0, v110
  v_cvt_pk_bf16_f32 v111, 0, v111
  v_pk_mul_f32 v[108:109], v[108:109], v[116:117] op_sel:[0,1]
  v_pk_mul_f32 v[110:111], v[110:111], v[116:117] op_sel:[0,1]
  v_cvt_pk_bf16_f32 v204, v192, v108
  v_cvt_pk_bf16_f32 v208, v193, v109
  v_cvt_pk_bf16_f32 v212, v194, v110
  v_cvt_pk_bf16_f32 v216, v195, v111
  s_waitcnt vmcnt(14)
  buffer_load_dwordx4 v[44:47], v93, s[12:15], s61 offen offset:1792 nt
  v_pk_fma_f32 v[108:109], v[72:73], s[92:93], v[116:117] op_sel_hi:[1,1,0] neg_lo:[0,0,1] neg_hi:[0,0,1]
  v_pk_fma_f32 v[110:111], v[74:75], s[92:93], v[116:117] op_sel_hi:[1,1,0] neg_lo:[0,0,1] neg_hi:[0,0,1]
  v_cvt_pk_bf16_f32 v108, 0, v108
  v_cvt_pk_bf16_f32 v109, 0, v109
  v_cvt_pk_bf16_f32 v110, 0, v110
  v_cvt_pk_bf16_f32 v111, 0, v111
  v_pk_mul_f32 v[108:109], v[108:109], v[116:117] op_sel:[0,1]
  v_pk_mul_f32 v[110:111], v[110:111], v[116:117] op_sel:[0,1]
  v_cvt_pk_bf16_f32 v220, v196, v108
  v_cvt_pk_bf16_f32 v224, v197, v109
  v_cvt_pk_bf16_f32 v228, v198, v110
  v_cvt_pk_bf16_f32 v232, v199, v111
  s_waitcnt vmcnt(14)
  buffer_load_dwordx4 v[48:51], v93, s[12:15], s61 offen offset:2048 nt
  v_pk_fma_f32 v[108:109], v[76:77], s[92:93], v[116:117] op_sel_hi:[1,1,0] neg_lo:[0,0,1] neg_hi:[0,0,1]
  v_pk_fma_f32 v[110:111], v[78:79], s[92:93], v[116:117] op_sel_hi:[1,1,0] neg_lo:[0,0,1] neg_hi:[0,0,1]
  v_cvt_pk_bf16_f32 v108, 0, v108
  v_cvt_pk_bf16_f32 v109, 0, v109
  v_cvt_pk_bf16_f32 v110, 0, v110
  v_cvt_pk_bf16_f32 v111, 0, v111
  v_pk_mul_f32 v[108:109], v[108:109], v[116:117] op_sel:[0,1]
  v_pk_mul_f32 v[110:111], v[110:111], v[116:117] op_sel:[0,1]
  v_cvt_pk_bf16_f32 v236, v200, v108
  v_cvt_pk_bf16_f32 v240, v201, v109
  v_cvt_pk_bf16_f32 v244, v202, v110
  v_cvt_pk_bf16_f32 v248, v203, v111
  s_waitcnt vmcnt(14)
  s_cbranch_vccnz L_vw1_30
  s_waitcnt vmcnt(9)
L_vw1_30:
  buffer_load_dwordx4 v[52:55], v93, s[12:15], s61 offen offset:2304 nt
  v_mov_b32_dpp v116, v114 row_newbcast:10 row_mask:0xf bank_mask:0xf
  v_mov_b32_dpp v117, v115 row_newbcast:10 row_mask:0xf bank_mask:0xf
  v_pk_fma_f32 v[192:193], v[80:81], s[92:93], v[116:117] op_sel_hi:[1,1,0] neg_lo:[0,0,1] neg_hi:[0,0,1]
  v_pk_fma_f32 v[194:195], v[82:83], s[92:93], v[116:117] op_sel_hi:[1,1,0] neg_lo:[0,0,1] neg_hi:[0,0,1]
  v_cvt_pk_bf16_f32 v192, 0, v192
  v_cvt_pk_bf16_f32 v193, 0, v193
  v_cvt_pk_bf16_f32 v194, 0, v194
  v_cvt_pk_bf16_f32 v195, 0, v195
  v_pk_mul_f32 v[192:193], v[192:193], v[116:117] op_sel:[0,1]
  v_pk_mul_f32 v[194:195], v[194:195], v[116:117] op_sel:[0,1]
  v_cvt_pk_bf16_f32 v205, v192, 0
  v_cvt_pk_bf16_f32 v209, v193, 0
  v_cvt_pk_bf16_f32 v213, v194, 0
  v_cvt_pk_bf16_f32 v217, v195, 0
  v_mfma_f32_16x16x16_bf16 v[128:131], v[184:185], v[204:205], v[128:131]
  v_mfma_f32_16x16x16_bf16 v[128:131], v[186:187], v[208:209], v[128:131]
  v_mfma_f32_16x16x16_bf16 v[128:131], v[188:189], v[212:213], v[128:131]
  v_mfma_f32_16x16x16_bf16 v[128:131], v[190:191], v[216:217], v[128:131]
  s_waitcnt vmcnt(14)
  buffer_load_dwordx4 v[56:59], v93, s[12:15], s61 offen offset:2560 nt
  v_pk_fma_f32 v[196:197], v[84:85], s[92:93], v[116:117] op_sel_hi:[1,1,0] neg_lo:[0,0,1] neg_hi:[0,0,1]
  v_pk_fma_f32 v[198:199], v[86:87], s[92:93], v[116:117] op_sel_hi:[1,1,0] neg_lo:[0,0,1] neg_hi:[0,0,1]
  v_cvt_pk_bf16_f32 v196, 0, v196
  v_cvt_pk_bf16_f32 v197, 0, v197
  v_cvt_pk_bf16_f32 v198, 0, v198
  v_cvt_pk_bf16_f32 v199, 0, v199
  v_pk_mul_f32 v[196:197], v[196:197], v[116:117] op_sel:[0,1]
  v_pk_mul_f32 v[198:199], v[198:199], v[116:117] op_sel:[0,1]
  v_cvt_pk_bf16_f32 v221, v196, 0
  v_cvt_pk_bf16_f32 v225, v197, 0
  v_cvt_pk_bf16_f32 v229, v198, 0
  v_cvt_pk_bf16_f32 v233, v199, 0
  v_mfma_f32_16x16x16_bf16 v[132:135], v[184:185], v[220:221], v[132:135]
  v_mfma_f32_16x16x16_bf16 v[132:135], v[186:187], v[224:225], v[132:135]
  v_mfma_f32_16x16x16_bf16 v[132:135], v[188:189], v[228:229], v[132:135]
  v_mfma_f32_16x16x16_bf16 v[132:135], v[190:191], v[232:233], v[132:135]
  s_waitcnt vmcnt(14)
  buffer_load_dwordx4 v[60:63], v93, s[12:15], s61 offen offset:2816 nt
  v_pk_fma_f32 v[200:201], v[88:89], s[92:93], v[116:117] op_sel_hi:[1,1,0] neg_lo:[0,0,1] neg_hi:[0,0,1]
  v_pk_fma_f32 v[202:203], v[90:91], s[92:93], v[116:117] op_sel_hi:[1,1,0] neg_lo:[0,0,1] neg_hi:[0,0,1]
  v_cvt_pk_bf16_f32 v200, 0, v200
  v_cvt_pk_bf16_f32 v201, 0, v201
  v_cvt_pk_bf16_f32 v202, 0, v202
  v_cvt_pk_bf16_f32 v203, 0, v203
  v_pk_mul_f32 v[200:201], v[200:201], v[116:117] op_sel:[0,1]
  v_pk_mul_f32 v[202:203], v[202:203], v[116:117] op_sel:[0,1]
  v_cvt_pk_bf16_f32 v237, v200, 0
  v_cvt_pk_bf16_f32 v241, v201, 0
  v_cvt_pk_bf16_f32 v245, v202, 0
  v_cvt_pk_bf16_f32 v249, v203, 0
  v_mfma_f32_16x16x16_bf16 v[136:139], v[184:185], v[236:237], v[136:139]
  v_mfma_f32_16x16x16_bf16 v[136:139], v[186:187], v[240:241], v[136:139]
  v_mfma_f32_16x16x16_bf16 v[136:139], v[188:189], v[244:245], v[136:139]
  v_mfma_f32_16x16x16_bf16 v[136:139], v[190:191], v[248:249], v[136:139]
  s_mov_b32 s60, s61
  s_cmp_ge_u32 s64, 96
  s_cbranch_scc1 L_v_done
  s_cmp_eq_u32 s89, s88
  s_cbranch_scc1 L_v0
  s_mov_b32 s88, s89
  v_mov_b32 v145, v143
  s_nop 1
  v_permlane32_swap_b32 v143, v145
  v_add_f32 v143, v143, v145
  v_mov_b32 v145, v143
  s_nop 1
  v_permlane16_swap_b32 v143, v145
  v_add_f32 v143, v143, v145
  ds_write_b64 v103, v[142:143]
  ds_write_b128 v102, v[128:131] offset:0
  ds_write_b128 v102, v[132:135] offset:1024
  ds_write_b128 v102, v[136:139] offset:2048
  s_and_b32 s70, s86, 15
  s_cmp_ge_u32 s70, 12
  s_cselect_b32 s70, 2, 0
  s_and_b32 s71, s87, 1
  s_add_u32 s70, s70, s71
  s_lshr_b32 s71, s86, 4
  s_lshl2_add_u32 s70, s71, s70
  s_add_u32 s71, s3, 0
  s_cmp_eq_u32 s100, s71
  s_cselect_b32 s44, s70, s44
  s_add_u32 s71, s3, 2
  s_cmp_eq_u32 s100, s71
  s_cselect_b32 s45, s70, s45
  s_add_u32 s100, s100, 1
  s_waitcnt lgkmcnt(0)
  v_add_u32 v102, 6208, v102
  v_add_u32 v103, 6208, v103
  v_mov_b32 v128, 0
  v_mov_b32 v129, 0
  v_mov_b32 v130, 0
  v_mov_b32 v131, 0
  v_mov_b32 v132, 0
  v_mov_b32 v133, 0
  v_mov_b32 v134, 0
  v_mov_b32 v135, 0
  v_mov_b32 v136, 0
  v_mov_b32 v137, 0
  v_mov_b32 v138, 0
  v_mov_b32 v139, 0
  v_mov_b32 v140, 0xff800000
  v_mov_b32 v142, 0x7f800000
  v_mov_b32 v143, 0
  s_branch L_v0
L_v_done:
  v_mov_b32 v144, 61704
  ds_read_b32 v140, v144
  v_lshlrev_b32 v147, 4, v0
  s_mul_i32 s70, s3, 6208
  v_add_u32 v148, s70, v147
  s_add_u32 s70, s70, 43008
  v_lshrrev_b32 v146, 1, v101
  v_add_u32 v149, s70, v146
  v_add_u32 v150, 12416, v149
  v_mov_b32 v145, v143
  s_nop 1
  v_permlane32_swap_b32 v143, v145
  v_add_f32 v143, v143, v145
  v_mov_b32 v145, v143
  s_nop 1
  v_permlane16_swap_b32 v143, v145
  v_add_f32 v143, v143, v145
  ds_write_b64 v103, v[142:143]
  ds_write_b128 v102, v[128:131] offset:0
  ds_write_b128 v102, v[132:135] offset:1024
  ds_write_b128 v102, v[136:139] offset:2048
  s_and_b32 s70, s86, 15
  s_cmp_ge_u32 s70, 12
  s_cselect_b32 s70, 2, 0
  s_and_b32 s71, s87, 1
  s_add_u32 s70, s70, s71
  s_lshr_b32 s71, s86, 4
  s_lshl2_add_u32 s70, s71, s70
  s_add_u32 s71, s3, 0
  s_cmp_eq_u32 s100, s71
  s_cselect_b32 s44, s70, s44
  s_add_u32 s71, s3, 2
  s_cmp_eq_u32 s100, s71
  s_cselect_b32 s45, s70, s45
  s_add_u32 s100, s100, 1
  s_waitcnt lgkmcnt(0)
  s_waitcnt vmcnt(0)
  s_barrier
  ds_read2_b64 v[4:7], v149 offset1:4
  ds_read_b128 v[168:171], v148 offset:36864
  ds_read_b128 v[172:175], v148 offset:37888
  ds_read_b128 v[176:179], v148 offset:38912
  ds_read_b128 v[180:183], v148 offset:39936
  ds_read_b128 v[184:187], v148 offset:40960
  ds_read_b128 v[188:191], v148 offset:41984
  ds_read2_b64 v[8:11], v150 offset1:4
  ds_read_b128 v[192:195], v148 offset:49280
  ds_read_b128 v[196:199], v148 offset:50304
  ds_read_b128 v[200:203], v148 offset:51328
  ds_read_b128 v[204:207], v148 offset:52352
  ds_read_b128 v[208:211], v148 offset:53376
  ds_read_b128 v[212:215], v148 offset:54400
  s_mov_b32 s100, -1
  s_add_u32 s97, s4, 1
  s_waitcnt lgkmcnt(7)
  v_min_f32 v28, v4, v6
  v_sub_f32 v4, v28, v4
  v_sub_f32 v6, v28, v6
  v_exp_f32 v4, v4
  v_exp_f32 v6, v6
  v_mul_f32 v12, v4, v168
  v_fma_f32 v12, v6, v180, v12
  v_mul_f32 v13, v4, v169
  v_fma_f32 v13, v6, v181, v13
  v_mul_f32 v14, v4, v170
  v_fma_f32 v14, v6, v182, v14
  v_mul_f32 v16, v4, v171
  v_fma_f32 v16, v6, v183, v16
  v_mul_f32 v17, v4, v172
  v_fma_f32 v17, v6, v184, v17
  v_mul_f32 v18, v4, v173
  v_fma_f32 v18, v6, v185, v18
  v_mul_f32 v20, v4, v174
  v_fma_f32 v20, v6, v186, v20
  v_mul_f32 v21, v4, v175
  v_fma_f32 v21, v6, v187, v21
  v_mul_f32 v22, v4, v176
  v_fma_f32 v22, v6, v188, v22
  v_mul_f32 v24, v4, v177
  v_fma_f32 v24, v6, v189, v24
  v_mul_f32 v25, v4, v178
  v_fma_f32 v25, v6, v190, v25
  v_mul_f32 v26, v4, v179
  v_fma_f32 v26, v6, v191, v26
  v_mul_f32 v29, v4, v5
  v_fma_f32 v29, v6, v7, v29
  s_bfe_u32 s70, s44, 0x20001
  s_cmp_eq_u32 s70, s97
  s_cbranch_scc1 L_own0
  v_mov_b32 v15, v140
  v_mov_b32 v19, v140
  v_mov_b32 v23, v140
  v_mov_b32 v27, v140
  v_mov_b32 v31, v140
  s_mul_i32 s70, s44, 5120
  s_add_u32 s70, s70, 1048576
  s_add_u32 s71, s70, 4096
  buffer_store_dwordx4 v[12:15], v147, s[40:43], s70 offen offset:0 sc1
  buffer_store_dwordx4 v[16:19], v147, s[40:43], s70 offen offset:1024 sc1
  buffer_store_dwordx4 v[20:23], v147, s[40:43], s70 offen offset:2048 sc1
  buffer_store_dwordx4 v[24:27], v147, s[40:43], s70 offen offset:3072 sc1
  buffer_store_dwordx4 v[28:31], v147, s[40:43], s71 offen offset:0 sc1
  s_branch L_pub0
L_own0:
  v_mov_b32 v52, v12
  v_mov_b32 v53, v13
  v_mov_b32 v54, v14
  v_mov_b32 v56, v16
  v_mov_b32 v57, v17
  v_mov_b32 v58, v18
  v_mov_b32 v60, v20
  v_mov_b32 v61, v21
  v_mov_b32 v62, v22
  v_mov_b32 v64, v24
  v_mov_b32 v65, v25
  v_mov_b32 v66, v26
  v_mov_b32 v68, v28
  v_mov_b32 v69, v29
  s_mov_b32 s100, s44
L_pub0:
  s_waitcnt lgkmcnt(0)
  v_min_f32 v48, v8, v10
  v_sub_f32 v8, v48, v8
  v_sub_f32 v10, v48, v10
  v_exp_f32 v8, v8
  v_exp_f32 v10, v10
  v_mul_f32 v32, v8, v192
  v_fma_f32 v32, v10, v204, v32
  v_mul_f32 v33, v8, v193
  v_fma_f32 v33, v10, v205, v33
  v_mul_f32 v34, v8, v194
  v_fma_f32 v34, v10, v206, v34
  v_mul_f32 v36, v8, v195
  v_fma_f32 v36, v10, v207, v36
  v_mul_f32 v37, v8, v196
  v_fma_f32 v37, v10, v208, v37
  v_mul_f32 v38, v8, v197
  v_fma_f32 v38, v10, v209, v38
  v_mul_f32 v40, v8, v198
  v_fma_f32 v40, v10, v210, v40
  v_mul_f32 v41, v8, v199
  v_fma_f32 v41, v10, v211, v41
  v_mul_f32 v42, v8, v200
  v_fma_f32 v42, v10, v212, v42
  v_mul_f32 v44, v8, v201
  v_fma_f32 v44, v10, v213, v44
  v_mul_f32 v45, v8, v202
  v_fma_f32 v45, v10, v214, v45
  v_mul_f32 v46, v8, v203
  v_fma_f32 v46, v10, v215, v46
  v_mul_f32 v49, v8, v9
  v_fma_f32 v49, v10, v11, v49
  s_bfe_u32 s70, s45, 0x20001
  s_cmp_eq_u32 s70, s97
  s_cbranch_scc1 L_own1
  v_mov_b32 v35, v140
  v_mov_b32 v39, v140
  v_mov_b32 v43, v140
  v_mov_b32 v47, v140
  v_mov_b32 v51, v140
  s_mul_i32 s70, s45, 5120
  s_add_u32 s70, s70, 1048576
  s_add_u32 s71, s70, 4096
  buffer_store_dwordx4 v[32:35], v147, s[40:43], s70 offen offset:0 sc1
  buffer_store_dwordx4 v[36:39], v147, s[40:43], s70 offen offset:1024 sc1
  buffer_store_dwordx4 v[40:43], v147, s[40:43], s70 offen offset:2048 sc1
  buffer_store_dwordx4 v[44:47], v147, s[40:43], s70 offen offset:3072 sc1
  buffer_store_dwordx4 v[48:51], v147, s[40:43], s71 offen offset:0 sc1
  s_branch L_pub1
L_own1:
  v_mov_b32 v52, v32
  v_mov_b32 v53, v33
  v_mov_b32 v54, v34
  v_mov_b32 v56, v36
  v_mov_b32 v57, v37
  v_mov_b32 v58, v38
  v_mov_b32 v60, v40
  v_mov_b32 v61, v41
  v_mov_b32 v62, v42
  v_mov_b32 v64, v44
  v_mov_b32 v65, v45
  v_mov_b32 v66, v46
  v_mov_b32 v68, v48
  v_mov_b32 v69, v49
  s_mov_b32 s100, s45
L_pub1:
  s_cmp_eq_u32 s100, -1
  s_cbranch_scc1 L_fin
  s_xor_b32 s84, s100, 1
  s_andn2_b32 s86, s100, 1
  s_xor_b32 s86, s86, 2
  s_add_u32 s88, s86, 1
  s_mul_i32 s84, s84, 5120
  s_add_u32 s84, s84, 1048576
  s_add_u32 s85, s84, 4096
  s_mul_i32 s86, s86, 5120
  s_add_u32 s86, s86, 1048576
  s_add_u32 s87, s86, 4096
  s_mul_i32 s88, s88, 5120
  s_add_u32 s88, s88, 1048576
  s_add_u32 s89, s88, 4096
  s_mov_b32 s64, 0
  s_mov_b32 s90, 7
L_gather:
  s_bitcmp0_b32 s90, 0
  s_cbranch_scc1 L_have0
  buffer_load_dwordx4 v[168:171], v147, s[40:43], s84 offen offset:0 sc1
  buffer_load_dwordx4 v[172:175], v147, s[40:43], s84 offen offset:1024 sc1
  buffer_load_dwordx4 v[176:179], v147, s[40:43], s84 offen offset:2048 sc1
  buffer_load_dwordx4 v[180:183], v147, s[40:43], s84 offen offset:3072 sc1
  buffer_load_dwordx4 v[184:187], v147, s[40:43], s85 offen offset:0 sc1
L_have0:
  s_bitcmp0_b32 s90, 1
  s_cbranch_scc1 L_have1
  buffer_load_dwordx4 v[188:191], v147, s[40:43], s86 offen offset:0 sc1
  buffer_load_dwordx4 v[192:195], v147, s[40:43], s86 offen offset:1024 sc1
  buffer_load_dwordx4 v[196:199], v147, s[40:43], s86 offen offset:2048 sc1
  buffer_load_dwordx4 v[200:203], v147, s[40:43], s86 offen offset:3072 sc1
  buffer_load_dwordx4 v[204:207], v147, s[40:43], s87 offen offset:0 sc1
L_have1:
  s_bitcmp0_b32 s90, 2
  s_cbranch_scc1 L_have2
  buffer_load_dwordx4 v[208:211], v147, s[40:43], s88 offen offset:0 sc1
  buffer_load_dwordx4 v[212:215], v147, s[40:43], s88 offen offset:1024 sc1
  buffer_load_dwordx4 v[216:219], v147, s[40:43], s88 offen offset:2048 sc1
  buffer_load_dwordx4 v[220:223], v147, s[40:43], s88 offen offset:3072 sc1
  buffer_load_dwordx4 v[224:227], v147, s[40:43], s89 offen offset:0 sc1
L_have2:
  s_mov_b32 s90, 0
  s_waitcnt vmcnt(0)
  v_min3_u32 v144, v171, v175, v179
  v_max3_u32 v145, v171, v175, v179
  v_min3_u32 v144, v144, v183, v187
  v_max3_u32 v145, v145, v183, v187
  v_cmp_ne_u32 s[70:71], v140, v144
  v_cmp_ne_u32 vcc, v140, v145
  s_nop 1
  s_or_b64 s[70:71], s[70:71], vcc
  s_cselect_b32 s70, 1, 0
  s_or_b32 s90, s90, s70
  v_min3_u32 v144, v191, v195, v199
  v_max3_u32 v145, v191, v195, v199
  v_min3_u32 v144, v144, v203, v207
  v_max3_u32 v145, v145, v203, v207
  v_cmp_ne_u32 s[70:71], v140, v144
  v_cmp_ne_u32 vcc, v140, v145
  s_nop 1
  s_or_b64 s[70:71], s[70:71], vcc
  s_cselect_b32 s70, 2, 0
  s_or_b32 s90, s90, s70
  v_min3_u32 v144, v211, v215, v219
  v_max3_u32 v145, v211, v215, v219
  v_min3_u32 v144, v144, v223, v227
  v_max3_u32 v145, v145, v223, v227
  v_cmp_ne_u32 s[70:71], v140, v144
  v_cmp_ne_u32 vcc, v140, v145
  s_nop 1
  s_or_b64 s[70:71], s[70:71], vcc
  s_cselect_b32 s70, 4, 0
  s_or_b32 s90, s90, s70
  s_cbranch_scc0 L_gathered
  s_add_u32 s64, s64, 1
  s_cmp_lt_u32 s64, 20000
  s_cbranch_scc1 L_gather
  s_endpgm
L_gathered:
  v_min_f32 v144, v68, v184
  v_min3_f32 v144, v144, v204, v224
  v_sub_f32 v68, v144, v68
  v_sub_f32 v184, v144, v184
  v_sub_f32 v204, v144, v204
  v_sub_f32 v224, v144, v224
  v_exp_f32 v68, v68
  v_exp_f32 v184, v184
  v_exp_f32 v204, v204
  v_exp_f32 v224, v224
  v_mul_u32_u24 v146, 24, v101
  v_and_b32 v144, 15, v0
  v_lshl_add_u32 v146, v144, 3, v146
  s_lshr_b32 s70, s100, 2
  s_mul_i32 s70, s70, 1536
  v_mul_f32 v69, v68, v69
  v_mul_f32 v185, v184, v185
  v_mul_f32 v205, v204, v205
  v_mul_f32 v225, v224, v225
  v_add_f32 v69, v69, v185
  v_add_f32 v205, v205, v225
  v_add_f32 v69, v69, v205
  v_rcp_f32 v145, v69
  v_mul_f32 v52, v68, v52
  v_mul_f32 v168, v184, v168
  v_mul_f32 v188, v204, v188
  v_mul_f32 v208, v224, v208
  v_add_f32 v52, v52, v168
  v_add_f32 v188, v188, v208
  v_add_f32 v52, v52, v188
  v_mul_f32 v52, v145, v52
  v_mul_f32 v53, v68, v53
  v_mul_f32 v169, v184, v169
  v_mul_f32 v189, v204, v189
  v_mul_f32 v209, v224, v209
  v_add_f32 v53, v53, v169
  v_add_f32 v189, v189, v209
  v_add_f32 v53, v53, v189
  v_mul_f32 v53, v145, v53
  v_mul_f32 v54, v68, v54
  v_mul_f32 v170, v184, v170
  v_mul_f32 v190, v204, v190
  v_mul_f32 v210, v224, v210
  v_add_f32 v54, v54, v170
  v_add_f32 v190, v190, v210
  v_add_f32 v54, v54, v190
  v_mul_f32 v54, v145, v54
  v_mul_f32 v56, v68, v56
  v_mul_f32 v172, v184, v172
  v_mul_f32 v192, v204, v192
  v_mul_f32 v212, v224, v212
  v_add_f32 v56, v56, v172
  v_add_f32 v192, v192, v212
  v_add_f32 v56, v56, v192
  v_mul_f32 v56, v145, v56
  v_cvt_pk_bf16_f32 v128, v52, v53
  v_cvt_pk_bf16_f32 v129, v54, v56
  buffer_store_dwordx2 v[128:129], v146, s[36:39], s70 offen offset:0
  v_mul_f32 v57, v68, v57
  v_mul_f32 v173, v184, v173
  v_mul_f32 v193, v204, v193
  v_mul_f32 v213, v224, v213
  v_add_f32 v57, v57, v173
  v_add_f32 v193, v193, v213
  v_add_f32 v57, v57, v193
  v_mul_f32 v57, v145, v57
  v_mul_f32 v58, v68, v58
  v_mul_f32 v174, v184, v174
  v_mul_f32 v194, v204, v194
  v_mul_f32 v214, v224, v214
  v_add_f32 v58, v58, v174
  v_add_f32 v194, v194, v214
  v_add_f32 v58, v58, v194
  v_mul_f32 v58, v145, v58
  v_mul_f32 v60, v68, v60
  v_mul_f32 v176, v184, v176
  v_mul_f32 v196, v204, v196
  v_mul_f32 v216, v224, v216
  v_add_f32 v60, v60, v176
  v_add_f32 v196, v196, v216
  v_add_f32 v60, v60, v196
  v_mul_f32 v60, v145, v60
  v_mul_f32 v61, v68, v61
  v_mul_f32 v177, v184, v177
  v_mul_f32 v197, v204, v197
  v_mul_f32 v217, v224, v217
  v_add_f32 v61, v61, v177
  v_add_f32 v197, v197, v217
  v_add_f32 v61, v61, v197
  v_mul_f32 v61, v145, v61
  v_cvt_pk_bf16_f32 v130, v57, v58
  v_cvt_pk_bf16_f32 v131, v60, v61
  buffer_store_dwordx2 v[130:131], v146, s[36:39], s70 offen offset:128
  v_mul_f32 v62, v68, v62
  v_mul_f32 v178, v184, v178
  v_mul_f32 v198, v204, v198
  v_mul_f32 v218, v224, v218
  v_add_f32 v62, v62, v178
  v_add_f32 v198, v198, v218
  v_add_f32 v62, v62, v198
  v_mul_f32 v62, v145, v62
  v_mul_f32 v64, v68, v64
  v_mul_f32 v180, v184, v180
  v_mul_f32 v200, v204, v200
  v_mul_f32 v220, v224, v220
  v_add_f32 v64, v64, v180
  v_add_f32 v200, v200, v220
  v_add_f32 v64, v64, v200
  v_mul_f32 v64, v145, v64
  v_mul_f32 v65, v68, v65
  v_mul_f32 v181, v184, v181
  v_mul_f32 v201, v204, v201
  v_mul_f32 v221, v224, v221
  v_add_f32 v65, v65, v181
  v_add_f32 v201, v201, v221
  v_add_f32 v65, v65, v201
  v_mul_f32 v65, v145, v65
  v_mul_f32 v66, v68, v66
  v_mul_f32 v182, v184, v182
  v_mul_f32 v202, v204, v202
  v_mul_f32 v222, v224, v222
  v_add_f32 v66, v66, v182
  v_add_f32 v202, v202, v222
  v_add_f32 v66, v66, v202
  v_mul_f32 v66, v145, v66
  v_cvt_pk_bf16_f32 v132, v62, v64
  v_cvt_pk_bf16_f32 v133, v65, v66
  buffer_store_dwordx2 v[132:133], v146, s[36:39], s70 offen offset:256
L_fin:
L_end:
  s_endpgm
L_helper:
  v_lshlrev_b32 v1, 2, v0
  v_add_u32 v1, 61696, v1
  v_mov_b32 v2, 0
  s_mov_b64 exec, 0xff
  ds_write_b32 v1, v2
  s_mov_b64 exec, -1
  s_waitcnt lgkmcnt(0)
  s_mov_b32 s8, s46
  s_and_b32 s9, s47, 0xffff
  s_mov_b32 s36, s44
  s_and_b32 s37, s45, 0xffff
  s_mov_b32 s16, s46
  s_and_b32 s17, s47, 0xffff
  s_mov_b32 s12, s48
  s_and_b32 s13, s49, 0xffff
  s_mov_b32 s40, s82
  s_and_b32 s41, s83, 0xffff
  s_barrier
  s_memrealtime s[72:73]
  s_getpc_b64 s[54:55]
L_h_pc:
  s_add_u32 s86, s54, L_h_cp - L_h_pc
  s_addc_u32 s87, s55, 0
  s_sub_u32 s54, s54, L_h_pc - L_k
  s_subb_u32 s55, s55, 0
  s_and_b32 s54, s54, -16
  s_lshr_b32 s70, s2, 3
  s_lshl_b32 s70, s70, 10
  v_lshl_add_u32 v106, v0, 4, s70
  v_mov_b32 v107, s55
  v_add_co_u32 v106, vcc, s54, v106
  s_nop 1
  v_addc_co_u32 v107, vcc, 0, v107, vcc
  s_lshr_b32 s70, s2, 3
  s_cmp_lt_u32 s70, (L_code_end - L_k) / 1024
  s_cbranch_scc0 L_h_cta
  global_load_dwordx4 v[108:111], v[106:107], off
L_h_cta:
  s_lshr_b32 s70, s2, 4
  s_and_b32 s70, s70, 8
  s_and_b32 s71, s2, 7
  s_add_u32 s70, s70, s71
  s_lshl_b32 s70, s70, 4
  v_lshl_add_u32 v104, v0, 3, s70
  v_and_b32 v105, 31, v0
  v_lshlrev_b32 v105, 3, v105
  v_and_b32 v112, 1, v0
  v_lshlrev_b32 v112, 2, v112
  v_add_u32 v112, 61712, v112
  v_mov_b32 v113, 0
  v_lshlrev_b32 v3, 4, v0
  s_mov_b32 s76, 12
  s_mov_b32 s77, 7340032
  s_getreg_b32 s50, hwreg(HW_REG_XCC_ID)
  s_bfe_u32 s50, s50, 0x10002
  s_bfe_u32 s52, s2, 0x30003
  s_cmp_eq_u32 s52, 7
  s_cbranch_scc1 L_h_voted
  s_lshr_b32 s70, s2, 6
  s_xor_b32 s70, s70, s2
  s_and_b32 s70, s70, 3
  s_cbranch_scc1 L_h_voted
  s_cmp_eq_u32 s52, 6
  s_cbranch_scc0 L_h_probe
  s_xor_b32 s48, s50, s4
  s_and_b32 s52, s2, 3
  s_lshl2_add_u32 s52, s52, 36
  s_branch L_h_vote
L_h_probe:
  s_cmp_ge_u32 s52, 3
  s_cselect_b32 s16, s12, s8
  s_cselect_b32 s17, s13, s9
  s_cselect_b32 s70, 3, 0
  s_sub_u32 s70, s52, s70
  s_lshl_b32 s70, s70, 28
  s_add_u32 s44, s5, s4
  s_lshl_b32 s44, s44, 16
  s_add_u32 s44, s44, s70
  s_add_u32 s44, s44, 0x1c0000
  s_mul_i32 s70, s2, 0x2a95
  s_and_b32 s70, s70, 0x7f80
  s_add_u32 s44, s44, s70
  s_add_u32 s70, s44, 0x8000
  s_buffer_load_dword s58, s[16:19], s70
  s_mov_b32 s45, -1
  s_mov_b32 s46, -1
  s_mul_i32 s52, s52, 6
L_h_progp:
  s_sleep 2
  ds_read_b32 v8, v112
  s_waitcnt lgkmcnt(0)
  v_cmp_gt_u32 vcc, 1, v8
  s_nop 1
  s_cmp_lg_u32 vcc_lo, 0
  s_cbranch_scc1 L_h_progp
  s_xor_b32 s70, s44, 0
  s_memtime s[54:55]
  s_waitcnt lgkmcnt(0)
  s_buffer_load_dword s58, s[16:19], s70
  s_waitcnt lgkmcnt(0)
  s_memtime s[56:57]
  s_waitcnt lgkmcnt(0)
  s_sub_u32 s56, s56, s54
  s_min_u32 s45, s45, s56
  s_xor_b32 s70, s44, 8192
  s_memtime s[54:55]
  s_waitcnt lgkmcnt(0)
  s_buffer_load_dword s58, s[16:19], s70
  s_waitcnt lgkmcnt(0)
  s_memtime s[56:57]
  s_waitcnt lgkmcnt(0)
  s_sub_u32 s56, s56, s54
  s_min_u32 s46, s46, s56
  s_xor_b32 s70, s44, 25472
  s_memtime s[54:55]
  s_waitcnt lgkmcnt(0)
  s_buffer_load_dword s58, s[16:19], s70
  s_waitcnt lgkmcnt(0)
  s_memtime s[56:57]
  s_waitcnt lgkmcnt(0)
  s_sub_u32 s56, s56, s54
  s_min_u32 s46, s46, s56
  s_xor_b32 s70, s44, 17280
  s_memtime s[54:55]
  s_waitcnt lgkmcnt(0)
  s_buffer_load_dword s58, s[16:19], s70
  s_waitcnt lgkmcnt(0)
  s_memtime s[56:57]
  s_waitcnt lgkmcnt(0)
  s_sub_u32 s56, s56, s54
  s_min_u32 s45, s45, s56
  s_xor_b32 s70, s44, 5888
  s_memtime s[54:55]
  s_waitcnt lgkmcnt(0)
  s_buffer_load_dword s58, s[16:19], s70
  s_waitcnt lgkmcnt(0)
  s_memtime s[56:57]
  s_waitcnt lgkmcnt(0)
  s_sub_u32 s56, s56, s54
  s_min_u32 s45, s45, s56
  s_xor_b32 s70, s44, 14080
  s_memtime s[54:55]
  s_waitcnt lgkmcnt(0)
  s_buffer_load_dword s58, s[16:19], s70
  s_waitcnt lgkmcnt(0)
  s_memtime s[56:57]
  s_waitcnt lgkmcnt(0)
  s_sub_u32 s56, s56, s54
  s_min_u32 s46, s46, s56
  s_cmp_lt_u32 s46, s45
  s_cselect_b32 s48, 1, 0
  s_lshr_b32 s70, s44, 13
  s_xor_b32 s70, s70, s2
  s_xor_b32 s70, s70, s50
  s_and_b32 s70, s70, 1
  s_xor_b32 s48, s48, s70
L_h_vote:
  s_mov_b32 s49, 0
  s_lshl_b64 s[48:49], s[48:49], s52
  s_or_b32 s49, s49, 0x1000000
  s_atomic_add_x2 s[48:49], s[80:81], 0
L_h_voted:
  s_waitcnt lgkmcnt(0)
  s_cmp_lg_u32 s2, 56
  s_cbranch_scc1 L_h_nonce
  s_lshl_b64 s[54:55], s[72:73], 2
  s_atomic_add_x2 s[54:55], s[80:81], 8
  s_waitcnt lgkmcnt(0)
L_h_nonce:
L_h_progv:
  s_sleep 8
  ds_read_b32 v8, v112
  s_waitcnt lgkmcnt(0)
  v_cmp_gt_u32 vcc, 6, v8
  s_nop 1
  s_cmp_lg_u32 vcc_lo, 0
  s_cbranch_scc1 L_h_progv
  s_load_dwordx2 s[48:49], s[80:81], 0
  s_mov_b32 s59, 0
L_h_votes:
  s_waitcnt lgkmcnt(0)
  s_lshr_b32 s70, s49, 24
  s_cmp_eq_u32 s70, 56
  s_cbranch_scc1 L_h_votes_done
  s_add_u32 s59, s59, 1
  s_cmp_gt_u32 s59, 2000
  s_cbranch_scc1 L_h_votes_done
  s_sleep 64
  s_mov_b64 s[48:49], 0
  s_atomic_or_x2 s[48:49], s[80:81], 0 glc
  s_branch L_h_votes
L_h_votes_done:
  s_mov_b32 s96, 0x80
  s_bfe_u64 s[54:55], s[48:49], 0x60000
  s_cmp_gt_u32 s54, 4
  s_cselect_b32 s56, 1, 0
  s_or_b32 s96, s96, s56
  s_bfe_u64 s[54:55], s[48:49], 0x60006
  s_cmp_gt_u32 s54, 4
  s_cselect_b32 s56, 2, 0
  s_or_b32 s96, s96, s56
  s_bfe_u64 s[54:55], s[48:49], 0x6000c
  s_cmp_gt_u32 s54, 4
  s_cselect_b32 s56, 4, 0
  s_or_b32 s96, s96, s56
  s_bfe_u64 s[54:55], s[48:49], 0x60012
  s_cmp_gt_u32 s54, 4
  s_cselect_b32 s56, 8, 0
  s_or_b32 s96, s96, s56
  s_bfe_u64 s[54:55], s[48:49], 0x60018
  s_cmp_gt_u32 s54, 4
  s_cselect_b32 s56, 16, 0
  s_or_b32 s96, s96, s56
  s_bfe_u64 s[54:55], s[48:49], 0x6001e
  s_cmp_gt_u32 s54, 4
  s_cselect_b32 s56, 32, 0
  s_or_b32 s96, s96, s56
  s_and_b32 s70, s2, 3
  s_lshl2_add_u32 s70, s70, 5
  s_lshr_b32 s54, s49, s70
  s_xor_b32 s54, s54, s2
  s_xor_b32 s54, s54, s4
  s_and_b32 s54, s54, 1
  s_mul_i32 s54, s54, 63
  s_xor_b32 s96, s96, s54
  v_mov_b32 v1, 61696
  v_mov_b32 v5, s96
  ds_write_b32 v1, v5
  s_load_dwordx2 s[74:75], s[80:81], 8
  s_mov_b32 s59, 0
L_h_getnonce:
  s_waitcnt lgkmcnt(0)
  s_cmp_lg_u64 s[74:75], 0
  s_cbranch_scc1 L_h_gotnonce
  s_add_u32 s59, s59, 1
  s_cmp_gt_u32 s59, 2000
  s_cbranch_scc1 L_h_gotnonce
  s_sleep 64
  s_atomic_or_x2 s[74:75], s[80:81], 8 glc
  s_branch L_h_getnonce
L_h_gotnonce:
  s_lshr_b64 s[54:55], s[74:75], 2
  v_mov_b32 v1, 61704
  v_mov_b32 v5, s54
  ds_write_b32 v1, v5
  s_lshl_b32 s62, s2, 8
  s_add_u32 s62, s62, 7405568
  s_xor_b32 s63, s62, 1024
  s_lshr_b32 s58, s96, 3
  s_xor_b32 s58, s58, s96
  s_lshr_b32 s70, s5, 4
  s_lshr_b32 s44, s70, 5
  s_lshl_b32 s44, s44, 21
  s_add_u32 s44, s44, 8388608
  s_and_b32 s64, s70, 31
  s_add_u32 s70, s64, s4
  s_lshl_b32 s70, s70, 10
  s_add_u32 s60, s44, s70
  s_xor_b32 s61, s60, 1024
  s_mov_b32 s78, 60
  s_swappc_b64 s[84:85], s[86:87]
L_h_proga:
  s_sleep 4
  ds_read_b32 v8, v112
  s_waitcnt lgkmcnt(0)
  v_cmp_gt_u32 vcc, 64, v8
  s_nop 1
  s_cmp_lg_u32 vcc_lo, 0
  s_cbranch_scc1 L_h_proga
  ds_read_b128 v[8:11], v3 offset:0
  ds_read_b128 v[12:15], v3 offset:1024
  ds_read_b128 v[16:19], v3 offset:2048
  s_waitcnt lgkmcnt(0)
  s_xor_b32 s70, s60, 0
  buffer_store_dwordx4 v[8:11], v3, s[40:43], s70 offen sc1
  s_xor_b32 s70, s60, 32768
  buffer_store_dwordx4 v[12:15], v3, s[40:43], s70 offen sc1
  s_xor_b32 s70, s60, 65536
  buffer_store_dwordx4 v[16:19], v3, s[40:43], s70 offen sc1
  s_bitcmp0_b32 s58, 2
  s_cbranch_scc1 L_h_e0
  ds_read_b128 v[20:23], v3 offset:3072
  ds_read_b128 v[24:27], v3 offset:4096
  ds_read_b128 v[28:31], v3 offset:5120
  ds_read_b128 v[32:35], v3 offset:6144
  ds_read_b128 v[36:39], v3 offset:7168
  ds_read_b128 v[40:43], v3 offset:8192
  ds_read_b128 v[44:47], v3 offset:9216
  ds_read_b128 v[48:51], v3 offset:10240
  ds_read_b128 v[52:55], v3 offset:11264
  s_waitcnt lgkmcnt(0)
  s_xor_b32 s70, s60, 98304
  buffer_store_dwordx4 v[20:23], v3, s[40:43], s70 offen sc1
  s_xor_b32 s70, s60, 132096
  buffer_store_dwordx4 v[24:27], v3, s[40:43], s70 offen sc1
  s_xor_b32 s70, s60, 164864
  buffer_store_dwordx4 v[28:31], v3, s[40:43], s70 offen sc1
  s_xor_b32 s70, s60, 197632
  buffer_store_dwordx4 v[32:35], v3, s[40:43], s70 offen sc1
  s_xor_b32 s70, s60, 230400
  buffer_store_dwordx4 v[36:39], v3, s[40:43], s70 offen sc1
  s_xor_b32 s70, s60, 264192
  buffer_store_dwordx4 v[40:43], v3, s[40:43], s70 offen sc1
  s_xor_b32 s70, s60, 296960
  buffer_store_dwordx4 v[44:47], v3, s[40:43], s70 offen sc1
  s_xor_b32 s70, s60, 329728
  buffer_store_dwordx4 v[48:51], v3, s[40:43], s70 offen sc1
  s_xor_b32 s70, s60, 362496
  buffer_store_dwordx4 v[52:55], v3, s[40:43], s70 offen sc1
L_h_e0:
  s_bitcmp0_b32 s58, 0
  s_cbranch_scc1 L_h_e1
  ds_read_b128 v[56:59], v3 offset:12288
  ds_read_b128 v[60:63], v3 offset:13312
  ds_read_b128 v[64:67], v3 offset:14336
  ds_read_b128 v[68:71], v3 offset:15360
  ds_read_b128 v[72:75], v3 offset:16384
  ds_read_b128 v[76:79], v3 offset:17408
  ds_read_b128 v[80:83], v3 offset:18432
  ds_read_b128 v[84:87], v3 offset:19456
  ds_read_b128 v[88:91], v3 offset:20480
  ds_read_b128 v[92:95], v3 offset:21504
  ds_read_b128 v[96:99], v3 offset:22528
  ds_read_b128 v[100:103], v3 offset:23552
  s_waitcnt lgkmcnt(0)
  s_xor_b32 s70, s60, 396288
  buffer_store_dwordx4 v[56:59], v3, s[40:43], s70 offen sc1
  s_xor_b32 s70, s60, 429056
  buffer_store_dwordx4 v[60:63], v3, s[40:43], s70 offen sc1
  s_xor_b32 s70, s60, 461824
  buffer_store_dwordx4 v[64:67], v3, s[40:43], s70 offen sc1
  s_xor_b32 s70, s60, 494592
  buffer_store_dwordx4 v[68:71], v3, s[40:43], s70 offen sc1
  s_xor_b32 s70, s60, 541696
  buffer_store_dwordx4 v[72:75], v3, s[40:43], s70 offen sc1
  s_xor_b32 s70, s60, 574464
  buffer_store_dwordx4 v[76:79], v3, s[40:43], s70 offen sc1
  s_xor_b32 s70, s60, 607232
  buffer_store_dwordx4 v[80:83], v3, s[40:43], s70 offen sc1
  s_xor_b32 s70, s60, 640000
  buffer_store_dwordx4 v[84:87], v3, s[40:43], s70 offen sc1
  s_xor_b32 s70, s60, 671744
  buffer_store_dwordx4 v[88:91], v3, s[40:43], s70 offen sc1
  s_xor_b32 s70, s60, 704512
  buffer_store_dwordx4 v[92:95], v3, s[40:43], s70 offen sc1
  s_xor_b32 s70, s60, 737280
  buffer_store_dwordx4 v[96:99], v3, s[40:43], s70 offen sc1
  s_xor_b32 s70, s60, 770048
  buffer_store_dwordx4 v[100:103], v3, s[40:43], s70 offen sc1
L_h_e1:
  s_add_u32 s54, s74, 1
  v_mov_b32 v5, 0
  s_waitcnt vmcnt(0)
  v_mov_b32 v8, s54
  v_mov_b32 v9, s75
  s_mov_b64 exec, 1
  buffer_store_dwordx2 v[8:9], v5, s[40:43], s62 offen sc1
  s_mov_b32 s59, 0
L_h_flaga:
  buffer_load_dwordx2 v[10:11], v5, s[40:43], s63 offen sc1
  s_waitcnt vmcnt(0)
  v_readfirstlane_b32 s56, v10
  v_readfirstlane_b32 s57, v11
  s_nop 0
  s_sub_u32 s56, s56, s54
  s_xor_b32 s57, s57, s75
  s_lshr_b32 s56, s56, 1
  s_or_b32 s56, s56, s57
  s_cbranch_scc0 L_h_flaga_done
  s_add_u32 s59, s59, 1
  s_cmp_gt_u32 s59, 10000
  s_cbranch_scc1 L_h_flaga_done
  s_sleep 8
  s_branch L_h_flaga
L_h_flaga_done:
  s_mov_b64 exec, -1
  s_bfe_u32 s54, s96, 0x10005
  s_mul_i32 s54, s54, 384
  v_lshrrev_b32 v4, 3, v0
  v_add_u32 v5, 0, v4
  v_mul_u32_u24 v5, 21846, v5
  v_bfe_u32 v5, v5, 16, 1
  v_mul_u32_u24 v6, 384, v5
  v_sub_u32 v6, v3, v6
  v_add_u32 v6, s54, v6
  v_add_u32 v6, 0, v6
  v_add_u32 v5, s64, v5
  v_lshrrev_b32 v2, 12, v6
  v_xor_b32 v5, v5, v2
  v_lshrrev_b32 v2, 10, v6
  v_lshl_add_u32 v5, v2, 5, v5
  v_and_b32 v6, 1023, v6
  v_lshl_add_u32 v5, v5, 10, v6
  buffer_load_dwordx4 v[8:11], v5, s[40:43], s44 offen sc1
  v_add_u32 v5, 8, v4
  v_mul_u32_u24 v5, 21846, v5
  v_bfe_u32 v5, v5, 16, 1
  v_mul_u32_u24 v6, 384, v5
  v_sub_u32 v6, v3, v6
  v_add_u32 v6, s54, v6
  v_add_u32 v6, 1024, v6
  v_add_u32 v5, s64, v5
  v_lshrrev_b32 v2, 12, v6
  v_xor_b32 v5, v5, v2
  v_lshrrev_b32 v2, 10, v6
  v_lshl_add_u32 v5, v2, 5, v5
  v_and_b32 v6, 1023, v6
  v_lshl_add_u32 v5, v5, 10, v6
  buffer_load_dwordx4 v[12:15], v5, s[40:43], s44 offen sc1
  v_add_u32 v5, 16, v4
  v_mul_u32_u24 v5, 21846, v5
  v_bfe_u32 v5, v5, 16, 1
  v_mul_u32_u24 v6, 384, v5
  v_sub_u32 v6, v3, v6
  v_add_u32 v6, s54, v6
  v_add_u32 v6, 2048, v6
  v_add_u32 v5, s64, v5
  v_lshrrev_b32 v2, 12, v6
  v_xor_b32 v5, v5, v2
  v_lshrrev_b32 v2, 10, v6
  v_lshl_add_u32 v5, v2, 5, v5
  v_and_b32 v6, 1023, v6
  v_lshl_add_u32 v5, v5, 10, v6
  buffer_load_dwordx4 v[16:19], v5, s[40:43], s44 offen sc1
  s_bitcmp0_b32 s58, 2
  s_cbranch_scc1 L_h_i0
  s_xor_b32 s70, s61, 98304
  buffer_load_dwordx4 v[20:23], v3, s[40:43], s70 offen sc1
  s_xor_b32 s70, s61, 132096
  buffer_load_dwordx4 v[24:27], v3, s[40:43], s70 offen sc1
  s_xor_b32 s70, s61, 164864
  buffer_load_dwordx4 v[28:31], v3, s[40:43], s70 offen sc1
  s_xor_b32 s70, s61, 197632
  buffer_load_dwordx4 v[32:35], v3, s[40:43], s70 offen sc1
  s_xor_b32 s70, s61, 230400
  buffer_load_dwordx4 v[36:39], v3, s[40:43], s70 offen sc1
  s_xor_b32 s70, s61, 264192
  buffer_load_dwordx4 v[40:43], v3, s[40:43], s70 offen sc1
  s_xor_b32 s70, s61, 296960
  buffer_load_dwordx4 v[44:47], v3, s[40:43], s70 offen sc1
  s_xor_b32 s70, s61, 329728
  buffer_load_dwordx4 v[48:51], v3, s[40:43], s70 offen sc1
  s_xor_b32 s70, s61, 362496
  buffer_load_dwordx4 v[52:55], v3, s[40:43], s70 offen sc1
  s_waitcnt vmcnt(0)
  ds_write_b128 v3, v[20:23] offset:3072
  ds_write_b128 v3, v[24:27] offset:4096
  ds_write_b128 v3, v[28:31] offset:5120
  ds_write_b128 v3, v[32:35] offset:6144
  ds_write_b128 v3, v[36:39] offset:7168
  ds_write_b128 v3, v[40:43] offset:8192
  ds_write_b128 v3, v[44:47] offset:9216
  ds_write_b128 v3, v[48:51] offset:10240
  ds_write_b128 v3, v[52:55] offset:11264
L_h_i0:
  s_bitcmp0_b32 s58, 0
  s_cbranch_scc1 L_h_i1
  s_xor_b32 s70, s61, 396288
  buffer_load_dwordx4 v[56:59], v3, s[40:43], s70 offen sc1
  s_xor_b32 s70, s61, 429056
  buffer_load_dwordx4 v[60:63], v3, s[40:43], s70 offen sc1
  s_xor_b32 s70, s61, 461824
  buffer_load_dwordx4 v[64:67], v3, s[40:43], s70 offen sc1
  s_xor_b32 s70, s61, 494592
  buffer_load_dwordx4 v[68:71], v3, s[40:43], s70 offen sc1
  s_xor_b32 s70, s61, 541696
  buffer_load_dwordx4 v[72:75], v3, s[40:43], s70 offen sc1
  s_xor_b32 s70, s61, 574464
  buffer_load_dwordx4 v[76:79], v3, s[40:43], s70 offen sc1
  s_xor_b32 s70, s61, 607232
  buffer_load_dwordx4 v[80:83], v3, s[40:43], s70 offen sc1
  s_xor_b32 s70, s61, 640000
  buffer_load_dwordx4 v[84:87], v3, s[40:43], s70 offen sc1
  s_xor_b32 s70, s61, 671744
  buffer_load_dwordx4 v[88:91], v3, s[40:43], s70 offen sc1
  s_xor_b32 s70, s61, 704512
  buffer_load_dwordx4 v[92:95], v3, s[40:43], s70 offen sc1
  s_xor_b32 s70, s61, 737280
  buffer_load_dwordx4 v[96:99], v3, s[40:43], s70 offen sc1
  s_xor_b32 s70, s61, 770048
  buffer_load_dwordx4 v[100:103], v3, s[40:43], s70 offen sc1
  s_waitcnt vmcnt(0)
  ds_write_b128 v3, v[56:59] offset:12288
  ds_write_b128 v3, v[60:63] offset:13312
  ds_write_b128 v3, v[64:67] offset:14336
  ds_write_b128 v3, v[68:71] offset:15360
  ds_write_b128 v3, v[72:75] offset:16384
  ds_write_b128 v3, v[76:79] offset:17408
  ds_write_b128 v3, v[80:83] offset:18432
  ds_write_b128 v3, v[84:87] offset:19456
  ds_write_b128 v3, v[88:91] offset:20480
  ds_write_b128 v3, v[92:95] offset:21504
  ds_write_b128 v3, v[96:99] offset:22528
  ds_write_b128 v3, v[100:103] offset:23552
L_h_i1:
  s_waitcnt vmcnt(0)
  ds_write_b128 v3, v[8:11] offset:0
  ds_write_b128 v3, v[12:15] offset:1024
  ds_write_b128 v3, v[16:19] offset:2048
  s_bitcmp0_b32 s58, 1
  s_cselect_b32 s70, 255, 32
  v_mov_b32 v1, 61700
  v_mov_b32 v5, s70
  ds_write_b32 v1, v5
  s_mov_b32 s78, 92
  s_swappc_b64 s[84:85], s[86:87]
  s_bitcmp0_b32 s58, 1
  s_cbranch_scc1 L_h_all
L_h_progb:
  s_sleep 4
  ds_read_b32 v8, v112
  s_waitcnt lgkmcnt(0)
  v_cmp_gt_u32 vcc, 96, v8
  s_nop 1
  s_cmp_lg_u32 vcc_lo, 0
  s_cbranch_scc1 L_h_progb
  ds_read_b128 v[8:11], v3 offset:24576
  ds_read_b128 v[12:15], v3 offset:25600
  ds_read_b128 v[16:19], v3 offset:26624
  ds_read_b128 v[20:23], v3 offset:27648
  ds_read_b128 v[24:27], v3 offset:28672
  ds_read_b128 v[28:31], v3 offset:29696
  ds_read_b128 v[32:35], v3 offset:30720
  ds_read_b128 v[36:39], v3 offset:31744
  ds_read_b128 v[40:43], v3 offset:32768
  ds_read_b128 v[44:47], v3 offset:33792
  ds_read_b128 v[48:51], v3 offset:34816
  ds_read_b128 v[52:55], v3 offset:35840
  s_waitcnt lgkmcnt(0)
  s_xor_b32 s70, s60, 805888
  buffer_store_dwordx4 v[8:11], v3, s[40:43], s70 offen sc1
  s_xor_b32 s70, s60, 838656
  buffer_store_dwordx4 v[12:15], v3, s[40:43], s70 offen sc1
  s_xor_b32 s70, s60, 871424
  buffer_store_dwordx4 v[16:19], v3, s[40:43], s70 offen sc1
  s_xor_b32 s70, s60, 904192
  buffer_store_dwordx4 v[20:23], v3, s[40:43], s70 offen sc1
  s_xor_b32 s70, s60, 935936
  buffer_store_dwordx4 v[24:27], v3, s[40:43], s70 offen sc1
  s_xor_b32 s70, s60, 968704
  buffer_store_dwordx4 v[28:31], v3, s[40:43], s70 offen sc1
  s_xor_b32 s70, s60, 1001472
  buffer_store_dwordx4 v[32:35], v3, s[40:43], s70 offen sc1
  s_xor_b32 s70, s60, 1034240
  buffer_store_dwordx4 v[36:39], v3, s[40:43], s70 offen sc1
  s_xor_b32 s70, s60, 1052672
  buffer_store_dwordx4 v[40:43], v3, s[40:43], s70 offen sc1
  s_xor_b32 s70, s60, 1085440
  buffer_store_dwordx4 v[44:47], v3, s[40:43], s70 offen sc1
  s_xor_b32 s70, s60, 1118208
  buffer_store_dwordx4 v[48:51], v3, s[40:43], s70 offen sc1
  s_xor_b32 s70, s60, 1150976
  buffer_store_dwordx4 v[52:55], v3, s[40:43], s70 offen sc1
  s_add_u32 s54, s74, 2
  v_mov_b32 v5, 0
  s_waitcnt vmcnt(0)
  v_mov_b32 v8, s54
  v_mov_b32 v9, s75
  s_mov_b64 exec, 1
  buffer_store_dwordx2 v[8:9], v5, s[40:43], s62 offen sc1
  s_mov_b32 s59, 0
L_h_flagb:
  buffer_load_dwordx2 v[10:11], v5, s[40:43], s63 offen sc1
  s_waitcnt vmcnt(0)
  v_readfirstlane_b32 s56, v10
  v_readfirstlane_b32 s57, v11
  s_nop 0
  s_sub_u32 s56, s56, s54
  s_xor_b32 s57, s57, s75
  s_lshr_b32 s56, s56, 1
  s_or_b32 s56, s56, s57
  s_cbranch_scc0 L_h_flagb_done
  s_add_u32 s59, s59, 1
  s_cmp_gt_u32 s59, 10000
  s_cbranch_scc1 L_h_flagb_done
  s_sleep 8
  s_branch L_h_flagb
L_h_flagb_done:
  s_mov_b64 exec, -1
  s_xor_b32 s70, s61, 805888
  buffer_load_dwordx4 v[8:11], v3, s[40:43], s70 offen sc1
  s_xor_b32 s70, s61, 838656
  buffer_load_dwordx4 v[12:15], v3, s[40:43], s70 offen sc1
  s_xor_b32 s70, s61, 871424
  buffer_load_dwordx4 v[16:19], v3, s[40:43], s70 offen sc1
  s_xor_b32 s70, s61, 904192
  buffer_load_dwordx4 v[20:23], v3, s[40:43], s70 offen sc1
  s_xor_b32 s70, s61, 935936
  buffer_load_dwordx4 v[24:27], v3, s[40:43], s70 offen sc1
  s_xor_b32 s70, s61, 968704
  buffer_load_dwordx4 v[28:31], v3, s[40:43], s70 offen sc1
  s_xor_b32 s70, s61, 1001472
  buffer_load_dwordx4 v[32:35], v3, s[40:43], s70 offen sc1
  s_xor_b32 s70, s61, 1034240
  buffer_load_dwordx4 v[36:39], v3, s[40:43], s70 offen sc1
  s_xor_b32 s70, s61, 1052672
  buffer_load_dwordx4 v[40:43], v3, s[40:43], s70 offen sc1
  s_xor_b32 s70, s61, 1085440
  buffer_load_dwordx4 v[44:47], v3, s[40:43], s70 offen sc1
  s_xor_b32 s70, s61, 1118208
  buffer_load_dwordx4 v[48:51], v3, s[40:43], s70 offen sc1
  s_xor_b32 s70, s61, 1150976
  buffer_load_dwordx4 v[52:55], v3, s[40:43], s70 offen sc1
  s_waitcnt vmcnt(0)
  ds_write_b128 v3, v[8:11] offset:24576
  ds_write_b128 v3, v[12:15] offset:25600
  ds_write_b128 v3, v[16:19] offset:26624
  ds_write_b128 v3, v[20:23] offset:27648
  ds_write_b128 v3, v[24:27] offset:28672
  ds_write_b128 v3, v[28:31] offset:29696
  ds_write_b128 v3, v[32:35] offset:30720
  ds_write_b128 v3, v[36:39] offset:31744
  ds_write_b128 v3, v[40:43] offset:32768
  ds_write_b128 v3, v[44:47] offset:33792
  ds_write_b128 v3, v[48:51] offset:34816
  ds_write_b128 v3, v[52:55] offset:35840
  v_mov_b32 v1, 61700
  v_mov_b32 v5, 255
  ds_write_b32 v1, v5
L_h_all:
  s_mov_b32 s78, 182
  s_swappc_b64 s[84:85], s[86:87]
L_h_progt:
  s_sleep 4
  ds_read_b32 v8, v112
  s_waitcnt lgkmcnt(0)
  v_cmp_gt_u32 vcc, 188, v8
  s_nop 1
  s_cmp_lg_u32 vcc_lo, 0
  s_cbranch_scc1 L_h_progt
  v_mov_b32 v8, 255
  ds_write_b32 v112, v8 offset:8
  s_waitcnt lgkmcnt(0)
  s_endpgm
L_h_cp:
  s_cmp_gt_u32 s76, s78
  s_cbranch_scc0 L_h_cpgo
  s_setpc_b64 s[84:85]
L_h_cpgo:
  ds_read_b32 v8, v112
  s_waitcnt lgkmcnt(0)
  v_cmp_gt_u32 vcc, s76, v8
  s_nop 1
  s_cmp_eq_u32 vcc_lo, 0
  s_cbranch_scc1 L_h_cpnext
L_h_first:
  s_sleep 2
  ds_read_b32 v8, v112
  s_waitcnt lgkmcnt(0)
  v_cmp_gt_u32 s[48:49], s76, v8
  s_nop 1
  s_cmp_eq_u32 s48, -1
  s_cbranch_scc1 L_h_first
  s_memrealtime s[54:55]
L_h_progm:
  s_sleep 2
  ds_read_b32 v8, v112
  s_waitcnt lgkmcnt(0)
  v_cmp_gt_u32 vcc, s76, v8
  s_nop 1
  s_cmp_lg_u32 vcc_lo, 0
  s_cbranch_scc1 L_h_progm
  s_memrealtime s[56:57]
  v_mov_b32 v114, s54
  v_mov_b32 v115, s55
  s_mov_b64 exec, s[48:49]
  s_waitcnt lgkmcnt(0)
  v_mov_b32 v114, s56
  v_mov_b32 v115, s57
  s_mov_b64 exec, -1
  s_and_b32 s70, s2, 0x78
  s_cbranch_scc1 L_h_np
  s_mov_b64 exec, 3
  buffer_store_dwordx2 v[114:115], v104, s[40:43], s77 offen sc1
  s_mov_b64 exec, -1
L_h_np:
  s_add_u32 s50, s76, 4
L_h_progc:
  s_sleep 4
  ds_read_b32 v8, v112
  s_waitcnt lgkmcnt(0)
  v_cmp_gt_u32 vcc, s50, v8
  s_nop 1
  s_cmp_lg_u32 vcc_lo, 0
  s_cbranch_scc1 L_h_progc
  buffer_load_dwordx2 v[8:9], v105, s[40:43], s77 offen
  v_mov_b32 v10, s73
  s_waitcnt vmcnt(0)
  ds_read_b32 v12, v112
  v_subrev_co_u32 v8, vcc, s72, v8
  s_nop 1
  v_subb_co_u32 v9, vcc, v9, v10, vcc
  v_lshrrev_b32 v10, 24, v8
  v_or_b32 v9, v9, v10
  v_cmp_eq_u32 vcc, 0, v9
  s_nop 1
  v_cndmask_b32 v8, 0, v8, vcc
  s_bcnt1_i32_b32 s56, vcc_lo
  s_nop 0
  v_add_u32_dpp v8, v8, v8 row_ror:8 row_mask:0xf bank_mask:0xf
  s_nop 1
  v_add_u32_dpp v8, v8, v8 row_ror:4 row_mask:0xf bank_mask:0xf
  s_nop 1
  v_add_u32_dpp v8, v8, v8 row_ror:2 row_mask:0xf bank_mask:0xf
  s_nop 1
  v_add_u32_dpp v8, v8, v8 row_ror:1 row_mask:0xf bank_mask:0xf
  s_nop 0
  v_readlane_b32 s54, v8, 0
  v_readlane_b32 s70, v8, 16
  v_subrev_u32 v8, s72, v114
  v_mul_lo_u32 v8, v8, s56
  s_add_u32 s54, s54, s70
  s_max_u32 s56, s56, 1
  v_subrev_u32 v8, s54, v8
  v_cvt_f32_u32 v9, s56
  v_cvt_f32_i32 v8, v8
  v_rcp_f32 v9, v9
  s_nop 0
  v_mul_f32 v8, v8, v9
  v_cvt_i32_f32 v8, v8
  s_waitcnt lgkmcnt(0)
  v_add_u32 v12, 2, v12
  v_min_u32 v9, v113, v12
  v_subrev_u32 v9, s76, v9
  v_max_i32 v9, 0, v9
  v_lshrrev_b32 v9, 1, v9
  v_mul_u32_u24 v9, 28, v9
  v_sub_u32 v8, v8, v9
  v_add_u32 v9, 14, v8
  v_max_i32 v9, 0, v9
  v_min_i32 v9, 2000, v9
  v_mul_u32_u24 v9, 2340, v9
  v_lshrrev_b32 v9, 16, v9
  v_cmp_ne_u32 vcc, 0, v9
  v_lshl_add_u32 v9, v9, 1, v12
  s_nop 0
  v_cndmask_b32 v113, 0, v9, vcc
  ds_write_b32 v112, v113 offset:8
L_h_cpnext:
  s_add_u32 s76, s76, 8
  s_add_u32 s77, s77, 256
  s_branch L_h_cp
L_code_end:
.section .rodata,"a"
.p2align 6
.amdhsa_kernel standalone__kv_cache_quant_int4_int2_kv_with_per_channel_or_per_token_scales__sampling_kernel
  .amdhsa_next_free_vgpr 256
  .amdhsa_next_free_sgpr 102
  .amdhsa_accum_offset 256
  .amdhsa_group_segment_fixed_size 0
  .amdhsa_kernarg_size 80
  .amdhsa_user_sgpr_count 2
  .amdhsa_user_sgpr_kernarg_segment_ptr 1
  .amdhsa_system_sgpr_workgroup_id_x 1
  .amdhsa_float_denorm_mode_32 3
.end_amdhsa_kernel
```

```asm
; @launch grid=(256,1,1) block=(192,1,1) lds=62464
.amdgcn_target "amdgcn-amd-amdhsa--gfx950"
.text
.globl standalone__kv_cache_quant_int4_int2_kv_with_per_channel_or_per_token_scales__sampling_kernel
.p2align 8
.type standalone__kv_cache_quant_int4_int2_kv_with_per_channel_or_per_token_scales__sampling_kernel,@function
standalone__kv_cache_quant_int4_int2_kv_with_per_channel_or_per_token_scales__sampling_kernel:
  s_cmp_ge_u32 s2, 256
  s_cbranch_scc1 L_end
  s_load_dwordx16 s[44:59], s[0:1], 0
  s_load_dwordx4 s[80:83], s[0:1], 64
  v_lshrrev_b32 v1, 6, v0
  v_and_b32 v0, 63, v0
  v_readfirstlane_b32 s3, v1
  s_bfe_u32 s4, s2, 0x10002
  s_lshr_b32 s5, s2, 3
  s_lshl_b32 s5, s5, 2
  s_and_b32 s70, s2, 3
  s_add_u32 s5, s5, s70
  s_lshl_b32 s5, s5, 5
  s_mov_b32 s22, 6291456
  s_mov_b32 s23, 0x20000
  s_mov_b32 s26, 6291456
  s_mov_b32 s27, 0x20000
  s_mov_b32 s30, 2097152
  s_mov_b32 s31, 0x20000
  s_mov_b32 s34, 2097152
  s_mov_b32 s35, 0x20000
  s_mov_b32 s10, 805306368
  s_mov_b32 s11, 0x20000
  s_mov_b32 s38, 393216
  s_mov_b32 s39, 0x20000
  s_mov_b32 s18, 805306368
  s_mov_b32 s19, 0x20000
  s_mov_b32 s14, 805306368
  s_mov_b32 s15, 0x20000
  s_mov_b32 s42, 25165824
  s_mov_b32 s43, 0x20000
  s_cmp_eq_u32 s3, 2
  s_cbranch_scc1 L_helper
  v_and_b32 v108, 3, v0
  v_bfe_u32 v109, v0, 2, 2
  v_lshrrev_b32 v110, 4, v0
  v_and_b32 v111, 15, v0
  v_lshlrev_b32 v144, 4, v108
  v_lshl_add_u32 v144, v110, 6, v144
  v_lshrrev_b32 v233, 1, v144
  v_and_b32 v231, 2, v109
  v_lshlrev_b32 v230, 5, v231
  v_add_u32 v230, 129, v230
  v_and_b32 v145, 1, v109
  v_lshl_add_u32 v231, v145, 2, v231
  v_mul_u32_u24 v145, 33024, v145
  v_add_u32 v232, v144, v145
  v_subrev_u32 v232, 33024, v232
  v_mul_u32_u24 v145, 384, v109
  v_add_u32 v235, v145, v233
  v_mov_b32 v105, 2147483632
  s_mov_b32 s90, 0xaaaaaaab
  s_mov_b32 s91, 0x492492
  s_movk_i32 s63, 768
  s_mov_b32 s64, s3
  s_mov_b32 s99, 8
  s_mov_b32 s96, 0
  v_lshlrev_b32 v114, 4, v0
  s_lshl1_add_u32 s70, s2, s3
  s_mul_i32 s88, s70, 4096
  s_mul_i32 s86, s70, 12288
  s_waitcnt lgkmcnt(0)
  s_mov_b32 s20, s50
  s_and_b32 s21, s51, 0xffff
  s_mov_b32 s24, s52
  s_and_b32 s25, s53, 0xffff
  s_mov_b32 s28, s54
  s_and_b32 s29, s55, 0xffff
  s_mov_b32 s32, s56
  s_and_b32 s33, s57, 0xffff
  buffer_load_dwordx4 v[128:131], v114, s[20:23], s86 offen offset:0
  buffer_load_dwordx4 v[128:131], v114, s[24:27], s86 offen offset:0
  buffer_load_dwordx4 v[128:131], v114, s[28:31], s88 offen offset:0
  buffer_load_dwordx4 v[128:131], v114, s[32:35], s88 offen offset:0
  buffer_load_dwordx4 v[128:131], v114, s[20:23], s86 offen offset:1024
  buffer_load_dwordx4 v[128:131], v114, s[24:27], s86 offen offset:1024
  buffer_load_dwordx4 v[128:131], v114, s[28:31], s88 offen offset:1024
  buffer_load_dwordx4 v[128:131], v114, s[32:35], s88 offen offset:1024
  s_mov_b32 s8, s46
  s_and_b32 s9, s47, 0xffff
  s_mov_b32 s36, s44
  s_and_b32 s37, s45, 0xffff
  s_mov_b32 s16, s46
  s_and_b32 s17, s47, 0xffff
  s_mov_b32 s12, s48
  s_and_b32 s13, s49, 0xffff
  s_mov_b32 s40, s82
  s_and_b32 s41, s83, 0xffff
  s_mov_b64 s[46:47], s[58:59]
  s_mov_b32 s56, 0x0f0f0f0f
  s_mov_b32 s57, 0x0f0f0f0f
  s_mov_b32 s58, 0xffff
  s_mov_b32 s59, 0xffff
  s_lshr_b32 s71, s64, 4
  s_andn2_b32 s71, s71, 1
  s_lshr_b32 s71, 0x12, s71
  s_and_b32 s71, s71, 3
  s_lshr_b32 s85, s96, s71
  s_andn2_b32 s70, s64, 1
  s_or_b32 s70, s70, s4
  s_cmp_lt_u32 s64, 8
  s_cselect_b32 s70, s70, s64
  s_cselect_b32 s85, s64, s85
  s_and_b32 s85, s85, 1
  s_and_b32 s70, s70, 31
  s_lshl_b32 s71, s71, 12
  s_add_u32 s70, s70, s5
  s_add_u32 s70, s70, s71
  s_mul_hi_u32 s84, s70, s90
  s_lshr_b32 s84, s84, 1
  s_mul_i32 s71, s84, 3
  s_sub_u32 s70, s70, s71
  s_lshl3_add_u32 s85, s70, s85
  s_mul_i32 s61, s84, 196608
  s_lshr_b32 s89, s84, 4
  s_lshl_b32 s70, s85, 5
  v_add_u32 v97, s70, v230
  v_mul_u32_u24 v97, 21846, v97
  v_lshrrev_b32 v97, 16, v97
  v_add_u32 v144, s85, v231
  v_lshrrev_b32 v145, v144, s91
  v_and_b32 v145, 1, v145
  v_cmp_eq_u32 s[54:55], 1, v145
  s_nop 1
  s_and_b64 s[52:53], s[54:55], s[56:57]
  s_andn2_b64 s[54:55], s[54:55], s[56:57]
  v_mul_u32_u24 v144, 43, v144
  v_lshrrev_b32 v144, 8, v144
  v_mul_u32_u24 v144, 384, v144
  v_add_u32 v234, v144, v233
  v_mad_u32_u24 v92, v97, s63, v232
  v_add_u32 v93, 768, v92
  v_add_u32 v94, 4608, v92
  v_add_u32 v95, 7680, v92
  v_cndmask_b32 v92, v92, v105, s[52:53]
  v_cndmask_b32 v95, v95, v105, s[54:55]
  s_mov_b32 s60, s61
  s_mul_i32 s70, s89, 1536
  buffer_load_dwordx2 v[174:175], v235, s[36:39], s70 offen offset:0
  buffer_load_dwordx2 v[176:177], v235, s[36:39], s70 offen offset:128
  buffer_load_dwordx2 v[178:179], v235, s[36:39], s70 offen offset:256
  buffer_load_dwordx4 v[4:7], v92, s[8:11], s60 offen offset:0 nt
  buffer_load_dwordx4 v[128:131], v114, s[20:23], s86 offen offset:2048
  buffer_load_dwordx4 v[128:131], v114, s[24:27], s86 offen offset:2048
  buffer_load_dwordx4 v[128:131], v114, s[28:31], s88 offen offset:2048
  buffer_load_dwordx4 v[128:131], v114, s[32:35], s88 offen offset:2048
  buffer_load_dwordx4 v[128:131], v114, s[20:23], s86 offen offset:3072
  buffer_load_dwordx4 v[128:131], v114, s[24:27], s86 offen offset:3072
  buffer_load_dwordx4 v[128:131], v114, s[28:31], s88 offen offset:3072
  buffer_load_dwordx4 v[128:131], v114, s[32:35], s88 offen offset:3072
  s_barrier
  s_mov_b64 vcc, 0
  v_lshlrev_b32 v144, 4, v111
  v_and_b32 v2, 2, v110
  v_lshlrev_b32 v1, 5, v2
  v_add_u32 v1, 129, v1
  v_and_b32 v145, 1, v110
  v_lshl_add_u32 v2, v145, 2, v2
  v_mul_u32_u24 v145, 33024, v145
  v_add_u32 v3, v144, v145
  v_subrev_u32 v3, 33024, v3
  v_and_b32 v145, 1, v110
  v_mul_u32_u24 v145, 86, v145
  v_lshl_add_u32 v96, v111, 1, v145
  v_subrev_u32 v96, 86, v96
  v_lshlrev_b32 v101, 4, v110
  v_lshrrev_b32 v144, 2, v0
  s_mul_i32 s70, s3, 384
  v_lshl_add_u32 v99, v144, 4, s70
  v_lshl_add_u32 v100, v144, 3, s70
  s_mul_i32 s70, s3, 3072
  s_add_u32 s70, s70, 36864
  v_lshl_add_u32 v102, v0, 4, s70
  s_lshl_b32 s70, s3, 5
  s_add_u32 s70, s70, 43008
  v_lshl_add_u32 v103, v109, 3, s70
  s_lshl2_add_u32 s70, s3, 61712
  v_mov_b32 v104, s70
  v_mov_b32 v112, 0
  v_mov_b32 v113, 0
  v_mov_b32 v236, 0xff800000
  v_mov_b32 v146, 1
  s_mov_b32 s65, 0xffff0000
  s_mov_b32 s66, 0x3fb8aa3b
  s_mov_b32 s68, 0x4893cd3a
  s_mov_b32 s92, 0x7f000000
  s_mov_b32 s94, 0x34800000
  s_mov_b32 s69, 0x4893cd3a
  s_mov_b32 s93, 0x7f000000
  s_mov_b32 s95, 0x34800000
  s_mov_b32 s72, 0x11111111
  s_mov_b32 s73, 0x11111111
  s_mov_b32 s74, 0x22222222
  s_mov_b32 s75, 0x22222222
  s_mov_b32 s76, 0x44444444
  s_mov_b32 s77, 0x44444444
  s_mov_b32 s78, 0x88888888
  s_mov_b32 s79, 0x88888888
  s_add_u32 s86, s86, 4096
  s_waitcnt vmcnt(15)
  buffer_load_dwordx4 v[128:131], v114, s[20:23], s86 offen offset:0
  s_waitcnt vmcnt(15)
  buffer_load_dwordx4 v[128:131], v114, s[24:27], s86 offen offset:0
  s_waitcnt vmcnt(15)
  buffer_load_dwordx4 v[128:131], v114, s[20:23], s86 offen offset:1024
  s_waitcnt vmcnt(15)
  buffer_load_dwordx4 v[128:131], v114, s[24:27], s86 offen offset:1024
  s_waitcnt vmcnt(15)
  buffer_load_dwordx4 v[128:131], v114, s[20:23], s86 offen offset:2048
  s_waitcnt vmcnt(15)
  buffer_load_dwordx4 v[128:131], v114, s[24:27], s86 offen offset:2048
  s_waitcnt vmcnt(15)
  buffer_load_dwordx4 v[128:131], v114, s[20:23], s86 offen offset:3072
  s_waitcnt vmcnt(15)
  buffer_load_dwordx4 v[128:131], v114, s[24:27], s86 offen offset:3072
  s_add_u32 s86, s86, 4096
  s_waitcnt vmcnt(15)
  buffer_load_dwordx4 v[128:131], v114, s[20:23], s86 offen offset:0
  s_waitcnt vmcnt(15)
  buffer_load_dwordx4 v[128:131], v114, s[24:27], s86 offen offset:0
  s_waitcnt vmcnt(15)
  buffer_load_dwordx4 v[128:131], v114, s[20:23], s86 offen offset:1024
  s_waitcnt vmcnt(15)
  buffer_load_dwordx4 v[128:131], v114, s[24:27], s86 offen offset:1024
  s_waitcnt vmcnt(15)
  buffer_load_dwordx4 v[128:131], v114, s[20:23], s86 offen offset:2048
  s_waitcnt vmcnt(15)
  buffer_load_dwordx4 v[128:131], v114, s[24:27], s86 offen offset:2048
  s_waitcnt vmcnt(15)
  buffer_load_dwordx4 v[128:131], v114, s[20:23], s86 offen offset:3072
  s_waitcnt vmcnt(15)
  buffer_load_dwordx4 v[128:131], v114, s[24:27], s86 offen offset:3072
  s_mov_b32 s88, s89
  s_mul_i32 s62, s84, 1536
  buffer_load_dwordx2 v[180:181], v234, s[20:23], s62 offen offset:0
  buffer_load_dwordx2 v[186:187], v234, s[24:27], s62 offen offset:0
  buffer_load_dwordx2 v[182:183], v234, s[20:23], s62 offen offset:128
  buffer_load_dwordx2 v[188:189], v234, s[24:27], s62 offen offset:128
  buffer_load_dwordx2 v[184:185], v234, s[20:23], s62 offen offset:256
  buffer_load_dwordx2 v[190:191], v234, s[24:27], s62 offen offset:256
  s_waitcnt vmcnt(15)
  buffer_load_dwordx4 v[8:11], v92, s[8:11], s60 offen offset:256 nt
  s_waitcnt vmcnt(15)
  buffer_load_dwordx4 v[12:15], v92, s[8:11], s60 offen offset:512 nt
  s_waitcnt vmcnt(15)
  buffer_load_dwordx4 v[16:19], v93, s[8:11], s60 offen offset:0 nt
  s_waitcnt vmcnt(15)
  buffer_load_dwordx4 v[20:23], v93, s[8:11], s60 offen offset:256 nt
  s_waitcnt vmcnt(15)
  buffer_load_dwordx4 v[24:27], v93, s[8:11], s60 offen offset:512 nt
  s_waitcnt vmcnt(15)
  buffer_load_dwordx4 v[28:31], v93, s[8:11], s60 offen offset:768 nt
  s_waitcnt vmcnt(15)
  buffer_load_dwordx4 v[32:35], v93, s[8:11], s60 offen offset:1024 nt
  s_waitcnt vmcnt(15)
  buffer_load_dwordx4 v[36:39], v93, s[8:11], s60 offen offset:1280 nt
  s_waitcnt vmcnt(15)
  buffer_load_dwordx4 v[40:43], v93, s[8:11], s60 offen offset:1536 nt
  s_waitcnt vmcnt(15)
  buffer_load_dwordx4 v[44:47], v93, s[8:11], s60 offen offset:1792 nt
  s_waitcnt vmcnt(16)
  buffer_load_dwordx4 v[48:51], v93, s[8:11], s60 offen offset:2048 nt
  s_waitcnt vmcnt(17)
  buffer_load_dwordx4 v[52:55], v93, s[8:11], s60 offen offset:2304 nt
  s_waitcnt vmcnt(18)
  buffer_load_dwordx4 v[56:59], v93, s[8:11], s60 offen offset:2560 nt
  s_waitcnt vmcnt(19)
  buffer_load_dwordx4 v[60:63], v93, s[8:11], s60 offen offset:2816 nt
  s_waitcnt vmcnt(14)
  ds_write_b32 v104, v146
L_k:
  v_add_u32 v144, s85, v2
  v_lshrrev_b32 v145, v144, s91
  v_and_b32 v145, 1, v145
  v_cmp_eq_u32 s[50:51], 1, v145
  s_nop 1
  s_and_b64 s[48:49], s[50:51], s[58:59]
  s_andn2_b64 s[50:51], s[50:51], s[58:59]
  s_mov_b32 s97, s64
  s_add_u32 s64, s64, 2
  ds_read_b32 v106, v104 offset:8
  s_waitcnt vmcnt(14)
  s_cbranch_vccnz L_kw0_0
  s_waitcnt vmcnt(9)
L_kw0_0:
  buffer_load_dwordx4 v[64:67], v93, s[8:11], s60 offen offset:3072 nt
  v_lshlrev_b32 v204, 16, v186
  v_and_b32 v205, s65, v186
  v_lshlrev_b32 v206, 16, v187
  v_and_b32 v207, s65, v187
  v_lshlrev_b32 v192, 16, v180
  v_and_b32 v193, s65, v180
  v_lshlrev_b32 v194, 16, v181
  v_and_b32 v195, s65, v181
  v_pk_mul_f32 v[204:205], v[204:205], s[94:95]
  v_mov_b32 v168, v174
  v_pk_mul_f32 v[206:207], v[206:207], s[94:95]
  v_mov_b32 v169, v175
  v_pk_fma_f32 v[108:109], v[4:5], s[92:93], v[204:205] neg_lo:[0,0,1] neg_hi:[0,0,1]
  v_pk_fma_f32 v[110:111], v[6:7], s[92:93], v[206:207] neg_lo:[0,0,1] neg_hi:[0,0,1]
  v_cvt_pk_bf16_f32 v108, 0, v108
  v_cvt_pk_bf16_f32 v109, 0, v109
  v_cvt_pk_bf16_f32 v110, 0, v110
  v_cvt_pk_bf16_f32 v111, 0, v111
  v_pk_mul_f32 v[108:109], v[108:109], v[192:193]
  v_pk_mul_f32 v[110:111], v[110:111], v[194:195]
  v_cvt_pk_bf16_f32 v216, v108, v109
  v_cvt_pk_bf16_f32 v217, v110, v111
  s_waitcnt lgkmcnt(0)
  v_cmp_lt_u32 vcc, s97, v106
  s_waitcnt vmcnt(14)
  buffer_load_dwordx4 v[68:71], v93, s[8:11], s60 offen offset:3328 nt
  v_lshlrev_b32 v208, 16, v188
  v_and_b32 v209, s65, v188
  v_lshlrev_b32 v210, 16, v189
  v_and_b32 v211, s65, v189
  v_lshlrev_b32 v196, 16, v182
  v_and_b32 v197, s65, v182
  v_lshlrev_b32 v198, 16, v183
  v_and_b32 v199, s65, v183
  v_pk_mul_f32 v[208:209], v[208:209], s[94:95]
  v_mov_b32 v170, v176
  v_pk_mul_f32 v[210:211], v[210:211], s[94:95]
  v_mov_b32 v171, v177
  v_pk_fma_f32 v[108:109], v[8:9], s[92:93], v[208:209] neg_lo:[0,0,1] neg_hi:[0,0,1]
  v_pk_fma_f32 v[110:111], v[10:11], s[92:93], v[210:211] neg_lo:[0,0,1] neg_hi:[0,0,1]
  v_cvt_pk_bf16_f32 v108, 0, v108
  v_cvt_pk_bf16_f32 v109, 0, v109
  v_cvt_pk_bf16_f32 v110, 0, v110
  v_cvt_pk_bf16_f32 v111, 0, v111
  v_pk_mul_f32 v[108:109], v[108:109], v[196:197]
  v_pk_mul_f32 v[110:111], v[110:111], v[198:199]
  v_cvt_pk_bf16_f32 v218, v108, v109
  v_cvt_pk_bf16_f32 v219, v110, v111
  s_waitcnt vmcnt(14)
  buffer_load_dwordx4 v[72:75], v93, s[8:11], s60 offen offset:3584 nt
  v_mfma_f32_16x16x32_bf16 v[224:227], v[216:219], v[168:171], 0
  v_lshlrev_b32 v212, 16, v190
  v_and_b32 v213, s65, v190
  v_lshlrev_b32 v214, 16, v191
  v_and_b32 v215, s65, v191
  v_lshlrev_b32 v200, 16, v184
  v_and_b32 v201, s65, v184
  v_lshlrev_b32 v202, 16, v185
  v_and_b32 v203, s65, v185
  v_pk_mul_f32 v[212:213], v[212:213], s[94:95]
  v_mov_b32 v172, v178
  v_pk_mul_f32 v[214:215], v[214:215], s[94:95]
  v_mov_b32 v173, v179
  v_pk_fma_f32 v[108:109], v[12:13], s[92:93], v[212:213] neg_lo:[0,0,1] neg_hi:[0,0,1]
  v_pk_fma_f32 v[110:111], v[14:15], s[92:93], v[214:215] neg_lo:[0,0,1] neg_hi:[0,0,1]
  v_cvt_pk_bf16_f32 v108, 0, v108
  v_cvt_pk_bf16_f32 v109, 0, v109
  v_cvt_pk_bf16_f32 v110, 0, v110
  v_cvt_pk_bf16_f32 v111, 0, v111
  v_pk_mul_f32 v[108:109], v[108:109], v[200:201]
  v_pk_mul_f32 v[110:111], v[110:111], v[202:203]
  v_cvt_pk_bf16_f32 v220, v108, v109
  v_cvt_pk_bf16_f32 v221, v110, v111
  s_waitcnt vmcnt(14)
  s_cbranch_vccnz L_kw0_3
  s_waitcnt vmcnt(9)
L_kw0_3:
  buffer_load_dwordx4 v[76:79], v94, s[8:11], s60 offen offset:0 nt
  v_mfma_f32_16x16x16_bf16 v[224:227], v[220:221], v[172:173], v[224:227]
  v_pk_fma_f32 v[108:109], v[16:17], s[92:93], v[204:205] neg_lo:[0,0,1] neg_hi:[0,0,1]
  v_pk_fma_f32 v[110:111], v[18:19], s[92:93], v[206:207] neg_lo:[0,0,1] neg_hi:[0,0,1]
  v_cvt_pk_bf16_f32 v108, 0, v108
  v_cvt_pk_bf16_f32 v109, 0, v109
  v_cvt_pk_bf16_f32 v110, 0, v110
  v_cvt_pk_bf16_f32 v111, 0, v111
  v_pk_mul_f32 v[108:109], v[108:109], v[192:193]
  v_pk_mul_f32 v[110:111], v[110:111], v[194:195]
  v_cvt_pk_bf16_f32 v216, v108, v109
  v_cvt_pk_bf16_f32 v217, v110, v111
  s_waitcnt vmcnt(14)
  buffer_load_dwordx4 v[80:83], v94, s[8:11], s60 offen offset:256 nt
  v_pk_fma_f32 v[108:109], v[20:21], s[92:93], v[208:209] neg_lo:[0,0,1] neg_hi:[0,0,1]
  v_pk_fma_f32 v[110:111], v[22:23], s[92:93], v[210:211] neg_lo:[0,0,1] neg_hi:[0,0,1]
  v_mov_b32_dpp v144, v224 quad_perm:[0,0,0,0] row_mask:0xf bank_mask:0xf
  v_mov_b32_dpp v145, v226 quad_perm:[2,2,2,2] row_mask:0xf bank_mask:0xf
  v_cvt_pk_bf16_f32 v108, 0, v108
  v_cvt_pk_bf16_f32 v109, 0, v109
  v_add_f32_dpp v144, v225, v144 quad_perm:[1,1,1,1] row_mask:0xf bank_mask:0xf
  v_add_f32_dpp v145, v227, v145 quad_perm:[3,3,3,3] row_mask:0xf bank_mask:0xf
  v_cvt_pk_bf16_f32 v110, 0, v110
  v_cvt_pk_bf16_f32 v111, 0, v111
  v_add_f32 v228, v144, v145
  v_pk_mul_f32 v[108:109], v[108:109], v[196:197]
  v_pk_mul_f32 v[110:111], v[110:111], v[198:199]
  v_cvt_pk_bf16_f32 v218, v108, v109
  v_cvt_pk_bf16_f32 v219, v110, v111
  s_waitcnt vmcnt(14)
  buffer_load_dwordx4 v[84:87], v94, s[8:11], s60 offen offset:512 nt
  v_mfma_f32_16x16x32_bf16 v[224:227], v[216:219], v[168:171], 0
  v_pk_fma_f32 v[108:109], v[24:25], s[92:93], v[212:213] neg_lo:[0,0,1] neg_hi:[0,0,1]
  v_pk_fma_f32 v[110:111], v[26:27], s[92:93], v[214:215] neg_lo:[0,0,1] neg_hi:[0,0,1]
  v_cvt_pk_bf16_f32 v108, 0, v108
  v_cndmask_b32 v228, v228, v236, s[48:49]
  v_cvt_pk_bf16_f32 v109, 0, v109
  v_cvt_pk_bf16_f32 v110, 0, v110
  v_cvt_pk_bf16_f32 v111, 0, v111
  v_pk_mul_f32 v[108:109], v[108:109], v[200:201]
  v_pk_mul_f32 v[110:111], v[110:111], v[202:203]
  v_cvt_pk_bf16_f32 v220, v108, v109
  v_cvt_pk_bf16_f32 v221, v110, v111
  s_waitcnt vmcnt(14)
  s_cbranch_vccnz L_kw0_6
  s_waitcnt vmcnt(9)
L_kw0_6:
  buffer_load_dwordx4 v[88:91], v94, s[8:11], s60 offen offset:768 nt
  v_mfma_f32_16x16x16_bf16 v[224:227], v[220:221], v[172:173], v[224:227]
  v_pk_fma_f32 v[108:109], v[28:29], s[92:93], v[204:205] neg_lo:[0,0,1] neg_hi:[0,0,1]
  v_pk_fma_f32 v[110:111], v[30:31], s[92:93], v[206:207] neg_lo:[0,0,1] neg_hi:[0,0,1]
  v_cvt_pk_bf16_f32 v108, 0, v108
  v_cvt_pk_bf16_f32 v109, 0, v109
  v_cvt_pk_bf16_f32 v110, 0, v110
  v_cvt_pk_bf16_f32 v111, 0, v111
  v_pk_mul_f32 v[108:109], v[108:109], v[192:193]
  v_pk_mul_f32 v[110:111], v[110:111], v[194:195]
  v_cvt_pk_bf16_f32 v216, v108, v109
  v_cvt_pk_bf16_f32 v217, v110, v111
  s_waitcnt vmcnt(14)
  buffer_load_dwordx4 v[4:7], v94, s[8:11], s60 offen offset:1024 nt
  v_pk_fma_f32 v[108:109], v[32:33], s[92:93], v[208:209] neg_lo:[0,0,1] neg_hi:[0,0,1]
  v_pk_fma_f32 v[110:111], v[34:35], s[92:93], v[210:211] neg_lo:[0,0,1] neg_hi:[0,0,1]
  v_mov_b32_dpp v144, v224 quad_perm:[0,0,0,0] row_mask:0xf bank_mask:0xf
  v_mov_b32_dpp v145, v226 quad_perm:[2,2,2,2] row_mask:0xf bank_mask:0xf
  v_cvt_pk_bf16_f32 v108, 0, v108
  v_cvt_pk_bf16_f32 v109, 0, v109
  v_add_f32_dpp v144, v225, v144 quad_perm:[1,1,1,1] row_mask:0xf bank_mask:0xf
  v_add_f32_dpp v145, v227, v145 quad_perm:[3,3,3,3] row_mask:0xf bank_mask:0xf
  v_cvt_pk_bf16_f32 v110, 0, v110
  v_cvt_pk_bf16_f32 v111, 0, v111
  v_add_f32 v229, v144, v145
  v_pk_mul_f32 v[108:109], v[108:109], v[196:197]
  v_pk_mul_f32 v[110:111], v[110:111], v[198:199]
  v_cvt_pk_bf16_f32 v218, v108, v109
  v_cvt_pk_bf16_f32 v219, v110, v111
  s_waitcnt vmcnt(14)
  buffer_load_dwordx4 v[8:11], v94, s[8:11], s60 offen offset:1280 nt
  v_mfma_f32_16x16x32_bf16 v[224:227], v[216:219], v[168:171], 0
  v_pk_fma_f32 v[108:109], v[36:37], s[92:93], v[212:213] neg_lo:[0,0,1] neg_hi:[0,0,1]
  v_pk_fma_f32 v[110:111], v[38:39], s[92:93], v[214:215] neg_lo:[0,0,1] neg_hi:[0,0,1]
  v_cvt_pk_bf16_f32 v108, 0, v108
  v_cvt_pk_bf16_f32 v228, 0, v228
  v_cvt_pk_bf16_f32 v109, 0, v109
  v_cvt_pk_bf16_f32 v229, 0, v229
  v_cvt_pk_bf16_f32 v110, 0, v110
  v_pk_mul_f32 v[228:229], v[228:229], s[68:69]
  v_cvt_pk_bf16_f32 v111, 0, v111
  v_cvt_pk_bf16_f32 v120, v228, v229
  v_pk_mul_f32 v[108:109], v[108:109], v[200:201]
  v_pk_mul_f32 v[110:111], v[110:111], v[202:203]
  v_cvt_pk_bf16_f32 v220, v108, v109
  v_cvt_pk_bf16_f32 v221, v110, v111
  s_waitcnt vmcnt(14)
  s_cbranch_vccnz L_kw0_9
  s_waitcnt vmcnt(9)
L_kw0_9:
  buffer_load_dwordx4 v[12:15], v94, s[8:11], s60 offen offset:1536 nt
  v_mfma_f32_16x16x16_bf16 v[224:227], v[220:221], v[172:173], v[224:227]
  v_pk_fma_f32 v[108:109], v[40:41], s[92:93], v[204:205] neg_lo:[0,0,1] neg_hi:[0,0,1]
  v_pk_fma_f32 v[110:111], v[42:43], s[92:93], v[206:207] neg_lo:[0,0,1] neg_hi:[0,0,1]
  v_cvt_pk_bf16_f32 v108, 0, v108
  v_cvt_pk_bf16_f32 v109, 0, v109
  v_cvt_pk_bf16_f32 v110, 0, v110
  v_cvt_pk_bf16_f32 v111, 0, v111
  v_pk_mul_f32 v[108:109], v[108:109], v[192:193]
  v_pk_mul_f32 v[110:111], v[110:111], v[194:195]
  v_cvt_pk_bf16_f32 v216, v108, v109
  v_cvt_pk_bf16_f32 v217, v110, v111
  s_waitcnt vmcnt(14)
  buffer_load_dwordx4 v[16:19], v94, s[8:11], s60 offen offset:1792 nt
  v_pk_fma_f32 v[108:109], v[44:45], s[92:93], v[208:209] neg_lo:[0,0,1] neg_hi:[0,0,1]
  v_pk_fma_f32 v[110:111], v[46:47], s[92:93], v[210:211] neg_lo:[0,0,1] neg_hi:[0,0,1]
  v_mov_b32_dpp v144, v224 quad_perm:[0,0,0,0] row_mask:0xf bank_mask:0xf
  v_mov_b32_dpp v145, v226 quad_perm:[2,2,2,2] row_mask:0xf bank_mask:0xf
  v_cvt_pk_bf16_f32 v108, 0, v108
  v_cvt_pk_bf16_f32 v109, 0, v109
  v_add_f32_dpp v144, v225, v144 quad_perm:[1,1,1,1] row_mask:0xf bank_mask:0xf
  v_add_f32_dpp v145, v227, v145 quad_perm:[3,3,3,3] row_mask:0xf bank_mask:0xf
  v_cvt_pk_bf16_f32 v110, 0, v110
  v_cvt_pk_bf16_f32 v111, 0, v111
  v_add_f32 v228, v144, v145
  v_pk_mul_f32 v[108:109], v[108:109], v[196:197]
  v_pk_mul_f32 v[110:111], v[110:111], v[198:199]
  v_cvt_pk_bf16_f32 v218, v108, v109
  v_cvt_pk_bf16_f32 v219, v110, v111
  s_waitcnt vmcnt(14)
  buffer_load_dwordx4 v[20:23], v94, s[8:11], s60 offen offset:2048 nt
  v_mfma_f32_16x16x32_bf16 v[224:227], v[216:219], v[168:171], 0
  v_pk_fma_f32 v[108:109], v[48:49], s[92:93], v[212:213] neg_lo:[0,0,1] neg_hi:[0,0,1]
  v_pk_fma_f32 v[110:111], v[50:51], s[92:93], v[214:215] neg_lo:[0,0,1] neg_hi:[0,0,1]
  v_cvt_pk_bf16_f32 v108, 0, v108
  v_cvt_pk_bf16_f32 v109, 0, v109
  v_cvt_pk_bf16_f32 v110, 0, v110
  v_cvt_pk_bf16_f32 v111, 0, v111
  v_pk_mul_f32 v[108:109], v[108:109], v[200:201]
  v_pk_mul_f32 v[110:111], v[110:111], v[202:203]
  v_cvt_pk_bf16_f32 v220, v108, v109
  v_cvt_pk_bf16_f32 v221, v110, v111
  s_waitcnt vmcnt(14)
  s_cbranch_vccnz L_kw0_12
  s_waitcnt vmcnt(9)
L_kw0_12:
  buffer_load_dwordx4 v[24:27], v94, s[8:11], s60 offen offset:2304 nt
  v_mfma_f32_16x16x16_bf16 v[224:227], v[220:221], v[172:173], v[224:227]
  v_pk_fma_f32 v[108:109], v[52:53], s[92:93], v[204:205] neg_lo:[0,0,1] neg_hi:[0,0,1]
  v_pk_fma_f32 v[110:111], v[54:55], s[92:93], v[206:207] neg_lo:[0,0,1] neg_hi:[0,0,1]
  v_cvt_pk_bf16_f32 v108, 0, v108
  v_cvt_pk_bf16_f32 v109, 0, v109
  v_cvt_pk_bf16_f32 v110, 0, v110
  v_cvt_pk_bf16_f32 v111, 0, v111
  v_pk_mul_f32 v[108:109], v[108:109], v[192:193]
  v_pk_mul_f32 v[110:111], v[110:111], v[194:195]
  v_cvt_pk_bf16_f32 v216, v108, v109
  v_cvt_pk_bf16_f32 v217, v110, v111
  s_waitcnt vmcnt(14)
  buffer_load_dwordx4 v[28:31], v94, s[8:11], s60 offen offset:2560 nt
  v_pk_fma_f32 v[108:109], v[56:57], s[92:93], v[208:209] neg_lo:[0,0,1] neg_hi:[0,0,1]
  v_pk_fma_f32 v[110:111], v[58:59], s[92:93], v[210:211] neg_lo:[0,0,1] neg_hi:[0,0,1]
  v_mov_b32_dpp v144, v224 quad_perm:[0,0,0,0] row_mask:0xf bank_mask:0xf
  v_mov_b32_dpp v145, v226 quad_perm:[2,2,2,2] row_mask:0xf bank_mask:0xf
  v_cvt_pk_bf16_f32 v108, 0, v108
  v_cvt_pk_bf16_f32 v109, 0, v109
  v_add_f32_dpp v144, v225, v144 quad_perm:[1,1,1,1] row_mask:0xf bank_mask:0xf
  v_add_f32_dpp v145, v227, v145 quad_perm:[3,3,3,3] row_mask:0xf bank_mask:0xf
  v_cvt_pk_bf16_f32 v110, 0, v110
  v_cvt_pk_bf16_f32 v111, 0, v111
  v_add_f32 v229, v144, v145
  v_pk_mul_f32 v[108:109], v[108:109], v[196:197]
  v_pk_mul_f32 v[110:111], v[110:111], v[198:199]
  v_cvt_pk_bf16_f32 v218, v108, v109
  v_cvt_pk_bf16_f32 v219, v110, v111
  s_waitcnt vmcnt(14)
  buffer_load_dwordx4 v[32:35], v94, s[8:11], s60 offen offset:2816 nt
  v_mfma_f32_16x16x32_bf16 v[224:227], v[216:219], v[168:171], 0
  v_pk_fma_f32 v[108:109], v[60:61], s[92:93], v[212:213] neg_lo:[0,0,1] neg_hi:[0,0,1]
  v_pk_fma_f32 v[110:111], v[62:63], s[92:93], v[214:215] neg_lo:[0,0,1] neg_hi:[0,0,1]
  v_cvt_pk_bf16_f32 v108, 0, v108
  v_cvt_pk_bf16_f32 v228, 0, v228
  v_cvt_pk_bf16_f32 v109, 0, v109
  v_cvt_pk_bf16_f32 v229, 0, v229
  v_cvt_pk_bf16_f32 v110, 0, v110
  v_pk_mul_f32 v[228:229], v[228:229], s[68:69]
  v_cvt_pk_bf16_f32 v111, 0, v111
  v_cvt_pk_bf16_f32 v121, v228, v229
  v_pk_mul_f32 v[108:109], v[108:109], v[200:201]
  v_pk_mul_f32 v[110:111], v[110:111], v[202:203]
  v_cvt_pk_bf16_f32 v220, v108, v109
  v_cvt_pk_bf16_f32 v221, v110, v111
  s_waitcnt vmcnt(14)
  s_cbranch_vccnz L_kw0_15
  s_waitcnt vmcnt(9)
L_kw0_15:
  buffer_load_dwordx4 v[36:39], v95, s[8:11], s60 offen offset:0 nt
  v_mfma_f32_16x16x16_bf16 v[224:227], v[220:221], v[172:173], v[224:227]
  v_pk_fma_f32 v[108:109], v[64:65], s[92:93], v[204:205] neg_lo:[0,0,1] neg_hi:[0,0,1]
  v_pk_fma_f32 v[110:111], v[66:67], s[92:93], v[206:207] neg_lo:[0,0,1] neg_hi:[0,0,1]
  v_cvt_pk_bf16_f32 v108, 0, v108
  v_cvt_pk_bf16_f32 v109, 0, v109
  v_cvt_pk_bf16_f32 v110, 0, v110
  v_cvt_pk_bf16_f32 v111, 0, v111
  v_pk_mul_f32 v[108:109], v[108:109], v[192:193]
  v_pk_mul_f32 v[110:111], v[110:111], v[194:195]
  v_cvt_pk_bf16_f32 v216, v108, v109
  v_cvt_pk_bf16_f32 v217, v110, v111
  s_waitcnt vmcnt(14)
  buffer_load_dwordx4 v[40:43], v95, s[8:11], s60 offen offset:256 nt
  v_pk_fma_f32 v[108:109], v[68:69], s[92:93], v[208:209] neg_lo:[0,0,1] neg_hi:[0,0,1]
  v_pk_fma_f32 v[110:111], v[70:71], s[92:93], v[210:211] neg_lo:[0,0,1] neg_hi:[0,0,1]
  v_mov_b32_dpp v144, v224 quad_perm:[0,0,0,0] row_mask:0xf bank_mask:0xf
  v_mov_b32_dpp v145, v226 quad_perm:[2,2,2,2] row_mask:0xf bank_mask:0xf
  v_cvt_pk_bf16_f32 v108, 0, v108
  v_cvt_pk_bf16_f32 v109, 0, v109
  v_add_f32_dpp v144, v225, v144 quad_perm:[1,1,1,1] row_mask:0xf bank_mask:0xf
  v_add_f32_dpp v145, v227, v145 quad_perm:[3,3,3,3] row_mask:0xf bank_mask:0xf
  v_cvt_pk_bf16_f32 v110, 0, v110
  v_cvt_pk_bf16_f32 v111, 0, v111
  v_add_f32 v228, v144, v145
  v_pk_mul_f32 v[108:109], v[108:109], v[196:197]
  v_pk_mul_f32 v[110:111], v[110:111], v[198:199]
  v_cvt_pk_bf16_f32 v218, v108, v109
  v_cvt_pk_bf16_f32 v219, v110, v111
  s_waitcnt vmcnt(14)
  buffer_load_dwordx4 v[44:47], v95, s[8:11], s60 offen offset:512 nt
  v_mfma_f32_16x16x32_bf16 v[224:227], v[216:219], v[168:171], 0
  v_pk_fma_f32 v[108:109], v[72:73], s[92:93], v[212:213] neg_lo:[0,0,1] neg_hi:[0,0,1]
  v_pk_fma_f32 v[110:111], v[74:75], s[92:93], v[214:215] neg_lo:[0,0,1] neg_hi:[0,0,1]
  s_cmp_lt_u32 s64, s99
  s_cbranch_scc1 L_k_known0
L_k_spin0:
  v_mov_b32 v144, 61696
  ds_read_b32 v144, v144
  s_waitcnt lgkmcnt(0)
  v_readfirstlane_b32 s96, v144
  s_nop 1
  s_cmp_eq_u32 s96, 0
  s_cbranch_scc1 L_k_spin0
  s_mov_b32 s99, -1
L_k_known0:
  s_lshr_b32 s71, s64, 4
  s_andn2_b32 s71, s71, 1
  s_lshr_b32 s71, 0x12, s71
  s_and_b32 s71, s71, 3
  s_lshr_b32 s85, s96, s71
  s_andn2_b32 s70, s64, 1
  s_or_b32 s70, s70, s4
  s_cmp_lt_u32 s64, 8
  s_cselect_b32 s70, s70, s64
  s_cselect_b32 s85, s64, s85
  s_and_b32 s85, s85, 1
  s_and_b32 s70, s70, 31
  s_lshl_b32 s71, s71, 12
  s_add_u32 s70, s70, s5
  s_add_u32 s70, s70, s71
  s_mul_hi_u32 s84, s70, s90
  s_lshr_b32 s84, s84, 1
  s_mul_i32 s71, s84, 3
  s_sub_u32 s70, s70, s71
  s_lshl3_add_u32 s85, s70, s85
  s_mul_i32 s61, s84, 196608
  s_lshr_b32 s89, s84, 4
  s_lshl_b32 s70, s85, 5
  v_add_u32 v97, s70, v230
  v_mul_u32_u24 v97, 21846, v97
  v_lshrrev_b32 v97, 16, v97
  v_add_u32 v144, s85, v231
  v_lshrrev_b32 v145, v144, s91
  v_and_b32 v145, 1, v145
  v_cmp_eq_u32 s[54:55], 1, v145
  s_nop 1
  s_and_b64 s[52:53], s[54:55], s[56:57]
  s_andn2_b64 s[54:55], s[54:55], s[56:57]
  v_mul_u32_u24 v144, 43, v144
  v_lshrrev_b32 v144, 8, v144
  v_mul_u32_u24 v144, 384, v144
  v_add_u32 v234, v144, v233
  s_cmp_eq_u32 s89, s88
  s_cbranch_scc1 L_k_sameq0
  s_mul_i32 s70, s89, 1536
  buffer_load_dwordx2 v[174:175], v235, s[36:39], s70 offen offset:0
  buffer_load_dwordx2 v[176:177], v235, s[36:39], s70 offen offset:128
  buffer_load_dwordx2 v[178:179], v235, s[36:39], s70 offen offset:256
  s_mov_b32 s88, s89
L_k_sameq0:
  s_mul_i32 s62, s84, 1536
  buffer_load_dwordx2 v[180:181], v234, s[20:23], s62 offen offset:0
  buffer_load_dwordx2 v[186:187], v234, s[24:27], s62 offen offset:0
  buffer_load_dwordx2 v[182:183], v234, s[20:23], s62 offen offset:128
  buffer_load_dwordx2 v[188:189], v234, s[24:27], s62 offen offset:128
  buffer_load_dwordx2 v[184:185], v234, s[20:23], s62 offen offset:256
  buffer_load_dwordx2 v[190:191], v234, s[24:27], s62 offen offset:256
  v_cvt_pk_bf16_f32 v108, 0, v108
  v_cvt_pk_bf16_f32 v109, 0, v109
  v_cvt_pk_bf16_f32 v110, 0, v110
  v_cvt_pk_bf16_f32 v111, 0, v111
  v_pk_mul_f32 v[108:109], v[108:109], v[200:201]
  v_pk_mul_f32 v[110:111], v[110:111], v[202:203]
  v_cvt_pk_bf16_f32 v220, v108, v109
  v_cvt_pk_bf16_f32 v221, v110, v111
  v_mad_u32_u24 v92, v97, s63, v232
  v_add_u32 v93, 768, v92
  v_add_u32 v94, 4608, v92
  v_add_u32 v95, 7680, v92
  v_cndmask_b32 v92, v92, v105, s[52:53]
  v_cndmask_b32 v95, v95, v105, s[54:55]
  s_waitcnt vmcnt(20)
  s_cbranch_vccnz L_kw0_18
  s_waitcnt vmcnt(15)
L_kw0_18:
  buffer_load_dwordx4 v[48:51], v92, s[16:19], s61 offen offset:0 nt
  v_mfma_f32_16x16x16_bf16 v[224:227], v[220:221], v[172:173], v[224:227]
  v_pk_fma_f32 v[108:109], v[76:77], s[92:93], v[204:205] neg_lo:[0,0,1] neg_hi:[0,0,1]
  v_pk_fma_f32 v[110:111], v[78:79], s[92:93], v[206:207] neg_lo:[0,0,1] neg_hi:[0,0,1]
  v_cvt_pk_bf16_f32 v108, 0, v108
  v_cvt_pk_bf16_f32 v109, 0, v109
  v_cvt_pk_bf16_f32 v110, 0, v110
  v_cvt_pk_bf16_f32 v111, 0, v111
  v_pk_mul_f32 v[108:109], v[108:109], v[192:193]
  v_pk_mul_f32 v[110:111], v[110:111], v[194:195]
  v_cvt_pk_bf16_f32 v216, v108, v109
  v_cvt_pk_bf16_f32 v217, v110, v111
  s_waitcnt vmcnt(20)
  buffer_load_dwordx4 v[52:55], v92, s[16:19], s61 offen offset:256 nt
  v_pk_fma_f32 v[108:109], v[80:81], s[92:93], v[208:209] neg_lo:[0,0,1] neg_hi:[0,0,1]
  v_pk_fma_f32 v[110:111], v[82:83], s[92:93], v[210:211] neg_lo:[0,0,1] neg_hi:[0,0,1]
  v_mov_b32_dpp v144, v224 quad_perm:[0,0,0,0] row_mask:0xf bank_mask:0xf
  v_mov_b32_dpp v145, v226 quad_perm:[2,2,2,2] row_mask:0xf bank_mask:0xf
  v_cvt_pk_bf16_f32 v108, 0, v108
  v_cvt_pk_bf16_f32 v109, 0, v109
  v_add_f32_dpp v144, v225, v144 quad_perm:[1,1,1,1] row_mask:0xf bank_mask:0xf
  v_add_f32_dpp v145, v227, v145 quad_perm:[3,3,3,3] row_mask:0xf bank_mask:0xf
  v_cvt_pk_bf16_f32 v110, 0, v110
  v_cvt_pk_bf16_f32 v111, 0, v111
  v_add_f32 v229, v144, v145
  v_pk_mul_f32 v[108:109], v[108:109], v[196:197]
  v_pk_mul_f32 v[110:111], v[110:111], v[198:199]
  v_cvt_pk_bf16_f32 v218, v108, v109
  v_cvt_pk_bf16_f32 v219, v110, v111
  s_waitcnt vmcnt(20)
  buffer_load_dwordx4 v[56:59], v92, s[16:19], s61 offen offset:512 nt
  v_mfma_f32_16x16x32_bf16 v[224:227], v[216:219], v[168:171], 0
  v_pk_fma_f32 v[108:109], v[84:85], s[92:93], v[212:213] neg_lo:[0,0,1] neg_hi:[0,0,1]
  v_pk_fma_f32 v[110:111], v[86:87], s[92:93], v[214:215] neg_lo:[0,0,1] neg_hi:[0,0,1]
  v_cvt_pk_bf16_f32 v108, 0, v108
  v_cvt_pk_bf16_f32 v228, 0, v228
  v_cvt_pk_bf16_f32 v109, 0, v109
  v_cvt_pk_bf16_f32 v229, 0, v229
  v_cvt_pk_bf16_f32 v110, 0, v110
  v_pk_mul_f32 v[228:229], v[228:229], s[68:69]
  v_cvt_pk_bf16_f32 v111, 0, v111
  v_cvt_pk_bf16_f32 v122, v228, v229
  v_pk_mul_f32 v[108:109], v[108:109], v[200:201]
  v_pk_mul_f32 v[110:111], v[110:111], v[202:203]
  v_cvt_pk_bf16_f32 v220, v108, v109
  v_cvt_pk_bf16_f32 v221, v110, v111
  s_waitcnt vmcnt(20)
  s_cbranch_vccnz L_kw0_21
  s_waitcnt vmcnt(15)
L_kw0_21:
  buffer_load_dwordx4 v[60:63], v93, s[16:19], s61 offen offset:0 nt
  v_mfma_f32_16x16x16_bf16 v[224:227], v[220:221], v[172:173], v[224:227]
  v_pk_fma_f32 v[108:109], v[88:89], s[92:93], v[204:205] neg_lo:[0,0,1] neg_hi:[0,0,1]
  v_pk_fma_f32 v[110:111], v[90:91], s[92:93], v[206:207] neg_lo:[0,0,1] neg_hi:[0,0,1]
  v_cvt_pk_bf16_f32 v108, 0, v108
  v_cvt_pk_bf16_f32 v109, 0, v109
  v_cvt_pk_bf16_f32 v110, 0, v110
  v_cvt_pk_bf16_f32 v111, 0, v111
  v_pk_mul_f32 v[108:109], v[108:109], v[192:193]
  v_pk_mul_f32 v[110:111], v[110:111], v[194:195]
  v_cvt_pk_bf16_f32 v216, v108, v109
  v_cvt_pk_bf16_f32 v217, v110, v111
  s_waitcnt vmcnt(20)
  buffer_load_dwordx4 v[64:67], v93, s[16:19], s61 offen offset:256 nt
  v_pk_fma_f32 v[108:109], v[4:5], s[92:93], v[208:209] neg_lo:[0,0,1] neg_hi:[0,0,1]
  v_pk_fma_f32 v[110:111], v[6:7], s[92:93], v[210:211] neg_lo:[0,0,1] neg_hi:[0,0,1]
  v_mov_b32_dpp v144, v224 quad_perm:[0,0,0,0] row_mask:0xf bank_mask:0xf
  v_mov_b32_dpp v145, v226 quad_perm:[2,2,2,2] row_mask:0xf bank_mask:0xf
  v_cvt_pk_bf16_f32 v108, 0, v108
  v_cvt_pk_bf16_f32 v109, 0, v109
  v_add_f32_dpp v144, v225, v144 quad_perm:[1,1,1,1] row_mask:0xf bank_mask:0xf
  v_add_f32_dpp v145, v227, v145 quad_perm:[3,3,3,3] row_mask:0xf bank_mask:0xf
  v_cvt_pk_bf16_f32 v110, 0, v110
  v_cvt_pk_bf16_f32 v111, 0, v111
  v_add_f32 v228, v144, v145
  v_pk_mul_f32 v[108:109], v[108:109], v[196:197]
  v_pk_mul_f32 v[110:111], v[110:111], v[198:199]
  v_cvt_pk_bf16_f32 v218, v108, v109
  v_cvt_pk_bf16_f32 v219, v110, v111
  s_waitcnt vmcnt(20)
  buffer_load_dwordx4 v[68:71], v93, s[16:19], s61 offen offset:512 nt
  v_mfma_f32_16x16x32_bf16 v[224:227], v[216:219], v[168:171], 0
  v_pk_fma_f32 v[108:109], v[8:9], s[92:93], v[212:213] neg_lo:[0,0,1] neg_hi:[0,0,1]
  v_pk_fma_f32 v[110:111], v[10:11], s[92:93], v[214:215] neg_lo:[0,0,1] neg_hi:[0,0,1]
  v_cvt_pk_bf16_f32 v108, 0, v108
  v_cvt_pk_bf16_f32 v109, 0, v109
  v_cvt_pk_bf16_f32 v110, 0, v110
  v_cvt_pk_bf16_f32 v111, 0, v111
  v_pk_mul_f32 v[108:109], v[108:109], v[200:201]
  v_pk_mul_f32 v[110:111], v[110:111], v[202:203]
  v_cvt_pk_bf16_f32 v220, v108, v109
  v_cvt_pk_bf16_f32 v221, v110, v111
  s_waitcnt vmcnt(20)
  s_cbranch_vccnz L_kw0_24
  s_waitcnt vmcnt(15)
L_kw0_24:
  buffer_load_dwordx4 v[72:75], v93, s[16:19], s61 offen offset:768 nt
  v_mfma_f32_16x16x16_bf16 v[224:227], v[220:221], v[172:173], v[224:227]
  v_pk_fma_f32 v[108:109], v[12:13], s[92:93], v[204:205] neg_lo:[0,0,1] neg_hi:[0,0,1]
  v_pk_fma_f32 v[110:111], v[14:15], s[92:93], v[206:207] neg_lo:[0,0,1] neg_hi:[0,0,1]
  v_cvt_pk_bf16_f32 v108, 0, v108
  v_cvt_pk_bf16_f32 v109, 0, v109
  v_cvt_pk_bf16_f32 v110, 0, v110
  v_cvt_pk_bf16_f32 v111, 0, v111
  v_pk_mul_f32 v[108:109], v[108:109], v[192:193]
  v_pk_mul_f32 v[110:111], v[110:111], v[194:195]
  v_cvt_pk_bf16_f32 v216, v108, v109
  v_cvt_pk_bf16_f32 v217, v110, v111
  s_waitcnt vmcnt(20)
  buffer_load_dwordx4 v[76:79], v93, s[16:19], s61 offen offset:1024 nt
  v_pk_fma_f32 v[108:109], v[16:17], s[92:93], v[208:209] neg_lo:[0,0,1] neg_hi:[0,0,1]
  v_pk_fma_f32 v[110:111], v[18:19], s[92:93], v[210:211] neg_lo:[0,0,1] neg_hi:[0,0,1]
  v_mov_b32_dpp v144, v224 quad_perm:[0,0,0,0] row_mask:0xf bank_mask:0xf
  v_mov_b32_dpp v145, v226 quad_perm:[2,2,2,2] row_mask:0xf bank_mask:0xf
  v_cvt_pk_bf16_f32 v108, 0, v108
  v_cvt_pk_bf16_f32 v109, 0, v109
  v_add_f32_dpp v144, v225, v144 quad_perm:[1,1,1,1] row_mask:0xf bank_mask:0xf
  v_add_f32_dpp v145, v227, v145 quad_perm:[3,3,3,3] row_mask:0xf bank_mask:0xf
  v_cvt_pk_bf16_f32 v110, 0, v110
  v_cvt_pk_bf16_f32 v111, 0, v111
  v_add_f32 v229, v144, v145
  v_pk_mul_f32 v[108:109], v[108:109], v[196:197]
  v_pk_mul_f32 v[110:111], v[110:111], v[198:199]
  v_cvt_pk_bf16_f32 v218, v108, v109
  v_cvt_pk_bf16_f32 v219, v110, v111
  s_waitcnt vmcnt(20)
  buffer_load_dwordx4 v[80:83], v93, s[16:19], s61 offen offset:1280 nt
  v_mfma_f32_16x16x32_bf16 v[224:227], v[216:219], v[168:171], 0
  v_pk_fma_f32 v[108:109], v[20:21], s[92:93], v[212:213] neg_lo:[0,0,1] neg_hi:[0,0,1]
  v_pk_fma_f32 v[110:111], v[22:23], s[92:93], v[214:215] neg_lo:[0,0,1] neg_hi:[0,0,1]
  v_cvt_pk_bf16_f32 v108, 0, v108
  v_cvt_pk_bf16_f32 v228, 0, v228
  v_cvt_pk_bf16_f32 v109, 0, v109
  v_cvt_pk_bf16_f32 v229, 0, v229
  v_cvt_pk_bf16_f32 v110, 0, v110
  v_pk_mul_f32 v[228:229], v[228:229], s[68:69]
  v_cvt_pk_bf16_f32 v111, 0, v111
  v_cvt_pk_bf16_f32 v123, v228, v229
  v_pk_mul_f32 v[108:109], v[108:109], v[200:201]
  v_pk_mul_f32 v[110:111], v[110:111], v[202:203]
  v_cvt_pk_bf16_f32 v220, v108, v109
  v_cvt_pk_bf16_f32 v221, v110, v111
  s_waitcnt vmcnt(20)
  s_cbranch_vccnz L_kw0_27
  s_waitcnt vmcnt(15)
L_kw0_27:
  buffer_load_dwordx4 v[84:87], v93, s[16:19], s61 offen offset:1536 nt
  v_mfma_f32_16x16x16_bf16 v[224:227], v[220:221], v[172:173], v[224:227]
  v_pk_fma_f32 v[108:109], v[24:25], s[92:93], v[204:205] neg_lo:[0,0,1] neg_hi:[0,0,1]
  v_pk_fma_f32 v[110:111], v[26:27], s[92:93], v[206:207] neg_lo:[0,0,1] neg_hi:[0,0,1]
  v_cvt_pk_bf16_f32 v108, 0, v108
  v_cvt_pk_bf16_f32 v109, 0, v109
  v_cvt_pk_bf16_f32 v110, 0, v110
  v_cvt_pk_bf16_f32 v111, 0, v111
  v_pk_mul_f32 v[108:109], v[108:109], v[192:193]
  v_pk_mul_f32 v[110:111], v[110:111], v[194:195]
  v_cvt_pk_bf16_f32 v216, v108, v109
  v_cvt_pk_bf16_f32 v217, v110, v111
  s_waitcnt vmcnt(20)
  buffer_load_dwordx4 v[88:91], v93, s[16:19], s61 offen offset:1792 nt
  v_pk_fma_f32 v[108:109], v[28:29], s[92:93], v[208:209] neg_lo:[0,0,1] neg_hi:[0,0,1]
  v_pk_fma_f32 v[110:111], v[30:31], s[92:93], v[210:211] neg_lo:[0,0,1] neg_hi:[0,0,1]
  v_mov_b32_dpp v144, v224 quad_perm:[0,0,0,0] row_mask:0xf bank_mask:0xf
  v_mov_b32_dpp v145, v226 quad_perm:[2,2,2,2] row_mask:0xf bank_mask:0xf
  v_cvt_pk_bf16_f32 v108, 0, v108
  v_cvt_pk_bf16_f32 v109, 0, v109
  v_add_f32_dpp v144, v225, v144 quad_perm:[1,1,1,1] row_mask:0xf bank_mask:0xf
  v_add_f32_dpp v145, v227, v145 quad_perm:[3,3,3,3] row_mask:0xf bank_mask:0xf
  v_cvt_pk_bf16_f32 v110, 0, v110
  v_cvt_pk_bf16_f32 v111, 0, v111
  v_add_f32 v228, v144, v145
  v_pk_mul_f32 v[108:109], v[108:109], v[196:197]
  v_pk_mul_f32 v[110:111], v[110:111], v[198:199]
  v_cvt_pk_bf16_f32 v218, v108, v109
  v_cvt_pk_bf16_f32 v219, v110, v111
  s_waitcnt vmcnt(20)
  buffer_load_dwordx4 v[4:7], v93, s[16:19], s61 offen offset:2048 nt
  v_mfma_f32_16x16x32_bf16 v[224:227], v[216:219], v[168:171], 0
  v_pk_fma_f32 v[108:109], v[32:33], s[92:93], v[212:213] neg_lo:[0,0,1] neg_hi:[0,0,1]
  v_pk_fma_f32 v[110:111], v[34:35], s[92:93], v[214:215] neg_lo:[0,0,1] neg_hi:[0,0,1]
  v_cvt_pk_bf16_f32 v108, 0, v108
  v_cvt_pk_bf16_f32 v109, 0, v109
  v_cvt_pk_bf16_f32 v110, 0, v110
  v_cvt_pk_bf16_f32 v111, 0, v111
  v_pk_mul_f32 v[108:109], v[108:109], v[200:201]
  v_pk_mul_f32 v[110:111], v[110:111], v[202:203]
  v_cvt_pk_bf16_f32 v220, v108, v109
  v_cvt_pk_bf16_f32 v221, v110, v111
  s_waitcnt vmcnt(20)
  s_cbranch_vccnz L_kw0_30
  s_waitcnt vmcnt(9)
L_kw0_30:
  buffer_load_dwordx4 v[8:11], v93, s[16:19], s61 offen offset:2304 nt
  v_mfma_f32_16x16x16_bf16 v[224:227], v[220:221], v[172:173], v[224:227]
  v_pk_fma_f32 v[108:109], v[36:37], s[92:93], v[204:205] neg_lo:[0,0,1] neg_hi:[0,0,1]
  v_pk_fma_f32 v[110:111], v[38:39], s[92:93], v[206:207] neg_lo:[0,0,1] neg_hi:[0,0,1]
  v_cvt_pk_bf16_f32 v108, 0, v108
  v_cvt_pk_bf16_f32 v109, 0, v109
  v_cvt_pk_bf16_f32 v110, 0, v110
  v_cvt_pk_bf16_f32 v111, 0, v111
  v_pk_mul_f32 v[108:109], v[108:109], v[192:193]
  v_pk_mul_f32 v[110:111], v[110:111], v[194:195]
  v_cvt_pk_bf16_f32 v216, v108, v109
  v_cvt_pk_bf16_f32 v217, v110, v111
  s_waitcnt vmcnt(20)
  buffer_load_dwordx4 v[12:15], v93, s[16:19], s61 offen offset:2560 nt
  v_pk_fma_f32 v[108:109], v[40:41], s[92:93], v[208:209] neg_lo:[0,0,1] neg_hi:[0,0,1]
  v_pk_fma_f32 v[110:111], v[42:43], s[92:93], v[210:211] neg_lo:[0,0,1] neg_hi:[0,0,1]
  v_mov_b32_dpp v144, v224 quad_perm:[0,0,0,0] row_mask:0xf bank_mask:0xf
  v_mov_b32_dpp v145, v226 quad_perm:[2,2,2,2] row_mask:0xf bank_mask:0xf
  v_cvt_pk_bf16_f32 v108, 0, v108
  v_cvt_pk_bf16_f32 v109, 0, v109
  v_add_f32_dpp v144, v225, v144 quad_perm:[1,1,1,1] row_mask:0xf bank_mask:0xf
  v_add_f32_dpp v145, v227, v145 quad_perm:[3,3,3,3] row_mask:0xf bank_mask:0xf
  v_cvt_pk_bf16_f32 v110, 0, v110
  v_cvt_pk_bf16_f32 v111, 0, v111
  v_add_f32 v229, v144, v145
  v_pk_mul_f32 v[108:109], v[108:109], v[196:197]
  v_pk_mul_f32 v[110:111], v[110:111], v[198:199]
  v_cvt_pk_bf16_f32 v218, v108, v109
  v_cvt_pk_bf16_f32 v219, v110, v111
  s_waitcnt vmcnt(20)
  buffer_load_dwordx4 v[16:19], v93, s[16:19], s61 offen offset:2816 nt
  v_mfma_f32_16x16x32_bf16 v[224:227], v[216:219], v[168:171], 0
  v_pk_fma_f32 v[108:109], v[44:45], s[92:93], v[212:213] neg_lo:[0,0,1] neg_hi:[0,0,1]
  v_pk_fma_f32 v[110:111], v[46:47], s[92:93], v[214:215] neg_lo:[0,0,1] neg_hi:[0,0,1]
  v_cvt_pk_bf16_f32 v108, 0, v108
  v_cvt_pk_bf16_f32 v228, 0, v228
  v_cvt_pk_bf16_f32 v109, 0, v109
  v_cvt_pk_bf16_f32 v229, 0, v229
  v_cvt_pk_bf16_f32 v110, 0, v110
  v_pk_mul_f32 v[228:229], v[228:229], s[68:69]
  v_cvt_pk_bf16_f32 v111, 0, v111
  v_cvt_pk_bf16_f32 v124, v228, v229
  v_pk_mul_f32 v[108:109], v[108:109], v[200:201]
  v_pk_mul_f32 v[110:111], v[110:111], v[202:203]
  v_cvt_pk_bf16_f32 v220, v108, v109
  v_cvt_pk_bf16_f32 v221, v110, v111
  s_mov_b32 s60, s61
  v_mov_b32 v146, s64
  v_mfma_f32_16x16x16_bf16 v[224:227], v[220:221], v[172:173], v[224:227]
  ds_write_b128 v99, v[120:123]
  v_add_u32 v99, 768, v99
  s_nop 5
  v_mov_b32_dpp v144, v224 quad_perm:[0,0,0,0] row_mask:0xf bank_mask:0xf
  v_mov_b32_dpp v145, v226 quad_perm:[2,2,2,2] row_mask:0xf bank_mask:0xf
  s_nop 0
  v_add_f32_dpp v144, v225, v144 quad_perm:[1,1,1,1] row_mask:0xf bank_mask:0xf
  v_add_f32_dpp v145, v227, v145 quad_perm:[3,3,3,3] row_mask:0xf bank_mask:0xf
  v_add_f32 v228, v144, v145
  v_cndmask_b32 v228, v228, v236, s[50:51]
  v_cvt_pk_bf16_f32 v228, 0, v228
  v_cvt_pk_bf16_f32 v229, 0, v229
  v_pk_mul_f32 v[228:229], v[228:229], s[68:69]
  v_cvt_pk_bf16_f32 v125, v228, v229
  ds_write_b64 v100, v[124:125] offset:256
  ds_write_b32 v104, v146
  v_add_u32 v100, 768, v100
  v_add_u32 v144, s85, v2
  v_lshrrev_b32 v145, v144, s91
  v_and_b32 v145, 1, v145
  v_cmp_eq_u32 s[50:51], 1, v145
  s_nop 1
  s_and_b64 s[48:49], s[50:51], s[58:59]
  s_andn2_b64 s[50:51], s[50:51], s[58:59]
  s_mov_b32 s97, s64
  s_add_u32 s64, s64, 2
  ds_read_b32 v106, v104 offset:8
  s_waitcnt vmcnt(14)
  s_cbranch_vccnz L_kw1_0
  s_waitcnt vmcnt(9)
L_kw1_0:
  buffer_load_dwordx4 v[20:23], v93, s[8:11], s60 offen offset:3072 nt
  v_lshlrev_b32 v204, 16, v186
  v_and_b32 v205, s65, v186
  v_lshlrev_b32 v206, 16, v187
  v_and_b32 v207, s65, v187
  v_lshlrev_b32 v192, 16, v180
  v_and_b32 v193, s65, v180
  v_lshlrev_b32 v194, 16, v181
  v_and_b32 v195, s65, v181
  v_pk_mul_f32 v[204:205], v[204:205], s[94:95]
  v_mov_b32 v168, v174
  v_pk_mul_f32 v[206:207], v[206:207], s[94:95]
  v_mov_b32 v169, v175
  v_pk_fma_f32 v[108:109], v[48:49], s[92:93], v[204:205] neg_lo:[0,0,1] neg_hi:[0,0,1]
  v_pk_fma_f32 v[110:111], v[50:51], s[92:93], v[206:207] neg_lo:[0,0,1] neg_hi:[0,0,1]
  v_cvt_pk_bf16_f32 v108, 0, v108
  v_cvt_pk_bf16_f32 v109, 0, v109
  v_cvt_pk_bf16_f32 v110, 0, v110
  v_cvt_pk_bf16_f32 v111, 0, v111
  v_pk_mul_f32 v[108:109], v[108:109], v[192:193]
  v_pk_mul_f32 v[110:111], v[110:111], v[194:195]
  v_cvt_pk_bf16_f32 v216, v108, v109
  v_cvt_pk_bf16_f32 v217, v110, v111
  s_waitcnt lgkmcnt(0)
  v_cmp_lt_u32 vcc, s97, v106
  s_waitcnt vmcnt(14)
  buffer_load_dwordx4 v[24:27], v93, s[8:11], s60 offen offset:3328 nt
  v_lshlrev_b32 v208, 16, v188
  v_and_b32 v209, s65, v188
  v_lshlrev_b32 v210, 16, v189
  v_and_b32 v211, s65, v189
  v_lshlrev_b32 v196, 16, v182
  v_and_b32 v197, s65, v182
  v_lshlrev_b32 v198, 16, v183
  v_and_b32 v199, s65, v183
  v_pk_mul_f32 v[208:209], v[208:209], s[94:95]
  v_mov_b32 v170, v176
  v_pk_mul_f32 v[210:211], v[210:211], s[94:95]
  v_mov_b32 v171, v177
  v_pk_fma_f32 v[108:109], v[52:53], s[92:93], v[208:209] neg_lo:[0,0,1] neg_hi:[0,0,1]
  v_pk_fma_f32 v[110:111], v[54:55], s[92:93], v[210:211] neg_lo:[0,0,1] neg_hi:[0,0,1]
  v_cvt_pk_bf16_f32 v108, 0, v108
  v_cvt_pk_bf16_f32 v109, 0, v109
  v_cvt_pk_bf16_f32 v110, 0, v110
  v_cvt_pk_bf16_f32 v111, 0, v111
  v_pk_mul_f32 v[108:109], v[108:109], v[196:197]
  v_pk_mul_f32 v[110:111], v[110:111], v[198:199]
  v_cvt_pk_bf16_f32 v218, v108, v109
  v_cvt_pk_bf16_f32 v219, v110, v111
  s_waitcnt vmcnt(14)
  buffer_load_dwordx4 v[28:31], v93, s[8:11], s60 offen offset:3584 nt
  v_mfma_f32_16x16x32_bf16 v[224:227], v[216:219], v[168:171], 0
  v_lshlrev_b32 v212, 16, v190
  v_and_b32 v213, s65, v190
  v_lshlrev_b32 v214, 16, v191
  v_and_b32 v215, s65, v191
  v_lshlrev_b32 v200, 16, v184
  v_and_b32 v201, s65, v184
  v_lshlrev_b32 v202, 16, v185
  v_and_b32 v203, s65, v185
  v_pk_mul_f32 v[212:213], v[212:213], s[94:95]
  v_mov_b32 v172, v178
  v_pk_mul_f32 v[214:215], v[214:215], s[94:95]
  v_mov_b32 v173, v179
  v_pk_fma_f32 v[108:109], v[56:57], s[92:93], v[212:213] neg_lo:[0,0,1] neg_hi:[0,0,1]
  v_pk_fma_f32 v[110:111], v[58:59], s[92:93], v[214:215] neg_lo:[0,0,1] neg_hi:[0,0,1]
  v_cvt_pk_bf16_f32 v108, 0, v108
  v_cvt_pk_bf16_f32 v109, 0, v109
  v_cvt_pk_bf16_f32 v110, 0, v110
  v_cvt_pk_bf16_f32 v111, 0, v111
  v_pk_mul_f32 v[108:109], v[108:109], v[200:201]
  v_pk_mul_f32 v[110:111], v[110:111], v[202:203]
  v_cvt_pk_bf16_f32 v220, v108, v109
  v_cvt_pk_bf16_f32 v221, v110, v111
  s_waitcnt vmcnt(14)
  s_cbranch_vccnz L_kw1_3
  s_waitcnt vmcnt(9)
L_kw1_3:
  buffer_load_dwordx4 v[32:35], v94, s[8:11], s60 offen offset:0 nt
  v_mfma_f32_16x16x16_bf16 v[224:227], v[220:221], v[172:173], v[224:227]
  v_pk_fma_f32 v[108:109], v[60:61], s[92:93], v[204:205] neg_lo:[0,0,1] neg_hi:[0,0,1]
  v_pk_fma_f32 v[110:111], v[62:63], s[92:93], v[206:207] neg_lo:[0,0,1] neg_hi:[0,0,1]
  v_cvt_pk_bf16_f32 v108, 0, v108
  v_cvt_pk_bf16_f32 v109, 0, v109
  v_cvt_pk_bf16_f32 v110, 0, v110
  v_cvt_pk_bf16_f32 v111, 0, v111
  v_pk_mul_f32 v[108:109], v[108:109], v[192:193]
  v_pk_mul_f32 v[110:111], v[110:111], v[194:195]
  v_cvt_pk_bf16_f32 v216, v108, v109
  v_cvt_pk_bf16_f32 v217, v110, v111
  s_waitcnt vmcnt(14)
  buffer_load_dwordx4 v[36:39], v94, s[8:11], s60 offen offset:256 nt
  v_pk_fma_f32 v[108:109], v[64:65], s[92:93], v[208:209] neg_lo:[0,0,1] neg_hi:[0,0,1]
  v_pk_fma_f32 v[110:111], v[66:67], s[92:93], v[210:211] neg_lo:[0,0,1] neg_hi:[0,0,1]
  v_mov_b32_dpp v144, v224 quad_perm:[0,0,0,0] row_mask:0xf bank_mask:0xf
  v_mov_b32_dpp v145, v226 quad_perm:[2,2,2,2] row_mask:0xf bank_mask:0xf
  v_cvt_pk_bf16_f32 v108, 0, v108
  v_cvt_pk_bf16_f32 v109, 0, v109
  v_add_f32_dpp v144, v225, v144 quad_perm:[1,1,1,1] row_mask:0xf bank_mask:0xf
  v_add_f32_dpp v145, v227, v145 quad_perm:[3,3,3,3] row_mask:0xf bank_mask:0xf
  v_cvt_pk_bf16_f32 v110, 0, v110
  v_cvt_pk_bf16_f32 v111, 0, v111
  v_add_f32 v228, v144, v145
  v_pk_mul_f32 v[108:109], v[108:109], v[196:197]
  v_pk_mul_f32 v[110:111], v[110:111], v[198:199]
  v_cvt_pk_bf16_f32 v218, v108, v109
  v_cvt_pk_bf16_f32 v219, v110, v111
  s_waitcnt vmcnt(14)
  buffer_load_dwordx4 v[40:43], v94, s[8:11], s60 offen offset:512 nt
  v_mfma_f32_16x16x32_bf16 v[224:227], v[216:219], v[168:171], 0
  v_pk_fma_f32 v[108:109], v[68:69], s[92:93], v[212:213] neg_lo:[0,0,1] neg_hi:[0,0,1]
  v_pk_fma_f32 v[110:111], v[70:71], s[92:93], v[214:215] neg_lo:[0,0,1] neg_hi:[0,0,1]
  v_cvt_pk_bf16_f32 v108, 0, v108
  v_cndmask_b32 v228, v228, v236, s[48:49]
  v_cvt_pk_bf16_f32 v109, 0, v109
  v_cvt_pk_bf16_f32 v110, 0, v110
  v_cvt_pk_bf16_f32 v111, 0, v111
  v_pk_mul_f32 v[108:109], v[108:109], v[200:201]
  v_pk_mul_f32 v[110:111], v[110:111], v[202:203]
  v_cvt_pk_bf16_f32 v220, v108, v109
  v_cvt_pk_bf16_f32 v221, v110, v111
  s_waitcnt vmcnt(14)
  s_cbranch_vccnz L_kw1_6
  s_waitcnt vmcnt(9)
L_kw1_6:
  buffer_load_dwordx4 v[44:47], v94, s[8:11], s60 offen offset:768 nt
  v_mfma_f32_16x16x16_bf16 v[224:227], v[220:221], v[172:173], v[224:227]
  v_pk_fma_f32 v[108:109], v[72:73], s[92:93], v[204:205] neg_lo:[0,0,1] neg_hi:[0,0,1]
  v_pk_fma_f32 v[110:111], v[74:75], s[92:93], v[206:207] neg_lo:[0,0,1] neg_hi:[0,0,1]
  v_cvt_pk_bf16_f32 v108, 0, v108
  v_cvt_pk_bf16_f32 v109, 0, v109
  v_cvt_pk_bf16_f32 v110, 0, v110
  v_cvt_pk_bf16_f32 v111, 0, v111
  v_pk_mul_f32 v[108:109], v[108:109], v[192:193]
  v_pk_mul_f32 v[110:111], v[110:111], v[194:195]
  v_cvt_pk_bf16_f32 v216, v108, v109
  v_cvt_pk_bf16_f32 v217, v110, v111
  s_waitcnt vmcnt(14)
  buffer_load_dwordx4 v[48:51], v94, s[8:11], s60 offen offset:1024 nt
  v_pk_fma_f32 v[108:109], v[76:77], s[92:93], v[208:209] neg_lo:[0,0,1] neg_hi:[0,0,1]
  v_pk_fma_f32 v[110:111], v[78:79], s[92:93], v[210:211] neg_lo:[0,0,1] neg_hi:[0,0,1]
  v_mov_b32_dpp v144, v224 quad_perm:[0,0,0,0] row_mask:0xf bank_mask:0xf
  v_mov_b32_dpp v145, v226 quad_perm:[2,2,2,2] row_mask:0xf bank_mask:0xf
  v_cvt_pk_bf16_f32 v108, 0, v108
  v_cvt_pk_bf16_f32 v109, 0, v109
  v_add_f32_dpp v144, v225, v144 quad_perm:[1,1,1,1] row_mask:0xf bank_mask:0xf
  v_add_f32_dpp v145, v227, v145 quad_perm:[3,3,3,3] row_mask:0xf bank_mask:0xf
  v_cvt_pk_bf16_f32 v110, 0, v110
  v_cvt_pk_bf16_f32 v111, 0, v111
  v_add_f32 v229, v144, v145
  v_pk_mul_f32 v[108:109], v[108:109], v[196:197]
  v_pk_mul_f32 v[110:111], v[110:111], v[198:199]
  v_cvt_pk_bf16_f32 v218, v108, v109
  v_cvt_pk_bf16_f32 v219, v110, v111
  s_waitcnt vmcnt(14)
  buffer_load_dwordx4 v[52:55], v94, s[8:11], s60 offen offset:1280 nt
  v_mfma_f32_16x16x32_bf16 v[224:227], v[216:219], v[168:171], 0
  v_pk_fma_f32 v[108:109], v[80:81], s[92:93], v[212:213] neg_lo:[0,0,1] neg_hi:[0,0,1]
  v_pk_fma_f32 v[110:111], v[82:83], s[92:93], v[214:215] neg_lo:[0,0,1] neg_hi:[0,0,1]
  v_cvt_pk_bf16_f32 v108, 0, v108
  v_cvt_pk_bf16_f32 v228, 0, v228
  v_cvt_pk_bf16_f32 v109, 0, v109
  v_cvt_pk_bf16_f32 v229, 0, v229
  v_cvt_pk_bf16_f32 v110, 0, v110
  v_pk_mul_f32 v[228:229], v[228:229], s[68:69]
  v_cvt_pk_bf16_f32 v111, 0, v111
  v_cvt_pk_bf16_f32 v120, v228, v229
  v_pk_mul_f32 v[108:109], v[108:109], v[200:201]
  v_pk_mul_f32 v[110:111], v[110:111], v[202:203]
  v_cvt_pk_bf16_f32 v220, v108, v109
  v_cvt_pk_bf16_f32 v221, v110, v111
  s_waitcnt vmcnt(14)
  s_cbranch_vccnz L_kw1_9
  s_waitcnt vmcnt(9)
L_kw1_9:
  buffer_load_dwordx4 v[56:59], v94, s[8:11], s60 offen offset:1536 nt
  v_mfma_f32_16x16x16_bf16 v[224:227], v[220:221], v[172:173], v[224:227]
  v_pk_fma_f32 v[108:109], v[84:85], s[92:93], v[204:205] neg_lo:[0,0,1] neg_hi:[0,0,1]
  v_pk_fma_f32 v[110:111], v[86:87], s[92:93], v[206:207] neg_lo:[0,0,1] neg_hi:[0,0,1]
  v_cvt_pk_bf16_f32 v108, 0, v108
  v_cvt_pk_bf16_f32 v109, 0, v109
  v_cvt_pk_bf16_f32 v110, 0, v110
  v_cvt_pk_bf16_f32 v111, 0, v111
  v_pk_mul_f32 v[108:109], v[108:109], v[192:193]
  v_pk_mul_f32 v[110:111], v[110:111], v[194:195]
  v_cvt_pk_bf16_f32 v216, v108, v109
  v_cvt_pk_bf16_f32 v217, v110, v111
  s_waitcnt vmcnt(14)
  buffer_load_dwordx4 v[60:63], v94, s[8:11], s60 offen offset:1792 nt
  v_pk_fma_f32 v[108:109], v[88:89], s[92:93], v[208:209] neg_lo:[0,0,1] neg_hi:[0,0,1]
  v_pk_fma_f32 v[110:111], v[90:91], s[92:93], v[210:211] neg_lo:[0,0,1] neg_hi:[0,0,1]
  v_mov_b32_dpp v144, v224 quad_perm:[0,0,0,0] row_mask:0xf bank_mask:0xf
  v_mov_b32_dpp v145, v226 quad_perm:[2,2,2,2] row_mask:0xf bank_mask:0xf
  v_cvt_pk_bf16_f32 v108, 0, v108
  v_cvt_pk_bf16_f32 v109, 0, v109
  v_add_f32_dpp v144, v225, v144 quad_perm:[1,1,1,1] row_mask:0xf bank_mask:0xf
  v_add_f32_dpp v145, v227, v145 quad_perm:[3,3,3,3] row_mask:0xf bank_mask:0xf
  v_cvt_pk_bf16_f32 v110, 0, v110
  v_cvt_pk_bf16_f32 v111, 0, v111
  v_add_f32 v228, v144, v145
  v_pk_mul_f32 v[108:109], v[108:109], v[196:197]
  v_pk_mul_f32 v[110:111], v[110:111], v[198:199]
  v_cvt_pk_bf16_f32 v218, v108, v109
  v_cvt_pk_bf16_f32 v219, v110, v111
  s_waitcnt vmcnt(14)
  buffer_load_dwordx4 v[64:67], v94, s[8:11], s60 offen offset:2048 nt
  v_mfma_f32_16x16x32_bf16 v[224:227], v[216:219], v[168:171], 0
  v_pk_fma_f32 v[108:109], v[4:5], s[92:93], v[212:213] neg_lo:[0,0,1] neg_hi:[0,0,1]
  v_pk_fma_f32 v[110:111], v[6:7], s[92:93], v[214:215] neg_lo:[0,0,1] neg_hi:[0,0,1]
  v_cvt_pk_bf16_f32 v108, 0, v108
  v_cvt_pk_bf16_f32 v109, 0, v109
  v_cvt_pk_bf16_f32 v110, 0, v110
  v_cvt_pk_bf16_f32 v111, 0, v111
  v_pk_mul_f32 v[108:109], v[108:109], v[200:201]
  v_pk_mul_f32 v[110:111], v[110:111], v[202:203]
  v_cvt_pk_bf16_f32 v220, v108, v109
  v_cvt_pk_bf16_f32 v221, v110, v111
  s_waitcnt vmcnt(14)
  s_cbranch_vccnz L_kw1_12
  s_waitcnt vmcnt(9)
L_kw1_12:
  buffer_load_dwordx4 v[68:71], v94, s[8:11], s60 offen offset:2304 nt
  v_mfma_f32_16x16x16_bf16 v[224:227], v[220:221], v[172:173], v[224:227]
  v_pk_fma_f32 v[108:109], v[8:9], s[92:93], v[204:205] neg_lo:[0,0,1] neg_hi:[0,0,1]
  v_pk_fma_f32 v[110:111], v[10:11], s[92:93], v[206:207] neg_lo:[0,0,1] neg_hi:[0,0,1]
  v_cvt_pk_bf16_f32 v108, 0, v108
  v_cvt_pk_bf16_f32 v109, 0, v109
  v_cvt_pk_bf16_f32 v110, 0, v110
  v_cvt_pk_bf16_f32 v111, 0, v111
  v_pk_mul_f32 v[108:109], v[108:109], v[192:193]
  v_pk_mul_f32 v[110:111], v[110:111], v[194:195]
  v_cvt_pk_bf16_f32 v216, v108, v109
  v_cvt_pk_bf16_f32 v217, v110, v111
  s_waitcnt vmcnt(14)
  buffer_load_dwordx4 v[72:75], v94, s[8:11], s60 offen offset:2560 nt
  v_pk_fma_f32 v[108:109], v[12:13], s[92:93], v[208:209] neg_lo:[0,0,1] neg_hi:[0,0,1]
  v_pk_fma_f32 v[110:111], v[14:15], s[92:93], v[210:211] neg_lo:[0,0,1] neg_hi:[0,0,1]
  v_mov_b32_dpp v144, v224 quad_perm:[0,0,0,0] row_mask:0xf bank_mask:0xf
  v_mov_b32_dpp v145, v226 quad_perm:[2,2,2,2] row_mask:0xf bank_mask:0xf
  v_cvt_pk_bf16_f32 v108, 0, v108
  v_cvt_pk_bf16_f32 v109, 0, v109
  v_add_f32_dpp v144, v225, v144 quad_perm:[1,1,1,1] row_mask:0xf bank_mask:0xf
  v_add_f32_dpp v145, v227, v145 quad_perm:[3,3,3,3] row_mask:0xf bank_mask:0xf
  v_cvt_pk_bf16_f32 v110, 0, v110
  v_cvt_pk_bf16_f32 v111, 0, v111
  v_add_f32 v229, v144, v145
  v_pk_mul_f32 v[108:109], v[108:109], v[196:197]
  v_pk_mul_f32 v[110:111], v[110:111], v[198:199]
  v_cvt_pk_bf16_f32 v218, v108, v109
  v_cvt_pk_bf16_f32 v219, v110, v111
  s_waitcnt vmcnt(14)
  buffer_load_dwordx4 v[76:79], v94, s[8:11], s60 offen offset:2816 nt
  v_mfma_f32_16x16x32_bf16 v[224:227], v[216:219], v[168:171], 0
  v_pk_fma_f32 v[108:109], v[16:17], s[92:93], v[212:213] neg_lo:[0,0,1] neg_hi:[0,0,1]
  v_pk_fma_f32 v[110:111], v[18:19], s[92:93], v[214:215] neg_lo:[0,0,1] neg_hi:[0,0,1]
  v_cvt_pk_bf16_f32 v108, 0, v108
  v_cvt_pk_bf16_f32 v228, 0, v228
  v_cvt_pk_bf16_f32 v109, 0, v109
  v_cvt_pk_bf16_f32 v229, 0, v229
  v_cvt_pk_bf16_f32 v110, 0, v110
  v_pk_mul_f32 v[228:229], v[228:229], s[68:69]
  v_cvt_pk_bf16_f32 v111, 0, v111
  v_cvt_pk_bf16_f32 v121, v228, v229
  v_pk_mul_f32 v[108:109], v[108:109], v[200:201]
  v_pk_mul_f32 v[110:111], v[110:111], v[202:203]
  v_cvt_pk_bf16_f32 v220, v108, v109
  v_cvt_pk_bf16_f32 v221, v110, v111
  s_waitcnt vmcnt(14)
  s_cbranch_vccnz L_kw1_15
  s_waitcnt vmcnt(9)
L_kw1_15:
  buffer_load_dwordx4 v[80:83], v95, s[8:11], s60 offen offset:0 nt
  v_mfma_f32_16x16x16_bf16 v[224:227], v[220:221], v[172:173], v[224:227]
  v_pk_fma_f32 v[108:109], v[20:21], s[92:93], v[204:205] neg_lo:[0,0,1] neg_hi:[0,0,1]
  v_pk_fma_f32 v[110:111], v[22:23], s[92:93], v[206:207] neg_lo:[0,0,1] neg_hi:[0,0,1]
  v_cvt_pk_bf16_f32 v108, 0, v108
  v_cvt_pk_bf16_f32 v109, 0, v109
  v_cvt_pk_bf16_f32 v110, 0, v110
  v_cvt_pk_bf16_f32 v111, 0, v111
  v_pk_mul_f32 v[108:109], v[108:109], v[192:193]
  v_pk_mul_f32 v[110:111], v[110:111], v[194:195]
  v_cvt_pk_bf16_f32 v216, v108, v109
  v_cvt_pk_bf16_f32 v217, v110, v111
  s_waitcnt vmcnt(14)
  buffer_load_dwordx4 v[84:87], v95, s[8:11], s60 offen offset:256 nt
  v_pk_fma_f32 v[108:109], v[24:25], s[92:93], v[208:209] neg_lo:[0,0,1] neg_hi:[0,0,1]
  v_pk_fma_f32 v[110:111], v[26:27], s[92:93], v[210:211] neg_lo:[0,0,1] neg_hi:[0,0,1]
  v_mov_b32_dpp v144, v224 quad_perm:[0,0,0,0] row_mask:0xf bank_mask:0xf
  v_mov_b32_dpp v145, v226 quad_perm:[2,2,2,2] row_mask:0xf bank_mask:0xf
  v_cvt_pk_bf16_f32 v108, 0, v108
  v_cvt_pk_bf16_f32 v109, 0, v109
  v_add_f32_dpp v144, v225, v144 quad_perm:[1,1,1,1] row_mask:0xf bank_mask:0xf
  v_add_f32_dpp v145, v227, v145 quad_perm:[3,3,3,3] row_mask:0xf bank_mask:0xf
  v_cvt_pk_bf16_f32 v110, 0, v110
  v_cvt_pk_bf16_f32 v111, 0, v111
  v_add_f32 v228, v144, v145
  v_pk_mul_f32 v[108:109], v[108:109], v[196:197]
  v_pk_mul_f32 v[110:111], v[110:111], v[198:199]
  v_cvt_pk_bf16_f32 v218, v108, v109
  v_cvt_pk_bf16_f32 v219, v110, v111
  s_waitcnt vmcnt(14)
  buffer_load_dwordx4 v[88:91], v95, s[8:11], s60 offen offset:512 nt
  v_mfma_f32_16x16x32_bf16 v[224:227], v[216:219], v[168:171], 0
  v_pk_fma_f32 v[108:109], v[28:29], s[92:93], v[212:213] neg_lo:[0,0,1] neg_hi:[0,0,1]
  v_pk_fma_f32 v[110:111], v[30:31], s[92:93], v[214:215] neg_lo:[0,0,1] neg_hi:[0,0,1]
  s_cmp_lt_u32 s64, s99
  s_cbranch_scc1 L_k_known1
L_k_spin1:
  v_mov_b32 v144, 61696
  ds_read_b32 v144, v144
  s_waitcnt lgkmcnt(0)
  v_readfirstlane_b32 s96, v144
  s_nop 1
  s_cmp_eq_u32 s96, 0
  s_cbranch_scc1 L_k_spin1
  s_mov_b32 s99, -1
L_k_known1:
  s_lshr_b32 s71, s64, 4
  s_andn2_b32 s71, s71, 1
  s_lshr_b32 s71, 0x12, s71
  s_and_b32 s71, s71, 3
  s_lshr_b32 s85, s96, s71
  s_andn2_b32 s70, s64, 1
  s_or_b32 s70, s70, s4
  s_cmp_lt_u32 s64, 8
  s_cselect_b32 s70, s70, s64
  s_cselect_b32 s85, s64, s85
  s_and_b32 s85, s85, 1
  s_and_b32 s70, s70, 31
  s_lshl_b32 s71, s71, 12
  s_add_u32 s70, s70, s5
  s_add_u32 s70, s70, s71
  s_mul_hi_u32 s84, s70, s90
  s_lshr_b32 s84, s84, 1
  s_mul_i32 s71, s84, 3
  s_sub_u32 s70, s70, s71
  s_lshl3_add_u32 s85, s70, s85
  s_mul_i32 s61, s84, 196608
  s_lshr_b32 s89, s84, 4
  s_lshl_b32 s70, s85, 5
  v_add_u32 v97, s70, v230
  v_mul_u32_u24 v97, 21846, v97
  v_lshrrev_b32 v97, 16, v97
  v_add_u32 v144, s85, v231
  v_lshrrev_b32 v145, v144, s91
  v_and_b32 v145, 1, v145
  v_cmp_eq_u32 s[54:55], 1, v145
  s_nop 1
  s_and_b64 s[52:53], s[54:55], s[56:57]
  s_andn2_b64 s[54:55], s[54:55], s[56:57]
  v_mul_u32_u24 v144, 43, v144
  v_lshrrev_b32 v144, 8, v144
  v_mul_u32_u24 v144, 384, v144
  v_add_u32 v234, v144, v233
  s_cmp_eq_u32 s89, s88
  s_cbranch_scc1 L_k_sameq1
  s_mul_i32 s70, s89, 1536
  buffer_load_dwordx2 v[174:175], v235, s[36:39], s70 offen offset:0
  buffer_load_dwordx2 v[176:177], v235, s[36:39], s70 offen offset:128
  buffer_load_dwordx2 v[178:179], v235, s[36:39], s70 offen offset:256
  s_mov_b32 s88, s89
L_k_sameq1:
  s_mul_i32 s62, s84, 1536
  buffer_load_dwordx2 v[180:181], v234, s[20:23], s62 offen offset:0
  buffer_load_dwordx2 v[186:187], v234, s[24:27], s62 offen offset:0
  buffer_load_dwordx2 v[182:183], v234, s[20:23], s62 offen offset:128
  buffer_load_dwordx2 v[188:189], v234, s[24:27], s62 offen offset:128
  buffer_load_dwordx2 v[184:185], v234, s[20:23], s62 offen offset:256
  buffer_load_dwordx2 v[190:191], v234, s[24:27], s62 offen offset:256
  v_cvt_pk_bf16_f32 v108, 0, v108
  v_cvt_pk_bf16_f32 v109, 0, v109
  v_cvt_pk_bf16_f32 v110, 0, v110
  v_cvt_pk_bf16_f32 v111, 0, v111
  v_pk_mul_f32 v[108:109], v[108:109], v[200:201]
  v_pk_mul_f32 v[110:111], v[110:111], v[202:203]
  v_cvt_pk_bf16_f32 v220, v108, v109
  v_cvt_pk_bf16_f32 v221, v110, v111
  s_cmp_lt_u32 s64, 96
  s_cbranch_scc1 L_k_keep
  s_lshr_b32 s71, s3, 5
  s_lshr_b32 s85, s96, s71
  s_bfe_u32 s85, s85, 0x10003
  s_and_b32 s70, s3, 31
  s_lshl_b32 s71, s71, 12
  s_add_u32 s70, s70, s5
  s_add_u32 s70, s70, s71
  s_mul_hi_u32 s84, s70, s90
  s_lshr_b32 s84, s84, 1
  s_mul_i32 s71, s84, 3
  s_sub_u32 s70, s70, s71
  s_lshl3_add_u32 s85, s70, s85
  s_mul_i32 s61, s84, 196608
  s_lshr_b32 s89, s84, 4
  s_lshl_b32 s70, s85, 5
  v_add_u32 v97, s70, v1
  v_mul_u32_u24 v97, 21846, v97
  v_lshrrev_b32 v97, 16, v97
  v_add_u32 v144, s85, v2
  v_lshrrev_b32 v145, v144, s91
  v_and_b32 v145, 1, v145
  v_cmp_eq_u32 s[54:55], 1, v145
  s_nop 1
  s_and_b64 s[52:53], s[54:55], s[58:59]
  s_andn2_b64 s[54:55], s[54:55], s[58:59]
  s_mov_b32 s16, s12
  s_mov_b32 s17, s13
  s_lshl_b32 s62, s84, 9
  v_lshl_add_u32 v98, v97, 1, v96
  buffer_load_short_d16_hi v112, v98, s[32:35], s62 offen
  buffer_load_short_d16_hi v113, v98, s[28:31], s62 offen
  v_mov_b32 v232, v3
L_k_keep:
  v_mad_u32_u24 v92, v97, s63, v232
  v_add_u32 v93, 768, v92
  v_add_u32 v94, 4608, v92
  v_add_u32 v95, 7680, v92
  v_cndmask_b32 v92, v92, v105, s[52:53]
  v_cndmask_b32 v95, v95, v105, s[54:55]
  s_waitcnt vmcnt(20)
  s_cbranch_vccnz L_kw1_18
  s_waitcnt vmcnt(15)
L_kw1_18:
  buffer_load_dwordx4 v[4:7], v92, s[16:19], s61 offen offset:0 nt
  v_mfma_f32_16x16x16_bf16 v[224:227], v[220:221], v[172:173], v[224:227]
  v_pk_fma_f32 v[108:109], v[32:33], s[92:93], v[204:205] neg_lo:[0,0,1] neg_hi:[0,0,1]
  v_pk_fma_f32 v[110:111], v[34:35], s[92:93], v[206:207] neg_lo:[0,0,1] neg_hi:[0,0,1]
  v_cvt_pk_bf16_f32 v108, 0, v108
  v_cvt_pk_bf16_f32 v109, 0, v109
  v_cvt_pk_bf16_f32 v110, 0, v110
  v_cvt_pk_bf16_f32 v111, 0, v111
  v_pk_mul_f32 v[108:109], v[108:109], v[192:193]
  v_pk_mul_f32 v[110:111], v[110:111], v[194:195]
  v_cvt_pk_bf16_f32 v216, v108, v109
  v_cvt_pk_bf16_f32 v217, v110, v111
  s_waitcnt vmcnt(20)
  buffer_load_dwordx4 v[8:11], v92, s[16:19], s61 offen offset:256 nt
  v_pk_fma_f32 v[108:109], v[36:37], s[92:93], v[208:209] neg_lo:[0,0,1] neg_hi:[0,0,1]
  v_pk_fma_f32 v[110:111], v[38:39], s[92:93], v[210:211] neg_lo:[0,0,1] neg_hi:[0,0,1]
  v_mov_b32_dpp v144, v224 quad_perm:[0,0,0,0] row_mask:0xf bank_mask:0xf
  v_mov_b32_dpp v145, v226 quad_perm:[2,2,2,2] row_mask:0xf bank_mask:0xf
  v_cvt_pk_bf16_f32 v108, 0, v108
  v_cvt_pk_bf16_f32 v109, 0, v109
  v_add_f32_dpp v144, v225, v144 quad_perm:[1,1,1,1] row_mask:0xf bank_mask:0xf
  v_add_f32_dpp v145, v227, v145 quad_perm:[3,3,3,3] row_mask:0xf bank_mask:0xf
  v_cvt_pk_bf16_f32 v110, 0, v110
  v_cvt_pk_bf16_f32 v111, 0, v111
  v_add_f32 v229, v144, v145
  v_pk_mul_f32 v[108:109], v[108:109], v[196:197]
  v_pk_mul_f32 v[110:111], v[110:111], v[198:199]
  v_cvt_pk_bf16_f32 v218, v108, v109
  v_cvt_pk_bf16_f32 v219, v110, v111
  s_waitcnt vmcnt(20)
  buffer_load_dwordx4 v[12:15], v92, s[16:19], s61 offen offset:512 nt
  v_mfma_f32_16x16x32_bf16 v[224:227], v[216:219], v[168:171], 0
  v_pk_fma_f32 v[108:109], v[40:41], s[92:93], v[212:213] neg_lo:[0,0,1] neg_hi:[0,0,1]
  v_pk_fma_f32 v[110:111], v[42:43], s[92:93], v[214:215] neg_lo:[0,0,1] neg_hi:[0,0,1]
  v_cvt_pk_bf16_f32 v108, 0, v108
  v_cvt_pk_bf16_f32 v228, 0, v228
  v_cvt_pk_bf16_f32 v109, 0, v109
  v_cvt_pk_bf16_f32 v229, 0, v229
  v_cvt_pk_bf16_f32 v110, 0, v110
  v_pk_mul_f32 v[228:229], v[228:229], s[68:69]
  v_cvt_pk_bf16_f32 v111, 0, v111
  v_cvt_pk_bf16_f32 v122, v228, v229
  v_pk_mul_f32 v[108:109], v[108:109], v[200:201]
  v_pk_mul_f32 v[110:111], v[110:111], v[202:203]
  v_cvt_pk_bf16_f32 v220, v108, v109
  v_cvt_pk_bf16_f32 v221, v110, v111
  s_waitcnt vmcnt(20)
  s_cbranch_vccnz L_kw1_21
  s_waitcnt vmcnt(15)
L_kw1_21:
  buffer_load_dwordx4 v[16:19], v93, s[16:19], s61 offen offset:0 nt
  v_mfma_f32_16x16x16_bf16 v[224:227], v[220:221], v[172:173], v[224:227]
  v_pk_fma_f32 v[108:109], v[44:45], s[92:93], v[204:205] neg_lo:[0,0,1] neg_hi:[0,0,1]
  v_pk_fma_f32 v[110:111], v[46:47], s[92:93], v[206:207] neg_lo:[0,0,1] neg_hi:[0,0,1]
  v_cvt_pk_bf16_f32 v108, 0, v108
  v_cvt_pk_bf16_f32 v109, 0, v109
  v_cvt_pk_bf16_f32 v110, 0, v110
  v_cvt_pk_bf16_f32 v111, 0, v111
  v_pk_mul_f32 v[108:109], v[108:109], v[192:193]
  v_pk_mul_f32 v[110:111], v[110:111], v[194:195]
  v_cvt_pk_bf16_f32 v216, v108, v109
  v_cvt_pk_bf16_f32 v217, v110, v111
  s_waitcnt vmcnt(20)
  buffer_load_dwordx4 v[20:23], v93, s[16:19], s61 offen offset:256 nt
  v_pk_fma_f32 v[108:109], v[48:49], s[92:93], v[208:209] neg_lo:[0,0,1] neg_hi:[0,0,1]
  v_pk_fma_f32 v[110:111], v[50:51], s[92:93], v[210:211] neg_lo:[0,0,1] neg_hi:[0,0,1]
  v_mov_b32_dpp v144, v224 quad_perm:[0,0,0,0] row_mask:0xf bank_mask:0xf
  v_mov_b32_dpp v145, v226 quad_perm:[2,2,2,2] row_mask:0xf bank_mask:0xf
  v_cvt_pk_bf16_f32 v108, 0, v108
  v_cvt_pk_bf16_f32 v109, 0, v109
  v_add_f32_dpp v144, v225, v144 quad_perm:[1,1,1,1] row_mask:0xf bank_mask:0xf
  v_add_f32_dpp v145, v227, v145 quad_perm:[3,3,3,3] row_mask:0xf bank_mask:0xf
  v_cvt_pk_bf16_f32 v110, 0, v110
  v_cvt_pk_bf16_f32 v111, 0, v111
  v_add_f32 v228, v144, v145
  v_pk_mul_f32 v[108:109], v[108:109], v[196:197]
  v_pk_mul_f32 v[110:111], v[110:111], v[198:199]
  v_cvt_pk_bf16_f32 v218, v108, v109
  v_cvt_pk_bf16_f32 v219, v110, v111
  s_waitcnt vmcnt(20)
  buffer_load_dwordx4 v[24:27], v93, s[16:19], s61 offen offset:512 nt
  v_mfma_f32_16x16x32_bf16 v[224:227], v[216:219], v[168:171], 0
  v_pk_fma_f32 v[108:109], v[52:53], s[92:93], v[212:213] neg_lo:[0,0,1] neg_hi:[0,0,1]
  v_pk_fma_f32 v[110:111], v[54:55], s[92:93], v[214:215] neg_lo:[0,0,1] neg_hi:[0,0,1]
  v_cvt_pk_bf16_f32 v108, 0, v108
  v_cvt_pk_bf16_f32 v109, 0, v109
  v_cvt_pk_bf16_f32 v110, 0, v110
  v_cvt_pk_bf16_f32 v111, 0, v111
  v_pk_mul_f32 v[108:109], v[108:109], v[200:201]
  v_pk_mul_f32 v[110:111], v[110:111], v[202:203]
  v_cvt_pk_bf16_f32 v220, v108, v109
  v_cvt_pk_bf16_f32 v221, v110, v111
  s_waitcnt vmcnt(20)
  s_cbranch_vccnz L_kw1_24
  s_waitcnt vmcnt(15)
L_kw1_24:
  buffer_load_dwordx4 v[28:31], v93, s[16:19], s61 offen offset:768 nt
  v_mfma_f32_16x16x16_bf16 v[224:227], v[220:221], v[172:173], v[224:227]
  v_pk_fma_f32 v[108:109], v[56:57], s[92:93], v[204:205] neg_lo:[0,0,1] neg_hi:[0,0,1]
  v_pk_fma_f32 v[110:111], v[58:59], s[92:93], v[206:207] neg_lo:[0,0,1] neg_hi:[0,0,1]
  v_cvt_pk_bf16_f32 v108, 0, v108
  v_cvt_pk_bf16_f32 v109, 0, v109
  v_cvt_pk_bf16_f32 v110, 0, v110
  v_cvt_pk_bf16_f32 v111, 0, v111
  v_pk_mul_f32 v[108:109], v[108:109], v[192:193]
  v_pk_mul_f32 v[110:111], v[110:111], v[194:195]
  v_cvt_pk_bf16_f32 v216, v108, v109
  v_cvt_pk_bf16_f32 v217, v110, v111
  s_waitcnt vmcnt(20)
  buffer_load_dwordx4 v[32:35], v93, s[16:19], s61 offen offset:1024 nt
  v_pk_fma_f32 v[108:109], v[60:61], s[92:93], v[208:209] neg_lo:[0,0,1] neg_hi:[0,0,1]
  v_pk_fma_f32 v[110:111], v[62:63], s[92:93], v[210:211] neg_lo:[0,0,1] neg_hi:[0,0,1]
  v_mov_b32_dpp v144, v224 quad_perm:[0,0,0,0] row_mask:0xf bank_mask:0xf
  v_mov_b32_dpp v145, v226 quad_perm:[2,2,2,2] row_mask:0xf bank_mask:0xf
  v_cvt_pk_bf16_f32 v108, 0, v108
  v_cvt_pk_bf16_f32 v109, 0, v109
  v_add_f32_dpp v144, v225, v144 quad_perm:[1,1,1,1] row_mask:0xf bank_mask:0xf
  v_add_f32_dpp v145, v227, v145 quad_perm:[3,3,3,3] row_mask:0xf bank_mask:0xf
  v_cvt_pk_bf16_f32 v110, 0, v110
  v_cvt_pk_bf16_f32 v111, 0, v111
  v_add_f32 v229, v144, v145
  v_pk_mul_f32 v[108:109], v[108:109], v[196:197]
  v_pk_mul_f32 v[110:111], v[110:111], v[198:199]
  v_cvt_pk_bf16_f32 v218, v108, v109
  v_cvt_pk_bf16_f32 v219, v110, v111
  s_waitcnt vmcnt(20)
  buffer_load_dwordx4 v[36:39], v93, s[16:19], s61 offen offset:1280 nt
  v_mfma_f32_16x16x32_bf16 v[224:227], v[216:219], v[168:171], 0
  v_pk_fma_f32 v[108:109], v[64:65], s[92:93], v[212:213] neg_lo:[0,0,1] neg_hi:[0,0,1]
  v_pk_fma_f32 v[110:111], v[66:67], s[92:93], v[214:215] neg_lo:[0,0,1] neg_hi:[0,0,1]
  v_cvt_pk_bf16_f32 v108, 0, v108
  v_cvt_pk_bf16_f32 v228, 0, v228
  v_cvt_pk_bf16_f32 v109, 0, v109
  v_cvt_pk_bf16_f32 v229, 0, v229
  v_cvt_pk_bf16_f32 v110, 0, v110
  v_pk_mul_f32 v[228:229], v[228:229], s[68:69]
  v_cvt_pk_bf16_f32 v111, 0, v111
  v_cvt_pk_bf16_f32 v123, v228, v229
  v_pk_mul_f32 v[108:109], v[108:109], v[200:201]
  v_pk_mul_f32 v[110:111], v[110:111], v[202:203]
  v_cvt_pk_bf16_f32 v220, v108, v109
  v_cvt_pk_bf16_f32 v221, v110, v111
  s_waitcnt vmcnt(20)
  s_cbranch_vccnz L_kw1_27
  s_waitcnt vmcnt(15)
L_kw1_27:
  buffer_load_dwordx4 v[40:43], v93, s[16:19], s61 offen offset:1536 nt
  v_mfma_f32_16x16x16_bf16 v[224:227], v[220:221], v[172:173], v[224:227]
  v_pk_fma_f32 v[108:109], v[68:69], s[92:93], v[204:205] neg_lo:[0,0,1] neg_hi:[0,0,1]
  v_pk_fma_f32 v[110:111], v[70:71], s[92:93], v[206:207] neg_lo:[0,0,1] neg_hi:[0,0,1]
  v_cvt_pk_bf16_f32 v108, 0, v108
  v_cvt_pk_bf16_f32 v109, 0, v109
  v_cvt_pk_bf16_f32 v110, 0, v110
  v_cvt_pk_bf16_f32 v111, 0, v111
  v_pk_mul_f32 v[108:109], v[108:109], v[192:193]
  v_pk_mul_f32 v[110:111], v[110:111], v[194:195]
  v_cvt_pk_bf16_f32 v216, v108, v109
  v_cvt_pk_bf16_f32 v217, v110, v111
  s_waitcnt vmcnt(20)
  buffer_load_dwordx4 v[44:47], v93, s[16:19], s61 offen offset:1792 nt
  v_pk_fma_f32 v[108:109], v[72:73], s[92:93], v[208:209] neg_lo:[0,0,1] neg_hi:[0,0,1]
  v_pk_fma_f32 v[110:111], v[74:75], s[92:93], v[210:211] neg_lo:[0,0,1] neg_hi:[0,0,1]
  v_mov_b32_dpp v144, v224 quad_perm:[0,0,0,0] row_mask:0xf bank_mask:0xf
  v_mov_b32_dpp v145, v226 quad_perm:[2,2,2,2] row_mask:0xf bank_mask:0xf
  v_cvt_pk_bf16_f32 v108, 0, v108
  v_cvt_pk_bf16_f32 v109, 0, v109
  v_add_f32_dpp v144, v225, v144 quad_perm:[1,1,1,1] row_mask:0xf bank_mask:0xf
  v_add_f32_dpp v145, v227, v145 quad_perm:[3,3,3,3] row_mask:0xf bank_mask:0xf
  v_cvt_pk_bf16_f32 v110, 0, v110
  v_cvt_pk_bf16_f32 v111, 0, v111
  v_add_f32 v228, v144, v145
  v_pk_mul_f32 v[108:109], v[108:109], v[196:197]
  v_pk_mul_f32 v[110:111], v[110:111], v[198:199]
  v_cvt_pk_bf16_f32 v218, v108, v109
  v_cvt_pk_bf16_f32 v219, v110, v111
  s_waitcnt vmcnt(20)
  buffer_load_dwordx4 v[48:51], v93, s[16:19], s61 offen offset:2048 nt
  v_mfma_f32_16x16x32_bf16 v[224:227], v[216:219], v[168:171], 0
  v_pk_fma_f32 v[108:109], v[76:77], s[92:93], v[212:213] neg_lo:[0,0,1] neg_hi:[0,0,1]
  v_pk_fma_f32 v[110:111], v[78:79], s[92:93], v[214:215] neg_lo:[0,0,1] neg_hi:[0,0,1]
  v_cvt_pk_bf16_f32 v108, 0, v108
  v_cvt_pk_bf16_f32 v109, 0, v109
  v_cvt_pk_bf16_f32 v110, 0, v110
  v_cvt_pk_bf16_f32 v111, 0, v111
  v_pk_mul_f32 v[108:109], v[108:109], v[200:201]
  v_pk_mul_f32 v[110:111], v[110:111], v[202:203]
  v_cvt_pk_bf16_f32 v220, v108, v109
  v_cvt_pk_bf16_f32 v221, v110, v111
  s_waitcnt vmcnt(20)
  s_cbranch_vccnz L_kw1_30
  s_waitcnt vmcnt(9)
L_kw1_30:
  buffer_load_dwordx4 v[52:55], v93, s[16:19], s61 offen offset:2304 nt
  v_mfma_f32_16x16x16_bf16 v[224:227], v[220:221], v[172:173], v[224:227]
  v_pk_fma_f32 v[108:109], v[80:81], s[92:93], v[204:205] neg_lo:[0,0,1] neg_hi:[0,0,1]
  v_pk_fma_f32 v[110:111], v[82:83], s[92:93], v[206:207] neg_lo:[0,0,1] neg_hi:[0,0,1]
  v_cvt_pk_bf16_f32 v108, 0, v108
  v_cvt_pk_bf16_f32 v109, 0, v109
  v_cvt_pk_bf16_f32 v110, 0, v110
  v_cvt_pk_bf16_f32 v111, 0, v111
  v_pk_mul_f32 v[108:109], v[108:109], v[192:193]
  v_pk_mul_f32 v[110:111], v[110:111], v[194:195]
  v_cvt_pk_bf16_f32 v216, v108, v109
  v_cvt_pk_bf16_f32 v217, v110, v111
  s_waitcnt vmcnt(20)
  buffer_load_dwordx4 v[56:59], v93, s[16:19], s61 offen offset:2560 nt
  v_pk_fma_f32 v[108:109], v[84:85], s[92:93], v[208:209] neg_lo:[0,0,1] neg_hi:[0,0,1]
  v_pk_fma_f32 v[110:111], v[86:87], s[92:93], v[210:211] neg_lo:[0,0,1] neg_hi:[0,0,1]
  v_mov_b32_dpp v144, v224 quad_perm:[0,0,0,0] row_mask:0xf bank_mask:0xf
  v_mov_b32_dpp v145, v226 quad_perm:[2,2,2,2] row_mask:0xf bank_mask:0xf
  v_cvt_pk_bf16_f32 v108, 0, v108
  v_cvt_pk_bf16_f32 v109, 0, v109
  v_add_f32_dpp v144, v225, v144 quad_perm:[1,1,1,1] row_mask:0xf bank_mask:0xf
  v_add_f32_dpp v145, v227, v145 quad_perm:[3,3,3,3] row_mask:0xf bank_mask:0xf
  v_cvt_pk_bf16_f32 v110, 0, v110
  v_cvt_pk_bf16_f32 v111, 0, v111
  v_add_f32 v229, v144, v145
  v_pk_mul_f32 v[108:109], v[108:109], v[196:197]
  v_pk_mul_f32 v[110:111], v[110:111], v[198:199]
  v_cvt_pk_bf16_f32 v218, v108, v109
  v_cvt_pk_bf16_f32 v219, v110, v111
  s_waitcnt vmcnt(20)
  buffer_load_dwordx4 v[60:63], v93, s[16:19], s61 offen offset:2816 nt
  v_mfma_f32_16x16x32_bf16 v[224:227], v[216:219], v[168:171], 0
  v_pk_fma_f32 v[108:109], v[88:89], s[92:93], v[212:213] neg_lo:[0,0,1] neg_hi:[0,0,1]
  v_pk_fma_f32 v[110:111], v[90:91], s[92:93], v[214:215] neg_lo:[0,0,1] neg_hi:[0,0,1]
  v_cvt_pk_bf16_f32 v108, 0, v108
  v_cvt_pk_bf16_f32 v228, 0, v228
  v_cvt_pk_bf16_f32 v109, 0, v109
  v_cvt_pk_bf16_f32 v229, 0, v229
  v_cvt_pk_bf16_f32 v110, 0, v110
  v_pk_mul_f32 v[228:229], v[228:229], s[68:69]
  v_cvt_pk_bf16_f32 v111, 0, v111
  v_cvt_pk_bf16_f32 v124, v228, v229
  v_pk_mul_f32 v[108:109], v[108:109], v[200:201]
  v_pk_mul_f32 v[110:111], v[110:111], v[202:203]
  v_cvt_pk_bf16_f32 v220, v108, v109
  v_cvt_pk_bf16_f32 v221, v110, v111
  s_mov_b32 s60, s61
  v_mov_b32 v146, s64
  v_mfma_f32_16x16x16_bf16 v[224:227], v[220:221], v[172:173], v[224:227]
  ds_write_b128 v99, v[120:123]
  v_add_u32 v99, 768, v99
  s_nop 5
  v_mov_b32_dpp v144, v224 quad_perm:[0,0,0,0] row_mask:0xf bank_mask:0xf
  v_mov_b32_dpp v145, v226 quad_perm:[2,2,2,2] row_mask:0xf bank_mask:0xf
  s_nop 0
  v_add_f32_dpp v144, v225, v144 quad_perm:[1,1,1,1] row_mask:0xf bank_mask:0xf
  v_add_f32_dpp v145, v227, v145 quad_perm:[3,3,3,3] row_mask:0xf bank_mask:0xf
  v_add_f32 v228, v144, v145
  v_cndmask_b32 v228, v228, v236, s[50:51]
  v_cvt_pk_bf16_f32 v228, 0, v228
  v_cvt_pk_bf16_f32 v229, 0, v229
  v_pk_mul_f32 v[228:229], v[228:229], s[68:69]
  v_cvt_pk_bf16_f32 v125, v228, v229
  ds_write_b64 v100, v[124:125] offset:256
  ds_write_b32 v104, v146
  v_add_u32 v100, 768, v100
  s_cmp_lt_u32 s64, 96
  s_cbranch_scc1 L_k
  v_subrev_u32 v99, 24576, v99
  v_subrev_u32 v100, 24576, v100
  s_mov_b32 s64, s3
  s_mov_b32 s88, s89
  s_mov_b32 s99, 0
  s_mov_b32 s36, s46
  s_and_b32 s37, s47, 0xffff
  s_cmp_lt_u32 s64, s99
  s_cbranch_scc1 L_v0_ok
L_v0_spin:
  v_mov_b32 v144, 61700
  ds_read_b32 v144, v144
  s_waitcnt lgkmcnt(0)
  v_readfirstlane_b32 s99, v144
  s_nop 1
  s_cmp_lt_u32 s64, s99
  s_cbranch_scc0 L_v0_spin
L_v0_ok:
  ds_read_b128 v[120:123], v99
  ds_read_b64 v[124:125], v100 offset:256
  v_mov_b32 v128, 0
  v_mov_b32 v129, 0
  v_mov_b32 v130, 0
  v_mov_b32 v131, 0
  v_mov_b32 v132, 0
  v_mov_b32 v133, 0
  v_mov_b32 v134, 0
  v_mov_b32 v135, 0
  v_mov_b32 v136, 0
  v_mov_b32 v137, 0
  v_mov_b32 v138, 0
  v_mov_b32 v139, 0
  v_mov_b32 v140, 0xff800000
  v_mov_b32 v142, 0x7f800000
  v_mov_b32 v143, 0
L_v0:
  s_add_u32 s97, s64, 96
  v_mov_b32 v146, s97
  s_mov_b32 s86, s84
  ds_write_b32 v104, v146
  s_add_u32 s64, s64, 2
  s_cmp_lt_u32 s64, s99
  s_cbranch_scc1 L_v10_ok
L_v10_spin:
  v_mov_b32 v144, 61700
  ds_read_b32 v144, v144
  s_waitcnt lgkmcnt(0)
  v_readfirstlane_b32 s99, v144
  s_nop 1
  s_cmp_lt_u32 s64, s99
  s_cbranch_scc0 L_v10_spin
L_v10_ok:
  s_lshr_b32 s71, s64, 5
  s_lshr_b32 s85, s96, s71
  s_bfe_u32 s85, s85, 0x10003
  s_and_b32 s70, s64, 31
  s_lshl_b32 s71, s71, 12
  s_add_u32 s70, s70, s5
  s_add_u32 s70, s70, s71
  s_mul_hi_u32 s84, s70, s90
  s_lshr_b32 s84, s84, 1
  s_mul_i32 s71, s84, 3
  s_sub_u32 s70, s70, s71
  s_lshl3_add_u32 s85, s70, s85
  s_mul_i32 s61, s84, 196608
  s_lshr_b32 s89, s84, 4
  s_lshl_b32 s70, s85, 5
  v_add_u32 v97, s70, v1
  v_mul_u32_u24 v97, 21846, v97
  v_lshrrev_b32 v97, 16, v97
  v_add_u32 v144, s85, v2
  v_lshrrev_b32 v145, v144, s91
  v_and_b32 v145, 1, v145
  v_cmp_eq_u32 s[54:55], 1, v145
  s_nop 1
  s_and_b64 s[52:53], s[54:55], s[58:59]
  s_andn2_b64 s[54:55], s[54:55], s[58:59]
  s_cmp_lt_u32 s64, 96
  s_cselect_b32 s61, s61, 805306368
  ds_read_b32 v106, v104 offset:8
  s_waitcnt vmcnt(14)
  s_cbranch_vccnz L_vw0_0
  s_waitcnt vmcnt(9)
L_vw0_0:
  buffer_load_dwordx4 v[64:67], v93, s[12:15], s60 offen offset:3072 nt
  v_mul_f32 v114, s94, v112
  v_mul_f32 v115, 0x4a800000, v113
  s_nop 0
  v_mov_b32_dpp v116, v114 row_newbcast:0 row_mask:0xf bank_mask:0xf
  v_mov_b32_dpp v117, v115 row_newbcast:0 row_mask:0xf bank_mask:0xf
  v_pk_fma_f32 v[192:193], v[4:5], s[92:93], v[116:117] op_sel_hi:[1,1,0] neg_lo:[0,0,1] neg_hi:[0,0,1]
  v_pk_fma_f32 v[194:195], v[6:7], s[92:93], v[116:117] op_sel_hi:[1,1,0] neg_lo:[0,0,1] neg_hi:[0,0,1]
  v_cvt_pk_bf16_f32 v192, 0, v192
  v_cvt_pk_bf16_f32 v193, 0, v193
  v_cvt_pk_bf16_f32 v194, 0, v194
  v_cvt_pk_bf16_f32 v195, 0, v195
  v_pk_mul_f32 v[192:193], v[192:193], v[116:117] op_sel:[0,1]
  v_pk_mul_f32 v[194:195], v[194:195], v[116:117] op_sel:[0,1]
  s_waitcnt lgkmcnt(0)
  v_cmp_lt_u32 vcc, s97, v106
  s_waitcnt vmcnt(14)
  buffer_load_dwordx4 v[68:71], v93, s[12:15], s60 offen offset:3328 nt
  v_pk_fma_f32 v[196:197], v[8:9], s[92:93], v[116:117] op_sel_hi:[1,1,0] neg_lo:[0,0,1] neg_hi:[0,0,1]
  v_pk_fma_f32 v[198:199], v[10:11], s[92:93], v[116:117] op_sel_hi:[1,1,0] neg_lo:[0,0,1] neg_hi:[0,0,1]
  v_cvt_pk_bf16_f32 v196, 0, v196
  v_lshlrev_b32 v148, 16, v120
  v_cvt_pk_bf16_f32 v197, 0, v197
  v_and_b32 v149, s65, v120
  v_cvt_pk_bf16_f32 v198, 0, v198
  v_lshlrev_b32 v150, 16, v121
  v_cvt_pk_bf16_f32 v199, 0, v199
  v_and_b32 v151, s65, v121
  v_pk_mul_f32 v[196:197], v[196:197], v[116:117] op_sel:[0,1]
  v_lshlrev_b32 v152, 16, v122
  v_pk_mul_f32 v[198:199], v[198:199], v[116:117] op_sel:[0,1]
  s_waitcnt vmcnt(14)
  buffer_load_dwordx4 v[72:75], v93, s[12:15], s60 offen offset:3584 nt
  v_pk_fma_f32 v[200:201], v[12:13], s[92:93], v[116:117] op_sel_hi:[1,1,0] neg_lo:[0,0,1] neg_hi:[0,0,1]
  v_pk_fma_f32 v[202:203], v[14:15], s[92:93], v[116:117] op_sel_hi:[1,1,0] neg_lo:[0,0,1] neg_hi:[0,0,1]
  v_cvt_pk_bf16_f32 v200, 0, v200
  v_and_b32 v153, s65, v122
  v_cvt_pk_bf16_f32 v201, 0, v201
  v_lshlrev_b32 v154, 16, v123
  v_cvt_pk_bf16_f32 v202, 0, v202
  v_and_b32 v155, s65, v123
  v_cvt_pk_bf16_f32 v203, 0, v203
  v_lshlrev_b32 v156, 16, v124
  v_pk_mul_f32 v[200:201], v[200:201], v[116:117] op_sel:[0,1]
  v_and_b32 v157, s65, v124
  v_pk_mul_f32 v[202:203], v[202:203], v[116:117] op_sel:[0,1]
  s_waitcnt vmcnt(14)
  s_cbranch_vccnz L_vw0_3
  s_waitcnt vmcnt(9)
L_vw0_3:
  buffer_load_dwordx4 v[76:79], v94, s[12:15], s60 offen offset:0 nt
  v_mov_b32_dpp v116, v114 row_newbcast:1 row_mask:0xf bank_mask:0xf
  v_mov_b32_dpp v117, v115 row_newbcast:1 row_mask:0xf bank_mask:0xf
  v_pk_fma_f32 v[108:109], v[16:17], s[92:93], v[116:117] op_sel_hi:[1,1,0] neg_lo:[0,0,1] neg_hi:[0,0,1]
  v_pk_fma_f32 v[110:111], v[18:19], s[92:93], v[116:117] op_sel_hi:[1,1,0] neg_lo:[0,0,1] neg_hi:[0,0,1]
  s_lshl_b32 s62, s84, 9
  v_lshl_add_u32 v98, v97, 1, v96
  buffer_load_short_d16_hi v112, v98, s[32:35], s62 offen
  buffer_load_short_d16_hi v113, v98, s[28:31], s62 offen
  v_cvt_pk_bf16_f32 v108, 0, v108
  v_lshlrev_b32 v158, 16, v125
  v_cvt_pk_bf16_f32 v109, 0, v109
  v_add_u32 v99, 768, v99
  v_cvt_pk_bf16_f32 v110, 0, v110
  v_add_u32 v100, 768, v100
  v_cvt_pk_bf16_f32 v111, 0, v111
  v_max3_f32 v144, v148, v149, v150
  v_pk_mul_f32 v[108:109], v[108:109], v[116:117] op_sel:[0,1]
  ds_read_b128 v[120:123], v99
  v_pk_mul_f32 v[110:111], v[110:111], v[116:117] op_sel:[0,1]
  v_cvt_pk_bf16_f32 v204, v192, v108
  v_cvt_pk_bf16_f32 v208, v193, v109
  v_cvt_pk_bf16_f32 v212, v194, v110
  v_cvt_pk_bf16_f32 v216, v195, v111
  s_waitcnt vmcnt(16)
  buffer_load_dwordx4 v[80:83], v94, s[12:15], s60 offen offset:256 nt
  v_pk_fma_f32 v[108:109], v[20:21], s[92:93], v[116:117] op_sel_hi:[1,1,0] neg_lo:[0,0,1] neg_hi:[0,0,1]
  v_pk_fma_f32 v[110:111], v[22:23], s[92:93], v[116:117] op_sel_hi:[1,1,0] neg_lo:[0,0,1] neg_hi:[0,0,1]
  v_cvt_pk_bf16_f32 v108, 0, v108
  ds_read_b64 v[124:125], v100 offset:256
  v_cvt_pk_bf16_f32 v109, 0, v109
  v_max3_f32 v145, v151, v152, v153
  v_cvt_pk_bf16_f32 v110, 0, v110
  v_max3_f32 v144, v144, v154, v155
  v_cvt_pk_bf16_f32 v111, 0, v111
  v_max3_f32 v145, v145, v156, v157
  v_pk_mul_f32 v[108:109], v[108:109], v[116:117] op_sel:[0,1]
  v_max3_f32 v144, v144, v158, v140
  v_pk_mul_f32 v[110:111], v[110:111], v[116:117] op_sel:[0,1]
  v_cvt_pk_bf16_f32 v220, v196, v108
  v_cvt_pk_bf16_f32 v224, v197, v109
  v_cvt_pk_bf16_f32 v228, v198, v110
  v_cvt_pk_bf16_f32 v232, v199, v111
  s_waitcnt vmcnt(16)
  buffer_load_dwordx4 v[84:87], v94, s[12:15], s60 offen offset:512 nt
  v_pk_fma_f32 v[108:109], v[24:25], s[92:93], v[116:117] op_sel_hi:[1,1,0] neg_lo:[0,0,1] neg_hi:[0,0,1]
  v_pk_fma_f32 v[110:111], v[26:27], s[92:93], v[116:117] op_sel_hi:[1,1,0] neg_lo:[0,0,1] neg_hi:[0,0,1]
  v_cvt_pk_bf16_f32 v108, 0, v108
  v_max_f32 v144, v144, v145
  v_cvt_pk_bf16_f32 v109, 0, v109
  v_mov_b32 v145, v144
  v_cvt_pk_bf16_f32 v110, 0, v110
  s_nop 0
  v_permlane32_swap_b32 v144, v145
  v_cvt_pk_bf16_f32 v111, 0, v111
  v_max_f32 v144, v144, v145
  v_pk_mul_f32 v[108:109], v[108:109], v[116:117] op_sel:[0,1]
  v_mov_b32 v145, v144
  v_pk_mul_f32 v[110:111], v[110:111], v[116:117] op_sel:[0,1]
  v_cvt_pk_bf16_f32 v236, v200, v108
  v_cvt_pk_bf16_f32 v240, v201, v109
  v_cvt_pk_bf16_f32 v244, v202, v110
  v_cvt_pk_bf16_f32 v248, v203, v111
  s_waitcnt vmcnt(16)
  s_cbranch_vccnz L_vw0_6
  s_waitcnt vmcnt(11)
L_vw0_6:
  buffer_load_dwordx4 v[88:91], v94, s[12:15], s60 offen offset:768 nt
  v_mov_b32_dpp v116, v114 row_newbcast:2 row_mask:0xf bank_mask:0xf
  v_mov_b32_dpp v117, v115 row_newbcast:2 row_mask:0xf bank_mask:0xf
  v_pk_fma_f32 v[192:193], v[28:29], s[92:93], v[116:117] op_sel_hi:[1,1,0] neg_lo:[0,0,1] neg_hi:[0,0,1]
  v_pk_fma_f32 v[194:195], v[30:31], s[92:93], v[116:117] op_sel_hi:[1,1,0] neg_lo:[0,0,1] neg_hi:[0,0,1]
  v_cvt_pk_bf16_f32 v192, 0, v192
  v_permlane16_swap_b32 v144, v145
  v_cvt_pk_bf16_f32 v193, 0, v193
  v_max_f32 v140, v144, v145
  v_cvt_pk_bf16_f32 v194, 0, v194
  v_mul_f32 v144, s66, v140
  v_cvt_pk_bf16_f32 v195, 0, v195
  v_add_f32 v146, v144, v142
  v_pk_mul_f32 v[192:193], v[192:193], v[116:117] op_sel:[0,1]
  v_sub_f32 v142, 0, v144
  v_pk_mul_f32 v[194:195], v[194:195], v[116:117] op_sel:[0,1]
  s_waitcnt vmcnt(16)
  buffer_load_dwordx4 v[4:7], v94, s[12:15], s60 offen offset:1024 nt
  v_pk_fma_f32 v[196:197], v[32:33], s[92:93], v[116:117] op_sel_hi:[1,1,0] neg_lo:[0,0,1] neg_hi:[0,0,1]
  v_pk_fma_f32 v[198:199], v[34:35], s[92:93], v[116:117] op_sel_hi:[1,1,0] neg_lo:[0,0,1] neg_hi:[0,0,1]
  v_cvt_pk_bf16_f32 v196, 0, v196
  v_exp_f32 v146, -v146
  v_cvt_pk_bf16_f32 v197, 0, v197
  ds_bpermute_b32 v147, v101, v146
  v_cvt_pk_bf16_f32 v198, 0, v198
  v_fma_f32 v148, v148, s66, v142
  v_cvt_pk_bf16_f32 v199, 0, v199
  v_exp_f32 v148, v148
  v_pk_mul_f32 v[196:197], v[196:197], v[116:117] op_sel:[0,1]
  v_fma_f32 v149, v149, s66, v142
  v_pk_mul_f32 v[198:199], v[198:199], v[116:117] op_sel:[0,1]
  s_waitcnt vmcnt(16)
  buffer_load_dwordx4 v[8:11], v94, s[12:15], s60 offen offset:1280 nt
  v_pk_fma_f32 v[200:201], v[36:37], s[92:93], v[116:117] op_sel_hi:[1,1,0] neg_lo:[0,0,1] neg_hi:[0,0,1]
  v_pk_fma_f32 v[202:203], v[38:39], s[92:93], v[116:117] op_sel_hi:[1,1,0] neg_lo:[0,0,1] neg_hi:[0,0,1]
  v_cvt_pk_bf16_f32 v200, 0, v200
  v_exp_f32 v149, v149
  v_cvt_pk_bf16_f32 v201, 0, v201
  v_fma_f32 v150, v150, s66, v142
  v_cvt_pk_bf16_f32 v202, 0, v202
  v_exp_f32 v150, v150
  v_cvt_pk_bf16_f32 v203, 0, v203
  v_fma_f32 v151, v151, s66, v142
  v_pk_mul_f32 v[200:201], v[200:201], v[116:117] op_sel:[0,1]
  v_exp_f32 v151, v151
  v_pk_mul_f32 v[202:203], v[202:203], v[116:117] op_sel:[0,1]
  s_waitcnt vmcnt(16)
  s_cbranch_vccnz L_vw0_9
  s_waitcnt vmcnt(11)
L_vw0_9:
  buffer_load_dwordx4 v[12:15], v94, s[12:15], s60 offen offset:1536 nt
  v_mov_b32_dpp v116, v114 row_newbcast:3 row_mask:0xf bank_mask:0xf
  v_mov_b32_dpp v117, v115 row_newbcast:3 row_mask:0xf bank_mask:0xf
  v_pk_fma_f32 v[108:109], v[40:41], s[92:93], v[116:117] op_sel_hi:[1,1,0] neg_lo:[0,0,1] neg_hi:[0,0,1]
  v_pk_fma_f32 v[110:111], v[42:43], s[92:93], v[116:117] op_sel_hi:[1,1,0] neg_lo:[0,0,1] neg_hi:[0,0,1]
  v_cvt_pk_bf16_f32 v108, 0, v108
  v_fma_f32 v152, v152, s66, v142
  v_cvt_pk_bf16_f32 v109, 0, v109
  v_exp_f32 v152, v152
  v_cvt_pk_bf16_f32 v110, 0, v110
  v_fma_f32 v153, v153, s66, v142
  v_cvt_pk_bf16_f32 v111, 0, v111
  v_exp_f32 v153, v153
  v_pk_mul_f32 v[108:109], v[108:109], v[116:117] op_sel:[0,1]
  v_fma_f32 v154, v154, s66, v142
  v_pk_mul_f32 v[110:111], v[110:111], v[116:117] op_sel:[0,1]
  v_cvt_pk_bf16_f32 v205, v192, v108
  v_cvt_pk_bf16_f32 v209, v193, v109
  v_cvt_pk_bf16_f32 v213, v194, v110
  v_cvt_pk_bf16_f32 v217, v195, v111
  s_waitcnt vmcnt(16)
  buffer_load_dwordx4 v[16:19], v94, s[12:15], s60 offen offset:1792 nt
  v_pk_fma_f32 v[108:109], v[44:45], s[92:93], v[116:117] op_sel_hi:[1,1,0] neg_lo:[0,0,1] neg_hi:[0,0,1]
  v_pk_fma_f32 v[110:111], v[46:47], s[92:93], v[116:117] op_sel_hi:[1,1,0] neg_lo:[0,0,1] neg_hi:[0,0,1]
  v_cvt_pk_bf16_f32 v108, 0, v108
  v_exp_f32 v154, v154
  v_cvt_pk_bf16_f32 v109, 0, v109
  v_fma_f32 v155, v155, s66, v142
  v_cvt_pk_bf16_f32 v110, 0, v110
  v_exp_f32 v155, v155
  v_cvt_pk_bf16_f32 v111, 0, v111
  v_fma_f32 v156, v156, s66, v142
  v_pk_mul_f32 v[108:109], v[108:109], v[116:117] op_sel:[0,1]
  v_exp_f32 v156, v156
  v_pk_mul_f32 v[110:111], v[110:111], v[116:117] op_sel:[0,1]
  v_cvt_pk_bf16_f32 v221, v196, v108
  v_cvt_pk_bf16_f32 v225, v197, v109
  v_cvt_pk_bf16_f32 v229, v198, v110
  v_cvt_pk_bf16_f32 v233, v199, v111
  s_waitcnt vmcnt(16)
  buffer_load_dwordx4 v[20:23], v94, s[12:15], s60 offen offset:2048 nt
  v_pk_fma_f32 v[108:109], v[48:49], s[92:93], v[116:117] op_sel_hi:[1,1,0] neg_lo:[0,0,1] neg_hi:[0,0,1]
  v_pk_fma_f32 v[110:111], v[50:51], s[92:93], v[116:117] op_sel_hi:[1,1,0] neg_lo:[0,0,1] neg_hi:[0,0,1]
  v_cvt_pk_bf16_f32 v108, 0, v108
  v_fma_f32 v157, v157, s66, v142
  v_cvt_pk_bf16_f32 v109, 0, v109
  v_exp_f32 v157, v157
  v_cvt_pk_bf16_f32 v110, 0, v110
  v_fma_f32 v158, v158, s66, v142
  v_cvt_pk_bf16_f32 v111, 0, v111
  v_exp_f32 v158, v158
  v_pk_mul_f32 v[108:109], v[108:109], v[116:117] op_sel:[0,1]
  v_add_f32 v144, v148, v149
  v_pk_mul_f32 v[110:111], v[110:111], v[116:117] op_sel:[0,1]
  v_cvt_pk_bf16_f32 v237, v200, v108
  v_cvt_pk_bf16_f32 v241, v201, v109
  v_cvt_pk_bf16_f32 v245, v202, v110
  v_cvt_pk_bf16_f32 v249, v203, v111
  s_waitcnt vmcnt(16)
  s_cbranch_vccnz L_vw0_12
  s_waitcnt vmcnt(11)
L_vw0_12:
  buffer_load_dwordx4 v[24:27], v94, s[12:15], s60 offen offset:2304 nt
  v_mov_b32_dpp v116, v114 row_newbcast:4 row_mask:0xf bank_mask:0xf
  v_mov_b32_dpp v117, v115 row_newbcast:4 row_mask:0xf bank_mask:0xf
  v_pk_fma_f32 v[192:193], v[52:53], s[92:93], v[116:117] op_sel_hi:[1,1,0] neg_lo:[0,0,1] neg_hi:[0,0,1]
  v_pk_fma_f32 v[194:195], v[54:55], s[92:93], v[116:117] op_sel_hi:[1,1,0] neg_lo:[0,0,1] neg_hi:[0,0,1]
  v_cvt_pk_bf16_f32 v192, 0, v192
  v_add_f32 v145, v150, v151
  v_cvt_pk_bf16_f32 v193, 0, v193
  v_add_f32 v144, v144, v152
  v_cvt_pk_bf16_f32 v194, 0, v194
  v_add_f32 v145, v145, v153
  v_cvt_pk_bf16_f32 v195, 0, v195
  v_add_f32 v144, v144, v154
  v_pk_mul_f32 v[192:193], v[192:193], v[116:117] op_sel:[0,1]
  v_add_f32 v145, v145, v155
  v_pk_mul_f32 v[194:195], v[194:195], v[116:117] op_sel:[0,1]
  s_waitcnt vmcnt(16)
  buffer_load_dwordx4 v[28:31], v94, s[12:15], s60 offen offset:2560 nt
  v_pk_fma_f32 v[196:197], v[56:57], s[92:93], v[116:117] op_sel_hi:[1,1,0] neg_lo:[0,0,1] neg_hi:[0,0,1]
  v_pk_fma_f32 v[198:199], v[58:59], s[92:93], v[116:117] op_sel_hi:[1,1,0] neg_lo:[0,0,1] neg_hi:[0,0,1]
  v_cvt_pk_bf16_f32 v196, 0, v196
  v_add_f32 v144, v144, v156
  v_cvt_pk_bf16_f32 v197, 0, v197
  v_add_f32 v145, v145, v157
  v_cvt_pk_bf16_f32 v198, 0, v198
  v_add_f32 v144, v144, v158
  v_cvt_pk_bf16_f32 v199, 0, v199
  v_add_f32 v144, v144, v145
  v_pk_mul_f32 v[196:197], v[196:197], v[116:117] op_sel:[0,1]
  v_fma_f32 v143, v143, v146, v144
  v_pk_mul_f32 v[198:199], v[198:199], v[116:117] op_sel:[0,1]
  s_waitcnt vmcnt(16)
  buffer_load_dwordx4 v[32:35], v94, s[12:15], s60 offen offset:2816 nt
  v_pk_fma_f32 v[200:201], v[60:61], s[92:93], v[116:117] op_sel_hi:[1,1,0] neg_lo:[0,0,1] neg_hi:[0,0,1]
  v_pk_fma_f32 v[202:203], v[62:63], s[92:93], v[116:117] op_sel_hi:[1,1,0] neg_lo:[0,0,1] neg_hi:[0,0,1]
  v_cvt_pk_bf16_f32 v200, 0, v200
  v_cvt_pk_bf16_f32 v159, v148, v149
  v_cvt_pk_bf16_f32 v201, 0, v201
  v_cvt_pk_bf16_f32 v160, v150, v151
  v_cvt_pk_bf16_f32 v202, 0, v202
  v_cvt_pk_bf16_f32 v161, v152, v153
  v_cvt_pk_bf16_f32 v203, 0, v203
  v_cvt_pk_bf16_f32 v162, v154, v155
  v_pk_mul_f32 v[200:201], v[200:201], v[116:117] op_sel:[0,1]
  v_cvt_pk_bf16_f32 v163, v156, v157
  v_pk_mul_f32 v[202:203], v[202:203], v[116:117] op_sel:[0,1]
  s_waitcnt vmcnt(16)
  s_cbranch_vccnz L_vw0_15
  s_waitcnt vmcnt(9)
L_vw0_15:
  buffer_load_dwordx4 v[36:39], v95, s[12:15], s60 offen offset:0 nt
  v_mov_b32_dpp v116, v114 row_newbcast:5 row_mask:0xf bank_mask:0xf
  v_mov_b32_dpp v117, v115 row_newbcast:5 row_mask:0xf bank_mask:0xf
  v_pk_fma_f32 v[108:109], v[64:65], s[92:93], v[116:117] op_sel_hi:[1,1,0] neg_lo:[0,0,1] neg_hi:[0,0,1]
  v_pk_fma_f32 v[110:111], v[66:67], s[92:93], v[116:117] op_sel_hi:[1,1,0] neg_lo:[0,0,1] neg_hi:[0,0,1]
  v_cvt_pk_bf16_f32 v108, 0, v108
  v_cvt_pk_bf16_f32 v164, v158, 0
  v_cvt_pk_bf16_f32 v109, 0, v109
  v_cndmask_b32 v168, 0, v159, s[72:73]
  v_cvt_pk_bf16_f32 v110, 0, v110
  v_cndmask_b32 v169, 0, v160, s[72:73]
  v_cvt_pk_bf16_f32 v111, 0, v111
  v_cndmask_b32 v170, 0, v161, s[72:73]
  v_pk_mul_f32 v[108:109], v[108:109], v[116:117] op_sel:[0,1]
  v_cndmask_b32 v171, 0, v162, s[72:73]
  v_pk_mul_f32 v[110:111], v[110:111], v[116:117] op_sel:[0,1]
  v_cvt_pk_bf16_f32 v206, v192, v108
  v_cvt_pk_bf16_f32 v210, v193, v109
  v_cvt_pk_bf16_f32 v214, v194, v110
  v_cvt_pk_bf16_f32 v218, v195, v111
  s_waitcnt vmcnt(16)
  buffer_load_dwordx4 v[40:43], v95, s[12:15], s60 offen offset:256 nt
  v_pk_fma_f32 v[108:109], v[68:69], s[92:93], v[116:117] op_sel_hi:[1,1,0] neg_lo:[0,0,1] neg_hi:[0,0,1]
  v_pk_fma_f32 v[110:111], v[70:71], s[92:93], v[116:117] op_sel_hi:[1,1,0] neg_lo:[0,0,1] neg_hi:[0,0,1]
  v_cvt_pk_bf16_f32 v108, 0, v108
  v_cndmask_b32 v172, 0, v159, s[74:75]
  v_cvt_pk_bf16_f32 v109, 0, v109
  v_cndmask_b32 v173, 0, v160, s[74:75]
  v_cvt_pk_bf16_f32 v110, 0, v110
  v_cndmask_b32 v174, 0, v161, s[74:75]
  v_cvt_pk_bf16_f32 v111, 0, v111
  v_cndmask_b32 v175, 0, v162, s[74:75]
  v_pk_mul_f32 v[108:109], v[108:109], v[116:117] op_sel:[0,1]
  v_cndmask_b32 v176, 0, v159, s[76:77]
  v_pk_mul_f32 v[110:111], v[110:111], v[116:117] op_sel:[0,1]
  v_cvt_pk_bf16_f32 v222, v196, v108
  v_cvt_pk_bf16_f32 v226, v197, v109
  v_cvt_pk_bf16_f32 v230, v198, v110
  v_cvt_pk_bf16_f32 v234, v199, v111
  s_waitcnt vmcnt(16)
  buffer_load_dwordx4 v[44:47], v95, s[12:15], s60 offen offset:512 nt
  v_pk_fma_f32 v[108:109], v[72:73], s[92:93], v[116:117] op_sel_hi:[1,1,0] neg_lo:[0,0,1] neg_hi:[0,0,1]
  v_pk_fma_f32 v[110:111], v[74:75], s[92:93], v[116:117] op_sel_hi:[1,1,0] neg_lo:[0,0,1] neg_hi:[0,0,1]
  v_cvt_pk_bf16_f32 v108, 0, v108
  v_cndmask_b32 v177, 0, v160, s[76:77]
  v_cvt_pk_bf16_f32 v109, 0, v109
  v_cndmask_b32 v178, 0, v161, s[76:77]
  v_cvt_pk_bf16_f32 v110, 0, v110
  v_cndmask_b32 v179, 0, v162, s[76:77]
  v_cvt_pk_bf16_f32 v111, 0, v111
  v_cndmask_b32 v180, 0, v159, s[78:79]
  v_pk_mul_f32 v[108:109], v[108:109], v[116:117] op_sel:[0,1]
  v_cndmask_b32 v181, 0, v160, s[78:79]
  v_pk_mul_f32 v[110:111], v[110:111], v[116:117] op_sel:[0,1]
  v_cvt_pk_bf16_f32 v238, v200, v108
  v_cvt_pk_bf16_f32 v242, v201, v109
  v_cvt_pk_bf16_f32 v246, v202, v110
  v_cvt_pk_bf16_f32 v250, v203, v111
  v_mad_u32_u24 v92, v97, s63, v3
  v_add_u32 v93, 768, v92
  v_add_u32 v94, 4608, v92
  v_add_u32 v95, 7680, v92
  v_cndmask_b32 v92, v92, v105, s[52:53]
  v_cndmask_b32 v95, v95, v105, s[54:55]
  s_waitcnt vmcnt(16)
  s_cbranch_vccnz L_vw0_18
  s_waitcnt vmcnt(9)
L_vw0_18:
  buffer_load_dwordx4 v[48:51], v92, s[12:15], s61 offen offset:0 nt
  v_mov_b32_dpp v116, v114 row_newbcast:6 row_mask:0xf bank_mask:0xf
  v_mov_b32_dpp v117, v115 row_newbcast:6 row_mask:0xf bank_mask:0xf
  v_pk_fma_f32 v[192:193], v[76:77], s[92:93], v[116:117] op_sel_hi:[1,1,0] neg_lo:[0,0,1] neg_hi:[0,0,1]
  v_pk_fma_f32 v[194:195], v[78:79], s[92:93], v[116:117] op_sel_hi:[1,1,0] neg_lo:[0,0,1] neg_hi:[0,0,1]
  v_cvt_pk_bf16_f32 v192, 0, v192
  v_cndmask_b32 v182, 0, v161, s[78:79]
  v_cvt_pk_bf16_f32 v193, 0, v193
  v_cndmask_b32 v183, 0, v162, s[78:79]
  v_cvt_pk_bf16_f32 v194, 0, v194
  s_waitcnt lgkmcnt(0)
  v_cvt_pk_bf16_f32 v195, 0, v195
  v_mul_f32 v128, v147, v128
  v_pk_mul_f32 v[192:193], v[192:193], v[116:117] op_sel:[0,1]
  v_mul_f32 v129, v147, v129
  v_pk_mul_f32 v[194:195], v[194:195], v[116:117] op_sel:[0,1]
  s_waitcnt vmcnt(14)
  buffer_load_dwordx4 v[52:55], v92, s[12:15], s61 offen offset:256 nt
  v_pk_fma_f32 v[196:197], v[80:81], s[92:93], v[116:117] op_sel_hi:[1,1,0] neg_lo:[0,0,1] neg_hi:[0,0,1]
  v_pk_fma_f32 v[198:199], v[82:83], s[92:93], v[116:117] op_sel_hi:[1,1,0] neg_lo:[0,0,1] neg_hi:[0,0,1]
  v_cvt_pk_bf16_f32 v196, 0, v196
  v_mul_f32 v130, v147, v130
  v_cvt_pk_bf16_f32 v197, 0, v197
  v_mul_f32 v131, v147, v131
  v_cvt_pk_bf16_f32 v198, 0, v198
  v_mul_f32 v132, v147, v132
  v_cvt_pk_bf16_f32 v199, 0, v199
  v_mul_f32 v133, v147, v133
  v_pk_mul_f32 v[196:197], v[196:197], v[116:117] op_sel:[0,1]
  v_mul_f32 v134, v147, v134
  v_pk_mul_f32 v[198:199], v[198:199], v[116:117] op_sel:[0,1]
  s_waitcnt vmcnt(14)
  buffer_load_dwordx4 v[56:59], v92, s[12:15], s61 offen offset:512 nt
  v_pk_fma_f32 v[200:201], v[84:85], s[92:93], v[116:117] op_sel_hi:[1,1,0] neg_lo:[0,0,1] neg_hi:[0,0,1]
  v_pk_fma_f32 v[202:203], v[86:87], s[92:93], v[116:117] op_sel_hi:[1,1,0] neg_lo:[0,0,1] neg_hi:[0,0,1]
  v_cvt_pk_bf16_f32 v200, 0, v200
  v_mul_f32 v135, v147, v135
  v_cvt_pk_bf16_f32 v201, 0, v201
  v_mul_f32 v136, v147, v136
  v_cvt_pk_bf16_f32 v202, 0, v202
  v_mul_f32 v137, v147, v137
  v_cvt_pk_bf16_f32 v203, 0, v203
  v_mul_f32 v138, v147, v138
  v_pk_mul_f32 v[200:201], v[200:201], v[116:117] op_sel:[0,1]
  v_mul_f32 v139, v147, v139
  v_pk_mul_f32 v[202:203], v[202:203], v[116:117] op_sel:[0,1]
  s_waitcnt vmcnt(14)
  s_cbranch_vccnz L_vw0_21
  s_waitcnt vmcnt(9)
L_vw0_21:
  buffer_load_dwordx4 v[60:63], v93, s[12:15], s61 offen offset:0 nt
  v_mov_b32_dpp v116, v114 row_newbcast:7 row_mask:0xf bank_mask:0xf
  v_mov_b32_dpp v117, v115 row_newbcast:7 row_mask:0xf bank_mask:0xf
  v_pk_fma_f32 v[108:109], v[88:89], s[92:93], v[116:117] op_sel_hi:[1,1,0] neg_lo:[0,0,1] neg_hi:[0,0,1]
  v_pk_fma_f32 v[110:111], v[90:91], s[92:93], v[116:117] op_sel_hi:[1,1,0] neg_lo:[0,0,1] neg_hi:[0,0,1]
  v_cvt_pk_bf16_f32 v108, 0, v108
  v_cvt_pk_bf16_f32 v109, 0, v109
  v_cvt_pk_bf16_f32 v110, 0, v110
  v_cvt_pk_bf16_f32 v111, 0, v111
  v_pk_mul_f32 v[108:109], v[108:109], v[116:117] op_sel:[0,1]
  v_pk_mul_f32 v[110:111], v[110:111], v[116:117] op_sel:[0,1]
  v_cvt_pk_bf16_f32 v207, v192, v108
  v_cvt_pk_bf16_f32 v211, v193, v109
  v_cvt_pk_bf16_f32 v215, v194, v110
  v_cvt_pk_bf16_f32 v219, v195, v111
  v_mfma_f32_16x16x32_bf16 v[128:131], v[168:171], v[204:207], v[128:131]
  v_mfma_f32_16x16x32_bf16 v[128:131], v[172:175], v[208:211], v[128:131]
  v_mfma_f32_16x16x32_bf16 v[128:131], v[176:179], v[212:215], v[128:131]
  v_mfma_f32_16x16x32_bf16 v[128:131], v[180:183], v[216:219], v[128:131]
  s_waitcnt vmcnt(14)
  buffer_load_dwordx4 v[64:67], v93, s[12:15], s61 offen offset:256 nt
  v_pk_fma_f32 v[108:109], v[4:5], s[92:93], v[116:117] op_sel_hi:[1,1,0] neg_lo:[0,0,1] neg_hi:[0,0,1]
  v_pk_fma_f32 v[110:111], v[6:7], s[92:93], v[116:117] op_sel_hi:[1,1,0] neg_lo:[0,0,1] neg_hi:[0,0,1]
  v_cvt_pk_bf16_f32 v108, 0, v108
  v_cvt_pk_bf16_f32 v109, 0, v109
  v_cvt_pk_bf16_f32 v110, 0, v110
  v_cvt_pk_bf16_f32 v111, 0, v111
  v_pk_mul_f32 v[108:109], v[108:109], v[116:117] op_sel:[0,1]
  v_pk_mul_f32 v[110:111], v[110:111], v[116:117] op_sel:[0,1]
  v_cvt_pk_bf16_f32 v223, v196, v108
  v_cvt_pk_bf16_f32 v227, v197, v109
  v_cvt_pk_bf16_f32 v231, v198, v110
  v_cvt_pk_bf16_f32 v235, v199, v111
  v_mfma_f32_16x16x32_bf16 v[132:135], v[168:171], v[220:223], v[132:135]
  v_mfma_f32_16x16x32_bf16 v[132:135], v[172:175], v[224:227], v[132:135]
  v_mfma_f32_16x16x32_bf16 v[132:135], v[176:179], v[228:231], v[132:135]
  v_mfma_f32_16x16x32_bf16 v[132:135], v[180:183], v[232:235], v[132:135]
  s_waitcnt vmcnt(14)
  buffer_load_dwordx4 v[68:71], v93, s[12:15], s61 offen offset:512 nt
  v_pk_fma_f32 v[108:109], v[8:9], s[92:93], v[116:117] op_sel_hi:[1,1,0] neg_lo:[0,0,1] neg_hi:[0,0,1]
  v_pk_fma_f32 v[110:111], v[10:11], s[92:93], v[116:117] op_sel_hi:[1,1,0] neg_lo:[0,0,1] neg_hi:[0,0,1]
  v_cvt_pk_bf16_f32 v108, 0, v108
  v_cvt_pk_bf16_f32 v109, 0, v109
  v_cvt_pk_bf16_f32 v110, 0, v110
  v_cvt_pk_bf16_f32 v111, 0, v111
  v_pk_mul_f32 v[108:109], v[108:109], v[116:117] op_sel:[0,1]
  v_pk_mul_f32 v[110:111], v[110:111], v[116:117] op_sel:[0,1]
  v_cvt_pk_bf16_f32 v239, v200, v108
  v_cvt_pk_bf16_f32 v243, v201, v109
  v_cvt_pk_bf16_f32 v247, v202, v110
  v_cvt_pk_bf16_f32 v251, v203, v111
  v_mfma_f32_16x16x32_bf16 v[136:139], v[168:171], v[236:239], v[136:139]
  v_mfma_f32_16x16x32_bf16 v[136:139], v[172:175], v[240:243], v[136:139]
  v_mfma_f32_16x16x32_bf16 v[136:139], v[176:179], v[244:247], v[136:139]
  v_mfma_f32_16x16x32_bf16 v[136:139], v[180:183], v[248:251], v[136:139]
  s_waitcnt vmcnt(14)
  s_cbranch_vccnz L_vw0_24
  s_waitcnt vmcnt(9)
L_vw0_24:
  buffer_load_dwordx4 v[72:75], v93, s[12:15], s61 offen offset:768 nt
  v_mov_b32_dpp v116, v114 row_newbcast:8 row_mask:0xf bank_mask:0xf
  v_mov_b32_dpp v117, v115 row_newbcast:8 row_mask:0xf bank_mask:0xf
  v_pk_fma_f32 v[192:193], v[12:13], s[92:93], v[116:117] op_sel_hi:[1,1,0] neg_lo:[0,0,1] neg_hi:[0,0,1]
  v_pk_fma_f32 v[194:195], v[14:15], s[92:93], v[116:117] op_sel_hi:[1,1,0] neg_lo:[0,0,1] neg_hi:[0,0,1]
  v_cvt_pk_bf16_f32 v192, 0, v192
  v_cndmask_b32 v184, 0, v163, s[72:73]
  v_cvt_pk_bf16_f32 v193, 0, v193
  v_cndmask_b32 v185, 0, v164, s[72:73]
  v_cvt_pk_bf16_f32 v194, 0, v194
  v_cndmask_b32 v186, 0, v163, s[74:75]
  v_cvt_pk_bf16_f32 v195, 0, v195
  v_cndmask_b32 v187, 0, v164, s[74:75]
  v_pk_mul_f32 v[192:193], v[192:193], v[116:117] op_sel:[0,1]
  v_cndmask_b32 v188, 0, v163, s[76:77]
  v_pk_mul_f32 v[194:195], v[194:195], v[116:117] op_sel:[0,1]
  s_waitcnt vmcnt(14)
  buffer_load_dwordx4 v[76:79], v93, s[12:15], s61 offen offset:1024 nt
  v_pk_fma_f32 v[196:197], v[16:17], s[92:93], v[116:117] op_sel_hi:[1,1,0] neg_lo:[0,0,1] neg_hi:[0,0,1]
  v_pk_fma_f32 v[198:199], v[18:19], s[92:93], v[116:117] op_sel_hi:[1,1,0] neg_lo:[0,0,1] neg_hi:[0,0,1]
  v_cvt_pk_bf16_f32 v196, 0, v196
  v_cndmask_b32 v189, 0, v164, s[76:77]
  v_cvt_pk_bf16_f32 v197, 0, v197
  v_cndmask_b32 v190, 0, v163, s[78:79]
  v_cvt_pk_bf16_f32 v198, 0, v198
  v_cndmask_b32 v191, 0, v164, s[78:79]
  v_cvt_pk_bf16_f32 v199, 0, v199
  v_pk_mul_f32 v[196:197], v[196:197], v[116:117] op_sel:[0,1]
  v_pk_mul_f32 v[198:199], v[198:199], v[116:117] op_sel:[0,1]
  s_waitcnt vmcnt(14)
  buffer_load_dwordx4 v[80:83], v93, s[12:15], s61 offen offset:1280 nt
  v_pk_fma_f32 v[200:201], v[20:21], s[92:93], v[116:117] op_sel_hi:[1,1,0] neg_lo:[0,0,1] neg_hi:[0,0,1]
  v_pk_fma_f32 v[202:203], v[22:23], s[92:93], v[116:117] op_sel_hi:[1,1,0] neg_lo:[0,0,1] neg_hi:[0,0,1]
  v_cvt_pk_bf16_f32 v200, 0, v200
  v_cvt_pk_bf16_f32 v201, 0, v201
  v_cvt_pk_bf16_f32 v202, 0, v202
  v_cvt_pk_bf16_f32 v203, 0, v203
  v_pk_mul_f32 v[200:201], v[200:201], v[116:117] op_sel:[0,1]
  v_pk_mul_f32 v[202:203], v[202:203], v[116:117] op_sel:[0,1]
  s_waitcnt vmcnt(14)
  s_cbranch_vccnz L_vw0_27
  s_waitcnt vmcnt(9)
L_vw0_27:
  buffer_load_dwordx4 v[84:87], v93, s[12:15], s61 offen offset:1536 nt
  v_mov_b32_dpp v116, v114 row_newbcast:9 row_mask:0xf bank_mask:0xf
  v_mov_b32_dpp v117, v115 row_newbcast:9 row_mask:0xf bank_mask:0xf
  v_pk_fma_f32 v[108:109], v[24:25], s[92:93], v[116:117] op_sel_hi:[1,1,0] neg_lo:[0,0,1] neg_hi:[0,0,1]
  v_pk_fma_f32 v[110:111], v[26:27], s[92:93], v[116:117] op_sel_hi:[1,1,0] neg_lo:[0,0,1] neg_hi:[0,0,1]
  v_cvt_pk_bf16_f32 v108, 0, v108
  v_cvt_pk_bf16_f32 v109, 0, v109
  v_cvt_pk_bf16_f32 v110, 0, v110
  v_cvt_pk_bf16_f32 v111, 0, v111
  v_pk_mul_f32 v[108:109], v[108:109], v[116:117] op_sel:[0,1]
  v_pk_mul_f32 v[110:111], v[110:111], v[116:117] op_sel:[0,1]
  v_cvt_pk_bf16_f32 v204, v192, v108
  v_cvt_pk_bf16_f32 v208, v193, v109
  v_cvt_pk_bf16_f32 v212, v194, v110
  v_cvt_pk_bf16_f32 v216, v195, v111
  s_waitcnt vmcnt(14)
  buffer_load_dwordx4 v[88:91], v93, s[12:15], s61 offen offset:1792 nt
  v_pk_fma_f32 v[108:109], v[28:29], s[92:93], v[116:117] op_sel_hi:[1,1,0] neg_lo:[0,0,1] neg_hi:[0,0,1]
  v_pk_fma_f32 v[110:111], v[30:31], s[92:93], v[116:117] op_sel_hi:[1,1,0] neg_lo:[0,0,1] neg_hi:[0,0,1]
  v_cvt_pk_bf16_f32 v108, 0, v108
  v_cvt_pk_bf16_f32 v109, 0, v109
  v_cvt_pk_bf16_f32 v110, 0, v110
  v_cvt_pk_bf16_f32 v111, 0, v111
  v_pk_mul_f32 v[108:109], v[108:109], v[116:117] op_sel:[0,1]
  v_pk_mul_f32 v[110:111], v[110:111], v[116:117] op_sel:[0,1]
  v_cvt_pk_bf16_f32 v220, v196, v108
  v_cvt_pk_bf16_f32 v224, v197, v109
  v_cvt_pk_bf16_f32 v228, v198, v110
  v_cvt_pk_bf16_f32 v232, v199, v111
  s_waitcnt vmcnt(14)
  buffer_load_dwordx4 v[4:7], v93, s[12:15], s61 offen offset:2048 nt
  v_pk_fma_f32 v[108:109], v[32:33], s[92:93], v[116:117] op_sel_hi:[1,1,0] neg_lo:[0,0,1] neg_hi:[0,0,1]
  v_pk_fma_f32 v[110:111], v[34:35], s[92:93], v[116:117] op_sel_hi:[1,1,0] neg_lo:[0,0,1] neg_hi:[0,0,1]
  v_cvt_pk_bf16_f32 v108, 0, v108
  v_cvt_pk_bf16_f32 v109, 0, v109
  v_cvt_pk_bf16_f32 v110, 0, v110
  v_cvt_pk_bf16_f32 v111, 0, v111
  v_pk_mul_f32 v[108:109], v[108:109], v[116:117] op_sel:[0,1]
  v_pk_mul_f32 v[110:111], v[110:111], v[116:117] op_sel:[0,1]
  v_cvt_pk_bf16_f32 v236, v200, v108
  v_cvt_pk_bf16_f32 v240, v201, v109
  v_cvt_pk_bf16_f32 v244, v202, v110
  v_cvt_pk_bf16_f32 v248, v203, v111
  s_waitcnt vmcnt(14)
  s_cbranch_vccnz L_vw0_30
  s_waitcnt vmcnt(9)
L_vw0_30:
  buffer_load_dwordx4 v[8:11], v93, s[12:15], s61 offen offset:2304 nt
  v_mov_b32_dpp v116, v114 row_newbcast:10 row_mask:0xf bank_mask:0xf
  v_mov_b32_dpp v117, v115 row_newbcast:10 row_mask:0xf bank_mask:0xf
  v_pk_fma_f32 v[192:193], v[36:37], s[92:93], v[116:117] op_sel_hi:[1,1,0] neg_lo:[0,0,1] neg_hi:[0,0,1]
  v_pk_fma_f32 v[194:195], v[38:39], s[92:93], v[116:117] op_sel_hi:[1,1,0] neg_lo:[0,0,1] neg_hi:[0,0,1]
  v_cvt_pk_bf16_f32 v192, 0, v192
  v_cvt_pk_bf16_f32 v193, 0, v193
  v_cvt_pk_bf16_f32 v194, 0, v194
  v_cvt_pk_bf16_f32 v195, 0, v195
  v_pk_mul_f32 v[192:193], v[192:193], v[116:117] op_sel:[0,1]
  v_pk_mul_f32 v[194:195], v[194:195], v[116:117] op_sel:[0,1]
  v_cvt_pk_bf16_f32 v205, v192, 0
  v_cvt_pk_bf16_f32 v209, v193, 0
  v_cvt_pk_bf16_f32 v213, v194, 0
  v_cvt_pk_bf16_f32 v217, v195, 0
  v_mfma_f32_16x16x16_bf16 v[128:131], v[184:185], v[204:205], v[128:131]
  v_mfma_f32_16x16x16_bf16 v[128:131], v[186:187], v[208:209], v[128:131]
  v_mfma_f32_16x16x16_bf16 v[128:131], v[188:189], v[212:213], v[128:131]
  v_mfma_f32_16x16x16_bf16 v[128:131], v[190:191], v[216:217], v[128:131]
  s_waitcnt vmcnt(14)
  buffer_load_dwordx4 v[12:15], v93, s[12:15], s61 offen offset:2560 nt
  v_pk_fma_f32 v[196:197], v[40:41], s[92:93], v[116:117] op_sel_hi:[1,1,0] neg_lo:[0,0,1] neg_hi:[0,0,1]
  v_pk_fma_f32 v[198:199], v[42:43], s[92:93], v[116:117] op_sel_hi:[1,1,0] neg_lo:[0,0,1] neg_hi:[0,0,1]
  v_cvt_pk_bf16_f32 v196, 0, v196
  v_cvt_pk_bf16_f32 v197, 0, v197
  v_cvt_pk_bf16_f32 v198, 0, v198
  v_cvt_pk_bf16_f32 v199, 0, v199
  v_pk_mul_f32 v[196:197], v[196:197], v[116:117] op_sel:[0,1]
  v_pk_mul_f32 v[198:199], v[198:199], v[116:117] op_sel:[0,1]
  v_cvt_pk_bf16_f32 v221, v196, 0
  v_cvt_pk_bf16_f32 v225, v197, 0
  v_cvt_pk_bf16_f32 v229, v198, 0
  v_cvt_pk_bf16_f32 v233, v199, 0
  v_mfma_f32_16x16x16_bf16 v[132:135], v[184:185], v[220:221], v[132:135]
  v_mfma_f32_16x16x16_bf16 v[132:135], v[186:187], v[224:225], v[132:135]
  v_mfma_f32_16x16x16_bf16 v[132:135], v[188:189], v[228:229], v[132:135]
  v_mfma_f32_16x16x16_bf16 v[132:135], v[190:191], v[232:233], v[132:135]
  s_waitcnt vmcnt(14)
  buffer_load_dwordx4 v[16:19], v93, s[12:15], s61 offen offset:2816 nt
  v_pk_fma_f32 v[200:201], v[44:45], s[92:93], v[116:117] op_sel_hi:[1,1,0] neg_lo:[0,0,1] neg_hi:[0,0,1]
  v_pk_fma_f32 v[202:203], v[46:47], s[92:93], v[116:117] op_sel_hi:[1,1,0] neg_lo:[0,0,1] neg_hi:[0,0,1]
  v_cvt_pk_bf16_f32 v200, 0, v200
  v_cvt_pk_bf16_f32 v201, 0, v201
  v_cvt_pk_bf16_f32 v202, 0, v202
  v_cvt_pk_bf16_f32 v203, 0, v203
  v_pk_mul_f32 v[200:201], v[200:201], v[116:117] op_sel:[0,1]
  v_pk_mul_f32 v[202:203], v[202:203], v[116:117] op_sel:[0,1]
  v_cvt_pk_bf16_f32 v237, v200, 0
  v_cvt_pk_bf16_f32 v241, v201, 0
  v_cvt_pk_bf16_f32 v245, v202, 0
  v_cvt_pk_bf16_f32 v249, v203, 0
  v_mfma_f32_16x16x16_bf16 v[136:139], v[184:185], v[236:237], v[136:139]
  v_mfma_f32_16x16x16_bf16 v[136:139], v[186:187], v[240:241], v[136:139]
  v_mfma_f32_16x16x16_bf16 v[136:139], v[188:189], v[244:245], v[136:139]
  v_mfma_f32_16x16x16_bf16 v[136:139], v[190:191], v[248:249], v[136:139]
  s_mov_b32 s60, s61
L_v1:
  s_add_u32 s97, s64, 96
  v_mov_b32 v146, s97
  s_mov_b32 s86, s84
  ds_write_b32 v104, v146
  s_add_u32 s64, s64, 2
  s_cmp_lt_u32 s64, s99
  s_cbranch_scc1 L_v11_ok
L_v11_spin:
  v_mov_b32 v144, 61700
  ds_read_b32 v144, v144
  s_waitcnt lgkmcnt(0)
  v_readfirstlane_b32 s99, v144
  s_nop 1
  s_cmp_lt_u32 s64, s99
  s_cbranch_scc0 L_v11_spin
L_v11_ok:
  s_lshr_b32 s71, s64, 5
  s_lshr_b32 s85, s96, s71
  s_bfe_u32 s85, s85, 0x10003
  s_and_b32 s70, s64, 31
  s_lshl_b32 s71, s71, 12
  s_add_u32 s70, s70, s5
  s_add_u32 s70, s70, s71
  s_mul_hi_u32 s84, s70, s90
  s_lshr_b32 s84, s84, 1
  s_mul_i32 s71, s84, 3
  s_sub_u32 s70, s70, s71
  s_lshl3_add_u32 s85, s70, s85
  s_mul_i32 s61, s84, 196608
  s_lshr_b32 s89, s84, 4
  s_lshl_b32 s70, s85, 5
  v_add_u32 v97, s70, v1
  v_mul_u32_u24 v97, 21846, v97
  v_lshrrev_b32 v97, 16, v97
  v_add_u32 v144, s85, v2
  v_lshrrev_b32 v145, v144, s91
  v_and_b32 v145, 1, v145
  v_cmp_eq_u32 s[54:55], 1, v145
  s_nop 1
  s_and_b64 s[52:53], s[54:55], s[58:59]
  s_andn2_b64 s[54:55], s[54:55], s[58:59]
  s_cmp_lt_u32 s64, 96
  s_cselect_b32 s61, s61, 805306368
  s_lshr_b32 s70, s64, 1
  s_cmp_eq_u32 s70, 32
  s_cselect_b32 s48, -36096, s63
  ds_read_b32 v106, v104 offset:8
  s_waitcnt vmcnt(14)
  s_cbranch_vccnz L_vw1_0
  s_waitcnt vmcnt(9)
L_vw1_0:
  buffer_load_dwordx4 v[20:23], v93, s[12:15], s60 offen offset:3072 nt
  v_mul_f32 v114, s94, v112
  v_mul_f32 v115, 0x4a800000, v113
  s_nop 0
  v_mov_b32_dpp v116, v114 row_newbcast:0 row_mask:0xf bank_mask:0xf
  v_mov_b32_dpp v117, v115 row_newbcast:0 row_mask:0xf bank_mask:0xf
  v_pk_fma_f32 v[192:193], v[48:49], s[92:93], v[116:117] op_sel_hi:[1,1,0] neg_lo:[0,0,1] neg_hi:[0,0,1]
  v_pk_fma_f32 v[194:195], v[50:51], s[92:93], v[116:117] op_sel_hi:[1,1,0] neg_lo:[0,0,1] neg_hi:[0,0,1]
  v_cvt_pk_bf16_f32 v192, 0, v192
  v_cvt_pk_bf16_f32 v193, 0, v193
  v_cvt_pk_bf16_f32 v194, 0, v194
  v_cvt_pk_bf16_f32 v195, 0, v195
  v_pk_mul_f32 v[192:193], v[192:193], v[116:117] op_sel:[0,1]
  v_pk_mul_f32 v[194:195], v[194:195], v[116:117] op_sel:[0,1]
  s_waitcnt lgkmcnt(0)
  v_cmp_lt_u32 vcc, s97, v106
  s_waitcnt vmcnt(14)
  buffer_load_dwordx4 v[24:27], v93, s[12:15], s60 offen offset:3328 nt
  v_pk_fma_f32 v[196:197], v[52:53], s[92:93], v[116:117] op_sel_hi:[1,1,0] neg_lo:[0,0,1] neg_hi:[0,0,1]
  v_pk_fma_f32 v[198:199], v[54:55], s[92:93], v[116:117] op_sel_hi:[1,1,0] neg_lo:[0,0,1] neg_hi:[0,0,1]
  v_cvt_pk_bf16_f32 v196, 0, v196
  v_lshlrev_b32 v148, 16, v120
  v_cvt_pk_bf16_f32 v197, 0, v197
  v_and_b32 v149, s65, v120
  v_cvt_pk_bf16_f32 v198, 0, v198
  v_lshlrev_b32 v150, 16, v121
  v_cvt_pk_bf16_f32 v199, 0, v199
  v_and_b32 v151, s65, v121
  v_pk_mul_f32 v[196:197], v[196:197], v[116:117] op_sel:[0,1]
  v_lshlrev_b32 v152, 16, v122
  v_pk_mul_f32 v[198:199], v[198:199], v[116:117] op_sel:[0,1]
  s_waitcnt vmcnt(14)
  buffer_load_dwordx4 v[28:31], v93, s[12:15], s60 offen offset:3584 nt
  v_pk_fma_f32 v[200:201], v[56:57], s[92:93], v[116:117] op_sel_hi:[1,1,0] neg_lo:[0,0,1] neg_hi:[0,0,1]
  v_pk_fma_f32 v[202:203], v[58:59], s[92:93], v[116:117] op_sel_hi:[1,1,0] neg_lo:[0,0,1] neg_hi:[0,0,1]
  v_cvt_pk_bf16_f32 v200, 0, v200
  v_and_b32 v153, s65, v122
  v_cvt_pk_bf16_f32 v201, 0, v201
  v_lshlrev_b32 v154, 16, v123
  v_cvt_pk_bf16_f32 v202, 0, v202
  v_and_b32 v155, s65, v123
  v_cvt_pk_bf16_f32 v203, 0, v203
  v_lshlrev_b32 v156, 16, v124
  v_pk_mul_f32 v[200:201], v[200:201], v[116:117] op_sel:[0,1]
  v_and_b32 v157, s65, v124
  v_pk_mul_f32 v[202:203], v[202:203], v[116:117] op_sel:[0,1]
  s_waitcnt vmcnt(14)
  s_cbranch_vccnz L_vw1_3
  s_waitcnt vmcnt(9)
L_vw1_3:
  buffer_load_dwordx4 v[32:35], v94, s[12:15], s60 offen offset:0 nt
  v_mov_b32_dpp v116, v114 row_newbcast:1 row_mask:0xf bank_mask:0xf
  v_mov_b32_dpp v117, v115 row_newbcast:1 row_mask:0xf bank_mask:0xf
  v_pk_fma_f32 v[108:109], v[60:61], s[92:93], v[116:117] op_sel_hi:[1,1,0] neg_lo:[0,0,1] neg_hi:[0,0,1]
  v_pk_fma_f32 v[110:111], v[62:63], s[92:93], v[116:117] op_sel_hi:[1,1,0] neg_lo:[0,0,1] neg_hi:[0,0,1]
  s_lshl_b32 s62, s84, 9
  v_lshl_add_u32 v98, v97, 1, v96
  buffer_load_short_d16_hi v112, v98, s[32:35], s62 offen
  buffer_load_short_d16_hi v113, v98, s[28:31], s62 offen
  v_cvt_pk_bf16_f32 v108, 0, v108
  v_lshlrev_b32 v158, 16, v125
  v_cvt_pk_bf16_f32 v109, 0, v109
  v_add_u32 v99, s48, v99
  v_cvt_pk_bf16_f32 v110, 0, v110
  v_add_u32 v100, s48, v100
  v_cvt_pk_bf16_f32 v111, 0, v111
  v_max3_f32 v144, v148, v149, v150
  v_pk_mul_f32 v[108:109], v[108:109], v[116:117] op_sel:[0,1]
  ds_read_b128 v[120:123], v99
  v_pk_mul_f32 v[110:111], v[110:111], v[116:117] op_sel:[0,1]
  v_cvt_pk_bf16_f32 v204, v192, v108
  v_cvt_pk_bf16_f32 v208, v193, v109
  v_cvt_pk_bf16_f32 v212, v194, v110
  v_cvt_pk_bf16_f32 v216, v195, v111
  s_waitcnt vmcnt(16)
  buffer_load_dwordx4 v[36:39], v94, s[12:15], s60 offen offset:256 nt
  v_pk_fma_f32 v[108:109], v[64:65], s[92:93], v[116:117] op_sel_hi:[1,1,0] neg_lo:[0,0,1] neg_hi:[0,0,1]
  v_pk_fma_f32 v[110:111], v[66:67], s[92:93], v[116:117] op_sel_hi:[1,1,0] neg_lo:[0,0,1] neg_hi:[0,0,1]
  v_cvt_pk_bf16_f32 v108, 0, v108
  ds_read_b64 v[124:125], v100 offset:256
  v_cvt_pk_bf16_f32 v109, 0, v109
  v_max3_f32 v145, v151, v152, v153
  v_cvt_pk_bf16_f32 v110, 0, v110
  v_max3_f32 v144, v144, v154, v155
  v_cvt_pk_bf16_f32 v111, 0, v111
  v_max3_f32 v145, v145, v156, v157
  v_pk_mul_f32 v[108:109], v[108:109], v[116:117] op_sel:[0,1]
  v_max3_f32 v144, v144, v158, v140
  v_pk_mul_f32 v[110:111], v[110:111], v[116:117] op_sel:[0,1]
  v_cvt_pk_bf16_f32 v220, v196, v108
  v_cvt_pk_bf16_f32 v224, v197, v109
  v_cvt_pk_bf16_f32 v228, v198, v110
  v_cvt_pk_bf16_f32 v232, v199, v111
  s_waitcnt vmcnt(16)
  buffer_load_dwordx4 v[40:43], v94, s[12:15], s60 offen offset:512 nt
  v_pk_fma_f32 v[108:109], v[68:69], s[92:93], v[116:117] op_sel_hi:[1,1,0] neg_lo:[0,0,1] neg_hi:[0,0,1]
  v_pk_fma_f32 v[110:111], v[70:71], s[92:93], v[116:117] op_sel_hi:[1,1,0] neg_lo:[0,0,1] neg_hi:[0,0,1]
  v_cvt_pk_bf16_f32 v108, 0, v108
  v_max_f32 v144, v144, v145
  v_cvt_pk_bf16_f32 v109, 0, v109
  v_mov_b32 v145, v144
  v_cvt_pk_bf16_f32 v110, 0, v110
  s_nop 0
  v_permlane32_swap_b32 v144, v145
  v_cvt_pk_bf16_f32 v111, 0, v111
  v_max_f32 v144, v144, v145
  v_pk_mul_f32 v[108:109], v[108:109], v[116:117] op_sel:[0,1]
  v_mov_b32 v145, v144
  v_pk_mul_f32 v[110:111], v[110:111], v[116:117] op_sel:[0,1]
  v_cvt_pk_bf16_f32 v236, v200, v108
  v_cvt_pk_bf16_f32 v240, v201, v109
  v_cvt_pk_bf16_f32 v244, v202, v110
  v_cvt_pk_bf16_f32 v248, v203, v111
  s_waitcnt vmcnt(16)
  s_cbranch_vccnz L_vw1_6
  s_waitcnt vmcnt(11)
L_vw1_6:
  buffer_load_dwordx4 v[44:47], v94, s[12:15], s60 offen offset:768 nt
  v_mov_b32_dpp v116, v114 row_newbcast:2 row_mask:0xf bank_mask:0xf
  v_mov_b32_dpp v117, v115 row_newbcast:2 row_mask:0xf bank_mask:0xf
  v_pk_fma_f32 v[192:193], v[72:73], s[92:93], v[116:117] op_sel_hi:[1,1,0] neg_lo:[0,0,1] neg_hi:[0,0,1]
  v_pk_fma_f32 v[194:195], v[74:75], s[92:93], v[116:117] op_sel_hi:[1,1,0] neg_lo:[0,0,1] neg_hi:[0,0,1]
  v_cvt_pk_bf16_f32 v192, 0, v192
  v_permlane16_swap_b32 v144, v145
  v_cvt_pk_bf16_f32 v193, 0, v193
  v_max_f32 v140, v144, v145
  v_cvt_pk_bf16_f32 v194, 0, v194
  v_mul_f32 v144, s66, v140
  v_cvt_pk_bf16_f32 v195, 0, v195
  v_add_f32 v146, v144, v142
  v_pk_mul_f32 v[192:193], v[192:193], v[116:117] op_sel:[0,1]
  v_sub_f32 v142, 0, v144
  v_pk_mul_f32 v[194:195], v[194:195], v[116:117] op_sel:[0,1]
  s_waitcnt vmcnt(16)
  buffer_load_dwordx4 v[48:51], v94, s[12:15], s60 offen offset:1024 nt
  v_pk_fma_f32 v[196:197], v[76:77], s[92:93], v[116:117] op_sel_hi:[1,1,0] neg_lo:[0,0,1] neg_hi:[0,0,1]
  v_pk_fma_f32 v[198:199], v[78:79], s[92:93], v[116:117] op_sel_hi:[1,1,0] neg_lo:[0,0,1] neg_hi:[0,0,1]
  v_cvt_pk_bf16_f32 v196, 0, v196
  v_exp_f32 v146, -v146
  v_cvt_pk_bf16_f32 v197, 0, v197
  ds_bpermute_b32 v147, v101, v146
  v_cvt_pk_bf16_f32 v198, 0, v198
  v_fma_f32 v148, v148, s66, v142
  v_cvt_pk_bf16_f32 v199, 0, v199
  v_exp_f32 v148, v148
  v_pk_mul_f32 v[196:197], v[196:197], v[116:117] op_sel:[0,1]
  v_fma_f32 v149, v149, s66, v142
  v_pk_mul_f32 v[198:199], v[198:199], v[116:117] op_sel:[0,1]
  s_waitcnt vmcnt(16)
  buffer_load_dwordx4 v[52:55], v94, s[12:15], s60 offen offset:1280 nt
  v_pk_fma_f32 v[200:201], v[80:81], s[92:93], v[116:117] op_sel_hi:[1,1,0] neg_lo:[0,0,1] neg_hi:[0,0,1]
  v_pk_fma_f32 v[202:203], v[82:83], s[92:93], v[116:117] op_sel_hi:[1,1,0] neg_lo:[0,0,1] neg_hi:[0,0,1]
  v_cvt_pk_bf16_f32 v200, 0, v200
  v_exp_f32 v149, v149
  v_cvt_pk_bf16_f32 v201, 0, v201
  v_fma_f32 v150, v150, s66, v142
  v_cvt_pk_bf16_f32 v202, 0, v202
  v_exp_f32 v150, v150
  v_cvt_pk_bf16_f32 v203, 0, v203
  v_fma_f32 v151, v151, s66, v142
  v_pk_mul_f32 v[200:201], v[200:201], v[116:117] op_sel:[0,1]
  v_exp_f32 v151, v151
  v_pk_mul_f32 v[202:203], v[202:203], v[116:117] op_sel:[0,1]
  s_waitcnt vmcnt(16)
  s_cbranch_vccnz L_vw1_9
  s_waitcnt vmcnt(11)
L_vw1_9:
  buffer_load_dwordx4 v[56:59], v94, s[12:15], s60 offen offset:1536 nt
  v_mov_b32_dpp v116, v114 row_newbcast:3 row_mask:0xf bank_mask:0xf
  v_mov_b32_dpp v117, v115 row_newbcast:3 row_mask:0xf bank_mask:0xf
  v_pk_fma_f32 v[108:109], v[84:85], s[92:93], v[116:117] op_sel_hi:[1,1,0] neg_lo:[0,0,1] neg_hi:[0,0,1]
  v_pk_fma_f32 v[110:111], v[86:87], s[92:93], v[116:117] op_sel_hi:[1,1,0] neg_lo:[0,0,1] neg_hi:[0,0,1]
  v_cvt_pk_bf16_f32 v108, 0, v108
  v_fma_f32 v152, v152, s66, v142
  v_cvt_pk_bf16_f32 v109, 0, v109
  v_exp_f32 v152, v152
  v_cvt_pk_bf16_f32 v110, 0, v110
  v_fma_f32 v153, v153, s66, v142
  v_cvt_pk_bf16_f32 v111, 0, v111
  v_exp_f32 v153, v153
  v_pk_mul_f32 v[108:109], v[108:109], v[116:117] op_sel:[0,1]
  v_fma_f32 v154, v154, s66, v142
  v_pk_mul_f32 v[110:111], v[110:111], v[116:117] op_sel:[0,1]
  v_cvt_pk_bf16_f32 v205, v192, v108
  v_cvt_pk_bf16_f32 v209, v193, v109
  v_cvt_pk_bf16_f32 v213, v194, v110
  v_cvt_pk_bf16_f32 v217, v195, v111
  s_waitcnt vmcnt(16)
  buffer_load_dwordx4 v[60:63], v94, s[12:15], s60 offen offset:1792 nt
  v_pk_fma_f32 v[108:109], v[88:89], s[92:93], v[116:117] op_sel_hi:[1,1,0] neg_lo:[0,0,1] neg_hi:[0,0,1]
  v_pk_fma_f32 v[110:111], v[90:91], s[92:93], v[116:117] op_sel_hi:[1,1,0] neg_lo:[0,0,1] neg_hi:[0,0,1]
  v_cvt_pk_bf16_f32 v108, 0, v108
  v_exp_f32 v154, v154
  v_cvt_pk_bf16_f32 v109, 0, v109
  v_fma_f32 v155, v155, s66, v142
  v_cvt_pk_bf16_f32 v110, 0, v110
  v_exp_f32 v155, v155
  v_cvt_pk_bf16_f32 v111, 0, v111
  v_fma_f32 v156, v156, s66, v142
  v_pk_mul_f32 v[108:109], v[108:109], v[116:117] op_sel:[0,1]
  v_exp_f32 v156, v156
  v_pk_mul_f32 v[110:111], v[110:111], v[116:117] op_sel:[0,1]
  v_cvt_pk_bf16_f32 v221, v196, v108
  v_cvt_pk_bf16_f32 v225, v197, v109
  v_cvt_pk_bf16_f32 v229, v198, v110
  v_cvt_pk_bf16_f32 v233, v199, v111
  s_waitcnt vmcnt(16)
  buffer_load_dwordx4 v[64:67], v94, s[12:15], s60 offen offset:2048 nt
  v_pk_fma_f32 v[108:109], v[4:5], s[92:93], v[116:117] op_sel_hi:[1,1,0] neg_lo:[0,0,1] neg_hi:[0,0,1]
  v_pk_fma_f32 v[110:111], v[6:7], s[92:93], v[116:117] op_sel_hi:[1,1,0] neg_lo:[0,0,1] neg_hi:[0,0,1]
  v_cvt_pk_bf16_f32 v108, 0, v108
  v_fma_f32 v157, v157, s66, v142
  v_cvt_pk_bf16_f32 v109, 0, v109
  v_exp_f32 v157, v157
  v_cvt_pk_bf16_f32 v110, 0, v110
  v_fma_f32 v158, v158, s66, v142
  v_cvt_pk_bf16_f32 v111, 0, v111
  v_exp_f32 v158, v158
  v_pk_mul_f32 v[108:109], v[108:109], v[116:117] op_sel:[0,1]
  v_add_f32 v144, v148, v149
  v_pk_mul_f32 v[110:111], v[110:111], v[116:117] op_sel:[0,1]
  v_cvt_pk_bf16_f32 v237, v200, v108
  v_cvt_pk_bf16_f32 v241, v201, v109
  v_cvt_pk_bf16_f32 v245, v202, v110
  v_cvt_pk_bf16_f32 v249, v203, v111
  s_waitcnt vmcnt(16)
  s_cbranch_vccnz L_vw1_12
  s_waitcnt vmcnt(11)
L_vw1_12:
  buffer_load_dwordx4 v[68:71], v94, s[12:15], s60 offen offset:2304 nt
  v_mov_b32_dpp v116, v114 row_newbcast:4 row_mask:0xf bank_mask:0xf
  v_mov_b32_dpp v117, v115 row_newbcast:4 row_mask:0xf bank_mask:0xf
  v_pk_fma_f32 v[192:193], v[8:9], s[92:93], v[116:117] op_sel_hi:[1,1,0] neg_lo:[0,0,1] neg_hi:[0,0,1]
  v_pk_fma_f32 v[194:195], v[10:11], s[92:93], v[116:117] op_sel_hi:[1,1,0] neg_lo:[0,0,1] neg_hi:[0,0,1]
  v_cvt_pk_bf16_f32 v192, 0, v192
  v_add_f32 v145, v150, v151
  v_cvt_pk_bf16_f32 v193, 0, v193
  v_add_f32 v144, v144, v152
  v_cvt_pk_bf16_f32 v194, 0, v194
  v_add_f32 v145, v145, v153
  v_cvt_pk_bf16_f32 v195, 0, v195
  v_add_f32 v144, v144, v154
  v_pk_mul_f32 v[192:193], v[192:193], v[116:117] op_sel:[0,1]
  v_add_f32 v145, v145, v155
  v_pk_mul_f32 v[194:195], v[194:195], v[116:117] op_sel:[0,1]
  s_waitcnt vmcnt(16)
  buffer_load_dwordx4 v[72:75], v94, s[12:15], s60 offen offset:2560 nt
  v_pk_fma_f32 v[196:197], v[12:13], s[92:93], v[116:117] op_sel_hi:[1,1,0] neg_lo:[0,0,1] neg_hi:[0,0,1]
  v_pk_fma_f32 v[198:199], v[14:15], s[92:93], v[116:117] op_sel_hi:[1,1,0] neg_lo:[0,0,1] neg_hi:[0,0,1]
  v_cvt_pk_bf16_f32 v196, 0, v196
  v_add_f32 v144, v144, v156
  v_cvt_pk_bf16_f32 v197, 0, v197
  v_add_f32 v145, v145, v157
  v_cvt_pk_bf16_f32 v198, 0, v198
  v_add_f32 v144, v144, v158
  v_cvt_pk_bf16_f32 v199, 0, v199
  v_add_f32 v144, v144, v145
  v_pk_mul_f32 v[196:197], v[196:197], v[116:117] op_sel:[0,1]
  v_fma_f32 v143, v143, v146, v144
  v_pk_mul_f32 v[198:199], v[198:199], v[116:117] op_sel:[0,1]
  s_waitcnt vmcnt(16)
  buffer_load_dwordx4 v[76:79], v94, s[12:15], s60 offen offset:2816 nt
  v_pk_fma_f32 v[200:201], v[16:17], s[92:93], v[116:117] op_sel_hi:[1,1,0] neg_lo:[0,0,1] neg_hi:[0,0,1]
  v_pk_fma_f32 v[202:203], v[18:19], s[92:93], v[116:117] op_sel_hi:[1,1,0] neg_lo:[0,0,1] neg_hi:[0,0,1]
  v_cvt_pk_bf16_f32 v200, 0, v200
  v_cvt_pk_bf16_f32 v159, v148, v149
  v_cvt_pk_bf16_f32 v201, 0, v201
  v_cvt_pk_bf16_f32 v160, v150, v151
  v_cvt_pk_bf16_f32 v202, 0, v202
  v_cvt_pk_bf16_f32 v161, v152, v153
  v_cvt_pk_bf16_f32 v203, 0, v203
  v_cvt_pk_bf16_f32 v162, v154, v155
  v_pk_mul_f32 v[200:201], v[200:201], v[116:117] op_sel:[0,1]
  v_cvt_pk_bf16_f32 v163, v156, v157
  v_pk_mul_f32 v[202:203], v[202:203], v[116:117] op_sel:[0,1]
  s_waitcnt vmcnt(16)
  s_cbranch_vccnz L_vw1_15
  s_waitcnt vmcnt(9)
L_vw1_15:
  buffer_load_dwordx4 v[80:83], v95, s[12:15], s60 offen offset:0 nt
  v_mov_b32_dpp v116, v114 row_newbcast:5 row_mask:0xf bank_mask:0xf
  v_mov_b32_dpp v117, v115 row_newbcast:5 row_mask:0xf bank_mask:0xf
  v_pk_fma_f32 v[108:109], v[20:21], s[92:93], v[116:117] op_sel_hi:[1,1,0] neg_lo:[0,0,1] neg_hi:[0,0,1]
  v_pk_fma_f32 v[110:111], v[22:23], s[92:93], v[116:117] op_sel_hi:[1,1,0] neg_lo:[0,0,1] neg_hi:[0,0,1]
  v_cvt_pk_bf16_f32 v108, 0, v108
  v_cvt_pk_bf16_f32 v164, v158, 0
  v_cvt_pk_bf16_f32 v109, 0, v109
  v_cndmask_b32 v168, 0, v159, s[72:73]
  v_cvt_pk_bf16_f32 v110, 0, v110
  v_cndmask_b32 v169, 0, v160, s[72:73]
  v_cvt_pk_bf16_f32 v111, 0, v111
  v_cndmask_b32 v170, 0, v161, s[72:73]
  v_pk_mul_f32 v[108:109], v[108:109], v[116:117] op_sel:[0,1]
  v_cndmask_b32 v171, 0, v162, s[72:73]
  v_pk_mul_f32 v[110:111], v[110:111], v[116:117] op_sel:[0,1]
  v_cvt_pk_bf16_f32 v206, v192, v108
  v_cvt_pk_bf16_f32 v210, v193, v109
  v_cvt_pk_bf16_f32 v214, v194, v110
  v_cvt_pk_bf16_f32 v218, v195, v111
  s_waitcnt vmcnt(16)
  buffer_load_dwordx4 v[84:87], v95, s[12:15], s60 offen offset:256 nt
  v_pk_fma_f32 v[108:109], v[24:25], s[92:93], v[116:117] op_sel_hi:[1,1,0] neg_lo:[0,0,1] neg_hi:[0,0,1]
  v_pk_fma_f32 v[110:111], v[26:27], s[92:93], v[116:117] op_sel_hi:[1,1,0] neg_lo:[0,0,1] neg_hi:[0,0,1]
  v_cvt_pk_bf16_f32 v108, 0, v108
  v_cndmask_b32 v172, 0, v159, s[74:75]
  v_cvt_pk_bf16_f32 v109, 0, v109
  v_cndmask_b32 v173, 0, v160, s[74:75]
  v_cvt_pk_bf16_f32 v110, 0, v110
  v_cndmask_b32 v174, 0, v161, s[74:75]
  v_cvt_pk_bf16_f32 v111, 0, v111
  v_cndmask_b32 v175, 0, v162, s[74:75]
  v_pk_mul_f32 v[108:109], v[108:109], v[116:117] op_sel:[0,1]
  v_cndmask_b32 v176, 0, v159, s[76:77]
  v_pk_mul_f32 v[110:111], v[110:111], v[116:117] op_sel:[0,1]
  v_cvt_pk_bf16_f32 v222, v196, v108
  v_cvt_pk_bf16_f32 v226, v197, v109
  v_cvt_pk_bf16_f32 v230, v198, v110
  v_cvt_pk_bf16_f32 v234, v199, v111
  s_waitcnt vmcnt(16)
  buffer_load_dwordx4 v[88:91], v95, s[12:15], s60 offen offset:512 nt
  v_pk_fma_f32 v[108:109], v[28:29], s[92:93], v[116:117] op_sel_hi:[1,1,0] neg_lo:[0,0,1] neg_hi:[0,0,1]
  v_pk_fma_f32 v[110:111], v[30:31], s[92:93], v[116:117] op_sel_hi:[1,1,0] neg_lo:[0,0,1] neg_hi:[0,0,1]
  v_cvt_pk_bf16_f32 v108, 0, v108
  v_cndmask_b32 v177, 0, v160, s[76:77]
  v_cvt_pk_bf16_f32 v109, 0, v109
  v_cndmask_b32 v178, 0, v161, s[76:77]
  v_cvt_pk_bf16_f32 v110, 0, v110
  v_cndmask_b32 v179, 0, v162, s[76:77]
  v_cvt_pk_bf16_f32 v111, 0, v111
  v_cndmask_b32 v180, 0, v159, s[78:79]
  v_pk_mul_f32 v[108:109], v[108:109], v[116:117] op_sel:[0,1]
  v_cndmask_b32 v181, 0, v160, s[78:79]
  v_pk_mul_f32 v[110:111], v[110:111], v[116:117] op_sel:[0,1]
  v_cvt_pk_bf16_f32 v238, v200, v108
  v_cvt_pk_bf16_f32 v242, v201, v109
  v_cvt_pk_bf16_f32 v246, v202, v110
  v_cvt_pk_bf16_f32 v250, v203, v111
  v_mad_u32_u24 v92, v97, s63, v3
  v_add_u32 v93, 768, v92
  v_add_u32 v94, 4608, v92
  v_add_u32 v95, 7680, v92
  v_cndmask_b32 v92, v92, v105, s[52:53]
  v_cndmask_b32 v95, v95, v105, s[54:55]
  s_waitcnt vmcnt(16)
  s_cbranch_vccnz L_vw1_18
  s_waitcnt vmcnt(9)
L_vw1_18:
  buffer_load_dwordx4 v[4:7], v92, s[12:15], s61 offen offset:0 nt
  v_mov_b32_dpp v116, v114 row_newbcast:6 row_mask:0xf bank_mask:0xf
  v_mov_b32_dpp v117, v115 row_newbcast:6 row_mask:0xf bank_mask:0xf
  v_pk_fma_f32 v[192:193], v[32:33], s[92:93], v[116:117] op_sel_hi:[1,1,0] neg_lo:[0,0,1] neg_hi:[0,0,1]
  v_pk_fma_f32 v[194:195], v[34:35], s[92:93], v[116:117] op_sel_hi:[1,1,0] neg_lo:[0,0,1] neg_hi:[0,0,1]
  v_cvt_pk_bf16_f32 v192, 0, v192
  v_cndmask_b32 v182, 0, v161, s[78:79]
  v_cvt_pk_bf16_f32 v193, 0, v193
  v_cndmask_b32 v183, 0, v162, s[78:79]
  v_cvt_pk_bf16_f32 v194, 0, v194
  s_waitcnt lgkmcnt(0)
  v_cvt_pk_bf16_f32 v195, 0, v195
  v_mul_f32 v128, v147, v128
  v_pk_mul_f32 v[192:193], v[192:193], v[116:117] op_sel:[0,1]
  v_mul_f32 v129, v147, v129
  v_pk_mul_f32 v[194:195], v[194:195], v[116:117] op_sel:[0,1]
  s_waitcnt vmcnt(14)
  buffer_load_dwordx4 v[8:11], v92, s[12:15], s61 offen offset:256 nt
  v_pk_fma_f32 v[196:197], v[36:37], s[92:93], v[116:117] op_sel_hi:[1,1,0] neg_lo:[0,0,1] neg_hi:[0,0,1]
  v_pk_fma_f32 v[198:199], v[38:39], s[92:93], v[116:117] op_sel_hi:[1,1,0] neg_lo:[0,0,1] neg_hi:[0,0,1]
  v_cvt_pk_bf16_f32 v196, 0, v196
  v_mul_f32 v130, v147, v130
  v_cvt_pk_bf16_f32 v197, 0, v197
  v_mul_f32 v131, v147, v131
  v_cvt_pk_bf16_f32 v198, 0, v198
  v_mul_f32 v132, v147, v132
  v_cvt_pk_bf16_f32 v199, 0, v199
  v_mul_f32 v133, v147, v133
  v_pk_mul_f32 v[196:197], v[196:197], v[116:117] op_sel:[0,1]
  v_mul_f32 v134, v147, v134
  v_pk_mul_f32 v[198:199], v[198:199], v[116:117] op_sel:[0,1]
  s_waitcnt vmcnt(14)
  buffer_load_dwordx4 v[12:15], v92, s[12:15], s61 offen offset:512 nt
  v_pk_fma_f32 v[200:201], v[40:41], s[92:93], v[116:117] op_sel_hi:[1,1,0] neg_lo:[0,0,1] neg_hi:[0,0,1]
  v_pk_fma_f32 v[202:203], v[42:43], s[92:93], v[116:117] op_sel_hi:[1,1,0] neg_lo:[0,0,1] neg_hi:[0,0,1]
  v_cvt_pk_bf16_f32 v200, 0, v200
  v_mul_f32 v135, v147, v135
  v_cvt_pk_bf16_f32 v201, 0, v201
  v_mul_f32 v136, v147, v136
  v_cvt_pk_bf16_f32 v202, 0, v202
  v_mul_f32 v137, v147, v137
  v_cvt_pk_bf16_f32 v203, 0, v203
  v_mul_f32 v138, v147, v138
  v_pk_mul_f32 v[200:201], v[200:201], v[116:117] op_sel:[0,1]
  v_mul_f32 v139, v147, v139
  v_pk_mul_f32 v[202:203], v[202:203], v[116:117] op_sel:[0,1]
  s_waitcnt vmcnt(14)
  s_cbranch_vccnz L_vw1_21
  s_waitcnt vmcnt(9)
L_vw1_21:
  buffer_load_dwordx4 v[16:19], v93, s[12:15], s61 offen offset:0 nt
  v_mov_b32_dpp v116, v114 row_newbcast:7 row_mask:0xf bank_mask:0xf
  v_mov_b32_dpp v117, v115 row_newbcast:7 row_mask:0xf bank_mask:0xf
  v_pk_fma_f32 v[108:109], v[44:45], s[92:93], v[116:117] op_sel_hi:[1,1,0] neg_lo:[0,0,1] neg_hi:[0,0,1]
  v_pk_fma_f32 v[110:111], v[46:47], s[92:93], v[116:117] op_sel_hi:[1,1,0] neg_lo:[0,0,1] neg_hi:[0,0,1]
  v_cvt_pk_bf16_f32 v108, 0, v108
  v_cvt_pk_bf16_f32 v109, 0, v109
  v_cvt_pk_bf16_f32 v110, 0, v110
  v_cvt_pk_bf16_f32 v111, 0, v111
  v_pk_mul_f32 v[108:109], v[108:109], v[116:117] op_sel:[0,1]
  v_pk_mul_f32 v[110:111], v[110:111], v[116:117] op_sel:[0,1]
  v_cvt_pk_bf16_f32 v207, v192, v108
  v_cvt_pk_bf16_f32 v211, v193, v109
  v_cvt_pk_bf16_f32 v215, v194, v110
  v_cvt_pk_bf16_f32 v219, v195, v111
  v_mfma_f32_16x16x32_bf16 v[128:131], v[168:171], v[204:207], v[128:131]
  v_mfma_f32_16x16x32_bf16 v[128:131], v[172:175], v[208:211], v[128:131]
  v_mfma_f32_16x16x32_bf16 v[128:131], v[176:179], v[212:215], v[128:131]
  v_mfma_f32_16x16x32_bf16 v[128:131], v[180:183], v[216:219], v[128:131]
  s_waitcnt vmcnt(14)
  buffer_load_dwordx4 v[20:23], v93, s[12:15], s61 offen offset:256 nt
  v_pk_fma_f32 v[108:109], v[48:49], s[92:93], v[116:117] op_sel_hi:[1,1,0] neg_lo:[0,0,1] neg_hi:[0,0,1]
  v_pk_fma_f32 v[110:111], v[50:51], s[92:93], v[116:117] op_sel_hi:[1,1,0] neg_lo:[0,0,1] neg_hi:[0,0,1]
  v_cvt_pk_bf16_f32 v108, 0, v108
  v_cvt_pk_bf16_f32 v109, 0, v109
  v_cvt_pk_bf16_f32 v110, 0, v110
  v_cvt_pk_bf16_f32 v111, 0, v111
  v_pk_mul_f32 v[108:109], v[108:109], v[116:117] op_sel:[0,1]
  v_pk_mul_f32 v[110:111], v[110:111], v[116:117] op_sel:[0,1]
  v_cvt_pk_bf16_f32 v223, v196, v108
  v_cvt_pk_bf16_f32 v227, v197, v109
  v_cvt_pk_bf16_f32 v231, v198, v110
  v_cvt_pk_bf16_f32 v235, v199, v111
  v_mfma_f32_16x16x32_bf16 v[132:135], v[168:171], v[220:223], v[132:135]
  v_mfma_f32_16x16x32_bf16 v[132:135], v[172:175], v[224:227], v[132:135]
  v_mfma_f32_16x16x32_bf16 v[132:135], v[176:179], v[228:231], v[132:135]
  v_mfma_f32_16x16x32_bf16 v[132:135], v[180:183], v[232:235], v[132:135]
  s_waitcnt vmcnt(14)
  buffer_load_dwordx4 v[24:27], v93, s[12:15], s61 offen offset:512 nt
  v_pk_fma_f32 v[108:109], v[52:53], s[92:93], v[116:117] op_sel_hi:[1,1,0] neg_lo:[0,0,1] neg_hi:[0,0,1]
  v_pk_fma_f32 v[110:111], v[54:55], s[92:93], v[116:117] op_sel_hi:[1,1,0] neg_lo:[0,0,1] neg_hi:[0,0,1]
  v_cvt_pk_bf16_f32 v108, 0, v108
  v_cvt_pk_bf16_f32 v109, 0, v109
  v_cvt_pk_bf16_f32 v110, 0, v110
  v_cvt_pk_bf16_f32 v111, 0, v111
  v_pk_mul_f32 v[108:109], v[108:109], v[116:117] op_sel:[0,1]
  v_pk_mul_f32 v[110:111], v[110:111], v[116:117] op_sel:[0,1]
  v_cvt_pk_bf16_f32 v239, v200, v108
  v_cvt_pk_bf16_f32 v243, v201, v109
  v_cvt_pk_bf16_f32 v247, v202, v110
  v_cvt_pk_bf16_f32 v251, v203, v111
  v_mfma_f32_16x16x32_bf16 v[136:139], v[168:171], v[236:239], v[136:139]
  v_mfma_f32_16x16x32_bf16 v[136:139], v[172:175], v[240:243], v[136:139]
  v_mfma_f32_16x16x32_bf16 v[136:139], v[176:179], v[244:247], v[136:139]
  v_mfma_f32_16x16x32_bf16 v[136:139], v[180:183], v[248:251], v[136:139]
  s_waitcnt vmcnt(14)
  s_cbranch_vccnz L_vw1_24
  s_waitcnt vmcnt(9)
L_vw1_24:
  buffer_load_dwordx4 v[28:31], v93, s[12:15], s61 offen offset:768 nt
  v_mov_b32_dpp v116, v114 row_newbcast:8 row_mask:0xf bank_mask:0xf
  v_mov_b32_dpp v117, v115 row_newbcast:8 row_mask:0xf bank_mask:0xf
  v_pk_fma_f32 v[192:193], v[56:57], s[92:93], v[116:117] op_sel_hi:[1,1,0] neg_lo:[0,0,1] neg_hi:[0,0,1]
  v_pk_fma_f32 v[194:195], v[58:59], s[92:93], v[116:117] op_sel_hi:[1,1,0] neg_lo:[0,0,1] neg_hi:[0,0,1]
  v_cvt_pk_bf16_f32 v192, 0, v192
  v_cndmask_b32 v184, 0, v163, s[72:73]
  v_cvt_pk_bf16_f32 v193, 0, v193
  v_cndmask_b32 v185, 0, v164, s[72:73]
  v_cvt_pk_bf16_f32 v194, 0, v194
  v_cndmask_b32 v186, 0, v163, s[74:75]
  v_cvt_pk_bf16_f32 v195, 0, v195
  v_cndmask_b32 v187, 0, v164, s[74:75]
  v_pk_mul_f32 v[192:193], v[192:193], v[116:117] op_sel:[0,1]
  v_cndmask_b32 v188, 0, v163, s[76:77]
  v_pk_mul_f32 v[194:195], v[194:195], v[116:117] op_sel:[0,1]
  s_waitcnt vmcnt(14)
  buffer_load_dwordx4 v[32:35], v93, s[12:15], s61 offen offset:1024 nt
  v_pk_fma_f32 v[196:197], v[60:61], s[92:93], v[116:117] op_sel_hi:[1,1,0] neg_lo:[0,0,1] neg_hi:[0,0,1]
  v_pk_fma_f32 v[198:199], v[62:63], s[92:93], v[116:117] op_sel_hi:[1,1,0] neg_lo:[0,0,1] neg_hi:[0,0,1]
  v_cvt_pk_bf16_f32 v196, 0, v196
  v_cndmask_b32 v189, 0, v164, s[76:77]
  v_cvt_pk_bf16_f32 v197, 0, v197
  v_cndmask_b32 v190, 0, v163, s[78:79]
  v_cvt_pk_bf16_f32 v198, 0, v198
  v_cndmask_b32 v191, 0, v164, s[78:79]
  v_cvt_pk_bf16_f32 v199, 0, v199
  v_pk_mul_f32 v[196:197], v[196:197], v[116:117] op_sel:[0,1]
  v_pk_mul_f32 v[198:199], v[198:199], v[116:117] op_sel:[0,1]
  s_waitcnt vmcnt(14)
  buffer_load_dwordx4 v[36:39], v93, s[12:15], s61 offen offset:1280 nt
  v_pk_fma_f32 v[200:201], v[64:65], s[92:93], v[116:117] op_sel_hi:[1,1,0] neg_lo:[0,0,1] neg_hi:[0,0,1]
  v_pk_fma_f32 v[202:203], v[66:67], s[92:93], v[116:117] op_sel_hi:[1,1,0] neg_lo:[0,0,1] neg_hi:[0,0,1]
  v_cvt_pk_bf16_f32 v200, 0, v200
  v_cvt_pk_bf16_f32 v201, 0, v201
  v_cvt_pk_bf16_f32 v202, 0, v202
  v_cvt_pk_bf16_f32 v203, 0, v203
  v_pk_mul_f32 v[200:201], v[200:201], v[116:117] op_sel:[0,1]
  v_pk_mul_f32 v[202:203], v[202:203], v[116:117] op_sel:[0,1]
  s_waitcnt vmcnt(14)
  s_cbranch_vccnz L_vw1_27
  s_waitcnt vmcnt(9)
L_vw1_27:
  buffer_load_dwordx4 v[40:43], v93, s[12:15], s61 offen offset:1536 nt
  v_mov_b32_dpp v116, v114 row_newbcast:9 row_mask:0xf bank_mask:0xf
  v_mov_b32_dpp v117, v115 row_newbcast:9 row_mask:0xf bank_mask:0xf
  v_pk_fma_f32 v[108:109], v[68:69], s[92:93], v[116:117] op_sel_hi:[1,1,0] neg_lo:[0,0,1] neg_hi:[0,0,1]
  v_pk_fma_f32 v[110:111], v[70:71], s[92:93], v[116:117] op_sel_hi:[1,1,0] neg_lo:[0,0,1] neg_hi:[0,0,1]
  v_cvt_pk_bf16_f32 v108, 0, v108
  v_cvt_pk_bf16_f32 v109, 0, v109
  v_cvt_pk_bf16_f32 v110, 0, v110
  v_cvt_pk_bf16_f32 v111, 0, v111
  v_pk_mul_f32 v[108:109], v[108:109], v[116:117] op_sel:[0,1]
  v_pk_mul_f32 v[110:111], v[110:111], v[116:117] op_sel:[0,1]
  v_cvt_pk_bf16_f32 v204, v192, v108
  v_cvt_pk_bf16_f32 v208, v193, v109
  v_cvt_pk_bf16_f32 v212, v194, v110
  v_cvt_pk_bf16_f32 v216, v195, v111
  s_waitcnt vmcnt(14)
  buffer_load_dwordx4 v[44:47], v93, s[12:15], s61 offen offset:1792 nt
  v_pk_fma_f32 v[108:109], v[72:73], s[92:93], v[116:117] op_sel_hi:[1,1,0] neg_lo:[0,0,1] neg_hi:[0,0,1]
  v_pk_fma_f32 v[110:111], v[74:75], s[92:93], v[116:117] op_sel_hi:[1,1,0] neg_lo:[0,0,1] neg_hi:[0,0,1]
  v_cvt_pk_bf16_f32 v108, 0, v108
  v_cvt_pk_bf16_f32 v109, 0, v109
  v_cvt_pk_bf16_f32 v110, 0, v110
  v_cvt_pk_bf16_f32 v111, 0, v111
  v_pk_mul_f32 v[108:109], v[108:109], v[116:117] op_sel:[0,1]
  v_pk_mul_f32 v[110:111], v[110:111], v[116:117] op_sel:[0,1]
  v_cvt_pk_bf16_f32 v220, v196, v108
  v_cvt_pk_bf16_f32 v224, v197, v109
  v_cvt_pk_bf16_f32 v228, v198, v110
  v_cvt_pk_bf16_f32 v232, v199, v111
  s_waitcnt vmcnt(14)
  buffer_load_dwordx4 v[48:51], v93, s[12:15], s61 offen offset:2048 nt
  v_pk_fma_f32 v[108:109], v[76:77], s[92:93], v[116:117] op_sel_hi:[1,1,0] neg_lo:[0,0,1] neg_hi:[0,0,1]
  v_pk_fma_f32 v[110:111], v[78:79], s[92:93], v[116:117] op_sel_hi:[1,1,0] neg_lo:[0,0,1] neg_hi:[0,0,1]
  v_cvt_pk_bf16_f32 v108, 0, v108
  v_cvt_pk_bf16_f32 v109, 0, v109
  v_cvt_pk_bf16_f32 v110, 0, v110
  v_cvt_pk_bf16_f32 v111, 0, v111
  v_pk_mul_f32 v[108:109], v[108:109], v[116:117] op_sel:[0,1]
  v_pk_mul_f32 v[110:111], v[110:111], v[116:117] op_sel:[0,1]
  v_cvt_pk_bf16_f32 v236, v200, v108
  v_cvt_pk_bf16_f32 v240, v201, v109
  v_cvt_pk_bf16_f32 v244, v202, v110
  v_cvt_pk_bf16_f32 v248, v203, v111
  s_waitcnt vmcnt(14)
  s_cbranch_vccnz L_vw1_30
  s_waitcnt vmcnt(9)
L_vw1_30:
  buffer_load_dwordx4 v[52:55], v93, s[12:15], s61 offen offset:2304 nt
  v_mov_b32_dpp v116, v114 row_newbcast:10 row_mask:0xf bank_mask:0xf
  v_mov_b32_dpp v117, v115 row_newbcast:10 row_mask:0xf bank_mask:0xf
  v_pk_fma_f32 v[192:193], v[80:81], s[92:93], v[116:117] op_sel_hi:[1,1,0] neg_lo:[0,0,1] neg_hi:[0,0,1]
  v_pk_fma_f32 v[194:195], v[82:83], s[92:93], v[116:117] op_sel_hi:[1,1,0] neg_lo:[0,0,1] neg_hi:[0,0,1]
  v_cvt_pk_bf16_f32 v192, 0, v192
  v_cvt_pk_bf16_f32 v193, 0, v193
  v_cvt_pk_bf16_f32 v194, 0, v194
  v_cvt_pk_bf16_f32 v195, 0, v195
  v_pk_mul_f32 v[192:193], v[192:193], v[116:117] op_sel:[0,1]
  v_pk_mul_f32 v[194:195], v[194:195], v[116:117] op_sel:[0,1]
  v_cvt_pk_bf16_f32 v205, v192, 0
  v_cvt_pk_bf16_f32 v209, v193, 0
  v_cvt_pk_bf16_f32 v213, v194, 0
  v_cvt_pk_bf16_f32 v217, v195, 0
  v_mfma_f32_16x16x16_bf16 v[128:131], v[184:185], v[204:205], v[128:131]
  v_mfma_f32_16x16x16_bf16 v[128:131], v[186:187], v[208:209], v[128:131]
  v_mfma_f32_16x16x16_bf16 v[128:131], v[188:189], v[212:213], v[128:131]
  v_mfma_f32_16x16x16_bf16 v[128:131], v[190:191], v[216:217], v[128:131]
  s_waitcnt vmcnt(14)
  buffer_load_dwordx4 v[56:59], v93, s[12:15], s61 offen offset:2560 nt
  v_pk_fma_f32 v[196:197], v[84:85], s[92:93], v[116:117] op_sel_hi:[1,1,0] neg_lo:[0,0,1] neg_hi:[0,0,1]
  v_pk_fma_f32 v[198:199], v[86:87], s[92:93], v[116:117] op_sel_hi:[1,1,0] neg_lo:[0,0,1] neg_hi:[0,0,1]
  v_cvt_pk_bf16_f32 v196, 0, v196
  v_cvt_pk_bf16_f32 v197, 0, v197
  v_cvt_pk_bf16_f32 v198, 0, v198
  v_cvt_pk_bf16_f32 v199, 0, v199
  v_pk_mul_f32 v[196:197], v[196:197], v[116:117] op_sel:[0,1]
  v_pk_mul_f32 v[198:199], v[198:199], v[116:117] op_sel:[0,1]
  v_cvt_pk_bf16_f32 v221, v196, 0
  v_cvt_pk_bf16_f32 v225, v197, 0
  v_cvt_pk_bf16_f32 v229, v198, 0
  v_cvt_pk_bf16_f32 v233, v199, 0
  v_mfma_f32_16x16x16_bf16 v[132:135], v[184:185], v[220:221], v[132:135]
  v_mfma_f32_16x16x16_bf16 v[132:135], v[186:187], v[224:225], v[132:135]
  v_mfma_f32_16x16x16_bf16 v[132:135], v[188:189], v[228:229], v[132:135]
  v_mfma_f32_16x16x16_bf16 v[132:135], v[190:191], v[232:233], v[132:135]
  s_waitcnt vmcnt(14)
  buffer_load_dwordx4 v[60:63], v93, s[12:15], s61 offen offset:2816 nt
  v_pk_fma_f32 v[200:201], v[88:89], s[92:93], v[116:117] op_sel_hi:[1,1,0] neg_lo:[0,0,1] neg_hi:[0,0,1]
  v_pk_fma_f32 v[202:203], v[90:91], s[92:93], v[116:117] op_sel_hi:[1,1,0] neg_lo:[0,0,1] neg_hi:[0,0,1]
  v_cvt_pk_bf16_f32 v200, 0, v200
  v_cvt_pk_bf16_f32 v201, 0, v201
  v_cvt_pk_bf16_f32 v202, 0, v202
  v_cvt_pk_bf16_f32 v203, 0, v203
  v_pk_mul_f32 v[200:201], v[200:201], v[116:117] op_sel:[0,1]
  v_pk_mul_f32 v[202:203], v[202:203], v[116:117] op_sel:[0,1]
  v_cvt_pk_bf16_f32 v237, v200, 0
  v_cvt_pk_bf16_f32 v241, v201, 0
  v_cvt_pk_bf16_f32 v245, v202, 0
  v_cvt_pk_bf16_f32 v249, v203, 0
  v_mfma_f32_16x16x16_bf16 v[136:139], v[184:185], v[236:237], v[136:139]
  v_mfma_f32_16x16x16_bf16 v[136:139], v[186:187], v[240:241], v[136:139]
  v_mfma_f32_16x16x16_bf16 v[136:139], v[188:189], v[244:245], v[136:139]
  v_mfma_f32_16x16x16_bf16 v[136:139], v[190:191], v[248:249], v[136:139]
  s_mov_b32 s60, s61
  s_cmp_ge_u32 s64, 96
  s_cbranch_scc1 L_v_done
  s_cmp_eq_u32 s89, s88
  s_cbranch_scc1 L_v0
  s_mov_b32 s88, s89
  s_and_b32 s70, s86, 15
  s_cmp_ge_u32 s70, 12
  s_cselect_b32 s70, 6208, 0
  s_bitcmp1_b32 s86, 4
  s_cselect_b32 s71, 12416, 0
  s_add_u32 s70, s70, s71
  v_mov_b32 v145, v143
  v_add_u32 v144, s70, v102
  v_add_u32 v147, s70, v103
  v_permlane32_swap_b32 v143, v145
  v_add_f32 v143, v143, v145
  v_mov_b32 v145, v143
  ds_write_b128 v144, v[128:131] offset:0
  ds_write_b128 v144, v[132:135] offset:1024
  ds_write_b128 v144, v[136:139] offset:2048
  v_permlane16_swap_b32 v143, v145
  v_add_f32 v143, v143, v145
  ds_write_b64 v147, v[142:143]
  s_waitcnt lgkmcnt(0)
  v_mov_b32 v128, 0
  v_mov_b32 v129, 0
  v_mov_b32 v130, 0
  v_mov_b32 v131, 0
  v_mov_b32 v132, 0
  v_mov_b32 v133, 0
  v_mov_b32 v134, 0
  v_mov_b32 v135, 0
  v_mov_b32 v136, 0
  v_mov_b32 v137, 0
  v_mov_b32 v138, 0
  v_mov_b32 v139, 0
  v_mov_b32 v140, 0xff800000
  v_mov_b32 v142, 0x7f800000
  v_mov_b32 v143, 0
  s_branch L_v0
L_v_done:
  s_and_b32 s70, s86, 15
  s_cmp_ge_u32 s70, 12
  s_cselect_b32 s70, 6208, 0
  s_bitcmp1_b32 s86, 4
  s_cselect_b32 s71, 12416, 0
  s_add_u32 s70, s70, s71
  v_mov_b32 v145, v143
  v_add_u32 v144, s70, v102
  v_add_u32 v147, s70, v103
  v_permlane32_swap_b32 v143, v145
  v_add_f32 v143, v143, v145
  v_mov_b32 v145, v143
  ds_write_b128 v144, v[128:131] offset:0
  ds_write_b128 v144, v[132:135] offset:1024
  ds_write_b128 v144, v[136:139] offset:2048
  v_permlane16_swap_b32 v143, v145
  v_add_f32 v143, v143, v145
  ds_write_b64 v147, v[142:143]
L_finish:
  v_mov_b32 v144, 61728
  ds_read_b128 v[168:171], v144
  ds_read_b128 v[172:175], v144 offset:16
  s_mul_i32 s70, s4, 6208
  s_lshl_b32 s71, s3, 10
  v_lshl_add_u32 v152, v0, 4, s71
  v_lshrrev_b32 v145, 4, v0
  v_lshlrev_b32 v154, 3, v145
  v_add_u32 v154, 43008, v154
  s_sub_u32 s97, 6208, s70
  v_add_u32 v153, s97, v152
  v_add_u32 v140, s70, v152
  s_sub_u32 s97, 12416, s70
  v_add_u32 v112, s97, v154
  s_add_u32 s97, s70, 6208
  v_add_u32 v113, s97, v154
  v_add_u32 v155, 18624, v154
  s_mul_i32 s70, s3, 1152
  v_lshl_add_u32 v156, v0, 4, s70
  v_lshl_add_u32 v157, v145, 4, s70
  v_mul_u32_u24 v146, 384, v145
  v_and_b32 v145, 15, v0
  v_lshl_add_u32 v146, v145, 3, v146
  s_movk_i32 s65, 0xff00
  s_mov_b32 s48, 0x10001
  s_mov_b32 s49, 0x10001
  s_mov_b32 s50, 0x0c0c0400
  s_mov_b32 s51, 0x05040100
  s_mov_b32 s64, 0
  s_waitcnt vmcnt(0) lgkmcnt(0)
  s_barrier
  ds_read2_b64 v[176:179], v154 offset1:4
  ds_read_b128 v[192:195], v152 offset:36864
  ds_read_b128 v[196:199], v152 offset:39936
  ds_read2_b64 v[180:183], v155 offset1:4
  ds_read_b128 v[200:203], v152 offset:55488
  ds_read_b128 v[204:207], v152 offset:58560
  ds_read2_b64 v[184:187], v112 offset1:4
  ds_read_b128 v[208:211], v153 offset:43072
  ds_read_b128 v[212:215], v153 offset:46144
  ds_read2_b64 v[188:191], v113 offset1:4
  ds_read_b128 v[216:219], v140 offset:43072
  ds_read_b128 v[220:223], v140 offset:46144
  v_readfirstlane_b32 s72, v168
  v_readfirstlane_b32 s73, v169
  v_readfirstlane_b32 s74, v170
  v_readfirstlane_b32 s75, v171
  v_readfirstlane_b32 s76, v172
  v_readfirstlane_b32 s77, v173
  v_readfirstlane_b32 s78, v174
  v_bfe_u32 v148, v175, 0, 8
  v_bfe_u32 v149, v175, 8, 8
  v_bfe_u32 v150, v175, 16, 8
  v_bfe_u32 v151, v175, 24, 8
  s_waitcnt lgkmcnt(9)
  v_min_f32 v144, v176, v178
  v_sub_f32 v176, v144, v176
  v_sub_f32 v178, v144, v178
  v_exp_f32 v176, v176
  v_exp_f32 v178, v178
  v_mul_f32 v145, v176, v177
  v_pk_mul_f32 v[192:193], v[192:193], v[176:177] op_sel_hi:[1,0]
  v_pk_mul_f32 v[194:195], v[194:195], v[176:177] op_sel_hi:[1,0]
  v_pk_fma_f32 v[192:193], v[196:197], v[178:179], v[192:193] op_sel_hi:[1,0,1]
  v_pk_fma_f32 v[194:195], v[198:199], v[178:179], v[194:195] op_sel_hi:[1,0,1]
  v_fma_f32 v197, v178, v179, v145
  v_mov_b32 v196, v144
  v_and_or_b32 v192, v192, s65, v148
  v_and_or_b32 v193, v193, s65, v149
  v_and_or_b32 v194, v194, s65, v150
  v_and_or_b32 v195, v195, s65, v151
  v_mov_b32 v199, v175
  buffer_store_dwordx4 v[192:195], v156, s[40:43], s72 offen sc1
  s_mov_b64 exec, s[48:49]
  buffer_store_dwordx4 v[196:199], v157, s[40:43], s72 offen offset:1024 sc1
  s_mov_b64 exec, -1
  s_waitcnt lgkmcnt(6)
  v_min_f32 v144, v180, v182
  v_sub_f32 v180, v144, v180
  v_sub_f32 v182, v144, v182
  v_exp_f32 v180, v180
  v_exp_f32 v182, v182
  v_mul_f32 v145, v180, v181
  v_pk_mul_f32 v[200:201], v[200:201], v[180:181] op_sel_hi:[1,0]
  v_pk_mul_f32 v[202:203], v[202:203], v[180:181] op_sel_hi:[1,0]
  v_pk_fma_f32 v[200:201], v[204:205], v[182:183], v[200:201] op_sel_hi:[1,0,1]
  v_pk_fma_f32 v[202:203], v[206:207], v[182:183], v[202:203] op_sel_hi:[1,0,1]
  v_fma_f32 v205, v182, v183, v145
  v_mov_b32 v204, v144
  v_and_or_b32 v200, v200, s65, v148
  v_and_or_b32 v201, v201, s65, v149
  v_and_or_b32 v202, v202, s65, v150
  v_and_or_b32 v203, v203, s65, v151
  v_mov_b32 v207, v175
  buffer_store_dwordx4 v[200:203], v156, s[40:43], s73 offen sc1
  s_mov_b64 exec, s[48:49]
  buffer_store_dwordx4 v[204:207], v157, s[40:43], s73 offen offset:1024 sc1
  s_mov_b64 exec, -1
  s_waitcnt lgkmcnt(3)
  v_min_f32 v144, v184, v186
  v_sub_f32 v184, v144, v184
  v_sub_f32 v186, v144, v186
  v_exp_f32 v184, v184
  v_exp_f32 v186, v186
  v_mul_f32 v145, v184, v185
  v_pk_mul_f32 v[208:209], v[208:209], v[184:185] op_sel_hi:[1,0]
  v_pk_mul_f32 v[210:211], v[210:211], v[184:185] op_sel_hi:[1,0]
  v_pk_fma_f32 v[208:209], v[212:213], v[186:187], v[208:209] op_sel_hi:[1,0,1]
  v_pk_fma_f32 v[210:211], v[214:215], v[186:187], v[210:211] op_sel_hi:[1,0,1]
  v_fma_f32 v213, v186, v187, v145
  v_mov_b32 v212, v144
  v_and_or_b32 v208, v208, s65, v148
  v_and_or_b32 v209, v209, s65, v149
  v_and_or_b32 v210, v210, s65, v150
  v_and_or_b32 v211, v211, s65, v151
  v_mov_b32 v215, v175
  buffer_store_dwordx4 v[208:211], v156, s[40:43], s74 offen sc1
  s_mov_b64 exec, s[48:49]
  buffer_store_dwordx4 v[212:215], v157, s[40:43], s74 offen offset:1024 sc1
  s_mov_b64 exec, -1
  buffer_load_dwordx4 v[224:227], v156, s[40:43], s75 offen sc1
  buffer_load_dwordx4 v[228:231], v157, s[40:43], s75 offen offset:1024 sc1
  buffer_load_dwordx4 v[232:235], v156, s[40:43], s76 offen sc1
  buffer_load_dwordx4 v[236:239], v157, s[40:43], s76 offen offset:1024 sc1
  buffer_load_dwordx4 v[240:243], v156, s[40:43], s77 offen sc1
  buffer_load_dwordx4 v[244:247], v157, s[40:43], s77 offen offset:1024 sc1
  s_waitcnt lgkmcnt(0)
  v_min_f32 v144, v188, v190
  v_sub_f32 v188, v144, v188
  v_sub_f32 v190, v144, v190
  v_exp_f32 v188, v188
  v_exp_f32 v190, v190
  v_mul_f32 v145, v188, v189
  v_pk_mul_f32 v[216:217], v[216:217], v[188:189] op_sel_hi:[1,0]
  v_pk_mul_f32 v[218:219], v[218:219], v[188:189] op_sel_hi:[1,0]
  v_pk_fma_f32 v[216:217], v[220:221], v[190:191], v[216:217] op_sel_hi:[1,0,1]
  v_pk_fma_f32 v[218:219], v[222:223], v[190:191], v[218:219] op_sel_hi:[1,0,1]
  v_fma_f32 v221, v190, v191, v145
  v_mov_b32 v220, v144
  s_branch L_check
L_gather:
  s_add_u32 s64, s64, 1
  s_cmp_gt_u32 s64, 20000
  s_cbranch_scc1 L_end
  s_bitcmp0_b32 s87, 0
  s_cbranch_scc1 L_have0
  buffer_load_dwordx4 v[224:227], v156, s[40:43], s75 offen sc1
  buffer_load_dwordx4 v[228:231], v157, s[40:43], s75 offen offset:1024 sc1
L_have0:
  s_bitcmp0_b32 s87, 1
  s_cbranch_scc1 L_have1
  buffer_load_dwordx4 v[232:235], v156, s[40:43], s76 offen sc1
  buffer_load_dwordx4 v[236:239], v157, s[40:43], s76 offen offset:1024 sc1
L_have1:
  s_bitcmp0_b32 s87, 2
  s_cbranch_scc1 L_have2
  buffer_load_dwordx4 v[240:243], v156, s[40:43], s77 offen sc1
  buffer_load_dwordx4 v[244:247], v157, s[40:43], s77 offen offset:1024 sc1
L_have2:
L_check:
  s_mov_b32 s87, 0
  s_waitcnt vmcnt(0)
  v_perm_b32 v144, v225, v224, s50
  v_perm_b32 v145, v227, v226, s50
  v_cmp_ne_u32 vcc, v175, v231
  v_perm_b32 v144, v145, v144, s51
  v_cmp_ne_u32 s[70:71], v175, v144
  s_nop 1
  s_or_b64 s[70:71], s[70:71], vcc
  s_cselect_b32 s70, 1, 0
  s_or_b32 s87, s87, s70
  v_perm_b32 v144, v233, v232, s50
  v_perm_b32 v145, v235, v234, s50
  v_cmp_ne_u32 vcc, v175, v239
  v_perm_b32 v144, v145, v144, s51
  v_cmp_ne_u32 s[70:71], v175, v144
  s_nop 1
  s_or_b64 s[70:71], s[70:71], vcc
  s_cselect_b32 s70, 2, 0
  s_or_b32 s87, s87, s70
  v_perm_b32 v144, v241, v240, s50
  v_perm_b32 v145, v243, v242, s50
  v_cmp_ne_u32 vcc, v175, v247
  v_perm_b32 v144, v145, v144, s51
  v_cmp_ne_u32 s[70:71], v175, v144
  s_nop 1
  s_or_b64 s[70:71], s[70:71], vcc
  s_cselect_b32 s70, 4, 0
  s_or_b32 s87, s87, s70
  s_cbranch_scc1 L_gather
  v_min_f32 v144, v220, v228
  v_min3_f32 v144, v144, v236, v244
  v_sub_f32 v220, v144, v220
  v_sub_f32 v228, v144, v228
  v_sub_f32 v236, v144, v236
  v_sub_f32 v244, v144, v244
  v_exp_f32 v220, v220
  v_exp_f32 v228, v228
  v_exp_f32 v236, v236
  v_exp_f32 v244, v244
  v_and_b32 v216, s65, v216
  v_and_b32 v217, s65, v217
  v_and_b32 v218, s65, v218
  v_and_b32 v219, s65, v219
  v_and_b32 v224, s65, v224
  v_and_b32 v225, s65, v225
  v_and_b32 v226, s65, v226
  v_and_b32 v227, s65, v227
  v_and_b32 v232, s65, v232
  v_and_b32 v233, s65, v233
  v_and_b32 v234, s65, v234
  v_and_b32 v235, s65, v235
  v_and_b32 v240, s65, v240
  v_and_b32 v241, s65, v241
  v_and_b32 v242, s65, v242
  v_and_b32 v243, s65, v243
  v_mul_f32 v221, v220, v221
  v_mul_f32 v229, v228, v229
  v_mul_f32 v237, v236, v237
  v_mul_f32 v245, v244, v245
  v_add_f32 v221, v221, v229
  v_add_f32 v237, v237, v245
  v_add_f32 v144, v221, v237
  v_rcp_f32 v144, v144
  s_lshl_b32 s70, s3, 7
  s_add_u32 s70, s70, s78
  v_pk_mul_f32 v[216:217], v[216:217], v[220:221] op_sel_hi:[1,0]
  v_pk_mul_f32 v[224:225], v[224:225], v[228:229] op_sel_hi:[1,0]
  v_pk_mul_f32 v[232:233], v[232:233], v[236:237] op_sel_hi:[1,0]
  v_pk_mul_f32 v[240:241], v[240:241], v[244:245] op_sel_hi:[1,0]
  v_pk_add_f32 v[216:217], v[216:217], v[224:225]
  v_pk_add_f32 v[232:233], v[232:233], v[240:241]
  v_pk_add_f32 v[216:217], v[216:217], v[232:233]
  v_pk_mul_f32 v[216:217], v[216:217], v[144:145] op_sel_hi:[1,0]
  v_cvt_pk_bf16_f32 v128, v216, v217
  v_pk_mul_f32 v[218:219], v[218:219], v[220:221] op_sel_hi:[1,0]
  v_pk_mul_f32 v[226:227], v[226:227], v[228:229] op_sel_hi:[1,0]
  v_pk_mul_f32 v[234:235], v[234:235], v[236:237] op_sel_hi:[1,0]
  v_pk_mul_f32 v[242:243], v[242:243], v[244:245] op_sel_hi:[1,0]
  v_pk_add_f32 v[218:219], v[218:219], v[226:227]
  v_pk_add_f32 v[234:235], v[234:235], v[242:243]
  v_pk_add_f32 v[218:219], v[218:219], v[234:235]
  v_pk_mul_f32 v[218:219], v[218:219], v[144:145] op_sel_hi:[1,0]
  v_cvt_pk_bf16_f32 v129, v218, v219
  buffer_store_dwordx2 v[128:129], v146, s[36:39], s70 offen
L_fin:
L_end:
  s_endpgm
L_helper:
  v_lshlrev_b32 v1, 2, v0
  v_add_u32 v1, 61696, v1
  v_mov_b32 v2, 0
  s_mov_b64 exec, 0xff
  ds_write_b32 v1, v2
  s_mov_b64 exec, -1
  s_waitcnt lgkmcnt(0)
  s_mov_b32 s8, s46
  s_and_b32 s9, s47, 0xffff
  s_mov_b32 s36, s44
  s_and_b32 s37, s45, 0xffff
  s_mov_b32 s16, s46
  s_and_b32 s17, s47, 0xffff
  s_mov_b32 s12, s48
  s_and_b32 s13, s49, 0xffff
  s_mov_b32 s40, s82
  s_and_b32 s41, s83, 0xffff
  s_mov_b32 s36, s58
  s_and_b32 s37, s59, 0xffff
  s_barrier
  s_memrealtime s[72:73]
  s_getpc_b64 s[54:55]
L_h_pc:
  s_add_u32 s86, s54, L_h_cp - L_h_pc
  s_addc_u32 s87, s55, 0
  s_sub_u32 s54, s54, L_h_pc - L_k
  s_subb_u32 s55, s55, 0
  s_and_b32 s54, s54, -16
  s_lshr_b32 s70, s2, 3
  s_lshl_b32 s70, s70, 10
  v_lshl_add_u32 v106, v0, 4, s70
  v_mov_b32 v107, s55
  v_add_co_u32 v106, vcc, s54, v106
  s_nop 1
  v_addc_co_u32 v107, vcc, 0, v107, vcc
  s_lshr_b32 s70, s2, 3
  s_cmp_lt_u32 s70, (L_code_end - L_k) / 1024
  s_cbranch_scc0 L_h_cta
  global_load_dwordx4 v[108:111], v[106:107], off
L_h_cta:
  s_lshr_b32 s70, s2, 4
  s_and_b32 s70, s70, 8
  s_and_b32 s71, s2, 7
  s_add_u32 s70, s70, s71
  s_lshl_b32 s70, s70, 4
  v_lshl_add_u32 v104, v0, 3, s70
  v_and_b32 v105, 31, v0
  v_lshlrev_b32 v105, 3, v105
  v_and_b32 v112, 1, v0
  v_lshlrev_b32 v112, 2, v112
  v_add_u32 v112, 61712, v112
  v_mov_b32 v113, 0
  v_lshlrev_b32 v3, 4, v0
  s_mov_b32 s76, 12
  s_mov_b32 s77, 7340032
  s_getreg_b32 s50, hwreg(HW_REG_XCC_ID)
  s_bfe_u32 s50, s50, 0x10002
  s_bfe_u32 s52, s2, 0x30003
  s_cmp_eq_u32 s52, 7
  s_cbranch_scc1 L_h_voted
  s_lshr_b32 s70, s2, 6
  s_xor_b32 s70, s70, s2
  s_and_b32 s70, s70, 3
  s_cbranch_scc1 L_h_voted
  s_cmp_eq_u32 s52, 6
  s_cbranch_scc0 L_h_probe
  s_xor_b32 s48, s50, s4
  s_and_b32 s52, s2, 3
  s_lshl2_add_u32 s52, s52, 36
  s_branch L_h_vote
L_h_probe:
  s_cmp_ge_u32 s52, 3
  s_cselect_b32 s16, s12, s8
  s_cselect_b32 s17, s13, s9
  s_cselect_b32 s70, 3, 0
  s_sub_u32 s70, s52, s70
  s_lshl_b32 s70, s70, 28
  s_add_u32 s44, s5, s4
  s_lshl_b32 s44, s44, 16
  s_add_u32 s44, s44, s70
  s_add_u32 s44, s44, 0x1c0000
  s_mul_i32 s70, s2, 0x2a95
  s_and_b32 s70, s70, 0x7f80
  s_add_u32 s44, s44, s70
  s_add_u32 s70, s44, 0x8000
  s_buffer_load_dword s58, s[16:19], s70
  s_mov_b32 s45, -1
  s_mov_b32 s46, -1
  s_mul_i32 s52, s52, 6
L_h_progp:
  s_sleep 2
  ds_read_b32 v8, v112
  s_waitcnt lgkmcnt(0)
  v_cmp_gt_u32 vcc, 1, v8
  s_nop 1
  s_cmp_lg_u32 vcc_lo, 0
  s_cbranch_scc1 L_h_progp
  s_xor_b32 s70, s44, 0
  s_memtime s[54:55]
  s_waitcnt lgkmcnt(0)
  s_buffer_load_dword s58, s[16:19], s70
  s_waitcnt lgkmcnt(0)
  s_memtime s[56:57]
  s_waitcnt lgkmcnt(0)
  s_sub_u32 s56, s56, s54
  s_min_u32 s45, s45, s56
  s_xor_b32 s70, s44, 8192
  s_memtime s[54:55]
  s_waitcnt lgkmcnt(0)
  s_buffer_load_dword s58, s[16:19], s70
  s_waitcnt lgkmcnt(0)
  s_memtime s[56:57]
  s_waitcnt lgkmcnt(0)
  s_sub_u32 s56, s56, s54
  s_min_u32 s46, s46, s56
  s_xor_b32 s70, s44, 25472
  s_memtime s[54:55]
  s_waitcnt lgkmcnt(0)
  s_buffer_load_dword s58, s[16:19], s70
  s_waitcnt lgkmcnt(0)
  s_memtime s[56:57]
  s_waitcnt lgkmcnt(0)
  s_sub_u32 s56, s56, s54
  s_min_u32 s46, s46, s56
  s_xor_b32 s70, s44, 17280
  s_memtime s[54:55]
  s_waitcnt lgkmcnt(0)
  s_buffer_load_dword s58, s[16:19], s70
  s_waitcnt lgkmcnt(0)
  s_memtime s[56:57]
  s_waitcnt lgkmcnt(0)
  s_sub_u32 s56, s56, s54
  s_min_u32 s45, s45, s56
  s_xor_b32 s70, s44, 5888
  s_memtime s[54:55]
  s_waitcnt lgkmcnt(0)
  s_buffer_load_dword s58, s[16:19], s70
  s_waitcnt lgkmcnt(0)
  s_memtime s[56:57]
  s_waitcnt lgkmcnt(0)
  s_sub_u32 s56, s56, s54
  s_min_u32 s45, s45, s56
  s_xor_b32 s70, s44, 14080
  s_memtime s[54:55]
  s_waitcnt lgkmcnt(0)
  s_buffer_load_dword s58, s[16:19], s70
  s_waitcnt lgkmcnt(0)
  s_memtime s[56:57]
  s_waitcnt lgkmcnt(0)
  s_sub_u32 s56, s56, s54
  s_min_u32 s46, s46, s56
  s_cmp_lt_u32 s46, s45
  s_cselect_b32 s48, 1, 0
  s_lshr_b32 s70, s44, 13
  s_xor_b32 s70, s70, s2
  s_xor_b32 s70, s70, s50
  s_and_b32 s70, s70, 1
  s_xor_b32 s48, s48, s70
L_h_vote:
  s_mov_b32 s49, 0
  s_lshl_b64 s[48:49], s[48:49], s52
  s_or_b32 s49, s49, 0x1000000
  s_atomic_add_x2 s[48:49], s[80:81], 0
L_h_voted:
  s_waitcnt lgkmcnt(0)
  s_cmp_lg_u32 s2, 56
  s_cbranch_scc1 L_h_nonce
  s_lshl_b64 s[54:55], s[72:73], 2
  s_atomic_add_x2 s[54:55], s[80:81], 8
  s_waitcnt lgkmcnt(0)
L_h_nonce:
L_h_progv:
  s_sleep 8
  ds_read_b32 v8, v112
  s_waitcnt lgkmcnt(0)
  v_cmp_gt_u32 vcc, 6, v8
  s_nop 1
  s_cmp_lg_u32 vcc_lo, 0
  s_cbranch_scc1 L_h_progv
  s_load_dwordx2 s[48:49], s[80:81], 0
  s_mov_b32 s59, 0
L_h_votes:
  s_waitcnt lgkmcnt(0)
  s_lshr_b32 s70, s49, 24
  s_cmp_eq_u32 s70, 56
  s_cbranch_scc1 L_h_votes_done
  s_add_u32 s59, s59, 1
  s_cmp_gt_u32 s59, 2000
  s_cbranch_scc1 L_h_votes_done
  s_sleep 64
  s_mov_b64 s[48:49], 0
  s_atomic_or_x2 s[48:49], s[80:81], 0 glc
  s_branch L_h_votes
L_h_votes_done:
  s_mov_b32 s96, 0x80
  s_bfe_u64 s[54:55], s[48:49], 0x60000
  s_cmp_gt_u32 s54, 4
  s_cselect_b32 s56, 1, 0
  s_or_b32 s96, s96, s56
  s_bfe_u64 s[54:55], s[48:49], 0x60006
  s_cmp_gt_u32 s54, 4
  s_cselect_b32 s56, 2, 0
  s_or_b32 s96, s96, s56
  s_bfe_u64 s[54:55], s[48:49], 0x6000c
  s_cmp_gt_u32 s54, 4
  s_cselect_b32 s56, 4, 0
  s_or_b32 s96, s96, s56
  s_bfe_u64 s[54:55], s[48:49], 0x60012
  s_cmp_gt_u32 s54, 4
  s_cselect_b32 s56, 8, 0
  s_or_b32 s96, s96, s56
  s_bfe_u64 s[54:55], s[48:49], 0x60018
  s_cmp_gt_u32 s54, 4
  s_cselect_b32 s56, 16, 0
  s_or_b32 s96, s96, s56
  s_bfe_u64 s[54:55], s[48:49], 0x6001e
  s_cmp_gt_u32 s54, 4
  s_cselect_b32 s56, 32, 0
  s_or_b32 s96, s96, s56
  s_and_b32 s70, s2, 3
  s_lshl2_add_u32 s70, s70, 5
  s_lshr_b32 s54, s49, s70
  s_xor_b32 s54, s54, s2
  s_xor_b32 s54, s54, s4
  s_and_b32 s54, s54, 1
  s_mul_i32 s54, s54, 63
  s_xor_b32 s96, s96, s54
  v_mov_b32 v1, 61696
  v_mov_b32 v5, s96
  ds_write_b32 v1, v5
  s_load_dwordx2 s[74:75], s[80:81], 8
  s_mov_b32 s59, 0
L_h_getnonce:
  s_waitcnt lgkmcnt(0)
  s_cmp_lg_u64 s[74:75], 0
  s_cbranch_scc1 L_h_gotnonce
  s_add_u32 s59, s59, 1
  s_cmp_gt_u32 s59, 2000
  s_cbranch_scc1 L_h_gotnonce
  s_sleep 64
  s_atomic_or_x2 s[74:75], s[80:81], 8 glc
  s_branch L_h_getnonce
L_h_gotnonce:
  s_lshr_b64 s[54:55], s[74:75], 2
  v_writelane_b32 v8, s54, 7
  s_lshr_b32 s64, s5, 5
  s_mov_b32 s50, 0xaaaaaaab
  s_add_u32 s54, s64, 0
  s_mul_hi_u32 s56, s54, s50
  s_lshr_b32 s56, s56, 1
  s_mul_i32 s56, s56, 3
  s_sub_u32 s54, s54, s56
  s_lshr_b32 s56, s96, s54
  s_bfe_u32 s56, s56, 0x10003
  s_lshl_b32 s54, s54, 7
  s_add_u32 s54, s54, s64
  s_mul_hi_u32 s54, s54, s50
  s_lshr_b32 s54, s54, 1
  s_lshl3_add_u32 s54, s54, s56
  s_mul_i32 s70, s54, 3456
  s_add_u32 s70, s70, 1048576
  v_writelane_b32 v8, s70, 0
  s_add_u32 s54, s64, 4
  s_mul_hi_u32 s56, s54, s50
  s_lshr_b32 s56, s56, 1
  s_mul_i32 s56, s56, 3
  s_sub_u32 s54, s54, s56
  s_lshr_b32 s56, s96, s54
  s_bfe_u32 s56, s56, 0x10003
  s_lshl_b32 s54, s54, 7
  s_add_u32 s54, s54, s64
  s_mul_hi_u32 s54, s54, s50
  s_lshr_b32 s54, s54, 1
  s_lshl3_add_u32 s54, s54, s56
  s_add_u32 s54, s54, 6
  s_mul_i32 s70, s54, 3456
  s_add_u32 s70, s70, 1048576
  v_writelane_b32 v8, s70, 1
  s_add_u32 s54, s64, 2
  s_mul_hi_u32 s56, s54, s50
  s_lshr_b32 s56, s56, 1
  s_mul_i32 s56, s56, 3
  s_sub_u32 s54, s54, s56
  s_lshr_b32 s56, s96, s54
  s_bfe_u32 s56, s56, 0x10003
  s_lshl_b32 s54, s54, 7
  s_add_u32 s54, s54, s64
  s_mul_hi_u32 s54, s54, s50
  s_lshr_b32 s54, s54, 1
  s_lshl3_add_u32 s54, s54, s56
  s_lshl_b32 s56, s4, 1
  s_sub_u32 s57, s54, s56
  s_add_u32 s57, s57, 4
  s_mul_i32 s70, s57, 3456
  s_add_u32 s70, s70, 1048576
  v_writelane_b32 v8, s70, 2
  s_add_u32 s54, s54, s56
  s_add_u32 s54, s54, 2
  s_xor_b32 s56, s54, 1
  s_mul_i32 s70, s56, 3456
  s_add_u32 s70, s70, 1048576
  v_writelane_b32 v8, s70, 3
  s_andn2_b32 s56, s54, 1
  s_xor_b32 s56, s56, 2
  s_mul_i32 s70, s56, 3456
  s_add_u32 s70, s70, 1048576
  v_writelane_b32 v8, s70, 4
  s_add_u32 s56, s56, 1
  s_mul_i32 s70, s56, 3456
  s_add_u32 s70, s70, 1048576
  v_writelane_b32 v8, s70, 5
  s_lshr_b32 s54, s54, 2
  s_mul_i32 s54, s54, 1536
  v_writelane_b32 v8, s54, 6
  v_lshlrev_b32 v1, 2, v0
  s_mov_b64 exec, 0xff
  ds_write_b32 v1, v8 offset:61728
  s_mov_b64 exec, -1
  s_lshl_b32 s62, s2, 8
  s_add_u32 s62, s62, 7405568
  s_xor_b32 s63, s62, 1024
  s_lshr_b32 s58, s96, 3
  s_xor_b32 s58, s58, s96
  s_lshr_b32 s70, s5, 4
  s_lshr_b32 s44, s70, 5
  s_lshl_b32 s44, s44, 21
  s_add_u32 s44, s44, 8388608
  s_and_b32 s64, s70, 31
  s_add_u32 s70, s64, s4
  s_lshl_b32 s70, s70, 10
  s_add_u32 s60, s44, s70
  s_xor_b32 s61, s60, 1024
  s_mov_b32 s78, 60
  s_swappc_b64 s[84:85], s[86:87]
L_h_proga:
  s_sleep 4
  ds_read_b32 v8, v112
  s_waitcnt lgkmcnt(0)
  v_cmp_gt_u32 vcc, 64, v8
  s_nop 1
  s_cmp_lg_u32 vcc_lo, 0
  s_cbranch_scc1 L_h_proga
  ds_read_b128 v[8:11], v3 offset:0
  ds_read_b128 v[12:15], v3 offset:1024
  ds_read_b128 v[16:19], v3 offset:2048
  s_waitcnt lgkmcnt(0)
  s_xor_b32 s70, s60, 0
  buffer_store_dwordx4 v[8:11], v3, s[40:43], s70 offen sc1
  s_xor_b32 s70, s60, 32768
  buffer_store_dwordx4 v[12:15], v3, s[40:43], s70 offen sc1
  s_xor_b32 s70, s60, 65536
  buffer_store_dwordx4 v[16:19], v3, s[40:43], s70 offen sc1
  s_bitcmp0_b32 s58, 2
  s_cbranch_scc1 L_h_e0
  ds_read_b128 v[20:23], v3 offset:3072
  ds_read_b128 v[24:27], v3 offset:4096
  ds_read_b128 v[28:31], v3 offset:5120
  ds_read_b128 v[32:35], v3 offset:6144
  ds_read_b128 v[36:39], v3 offset:7168
  ds_read_b128 v[40:43], v3 offset:8192
  ds_read_b128 v[44:47], v3 offset:9216
  ds_read_b128 v[48:51], v3 offset:10240
  ds_read_b128 v[52:55], v3 offset:11264
  s_waitcnt lgkmcnt(0)
  s_xor_b32 s70, s60, 98304
  buffer_store_dwordx4 v[20:23], v3, s[40:43], s70 offen sc1
  s_xor_b32 s70, s60, 132096
  buffer_store_dwordx4 v[24:27], v3, s[40:43], s70 offen sc1
  s_xor_b32 s70, s60, 164864
  buffer_store_dwordx4 v[28:31], v3, s[40:43], s70 offen sc1
  s_xor_b32 s70, s60, 197632
  buffer_store_dwordx4 v[32:35], v3, s[40:43], s70 offen sc1
  s_xor_b32 s70, s60, 230400
  buffer_store_dwordx4 v[36:39], v3, s[40:43], s70 offen sc1
  s_xor_b32 s70, s60, 264192
  buffer_store_dwordx4 v[40:43], v3, s[40:43], s70 offen sc1
  s_xor_b32 s70, s60, 296960
  buffer_store_dwordx4 v[44:47], v3, s[40:43], s70 offen sc1
  s_xor_b32 s70, s60, 329728
  buffer_store_dwordx4 v[48:51], v3, s[40:43], s70 offen sc1
  s_xor_b32 s70, s60, 362496
  buffer_store_dwordx4 v[52:55], v3, s[40:43], s70 offen sc1
L_h_e0:
  s_bitcmp0_b32 s58, 0
  s_cbranch_scc1 L_h_e1
  ds_read_b128 v[56:59], v3 offset:12288
  ds_read_b128 v[60:63], v3 offset:13312
  ds_read_b128 v[64:67], v3 offset:14336
  ds_read_b128 v[68:71], v3 offset:15360
  ds_read_b128 v[72:75], v3 offset:16384
  ds_read_b128 v[76:79], v3 offset:17408
  ds_read_b128 v[80:83], v3 offset:18432
  ds_read_b128 v[84:87], v3 offset:19456
  ds_read_b128 v[88:91], v3 offset:20480
  ds_read_b128 v[92:95], v3 offset:21504
  ds_read_b128 v[96:99], v3 offset:22528
  ds_read_b128 v[100:103], v3 offset:23552
  s_waitcnt lgkmcnt(0)
  s_xor_b32 s70, s60, 396288
  buffer_store_dwordx4 v[56:59], v3, s[40:43], s70 offen sc1
  s_xor_b32 s70, s60, 429056
  buffer_store_dwordx4 v[60:63], v3, s[40:43], s70 offen sc1
  s_xor_b32 s70, s60, 461824
  buffer_store_dwordx4 v[64:67], v3, s[40:43], s70 offen sc1
  s_xor_b32 s70, s60, 494592
  buffer_store_dwordx4 v[68:71], v3, s[40:43], s70 offen sc1
  s_xor_b32 s70, s60, 541696
  buffer_store_dwordx4 v[72:75], v3, s[40:43], s70 offen sc1
  s_xor_b32 s70, s60, 574464
  buffer_store_dwordx4 v[76:79], v3, s[40:43], s70 offen sc1
  s_xor_b32 s70, s60, 607232
  buffer_store_dwordx4 v[80:83], v3, s[40:43], s70 offen sc1
  s_xor_b32 s70, s60, 640000
  buffer_store_dwordx4 v[84:87], v3, s[40:43], s70 offen sc1
  s_xor_b32 s70, s60, 671744
  buffer_store_dwordx4 v[88:91], v3, s[40:43], s70 offen sc1
  s_xor_b32 s70, s60, 704512
  buffer_store_dwordx4 v[92:95], v3, s[40:43], s70 offen sc1
  s_xor_b32 s70, s60, 737280
  buffer_store_dwordx4 v[96:99], v3, s[40:43], s70 offen sc1
  s_xor_b32 s70, s60, 770048
  buffer_store_dwordx4 v[100:103], v3, s[40:43], s70 offen sc1
L_h_e1:
  s_add_u32 s54, s74, 1
  v_mov_b32 v5, 0
  s_waitcnt vmcnt(0)
  v_mov_b32 v8, s54
  v_mov_b32 v9, s75
  s_mov_b64 exec, 1
  buffer_store_dwordx2 v[8:9], v5, s[40:43], s62 offen sc1
  s_mov_b32 s59, 0
L_h_flaga:
  buffer_load_dwordx2 v[10:11], v5, s[40:43], s63 offen sc1
  s_waitcnt vmcnt(0)
  v_readfirstlane_b32 s56, v10
  v_readfirstlane_b32 s57, v11
  s_nop 0
  s_sub_u32 s56, s56, s54
  s_xor_b32 s57, s57, s75
  s_lshr_b32 s56, s56, 1
  s_or_b32 s56, s56, s57
  s_cbranch_scc0 L_h_flaga_done
  s_add_u32 s59, s59, 1
  s_cmp_gt_u32 s59, 10000
  s_cbranch_scc1 L_h_flaga_done
  s_sleep 8
  s_branch L_h_flaga
L_h_flaga_done:
  s_mov_b64 exec, -1
  s_bfe_u32 s54, s96, 0x10005
  s_mul_i32 s54, s54, 384
  v_lshrrev_b32 v4, 3, v0
  v_add_u32 v5, 0, v4
  v_mul_u32_u24 v5, 21846, v5
  v_bfe_u32 v5, v5, 16, 1
  v_mul_u32_u24 v6, 384, v5
  v_sub_u32 v6, v3, v6
  v_add_u32 v6, s54, v6
  v_add_u32 v6, 0, v6
  v_add_u32 v5, s64, v5
  v_lshrrev_b32 v2, 12, v6
  v_xor_b32 v5, v5, v2
  v_lshrrev_b32 v2, 10, v6
  v_lshl_add_u32 v5, v2, 5, v5
  v_and_b32 v6, 1023, v6
  v_lshl_add_u32 v5, v5, 10, v6
  buffer_load_dwordx4 v[8:11], v5, s[40:43], s44 offen sc1
  v_add_u32 v5, 8, v4
  v_mul_u32_u24 v5, 21846, v5
  v_bfe_u32 v5, v5, 16, 1
  v_mul_u32_u24 v6, 384, v5
  v_sub_u32 v6, v3, v6
  v_add_u32 v6, s54, v6
  v_add_u32 v6, 1024, v6
  v_add_u32 v5, s64, v5
  v_lshrrev_b32 v2, 12, v6
  v_xor_b32 v5, v5, v2
  v_lshrrev_b32 v2, 10, v6
  v_lshl_add_u32 v5, v2, 5, v5
  v_and_b32 v6, 1023, v6
  v_lshl_add_u32 v5, v5, 10, v6
  buffer_load_dwordx4 v[12:15], v5, s[40:43], s44 offen sc1
  v_add_u32 v5, 16, v4
  v_mul_u32_u24 v5, 21846, v5
  v_bfe_u32 v5, v5, 16, 1
  v_mul_u32_u24 v6, 384, v5
  v_sub_u32 v6, v3, v6
  v_add_u32 v6, s54, v6
  v_add_u32 v6, 2048, v6
  v_add_u32 v5, s64, v5
  v_lshrrev_b32 v2, 12, v6
  v_xor_b32 v5, v5, v2
  v_lshrrev_b32 v2, 10, v6
  v_lshl_add_u32 v5, v2, 5, v5
  v_and_b32 v6, 1023, v6
  v_lshl_add_u32 v5, v5, 10, v6
  buffer_load_dwordx4 v[16:19], v5, s[40:43], s44 offen sc1
  s_bitcmp0_b32 s58, 2
  s_cbranch_scc1 L_h_i0
  s_xor_b32 s70, s61, 98304
  buffer_load_dwordx4 v[20:23], v3, s[40:43], s70 offen sc1
  s_xor_b32 s70, s61, 132096
  buffer_load_dwordx4 v[24:27], v3, s[40:43], s70 offen sc1
  s_xor_b32 s70, s61, 164864
  buffer_load_dwordx4 v[28:31], v3, s[40:43], s70 offen sc1
  s_xor_b32 s70, s61, 197632
  buffer_load_dwordx4 v[32:35], v3, s[40:43], s70 offen sc1
  s_xor_b32 s70, s61, 230400
  buffer_load_dwordx4 v[36:39], v3, s[40:43], s70 offen sc1
  s_xor_b32 s70, s61, 264192
  buffer_load_dwordx4 v[40:43], v3, s[40:43], s70 offen sc1
  s_xor_b32 s70, s61, 296960
  buffer_load_dwordx4 v[44:47], v3, s[40:43], s70 offen sc1
  s_xor_b32 s70, s61, 329728
  buffer_load_dwordx4 v[48:51], v3, s[40:43], s70 offen sc1
  s_xor_b32 s70, s61, 362496
  buffer_load_dwordx4 v[52:55], v3, s[40:43], s70 offen sc1
  s_waitcnt vmcnt(0)
  ds_write_b128 v3, v[20:23] offset:3072
  ds_write_b128 v3, v[24:27] offset:4096
  ds_write_b128 v3, v[28:31] offset:5120
  ds_write_b128 v3, v[32:35] offset:6144
  ds_write_b128 v3, v[36:39] offset:7168
  ds_write_b128 v3, v[40:43] offset:8192
  ds_write_b128 v3, v[44:47] offset:9216
  ds_write_b128 v3, v[48:51] offset:10240
  ds_write_b128 v3, v[52:55] offset:11264
L_h_i0:
  s_bitcmp0_b32 s58, 0
  s_cbranch_scc1 L_h_i1
  s_xor_b32 s70, s61, 396288
  buffer_load_dwordx4 v[56:59], v3, s[40:43], s70 offen sc1
  s_xor_b32 s70, s61, 429056
  buffer_load_dwordx4 v[60:63], v3, s[40:43], s70 offen sc1
  s_xor_b32 s70, s61, 461824
  buffer_load_dwordx4 v[64:67], v3, s[40:43], s70 offen sc1
  s_xor_b32 s70, s61, 494592
  buffer_load_dwordx4 v[68:71], v3, s[40:43], s70 offen sc1
  s_xor_b32 s70, s61, 541696
  buffer_load_dwordx4 v[72:75], v3, s[40:43], s70 offen sc1
  s_xor_b32 s70, s61, 574464
  buffer_load_dwordx4 v[76:79], v3, s[40:43], s70 offen sc1
  s_xor_b32 s70, s61, 607232
  buffer_load_dwordx4 v[80:83], v3, s[40:43], s70 offen sc1
  s_xor_b32 s70, s61, 640000
  buffer_load_dwordx4 v[84:87], v3, s[40:43], s70 offen sc1
  s_xor_b32 s70, s61, 671744
  buffer_load_dwordx4 v[88:91], v3, s[40:43], s70 offen sc1
  s_xor_b32 s70, s61, 704512
  buffer_load_dwordx4 v[92:95], v3, s[40:43], s70 offen sc1
  s_xor_b32 s70, s61, 737280
  buffer_load_dwordx4 v[96:99], v3, s[40:43], s70 offen sc1
  s_xor_b32 s70, s61, 770048
  buffer_load_dwordx4 v[100:103], v3, s[40:43], s70 offen sc1
  s_waitcnt vmcnt(0)
  ds_write_b128 v3, v[56:59] offset:12288
  ds_write_b128 v3, v[60:63] offset:13312
  ds_write_b128 v3, v[64:67] offset:14336
  ds_write_b128 v3, v[68:71] offset:15360
  ds_write_b128 v3, v[72:75] offset:16384
  ds_write_b128 v3, v[76:79] offset:17408
  ds_write_b128 v3, v[80:83] offset:18432
  ds_write_b128 v3, v[84:87] offset:19456
  ds_write_b128 v3, v[88:91] offset:20480
  ds_write_b128 v3, v[92:95] offset:21504
  ds_write_b128 v3, v[96:99] offset:22528
  ds_write_b128 v3, v[100:103] offset:23552
L_h_i1:
  s_waitcnt vmcnt(0)
  ds_write_b128 v3, v[8:11] offset:0
  ds_write_b128 v3, v[12:15] offset:1024
  ds_write_b128 v3, v[16:19] offset:2048
  s_bitcmp0_b32 s58, 1
  s_cselect_b32 s70, 255, 32
  v_mov_b32 v1, 61700
  v_mov_b32 v5, s70
  ds_write_b32 v1, v5
  s_mov_b32 s78, 92
  s_swappc_b64 s[84:85], s[86:87]
  s_bitcmp0_b32 s58, 1
  s_cbranch_scc1 L_h_all
L_h_progb:
  s_sleep 4
  ds_read_b32 v8, v112
  s_waitcnt lgkmcnt(0)
  v_cmp_gt_u32 vcc, 96, v8
  s_nop 1
  s_cmp_lg_u32 vcc_lo, 0
  s_cbranch_scc1 L_h_progb
  ds_read_b128 v[8:11], v3 offset:24576
  ds_read_b128 v[12:15], v3 offset:25600
  ds_read_b128 v[16:19], v3 offset:26624
  ds_read_b128 v[20:23], v3 offset:27648
  ds_read_b128 v[24:27], v3 offset:28672
  ds_read_b128 v[28:31], v3 offset:29696
  ds_read_b128 v[32:35], v3 offset:30720
  ds_read_b128 v[36:39], v3 offset:31744
  ds_read_b128 v[40:43], v3 offset:32768
  ds_read_b128 v[44:47], v3 offset:33792
  ds_read_b128 v[48:51], v3 offset:34816
  ds_read_b128 v[52:55], v3 offset:35840
  s_waitcnt lgkmcnt(0)
  s_xor_b32 s70, s60, 805888
  buffer_store_dwordx4 v[8:11], v3, s[40:43], s70 offen sc1
  s_xor_b32 s70, s60, 838656
  buffer_store_dwordx4 v[12:15], v3, s[40:43], s70 offen sc1
  s_xor_b32 s70, s60, 871424
  buffer_store_dwordx4 v[16:19], v3, s[40:43], s70 offen sc1
  s_xor_b32 s70, s60, 904192
  buffer_store_dwordx4 v[20:23], v3, s[40:43], s70 offen sc1
  s_xor_b32 s70, s60, 935936
  buffer_store_dwordx4 v[24:27], v3, s[40:43], s70 offen sc1
  s_xor_b32 s70, s60, 968704
  buffer_store_dwordx4 v[28:31], v3, s[40:43], s70 offen sc1
  s_xor_b32 s70, s60, 1001472
  buffer_store_dwordx4 v[32:35], v3, s[40:43], s70 offen sc1
  s_xor_b32 s70, s60, 1034240
  buffer_store_dwordx4 v[36:39], v3, s[40:43], s70 offen sc1
  s_xor_b32 s70, s60, 1052672
  buffer_store_dwordx4 v[40:43], v3, s[40:43], s70 offen sc1
  s_xor_b32 s70, s60, 1085440
  buffer_store_dwordx4 v[44:47], v3, s[40:43], s70 offen sc1
  s_xor_b32 s70, s60, 1118208
  buffer_store_dwordx4 v[48:51], v3, s[40:43], s70 offen sc1
  s_xor_b32 s70, s60, 1150976
  buffer_store_dwordx4 v[52:55], v3, s[40:43], s70 offen sc1
  s_add_u32 s54, s74, 2
  v_mov_b32 v5, 0
  s_waitcnt vmcnt(0)
  v_mov_b32 v8, s54
  v_mov_b32 v9, s75
  s_mov_b64 exec, 1
  buffer_store_dwordx2 v[8:9], v5, s[40:43], s62 offen sc1
  s_mov_b32 s59, 0
L_h_flagb:
  buffer_load_dwordx2 v[10:11], v5, s[40:43], s63 offen sc1
  s_waitcnt vmcnt(0)
  v_readfirstlane_b32 s56, v10
  v_readfirstlane_b32 s57, v11
  s_nop 0
  s_sub_u32 s56, s56, s54
  s_xor_b32 s57, s57, s75
  s_lshr_b32 s56, s56, 1
  s_or_b32 s56, s56, s57
  s_cbranch_scc0 L_h_flagb_done
  s_add_u32 s59, s59, 1
  s_cmp_gt_u32 s59, 10000
  s_cbranch_scc1 L_h_flagb_done
  s_sleep 8
  s_branch L_h_flagb
L_h_flagb_done:
  s_mov_b64 exec, -1
  s_xor_b32 s70, s61, 805888
  buffer_load_dwordx4 v[8:11], v3, s[40:43], s70 offen sc1
  s_xor_b32 s70, s61, 838656
  buffer_load_dwordx4 v[12:15], v3, s[40:43], s70 offen sc1
  s_xor_b32 s70, s61, 871424
  buffer_load_dwordx4 v[16:19], v3, s[40:43], s70 offen sc1
  s_xor_b32 s70, s61, 904192
  buffer_load_dwordx4 v[20:23], v3, s[40:43], s70 offen sc1
  s_xor_b32 s70, s61, 935936
  buffer_load_dwordx4 v[24:27], v3, s[40:43], s70 offen sc1
  s_xor_b32 s70, s61, 968704
  buffer_load_dwordx4 v[28:31], v3, s[40:43], s70 offen sc1
  s_xor_b32 s70, s61, 1001472
  buffer_load_dwordx4 v[32:35], v3, s[40:43], s70 offen sc1
  s_xor_b32 s70, s61, 1034240
  buffer_load_dwordx4 v[36:39], v3, s[40:43], s70 offen sc1
  s_xor_b32 s70, s61, 1052672
  buffer_load_dwordx4 v[40:43], v3, s[40:43], s70 offen sc1
  s_xor_b32 s70, s61, 1085440
  buffer_load_dwordx4 v[44:47], v3, s[40:43], s70 offen sc1
  s_xor_b32 s70, s61, 1118208
  buffer_load_dwordx4 v[48:51], v3, s[40:43], s70 offen sc1
  s_xor_b32 s70, s61, 1150976
  buffer_load_dwordx4 v[52:55], v3, s[40:43], s70 offen sc1
  s_waitcnt vmcnt(0)
  ds_write_b128 v3, v[8:11] offset:24576
  ds_write_b128 v3, v[12:15] offset:25600
  ds_write_b128 v3, v[16:19] offset:26624
  ds_write_b128 v3, v[20:23] offset:27648
  ds_write_b128 v3, v[24:27] offset:28672
  ds_write_b128 v3, v[28:31] offset:29696
  ds_write_b128 v3, v[32:35] offset:30720
  ds_write_b128 v3, v[36:39] offset:31744
  ds_write_b128 v3, v[40:43] offset:32768
  ds_write_b128 v3, v[44:47] offset:33792
  ds_write_b128 v3, v[48:51] offset:34816
  ds_write_b128 v3, v[52:55] offset:35840
  v_mov_b32 v1, 61700
  v_mov_b32 v5, 255
  ds_write_b32 v1, v5
L_h_all:
  s_mov_b32 s78, 182
  s_swappc_b64 s[84:85], s[86:87]
L_h_progt:
  s_sleep 4
  ds_read_b32 v8, v112
  s_waitcnt lgkmcnt(0)
  v_cmp_gt_u32 vcc, 188, v8
  s_nop 1
  s_cmp_lg_u32 vcc_lo, 0
  s_cbranch_scc1 L_h_progt
  v_mov_b32 v8, 255
  ds_write_b32 v112, v8 offset:8
  s_branch L_finish
L_h_cp:
  s_cmp_gt_u32 s76, s78
  s_cbranch_scc0 L_h_cpgo
  s_setpc_b64 s[84:85]
L_h_cpgo:
  ds_read_b32 v8, v112
  s_waitcnt lgkmcnt(0)
  v_cmp_gt_u32 vcc, s76, v8
  s_nop 1
  s_cmp_eq_u32 vcc_lo, 0
  s_cbranch_scc1 L_h_cpnext
L_h_first:
  s_sleep 2
  ds_read_b32 v8, v112
  s_waitcnt lgkmcnt(0)
  v_cmp_gt_u32 s[48:49], s76, v8
  s_nop 1
  s_cmp_eq_u32 s48, -1
  s_cbranch_scc1 L_h_first
  s_memrealtime s[54:55]
L_h_progm:
  s_sleep 2
  ds_read_b32 v8, v112
  s_waitcnt lgkmcnt(0)
  v_cmp_gt_u32 vcc, s76, v8
  s_nop 1
  s_cmp_lg_u32 vcc_lo, 0
  s_cbranch_scc1 L_h_progm
  s_memrealtime s[56:57]
  v_mov_b32 v114, s54
  v_mov_b32 v115, s55
  s_mov_b64 exec, s[48:49]
  s_waitcnt lgkmcnt(0)
  v_mov_b32 v114, s56
  v_mov_b32 v115, s57
  s_mov_b64 exec, -1
  s_and_b32 s70, s2, 0x78
  s_cbranch_scc1 L_h_np
  s_mov_b64 exec, 3
  buffer_store_dwordx2 v[114:115], v104, s[40:43], s77 offen sc1
  s_mov_b64 exec, -1
L_h_np:
  s_add_u32 s50, s76, 4
L_h_progc:
  s_sleep 4
  ds_read_b32 v8, v112
  s_waitcnt lgkmcnt(0)
  v_cmp_gt_u32 vcc, s50, v8
  s_nop 1
  s_cmp_lg_u32 vcc_lo, 0
  s_cbranch_scc1 L_h_progc
  buffer_load_dwordx2 v[8:9], v105, s[40:43], s77 offen
  v_mov_b32 v10, s73
  s_waitcnt vmcnt(0)
  ds_read_b32 v12, v112
  v_subrev_co_u32 v8, vcc, s72, v8
  s_nop 1
  v_subb_co_u32 v9, vcc, v9, v10, vcc
  v_lshrrev_b32 v10, 24, v8
  v_or_b32 v9, v9, v10
  v_cmp_eq_u32 vcc, 0, v9
  s_nop 1
  v_cndmask_b32 v8, 0, v8, vcc
  s_bcnt1_i32_b32 s56, vcc_lo
  s_nop 0
  v_add_u32_dpp v8, v8, v8 row_ror:8 row_mask:0xf bank_mask:0xf
  s_nop 1
  v_add_u32_dpp v8, v8, v8 row_ror:4 row_mask:0xf bank_mask:0xf
  s_nop 1
  v_add_u32_dpp v8, v8, v8 row_ror:2 row_mask:0xf bank_mask:0xf
  s_nop 1
  v_add_u32_dpp v8, v8, v8 row_ror:1 row_mask:0xf bank_mask:0xf
  s_nop 0
  v_readlane_b32 s54, v8, 0
  v_readlane_b32 s70, v8, 16
  v_subrev_u32 v8, s72, v114
  v_mul_lo_u32 v8, v8, s56
  s_add_u32 s54, s54, s70
  s_max_u32 s56, s56, 1
  v_subrev_u32 v8, s54, v8
  v_cvt_f32_u32 v9, s56
  v_cvt_f32_i32 v8, v8
  v_rcp_f32 v9, v9
  s_nop 0
  v_mul_f32 v8, v8, v9
  v_cvt_i32_f32 v8, v8
  s_waitcnt lgkmcnt(0)
  v_add_u32 v12, 2, v12
  v_min_u32 v9, v113, v12
  v_subrev_u32 v9, s76, v9
  v_max_i32 v9, 0, v9
  v_lshrrev_b32 v9, 1, v9
  v_mul_u32_u24 v9, 28, v9
  v_sub_u32 v8, v8, v9
  v_add_u32 v9, 14, v8
  v_max_i32 v9, 0, v9
  v_min_i32 v9, 2000, v9
  v_mul_u32_u24 v9, 2340, v9
  v_lshrrev_b32 v9, 16, v9
  v_cmp_ne_u32 vcc, 0, v9
  v_lshl_add_u32 v9, v9, 1, v12
  s_nop 0
  v_cndmask_b32 v113, 0, v9, vcc
  ds_write_b32 v112, v113 offset:8
L_h_cpnext:
  s_add_u32 s76, s76, 8
  s_add_u32 s77, s77, 256
  s_branch L_h_cp
L_code_end:
.section .rodata,"a"
.p2align 6
.amdhsa_kernel standalone__kv_cache_quant_int4_int2_kv_with_per_channel_or_per_token_scales__sampling_kernel
  .amdhsa_next_free_vgpr 256
  .amdhsa_next_free_sgpr 102
  .amdhsa_accum_offset 256
  .amdhsa_group_segment_fixed_size 0
  .amdhsa_kernarg_size 80
  .amdhsa_user_sgpr_count 2
  .amdhsa_user_sgpr_kernarg_segment_ptr 1
  .amdhsa_system_sgpr_workgroup_id_x 1
  .amdhsa_float_denorm_mode_32 3
.end_amdhsa_kernel
```

```asm
; @launch grid=(256,1,1) block=(192,1,1) lds=62464
.amdgcn_target "amdgcn-amd-amdhsa--gfx950"
.text
.globl standalone__kv_cache_quant_int4_int2_kv_with_per_channel_or_per_token_scales__sampling_kernel
.p2align 8
.type standalone__kv_cache_quant_int4_int2_kv_with_per_channel_or_per_token_scales__sampling_kernel,@function
standalone__kv_cache_quant_int4_int2_kv_with_per_channel_or_per_token_scales__sampling_kernel:
  s_cmp_ge_u32 s2, 256
  s_cbranch_scc1 L_end
  s_load_dwordx16 s[44:59], s[0:1], 0
  s_load_dwordx4 s[80:83], s[0:1], 64
  v_lshrrev_b32 v1, 6, v0
  v_and_b32 v0, 63, v0
  v_readfirstlane_b32 s3, v1
  s_bfe_u32 s4, s2, 0x10002
  s_lshr_b32 s5, s2, 3
  s_lshl_b32 s5, s5, 2
  s_and_b32 s70, s2, 3
  s_add_u32 s5, s5, s70
  s_lshl_b32 s5, s5, 5
  s_mov_b32 s22, 6291456
  s_mov_b32 s23, 0x20000
  s_mov_b32 s26, 6291456
  s_mov_b32 s27, 0x20000
  s_mov_b32 s30, 2097152
  s_mov_b32 s31, 0x20000
  s_mov_b32 s34, 2097152
  s_mov_b32 s35, 0x20000
  s_mov_b32 s10, 805306368
  s_mov_b32 s11, 0x20000
  s_mov_b32 s38, 393216
  s_mov_b32 s39, 0x20000
  s_mov_b32 s18, 805306368
  s_mov_b32 s19, 0x20000
  s_mov_b32 s14, 805306368
  s_mov_b32 s15, 0x20000
  s_mov_b32 s42, 25165824
  s_mov_b32 s43, 0x20000
  s_cmp_eq_u32 s3, 2
  s_cbranch_scc1 L_helper
  v_and_b32 v108, 3, v0
  v_bfe_u32 v109, v0, 2, 2
  v_lshrrev_b32 v110, 4, v0
  v_and_b32 v111, 15, v0
  v_lshlrev_b32 v144, 4, v108
  v_lshl_add_u32 v144, v110, 6, v144
  v_lshrrev_b32 v233, 1, v144
  v_and_b32 v231, 2, v109
  v_lshlrev_b32 v230, 5, v231
  v_add_u32 v230, 129, v230
  v_and_b32 v145, 1, v109
  v_lshl_add_u32 v231, v145, 2, v231
  v_mul_u32_u24 v145, 33024, v145
  v_add_u32 v232, v144, v145
  v_subrev_u32 v232, 33024, v232
  v_mul_u32_u24 v145, 384, v109
  v_add_u32 v235, v145, v233
  v_mov_b32 v105, 2147483632
  s_mov_b32 s90, 0xaaaaaaab
  s_mov_b32 s91, 0x492492
  s_movk_i32 s63, 768
  s_mov_b32 s64, s3
  s_mov_b32 s99, 8
  s_mov_b32 s96, 0
  v_lshlrev_b32 v114, 4, v0
  s_lshl1_add_u32 s70, s2, s3
  s_mul_i32 s88, s70, 4096
  s_mul_i32 s86, s70, 12288
  s_waitcnt lgkmcnt(0)
  s_mov_b32 s20, s50
  s_and_b32 s21, s51, 0xffff
  s_mov_b32 s24, s52
  s_and_b32 s25, s53, 0xffff
  s_mov_b32 s28, s54
  s_and_b32 s29, s55, 0xffff
  s_mov_b32 s32, s56
  s_and_b32 s33, s57, 0xffff
  buffer_load_dwordx4 v[128:131], v114, s[20:23], s86 offen offset:0
  buffer_load_dwordx4 v[128:131], v114, s[24:27], s86 offen offset:0
  buffer_load_dwordx4 v[128:131], v114, s[28:31], s88 offen offset:0
  buffer_load_dwordx4 v[128:131], v114, s[32:35], s88 offen offset:0
  buffer_load_dwordx4 v[128:131], v114, s[20:23], s86 offen offset:1024
  buffer_load_dwordx4 v[128:131], v114, s[24:27], s86 offen offset:1024
  buffer_load_dwordx4 v[128:131], v114, s[28:31], s88 offen offset:1024
  buffer_load_dwordx4 v[128:131], v114, s[32:35], s88 offen offset:1024
  s_mov_b32 s8, s46
  s_and_b32 s9, s47, 0xffff
  s_mov_b32 s36, s44
  s_and_b32 s37, s45, 0xffff
  s_mov_b32 s16, s46
  s_and_b32 s17, s47, 0xffff
  s_mov_b32 s12, s48
  s_and_b32 s13, s49, 0xffff
  s_mov_b32 s40, s82
  s_and_b32 s41, s83, 0xffff
  s_mov_b64 s[46:47], s[58:59]
  s_mov_b32 s56, 0x0f0f0f0f
  s_mov_b32 s57, 0x0f0f0f0f
  s_mov_b32 s58, 0xffff
  s_mov_b32 s59, 0xffff
  s_lshr_b32 s71, s64, 4
  s_andn2_b32 s71, s71, 1
  s_lshr_b32 s71, 0x12, s71
  s_and_b32 s71, s71, 3
  s_lshr_b32 s85, s96, s71
  s_andn2_b32 s70, s64, 1
  s_or_b32 s70, s70, s4
  s_cmp_lt_u32 s64, 8
  s_cselect_b32 s70, s70, s64
  s_cselect_b32 s85, s64, s85
  s_and_b32 s85, s85, 1
  s_and_b32 s70, s70, 31
  s_lshl_b32 s71, s71, 12
  s_add_u32 s70, s70, s5
  s_add_u32 s70, s70, s71
  s_mul_hi_u32 s84, s70, s90
  s_lshr_b32 s84, s84, 1
  s_mul_i32 s71, s84, 3
  s_sub_u32 s70, s70, s71
  s_lshl3_add_u32 s85, s70, s85
  s_mul_i32 s61, s84, 196608
  s_lshr_b32 s89, s84, 4
  s_lshl_b32 s70, s85, 5
  v_add_u32 v97, s70, v230
  v_mul_u32_u24 v97, 21846, v97
  v_lshrrev_b32 v97, 16, v97
  v_add_u32 v144, s85, v231
  v_lshrrev_b32 v145, v144, s91
  v_and_b32 v145, 1, v145
  v_cmp_eq_u32 s[54:55], 1, v145
  s_nop 1
  s_and_b64 s[52:53], s[54:55], s[56:57]
  s_andn2_b64 s[54:55], s[54:55], s[56:57]
  v_mul_u32_u24 v144, 43, v144
  v_lshrrev_b32 v144, 8, v144
  v_mul_u32_u24 v144, 384, v144
  v_add_u32 v234, v144, v233
  v_mad_u32_u24 v92, v97, s63, v232
  v_add_u32 v93, 768, v92
  v_add_u32 v94, 4608, v92
  v_add_u32 v95, 7680, v92
  v_cndmask_b32 v92, v92, v105, s[52:53]
  v_cndmask_b32 v95, v95, v105, s[54:55]
  s_mov_b32 s60, s61
  s_mul_i32 s70, s89, 1536
  buffer_load_dwordx2 v[174:175], v235, s[36:39], s70 offen offset:0
  buffer_load_dwordx2 v[176:177], v235, s[36:39], s70 offen offset:128
  buffer_load_dwordx2 v[178:179], v235, s[36:39], s70 offen offset:256
  buffer_load_dwordx4 v[4:7], v92, s[8:11], s60 offen offset:0 nt
  buffer_load_dwordx4 v[128:131], v114, s[20:23], s86 offen offset:2048
  buffer_load_dwordx4 v[128:131], v114, s[24:27], s86 offen offset:2048
  buffer_load_dwordx4 v[128:131], v114, s[28:31], s88 offen offset:2048
  buffer_load_dwordx4 v[128:131], v114, s[32:35], s88 offen offset:2048
  buffer_load_dwordx4 v[128:131], v114, s[20:23], s86 offen offset:3072
  buffer_load_dwordx4 v[128:131], v114, s[24:27], s86 offen offset:3072
  buffer_load_dwordx4 v[128:131], v114, s[28:31], s88 offen offset:3072
  buffer_load_dwordx4 v[128:131], v114, s[32:35], s88 offen offset:3072
  s_barrier
  s_mov_b64 vcc, 0
  v_lshlrev_b32 v144, 4, v111
  v_and_b32 v2, 2, v110
  v_lshlrev_b32 v1, 5, v2
  v_add_u32 v1, 129, v1
  v_and_b32 v145, 1, v110
  v_lshl_add_u32 v2, v145, 2, v2
  v_mul_u32_u24 v145, 33024, v145
  v_add_u32 v3, v144, v145
  v_subrev_u32 v3, 33024, v3
  v_and_b32 v145, 1, v110
  v_mul_u32_u24 v145, 86, v145
  v_lshl_add_u32 v96, v111, 1, v145
  v_subrev_u32 v96, 86, v96
  v_lshlrev_b32 v101, 4, v110
  v_lshrrev_b32 v144, 2, v0
  s_mul_i32 s70, s3, 384
  v_lshl_add_u32 v99, v144, 4, s70
  v_lshl_add_u32 v100, v144, 3, s70
  s_mul_i32 s70, s3, 3072
  s_add_u32 s70, s70, 36864
  v_lshl_add_u32 v102, v0, 4, s70
  s_lshl_b32 s70, s3, 5
  s_add_u32 s70, s70, 43008
  v_lshl_add_u32 v103, v109, 3, s70
  s_lshl2_add_u32 s70, s3, 61712
  v_mov_b32 v104, s70
  v_mov_b32 v112, 0
  v_mov_b32 v113, 0
  v_mov_b32 v236, 0xff800000
  v_mov_b32 v146, 1
  s_mov_b32 s65, 0xffff0000
  s_mov_b32 s66, 0x3fb8aa3b
  s_mov_b32 s68, 0x3d93cd3a
  s_mov_b32 s69, 0x3d93cd3a
  s_mov_b32 s72, 0x11111111
  s_mov_b32 s73, 0x11111111
  s_mov_b32 s74, 0x22222222
  s_mov_b32 s75, 0x22222222
  s_mov_b32 s76, 0x44444444
  s_mov_b32 s77, 0x44444444
  s_mov_b32 s78, 0x88888888
  s_mov_b32 s79, 0x88888888
  s_add_u32 s86, s86, 4096
  s_waitcnt vmcnt(15)
  buffer_load_dwordx4 v[128:131], v114, s[20:23], s86 offen offset:0
  s_waitcnt vmcnt(15)
  buffer_load_dwordx4 v[128:131], v114, s[24:27], s86 offen offset:0
  s_waitcnt vmcnt(15)
  buffer_load_dwordx4 v[128:131], v114, s[20:23], s86 offen offset:1024
  s_waitcnt vmcnt(15)
  buffer_load_dwordx4 v[128:131], v114, s[24:27], s86 offen offset:1024
  s_waitcnt vmcnt(15)
  buffer_load_dwordx4 v[128:131], v114, s[20:23], s86 offen offset:2048
  s_waitcnt vmcnt(15)
  buffer_load_dwordx4 v[128:131], v114, s[24:27], s86 offen offset:2048
  s_waitcnt vmcnt(15)
  buffer_load_dwordx4 v[128:131], v114, s[20:23], s86 offen offset:3072
  s_waitcnt vmcnt(15)
  buffer_load_dwordx4 v[128:131], v114, s[24:27], s86 offen offset:3072
  s_add_u32 s86, s86, 4096
  s_waitcnt vmcnt(15)
  buffer_load_dwordx4 v[128:131], v114, s[20:23], s86 offen offset:0
  s_waitcnt vmcnt(15)
  buffer_load_dwordx4 v[128:131], v114, s[24:27], s86 offen offset:0
  s_waitcnt vmcnt(15)
  buffer_load_dwordx4 v[128:131], v114, s[20:23], s86 offen offset:1024
  s_waitcnt vmcnt(15)
  buffer_load_dwordx4 v[128:131], v114, s[24:27], s86 offen offset:1024
  s_waitcnt vmcnt(15)
  buffer_load_dwordx4 v[128:131], v114, s[20:23], s86 offen offset:2048
  s_waitcnt vmcnt(15)
  buffer_load_dwordx4 v[128:131], v114, s[24:27], s86 offen offset:2048
  s_waitcnt vmcnt(15)
  buffer_load_dwordx4 v[128:131], v114, s[20:23], s86 offen offset:3072
  s_waitcnt vmcnt(15)
  buffer_load_dwordx4 v[128:131], v114, s[24:27], s86 offen offset:3072
  s_mov_b32 s88, s89
  s_mul_i32 s62, s84, 1536
  buffer_load_dwordx2 v[180:181], v234, s[20:23], s62 offen offset:0
  buffer_load_dwordx2 v[186:187], v234, s[24:27], s62 offen offset:0
  buffer_load_dwordx2 v[182:183], v234, s[20:23], s62 offen offset:128
  buffer_load_dwordx2 v[188:189], v234, s[24:27], s62 offen offset:128
  buffer_load_dwordx2 v[184:185], v234, s[20:23], s62 offen offset:256
  buffer_load_dwordx2 v[190:191], v234, s[24:27], s62 offen offset:256
  s_waitcnt vmcnt(15)
  buffer_load_dwordx4 v[8:11], v92, s[8:11], s60 offen offset:256 nt
  s_waitcnt vmcnt(15)
  buffer_load_dwordx4 v[12:15], v92, s[8:11], s60 offen offset:512 nt
  s_waitcnt vmcnt(15)
  buffer_load_dwordx4 v[16:19], v93, s[8:11], s60 offen offset:0 nt
  s_waitcnt vmcnt(15)
  buffer_load_dwordx4 v[20:23], v93, s[8:11], s60 offen offset:256 nt
  s_waitcnt vmcnt(15)
  buffer_load_dwordx4 v[24:27], v93, s[8:11], s60 offen offset:512 nt
  s_waitcnt vmcnt(15)
  buffer_load_dwordx4 v[28:31], v93, s[8:11], s60 offen offset:768 nt
  s_waitcnt vmcnt(15)
  buffer_load_dwordx4 v[32:35], v93, s[8:11], s60 offen offset:1024 nt
  s_waitcnt vmcnt(15)
  buffer_load_dwordx4 v[36:39], v93, s[8:11], s60 offen offset:1280 nt
  s_waitcnt vmcnt(15)
  buffer_load_dwordx4 v[40:43], v93, s[8:11], s60 offen offset:1536 nt
  s_waitcnt vmcnt(15)
  buffer_load_dwordx4 v[44:47], v93, s[8:11], s60 offen offset:1792 nt
  s_waitcnt vmcnt(16)
  buffer_load_dwordx4 v[48:51], v93, s[8:11], s60 offen offset:2048 nt
  s_waitcnt vmcnt(17)
  buffer_load_dwordx4 v[52:55], v93, s[8:11], s60 offen offset:2304 nt
  s_waitcnt vmcnt(18)
  buffer_load_dwordx4 v[56:59], v93, s[8:11], s60 offen offset:2560 nt
  s_waitcnt vmcnt(19)
  buffer_load_dwordx4 v[60:63], v93, s[8:11], s60 offen offset:2816 nt
  s_waitcnt vmcnt(14)
  ds_write_b32 v104, v146
L_k:
  v_add_u32 v144, s85, v2
  v_lshrrev_b32 v145, v144, s91
  v_and_b32 v145, 1, v145
  v_cmp_eq_u32 s[50:51], 1, v145
  s_nop 1
  s_and_b64 s[48:49], s[50:51], s[58:59]
  s_andn2_b64 s[50:51], s[50:51], s[58:59]
  s_mov_b32 s97, s64
  s_add_u32 s64, s64, 2
  ds_read_b32 v106, v104 offset:8
  s_waitcnt vmcnt(14)
  s_cbranch_vccnz L_kw0_0
  s_waitcnt vmcnt(9)
L_kw0_0:
  buffer_load_dwordx4 v[64:67], v93, s[8:11], s60 offen offset:3072 nt
  v_lshlrev_b32 v204, 16, v186
  v_and_b32 v205, s65, v186
  v_lshlrev_b32 v206, 16, v187
  v_and_b32 v207, s65, v187
  v_lshlrev_b32 v192, 16, v180
  v_and_b32 v193, s65, v180
  v_lshlrev_b32 v194, 16, v181
  v_and_b32 v195, s65, v181
  v_mov_b32 v168, v174
  v_mov_b32 v169, v175
  v_cvt_f32_i32 v108, v4
  v_cvt_f32_i32 v109, v5
  v_cvt_f32_i32 v110, v6
  v_cvt_f32_i32 v111, v7
  v_pk_add_f32 v[108:109], v[108:109], v[204:205] neg_lo:[0,1] neg_hi:[0,1]
  v_pk_add_f32 v[110:111], v[110:111], v[206:207] neg_lo:[0,1] neg_hi:[0,1]
  v_cvt_pk_bf16_f32 v108, 0, v108
  v_cvt_pk_bf16_f32 v109, 0, v109
  v_cvt_pk_bf16_f32 v110, 0, v110
  v_cvt_pk_bf16_f32 v111, 0, v111
  v_pk_mul_f32 v[108:109], v[108:109], v[192:193]
  v_pk_mul_f32 v[110:111], v[110:111], v[194:195]
  v_cvt_pk_bf16_f32 v216, v108, v109
  v_cvt_pk_bf16_f32 v217, v110, v111
  s_waitcnt lgkmcnt(0)
  v_cmp_lt_u32 vcc, s97, v106
  s_waitcnt vmcnt(14)
  buffer_load_dwordx4 v[68:71], v93, s[8:11], s60 offen offset:3328 nt
  v_lshlrev_b32 v208, 16, v188
  v_and_b32 v209, s65, v188
  v_lshlrev_b32 v210, 16, v189
  v_and_b32 v211, s65, v189
  v_lshlrev_b32 v196, 16, v182
  v_and_b32 v197, s65, v182
  v_lshlrev_b32 v198, 16, v183
  v_and_b32 v199, s65, v183
  v_mov_b32 v170, v176
  v_mov_b32 v171, v177
  v_cvt_f32_i32 v108, v8
  v_cvt_f32_i32 v109, v9
  v_cvt_f32_i32 v110, v10
  v_cvt_f32_i32 v111, v11
  v_pk_add_f32 v[108:109], v[108:109], v[208:209] neg_lo:[0,1] neg_hi:[0,1]
  v_pk_add_f32 v[110:111], v[110:111], v[210:211] neg_lo:[0,1] neg_hi:[0,1]
  v_cvt_pk_bf16_f32 v108, 0, v108
  v_cvt_pk_bf16_f32 v109, 0, v109
  v_cvt_pk_bf16_f32 v110, 0, v110
  v_cvt_pk_bf16_f32 v111, 0, v111
  v_pk_mul_f32 v[108:109], v[108:109], v[196:197]
  v_pk_mul_f32 v[110:111], v[110:111], v[198:199]
  v_cvt_pk_bf16_f32 v218, v108, v109
  v_cvt_pk_bf16_f32 v219, v110, v111
  s_waitcnt vmcnt(14)
  buffer_load_dwordx4 v[72:75], v93, s[8:11], s60 offen offset:3584 nt
  v_mfma_f32_16x16x32_bf16 v[224:227], v[216:219], v[168:171], 0
  v_lshlrev_b32 v212, 16, v190
  v_and_b32 v213, s65, v190
  v_lshlrev_b32 v214, 16, v191
  v_and_b32 v215, s65, v191
  v_lshlrev_b32 v200, 16, v184
  v_and_b32 v201, s65, v184
  v_lshlrev_b32 v202, 16, v185
  v_and_b32 v203, s65, v185
  v_mov_b32 v172, v178
  v_mov_b32 v173, v179
  v_cvt_f32_i32 v108, v12
  v_cvt_f32_i32 v109, v13
  v_cvt_f32_i32 v110, v14
  v_cvt_f32_i32 v111, v15
  v_pk_add_f32 v[108:109], v[108:109], v[212:213] neg_lo:[0,1] neg_hi:[0,1]
  v_pk_add_f32 v[110:111], v[110:111], v[214:215] neg_lo:[0,1] neg_hi:[0,1]
  v_cvt_pk_bf16_f32 v108, 0, v108
  v_cvt_pk_bf16_f32 v109, 0, v109
  v_cvt_pk_bf16_f32 v110, 0, v110
  v_cvt_pk_bf16_f32 v111, 0, v111
  v_pk_mul_f32 v[108:109], v[108:109], v[200:201]
  v_pk_mul_f32 v[110:111], v[110:111], v[202:203]
  v_cvt_pk_bf16_f32 v220, v108, v109
  v_cvt_pk_bf16_f32 v221, v110, v111
  s_waitcnt vmcnt(14)
  s_cbranch_vccnz L_kw0_3
  s_waitcnt vmcnt(9)
L_kw0_3:
  buffer_load_dwordx4 v[76:79], v94, s[8:11], s60 offen offset:0 nt
  v_mfma_f32_16x16x16_bf16 v[224:227], v[220:221], v[172:173], v[224:227]
  v_cvt_f32_i32 v108, v16
  v_cvt_f32_i32 v109, v17
  v_cvt_f32_i32 v110, v18
  v_cvt_f32_i32 v111, v19
  v_pk_add_f32 v[108:109], v[108:109], v[204:205] neg_lo:[0,1] neg_hi:[0,1]
  v_pk_add_f32 v[110:111], v[110:111], v[206:207] neg_lo:[0,1] neg_hi:[0,1]
  v_cvt_pk_bf16_f32 v108, 0, v108
  v_cvt_pk_bf16_f32 v109, 0, v109
  v_cvt_pk_bf16_f32 v110, 0, v110
  v_cvt_pk_bf16_f32 v111, 0, v111
  v_pk_mul_f32 v[108:109], v[108:109], v[192:193]
  v_pk_mul_f32 v[110:111], v[110:111], v[194:195]
  v_cvt_pk_bf16_f32 v216, v108, v109
  v_cvt_pk_bf16_f32 v217, v110, v111
  s_waitcnt vmcnt(14)
  buffer_load_dwordx4 v[80:83], v94, s[8:11], s60 offen offset:256 nt
  v_cvt_f32_i32 v108, v20
  v_cvt_f32_i32 v109, v21
  v_cvt_f32_i32 v110, v22
  v_cvt_f32_i32 v111, v23
  v_pk_add_f32 v[108:109], v[108:109], v[208:209] neg_lo:[0,1] neg_hi:[0,1]
  v_pk_add_f32 v[110:111], v[110:111], v[210:211] neg_lo:[0,1] neg_hi:[0,1]
  v_mov_b32_dpp v144, v224 quad_perm:[0,0,0,0] row_mask:0xf bank_mask:0xf
  v_mov_b32_dpp v145, v226 quad_perm:[2,2,2,2] row_mask:0xf bank_mask:0xf
  v_cvt_pk_bf16_f32 v108, 0, v108
  v_cvt_pk_bf16_f32 v109, 0, v109
  v_add_f32_dpp v144, v225, v144 quad_perm:[1,1,1,1] row_mask:0xf bank_mask:0xf
  v_add_f32_dpp v145, v227, v145 quad_perm:[3,3,3,3] row_mask:0xf bank_mask:0xf
  v_cvt_pk_bf16_f32 v110, 0, v110
  v_cvt_pk_bf16_f32 v111, 0, v111
  v_add_f32 v228, v144, v145
  v_pk_mul_f32 v[108:109], v[108:109], v[196:197]
  v_pk_mul_f32 v[110:111], v[110:111], v[198:199]
  v_cvt_pk_bf16_f32 v218, v108, v109
  v_cvt_pk_bf16_f32 v219, v110, v111
  s_waitcnt vmcnt(14)
  buffer_load_dwordx4 v[84:87], v94, s[8:11], s60 offen offset:512 nt
  v_mfma_f32_16x16x32_bf16 v[224:227], v[216:219], v[168:171], 0
  v_cvt_f32_i32 v108, v24
  v_cvt_f32_i32 v109, v25
  v_cvt_f32_i32 v110, v26
  v_cvt_f32_i32 v111, v27
  v_pk_add_f32 v[108:109], v[108:109], v[212:213] neg_lo:[0,1] neg_hi:[0,1]
  v_pk_add_f32 v[110:111], v[110:111], v[214:215] neg_lo:[0,1] neg_hi:[0,1]
  v_cvt_pk_bf16_f32 v108, 0, v108
  v_cndmask_b32 v228, v228, v236, s[48:49]
  v_cvt_pk_bf16_f32 v109, 0, v109
  v_cvt_pk_bf16_f32 v110, 0, v110
  v_cvt_pk_bf16_f32 v111, 0, v111
  v_pk_mul_f32 v[108:109], v[108:109], v[200:201]
  v_pk_mul_f32 v[110:111], v[110:111], v[202:203]
  v_cvt_pk_bf16_f32 v220, v108, v109
  v_cvt_pk_bf16_f32 v221, v110, v111
  s_waitcnt vmcnt(14)
  s_cbranch_vccnz L_kw0_6
  s_waitcnt vmcnt(9)
L_kw0_6:
  buffer_load_dwordx4 v[88:91], v94, s[8:11], s60 offen offset:768 nt
  v_mfma_f32_16x16x16_bf16 v[224:227], v[220:221], v[172:173], v[224:227]
  v_cvt_f32_i32 v108, v28
  v_cvt_f32_i32 v109, v29
  v_cvt_f32_i32 v110, v30
  v_cvt_f32_i32 v111, v31
  v_pk_add_f32 v[108:109], v[108:109], v[204:205] neg_lo:[0,1] neg_hi:[0,1]
  v_pk_add_f32 v[110:111], v[110:111], v[206:207] neg_lo:[0,1] neg_hi:[0,1]
  v_cvt_pk_bf16_f32 v108, 0, v108
  v_cvt_pk_bf16_f32 v109, 0, v109
  v_cvt_pk_bf16_f32 v110, 0, v110
  v_cvt_pk_bf16_f32 v111, 0, v111
  v_pk_mul_f32 v[108:109], v[108:109], v[192:193]
  v_pk_mul_f32 v[110:111], v[110:111], v[194:195]
  v_cvt_pk_bf16_f32 v216, v108, v109
  v_cvt_pk_bf16_f32 v217, v110, v111
  s_waitcnt vmcnt(14)
  buffer_load_dwordx4 v[4:7], v94, s[8:11], s60 offen offset:1024 nt
  v_cvt_f32_i32 v108, v32
  v_cvt_f32_i32 v109, v33
  v_cvt_f32_i32 v110, v34
  v_cvt_f32_i32 v111, v35
  v_pk_add_f32 v[108:109], v[108:109], v[208:209] neg_lo:[0,1] neg_hi:[0,1]
  v_pk_add_f32 v[110:111], v[110:111], v[210:211] neg_lo:[0,1] neg_hi:[0,1]
  v_mov_b32_dpp v144, v224 quad_perm:[0,0,0,0] row_mask:0xf bank_mask:0xf
  v_mov_b32_dpp v145, v226 quad_perm:[2,2,2,2] row_mask:0xf bank_mask:0xf
  v_cvt_pk_bf16_f32 v108, 0, v108
  v_cvt_pk_bf16_f32 v109, 0, v109
  v_add_f32_dpp v144, v225, v144 quad_perm:[1,1,1,1] row_mask:0xf bank_mask:0xf
  v_add_f32_dpp v145, v227, v145 quad_perm:[3,3,3,3] row_mask:0xf bank_mask:0xf
  v_cvt_pk_bf16_f32 v110, 0, v110
  v_cvt_pk_bf16_f32 v111, 0, v111
  v_add_f32 v229, v144, v145
  v_pk_mul_f32 v[108:109], v[108:109], v[196:197]
  v_pk_mul_f32 v[110:111], v[110:111], v[198:199]
  v_cvt_pk_bf16_f32 v218, v108, v109
  v_cvt_pk_bf16_f32 v219, v110, v111
  s_waitcnt vmcnt(14)
  buffer_load_dwordx4 v[8:11], v94, s[8:11], s60 offen offset:1280 nt
  v_mfma_f32_16x16x32_bf16 v[224:227], v[216:219], v[168:171], 0
  v_cvt_f32_i32 v108, v36
  v_cvt_f32_i32 v109, v37
  v_cvt_f32_i32 v110, v38
  v_cvt_f32_i32 v111, v39
  v_pk_add_f32 v[108:109], v[108:109], v[212:213] neg_lo:[0,1] neg_hi:[0,1]
  v_pk_add_f32 v[110:111], v[110:111], v[214:215] neg_lo:[0,1] neg_hi:[0,1]
  v_cvt_pk_bf16_f32 v108, 0, v108
  v_cvt_pk_bf16_f32 v228, 0, v228
  v_cvt_pk_bf16_f32 v109, 0, v109
  v_cvt_pk_bf16_f32 v229, 0, v229
  v_cvt_pk_bf16_f32 v110, 0, v110
  v_pk_mul_f32 v[228:229], v[228:229], s[68:69]
  v_cvt_pk_bf16_f32 v111, 0, v111
  v_cvt_pk_bf16_f32 v120, v228, v229
  v_pk_mul_f32 v[108:109], v[108:109], v[200:201]
  v_pk_mul_f32 v[110:111], v[110:111], v[202:203]
  v_cvt_pk_bf16_f32 v220, v108, v109
  v_cvt_pk_bf16_f32 v221, v110, v111
  s_waitcnt vmcnt(14)
  s_cbranch_vccnz L_kw0_9
  s_waitcnt vmcnt(9)
L_kw0_9:
  buffer_load_dwordx4 v[12:15], v94, s[8:11], s60 offen offset:1536 nt
  v_mfma_f32_16x16x16_bf16 v[224:227], v[220:221], v[172:173], v[224:227]
  v_cvt_f32_i32 v108, v40
  v_cvt_f32_i32 v109, v41
  v_cvt_f32_i32 v110, v42
  v_cvt_f32_i32 v111, v43
  v_pk_add_f32 v[108:109], v[108:109], v[204:205] neg_lo:[0,1] neg_hi:[0,1]
  v_pk_add_f32 v[110:111], v[110:111], v[206:207] neg_lo:[0,1] neg_hi:[0,1]
  v_cvt_pk_bf16_f32 v108, 0, v108
  v_cvt_pk_bf16_f32 v109, 0, v109
  v_cvt_pk_bf16_f32 v110, 0, v110
  v_cvt_pk_bf16_f32 v111, 0, v111
  v_pk_mul_f32 v[108:109], v[108:109], v[192:193]
  v_pk_mul_f32 v[110:111], v[110:111], v[194:195]
  v_cvt_pk_bf16_f32 v216, v108, v109
  v_cvt_pk_bf16_f32 v217, v110, v111
  s_waitcnt vmcnt(14)
  buffer_load_dwordx4 v[16:19], v94, s[8:11], s60 offen offset:1792 nt
  v_cvt_f32_i32 v108, v44
  v_cvt_f32_i32 v109, v45
  v_cvt_f32_i32 v110, v46
  v_cvt_f32_i32 v111, v47
  v_pk_add_f32 v[108:109], v[108:109], v[208:209] neg_lo:[0,1] neg_hi:[0,1]
  v_pk_add_f32 v[110:111], v[110:111], v[210:211] neg_lo:[0,1] neg_hi:[0,1]
  v_mov_b32_dpp v144, v224 quad_perm:[0,0,0,0] row_mask:0xf bank_mask:0xf
  v_mov_b32_dpp v145, v226 quad_perm:[2,2,2,2] row_mask:0xf bank_mask:0xf
  v_cvt_pk_bf16_f32 v108, 0, v108
  v_cvt_pk_bf16_f32 v109, 0, v109
  v_add_f32_dpp v144, v225, v144 quad_perm:[1,1,1,1] row_mask:0xf bank_mask:0xf
  v_add_f32_dpp v145, v227, v145 quad_perm:[3,3,3,3] row_mask:0xf bank_mask:0xf
  v_cvt_pk_bf16_f32 v110, 0, v110
  v_cvt_pk_bf16_f32 v111, 0, v111
  v_add_f32 v228, v144, v145
  v_pk_mul_f32 v[108:109], v[108:109], v[196:197]
  v_pk_mul_f32 v[110:111], v[110:111], v[198:199]
  v_cvt_pk_bf16_f32 v218, v108, v109
  v_cvt_pk_bf16_f32 v219, v110, v111
  s_waitcnt vmcnt(14)
  buffer_load_dwordx4 v[20:23], v94, s[8:11], s60 offen offset:2048 nt
  v_mfma_f32_16x16x32_bf16 v[224:227], v[216:219], v[168:171], 0
  v_cvt_f32_i32 v108, v48
  v_cvt_f32_i32 v109, v49
  v_cvt_f32_i32 v110, v50
  v_cvt_f32_i32 v111, v51
  v_pk_add_f32 v[108:109], v[108:109], v[212:213] neg_lo:[0,1] neg_hi:[0,1]
  v_pk_add_f32 v[110:111], v[110:111], v[214:215] neg_lo:[0,1] neg_hi:[0,1]
  v_cvt_pk_bf16_f32 v108, 0, v108
  v_cvt_pk_bf16_f32 v109, 0, v109
  v_cvt_pk_bf16_f32 v110, 0, v110
  v_cvt_pk_bf16_f32 v111, 0, v111
  v_pk_mul_f32 v[108:109], v[108:109], v[200:201]
  v_pk_mul_f32 v[110:111], v[110:111], v[202:203]
  v_cvt_pk_bf16_f32 v220, v108, v109
  v_cvt_pk_bf16_f32 v221, v110, v111
  s_waitcnt vmcnt(14)
  s_cbranch_vccnz L_kw0_12
  s_waitcnt vmcnt(9)
L_kw0_12:
  buffer_load_dwordx4 v[24:27], v94, s[8:11], s60 offen offset:2304 nt
  v_mfma_f32_16x16x16_bf16 v[224:227], v[220:221], v[172:173], v[224:227]
  v_cvt_f32_i32 v108, v52
  v_cvt_f32_i32 v109, v53
  v_cvt_f32_i32 v110, v54
  v_cvt_f32_i32 v111, v55
  v_pk_add_f32 v[108:109], v[108:109], v[204:205] neg_lo:[0,1] neg_hi:[0,1]
  v_pk_add_f32 v[110:111], v[110:111], v[206:207] neg_lo:[0,1] neg_hi:[0,1]
  v_cvt_pk_bf16_f32 v108, 0, v108
  v_cvt_pk_bf16_f32 v109, 0, v109
  v_cvt_pk_bf16_f32 v110, 0, v110
  v_cvt_pk_bf16_f32 v111, 0, v111
  v_pk_mul_f32 v[108:109], v[108:109], v[192:193]
  v_pk_mul_f32 v[110:111], v[110:111], v[194:195]
  v_cvt_pk_bf16_f32 v216, v108, v109
  v_cvt_pk_bf16_f32 v217, v110, v111
  s_waitcnt vmcnt(14)
  buffer_load_dwordx4 v[28:31], v94, s[8:11], s60 offen offset:2560 nt
  v_cvt_f32_i32 v108, v56
  v_cvt_f32_i32 v109, v57
  v_cvt_f32_i32 v110, v58
  v_cvt_f32_i32 v111, v59
  v_pk_add_f32 v[108:109], v[108:109], v[208:209] neg_lo:[0,1] neg_hi:[0,1]
  v_pk_add_f32 v[110:111], v[110:111], v[210:211] neg_lo:[0,1] neg_hi:[0,1]
  v_mov_b32_dpp v144, v224 quad_perm:[0,0,0,0] row_mask:0xf bank_mask:0xf
  v_mov_b32_dpp v145, v226 quad_perm:[2,2,2,2] row_mask:0xf bank_mask:0xf
  v_cvt_pk_bf16_f32 v108, 0, v108
  v_cvt_pk_bf16_f32 v109, 0, v109
  v_add_f32_dpp v144, v225, v144 quad_perm:[1,1,1,1] row_mask:0xf bank_mask:0xf
  v_add_f32_dpp v145, v227, v145 quad_perm:[3,3,3,3] row_mask:0xf bank_mask:0xf
  v_cvt_pk_bf16_f32 v110, 0, v110
  v_cvt_pk_bf16_f32 v111, 0, v111
  v_add_f32 v229, v144, v145
  v_pk_mul_f32 v[108:109], v[108:109], v[196:197]
  v_pk_mul_f32 v[110:111], v[110:111], v[198:199]
  v_cvt_pk_bf16_f32 v218, v108, v109
  v_cvt_pk_bf16_f32 v219, v110, v111
  s_waitcnt vmcnt(14)
  buffer_load_dwordx4 v[32:35], v94, s[8:11], s60 offen offset:2816 nt
  v_mfma_f32_16x16x32_bf16 v[224:227], v[216:219], v[168:171], 0
  v_cvt_f32_i32 v108, v60
  v_cvt_f32_i32 v109, v61
  v_cvt_f32_i32 v110, v62
  v_cvt_f32_i32 v111, v63
  v_pk_add_f32 v[108:109], v[108:109], v[212:213] neg_lo:[0,1] neg_hi:[0,1]
  v_pk_add_f32 v[110:111], v[110:111], v[214:215] neg_lo:[0,1] neg_hi:[0,1]
  v_cvt_pk_bf16_f32 v108, 0, v108
  v_cvt_pk_bf16_f32 v228, 0, v228
  v_cvt_pk_bf16_f32 v109, 0, v109
  v_cvt_pk_bf16_f32 v229, 0, v229
  v_cvt_pk_bf16_f32 v110, 0, v110
  v_pk_mul_f32 v[228:229], v[228:229], s[68:69]
  v_cvt_pk_bf16_f32 v111, 0, v111
  v_cvt_pk_bf16_f32 v121, v228, v229
  v_pk_mul_f32 v[108:109], v[108:109], v[200:201]
  v_pk_mul_f32 v[110:111], v[110:111], v[202:203]
  v_cvt_pk_bf16_f32 v220, v108, v109
  v_cvt_pk_bf16_f32 v221, v110, v111
  s_waitcnt vmcnt(14)
  s_cbranch_vccnz L_kw0_15
  s_waitcnt vmcnt(9)
L_kw0_15:
  buffer_load_dwordx4 v[36:39], v95, s[8:11], s60 offen offset:0 nt
  v_mfma_f32_16x16x16_bf16 v[224:227], v[220:221], v[172:173], v[224:227]
  v_cvt_f32_i32 v108, v64
  v_cvt_f32_i32 v109, v65
  v_cvt_f32_i32 v110, v66
  v_cvt_f32_i32 v111, v67
  v_pk_add_f32 v[108:109], v[108:109], v[204:205] neg_lo:[0,1] neg_hi:[0,1]
  v_pk_add_f32 v[110:111], v[110:111], v[206:207] neg_lo:[0,1] neg_hi:[0,1]
  v_cvt_pk_bf16_f32 v108, 0, v108
  v_cvt_pk_bf16_f32 v109, 0, v109
  v_cvt_pk_bf16_f32 v110, 0, v110
  v_cvt_pk_bf16_f32 v111, 0, v111
  v_pk_mul_f32 v[108:109], v[108:109], v[192:193]
  v_pk_mul_f32 v[110:111], v[110:111], v[194:195]
  v_cvt_pk_bf16_f32 v216, v108, v109
  v_cvt_pk_bf16_f32 v217, v110, v111
  s_waitcnt vmcnt(14)
  buffer_load_dwordx4 v[40:43], v95, s[8:11], s60 offen offset:256 nt
  v_cvt_f32_i32 v108, v68
  v_cvt_f32_i32 v109, v69
  v_cvt_f32_i32 v110, v70
  v_cvt_f32_i32 v111, v71
  v_pk_add_f32 v[108:109], v[108:109], v[208:209] neg_lo:[0,1] neg_hi:[0,1]
  v_pk_add_f32 v[110:111], v[110:111], v[210:211] neg_lo:[0,1] neg_hi:[0,1]
  v_mov_b32_dpp v144, v224 quad_perm:[0,0,0,0] row_mask:0xf bank_mask:0xf
  v_mov_b32_dpp v145, v226 quad_perm:[2,2,2,2] row_mask:0xf bank_mask:0xf
  v_cvt_pk_bf16_f32 v108, 0, v108
  v_cvt_pk_bf16_f32 v109, 0, v109
  v_add_f32_dpp v144, v225, v144 quad_perm:[1,1,1,1] row_mask:0xf bank_mask:0xf
  v_add_f32_dpp v145, v227, v145 quad_perm:[3,3,3,3] row_mask:0xf bank_mask:0xf
  v_cvt_pk_bf16_f32 v110, 0, v110
  v_cvt_pk_bf16_f32 v111, 0, v111
  v_add_f32 v228, v144, v145
  v_pk_mul_f32 v[108:109], v[108:109], v[196:197]
  v_pk_mul_f32 v[110:111], v[110:111], v[198:199]
  v_cvt_pk_bf16_f32 v218, v108, v109
  v_cvt_pk_bf16_f32 v219, v110, v111
  s_waitcnt vmcnt(14)
  buffer_load_dwordx4 v[44:47], v95, s[8:11], s60 offen offset:512 nt
  v_mfma_f32_16x16x32_bf16 v[224:227], v[216:219], v[168:171], 0
  v_cvt_f32_i32 v108, v72
  v_cvt_f32_i32 v109, v73
  v_cvt_f32_i32 v110, v74
  v_cvt_f32_i32 v111, v75
  v_pk_add_f32 v[108:109], v[108:109], v[212:213] neg_lo:[0,1] neg_hi:[0,1]
  v_pk_add_f32 v[110:111], v[110:111], v[214:215] neg_lo:[0,1] neg_hi:[0,1]
  s_cmp_lt_u32 s64, s99
  s_cbranch_scc1 L_k_known0
L_k_spin0:
  v_mov_b32 v144, 61696
  ds_read_b32 v144, v144
  s_waitcnt lgkmcnt(0)
  v_readfirstlane_b32 s96, v144
  s_nop 1
  s_cmp_eq_u32 s96, 0
  s_cbranch_scc1 L_k_spin0
  s_mov_b32 s99, -1
L_k_known0:
  s_lshr_b32 s71, s64, 4
  s_andn2_b32 s71, s71, 1
  s_lshr_b32 s71, 0x12, s71
  s_and_b32 s71, s71, 3
  s_lshr_b32 s85, s96, s71
  s_andn2_b32 s70, s64, 1
  s_or_b32 s70, s70, s4
  s_cmp_lt_u32 s64, 8
  s_cselect_b32 s70, s70, s64
  s_cselect_b32 s85, s64, s85
  s_and_b32 s85, s85, 1
  s_and_b32 s70, s70, 31
  s_lshl_b32 s71, s71, 12
  s_add_u32 s70, s70, s5
  s_add_u32 s70, s70, s71
  s_mul_hi_u32 s84, s70, s90
  s_lshr_b32 s84, s84, 1
  s_mul_i32 s71, s84, 3
  s_sub_u32 s70, s70, s71
  s_lshl3_add_u32 s85, s70, s85
  s_mul_i32 s61, s84, 196608
  s_lshr_b32 s89, s84, 4
  s_lshl_b32 s70, s85, 5
  v_add_u32 v97, s70, v230
  v_mul_u32_u24 v97, 21846, v97
  v_lshrrev_b32 v97, 16, v97
  v_add_u32 v144, s85, v231
  v_lshrrev_b32 v145, v144, s91
  v_and_b32 v145, 1, v145
  v_cmp_eq_u32 s[54:55], 1, v145
  s_nop 1
  s_and_b64 s[52:53], s[54:55], s[56:57]
  s_andn2_b64 s[54:55], s[54:55], s[56:57]
  v_mul_u32_u24 v144, 43, v144
  v_lshrrev_b32 v144, 8, v144
  v_mul_u32_u24 v144, 384, v144
  v_add_u32 v234, v144, v233
  s_cmp_eq_u32 s89, s88
  s_cbranch_scc1 L_k_sameq0
  s_mul_i32 s70, s89, 1536
  buffer_load_dwordx2 v[174:175], v235, s[36:39], s70 offen offset:0
  buffer_load_dwordx2 v[176:177], v235, s[36:39], s70 offen offset:128
  buffer_load_dwordx2 v[178:179], v235, s[36:39], s70 offen offset:256
  s_mov_b32 s88, s89
L_k_sameq0:
  s_mul_i32 s62, s84, 1536
  buffer_load_dwordx2 v[180:181], v234, s[20:23], s62 offen offset:0
  buffer_load_dwordx2 v[186:187], v234, s[24:27], s62 offen offset:0
  buffer_load_dwordx2 v[182:183], v234, s[20:23], s62 offen offset:128
  buffer_load_dwordx2 v[188:189], v234, s[24:27], s62 offen offset:128
  buffer_load_dwordx2 v[184:185], v234, s[20:23], s62 offen offset:256
  buffer_load_dwordx2 v[190:191], v234, s[24:27], s62 offen offset:256
  v_cvt_pk_bf16_f32 v108, 0, v108
  v_cvt_pk_bf16_f32 v109, 0, v109
  v_cvt_pk_bf16_f32 v110, 0, v110
  v_cvt_pk_bf16_f32 v111, 0, v111
  v_pk_mul_f32 v[108:109], v[108:109], v[200:201]
  v_pk_mul_f32 v[110:111], v[110:111], v[202:203]
  v_cvt_pk_bf16_f32 v220, v108, v109
  v_cvt_pk_bf16_f32 v221, v110, v111
  v_mad_u32_u24 v92, v97, s63, v232
  v_add_u32 v93, 768, v92
  v_add_u32 v94, 4608, v92
  v_add_u32 v95, 7680, v92
  v_cndmask_b32 v92, v92, v105, s[52:53]
  v_cndmask_b32 v95, v95, v105, s[54:55]
  s_waitcnt vmcnt(20)
  s_cbranch_vccnz L_kw0_18
  s_waitcnt vmcnt(15)
L_kw0_18:
  buffer_load_dwordx4 v[48:51], v92, s[16:19], s61 offen offset:0 nt
  v_mfma_f32_16x16x16_bf16 v[224:227], v[220:221], v[172:173], v[224:227]
  v_cvt_f32_i32 v108, v76
  v_cvt_f32_i32 v109, v77
  v_cvt_f32_i32 v110, v78
  v_cvt_f32_i32 v111, v79
  v_pk_add_f32 v[108:109], v[108:109], v[204:205] neg_lo:[0,1] neg_hi:[0,1]
  v_pk_add_f32 v[110:111], v[110:111], v[206:207] neg_lo:[0,1] neg_hi:[0,1]
  v_cvt_pk_bf16_f32 v108, 0, v108
  v_cvt_pk_bf16_f32 v109, 0, v109
  v_cvt_pk_bf16_f32 v110, 0, v110
  v_cvt_pk_bf16_f32 v111, 0, v111
  v_pk_mul_f32 v[108:109], v[108:109], v[192:193]
  v_pk_mul_f32 v[110:111], v[110:111], v[194:195]
  v_cvt_pk_bf16_f32 v216, v108, v109
  v_cvt_pk_bf16_f32 v217, v110, v111
  s_waitcnt vmcnt(20)
  buffer_load_dwordx4 v[52:55], v92, s[16:19], s61 offen offset:256 nt
  v_cvt_f32_i32 v108, v80
  v_cvt_f32_i32 v109, v81
  v_cvt_f32_i32 v110, v82
  v_cvt_f32_i32 v111, v83
  v_pk_add_f32 v[108:109], v[108:109], v[208:209] neg_lo:[0,1] neg_hi:[0,1]
  v_pk_add_f32 v[110:111], v[110:111], v[210:211] neg_lo:[0,1] neg_hi:[0,1]
  v_mov_b32_dpp v144, v224 quad_perm:[0,0,0,0] row_mask:0xf bank_mask:0xf
  v_mov_b32_dpp v145, v226 quad_perm:[2,2,2,2] row_mask:0xf bank_mask:0xf
  v_cvt_pk_bf16_f32 v108, 0, v108
  v_cvt_pk_bf16_f32 v109, 0, v109
  v_add_f32_dpp v144, v225, v144 quad_perm:[1,1,1,1] row_mask:0xf bank_mask:0xf
  v_add_f32_dpp v145, v227, v145 quad_perm:[3,3,3,3] row_mask:0xf bank_mask:0xf
  v_cvt_pk_bf16_f32 v110, 0, v110
  v_cvt_pk_bf16_f32 v111, 0, v111
  v_add_f32 v229, v144, v145
  v_pk_mul_f32 v[108:109], v[108:109], v[196:197]
  v_pk_mul_f32 v[110:111], v[110:111], v[198:199]
  v_cvt_pk_bf16_f32 v218, v108, v109
  v_cvt_pk_bf16_f32 v219, v110, v111
  s_waitcnt vmcnt(20)
  buffer_load_dwordx4 v[56:59], v92, s[16:19], s61 offen offset:512 nt
  v_mfma_f32_16x16x32_bf16 v[224:227], v[216:219], v[168:171], 0
  v_cvt_f32_i32 v108, v84
  v_cvt_f32_i32 v109, v85
  v_cvt_f32_i32 v110, v86
  v_cvt_f32_i32 v111, v87
  v_pk_add_f32 v[108:109], v[108:109], v[212:213] neg_lo:[0,1] neg_hi:[0,1]
  v_pk_add_f32 v[110:111], v[110:111], v[214:215] neg_lo:[0,1] neg_hi:[0,1]
  v_cvt_pk_bf16_f32 v108, 0, v108
  v_cvt_pk_bf16_f32 v228, 0, v228
  v_cvt_pk_bf16_f32 v109, 0, v109
  v_cvt_pk_bf16_f32 v229, 0, v229
  v_cvt_pk_bf16_f32 v110, 0, v110
  v_pk_mul_f32 v[228:229], v[228:229], s[68:69]
  v_cvt_pk_bf16_f32 v111, 0, v111
  v_cvt_pk_bf16_f32 v122, v228, v229
  v_pk_mul_f32 v[108:109], v[108:109], v[200:201]
  v_pk_mul_f32 v[110:111], v[110:111], v[202:203]
  v_cvt_pk_bf16_f32 v220, v108, v109
  v_cvt_pk_bf16_f32 v221, v110, v111
  s_waitcnt vmcnt(20)
  s_cbranch_vccnz L_kw0_21
  s_waitcnt vmcnt(15)
L_kw0_21:
  buffer_load_dwordx4 v[60:63], v93, s[16:19], s61 offen offset:0 nt
  v_mfma_f32_16x16x16_bf16 v[224:227], v[220:221], v[172:173], v[224:227]
  v_cvt_f32_i32 v108, v88
  v_cvt_f32_i32 v109, v89
  v_cvt_f32_i32 v110, v90
  v_cvt_f32_i32 v111, v91
  v_pk_add_f32 v[108:109], v[108:109], v[204:205] neg_lo:[0,1] neg_hi:[0,1]
  v_pk_add_f32 v[110:111], v[110:111], v[206:207] neg_lo:[0,1] neg_hi:[0,1]
  v_cvt_pk_bf16_f32 v108, 0, v108
  v_cvt_pk_bf16_f32 v109, 0, v109
  v_cvt_pk_bf16_f32 v110, 0, v110
  v_cvt_pk_bf16_f32 v111, 0, v111
  v_pk_mul_f32 v[108:109], v[108:109], v[192:193]
  v_pk_mul_f32 v[110:111], v[110:111], v[194:195]
  v_cvt_pk_bf16_f32 v216, v108, v109
  v_cvt_pk_bf16_f32 v217, v110, v111
  s_waitcnt vmcnt(20)
  buffer_load_dwordx4 v[64:67], v93, s[16:19], s61 offen offset:256 nt
  v_cvt_f32_i32 v108, v4
  v_cvt_f32_i32 v109, v5
  v_cvt_f32_i32 v110, v6
  v_cvt_f32_i32 v111, v7
  v_pk_add_f32 v[108:109], v[108:109], v[208:209] neg_lo:[0,1] neg_hi:[0,1]
  v_pk_add_f32 v[110:111], v[110:111], v[210:211] neg_lo:[0,1] neg_hi:[0,1]
  v_mov_b32_dpp v144, v224 quad_perm:[0,0,0,0] row_mask:0xf bank_mask:0xf
  v_mov_b32_dpp v145, v226 quad_perm:[2,2,2,2] row_mask:0xf bank_mask:0xf
  v_cvt_pk_bf16_f32 v108, 0, v108
  v_cvt_pk_bf16_f32 v109, 0, v109
  v_add_f32_dpp v144, v225, v144 quad_perm:[1,1,1,1] row_mask:0xf bank_mask:0xf
  v_add_f32_dpp v145, v227, v145 quad_perm:[3,3,3,3] row_mask:0xf bank_mask:0xf
  v_cvt_pk_bf16_f32 v110, 0, v110
  v_cvt_pk_bf16_f32 v111, 0, v111
  v_add_f32 v228, v144, v145
  v_pk_mul_f32 v[108:109], v[108:109], v[196:197]
  v_pk_mul_f32 v[110:111], v[110:111], v[198:199]
  v_cvt_pk_bf16_f32 v218, v108, v109
  v_cvt_pk_bf16_f32 v219, v110, v111
  s_waitcnt vmcnt(20)
  buffer_load_dwordx4 v[68:71], v93, s[16:19], s61 offen offset:512 nt
  v_mfma_f32_16x16x32_bf16 v[224:227], v[216:219], v[168:171], 0
  v_cvt_f32_i32 v108, v8
  v_cvt_f32_i32 v109, v9
  v_cvt_f32_i32 v110, v10
  v_cvt_f32_i32 v111, v11
  v_pk_add_f32 v[108:109], v[108:109], v[212:213] neg_lo:[0,1] neg_hi:[0,1]
  v_pk_add_f32 v[110:111], v[110:111], v[214:215] neg_lo:[0,1] neg_hi:[0,1]
  v_cvt_pk_bf16_f32 v108, 0, v108
  v_cvt_pk_bf16_f32 v109, 0, v109
  v_cvt_pk_bf16_f32 v110, 0, v110
  v_cvt_pk_bf16_f32 v111, 0, v111
  v_pk_mul_f32 v[108:109], v[108:109], v[200:201]
  v_pk_mul_f32 v[110:111], v[110:111], v[202:203]
  v_cvt_pk_bf16_f32 v220, v108, v109
  v_cvt_pk_bf16_f32 v221, v110, v111
  s_waitcnt vmcnt(20)
  s_cbranch_vccnz L_kw0_24
  s_waitcnt vmcnt(15)
L_kw0_24:
  buffer_load_dwordx4 v[72:75], v93, s[16:19], s61 offen offset:768 nt
  v_mfma_f32_16x16x16_bf16 v[224:227], v[220:221], v[172:173], v[224:227]
  v_cvt_f32_i32 v108, v12
  v_cvt_f32_i32 v109, v13
  v_cvt_f32_i32 v110, v14
  v_cvt_f32_i32 v111, v15
  v_pk_add_f32 v[108:109], v[108:109], v[204:205] neg_lo:[0,1] neg_hi:[0,1]
  v_pk_add_f32 v[110:111], v[110:111], v[206:207] neg_lo:[0,1] neg_hi:[0,1]
  v_cvt_pk_bf16_f32 v108, 0, v108
  v_cvt_pk_bf16_f32 v109, 0, v109
  v_cvt_pk_bf16_f32 v110, 0, v110
  v_cvt_pk_bf16_f32 v111, 0, v111
  v_pk_mul_f32 v[108:109], v[108:109], v[192:193]
  v_pk_mul_f32 v[110:111], v[110:111], v[194:195]
  v_cvt_pk_bf16_f32 v216, v108, v109
  v_cvt_pk_bf16_f32 v217, v110, v111
  s_waitcnt vmcnt(20)
  buffer_load_dwordx4 v[76:79], v93, s[16:19], s61 offen offset:1024 nt
  v_cvt_f32_i32 v108, v16
  v_cvt_f32_i32 v109, v17
  v_cvt_f32_i32 v110, v18
  v_cvt_f32_i32 v111, v19
  v_pk_add_f32 v[108:109], v[108:109], v[208:209] neg_lo:[0,1] neg_hi:[0,1]
  v_pk_add_f32 v[110:111], v[110:111], v[210:211] neg_lo:[0,1] neg_hi:[0,1]
  v_mov_b32_dpp v144, v224 quad_perm:[0,0,0,0] row_mask:0xf bank_mask:0xf
  v_mov_b32_dpp v145, v226 quad_perm:[2,2,2,2] row_mask:0xf bank_mask:0xf
  v_cvt_pk_bf16_f32 v108, 0, v108
  v_cvt_pk_bf16_f32 v109, 0, v109
  v_add_f32_dpp v144, v225, v144 quad_perm:[1,1,1,1] row_mask:0xf bank_mask:0xf
  v_add_f32_dpp v145, v227, v145 quad_perm:[3,3,3,3] row_mask:0xf bank_mask:0xf
  v_cvt_pk_bf16_f32 v110, 0, v110
  v_cvt_pk_bf16_f32 v111, 0, v111
  v_add_f32 v229, v144, v145
  v_pk_mul_f32 v[108:109], v[108:109], v[196:197]
  v_pk_mul_f32 v[110:111], v[110:111], v[198:199]
  v_cvt_pk_bf16_f32 v218, v108, v109
  v_cvt_pk_bf16_f32 v219, v110, v111
  s_waitcnt vmcnt(20)
  buffer_load_dwordx4 v[80:83], v93, s[16:19], s61 offen offset:1280 nt
  v_mfma_f32_16x16x32_bf16 v[224:227], v[216:219], v[168:171], 0
  v_cvt_f32_i32 v108, v20
  v_cvt_f32_i32 v109, v21
  v_cvt_f32_i32 v110, v22
  v_cvt_f32_i32 v111, v23
  v_pk_add_f32 v[108:109], v[108:109], v[212:213] neg_lo:[0,1] neg_hi:[0,1]
  v_pk_add_f32 v[110:111], v[110:111], v[214:215] neg_lo:[0,1] neg_hi:[0,1]
  v_cvt_pk_bf16_f32 v108, 0, v108
  v_cvt_pk_bf16_f32 v228, 0, v228
  v_cvt_pk_bf16_f32 v109, 0, v109
  v_cvt_pk_bf16_f32 v229, 0, v229
  v_cvt_pk_bf16_f32 v110, 0, v110
  v_pk_mul_f32 v[228:229], v[228:229], s[68:69]
  v_cvt_pk_bf16_f32 v111, 0, v111
  v_cvt_pk_bf16_f32 v123, v228, v229
  v_pk_mul_f32 v[108:109], v[108:109], v[200:201]
  v_pk_mul_f32 v[110:111], v[110:111], v[202:203]
  v_cvt_pk_bf16_f32 v220, v108, v109
  v_cvt_pk_bf16_f32 v221, v110, v111
  s_waitcnt vmcnt(20)
  s_cbranch_vccnz L_kw0_27
  s_waitcnt vmcnt(15)
L_kw0_27:
  buffer_load_dwordx4 v[84:87], v93, s[16:19], s61 offen offset:1536 nt
  v_mfma_f32_16x16x16_bf16 v[224:227], v[220:221], v[172:173], v[224:227]
  v_cvt_f32_i32 v108, v24
  v_cvt_f32_i32 v109, v25
  v_cvt_f32_i32 v110, v26
  v_cvt_f32_i32 v111, v27
  v_pk_add_f32 v[108:109], v[108:109], v[204:205] neg_lo:[0,1] neg_hi:[0,1]
  v_pk_add_f32 v[110:111], v[110:111], v[206:207] neg_lo:[0,1] neg_hi:[0,1]
  v_cvt_pk_bf16_f32 v108, 0, v108
  v_cvt_pk_bf16_f32 v109, 0, v109
  v_cvt_pk_bf16_f32 v110, 0, v110
  v_cvt_pk_bf16_f32 v111, 0, v111
  v_pk_mul_f32 v[108:109], v[108:109], v[192:193]
  v_pk_mul_f32 v[110:111], v[110:111], v[194:195]
  v_cvt_pk_bf16_f32 v216, v108, v109
  v_cvt_pk_bf16_f32 v217, v110, v111
  s_waitcnt vmcnt(20)
  buffer_load_dwordx4 v[88:91], v93, s[16:19], s61 offen offset:1792 nt
  v_cvt_f32_i32 v108, v28
  v_cvt_f32_i32 v109, v29
  v_cvt_f32_i32 v110, v30
  v_cvt_f32_i32 v111, v31
  v_pk_add_f32 v[108:109], v[108:109], v[208:209] neg_lo:[0,1] neg_hi:[0,1]
  v_pk_add_f32 v[110:111], v[110:111], v[210:211] neg_lo:[0,1] neg_hi:[0,1]
  v_mov_b32_dpp v144, v224 quad_perm:[0,0,0,0] row_mask:0xf bank_mask:0xf
  v_mov_b32_dpp v145, v226 quad_perm:[2,2,2,2] row_mask:0xf bank_mask:0xf
  v_cvt_pk_bf16_f32 v108, 0, v108
  v_cvt_pk_bf16_f32 v109, 0, v109
  v_add_f32_dpp v144, v225, v144 quad_perm:[1,1,1,1] row_mask:0xf bank_mask:0xf
  v_add_f32_dpp v145, v227, v145 quad_perm:[3,3,3,3] row_mask:0xf bank_mask:0xf
  v_cvt_pk_bf16_f32 v110, 0, v110
  v_cvt_pk_bf16_f32 v111, 0, v111
  v_add_f32 v228, v144, v145
  v_pk_mul_f32 v[108:109], v[108:109], v[196:197]
  v_pk_mul_f32 v[110:111], v[110:111], v[198:199]
  v_cvt_pk_bf16_f32 v218, v108, v109
  v_cvt_pk_bf16_f32 v219, v110, v111
  s_waitcnt vmcnt(20)
  buffer_load_dwordx4 v[4:7], v93, s[16:19], s61 offen offset:2048 nt
  v_mfma_f32_16x16x32_bf16 v[224:227], v[216:219], v[168:171], 0
  v_cvt_f32_i32 v108, v32
  v_cvt_f32_i32 v109, v33
  v_cvt_f32_i32 v110, v34
  v_cvt_f32_i32 v111, v35
  v_pk_add_f32 v[108:109], v[108:109], v[212:213] neg_lo:[0,1] neg_hi:[0,1]
  v_pk_add_f32 v[110:111], v[110:111], v[214:215] neg_lo:[0,1] neg_hi:[0,1]
  v_cvt_pk_bf16_f32 v108, 0, v108
  v_cvt_pk_bf16_f32 v109, 0, v109
  v_cvt_pk_bf16_f32 v110, 0, v110
  v_cvt_pk_bf16_f32 v111, 0, v111
  v_pk_mul_f32 v[108:109], v[108:109], v[200:201]
  v_pk_mul_f32 v[110:111], v[110:111], v[202:203]
  v_cvt_pk_bf16_f32 v220, v108, v109
  v_cvt_pk_bf16_f32 v221, v110, v111
  s_waitcnt vmcnt(20)
  s_cbranch_vccnz L_kw0_30
  s_waitcnt vmcnt(9)
L_kw0_30:
  buffer_load_dwordx4 v[8:11], v93, s[16:19], s61 offen offset:2304 nt
  v_mfma_f32_16x16x16_bf16 v[224:227], v[220:221], v[172:173], v[224:227]
  v_cvt_f32_i32 v108, v36
  v_cvt_f32_i32 v109, v37
  v_cvt_f32_i32 v110, v38
  v_cvt_f32_i32 v111, v39
  v_pk_add_f32 v[108:109], v[108:109], v[204:205] neg_lo:[0,1] neg_hi:[0,1]
  v_pk_add_f32 v[110:111], v[110:111], v[206:207] neg_lo:[0,1] neg_hi:[0,1]
  v_cvt_pk_bf16_f32 v108, 0, v108
  v_cvt_pk_bf16_f32 v109, 0, v109
  v_cvt_pk_bf16_f32 v110, 0, v110
  v_cvt_pk_bf16_f32 v111, 0, v111
  v_pk_mul_f32 v[108:109], v[108:109], v[192:193]
  v_pk_mul_f32 v[110:111], v[110:111], v[194:195]
  v_cvt_pk_bf16_f32 v216, v108, v109
  v_cvt_pk_bf16_f32 v217, v110, v111
  s_waitcnt vmcnt(20)
  buffer_load_dwordx4 v[12:15], v93, s[16:19], s61 offen offset:2560 nt
  v_cvt_f32_i32 v108, v40
  v_cvt_f32_i32 v109, v41
  v_cvt_f32_i32 v110, v42
  v_cvt_f32_i32 v111, v43
  v_pk_add_f32 v[108:109], v[108:109], v[208:209] neg_lo:[0,1] neg_hi:[0,1]
  v_pk_add_f32 v[110:111], v[110:111], v[210:211] neg_lo:[0,1] neg_hi:[0,1]
  v_mov_b32_dpp v144, v224 quad_perm:[0,0,0,0] row_mask:0xf bank_mask:0xf
  v_mov_b32_dpp v145, v226 quad_perm:[2,2,2,2] row_mask:0xf bank_mask:0xf
  v_cvt_pk_bf16_f32 v108, 0, v108
  v_cvt_pk_bf16_f32 v109, 0, v109
  v_add_f32_dpp v144, v225, v144 quad_perm:[1,1,1,1] row_mask:0xf bank_mask:0xf
  v_add_f32_dpp v145, v227, v145 quad_perm:[3,3,3,3] row_mask:0xf bank_mask:0xf
  v_cvt_pk_bf16_f32 v110, 0, v110
  v_cvt_pk_bf16_f32 v111, 0, v111
  v_add_f32 v229, v144, v145
  v_pk_mul_f32 v[108:109], v[108:109], v[196:197]
  v_pk_mul_f32 v[110:111], v[110:111], v[198:199]
  v_cvt_pk_bf16_f32 v218, v108, v109
  v_cvt_pk_bf16_f32 v219, v110, v111
  s_waitcnt vmcnt(20)
  buffer_load_dwordx4 v[16:19], v93, s[16:19], s61 offen offset:2816 nt
  v_mfma_f32_16x16x32_bf16 v[224:227], v[216:219], v[168:171], 0
  v_cvt_f32_i32 v108, v44
  v_cvt_f32_i32 v109, v45
  v_cvt_f32_i32 v110, v46
  v_cvt_f32_i32 v111, v47
  v_pk_add_f32 v[108:109], v[108:109], v[212:213] neg_lo:[0,1] neg_hi:[0,1]
  v_pk_add_f32 v[110:111], v[110:111], v[214:215] neg_lo:[0,1] neg_hi:[0,1]
  v_cvt_pk_bf16_f32 v108, 0, v108
  v_cvt_pk_bf16_f32 v228, 0, v228
  v_cvt_pk_bf16_f32 v109, 0, v109
  v_cvt_pk_bf16_f32 v229, 0, v229
  v_cvt_pk_bf16_f32 v110, 0, v110
  v_pk_mul_f32 v[228:229], v[228:229], s[68:69]
  v_cvt_pk_bf16_f32 v111, 0, v111
  v_cvt_pk_bf16_f32 v124, v228, v229
  v_pk_mul_f32 v[108:109], v[108:109], v[200:201]
  v_pk_mul_f32 v[110:111], v[110:111], v[202:203]
  v_cvt_pk_bf16_f32 v220, v108, v109
  v_cvt_pk_bf16_f32 v221, v110, v111
  s_mov_b32 s60, s61
  v_mov_b32 v146, s64
  v_mfma_f32_16x16x16_bf16 v[224:227], v[220:221], v[172:173], v[224:227]
  ds_write_b128 v99, v[120:123]
  v_add_u32 v99, 768, v99
  s_nop 5
  v_mov_b32_dpp v144, v224 quad_perm:[0,0,0,0] row_mask:0xf bank_mask:0xf
  v_mov_b32_dpp v145, v226 quad_perm:[2,2,2,2] row_mask:0xf bank_mask:0xf
  s_nop 0
  v_add_f32_dpp v144, v225, v144 quad_perm:[1,1,1,1] row_mask:0xf bank_mask:0xf
  v_add_f32_dpp v145, v227, v145 quad_perm:[3,3,3,3] row_mask:0xf bank_mask:0xf
  v_add_f32 v228, v144, v145
  v_cndmask_b32 v228, v228, v236, s[50:51]
  v_cvt_pk_bf16_f32 v228, 0, v228
  v_cvt_pk_bf16_f32 v229, 0, v229
  v_pk_mul_f32 v[228:229], v[228:229], s[68:69]
  v_cvt_pk_bf16_f32 v125, v228, v229
  ds_write_b64 v100, v[124:125] offset:256
  ds_write_b32 v104, v146
  v_add_u32 v100, 768, v100
  v_add_u32 v144, s85, v2
  v_lshrrev_b32 v145, v144, s91
  v_and_b32 v145, 1, v145
  v_cmp_eq_u32 s[50:51], 1, v145
  s_nop 1
  s_and_b64 s[48:49], s[50:51], s[58:59]
  s_andn2_b64 s[50:51], s[50:51], s[58:59]
  s_mov_b32 s97, s64
  s_add_u32 s64, s64, 2
  ds_read_b32 v106, v104 offset:8
  s_waitcnt vmcnt(14)
  s_cbranch_vccnz L_kw1_0
  s_waitcnt vmcnt(9)
L_kw1_0:
  buffer_load_dwordx4 v[20:23], v93, s[8:11], s60 offen offset:3072 nt
  v_lshlrev_b32 v204, 16, v186
  v_and_b32 v205, s65, v186
  v_lshlrev_b32 v206, 16, v187
  v_and_b32 v207, s65, v187
  v_lshlrev_b32 v192, 16, v180
  v_and_b32 v193, s65, v180
  v_lshlrev_b32 v194, 16, v181
  v_and_b32 v195, s65, v181
  v_mov_b32 v168, v174
  v_mov_b32 v169, v175
  v_cvt_f32_i32 v108, v48
  v_cvt_f32_i32 v109, v49
  v_cvt_f32_i32 v110, v50
  v_cvt_f32_i32 v111, v51
  v_pk_add_f32 v[108:109], v[108:109], v[204:205] neg_lo:[0,1] neg_hi:[0,1]
  v_pk_add_f32 v[110:111], v[110:111], v[206:207] neg_lo:[0,1] neg_hi:[0,1]
  v_cvt_pk_bf16_f32 v108, 0, v108
  v_cvt_pk_bf16_f32 v109, 0, v109
  v_cvt_pk_bf16_f32 v110, 0, v110
  v_cvt_pk_bf16_f32 v111, 0, v111
  v_pk_mul_f32 v[108:109], v[108:109], v[192:193]
  v_pk_mul_f32 v[110:111], v[110:111], v[194:195]
  v_cvt_pk_bf16_f32 v216, v108, v109
  v_cvt_pk_bf16_f32 v217, v110, v111
  s_waitcnt lgkmcnt(0)
  v_cmp_lt_u32 vcc, s97, v106
  s_waitcnt vmcnt(14)
  buffer_load_dwordx4 v[24:27], v93, s[8:11], s60 offen offset:3328 nt
  v_lshlrev_b32 v208, 16, v188
  v_and_b32 v209, s65, v188
  v_lshlrev_b32 v210, 16, v189
  v_and_b32 v211, s65, v189
  v_lshlrev_b32 v196, 16, v182
  v_and_b32 v197, s65, v182
  v_lshlrev_b32 v198, 16, v183
  v_and_b32 v199, s65, v183
  v_mov_b32 v170, v176
  v_mov_b32 v171, v177
  v_cvt_f32_i32 v108, v52
  v_cvt_f32_i32 v109, v53
  v_cvt_f32_i32 v110, v54
  v_cvt_f32_i32 v111, v55
  v_pk_add_f32 v[108:109], v[108:109], v[208:209] neg_lo:[0,1] neg_hi:[0,1]
  v_pk_add_f32 v[110:111], v[110:111], v[210:211] neg_lo:[0,1] neg_hi:[0,1]
  v_cvt_pk_bf16_f32 v108, 0, v108
  v_cvt_pk_bf16_f32 v109, 0, v109
  v_cvt_pk_bf16_f32 v110, 0, v110
  v_cvt_pk_bf16_f32 v111, 0, v111
  v_pk_mul_f32 v[108:109], v[108:109], v[196:197]
  v_pk_mul_f32 v[110:111], v[110:111], v[198:199]
  v_cvt_pk_bf16_f32 v218, v108, v109
  v_cvt_pk_bf16_f32 v219, v110, v111
  s_waitcnt vmcnt(14)
  buffer_load_dwordx4 v[28:31], v93, s[8:11], s60 offen offset:3584 nt
  v_mfma_f32_16x16x32_bf16 v[224:227], v[216:219], v[168:171], 0
  v_lshlrev_b32 v212, 16, v190
  v_and_b32 v213, s65, v190
  v_lshlrev_b32 v214, 16, v191
  v_and_b32 v215, s65, v191
  v_lshlrev_b32 v200, 16, v184
  v_and_b32 v201, s65, v184
  v_lshlrev_b32 v202, 16, v185
  v_and_b32 v203, s65, v185
  v_mov_b32 v172, v178
  v_mov_b32 v173, v179
  v_cvt_f32_i32 v108, v56
  v_cvt_f32_i32 v109, v57
  v_cvt_f32_i32 v110, v58
  v_cvt_f32_i32 v111, v59
  v_pk_add_f32 v[108:109], v[108:109], v[212:213] neg_lo:[0,1] neg_hi:[0,1]
  v_pk_add_f32 v[110:111], v[110:111], v[214:215] neg_lo:[0,1] neg_hi:[0,1]
  v_cvt_pk_bf16_f32 v108, 0, v108
  v_cvt_pk_bf16_f32 v109, 0, v109
  v_cvt_pk_bf16_f32 v110, 0, v110
  v_cvt_pk_bf16_f32 v111, 0, v111
  v_pk_mul_f32 v[108:109], v[108:109], v[200:201]
  v_pk_mul_f32 v[110:111], v[110:111], v[202:203]
  v_cvt_pk_bf16_f32 v220, v108, v109
  v_cvt_pk_bf16_f32 v221, v110, v111
  s_waitcnt vmcnt(14)
  s_cbranch_vccnz L_kw1_3
  s_waitcnt vmcnt(9)
L_kw1_3:
  buffer_load_dwordx4 v[32:35], v94, s[8:11], s60 offen offset:0 nt
  v_mfma_f32_16x16x16_bf16 v[224:227], v[220:221], v[172:173], v[224:227]
  v_cvt_f32_i32 v108, v60
  v_cvt_f32_i32 v109, v61
  v_cvt_f32_i32 v110, v62
  v_cvt_f32_i32 v111, v63
  v_pk_add_f32 v[108:109], v[108:109], v[204:205] neg_lo:[0,1] neg_hi:[0,1]
  v_pk_add_f32 v[110:111], v[110:111], v[206:207] neg_lo:[0,1] neg_hi:[0,1]
  v_cvt_pk_bf16_f32 v108, 0, v108
  v_cvt_pk_bf16_f32 v109, 0, v109
  v_cvt_pk_bf16_f32 v110, 0, v110
  v_cvt_pk_bf16_f32 v111, 0, v111
  v_pk_mul_f32 v[108:109], v[108:109], v[192:193]
  v_pk_mul_f32 v[110:111], v[110:111], v[194:195]
  v_cvt_pk_bf16_f32 v216, v108, v109
  v_cvt_pk_bf16_f32 v217, v110, v111
  s_waitcnt vmcnt(14)
  buffer_load_dwordx4 v[36:39], v94, s[8:11], s60 offen offset:256 nt
  v_cvt_f32_i32 v108, v64
  v_cvt_f32_i32 v109, v65
  v_cvt_f32_i32 v110, v66
  v_cvt_f32_i32 v111, v67
  v_pk_add_f32 v[108:109], v[108:109], v[208:209] neg_lo:[0,1] neg_hi:[0,1]
  v_pk_add_f32 v[110:111], v[110:111], v[210:211] neg_lo:[0,1] neg_hi:[0,1]
  v_mov_b32_dpp v144, v224 quad_perm:[0,0,0,0] row_mask:0xf bank_mask:0xf
  v_mov_b32_dpp v145, v226 quad_perm:[2,2,2,2] row_mask:0xf bank_mask:0xf
  v_cvt_pk_bf16_f32 v108, 0, v108
  v_cvt_pk_bf16_f32 v109, 0, v109
  v_add_f32_dpp v144, v225, v144 quad_perm:[1,1,1,1] row_mask:0xf bank_mask:0xf
  v_add_f32_dpp v145, v227, v145 quad_perm:[3,3,3,3] row_mask:0xf bank_mask:0xf
  v_cvt_pk_bf16_f32 v110, 0, v110
  v_cvt_pk_bf16_f32 v111, 0, v111
  v_add_f32 v228, v144, v145
  v_pk_mul_f32 v[108:109], v[108:109], v[196:197]
  v_pk_mul_f32 v[110:111], v[110:111], v[198:199]
  v_cvt_pk_bf16_f32 v218, v108, v109
  v_cvt_pk_bf16_f32 v219, v110, v111
  s_waitcnt vmcnt(14)
  buffer_load_dwordx4 v[40:43], v94, s[8:11], s60 offen offset:512 nt
  v_mfma_f32_16x16x32_bf16 v[224:227], v[216:219], v[168:171], 0
  v_cvt_f32_i32 v108, v68
  v_cvt_f32_i32 v109, v69
  v_cvt_f32_i32 v110, v70
  v_cvt_f32_i32 v111, v71
  v_pk_add_f32 v[108:109], v[108:109], v[212:213] neg_lo:[0,1] neg_hi:[0,1]
  v_pk_add_f32 v[110:111], v[110:111], v[214:215] neg_lo:[0,1] neg_hi:[0,1]
  v_cvt_pk_bf16_f32 v108, 0, v108
  v_cndmask_b32 v228, v228, v236, s[48:49]
  v_cvt_pk_bf16_f32 v109, 0, v109
  v_cvt_pk_bf16_f32 v110, 0, v110
  v_cvt_pk_bf16_f32 v111, 0, v111
  v_pk_mul_f32 v[108:109], v[108:109], v[200:201]
  v_pk_mul_f32 v[110:111], v[110:111], v[202:203]
  v_cvt_pk_bf16_f32 v220, v108, v109
  v_cvt_pk_bf16_f32 v221, v110, v111
  s_waitcnt vmcnt(14)
  s_cbranch_vccnz L_kw1_6
  s_waitcnt vmcnt(9)
L_kw1_6:
  buffer_load_dwordx4 v[44:47], v94, s[8:11], s60 offen offset:768 nt
  v_mfma_f32_16x16x16_bf16 v[224:227], v[220:221], v[172:173], v[224:227]
  v_cvt_f32_i32 v108, v72
  v_cvt_f32_i32 v109, v73
  v_cvt_f32_i32 v110, v74
  v_cvt_f32_i32 v111, v75
  v_pk_add_f32 v[108:109], v[108:109], v[204:205] neg_lo:[0,1] neg_hi:[0,1]
  v_pk_add_f32 v[110:111], v[110:111], v[206:207] neg_lo:[0,1] neg_hi:[0,1]
  v_cvt_pk_bf16_f32 v108, 0, v108
  v_cvt_pk_bf16_f32 v109, 0, v109
  v_cvt_pk_bf16_f32 v110, 0, v110
  v_cvt_pk_bf16_f32 v111, 0, v111
  v_pk_mul_f32 v[108:109], v[108:109], v[192:193]
  v_pk_mul_f32 v[110:111], v[110:111], v[194:195]
  v_cvt_pk_bf16_f32 v216, v108, v109
  v_cvt_pk_bf16_f32 v217, v110, v111
  s_waitcnt vmcnt(14)
  buffer_load_dwordx4 v[48:51], v94, s[8:11], s60 offen offset:1024 nt
  v_cvt_f32_i32 v108, v76
  v_cvt_f32_i32 v109, v77
  v_cvt_f32_i32 v110, v78
  v_cvt_f32_i32 v111, v79
  v_pk_add_f32 v[108:109], v[108:109], v[208:209] neg_lo:[0,1] neg_hi:[0,1]
  v_pk_add_f32 v[110:111], v[110:111], v[210:211] neg_lo:[0,1] neg_hi:[0,1]
  v_mov_b32_dpp v144, v224 quad_perm:[0,0,0,0] row_mask:0xf bank_mask:0xf
  v_mov_b32_dpp v145, v226 quad_perm:[2,2,2,2] row_mask:0xf bank_mask:0xf
  v_cvt_pk_bf16_f32 v108, 0, v108
  v_cvt_pk_bf16_f32 v109, 0, v109
  v_add_f32_dpp v144, v225, v144 quad_perm:[1,1,1,1] row_mask:0xf bank_mask:0xf
  v_add_f32_dpp v145, v227, v145 quad_perm:[3,3,3,3] row_mask:0xf bank_mask:0xf
  v_cvt_pk_bf16_f32 v110, 0, v110
  v_cvt_pk_bf16_f32 v111, 0, v111
  v_add_f32 v229, v144, v145
  v_pk_mul_f32 v[108:109], v[108:109], v[196:197]
  v_pk_mul_f32 v[110:111], v[110:111], v[198:199]
  v_cvt_pk_bf16_f32 v218, v108, v109
  v_cvt_pk_bf16_f32 v219, v110, v111
  s_waitcnt vmcnt(14)
  buffer_load_dwordx4 v[52:55], v94, s[8:11], s60 offen offset:1280 nt
  v_mfma_f32_16x16x32_bf16 v[224:227], v[216:219], v[168:171], 0
  v_cvt_f32_i32 v108, v80
  v_cvt_f32_i32 v109, v81
  v_cvt_f32_i32 v110, v82
  v_cvt_f32_i32 v111, v83
  v_pk_add_f32 v[108:109], v[108:109], v[212:213] neg_lo:[0,1] neg_hi:[0,1]
  v_pk_add_f32 v[110:111], v[110:111], v[214:215] neg_lo:[0,1] neg_hi:[0,1]
  v_cvt_pk_bf16_f32 v108, 0, v108
  v_cvt_pk_bf16_f32 v228, 0, v228
  v_cvt_pk_bf16_f32 v109, 0, v109
  v_cvt_pk_bf16_f32 v229, 0, v229
  v_cvt_pk_bf16_f32 v110, 0, v110
  v_pk_mul_f32 v[228:229], v[228:229], s[68:69]
  v_cvt_pk_bf16_f32 v111, 0, v111
  v_cvt_pk_bf16_f32 v120, v228, v229
  v_pk_mul_f32 v[108:109], v[108:109], v[200:201]
  v_pk_mul_f32 v[110:111], v[110:111], v[202:203]
  v_cvt_pk_bf16_f32 v220, v108, v109
  v_cvt_pk_bf16_f32 v221, v110, v111
  s_waitcnt vmcnt(14)
  s_cbranch_vccnz L_kw1_9
  s_waitcnt vmcnt(9)
L_kw1_9:
  buffer_load_dwordx4 v[56:59], v94, s[8:11], s60 offen offset:1536 nt
  v_mfma_f32_16x16x16_bf16 v[224:227], v[220:221], v[172:173], v[224:227]
  v_cvt_f32_i32 v108, v84
  v_cvt_f32_i32 v109, v85
  v_cvt_f32_i32 v110, v86
  v_cvt_f32_i32 v111, v87
  v_pk_add_f32 v[108:109], v[108:109], v[204:205] neg_lo:[0,1] neg_hi:[0,1]
  v_pk_add_f32 v[110:111], v[110:111], v[206:207] neg_lo:[0,1] neg_hi:[0,1]
  v_cvt_pk_bf16_f32 v108, 0, v108
  v_cvt_pk_bf16_f32 v109, 0, v109
  v_cvt_pk_bf16_f32 v110, 0, v110
  v_cvt_pk_bf16_f32 v111, 0, v111
  v_pk_mul_f32 v[108:109], v[108:109], v[192:193]
  v_pk_mul_f32 v[110:111], v[110:111], v[194:195]
  v_cvt_pk_bf16_f32 v216, v108, v109
  v_cvt_pk_bf16_f32 v217, v110, v111
  s_waitcnt vmcnt(14)
  buffer_load_dwordx4 v[60:63], v94, s[8:11], s60 offen offset:1792 nt
  v_cvt_f32_i32 v108, v88
  v_cvt_f32_i32 v109, v89
  v_cvt_f32_i32 v110, v90
  v_cvt_f32_i32 v111, v91
  v_pk_add_f32 v[108:109], v[108:109], v[208:209] neg_lo:[0,1] neg_hi:[0,1]
  v_pk_add_f32 v[110:111], v[110:111], v[210:211] neg_lo:[0,1] neg_hi:[0,1]
  v_mov_b32_dpp v144, v224 quad_perm:[0,0,0,0] row_mask:0xf bank_mask:0xf
  v_mov_b32_dpp v145, v226 quad_perm:[2,2,2,2] row_mask:0xf bank_mask:0xf
  v_cvt_pk_bf16_f32 v108, 0, v108
  v_cvt_pk_bf16_f32 v109, 0, v109
  v_add_f32_dpp v144, v225, v144 quad_perm:[1,1,1,1] row_mask:0xf bank_mask:0xf
  v_add_f32_dpp v145, v227, v145 quad_perm:[3,3,3,3] row_mask:0xf bank_mask:0xf
  v_cvt_pk_bf16_f32 v110, 0, v110
  v_cvt_pk_bf16_f32 v111, 0, v111
  v_add_f32 v228, v144, v145
  v_pk_mul_f32 v[108:109], v[108:109], v[196:197]
  v_pk_mul_f32 v[110:111], v[110:111], v[198:199]
  v_cvt_pk_bf16_f32 v218, v108, v109
  v_cvt_pk_bf16_f32 v219, v110, v111
  s_waitcnt vmcnt(14)
  buffer_load_dwordx4 v[64:67], v94, s[8:11], s60 offen offset:2048 nt
  v_mfma_f32_16x16x32_bf16 v[224:227], v[216:219], v[168:171], 0
  v_cvt_f32_i32 v108, v4
  v_cvt_f32_i32 v109, v5
  v_cvt_f32_i32 v110, v6
  v_cvt_f32_i32 v111, v7
  v_pk_add_f32 v[108:109], v[108:109], v[212:213] neg_lo:[0,1] neg_hi:[0,1]
  v_pk_add_f32 v[110:111], v[110:111], v[214:215] neg_lo:[0,1] neg_hi:[0,1]
  v_cvt_pk_bf16_f32 v108, 0, v108
  v_cvt_pk_bf16_f32 v109, 0, v109
  v_cvt_pk_bf16_f32 v110, 0, v110
  v_cvt_pk_bf16_f32 v111, 0, v111
  v_pk_mul_f32 v[108:109], v[108:109], v[200:201]
  v_pk_mul_f32 v[110:111], v[110:111], v[202:203]
  v_cvt_pk_bf16_f32 v220, v108, v109
  v_cvt_pk_bf16_f32 v221, v110, v111
  s_waitcnt vmcnt(14)
  s_cbranch_vccnz L_kw1_12
  s_waitcnt vmcnt(9)
L_kw1_12:
  buffer_load_dwordx4 v[68:71], v94, s[8:11], s60 offen offset:2304 nt
  v_mfma_f32_16x16x16_bf16 v[224:227], v[220:221], v[172:173], v[224:227]
  v_cvt_f32_i32 v108, v8
  v_cvt_f32_i32 v109, v9
  v_cvt_f32_i32 v110, v10
  v_cvt_f32_i32 v111, v11
  v_pk_add_f32 v[108:109], v[108:109], v[204:205] neg_lo:[0,1] neg_hi:[0,1]
  v_pk_add_f32 v[110:111], v[110:111], v[206:207] neg_lo:[0,1] neg_hi:[0,1]
  v_cvt_pk_bf16_f32 v108, 0, v108
  v_cvt_pk_bf16_f32 v109, 0, v109
  v_cvt_pk_bf16_f32 v110, 0, v110
  v_cvt_pk_bf16_f32 v111, 0, v111
  v_pk_mul_f32 v[108:109], v[108:109], v[192:193]
  v_pk_mul_f32 v[110:111], v[110:111], v[194:195]
  v_cvt_pk_bf16_f32 v216, v108, v109
  v_cvt_pk_bf16_f32 v217, v110, v111
  s_waitcnt vmcnt(14)
  buffer_load_dwordx4 v[72:75], v94, s[8:11], s60 offen offset:2560 nt
  v_cvt_f32_i32 v108, v12
  v_cvt_f32_i32 v109, v13
  v_cvt_f32_i32 v110, v14
  v_cvt_f32_i32 v111, v15
  v_pk_add_f32 v[108:109], v[108:109], v[208:209] neg_lo:[0,1] neg_hi:[0,1]
  v_pk_add_f32 v[110:111], v[110:111], v[210:211] neg_lo:[0,1] neg_hi:[0,1]
  v_mov_b32_dpp v144, v224 quad_perm:[0,0,0,0] row_mask:0xf bank_mask:0xf
  v_mov_b32_dpp v145, v226 quad_perm:[2,2,2,2] row_mask:0xf bank_mask:0xf
  v_cvt_pk_bf16_f32 v108, 0, v108
  v_cvt_pk_bf16_f32 v109, 0, v109
  v_add_f32_dpp v144, v225, v144 quad_perm:[1,1,1,1] row_mask:0xf bank_mask:0xf
  v_add_f32_dpp v145, v227, v145 quad_perm:[3,3,3,3] row_mask:0xf bank_mask:0xf
  v_cvt_pk_bf16_f32 v110, 0, v110
  v_cvt_pk_bf16_f32 v111, 0, v111
  v_add_f32 v229, v144, v145
  v_pk_mul_f32 v[108:109], v[108:109], v[196:197]
  v_pk_mul_f32 v[110:111], v[110:111], v[198:199]
  v_cvt_pk_bf16_f32 v218, v108, v109
  v_cvt_pk_bf16_f32 v219, v110, v111
  s_waitcnt vmcnt(14)
  buffer_load_dwordx4 v[76:79], v94, s[8:11], s60 offen offset:2816 nt
  v_mfma_f32_16x16x32_bf16 v[224:227], v[216:219], v[168:171], 0
  v_cvt_f32_i32 v108, v16
  v_cvt_f32_i32 v109, v17
  v_cvt_f32_i32 v110, v18
  v_cvt_f32_i32 v111, v19
  v_pk_add_f32 v[108:109], v[108:109], v[212:213] neg_lo:[0,1] neg_hi:[0,1]
  v_pk_add_f32 v[110:111], v[110:111], v[214:215] neg_lo:[0,1] neg_hi:[0,1]
  v_cvt_pk_bf16_f32 v108, 0, v108
  v_cvt_pk_bf16_f32 v228, 0, v228
  v_cvt_pk_bf16_f32 v109, 0, v109
  v_cvt_pk_bf16_f32 v229, 0, v229
  v_cvt_pk_bf16_f32 v110, 0, v110
  v_pk_mul_f32 v[228:229], v[228:229], s[68:69]
  v_cvt_pk_bf16_f32 v111, 0, v111
  v_cvt_pk_bf16_f32 v121, v228, v229
  v_pk_mul_f32 v[108:109], v[108:109], v[200:201]
  v_pk_mul_f32 v[110:111], v[110:111], v[202:203]
  v_cvt_pk_bf16_f32 v220, v108, v109
  v_cvt_pk_bf16_f32 v221, v110, v111
  s_waitcnt vmcnt(14)
  s_cbranch_vccnz L_kw1_15
  s_waitcnt vmcnt(9)
L_kw1_15:
  buffer_load_dwordx4 v[80:83], v95, s[8:11], s60 offen offset:0 nt
  v_mfma_f32_16x16x16_bf16 v[224:227], v[220:221], v[172:173], v[224:227]
  v_cvt_f32_i32 v108, v20
  v_cvt_f32_i32 v109, v21
  v_cvt_f32_i32 v110, v22
  v_cvt_f32_i32 v111, v23
  v_pk_add_f32 v[108:109], v[108:109], v[204:205] neg_lo:[0,1] neg_hi:[0,1]
  v_pk_add_f32 v[110:111], v[110:111], v[206:207] neg_lo:[0,1] neg_hi:[0,1]
  v_cvt_pk_bf16_f32 v108, 0, v108
  v_cvt_pk_bf16_f32 v109, 0, v109
  v_cvt_pk_bf16_f32 v110, 0, v110
  v_cvt_pk_bf16_f32 v111, 0, v111
  v_pk_mul_f32 v[108:109], v[108:109], v[192:193]
  v_pk_mul_f32 v[110:111], v[110:111], v[194:195]
  v_cvt_pk_bf16_f32 v216, v108, v109
  v_cvt_pk_bf16_f32 v217, v110, v111
  s_waitcnt vmcnt(14)
  buffer_load_dwordx4 v[84:87], v95, s[8:11], s60 offen offset:256 nt
  v_cvt_f32_i32 v108, v24
  v_cvt_f32_i32 v109, v25
  v_cvt_f32_i32 v110, v26
  v_cvt_f32_i32 v111, v27
  v_pk_add_f32 v[108:109], v[108:109], v[208:209] neg_lo:[0,1] neg_hi:[0,1]
  v_pk_add_f32 v[110:111], v[110:111], v[210:211] neg_lo:[0,1] neg_hi:[0,1]
  v_mov_b32_dpp v144, v224 quad_perm:[0,0,0,0] row_mask:0xf bank_mask:0xf
  v_mov_b32_dpp v145, v226 quad_perm:[2,2,2,2] row_mask:0xf bank_mask:0xf
  v_cvt_pk_bf16_f32 v108, 0, v108
  v_cvt_pk_bf16_f32 v109, 0, v109
  v_add_f32_dpp v144, v225, v144 quad_perm:[1,1,1,1] row_mask:0xf bank_mask:0xf
  v_add_f32_dpp v145, v227, v145 quad_perm:[3,3,3,3] row_mask:0xf bank_mask:0xf
  v_cvt_pk_bf16_f32 v110, 0, v110
  v_cvt_pk_bf16_f32 v111, 0, v111
  v_add_f32 v228, v144, v145
  v_pk_mul_f32 v[108:109], v[108:109], v[196:197]
  v_pk_mul_f32 v[110:111], v[110:111], v[198:199]
  v_cvt_pk_bf16_f32 v218, v108, v109
  v_cvt_pk_bf16_f32 v219, v110, v111
  s_waitcnt vmcnt(14)
  buffer_load_dwordx4 v[88:91], v95, s[8:11], s60 offen offset:512 nt
  v_mfma_f32_16x16x32_bf16 v[224:227], v[216:219], v[168:171], 0
  v_cvt_f32_i32 v108, v28
  v_cvt_f32_i32 v109, v29
  v_cvt_f32_i32 v110, v30
  v_cvt_f32_i32 v111, v31
  v_pk_add_f32 v[108:109], v[108:109], v[212:213] neg_lo:[0,1] neg_hi:[0,1]
  v_pk_add_f32 v[110:111], v[110:111], v[214:215] neg_lo:[0,1] neg_hi:[0,1]
  s_cmp_lt_u32 s64, s99
  s_cbranch_scc1 L_k_known1
L_k_spin1:
  v_mov_b32 v144, 61696
  ds_read_b32 v144, v144
  s_waitcnt lgkmcnt(0)
  v_readfirstlane_b32 s96, v144
  s_nop 1
  s_cmp_eq_u32 s96, 0
  s_cbranch_scc1 L_k_spin1
  s_mov_b32 s99, -1
L_k_known1:
  s_lshr_b32 s71, s64, 4
  s_andn2_b32 s71, s71, 1
  s_lshr_b32 s71, 0x12, s71
  s_and_b32 s71, s71, 3
  s_lshr_b32 s85, s96, s71
  s_andn2_b32 s70, s64, 1
  s_or_b32 s70, s70, s4
  s_cmp_lt_u32 s64, 8
  s_cselect_b32 s70, s70, s64
  s_cselect_b32 s85, s64, s85
  s_and_b32 s85, s85, 1
  s_and_b32 s70, s70, 31
  s_lshl_b32 s71, s71, 12
  s_add_u32 s70, s70, s5
  s_add_u32 s70, s70, s71
  s_mul_hi_u32 s84, s70, s90
  s_lshr_b32 s84, s84, 1
  s_mul_i32 s71, s84, 3
  s_sub_u32 s70, s70, s71
  s_lshl3_add_u32 s85, s70, s85
  s_mul_i32 s61, s84, 196608
  s_lshr_b32 s89, s84, 4
  s_lshl_b32 s70, s85, 5
  v_add_u32 v97, s70, v230
  v_mul_u32_u24 v97, 21846, v97
  v_lshrrev_b32 v97, 16, v97
  v_add_u32 v144, s85, v231
  v_lshrrev_b32 v145, v144, s91
  v_and_b32 v145, 1, v145
  v_cmp_eq_u32 s[54:55], 1, v145
  s_nop 1
  s_and_b64 s[52:53], s[54:55], s[56:57]
  s_andn2_b64 s[54:55], s[54:55], s[56:57]
  v_mul_u32_u24 v144, 43, v144
  v_lshrrev_b32 v144, 8, v144
  v_mul_u32_u24 v144, 384, v144
  v_add_u32 v234, v144, v233
  s_cmp_eq_u32 s89, s88
  s_cbranch_scc1 L_k_sameq1
  s_mul_i32 s70, s89, 1536
  buffer_load_dwordx2 v[174:175], v235, s[36:39], s70 offen offset:0
  buffer_load_dwordx2 v[176:177], v235, s[36:39], s70 offen offset:128
  buffer_load_dwordx2 v[178:179], v235, s[36:39], s70 offen offset:256
  s_mov_b32 s88, s89
L_k_sameq1:
  s_mul_i32 s62, s84, 1536
  buffer_load_dwordx2 v[180:181], v234, s[20:23], s62 offen offset:0
  buffer_load_dwordx2 v[186:187], v234, s[24:27], s62 offen offset:0
  buffer_load_dwordx2 v[182:183], v234, s[20:23], s62 offen offset:128
  buffer_load_dwordx2 v[188:189], v234, s[24:27], s62 offen offset:128
  buffer_load_dwordx2 v[184:185], v234, s[20:23], s62 offen offset:256
  buffer_load_dwordx2 v[190:191], v234, s[24:27], s62 offen offset:256
  v_cvt_pk_bf16_f32 v108, 0, v108
  v_cvt_pk_bf16_f32 v109, 0, v109
  v_cvt_pk_bf16_f32 v110, 0, v110
  v_cvt_pk_bf16_f32 v111, 0, v111
  v_pk_mul_f32 v[108:109], v[108:109], v[200:201]
  v_pk_mul_f32 v[110:111], v[110:111], v[202:203]
  v_cvt_pk_bf16_f32 v220, v108, v109
  v_cvt_pk_bf16_f32 v221, v110, v111
  s_cmp_lt_u32 s64, 96
  s_cbranch_scc1 L_k_keep
  s_lshr_b32 s71, s3, 5
  s_lshr_b32 s85, s96, s71
  s_bfe_u32 s85, s85, 0x10003
  s_and_b32 s70, s3, 31
  s_lshl_b32 s71, s71, 12
  s_add_u32 s70, s70, s5
  s_add_u32 s70, s70, s71
  s_mul_hi_u32 s84, s70, s90
  s_lshr_b32 s84, s84, 1
  s_mul_i32 s71, s84, 3
  s_sub_u32 s70, s70, s71
  s_lshl3_add_u32 s85, s70, s85
  s_mul_i32 s61, s84, 196608
  s_lshr_b32 s89, s84, 4
  s_lshl_b32 s70, s85, 5
  v_add_u32 v97, s70, v1
  v_mul_u32_u24 v97, 21846, v97
  v_lshrrev_b32 v97, 16, v97
  v_add_u32 v144, s85, v2
  v_lshrrev_b32 v145, v144, s91
  v_and_b32 v145, 1, v145
  v_cmp_eq_u32 s[54:55], 1, v145
  s_nop 1
  s_and_b64 s[52:53], s[54:55], s[58:59]
  s_andn2_b64 s[54:55], s[54:55], s[58:59]
  s_mov_b32 s16, s12
  s_mov_b32 s17, s13
  s_lshl_b32 s62, s84, 9
  v_lshl_add_u32 v98, v97, 1, v96
  buffer_load_short_d16_hi v112, v98, s[32:35], s62 offen
  buffer_load_short_d16_hi v113, v98, s[28:31], s62 offen
  v_mov_b32 v232, v3
L_k_keep:
  v_mad_u32_u24 v92, v97, s63, v232
  v_add_u32 v93, 768, v92
  v_add_u32 v94, 4608, v92
  v_add_u32 v95, 7680, v92
  v_cndmask_b32 v92, v92, v105, s[52:53]
  v_cndmask_b32 v95, v95, v105, s[54:55]
  s_waitcnt vmcnt(20)
  s_cbranch_vccnz L_kw1_18
  s_waitcnt vmcnt(15)
L_kw1_18:
  buffer_load_dwordx4 v[4:7], v92, s[16:19], s61 offen offset:0 nt
  v_mfma_f32_16x16x16_bf16 v[224:227], v[220:221], v[172:173], v[224:227]
  v_cvt_f32_i32 v108, v32
  v_cvt_f32_i32 v109, v33
  v_cvt_f32_i32 v110, v34
  v_cvt_f32_i32 v111, v35
  v_pk_add_f32 v[108:109], v[108:109], v[204:205] neg_lo:[0,1] neg_hi:[0,1]
  v_pk_add_f32 v[110:111], v[110:111], v[206:207] neg_lo:[0,1] neg_hi:[0,1]
  v_cvt_pk_bf16_f32 v108, 0, v108
  v_cvt_pk_bf16_f32 v109, 0, v109
  v_cvt_pk_bf16_f32 v110, 0, v110
  v_cvt_pk_bf16_f32 v111, 0, v111
  v_pk_mul_f32 v[108:109], v[108:109], v[192:193]
  v_pk_mul_f32 v[110:111], v[110:111], v[194:195]
  v_cvt_pk_bf16_f32 v216, v108, v109
  v_cvt_pk_bf16_f32 v217, v110, v111
  s_waitcnt vmcnt(20)
  buffer_load_dwordx4 v[8:11], v92, s[16:19], s61 offen offset:256 nt
  v_cvt_f32_i32 v108, v36
  v_cvt_f32_i32 v109, v37
  v_cvt_f32_i32 v110, v38
  v_cvt_f32_i32 v111, v39
  v_pk_add_f32 v[108:109], v[108:109], v[208:209] neg_lo:[0,1] neg_hi:[0,1]
  v_pk_add_f32 v[110:111], v[110:111], v[210:211] neg_lo:[0,1] neg_hi:[0,1]
  v_mov_b32_dpp v144, v224 quad_perm:[0,0,0,0] row_mask:0xf bank_mask:0xf
  v_mov_b32_dpp v145, v226 quad_perm:[2,2,2,2] row_mask:0xf bank_mask:0xf
  v_cvt_pk_bf16_f32 v108, 0, v108
  v_cvt_pk_bf16_f32 v109, 0, v109
  v_add_f32_dpp v144, v225, v144 quad_perm:[1,1,1,1] row_mask:0xf bank_mask:0xf
  v_add_f32_dpp v145, v227, v145 quad_perm:[3,3,3,3] row_mask:0xf bank_mask:0xf
  v_cvt_pk_bf16_f32 v110, 0, v110
  v_cvt_pk_bf16_f32 v111, 0, v111
  v_add_f32 v229, v144, v145
  v_pk_mul_f32 v[108:109], v[108:109], v[196:197]
  v_pk_mul_f32 v[110:111], v[110:111], v[198:199]
  v_cvt_pk_bf16_f32 v218, v108, v109
  v_cvt_pk_bf16_f32 v219, v110, v111
  s_waitcnt vmcnt(20)
  buffer_load_dwordx4 v[12:15], v92, s[16:19], s61 offen offset:512 nt
  v_mfma_f32_16x16x32_bf16 v[224:227], v[216:219], v[168:171], 0
  v_cvt_f32_i32 v108, v40
  v_cvt_f32_i32 v109, v41
  v_cvt_f32_i32 v110, v42
  v_cvt_f32_i32 v111, v43
  v_pk_add_f32 v[108:109], v[108:109], v[212:213] neg_lo:[0,1] neg_hi:[0,1]
  v_pk_add_f32 v[110:111], v[110:111], v[214:215] neg_lo:[0,1] neg_hi:[0,1]
  v_cvt_pk_bf16_f32 v108, 0, v108
  v_cvt_pk_bf16_f32 v228, 0, v228
  v_cvt_pk_bf16_f32 v109, 0, v109
  v_cvt_pk_bf16_f32 v229, 0, v229
  v_cvt_pk_bf16_f32 v110, 0, v110
  v_pk_mul_f32 v[228:229], v[228:229], s[68:69]
  v_cvt_pk_bf16_f32 v111, 0, v111
  v_cvt_pk_bf16_f32 v122, v228, v229
  v_pk_mul_f32 v[108:109], v[108:109], v[200:201]
  v_pk_mul_f32 v[110:111], v[110:111], v[202:203]
  v_cvt_pk_bf16_f32 v220, v108, v109
  v_cvt_pk_bf16_f32 v221, v110, v111
  s_waitcnt vmcnt(20)
  s_cbranch_vccnz L_kw1_21
  s_waitcnt vmcnt(15)
L_kw1_21:
  buffer_load_dwordx4 v[16:19], v93, s[16:19], s61 offen offset:0 nt
  v_mfma_f32_16x16x16_bf16 v[224:227], v[220:221], v[172:173], v[224:227]
  v_cvt_f32_i32 v108, v44
  v_cvt_f32_i32 v109, v45
  v_cvt_f32_i32 v110, v46
  v_cvt_f32_i32 v111, v47
  v_pk_add_f32 v[108:109], v[108:109], v[204:205] neg_lo:[0,1] neg_hi:[0,1]
  v_pk_add_f32 v[110:111], v[110:111], v[206:207] neg_lo:[0,1] neg_hi:[0,1]
  v_cvt_pk_bf16_f32 v108, 0, v108
  v_cvt_pk_bf16_f32 v109, 0, v109
  v_cvt_pk_bf16_f32 v110, 0, v110
  v_cvt_pk_bf16_f32 v111, 0, v111
  v_pk_mul_f32 v[108:109], v[108:109], v[192:193]
  v_pk_mul_f32 v[110:111], v[110:111], v[194:195]
  v_cvt_pk_bf16_f32 v216, v108, v109
  v_cvt_pk_bf16_f32 v217, v110, v111
  s_waitcnt vmcnt(20)
  buffer_load_dwordx4 v[20:23], v93, s[16:19], s61 offen offset:256 nt
  v_cvt_f32_i32 v108, v48
  v_cvt_f32_i32 v109, v49
  v_cvt_f32_i32 v110, v50
  v_cvt_f32_i32 v111, v51
  v_pk_add_f32 v[108:109], v[108:109], v[208:209] neg_lo:[0,1] neg_hi:[0,1]
  v_pk_add_f32 v[110:111], v[110:111], v[210:211] neg_lo:[0,1] neg_hi:[0,1]
  v_mov_b32_dpp v144, v224 quad_perm:[0,0,0,0] row_mask:0xf bank_mask:0xf
  v_mov_b32_dpp v145, v226 quad_perm:[2,2,2,2] row_mask:0xf bank_mask:0xf
  v_cvt_pk_bf16_f32 v108, 0, v108
  v_cvt_pk_bf16_f32 v109, 0, v109
  v_add_f32_dpp v144, v225, v144 quad_perm:[1,1,1,1] row_mask:0xf bank_mask:0xf
  v_add_f32_dpp v145, v227, v145 quad_perm:[3,3,3,3] row_mask:0xf bank_mask:0xf
  v_cvt_pk_bf16_f32 v110, 0, v110
  v_cvt_pk_bf16_f32 v111, 0, v111
  v_add_f32 v228, v144, v145
  v_pk_mul_f32 v[108:109], v[108:109], v[196:197]
  v_pk_mul_f32 v[110:111], v[110:111], v[198:199]
  v_cvt_pk_bf16_f32 v218, v108, v109
  v_cvt_pk_bf16_f32 v219, v110, v111
  s_waitcnt vmcnt(20)
  buffer_load_dwordx4 v[24:27], v93, s[16:19], s61 offen offset:512 nt
  v_mfma_f32_16x16x32_bf16 v[224:227], v[216:219], v[168:171], 0
  v_cvt_f32_i32 v108, v52
  v_cvt_f32_i32 v109, v53
  v_cvt_f32_i32 v110, v54
  v_cvt_f32_i32 v111, v55
  v_pk_add_f32 v[108:109], v[108:109], v[212:213] neg_lo:[0,1] neg_hi:[0,1]
  v_pk_add_f32 v[110:111], v[110:111], v[214:215] neg_lo:[0,1] neg_hi:[0,1]
  v_cvt_pk_bf16_f32 v108, 0, v108
  v_cvt_pk_bf16_f32 v109, 0, v109
  v_cvt_pk_bf16_f32 v110, 0, v110
  v_cvt_pk_bf16_f32 v111, 0, v111
  v_pk_mul_f32 v[108:109], v[108:109], v[200:201]
  v_pk_mul_f32 v[110:111], v[110:111], v[202:203]
  v_cvt_pk_bf16_f32 v220, v108, v109
  v_cvt_pk_bf16_f32 v221, v110, v111
  s_waitcnt vmcnt(20)
  s_cbranch_vccnz L_kw1_24
  s_waitcnt vmcnt(15)
L_kw1_24:
  buffer_load_dwordx4 v[28:31], v93, s[16:19], s61 offen offset:768 nt
  v_mfma_f32_16x16x16_bf16 v[224:227], v[220:221], v[172:173], v[224:227]
  v_cvt_f32_i32 v108, v56
  v_cvt_f32_i32 v109, v57
  v_cvt_f32_i32 v110, v58
  v_cvt_f32_i32 v111, v59
  v_pk_add_f32 v[108:109], v[108:109], v[204:205] neg_lo:[0,1] neg_hi:[0,1]
  v_pk_add_f32 v[110:111], v[110:111], v[206:207] neg_lo:[0,1] neg_hi:[0,1]
  v_cvt_pk_bf16_f32 v108, 0, v108
  v_cvt_pk_bf16_f32 v109, 0, v109
  v_cvt_pk_bf16_f32 v110, 0, v110
  v_cvt_pk_bf16_f32 v111, 0, v111
  v_pk_mul_f32 v[108:109], v[108:109], v[192:193]
  v_pk_mul_f32 v[110:111], v[110:111], v[194:195]
  v_cvt_pk_bf16_f32 v216, v108, v109
  v_cvt_pk_bf16_f32 v217, v110, v111
  s_waitcnt vmcnt(20)
  buffer_load_dwordx4 v[32:35], v93, s[16:19], s61 offen offset:1024 nt
  v_cvt_f32_i32 v108, v60
  v_cvt_f32_i32 v109, v61
  v_cvt_f32_i32 v110, v62
  v_cvt_f32_i32 v111, v63
  v_pk_add_f32 v[108:109], v[108:109], v[208:209] neg_lo:[0,1] neg_hi:[0,1]
  v_pk_add_f32 v[110:111], v[110:111], v[210:211] neg_lo:[0,1] neg_hi:[0,1]
  v_mov_b32_dpp v144, v224 quad_perm:[0,0,0,0] row_mask:0xf bank_mask:0xf
  v_mov_b32_dpp v145, v226 quad_perm:[2,2,2,2] row_mask:0xf bank_mask:0xf
  v_cvt_pk_bf16_f32 v108, 0, v108
  v_cvt_pk_bf16_f32 v109, 0, v109
  v_add_f32_dpp v144, v225, v144 quad_perm:[1,1,1,1] row_mask:0xf bank_mask:0xf
  v_add_f32_dpp v145, v227, v145 quad_perm:[3,3,3,3] row_mask:0xf bank_mask:0xf
  v_cvt_pk_bf16_f32 v110, 0, v110
  v_cvt_pk_bf16_f32 v111, 0, v111
  v_add_f32 v229, v144, v145
  v_pk_mul_f32 v[108:109], v[108:109], v[196:197]
  v_pk_mul_f32 v[110:111], v[110:111], v[198:199]
  v_cvt_pk_bf16_f32 v218, v108, v109
  v_cvt_pk_bf16_f32 v219, v110, v111
  s_waitcnt vmcnt(20)
  buffer_load_dwordx4 v[36:39], v93, s[16:19], s61 offen offset:1280 nt
  v_mfma_f32_16x16x32_bf16 v[224:227], v[216:219], v[168:171], 0
  v_cvt_f32_i32 v108, v64
  v_cvt_f32_i32 v109, v65
  v_cvt_f32_i32 v110, v66
  v_cvt_f32_i32 v111, v67
  v_pk_add_f32 v[108:109], v[108:109], v[212:213] neg_lo:[0,1] neg_hi:[0,1]
  v_pk_add_f32 v[110:111], v[110:111], v[214:215] neg_lo:[0,1] neg_hi:[0,1]
  v_cvt_pk_bf16_f32 v108, 0, v108
  v_cvt_pk_bf16_f32 v228, 0, v228
  v_cvt_pk_bf16_f32 v109, 0, v109
  v_cvt_pk_bf16_f32 v229, 0, v229
  v_cvt_pk_bf16_f32 v110, 0, v110
  v_pk_mul_f32 v[228:229], v[228:229], s[68:69]
  v_cvt_pk_bf16_f32 v111, 0, v111
  v_cvt_pk_bf16_f32 v123, v228, v229
  v_pk_mul_f32 v[108:109], v[108:109], v[200:201]
  v_pk_mul_f32 v[110:111], v[110:111], v[202:203]
  v_cvt_pk_bf16_f32 v220, v108, v109
  v_cvt_pk_bf16_f32 v221, v110, v111
  s_waitcnt vmcnt(20)
  s_cbranch_vccnz L_kw1_27
  s_waitcnt vmcnt(15)
L_kw1_27:
  buffer_load_dwordx4 v[40:43], v93, s[16:19], s61 offen offset:1536 nt
  v_mfma_f32_16x16x16_bf16 v[224:227], v[220:221], v[172:173], v[224:227]
  v_cvt_f32_i32 v108, v68
  v_cvt_f32_i32 v109, v69
  v_cvt_f32_i32 v110, v70
  v_cvt_f32_i32 v111, v71
  v_pk_add_f32 v[108:109], v[108:109], v[204:205] neg_lo:[0,1] neg_hi:[0,1]
  v_pk_add_f32 v[110:111], v[110:111], v[206:207] neg_lo:[0,1] neg_hi:[0,1]
  v_cvt_pk_bf16_f32 v108, 0, v108
  v_cvt_pk_bf16_f32 v109, 0, v109
  v_cvt_pk_bf16_f32 v110, 0, v110
  v_cvt_pk_bf16_f32 v111, 0, v111
  v_pk_mul_f32 v[108:109], v[108:109], v[192:193]
  v_pk_mul_f32 v[110:111], v[110:111], v[194:195]
  v_cvt_pk_bf16_f32 v216, v108, v109
  v_cvt_pk_bf16_f32 v217, v110, v111
  s_waitcnt vmcnt(20)
  buffer_load_dwordx4 v[44:47], v93, s[16:19], s61 offen offset:1792 nt
  v_cvt_f32_i32 v108, v72
  v_cvt_f32_i32 v109, v73
  v_cvt_f32_i32 v110, v74
  v_cvt_f32_i32 v111, v75
  v_pk_add_f32 v[108:109], v[108:109], v[208:209] neg_lo:[0,1] neg_hi:[0,1]
  v_pk_add_f32 v[110:111], v[110:111], v[210:211] neg_lo:[0,1] neg_hi:[0,1]
  v_mov_b32_dpp v144, v224 quad_perm:[0,0,0,0] row_mask:0xf bank_mask:0xf
  v_mov_b32_dpp v145, v226 quad_perm:[2,2,2,2] row_mask:0xf bank_mask:0xf
  v_cvt_pk_bf16_f32 v108, 0, v108
  v_cvt_pk_bf16_f32 v109, 0, v109
  v_add_f32_dpp v144, v225, v144 quad_perm:[1,1,1,1] row_mask:0xf bank_mask:0xf
  v_add_f32_dpp v145, v227, v145 quad_perm:[3,3,3,3] row_mask:0xf bank_mask:0xf
  v_cvt_pk_bf16_f32 v110, 0, v110
  v_cvt_pk_bf16_f32 v111, 0, v111
  v_add_f32 v228, v144, v145
  v_pk_mul_f32 v[108:109], v[108:109], v[196:197]
  v_pk_mul_f32 v[110:111], v[110:111], v[198:199]
  v_cvt_pk_bf16_f32 v218, v108, v109
  v_cvt_pk_bf16_f32 v219, v110, v111
  s_waitcnt vmcnt(20)
  buffer_load_dwordx4 v[48:51], v93, s[16:19], s61 offen offset:2048 nt
  v_mfma_f32_16x16x32_bf16 v[224:227], v[216:219], v[168:171], 0
  v_cvt_f32_i32 v108, v76
  v_cvt_f32_i32 v109, v77
  v_cvt_f32_i32 v110, v78
  v_cvt_f32_i32 v111, v79
  v_pk_add_f32 v[108:109], v[108:109], v[212:213] neg_lo:[0,1] neg_hi:[0,1]
  v_pk_add_f32 v[110:111], v[110:111], v[214:215] neg_lo:[0,1] neg_hi:[0,1]
  v_cvt_pk_bf16_f32 v108, 0, v108
  v_cvt_pk_bf16_f32 v109, 0, v109
  v_cvt_pk_bf16_f32 v110, 0, v110
  v_cvt_pk_bf16_f32 v111, 0, v111
  v_pk_mul_f32 v[108:109], v[108:109], v[200:201]
  v_pk_mul_f32 v[110:111], v[110:111], v[202:203]
  v_cvt_pk_bf16_f32 v220, v108, v109
  v_cvt_pk_bf16_f32 v221, v110, v111
  s_waitcnt vmcnt(20)
  s_cbranch_vccnz L_kw1_30
  s_waitcnt vmcnt(9)
L_kw1_30:
  buffer_load_dwordx4 v[52:55], v93, s[16:19], s61 offen offset:2304 nt
  v_mfma_f32_16x16x16_bf16 v[224:227], v[220:221], v[172:173], v[224:227]
  v_cvt_f32_i32 v108, v80
  v_cvt_f32_i32 v109, v81
  v_cvt_f32_i32 v110, v82
  v_cvt_f32_i32 v111, v83
  v_pk_add_f32 v[108:109], v[108:109], v[204:205] neg_lo:[0,1] neg_hi:[0,1]
  v_pk_add_f32 v[110:111], v[110:111], v[206:207] neg_lo:[0,1] neg_hi:[0,1]
  v_cvt_pk_bf16_f32 v108, 0, v108
  v_cvt_pk_bf16_f32 v109, 0, v109
  v_cvt_pk_bf16_f32 v110, 0, v110
  v_cvt_pk_bf16_f32 v111, 0, v111
  v_pk_mul_f32 v[108:109], v[108:109], v[192:193]
  v_pk_mul_f32 v[110:111], v[110:111], v[194:195]
  v_cvt_pk_bf16_f32 v216, v108, v109
  v_cvt_pk_bf16_f32 v217, v110, v111
  s_waitcnt vmcnt(20)
  buffer_load_dwordx4 v[56:59], v93, s[16:19], s61 offen offset:2560 nt
  v_cvt_f32_i32 v108, v84
  v_cvt_f32_i32 v109, v85
  v_cvt_f32_i32 v110, v86
  v_cvt_f32_i32 v111, v87
  v_pk_add_f32 v[108:109], v[108:109], v[208:209] neg_lo:[0,1] neg_hi:[0,1]
  v_pk_add_f32 v[110:111], v[110:111], v[210:211] neg_lo:[0,1] neg_hi:[0,1]
  v_mov_b32_dpp v144, v224 quad_perm:[0,0,0,0] row_mask:0xf bank_mask:0xf
  v_mov_b32_dpp v145, v226 quad_perm:[2,2,2,2] row_mask:0xf bank_mask:0xf
  v_cvt_pk_bf16_f32 v108, 0, v108
  v_cvt_pk_bf16_f32 v109, 0, v109
  v_add_f32_dpp v144, v225, v144 quad_perm:[1,1,1,1] row_mask:0xf bank_mask:0xf
  v_add_f32_dpp v145, v227, v145 quad_perm:[3,3,3,3] row_mask:0xf bank_mask:0xf
  v_cvt_pk_bf16_f32 v110, 0, v110
  v_cvt_pk_bf16_f32 v111, 0, v111
  v_add_f32 v229, v144, v145
  v_pk_mul_f32 v[108:109], v[108:109], v[196:197]
  v_pk_mul_f32 v[110:111], v[110:111], v[198:199]
  v_cvt_pk_bf16_f32 v218, v108, v109
  v_cvt_pk_bf16_f32 v219, v110, v111
  s_waitcnt vmcnt(20)
  buffer_load_dwordx4 v[60:63], v93, s[16:19], s61 offen offset:2816 nt
  v_mfma_f32_16x16x32_bf16 v[224:227], v[216:219], v[168:171], 0
  v_cvt_f32_i32 v108, v88
  v_cvt_f32_i32 v109, v89
  v_cvt_f32_i32 v110, v90
  v_cvt_f32_i32 v111, v91
  v_pk_add_f32 v[108:109], v[108:109], v[212:213] neg_lo:[0,1] neg_hi:[0,1]
  v_pk_add_f32 v[110:111], v[110:111], v[214:215] neg_lo:[0,1] neg_hi:[0,1]
  v_cvt_pk_bf16_f32 v108, 0, v108
  v_cvt_pk_bf16_f32 v228, 0, v228
  v_cvt_pk_bf16_f32 v109, 0, v109
  v_cvt_pk_bf16_f32 v229, 0, v229
  v_cvt_pk_bf16_f32 v110, 0, v110
  v_pk_mul_f32 v[228:229], v[228:229], s[68:69]
  v_cvt_pk_bf16_f32 v111, 0, v111
  v_cvt_pk_bf16_f32 v124, v228, v229
  v_pk_mul_f32 v[108:109], v[108:109], v[200:201]
  v_pk_mul_f32 v[110:111], v[110:111], v[202:203]
  v_cvt_pk_bf16_f32 v220, v108, v109
  v_cvt_pk_bf16_f32 v221, v110, v111
  s_mov_b32 s60, s61
  v_mov_b32 v146, s64
  v_mfma_f32_16x16x16_bf16 v[224:227], v[220:221], v[172:173], v[224:227]
  ds_write_b128 v99, v[120:123]
  v_add_u32 v99, 768, v99
  s_nop 5
  v_mov_b32_dpp v144, v224 quad_perm:[0,0,0,0] row_mask:0xf bank_mask:0xf
  v_mov_b32_dpp v145, v226 quad_perm:[2,2,2,2] row_mask:0xf bank_mask:0xf
  s_nop 0
  v_add_f32_dpp v144, v225, v144 quad_perm:[1,1,1,1] row_mask:0xf bank_mask:0xf
  v_add_f32_dpp v145, v227, v145 quad_perm:[3,3,3,3] row_mask:0xf bank_mask:0xf
  v_add_f32 v228, v144, v145
  v_cndmask_b32 v228, v228, v236, s[50:51]
  v_cvt_pk_bf16_f32 v228, 0, v228
  v_cvt_pk_bf16_f32 v229, 0, v229
  v_pk_mul_f32 v[228:229], v[228:229], s[68:69]
  v_cvt_pk_bf16_f32 v125, v228, v229
  ds_write_b64 v100, v[124:125] offset:256
  ds_write_b32 v104, v146
  v_add_u32 v100, 768, v100
  s_cmp_lt_u32 s64, 96
  s_cbranch_scc1 L_k
  v_subrev_u32 v99, 24576, v99
  v_subrev_u32 v100, 24576, v100
  s_mov_b32 s64, s3
  s_mov_b32 s88, s89
  s_mov_b32 s99, 0
  s_mov_b32 s36, s46
  s_and_b32 s37, s47, 0xffff
  s_cmp_lt_u32 s64, s99
  s_cbranch_scc1 L_v0_ok
L_v0_spin:
  v_mov_b32 v144, 61700
  ds_read_b32 v144, v144
  s_waitcnt lgkmcnt(0)
  v_readfirstlane_b32 s99, v144
  s_nop 1
  s_cmp_lt_u32 s64, s99
  s_cbranch_scc0 L_v0_spin
L_v0_ok:
  ds_read_b128 v[120:123], v99
  ds_read_b64 v[124:125], v100 offset:256
  v_mov_b32 v128, 0
  v_mov_b32 v129, 0
  v_mov_b32 v130, 0
  v_mov_b32 v131, 0
  v_mov_b32 v132, 0
  v_mov_b32 v133, 0
  v_mov_b32 v134, 0
  v_mov_b32 v135, 0
  v_mov_b32 v136, 0
  v_mov_b32 v137, 0
  v_mov_b32 v138, 0
  v_mov_b32 v139, 0
  v_mov_b32 v140, 0xff800000
  v_mov_b32 v142, 0x7f800000
  v_mov_b32 v143, 0
L_v0:
  s_add_u32 s97, s64, 96
  v_mov_b32 v146, s97
  s_mov_b32 s86, s84
  ds_write_b32 v104, v146
  s_add_u32 s64, s64, 2
  s_cmp_lt_u32 s64, s99
  s_cbranch_scc1 L_v10_ok
L_v10_spin:
  v_mov_b32 v144, 61700
  ds_read_b32 v144, v144
  s_waitcnt lgkmcnt(0)
  v_readfirstlane_b32 s99, v144
  s_nop 1
  s_cmp_lt_u32 s64, s99
  s_cbranch_scc0 L_v10_spin
L_v10_ok:
  s_lshr_b32 s71, s64, 5
  s_lshr_b32 s85, s96, s71
  s_bfe_u32 s85, s85, 0x10003
  s_and_b32 s70, s64, 31
  s_lshl_b32 s71, s71, 12
  s_add_u32 s70, s70, s5
  s_add_u32 s70, s70, s71
  s_mul_hi_u32 s84, s70, s90
  s_lshr_b32 s84, s84, 1
  s_mul_i32 s71, s84, 3
  s_sub_u32 s70, s70, s71
  s_lshl3_add_u32 s85, s70, s85
  s_mul_i32 s61, s84, 196608
  s_lshr_b32 s89, s84, 4
  s_lshl_b32 s70, s85, 5
  v_add_u32 v97, s70, v1
  v_mul_u32_u24 v97, 21846, v97
  v_lshrrev_b32 v97, 16, v97
  v_add_u32 v144, s85, v2
  v_lshrrev_b32 v145, v144, s91
  v_and_b32 v145, 1, v145
  v_cmp_eq_u32 s[54:55], 1, v145
  s_nop 1
  s_and_b64 s[52:53], s[54:55], s[58:59]
  s_andn2_b64 s[54:55], s[54:55], s[58:59]
  s_cmp_lt_u32 s64, 96
  s_cselect_b32 s61, s61, 805306368
  ds_read_b32 v106, v104 offset:8
  s_waitcnt vmcnt(14)
  s_cbranch_vccnz L_vw0_0
  s_waitcnt vmcnt(9)
L_vw0_0:
  buffer_load_dwordx4 v[64:67], v93, s[12:15], s60 offen offset:3072 nt
  v_mov_b32 v114, v112
  v_mov_b32 v115, v113
  v_cvt_f32_i32 v192, v4
  v_cvt_f32_i32 v193, v5
  v_mov_b32_dpp v116, v114 row_newbcast:0 row_mask:0xf bank_mask:0xf
  v_mov_b32_dpp v117, v115 row_newbcast:0 row_mask:0xf bank_mask:0xf
  v_cvt_f32_i32 v194, v6
  v_cvt_f32_i32 v195, v7
  v_pk_add_f32 v[192:193], v[192:193], v[116:117] op_sel_hi:[1,0] neg_lo:[0,1] neg_hi:[0,1]
  v_pk_add_f32 v[194:195], v[194:195], v[116:117] op_sel_hi:[1,0] neg_lo:[0,1] neg_hi:[0,1]
  v_cvt_pk_bf16_f32 v192, 0, v192
  v_cvt_pk_bf16_f32 v193, 0, v193
  v_cvt_pk_bf16_f32 v194, 0, v194
  v_cvt_pk_bf16_f32 v195, 0, v195
  v_pk_mul_f32 v[192:193], v[192:193], v[116:117] op_sel:[0,1]
  v_pk_mul_f32 v[194:195], v[194:195], v[116:117] op_sel:[0,1]
  s_waitcnt lgkmcnt(0)
  v_cmp_lt_u32 vcc, s97, v106
  s_waitcnt vmcnt(14)
  buffer_load_dwordx4 v[68:71], v93, s[12:15], s60 offen offset:3328 nt
  v_cvt_f32_i32 v196, v8
  v_cvt_f32_i32 v197, v9
  v_cvt_f32_i32 v198, v10
  v_cvt_f32_i32 v199, v11
  v_pk_add_f32 v[196:197], v[196:197], v[116:117] op_sel_hi:[1,0] neg_lo:[0,1] neg_hi:[0,1]
  v_pk_add_f32 v[198:199], v[198:199], v[116:117] op_sel_hi:[1,0] neg_lo:[0,1] neg_hi:[0,1]
  v_cvt_pk_bf16_f32 v196, 0, v196
  v_lshlrev_b32 v148, 16, v120
  v_cvt_pk_bf16_f32 v197, 0, v197
  v_and_b32 v149, s65, v120
  v_cvt_pk_bf16_f32 v198, 0, v198
  v_lshlrev_b32 v150, 16, v121
  v_cvt_pk_bf16_f32 v199, 0, v199
  v_and_b32 v151, s65, v121
  v_pk_mul_f32 v[196:197], v[196:197], v[116:117] op_sel:[0,1]
  v_lshlrev_b32 v152, 16, v122
  v_pk_mul_f32 v[198:199], v[198:199], v[116:117] op_sel:[0,1]
  s_waitcnt vmcnt(14)
  buffer_load_dwordx4 v[72:75], v93, s[12:15], s60 offen offset:3584 nt
  v_cvt_f32_i32 v200, v12
  v_cvt_f32_i32 v201, v13
  v_cvt_f32_i32 v202, v14
  v_cvt_f32_i32 v203, v15
  v_pk_add_f32 v[200:201], v[200:201], v[116:117] op_sel_hi:[1,0] neg_lo:[0,1] neg_hi:[0,1]
  v_pk_add_f32 v[202:203], v[202:203], v[116:117] op_sel_hi:[1,0] neg_lo:[0,1] neg_hi:[0,1]
  v_cvt_pk_bf16_f32 v200, 0, v200
  v_and_b32 v153, s65, v122
  v_cvt_pk_bf16_f32 v201, 0, v201
  v_lshlrev_b32 v154, 16, v123
  v_cvt_pk_bf16_f32 v202, 0, v202
  v_and_b32 v155, s65, v123
  v_cvt_pk_bf16_f32 v203, 0, v203
  v_lshlrev_b32 v156, 16, v124
  v_pk_mul_f32 v[200:201], v[200:201], v[116:117] op_sel:[0,1]
  v_and_b32 v157, s65, v124
  v_pk_mul_f32 v[202:203], v[202:203], v[116:117] op_sel:[0,1]
  s_waitcnt vmcnt(14)
  s_cbranch_vccnz L_vw0_3
  s_waitcnt vmcnt(9)
L_vw0_3:
  buffer_load_dwordx4 v[76:79], v94, s[12:15], s60 offen offset:0 nt
  v_cvt_f32_i32 v108, v16
  v_cvt_f32_i32 v109, v17
  v_mov_b32_dpp v116, v114 row_newbcast:1 row_mask:0xf bank_mask:0xf
  v_mov_b32_dpp v117, v115 row_newbcast:1 row_mask:0xf bank_mask:0xf
  v_cvt_f32_i32 v110, v18
  v_cvt_f32_i32 v111, v19
  v_pk_add_f32 v[108:109], v[108:109], v[116:117] op_sel_hi:[1,0] neg_lo:[0,1] neg_hi:[0,1]
  v_pk_add_f32 v[110:111], v[110:111], v[116:117] op_sel_hi:[1,0] neg_lo:[0,1] neg_hi:[0,1]
  s_lshl_b32 s62, s84, 9
  v_lshl_add_u32 v98, v97, 1, v96
  buffer_load_short_d16_hi v112, v98, s[32:35], s62 offen
  buffer_load_short_d16_hi v113, v98, s[28:31], s62 offen
  v_cvt_pk_bf16_f32 v108, 0, v108
  v_lshlrev_b32 v158, 16, v125
  v_cvt_pk_bf16_f32 v109, 0, v109
  v_add_u32 v99, 768, v99
  v_cvt_pk_bf16_f32 v110, 0, v110
  v_add_u32 v100, 768, v100
  v_cvt_pk_bf16_f32 v111, 0, v111
  v_max3_f32 v144, v148, v149, v150
  v_pk_mul_f32 v[108:109], v[108:109], v[116:117] op_sel:[0,1]
  ds_read_b128 v[120:123], v99
  v_pk_mul_f32 v[110:111], v[110:111], v[116:117] op_sel:[0,1]
  v_cvt_pk_bf16_f32 v204, v192, v108
  v_cvt_pk_bf16_f32 v208, v193, v109
  v_cvt_pk_bf16_f32 v212, v194, v110
  v_cvt_pk_bf16_f32 v216, v195, v111
  s_waitcnt vmcnt(16)
  buffer_load_dwordx4 v[80:83], v94, s[12:15], s60 offen offset:256 nt
  v_cvt_f32_i32 v108, v20
  v_cvt_f32_i32 v109, v21
  v_cvt_f32_i32 v110, v22
  v_cvt_f32_i32 v111, v23
  v_pk_add_f32 v[108:109], v[108:109], v[116:117] op_sel_hi:[1,0] neg_lo:[0,1] neg_hi:[0,1]
  v_pk_add_f32 v[110:111], v[110:111], v[116:117] op_sel_hi:[1,0] neg_lo:[0,1] neg_hi:[0,1]
  v_cvt_pk_bf16_f32 v108, 0, v108
  ds_read_b64 v[124:125], v100 offset:256
  v_cvt_pk_bf16_f32 v109, 0, v109
  v_max3_f32 v145, v151, v152, v153
  v_cvt_pk_bf16_f32 v110, 0, v110
  v_max3_f32 v144, v144, v154, v155
  v_cvt_pk_bf16_f32 v111, 0, v111
  v_max3_f32 v145, v145, v156, v157
  v_pk_mul_f32 v[108:109], v[108:109], v[116:117] op_sel:[0,1]
  v_max3_f32 v144, v144, v158, v140
  v_pk_mul_f32 v[110:111], v[110:111], v[116:117] op_sel:[0,1]
  v_cvt_pk_bf16_f32 v220, v196, v108
  v_cvt_pk_bf16_f32 v224, v197, v109
  v_cvt_pk_bf16_f32 v228, v198, v110
  v_cvt_pk_bf16_f32 v232, v199, v111
  s_waitcnt vmcnt(16)
  buffer_load_dwordx4 v[84:87], v94, s[12:15], s60 offen offset:512 nt
  v_cvt_f32_i32 v108, v24
  v_cvt_f32_i32 v109, v25
  v_cvt_f32_i32 v110, v26
  v_cvt_f32_i32 v111, v27
  v_pk_add_f32 v[108:109], v[108:109], v[116:117] op_sel_hi:[1,0] neg_lo:[0,1] neg_hi:[0,1]
  v_pk_add_f32 v[110:111], v[110:111], v[116:117] op_sel_hi:[1,0] neg_lo:[0,1] neg_hi:[0,1]
  v_cvt_pk_bf16_f32 v108, 0, v108
  v_max_f32 v144, v144, v145
  v_cvt_pk_bf16_f32 v109, 0, v109
  v_mov_b32 v145, v144
  v_cvt_pk_bf16_f32 v110, 0, v110
  s_nop 0
  v_permlane32_swap_b32 v144, v145
  v_cvt_pk_bf16_f32 v111, 0, v111
  v_max_f32 v144, v144, v145
  v_pk_mul_f32 v[108:109], v[108:109], v[116:117] op_sel:[0,1]
  v_mov_b32 v145, v144
  v_pk_mul_f32 v[110:111], v[110:111], v[116:117] op_sel:[0,1]
  v_cvt_pk_bf16_f32 v236, v200, v108
  v_cvt_pk_bf16_f32 v240, v201, v109
  v_cvt_pk_bf16_f32 v244, v202, v110
  v_cvt_pk_bf16_f32 v248, v203, v111
  s_waitcnt vmcnt(16)
  s_cbranch_vccnz L_vw0_6
  s_waitcnt vmcnt(11)
L_vw0_6:
  buffer_load_dwordx4 v[88:91], v94, s[12:15], s60 offen offset:768 nt
  v_cvt_f32_i32 v192, v28
  v_cvt_f32_i32 v193, v29
  v_mov_b32_dpp v116, v114 row_newbcast:2 row_mask:0xf bank_mask:0xf
  v_mov_b32_dpp v117, v115 row_newbcast:2 row_mask:0xf bank_mask:0xf
  v_cvt_f32_i32 v194, v30
  v_cvt_f32_i32 v195, v31
  v_pk_add_f32 v[192:193], v[192:193], v[116:117] op_sel_hi:[1,0] neg_lo:[0,1] neg_hi:[0,1]
  v_pk_add_f32 v[194:195], v[194:195], v[116:117] op_sel_hi:[1,0] neg_lo:[0,1] neg_hi:[0,1]
  v_cvt_pk_bf16_f32 v192, 0, v192
  v_permlane16_swap_b32 v144, v145
  v_cvt_pk_bf16_f32 v193, 0, v193
  v_max_f32 v140, v144, v145
  v_cvt_pk_bf16_f32 v194, 0, v194
  v_mul_f32 v144, s66, v140
  v_cvt_pk_bf16_f32 v195, 0, v195
  v_add_f32 v146, v144, v142
  v_pk_mul_f32 v[192:193], v[192:193], v[116:117] op_sel:[0,1]
  v_sub_f32 v142, 0, v144
  v_pk_mul_f32 v[194:195], v[194:195], v[116:117] op_sel:[0,1]
  s_waitcnt vmcnt(16)
  buffer_load_dwordx4 v[4:7], v94, s[12:15], s60 offen offset:1024 nt
  v_cvt_f32_i32 v196, v32
  v_cvt_f32_i32 v197, v33
  v_cvt_f32_i32 v198, v34
  v_cvt_f32_i32 v199, v35
  v_pk_add_f32 v[196:197], v[196:197], v[116:117] op_sel_hi:[1,0] neg_lo:[0,1] neg_hi:[0,1]
  v_pk_add_f32 v[198:199], v[198:199], v[116:117] op_sel_hi:[1,0] neg_lo:[0,1] neg_hi:[0,1]
  v_cvt_pk_bf16_f32 v196, 0, v196
  v_exp_f32 v146, -v146
  v_cvt_pk_bf16_f32 v197, 0, v197
  ds_bpermute_b32 v147, v101, v146
  v_cvt_pk_bf16_f32 v198, 0, v198
  v_fma_f32 v148, v148, s66, v142
  v_cvt_pk_bf16_f32 v199, 0, v199
  v_exp_f32 v148, v148
  v_pk_mul_f32 v[196:197], v[196:197], v[116:117] op_sel:[0,1]
  v_fma_f32 v149, v149, s66, v142
  v_pk_mul_f32 v[198:199], v[198:199], v[116:117] op_sel:[0,1]
  s_waitcnt vmcnt(16)
  buffer_load_dwordx4 v[8:11], v94, s[12:15], s60 offen offset:1280 nt
  v_cvt_f32_i32 v200, v36
  v_cvt_f32_i32 v201, v37
  v_cvt_f32_i32 v202, v38
  v_cvt_f32_i32 v203, v39
  v_pk_add_f32 v[200:201], v[200:201], v[116:117] op_sel_hi:[1,0] neg_lo:[0,1] neg_hi:[0,1]
  v_pk_add_f32 v[202:203], v[202:203], v[116:117] op_sel_hi:[1,0] neg_lo:[0,1] neg_hi:[0,1]
  v_cvt_pk_bf16_f32 v200, 0, v200
  v_exp_f32 v149, v149
  v_cvt_pk_bf16_f32 v201, 0, v201
  v_fma_f32 v150, v150, s66, v142
  v_cvt_pk_bf16_f32 v202, 0, v202
  v_exp_f32 v150, v150
  v_cvt_pk_bf16_f32 v203, 0, v203
  v_fma_f32 v151, v151, s66, v142
  v_pk_mul_f32 v[200:201], v[200:201], v[116:117] op_sel:[0,1]
  v_exp_f32 v151, v151
  v_pk_mul_f32 v[202:203], v[202:203], v[116:117] op_sel:[0,1]
  s_waitcnt vmcnt(16)
  s_cbranch_vccnz L_vw0_9
  s_waitcnt vmcnt(11)
L_vw0_9:
  buffer_load_dwordx4 v[12:15], v94, s[12:15], s60 offen offset:1536 nt
  v_cvt_f32_i32 v108, v40
  v_cvt_f32_i32 v109, v41
  v_mov_b32_dpp v116, v114 row_newbcast:3 row_mask:0xf bank_mask:0xf
  v_mov_b32_dpp v117, v115 row_newbcast:3 row_mask:0xf bank_mask:0xf
  v_cvt_f32_i32 v110, v42
  v_cvt_f32_i32 v111, v43
  v_pk_add_f32 v[108:109], v[108:109], v[116:117] op_sel_hi:[1,0] neg_lo:[0,1] neg_hi:[0,1]
  v_pk_add_f32 v[110:111], v[110:111], v[116:117] op_sel_hi:[1,0] neg_lo:[0,1] neg_hi:[0,1]
  v_cvt_pk_bf16_f32 v108, 0, v108
  v_fma_f32 v152, v152, s66, v142
  v_cvt_pk_bf16_f32 v109, 0, v109
  v_exp_f32 v152, v152
  v_cvt_pk_bf16_f32 v110, 0, v110
  v_fma_f32 v153, v153, s66, v142
  v_cvt_pk_bf16_f32 v111, 0, v111
  v_exp_f32 v153, v153
  v_pk_mul_f32 v[108:109], v[108:109], v[116:117] op_sel:[0,1]
  v_fma_f32 v154, v154, s66, v142
  v_pk_mul_f32 v[110:111], v[110:111], v[116:117] op_sel:[0,1]
  v_cvt_pk_bf16_f32 v205, v192, v108
  v_cvt_pk_bf16_f32 v209, v193, v109
  v_cvt_pk_bf16_f32 v213, v194, v110
  v_cvt_pk_bf16_f32 v217, v195, v111
  s_waitcnt vmcnt(16)
  buffer_load_dwordx4 v[16:19], v94, s[12:15], s60 offen offset:1792 nt
  v_cvt_f32_i32 v108, v44
  v_cvt_f32_i32 v109, v45
  v_cvt_f32_i32 v110, v46
  v_cvt_f32_i32 v111, v47
  v_pk_add_f32 v[108:109], v[108:109], v[116:117] op_sel_hi:[1,0] neg_lo:[0,1] neg_hi:[0,1]
  v_pk_add_f32 v[110:111], v[110:111], v[116:117] op_sel_hi:[1,0] neg_lo:[0,1] neg_hi:[0,1]
  v_cvt_pk_bf16_f32 v108, 0, v108
  v_exp_f32 v154, v154
  v_cvt_pk_bf16_f32 v109, 0, v109
  v_fma_f32 v155, v155, s66, v142
  v_cvt_pk_bf16_f32 v110, 0, v110
  v_exp_f32 v155, v155
  v_cvt_pk_bf16_f32 v111, 0, v111
  v_fma_f32 v156, v156, s66, v142
  v_pk_mul_f32 v[108:109], v[108:109], v[116:117] op_sel:[0,1]
  v_exp_f32 v156, v156
  v_pk_mul_f32 v[110:111], v[110:111], v[116:117] op_sel:[0,1]
  v_cvt_pk_bf16_f32 v221, v196, v108
  v_cvt_pk_bf16_f32 v225, v197, v109
  v_cvt_pk_bf16_f32 v229, v198, v110
  v_cvt_pk_bf16_f32 v233, v199, v111
  s_waitcnt vmcnt(16)
  buffer_load_dwordx4 v[20:23], v94, s[12:15], s60 offen offset:2048 nt
  v_cvt_f32_i32 v108, v48
  v_cvt_f32_i32 v109, v49
  v_cvt_f32_i32 v110, v50
  v_cvt_f32_i32 v111, v51
  v_pk_add_f32 v[108:109], v[108:109], v[116:117] op_sel_hi:[1,0] neg_lo:[0,1] neg_hi:[0,1]
  v_pk_add_f32 v[110:111], v[110:111], v[116:117] op_sel_hi:[1,0] neg_lo:[0,1] neg_hi:[0,1]
  v_cvt_pk_bf16_f32 v108, 0, v108
  v_fma_f32 v157, v157, s66, v142
  v_cvt_pk_bf16_f32 v109, 0, v109
  v_exp_f32 v157, v157
  v_cvt_pk_bf16_f32 v110, 0, v110
  v_fma_f32 v158, v158, s66, v142
  v_cvt_pk_bf16_f32 v111, 0, v111
  v_exp_f32 v158, v158
  v_pk_mul_f32 v[108:109], v[108:109], v[116:117] op_sel:[0,1]
  v_add_f32 v144, v148, v149
  v_pk_mul_f32 v[110:111], v[110:111], v[116:117] op_sel:[0,1]
  v_cvt_pk_bf16_f32 v237, v200, v108
  v_cvt_pk_bf16_f32 v241, v201, v109
  v_cvt_pk_bf16_f32 v245, v202, v110
  v_cvt_pk_bf16_f32 v249, v203, v111
  s_waitcnt vmcnt(16)
  s_cbranch_vccnz L_vw0_12
  s_waitcnt vmcnt(11)
L_vw0_12:
  buffer_load_dwordx4 v[24:27], v94, s[12:15], s60 offen offset:2304 nt
  v_cvt_f32_i32 v192, v52
  v_cvt_f32_i32 v193, v53
  v_mov_b32_dpp v116, v114 row_newbcast:4 row_mask:0xf bank_mask:0xf
  v_mov_b32_dpp v117, v115 row_newbcast:4 row_mask:0xf bank_mask:0xf
  v_cvt_f32_i32 v194, v54
  v_cvt_f32_i32 v195, v55
  v_pk_add_f32 v[192:193], v[192:193], v[116:117] op_sel_hi:[1,0] neg_lo:[0,1] neg_hi:[0,1]
  v_pk_add_f32 v[194:195], v[194:195], v[116:117] op_sel_hi:[1,0] neg_lo:[0,1] neg_hi:[0,1]
  v_cvt_pk_bf16_f32 v192, 0, v192
  v_add_f32 v145, v150, v151
  v_cvt_pk_bf16_f32 v193, 0, v193
  v_add_f32 v144, v144, v152
  v_cvt_pk_bf16_f32 v194, 0, v194
  v_add_f32 v145, v145, v153
  v_cvt_pk_bf16_f32 v195, 0, v195
  v_add_f32 v144, v144, v154
  v_pk_mul_f32 v[192:193], v[192:193], v[116:117] op_sel:[0,1]
  v_add_f32 v145, v145, v155
  v_pk_mul_f32 v[194:195], v[194:195], v[116:117] op_sel:[0,1]
  s_waitcnt vmcnt(16)
  buffer_load_dwordx4 v[28:31], v94, s[12:15], s60 offen offset:2560 nt
  v_cvt_f32_i32 v196, v56
  v_cvt_f32_i32 v197, v57
  v_cvt_f32_i32 v198, v58
  v_cvt_f32_i32 v199, v59
  v_pk_add_f32 v[196:197], v[196:197], v[116:117] op_sel_hi:[1,0] neg_lo:[0,1] neg_hi:[0,1]
  v_pk_add_f32 v[198:199], v[198:199], v[116:117] op_sel_hi:[1,0] neg_lo:[0,1] neg_hi:[0,1]
  v_cvt_pk_bf16_f32 v196, 0, v196
  v_add_f32 v144, v144, v156
  v_cvt_pk_bf16_f32 v197, 0, v197
  v_add_f32 v145, v145, v157
  v_cvt_pk_bf16_f32 v198, 0, v198
  v_add_f32 v144, v144, v158
  v_cvt_pk_bf16_f32 v199, 0, v199
  v_add_f32 v144, v144, v145
  v_pk_mul_f32 v[196:197], v[196:197], v[116:117] op_sel:[0,1]
  v_fma_f32 v143, v143, v146, v144
  v_pk_mul_f32 v[198:199], v[198:199], v[116:117] op_sel:[0,1]
  s_waitcnt vmcnt(16)
  buffer_load_dwordx4 v[32:35], v94, s[12:15], s60 offen offset:2816 nt
  v_cvt_f32_i32 v200, v60
  v_cvt_f32_i32 v201, v61
  v_cvt_f32_i32 v202, v62
  v_cvt_f32_i32 v203, v63
  v_pk_add_f32 v[200:201], v[200:201], v[116:117] op_sel_hi:[1,0] neg_lo:[0,1] neg_hi:[0,1]
  v_pk_add_f32 v[202:203], v[202:203], v[116:117] op_sel_hi:[1,0] neg_lo:[0,1] neg_hi:[0,1]
  v_cvt_pk_bf16_f32 v200, 0, v200
  v_cvt_pk_bf16_f32 v159, v148, v149
  v_cvt_pk_bf16_f32 v201, 0, v201
  v_cvt_pk_bf16_f32 v160, v150, v151
  v_cvt_pk_bf16_f32 v202, 0, v202
  v_cvt_pk_bf16_f32 v161, v152, v153
  v_cvt_pk_bf16_f32 v203, 0, v203
  v_cvt_pk_bf16_f32 v162, v154, v155
  v_pk_mul_f32 v[200:201], v[200:201], v[116:117] op_sel:[0,1]
  v_cvt_pk_bf16_f32 v163, v156, v157
  v_pk_mul_f32 v[202:203], v[202:203], v[116:117] op_sel:[0,1]
  s_waitcnt vmcnt(16)
  s_cbranch_vccnz L_vw0_15
  s_waitcnt vmcnt(9)
L_vw0_15:
  buffer_load_dwordx4 v[36:39], v95, s[12:15], s60 offen offset:0 nt
  v_cvt_f32_i32 v108, v64
  v_cvt_f32_i32 v109, v65
  v_mov_b32_dpp v116, v114 row_newbcast:5 row_mask:0xf bank_mask:0xf
  v_mov_b32_dpp v117, v115 row_newbcast:5 row_mask:0xf bank_mask:0xf
  v_cvt_f32_i32 v110, v66
  v_cvt_f32_i32 v111, v67
  v_pk_add_f32 v[108:109], v[108:109], v[116:117] op_sel_hi:[1,0] neg_lo:[0,1] neg_hi:[0,1]
  v_pk_add_f32 v[110:111], v[110:111], v[116:117] op_sel_hi:[1,0] neg_lo:[0,1] neg_hi:[0,1]
  v_cvt_pk_bf16_f32 v108, 0, v108
  v_cvt_pk_bf16_f32 v164, v158, 0
  v_cvt_pk_bf16_f32 v109, 0, v109
  v_cndmask_b32 v168, 0, v159, s[72:73]
  v_cvt_pk_bf16_f32 v110, 0, v110
  v_cndmask_b32 v169, 0, v160, s[72:73]
  v_cvt_pk_bf16_f32 v111, 0, v111
  v_cndmask_b32 v170, 0, v161, s[72:73]
  v_pk_mul_f32 v[108:109], v[108:109], v[116:117] op_sel:[0,1]
  v_cndmask_b32 v171, 0, v162, s[72:73]
  v_pk_mul_f32 v[110:111], v[110:111], v[116:117] op_sel:[0,1]
  v_cvt_pk_bf16_f32 v206, v192, v108
  v_cvt_pk_bf16_f32 v210, v193, v109
  v_cvt_pk_bf16_f32 v214, v194, v110
  v_cvt_pk_bf16_f32 v218, v195, v111
  s_waitcnt vmcnt(16)
  buffer_load_dwordx4 v[40:43], v95, s[12:15], s60 offen offset:256 nt
  v_cvt_f32_i32 v108, v68
  v_cvt_f32_i32 v109, v69
  v_cvt_f32_i32 v110, v70
  v_cvt_f32_i32 v111, v71
  v_pk_add_f32 v[108:109], v[108:109], v[116:117] op_sel_hi:[1,0] neg_lo:[0,1] neg_hi:[0,1]
  v_pk_add_f32 v[110:111], v[110:111], v[116:117] op_sel_hi:[1,0] neg_lo:[0,1] neg_hi:[0,1]
  v_cvt_pk_bf16_f32 v108, 0, v108
  v_cndmask_b32 v172, 0, v159, s[74:75]
  v_cvt_pk_bf16_f32 v109, 0, v109
  v_cndmask_b32 v173, 0, v160, s[74:75]
  v_cvt_pk_bf16_f32 v110, 0, v110
  v_cndmask_b32 v174, 0, v161, s[74:75]
  v_cvt_pk_bf16_f32 v111, 0, v111
  v_cndmask_b32 v175, 0, v162, s[74:75]
  v_pk_mul_f32 v[108:109], v[108:109], v[116:117] op_sel:[0,1]
  v_cndmask_b32 v176, 0, v159, s[76:77]
  v_pk_mul_f32 v[110:111], v[110:111], v[116:117] op_sel:[0,1]
  v_cvt_pk_bf16_f32 v222, v196, v108
  v_cvt_pk_bf16_f32 v226, v197, v109
  v_cvt_pk_bf16_f32 v230, v198, v110
  v_cvt_pk_bf16_f32 v234, v199, v111
  s_waitcnt vmcnt(16)
  buffer_load_dwordx4 v[44:47], v95, s[12:15], s60 offen offset:512 nt
  v_cvt_f32_i32 v108, v72
  v_cvt_f32_i32 v109, v73
  v_cvt_f32_i32 v110, v74
  v_cvt_f32_i32 v111, v75
  v_pk_add_f32 v[108:109], v[108:109], v[116:117] op_sel_hi:[1,0] neg_lo:[0,1] neg_hi:[0,1]
  v_pk_add_f32 v[110:111], v[110:111], v[116:117] op_sel_hi:[1,0] neg_lo:[0,1] neg_hi:[0,1]
  v_cvt_pk_bf16_f32 v108, 0, v108
  v_cndmask_b32 v177, 0, v160, s[76:77]
  v_cvt_pk_bf16_f32 v109, 0, v109
  v_cndmask_b32 v178, 0, v161, s[76:77]
  v_cvt_pk_bf16_f32 v110, 0, v110
  v_cndmask_b32 v179, 0, v162, s[76:77]
  v_cvt_pk_bf16_f32 v111, 0, v111
  v_cndmask_b32 v180, 0, v159, s[78:79]
  v_pk_mul_f32 v[108:109], v[108:109], v[116:117] op_sel:[0,1]
  v_cndmask_b32 v181, 0, v160, s[78:79]
  v_pk_mul_f32 v[110:111], v[110:111], v[116:117] op_sel:[0,1]
  v_cvt_pk_bf16_f32 v238, v200, v108
  v_cvt_pk_bf16_f32 v242, v201, v109
  v_cvt_pk_bf16_f32 v246, v202, v110
  v_cvt_pk_bf16_f32 v250, v203, v111
  v_mad_u32_u24 v92, v97, s63, v3
  v_add_u32 v93, 768, v92
  v_add_u32 v94, 4608, v92
  v_add_u32 v95, 7680, v92
  v_cndmask_b32 v92, v92, v105, s[52:53]
  v_cndmask_b32 v95, v95, v105, s[54:55]
  s_waitcnt vmcnt(16)
  s_cbranch_vccnz L_vw0_18
  s_waitcnt vmcnt(9)
L_vw0_18:
  buffer_load_dwordx4 v[48:51], v92, s[12:15], s61 offen offset:0 nt
  v_cvt_f32_i32 v192, v76
  v_cvt_f32_i32 v193, v77
  v_mov_b32_dpp v116, v114 row_newbcast:6 row_mask:0xf bank_mask:0xf
  v_mov_b32_dpp v117, v115 row_newbcast:6 row_mask:0xf bank_mask:0xf
  v_cvt_f32_i32 v194, v78
  v_cvt_f32_i32 v195, v79
  v_pk_add_f32 v[192:193], v[192:193], v[116:117] op_sel_hi:[1,0] neg_lo:[0,1] neg_hi:[0,1]
  v_pk_add_f32 v[194:195], v[194:195], v[116:117] op_sel_hi:[1,0] neg_lo:[0,1] neg_hi:[0,1]
  v_cvt_pk_bf16_f32 v192, 0, v192
  v_cndmask_b32 v182, 0, v161, s[78:79]
  v_cvt_pk_bf16_f32 v193, 0, v193
  v_cndmask_b32 v183, 0, v162, s[78:79]
  v_cvt_pk_bf16_f32 v194, 0, v194
  s_waitcnt lgkmcnt(0)
  v_cvt_pk_bf16_f32 v195, 0, v195
  v_mul_f32 v128, v147, v128
  v_pk_mul_f32 v[192:193], v[192:193], v[116:117] op_sel:[0,1]
  v_mul_f32 v129, v147, v129
  v_pk_mul_f32 v[194:195], v[194:195], v[116:117] op_sel:[0,1]
  s_waitcnt vmcnt(14)
  buffer_load_dwordx4 v[52:55], v92, s[12:15], s61 offen offset:256 nt
  v_cvt_f32_i32 v196, v80
  v_cvt_f32_i32 v197, v81
  v_cvt_f32_i32 v198, v82
  v_cvt_f32_i32 v199, v83
  v_pk_add_f32 v[196:197], v[196:197], v[116:117] op_sel_hi:[1,0] neg_lo:[0,1] neg_hi:[0,1]
  v_pk_add_f32 v[198:199], v[198:199], v[116:117] op_sel_hi:[1,0] neg_lo:[0,1] neg_hi:[0,1]
  v_cvt_pk_bf16_f32 v196, 0, v196
  v_mul_f32 v130, v147, v130
  v_cvt_pk_bf16_f32 v197, 0, v197
  v_mul_f32 v131, v147, v131
  v_cvt_pk_bf16_f32 v198, 0, v198
  v_mul_f32 v132, v147, v132
  v_cvt_pk_bf16_f32 v199, 0, v199
  v_mul_f32 v133, v147, v133
  v_pk_mul_f32 v[196:197], v[196:197], v[116:117] op_sel:[0,1]
  v_mul_f32 v134, v147, v134
  v_pk_mul_f32 v[198:199], v[198:199], v[116:117] op_sel:[0,1]
  s_waitcnt vmcnt(14)
  buffer_load_dwordx4 v[56:59], v92, s[12:15], s61 offen offset:512 nt
  v_cvt_f32_i32 v200, v84
  v_cvt_f32_i32 v201, v85
  v_cvt_f32_i32 v202, v86
  v_cvt_f32_i32 v203, v87
  v_pk_add_f32 v[200:201], v[200:201], v[116:117] op_sel_hi:[1,0] neg_lo:[0,1] neg_hi:[0,1]
  v_pk_add_f32 v[202:203], v[202:203], v[116:117] op_sel_hi:[1,0] neg_lo:[0,1] neg_hi:[0,1]
  v_cvt_pk_bf16_f32 v200, 0, v200
  v_mul_f32 v135, v147, v135
  v_cvt_pk_bf16_f32 v201, 0, v201
  v_mul_f32 v136, v147, v136
  v_cvt_pk_bf16_f32 v202, 0, v202
  v_mul_f32 v137, v147, v137
  v_cvt_pk_bf16_f32 v203, 0, v203
  v_mul_f32 v138, v147, v138
  v_pk_mul_f32 v[200:201], v[200:201], v[116:117] op_sel:[0,1]
  v_mul_f32 v139, v147, v139
  v_pk_mul_f32 v[202:203], v[202:203], v[116:117] op_sel:[0,1]
  s_waitcnt vmcnt(14)
  s_cbranch_vccnz L_vw0_21
  s_waitcnt vmcnt(9)
L_vw0_21:
  buffer_load_dwordx4 v[60:63], v93, s[12:15], s61 offen offset:0 nt
  v_cvt_f32_i32 v108, v88
  v_cvt_f32_i32 v109, v89
  v_mov_b32_dpp v116, v114 row_newbcast:7 row_mask:0xf bank_mask:0xf
  v_mov_b32_dpp v117, v115 row_newbcast:7 row_mask:0xf bank_mask:0xf
  v_cvt_f32_i32 v110, v90
  v_cvt_f32_i32 v111, v91
  v_pk_add_f32 v[108:109], v[108:109], v[116:117] op_sel_hi:[1,0] neg_lo:[0,1] neg_hi:[0,1]
  v_pk_add_f32 v[110:111], v[110:111], v[116:117] op_sel_hi:[1,0] neg_lo:[0,1] neg_hi:[0,1]
  v_cvt_pk_bf16_f32 v108, 0, v108
  v_cvt_pk_bf16_f32 v109, 0, v109
  v_cvt_pk_bf16_f32 v110, 0, v110
  v_cvt_pk_bf16_f32 v111, 0, v111
  v_pk_mul_f32 v[108:109], v[108:109], v[116:117] op_sel:[0,1]
  v_pk_mul_f32 v[110:111], v[110:111], v[116:117] op_sel:[0,1]
  v_cvt_pk_bf16_f32 v207, v192, v108
  v_cvt_pk_bf16_f32 v211, v193, v109
  v_cvt_pk_bf16_f32 v215, v194, v110
  v_cvt_pk_bf16_f32 v219, v195, v111
  v_mfma_f32_16x16x32_bf16 v[128:131], v[168:171], v[204:207], v[128:131]
  v_mfma_f32_16x16x32_bf16 v[128:131], v[172:175], v[208:211], v[128:131]
  v_mfma_f32_16x16x32_bf16 v[128:131], v[176:179], v[212:215], v[128:131]
  v_mfma_f32_16x16x32_bf16 v[128:131], v[180:183], v[216:219], v[128:131]
  s_waitcnt vmcnt(14)
  buffer_load_dwordx4 v[64:67], v93, s[12:15], s61 offen offset:256 nt
  v_cvt_f32_i32 v108, v4
  v_cvt_f32_i32 v109, v5
  v_cvt_f32_i32 v110, v6
  v_cvt_f32_i32 v111, v7
  v_pk_add_f32 v[108:109], v[108:109], v[116:117] op_sel_hi:[1,0] neg_lo:[0,1] neg_hi:[0,1]
  v_pk_add_f32 v[110:111], v[110:111], v[116:117] op_sel_hi:[1,0] neg_lo:[0,1] neg_hi:[0,1]
  v_cvt_pk_bf16_f32 v108, 0, v108
  v_cvt_pk_bf16_f32 v109, 0, v109
  v_cvt_pk_bf16_f32 v110, 0, v110
  v_cvt_pk_bf16_f32 v111, 0, v111
  v_pk_mul_f32 v[108:109], v[108:109], v[116:117] op_sel:[0,1]
  v_pk_mul_f32 v[110:111], v[110:111], v[116:117] op_sel:[0,1]
  v_cvt_pk_bf16_f32 v223, v196, v108
  v_cvt_pk_bf16_f32 v227, v197, v109
  v_cvt_pk_bf16_f32 v231, v198, v110
  v_cvt_pk_bf16_f32 v235, v199, v111
  v_mfma_f32_16x16x32_bf16 v[132:135], v[168:171], v[220:223], v[132:135]
  v_mfma_f32_16x16x32_bf16 v[132:135], v[172:175], v[224:227], v[132:135]
  v_mfma_f32_16x16x32_bf16 v[132:135], v[176:179], v[228:231], v[132:135]
  v_mfma_f32_16x16x32_bf16 v[132:135], v[180:183], v[232:235], v[132:135]
  s_waitcnt vmcnt(14)
  buffer_load_dwordx4 v[68:71], v93, s[12:15], s61 offen offset:512 nt
  v_cvt_f32_i32 v108, v8
  v_cvt_f32_i32 v109, v9
  v_cvt_f32_i32 v110, v10
  v_cvt_f32_i32 v111, v11
  v_pk_add_f32 v[108:109], v[108:109], v[116:117] op_sel_hi:[1,0] neg_lo:[0,1] neg_hi:[0,1]
  v_pk_add_f32 v[110:111], v[110:111], v[116:117] op_sel_hi:[1,0] neg_lo:[0,1] neg_hi:[0,1]
  v_cvt_pk_bf16_f32 v108, 0, v108
  v_cvt_pk_bf16_f32 v109, 0, v109
  v_cvt_pk_bf16_f32 v110, 0, v110
  v_cvt_pk_bf16_f32 v111, 0, v111
  v_pk_mul_f32 v[108:109], v[108:109], v[116:117] op_sel:[0,1]
  v_pk_mul_f32 v[110:111], v[110:111], v[116:117] op_sel:[0,1]
  v_cvt_pk_bf16_f32 v239, v200, v108
  v_cvt_pk_bf16_f32 v243, v201, v109
  v_cvt_pk_bf16_f32 v247, v202, v110
  v_cvt_pk_bf16_f32 v251, v203, v111
  v_mfma_f32_16x16x32_bf16 v[136:139], v[168:171], v[236:239], v[136:139]
  v_mfma_f32_16x16x32_bf16 v[136:139], v[172:175], v[240:243], v[136:139]
  v_mfma_f32_16x16x32_bf16 v[136:139], v[176:179], v[244:247], v[136:139]
  v_mfma_f32_16x16x32_bf16 v[136:139], v[180:183], v[248:251], v[136:139]
  s_waitcnt vmcnt(14)
  s_cbranch_vccnz L_vw0_24
  s_waitcnt vmcnt(9)
L_vw0_24:
  buffer_load_dwordx4 v[72:75], v93, s[12:15], s61 offen offset:768 nt
  v_cvt_f32_i32 v192, v12
  v_cvt_f32_i32 v193, v13
  v_mov_b32_dpp v116, v114 row_newbcast:8 row_mask:0xf bank_mask:0xf
  v_mov_b32_dpp v117, v115 row_newbcast:8 row_mask:0xf bank_mask:0xf
  v_cvt_f32_i32 v194, v14
  v_cvt_f32_i32 v195, v15
  v_pk_add_f32 v[192:193], v[192:193], v[116:117] op_sel_hi:[1,0] neg_lo:[0,1] neg_hi:[0,1]
  v_pk_add_f32 v[194:195], v[194:195], v[116:117] op_sel_hi:[1,0] neg_lo:[0,1] neg_hi:[0,1]
  v_cvt_pk_bf16_f32 v192, 0, v192
  v_cndmask_b32 v184, 0, v163, s[72:73]
  v_cvt_pk_bf16_f32 v193, 0, v193
  v_cndmask_b32 v185, 0, v164, s[72:73]
  v_cvt_pk_bf16_f32 v194, 0, v194
  v_cndmask_b32 v186, 0, v163, s[74:75]
  v_cvt_pk_bf16_f32 v195, 0, v195
  v_cndmask_b32 v187, 0, v164, s[74:75]
  v_pk_mul_f32 v[192:193], v[192:193], v[116:117] op_sel:[0,1]
  v_cndmask_b32 v188, 0, v163, s[76:77]
  v_pk_mul_f32 v[194:195], v[194:195], v[116:117] op_sel:[0,1]
  s_waitcnt vmcnt(14)
  buffer_load_dwordx4 v[76:79], v93, s[12:15], s61 offen offset:1024 nt
  v_cvt_f32_i32 v196, v16
  v_cvt_f32_i32 v197, v17
  v_cvt_f32_i32 v198, v18
  v_cvt_f32_i32 v199, v19
  v_pk_add_f32 v[196:197], v[196:197], v[116:117] op_sel_hi:[1,0] neg_lo:[0,1] neg_hi:[0,1]
  v_pk_add_f32 v[198:199], v[198:199], v[116:117] op_sel_hi:[1,0] neg_lo:[0,1] neg_hi:[0,1]
  v_cvt_pk_bf16_f32 v196, 0, v196
  v_cndmask_b32 v189, 0, v164, s[76:77]
  v_cvt_pk_bf16_f32 v197, 0, v197
  v_cndmask_b32 v190, 0, v163, s[78:79]
  v_cvt_pk_bf16_f32 v198, 0, v198
  v_cndmask_b32 v191, 0, v164, s[78:79]
  v_cvt_pk_bf16_f32 v199, 0, v199
  v_pk_mul_f32 v[196:197], v[196:197], v[116:117] op_sel:[0,1]
  v_pk_mul_f32 v[198:199], v[198:199], v[116:117] op_sel:[0,1]
  s_waitcnt vmcnt(14)
  buffer_load_dwordx4 v[80:83], v93, s[12:15], s61 offen offset:1280 nt
  v_cvt_f32_i32 v200, v20
  v_cvt_f32_i32 v201, v21
  v_cvt_f32_i32 v202, v22
  v_cvt_f32_i32 v203, v23
  v_pk_add_f32 v[200:201], v[200:201], v[116:117] op_sel_hi:[1,0] neg_lo:[0,1] neg_hi:[0,1]
  v_pk_add_f32 v[202:203], v[202:203], v[116:117] op_sel_hi:[1,0] neg_lo:[0,1] neg_hi:[0,1]
  v_cvt_pk_bf16_f32 v200, 0, v200
  v_cvt_pk_bf16_f32 v201, 0, v201
  v_cvt_pk_bf16_f32 v202, 0, v202
  v_cvt_pk_bf16_f32 v203, 0, v203
  v_pk_mul_f32 v[200:201], v[200:201], v[116:117] op_sel:[0,1]
  v_pk_mul_f32 v[202:203], v[202:203], v[116:117] op_sel:[0,1]
  s_waitcnt vmcnt(14)
  s_cbranch_vccnz L_vw0_27
  s_waitcnt vmcnt(9)
L_vw0_27:
  buffer_load_dwordx4 v[84:87], v93, s[12:15], s61 offen offset:1536 nt
  v_cvt_f32_i32 v108, v24
  v_cvt_f32_i32 v109, v25
  v_mov_b32_dpp v116, v114 row_newbcast:9 row_mask:0xf bank_mask:0xf
  v_mov_b32_dpp v117, v115 row_newbcast:9 row_mask:0xf bank_mask:0xf
  v_cvt_f32_i32 v110, v26
  v_cvt_f32_i32 v111, v27
  v_pk_add_f32 v[108:109], v[108:109], v[116:117] op_sel_hi:[1,0] neg_lo:[0,1] neg_hi:[0,1]
  v_pk_add_f32 v[110:111], v[110:111], v[116:117] op_sel_hi:[1,0] neg_lo:[0,1] neg_hi:[0,1]
  v_cvt_pk_bf16_f32 v108, 0, v108
  v_cvt_pk_bf16_f32 v109, 0, v109
  v_cvt_pk_bf16_f32 v110, 0, v110
  v_cvt_pk_bf16_f32 v111, 0, v111
  v_pk_mul_f32 v[108:109], v[108:109], v[116:117] op_sel:[0,1]
  v_pk_mul_f32 v[110:111], v[110:111], v[116:117] op_sel:[0,1]
  v_cvt_pk_bf16_f32 v204, v192, v108
  v_cvt_pk_bf16_f32 v208, v193, v109
  v_cvt_pk_bf16_f32 v212, v194, v110
  v_cvt_pk_bf16_f32 v216, v195, v111
  s_waitcnt vmcnt(14)
  buffer_load_dwordx4 v[88:91], v93, s[12:15], s61 offen offset:1792 nt
  v_cvt_f32_i32 v108, v28
  v_cvt_f32_i32 v109, v29
  v_cvt_f32_i32 v110, v30
  v_cvt_f32_i32 v111, v31
  v_pk_add_f32 v[108:109], v[108:109], v[116:117] op_sel_hi:[1,0] neg_lo:[0,1] neg_hi:[0,1]
  v_pk_add_f32 v[110:111], v[110:111], v[116:117] op_sel_hi:[1,0] neg_lo:[0,1] neg_hi:[0,1]
  v_cvt_pk_bf16_f32 v108, 0, v108
  v_cvt_pk_bf16_f32 v109, 0, v109
  v_cvt_pk_bf16_f32 v110, 0, v110
  v_cvt_pk_bf16_f32 v111, 0, v111
  v_pk_mul_f32 v[108:109], v[108:109], v[116:117] op_sel:[0,1]
  v_pk_mul_f32 v[110:111], v[110:111], v[116:117] op_sel:[0,1]
  v_cvt_pk_bf16_f32 v220, v196, v108
  v_cvt_pk_bf16_f32 v224, v197, v109
  v_cvt_pk_bf16_f32 v228, v198, v110
  v_cvt_pk_bf16_f32 v232, v199, v111
  s_waitcnt vmcnt(14)
  buffer_load_dwordx4 v[4:7], v93, s[12:15], s61 offen offset:2048 nt
  v_cvt_f32_i32 v108, v32
  v_cvt_f32_i32 v109, v33
  v_cvt_f32_i32 v110, v34
  v_cvt_f32_i32 v111, v35
  v_pk_add_f32 v[108:109], v[108:109], v[116:117] op_sel_hi:[1,0] neg_lo:[0,1] neg_hi:[0,1]
  v_pk_add_f32 v[110:111], v[110:111], v[116:117] op_sel_hi:[1,0] neg_lo:[0,1] neg_hi:[0,1]
  v_cvt_pk_bf16_f32 v108, 0, v108
  v_cvt_pk_bf16_f32 v109, 0, v109
  v_cvt_pk_bf16_f32 v110, 0, v110
  v_cvt_pk_bf16_f32 v111, 0, v111
  v_pk_mul_f32 v[108:109], v[108:109], v[116:117] op_sel:[0,1]
  v_pk_mul_f32 v[110:111], v[110:111], v[116:117] op_sel:[0,1]
  v_cvt_pk_bf16_f32 v236, v200, v108
  v_cvt_pk_bf16_f32 v240, v201, v109
  v_cvt_pk_bf16_f32 v244, v202, v110
  v_cvt_pk_bf16_f32 v248, v203, v111
  s_waitcnt vmcnt(14)
  s_cbranch_vccnz L_vw0_30
  s_waitcnt vmcnt(9)
L_vw0_30:
  buffer_load_dwordx4 v[8:11], v93, s[12:15], s61 offen offset:2304 nt
  v_cvt_f32_i32 v192, v36
  v_cvt_f32_i32 v193, v37
  v_mov_b32_dpp v116, v114 row_newbcast:10 row_mask:0xf bank_mask:0xf
  v_mov_b32_dpp v117, v115 row_newbcast:10 row_mask:0xf bank_mask:0xf
  v_cvt_f32_i32 v194, v38
  v_cvt_f32_i32 v195, v39
  v_pk_add_f32 v[192:193], v[192:193], v[116:117] op_sel_hi:[1,0] neg_lo:[0,1] neg_hi:[0,1]
  v_pk_add_f32 v[194:195], v[194:195], v[116:117] op_sel_hi:[1,0] neg_lo:[0,1] neg_hi:[0,1]
  v_cvt_pk_bf16_f32 v192, 0, v192
  v_cvt_pk_bf16_f32 v193, 0, v193
  v_cvt_pk_bf16_f32 v194, 0, v194
  v_cvt_pk_bf16_f32 v195, 0, v195
  v_pk_mul_f32 v[192:193], v[192:193], v[116:117] op_sel:[0,1]
  v_pk_mul_f32 v[194:195], v[194:195], v[116:117] op_sel:[0,1]
  v_cvt_pk_bf16_f32 v205, v192, 0
  v_cvt_pk_bf16_f32 v209, v193, 0
  v_cvt_pk_bf16_f32 v213, v194, 0
  v_cvt_pk_bf16_f32 v217, v195, 0
  v_mfma_f32_16x16x16_bf16 v[128:131], v[184:185], v[204:205], v[128:131]
  v_mfma_f32_16x16x16_bf16 v[128:131], v[186:187], v[208:209], v[128:131]
  v_mfma_f32_16x16x16_bf16 v[128:131], v[188:189], v[212:213], v[128:131]
  v_mfma_f32_16x16x16_bf16 v[128:131], v[190:191], v[216:217], v[128:131]
  s_waitcnt vmcnt(14)
  buffer_load_dwordx4 v[12:15], v93, s[12:15], s61 offen offset:2560 nt
  v_cvt_f32_i32 v196, v40
  v_cvt_f32_i32 v197, v41
  v_cvt_f32_i32 v198, v42
  v_cvt_f32_i32 v199, v43
  v_pk_add_f32 v[196:197], v[196:197], v[116:117] op_sel_hi:[1,0] neg_lo:[0,1] neg_hi:[0,1]
  v_pk_add_f32 v[198:199], v[198:199], v[116:117] op_sel_hi:[1,0] neg_lo:[0,1] neg_hi:[0,1]
  v_cvt_pk_bf16_f32 v196, 0, v196
  v_cvt_pk_bf16_f32 v197, 0, v197
  v_cvt_pk_bf16_f32 v198, 0, v198
  v_cvt_pk_bf16_f32 v199, 0, v199
  v_pk_mul_f32 v[196:197], v[196:197], v[116:117] op_sel:[0,1]
  v_pk_mul_f32 v[198:199], v[198:199], v[116:117] op_sel:[0,1]
  v_cvt_pk_bf16_f32 v221, v196, 0
  v_cvt_pk_bf16_f32 v225, v197, 0
  v_cvt_pk_bf16_f32 v229, v198, 0
  v_cvt_pk_bf16_f32 v233, v199, 0
  v_mfma_f32_16x16x16_bf16 v[132:135], v[184:185], v[220:221], v[132:135]
  v_mfma_f32_16x16x16_bf16 v[132:135], v[186:187], v[224:225], v[132:135]
  v_mfma_f32_16x16x16_bf16 v[132:135], v[188:189], v[228:229], v[132:135]
  v_mfma_f32_16x16x16_bf16 v[132:135], v[190:191], v[232:233], v[132:135]
  s_waitcnt vmcnt(14)
  buffer_load_dwordx4 v[16:19], v93, s[12:15], s61 offen offset:2816 nt
  v_cvt_f32_i32 v200, v44
  v_cvt_f32_i32 v201, v45
  v_cvt_f32_i32 v202, v46
  v_cvt_f32_i32 v203, v47
  v_pk_add_f32 v[200:201], v[200:201], v[116:117] op_sel_hi:[1,0] neg_lo:[0,1] neg_hi:[0,1]
  v_pk_add_f32 v[202:203], v[202:203], v[116:117] op_sel_hi:[1,0] neg_lo:[0,1] neg_hi:[0,1]
  v_cvt_pk_bf16_f32 v200, 0, v200
  v_cvt_pk_bf16_f32 v201, 0, v201
  v_cvt_pk_bf16_f32 v202, 0, v202
  v_cvt_pk_bf16_f32 v203, 0, v203
  v_pk_mul_f32 v[200:201], v[200:201], v[116:117] op_sel:[0,1]
  v_pk_mul_f32 v[202:203], v[202:203], v[116:117] op_sel:[0,1]
  v_cvt_pk_bf16_f32 v237, v200, 0
  v_cvt_pk_bf16_f32 v241, v201, 0
  v_cvt_pk_bf16_f32 v245, v202, 0
  v_cvt_pk_bf16_f32 v249, v203, 0
  v_mfma_f32_16x16x16_bf16 v[136:139], v[184:185], v[236:237], v[136:139]
  v_mfma_f32_16x16x16_bf16 v[136:139], v[186:187], v[240:241], v[136:139]
  v_mfma_f32_16x16x16_bf16 v[136:139], v[188:189], v[244:245], v[136:139]
  v_mfma_f32_16x16x16_bf16 v[136:139], v[190:191], v[248:249], v[136:139]
  s_mov_b32 s60, s61
L_v1:
  s_add_u32 s97, s64, 96
  v_mov_b32 v146, s97
  s_mov_b32 s86, s84
  ds_write_b32 v104, v146
  s_add_u32 s64, s64, 2
  s_cmp_lt_u32 s64, s99
  s_cbranch_scc1 L_v11_ok
L_v11_spin:
  v_mov_b32 v144, 61700
  ds_read_b32 v144, v144
  s_waitcnt lgkmcnt(0)
  v_readfirstlane_b32 s99, v144
  s_nop 1
  s_cmp_lt_u32 s64, s99
  s_cbranch_scc0 L_v11_spin
L_v11_ok:
  s_lshr_b32 s71, s64, 5
  s_lshr_b32 s85, s96, s71
  s_bfe_u32 s85, s85, 0x10003
  s_and_b32 s70, s64, 31
  s_lshl_b32 s71, s71, 12
  s_add_u32 s70, s70, s5
  s_add_u32 s70, s70, s71
  s_mul_hi_u32 s84, s70, s90
  s_lshr_b32 s84, s84, 1
  s_mul_i32 s71, s84, 3
  s_sub_u32 s70, s70, s71
  s_lshl3_add_u32 s85, s70, s85
  s_mul_i32 s61, s84, 196608
  s_lshr_b32 s89, s84, 4
  s_lshl_b32 s70, s85, 5
  v_add_u32 v97, s70, v1
  v_mul_u32_u24 v97, 21846, v97
  v_lshrrev_b32 v97, 16, v97
  v_add_u32 v144, s85, v2
  v_lshrrev_b32 v145, v144, s91
  v_and_b32 v145, 1, v145
  v_cmp_eq_u32 s[54:55], 1, v145
  s_nop 1
  s_and_b64 s[52:53], s[54:55], s[58:59]
  s_andn2_b64 s[54:55], s[54:55], s[58:59]
  s_cmp_lt_u32 s64, 96
  s_cselect_b32 s61, s61, 805306368
  s_lshr_b32 s70, s64, 1
  s_cmp_eq_u32 s70, 32
  s_cselect_b32 s48, -36096, s63
  ds_read_b32 v106, v104 offset:8
  s_waitcnt vmcnt(14)
  s_cbranch_vccnz L_vw1_0
  s_waitcnt vmcnt(9)
L_vw1_0:
  buffer_load_dwordx4 v[20:23], v93, s[12:15], s60 offen offset:3072 nt
  v_mov_b32 v114, v112
  v_mov_b32 v115, v113
  v_cvt_f32_i32 v192, v48
  v_cvt_f32_i32 v193, v49
  v_mov_b32_dpp v116, v114 row_newbcast:0 row_mask:0xf bank_mask:0xf
  v_mov_b32_dpp v117, v115 row_newbcast:0 row_mask:0xf bank_mask:0xf
  v_cvt_f32_i32 v194, v50
  v_cvt_f32_i32 v195, v51
  v_pk_add_f32 v[192:193], v[192:193], v[116:117] op_sel_hi:[1,0] neg_lo:[0,1] neg_hi:[0,1]
  v_pk_add_f32 v[194:195], v[194:195], v[116:117] op_sel_hi:[1,0] neg_lo:[0,1] neg_hi:[0,1]
  v_cvt_pk_bf16_f32 v192, 0, v192
  v_cvt_pk_bf16_f32 v193, 0, v193
  v_cvt_pk_bf16_f32 v194, 0, v194
  v_cvt_pk_bf16_f32 v195, 0, v195
  v_pk_mul_f32 v[192:193], v[192:193], v[116:117] op_sel:[0,1]
  v_pk_mul_f32 v[194:195], v[194:195], v[116:117] op_sel:[0,1]
  s_waitcnt lgkmcnt(0)
  v_cmp_lt_u32 vcc, s97, v106
  s_waitcnt vmcnt(14)
  buffer_load_dwordx4 v[24:27], v93, s[12:15], s60 offen offset:3328 nt
  v_cvt_f32_i32 v196, v52
  v_cvt_f32_i32 v197, v53
  v_cvt_f32_i32 v198, v54
  v_cvt_f32_i32 v199, v55
  v_pk_add_f32 v[196:197], v[196:197], v[116:117] op_sel_hi:[1,0] neg_lo:[0,1] neg_hi:[0,1]
  v_pk_add_f32 v[198:199], v[198:199], v[116:117] op_sel_hi:[1,0] neg_lo:[0,1] neg_hi:[0,1]
  v_cvt_pk_bf16_f32 v196, 0, v196
  v_lshlrev_b32 v148, 16, v120
  v_cvt_pk_bf16_f32 v197, 0, v197
  v_and_b32 v149, s65, v120
  v_cvt_pk_bf16_f32 v198, 0, v198
  v_lshlrev_b32 v150, 16, v121
  v_cvt_pk_bf16_f32 v199, 0, v199
  v_and_b32 v151, s65, v121
  v_pk_mul_f32 v[196:197], v[196:197], v[116:117] op_sel:[0,1]
  v_lshlrev_b32 v152, 16, v122
  v_pk_mul_f32 v[198:199], v[198:199], v[116:117] op_sel:[0,1]
  s_waitcnt vmcnt(14)
  buffer_load_dwordx4 v[28:31], v93, s[12:15], s60 offen offset:3584 nt
  v_cvt_f32_i32 v200, v56
  v_cvt_f32_i32 v201, v57
  v_cvt_f32_i32 v202, v58
  v_cvt_f32_i32 v203, v59
  v_pk_add_f32 v[200:201], v[200:201], v[116:117] op_sel_hi:[1,0] neg_lo:[0,1] neg_hi:[0,1]
  v_pk_add_f32 v[202:203], v[202:203], v[116:117] op_sel_hi:[1,0] neg_lo:[0,1] neg_hi:[0,1]
  v_cvt_pk_bf16_f32 v200, 0, v200
  v_and_b32 v153, s65, v122
  v_cvt_pk_bf16_f32 v201, 0, v201
  v_lshlrev_b32 v154, 16, v123
  v_cvt_pk_bf16_f32 v202, 0, v202
  v_and_b32 v155, s65, v123
  v_cvt_pk_bf16_f32 v203, 0, v203
  v_lshlrev_b32 v156, 16, v124
  v_pk_mul_f32 v[200:201], v[200:201], v[116:117] op_sel:[0,1]
  v_and_b32 v157, s65, v124
  v_pk_mul_f32 v[202:203], v[202:203], v[116:117] op_sel:[0,1]
  s_waitcnt vmcnt(14)
  s_cbranch_vccnz L_vw1_3
  s_waitcnt vmcnt(9)
L_vw1_3:
  buffer_load_dwordx4 v[32:35], v94, s[12:15], s60 offen offset:0 nt
  v_cvt_f32_i32 v108, v60
  v_cvt_f32_i32 v109, v61
  v_mov_b32_dpp v116, v114 row_newbcast:1 row_mask:0xf bank_mask:0xf
  v_mov_b32_dpp v117, v115 row_newbcast:1 row_mask:0xf bank_mask:0xf
  v_cvt_f32_i32 v110, v62
  v_cvt_f32_i32 v111, v63
  v_pk_add_f32 v[108:109], v[108:109], v[116:117] op_sel_hi:[1,0] neg_lo:[0,1] neg_hi:[0,1]
  v_pk_add_f32 v[110:111], v[110:111], v[116:117] op_sel_hi:[1,0] neg_lo:[0,1] neg_hi:[0,1]
  s_lshl_b32 s62, s84, 9
  v_lshl_add_u32 v98, v97, 1, v96
  buffer_load_short_d16_hi v112, v98, s[32:35], s62 offen
  buffer_load_short_d16_hi v113, v98, s[28:31], s62 offen
  v_cvt_pk_bf16_f32 v108, 0, v108
  v_lshlrev_b32 v158, 16, v125
  v_cvt_pk_bf16_f32 v109, 0, v109
  v_add_u32 v99, s48, v99
  v_cvt_pk_bf16_f32 v110, 0, v110
  v_add_u32 v100, s48, v100
  v_cvt_pk_bf16_f32 v111, 0, v111
  v_max3_f32 v144, v148, v149, v150
  v_pk_mul_f32 v[108:109], v[108:109], v[116:117] op_sel:[0,1]
  ds_read_b128 v[120:123], v99
  v_pk_mul_f32 v[110:111], v[110:111], v[116:117] op_sel:[0,1]
  v_cvt_pk_bf16_f32 v204, v192, v108
  v_cvt_pk_bf16_f32 v208, v193, v109
  v_cvt_pk_bf16_f32 v212, v194, v110
  v_cvt_pk_bf16_f32 v216, v195, v111
  s_waitcnt vmcnt(16)
  buffer_load_dwordx4 v[36:39], v94, s[12:15], s60 offen offset:256 nt
  v_cvt_f32_i32 v108, v64
  v_cvt_f32_i32 v109, v65
  v_cvt_f32_i32 v110, v66
  v_cvt_f32_i32 v111, v67
  v_pk_add_f32 v[108:109], v[108:109], v[116:117] op_sel_hi:[1,0] neg_lo:[0,1] neg_hi:[0,1]
  v_pk_add_f32 v[110:111], v[110:111], v[116:117] op_sel_hi:[1,0] neg_lo:[0,1] neg_hi:[0,1]
  v_cvt_pk_bf16_f32 v108, 0, v108
  ds_read_b64 v[124:125], v100 offset:256
  v_cvt_pk_bf16_f32 v109, 0, v109
  v_max3_f32 v145, v151, v152, v153
  v_cvt_pk_bf16_f32 v110, 0, v110
  v_max3_f32 v144, v144, v154, v155
  v_cvt_pk_bf16_f32 v111, 0, v111
  v_max3_f32 v145, v145, v156, v157
  v_pk_mul_f32 v[108:109], v[108:109], v[116:117] op_sel:[0,1]
  v_max3_f32 v144, v144, v158, v140
  v_pk_mul_f32 v[110:111], v[110:111], v[116:117] op_sel:[0,1]
  v_cvt_pk_bf16_f32 v220, v196, v108
  v_cvt_pk_bf16_f32 v224, v197, v109
  v_cvt_pk_bf16_f32 v228, v198, v110
  v_cvt_pk_bf16_f32 v232, v199, v111
  s_waitcnt vmcnt(16)
  buffer_load_dwordx4 v[40:43], v94, s[12:15], s60 offen offset:512 nt
  v_cvt_f32_i32 v108, v68
  v_cvt_f32_i32 v109, v69
  v_cvt_f32_i32 v110, v70
  v_cvt_f32_i32 v111, v71
  v_pk_add_f32 v[108:109], v[108:109], v[116:117] op_sel_hi:[1,0] neg_lo:[0,1] neg_hi:[0,1]
  v_pk_add_f32 v[110:111], v[110:111], v[116:117] op_sel_hi:[1,0] neg_lo:[0,1] neg_hi:[0,1]
  v_cvt_pk_bf16_f32 v108, 0, v108
  v_max_f32 v144, v144, v145
  v_cvt_pk_bf16_f32 v109, 0, v109
  v_mov_b32 v145, v144
  v_cvt_pk_bf16_f32 v110, 0, v110
  s_nop 0
  v_permlane32_swap_b32 v144, v145
  v_cvt_pk_bf16_f32 v111, 0, v111
  v_max_f32 v144, v144, v145
  v_pk_mul_f32 v[108:109], v[108:109], v[116:117] op_sel:[0,1]
  v_mov_b32 v145, v144
  v_pk_mul_f32 v[110:111], v[110:111], v[116:117] op_sel:[0,1]
  v_cvt_pk_bf16_f32 v236, v200, v108
  v_cvt_pk_bf16_f32 v240, v201, v109
  v_cvt_pk_bf16_f32 v244, v202, v110
  v_cvt_pk_bf16_f32 v248, v203, v111
  s_waitcnt vmcnt(16)
  s_cbranch_vccnz L_vw1_6
  s_waitcnt vmcnt(11)
L_vw1_6:
  buffer_load_dwordx4 v[44:47], v94, s[12:15], s60 offen offset:768 nt
  v_cvt_f32_i32 v192, v72
  v_cvt_f32_i32 v193, v73
  v_mov_b32_dpp v116, v114 row_newbcast:2 row_mask:0xf bank_mask:0xf
  v_mov_b32_dpp v117, v115 row_newbcast:2 row_mask:0xf bank_mask:0xf
  v_cvt_f32_i32 v194, v74
  v_cvt_f32_i32 v195, v75
  v_pk_add_f32 v[192:193], v[192:193], v[116:117] op_sel_hi:[1,0] neg_lo:[0,1] neg_hi:[0,1]
  v_pk_add_f32 v[194:195], v[194:195], v[116:117] op_sel_hi:[1,0] neg_lo:[0,1] neg_hi:[0,1]
  v_cvt_pk_bf16_f32 v192, 0, v192
  v_permlane16_swap_b32 v144, v145
  v_cvt_pk_bf16_f32 v193, 0, v193
  v_max_f32 v140, v144, v145
  v_cvt_pk_bf16_f32 v194, 0, v194
  v_mul_f32 v144, s66, v140
  v_cvt_pk_bf16_f32 v195, 0, v195
  v_add_f32 v146, v144, v142
  v_pk_mul_f32 v[192:193], v[192:193], v[116:117] op_sel:[0,1]
  v_sub_f32 v142, 0, v144
  v_pk_mul_f32 v[194:195], v[194:195], v[116:117] op_sel:[0,1]
  s_waitcnt vmcnt(16)
  buffer_load_dwordx4 v[48:51], v94, s[12:15], s60 offen offset:1024 nt
  v_cvt_f32_i32 v196, v76
  v_cvt_f32_i32 v197, v77
  v_cvt_f32_i32 v198, v78
  v_cvt_f32_i32 v199, v79
  v_pk_add_f32 v[196:197], v[196:197], v[116:117] op_sel_hi:[1,0] neg_lo:[0,1] neg_hi:[0,1]
  v_pk_add_f32 v[198:199], v[198:199], v[116:117] op_sel_hi:[1,0] neg_lo:[0,1] neg_hi:[0,1]
  v_cvt_pk_bf16_f32 v196, 0, v196
  v_exp_f32 v146, -v146
  v_cvt_pk_bf16_f32 v197, 0, v197
  ds_bpermute_b32 v147, v101, v146
  v_cvt_pk_bf16_f32 v198, 0, v198
  v_fma_f32 v148, v148, s66, v142
  v_cvt_pk_bf16_f32 v199, 0, v199
  v_exp_f32 v148, v148
  v_pk_mul_f32 v[196:197], v[196:197], v[116:117] op_sel:[0,1]
  v_fma_f32 v149, v149, s66, v142
  v_pk_mul_f32 v[198:199], v[198:199], v[116:117] op_sel:[0,1]
  s_waitcnt vmcnt(16)
  buffer_load_dwordx4 v[52:55], v94, s[12:15], s60 offen offset:1280 nt
  v_cvt_f32_i32 v200, v80
  v_cvt_f32_i32 v201, v81
  v_cvt_f32_i32 v202, v82
  v_cvt_f32_i32 v203, v83
  v_pk_add_f32 v[200:201], v[200:201], v[116:117] op_sel_hi:[1,0] neg_lo:[0,1] neg_hi:[0,1]
  v_pk_add_f32 v[202:203], v[202:203], v[116:117] op_sel_hi:[1,0] neg_lo:[0,1] neg_hi:[0,1]
  v_cvt_pk_bf16_f32 v200, 0, v200
  v_exp_f32 v149, v149
  v_cvt_pk_bf16_f32 v201, 0, v201
  v_fma_f32 v150, v150, s66, v142
  v_cvt_pk_bf16_f32 v202, 0, v202
  v_exp_f32 v150, v150
  v_cvt_pk_bf16_f32 v203, 0, v203
  v_fma_f32 v151, v151, s66, v142
  v_pk_mul_f32 v[200:201], v[200:201], v[116:117] op_sel:[0,1]
  v_exp_f32 v151, v151
  v_pk_mul_f32 v[202:203], v[202:203], v[116:117] op_sel:[0,1]
  s_waitcnt vmcnt(16)
  s_cbranch_vccnz L_vw1_9
  s_waitcnt vmcnt(11)
L_vw1_9:
  buffer_load_dwordx4 v[56:59], v94, s[12:15], s60 offen offset:1536 nt
  v_cvt_f32_i32 v108, v84
  v_cvt_f32_i32 v109, v85
  v_mov_b32_dpp v116, v114 row_newbcast:3 row_mask:0xf bank_mask:0xf
  v_mov_b32_dpp v117, v115 row_newbcast:3 row_mask:0xf bank_mask:0xf
  v_cvt_f32_i32 v110, v86
  v_cvt_f32_i32 v111, v87
  v_pk_add_f32 v[108:109], v[108:109], v[116:117] op_sel_hi:[1,0] neg_lo:[0,1] neg_hi:[0,1]
  v_pk_add_f32 v[110:111], v[110:111], v[116:117] op_sel_hi:[1,0] neg_lo:[0,1] neg_hi:[0,1]
  v_cvt_pk_bf16_f32 v108, 0, v108
  v_fma_f32 v152, v152, s66, v142
  v_cvt_pk_bf16_f32 v109, 0, v109
  v_exp_f32 v152, v152
  v_cvt_pk_bf16_f32 v110, 0, v110
  v_fma_f32 v153, v153, s66, v142
  v_cvt_pk_bf16_f32 v111, 0, v111
  v_exp_f32 v153, v153
  v_pk_mul_f32 v[108:109], v[108:109], v[116:117] op_sel:[0,1]
  v_fma_f32 v154, v154, s66, v142
  v_pk_mul_f32 v[110:111], v[110:111], v[116:117] op_sel:[0,1]
  v_cvt_pk_bf16_f32 v205, v192, v108
  v_cvt_pk_bf16_f32 v209, v193, v109
  v_cvt_pk_bf16_f32 v213, v194, v110
  v_cvt_pk_bf16_f32 v217, v195, v111
  s_waitcnt vmcnt(16)
  buffer_load_dwordx4 v[60:63], v94, s[12:15], s60 offen offset:1792 nt
  v_cvt_f32_i32 v108, v88
  v_cvt_f32_i32 v109, v89
  v_cvt_f32_i32 v110, v90
  v_cvt_f32_i32 v111, v91
  v_pk_add_f32 v[108:109], v[108:109], v[116:117] op_sel_hi:[1,0] neg_lo:[0,1] neg_hi:[0,1]
  v_pk_add_f32 v[110:111], v[110:111], v[116:117] op_sel_hi:[1,0] neg_lo:[0,1] neg_hi:[0,1]
  v_cvt_pk_bf16_f32 v108, 0, v108
  v_exp_f32 v154, v154
  v_cvt_pk_bf16_f32 v109, 0, v109
  v_fma_f32 v155, v155, s66, v142
  v_cvt_pk_bf16_f32 v110, 0, v110
  v_exp_f32 v155, v155
  v_cvt_pk_bf16_f32 v111, 0, v111
  v_fma_f32 v156, v156, s66, v142
  v_pk_mul_f32 v[108:109], v[108:109], v[116:117] op_sel:[0,1]
  v_exp_f32 v156, v156
  v_pk_mul_f32 v[110:111], v[110:111], v[116:117] op_sel:[0,1]
  v_cvt_pk_bf16_f32 v221, v196, v108
  v_cvt_pk_bf16_f32 v225, v197, v109
  v_cvt_pk_bf16_f32 v229, v198, v110
  v_cvt_pk_bf16_f32 v233, v199, v111
  s_waitcnt vmcnt(16)
  buffer_load_dwordx4 v[64:67], v94, s[12:15], s60 offen offset:2048 nt
  v_cvt_f32_i32 v108, v4
  v_cvt_f32_i32 v109, v5
  v_cvt_f32_i32 v110, v6
  v_cvt_f32_i32 v111, v7
  v_pk_add_f32 v[108:109], v[108:109], v[116:117] op_sel_hi:[1,0] neg_lo:[0,1] neg_hi:[0,1]
  v_pk_add_f32 v[110:111], v[110:111], v[116:117] op_sel_hi:[1,0] neg_lo:[0,1] neg_hi:[0,1]
  v_cvt_pk_bf16_f32 v108, 0, v108
  v_fma_f32 v157, v157, s66, v142
  v_cvt_pk_bf16_f32 v109, 0, v109
  v_exp_f32 v157, v157
  v_cvt_pk_bf16_f32 v110, 0, v110
  v_fma_f32 v158, v158, s66, v142
  v_cvt_pk_bf16_f32 v111, 0, v111
  v_exp_f32 v158, v158
  v_pk_mul_f32 v[108:109], v[108:109], v[116:117] op_sel:[0,1]
  v_add_f32 v144, v148, v149
  v_pk_mul_f32 v[110:111], v[110:111], v[116:117] op_sel:[0,1]
  v_cvt_pk_bf16_f32 v237, v200, v108
  v_cvt_pk_bf16_f32 v241, v201, v109
  v_cvt_pk_bf16_f32 v245, v202, v110
  v_cvt_pk_bf16_f32 v249, v203, v111
  s_waitcnt vmcnt(16)
  s_cbranch_vccnz L_vw1_12
  s_waitcnt vmcnt(11)
L_vw1_12:
  buffer_load_dwordx4 v[68:71], v94, s[12:15], s60 offen offset:2304 nt
  v_cvt_f32_i32 v192, v8
  v_cvt_f32_i32 v193, v9
  v_mov_b32_dpp v116, v114 row_newbcast:4 row_mask:0xf bank_mask:0xf
  v_mov_b32_dpp v117, v115 row_newbcast:4 row_mask:0xf bank_mask:0xf
  v_cvt_f32_i32 v194, v10
  v_cvt_f32_i32 v195, v11
  v_pk_add_f32 v[192:193], v[192:193], v[116:117] op_sel_hi:[1,0] neg_lo:[0,1] neg_hi:[0,1]
  v_pk_add_f32 v[194:195], v[194:195], v[116:117] op_sel_hi:[1,0] neg_lo:[0,1] neg_hi:[0,1]
  v_cvt_pk_bf16_f32 v192, 0, v192
  v_add_f32 v145, v150, v151
  v_cvt_pk_bf16_f32 v193, 0, v193
  v_add_f32 v144, v144, v152
  v_cvt_pk_bf16_f32 v194, 0, v194
  v_add_f32 v145, v145, v153
  v_cvt_pk_bf16_f32 v195, 0, v195
  v_add_f32 v144, v144, v154
  v_pk_mul_f32 v[192:193], v[192:193], v[116:117] op_sel:[0,1]
  v_add_f32 v145, v145, v155
  v_pk_mul_f32 v[194:195], v[194:195], v[116:117] op_sel:[0,1]
  s_waitcnt vmcnt(16)
  buffer_load_dwordx4 v[72:75], v94, s[12:15], s60 offen offset:2560 nt
  v_cvt_f32_i32 v196, v12
  v_cvt_f32_i32 v197, v13
  v_cvt_f32_i32 v198, v14
  v_cvt_f32_i32 v199, v15
  v_pk_add_f32 v[196:197], v[196:197], v[116:117] op_sel_hi:[1,0] neg_lo:[0,1] neg_hi:[0,1]
  v_pk_add_f32 v[198:199], v[198:199], v[116:117] op_sel_hi:[1,0] neg_lo:[0,1] neg_hi:[0,1]
  v_cvt_pk_bf16_f32 v196, 0, v196
  v_add_f32 v144, v144, v156
  v_cvt_pk_bf16_f32 v197, 0, v197
  v_add_f32 v145, v145, v157
  v_cvt_pk_bf16_f32 v198, 0, v198
  v_add_f32 v144, v144, v158
  v_cvt_pk_bf16_f32 v199, 0, v199
  v_add_f32 v144, v144, v145
  v_pk_mul_f32 v[196:197], v[196:197], v[116:117] op_sel:[0,1]
  v_fma_f32 v143, v143, v146, v144
  v_pk_mul_f32 v[198:199], v[198:199], v[116:117] op_sel:[0,1]
  s_waitcnt vmcnt(16)
  buffer_load_dwordx4 v[76:79], v94, s[12:15], s60 offen offset:2816 nt
  v_cvt_f32_i32 v200, v16
  v_cvt_f32_i32 v201, v17
  v_cvt_f32_i32 v202, v18
  v_cvt_f32_i32 v203, v19
  v_pk_add_f32 v[200:201], v[200:201], v[116:117] op_sel_hi:[1,0] neg_lo:[0,1] neg_hi:[0,1]
  v_pk_add_f32 v[202:203], v[202:203], v[116:117] op_sel_hi:[1,0] neg_lo:[0,1] neg_hi:[0,1]
  v_cvt_pk_bf16_f32 v200, 0, v200
  v_cvt_pk_bf16_f32 v159, v148, v149
  v_cvt_pk_bf16_f32 v201, 0, v201
  v_cvt_pk_bf16_f32 v160, v150, v151
  v_cvt_pk_bf16_f32 v202, 0, v202
  v_cvt_pk_bf16_f32 v161, v152, v153
  v_cvt_pk_bf16_f32 v203, 0, v203
  v_cvt_pk_bf16_f32 v162, v154, v155
  v_pk_mul_f32 v[200:201], v[200:201], v[116:117] op_sel:[0,1]
  v_cvt_pk_bf16_f32 v163, v156, v157
  v_pk_mul_f32 v[202:203], v[202:203], v[116:117] op_sel:[0,1]
  s_waitcnt vmcnt(16)
  s_cbranch_vccnz L_vw1_15
  s_waitcnt vmcnt(9)
L_vw1_15:
  buffer_load_dwordx4 v[80:83], v95, s[12:15], s60 offen offset:0 nt
  v_cvt_f32_i32 v108, v20
  v_cvt_f32_i32 v109, v21
  v_mov_b32_dpp v116, v114 row_newbcast:5 row_mask:0xf bank_mask:0xf
  v_mov_b32_dpp v117, v115 row_newbcast:5 row_mask:0xf bank_mask:0xf
  v_cvt_f32_i32 v110, v22
  v_cvt_f32_i32 v111, v23
  v_pk_add_f32 v[108:109], v[108:109], v[116:117] op_sel_hi:[1,0] neg_lo:[0,1] neg_hi:[0,1]
  v_pk_add_f32 v[110:111], v[110:111], v[116:117] op_sel_hi:[1,0] neg_lo:[0,1] neg_hi:[0,1]
  v_cvt_pk_bf16_f32 v108, 0, v108
  v_cvt_pk_bf16_f32 v164, v158, 0
  v_cvt_pk_bf16_f32 v109, 0, v109
  v_cndmask_b32 v168, 0, v159, s[72:73]
  v_cvt_pk_bf16_f32 v110, 0, v110
  v_cndmask_b32 v169, 0, v160, s[72:73]
  v_cvt_pk_bf16_f32 v111, 0, v111
  v_cndmask_b32 v170, 0, v161, s[72:73]
  v_pk_mul_f32 v[108:109], v[108:109], v[116:117] op_sel:[0,1]
  v_cndmask_b32 v171, 0, v162, s[72:73]
  v_pk_mul_f32 v[110:111], v[110:111], v[116:117] op_sel:[0,1]
  v_cvt_pk_bf16_f32 v206, v192, v108
  v_cvt_pk_bf16_f32 v210, v193, v109
  v_cvt_pk_bf16_f32 v214, v194, v110
  v_cvt_pk_bf16_f32 v218, v195, v111
  s_waitcnt vmcnt(16)
  buffer_load_dwordx4 v[84:87], v95, s[12:15], s60 offen offset:256 nt
  v_cvt_f32_i32 v108, v24
  v_cvt_f32_i32 v109, v25
  v_cvt_f32_i32 v110, v26
  v_cvt_f32_i32 v111, v27
  v_pk_add_f32 v[108:109], v[108:109], v[116:117] op_sel_hi:[1,0] neg_lo:[0,1] neg_hi:[0,1]
  v_pk_add_f32 v[110:111], v[110:111], v[116:117] op_sel_hi:[1,0] neg_lo:[0,1] neg_hi:[0,1]
  v_cvt_pk_bf16_f32 v108, 0, v108
  v_cndmask_b32 v172, 0, v159, s[74:75]
  v_cvt_pk_bf16_f32 v109, 0, v109
  v_cndmask_b32 v173, 0, v160, s[74:75]
  v_cvt_pk_bf16_f32 v110, 0, v110
  v_cndmask_b32 v174, 0, v161, s[74:75]
  v_cvt_pk_bf16_f32 v111, 0, v111
  v_cndmask_b32 v175, 0, v162, s[74:75]
  v_pk_mul_f32 v[108:109], v[108:109], v[116:117] op_sel:[0,1]
  v_cndmask_b32 v176, 0, v159, s[76:77]
  v_pk_mul_f32 v[110:111], v[110:111], v[116:117] op_sel:[0,1]
  v_cvt_pk_bf16_f32 v222, v196, v108
  v_cvt_pk_bf16_f32 v226, v197, v109
  v_cvt_pk_bf16_f32 v230, v198, v110
  v_cvt_pk_bf16_f32 v234, v199, v111
  s_waitcnt vmcnt(16)
  buffer_load_dwordx4 v[88:91], v95, s[12:15], s60 offen offset:512 nt
  v_cvt_f32_i32 v108, v28
  v_cvt_f32_i32 v109, v29
  v_cvt_f32_i32 v110, v30
  v_cvt_f32_i32 v111, v31
  v_pk_add_f32 v[108:109], v[108:109], v[116:117] op_sel_hi:[1,0] neg_lo:[0,1] neg_hi:[0,1]
  v_pk_add_f32 v[110:111], v[110:111], v[116:117] op_sel_hi:[1,0] neg_lo:[0,1] neg_hi:[0,1]
  v_cvt_pk_bf16_f32 v108, 0, v108
  v_cndmask_b32 v177, 0, v160, s[76:77]
  v_cvt_pk_bf16_f32 v109, 0, v109
  v_cndmask_b32 v178, 0, v161, s[76:77]
  v_cvt_pk_bf16_f32 v110, 0, v110
  v_cndmask_b32 v179, 0, v162, s[76:77]
  v_cvt_pk_bf16_f32 v111, 0, v111
  v_cndmask_b32 v180, 0, v159, s[78:79]
  v_pk_mul_f32 v[108:109], v[108:109], v[116:117] op_sel:[0,1]
  v_cndmask_b32 v181, 0, v160, s[78:79]
  v_pk_mul_f32 v[110:111], v[110:111], v[116:117] op_sel:[0,1]
  v_cvt_pk_bf16_f32 v238, v200, v108
  v_cvt_pk_bf16_f32 v242, v201, v109
  v_cvt_pk_bf16_f32 v246, v202, v110
  v_cvt_pk_bf16_f32 v250, v203, v111
  v_mad_u32_u24 v92, v97, s63, v3
  v_add_u32 v93, 768, v92
  v_add_u32 v94, 4608, v92
  v_add_u32 v95, 7680, v92
  v_cndmask_b32 v92, v92, v105, s[52:53]
  v_cndmask_b32 v95, v95, v105, s[54:55]
  s_waitcnt vmcnt(16)
  s_cbranch_vccnz L_vw1_18
  s_waitcnt vmcnt(9)
L_vw1_18:
  buffer_load_dwordx4 v[4:7], v92, s[12:15], s61 offen offset:0 nt
  v_cvt_f32_i32 v192, v32
  v_cvt_f32_i32 v193, v33
  v_mov_b32_dpp v116, v114 row_newbcast:6 row_mask:0xf bank_mask:0xf
  v_mov_b32_dpp v117, v115 row_newbcast:6 row_mask:0xf bank_mask:0xf
  v_cvt_f32_i32 v194, v34
  v_cvt_f32_i32 v195, v35
  v_pk_add_f32 v[192:193], v[192:193], v[116:117] op_sel_hi:[1,0] neg_lo:[0,1] neg_hi:[0,1]
  v_pk_add_f32 v[194:195], v[194:195], v[116:117] op_sel_hi:[1,0] neg_lo:[0,1] neg_hi:[0,1]
  v_cvt_pk_bf16_f32 v192, 0, v192
  v_cndmask_b32 v182, 0, v161, s[78:79]
  v_cvt_pk_bf16_f32 v193, 0, v193
  v_cndmask_b32 v183, 0, v162, s[78:79]
  v_cvt_pk_bf16_f32 v194, 0, v194
  s_waitcnt lgkmcnt(0)
  v_cvt_pk_bf16_f32 v195, 0, v195
  v_mul_f32 v128, v147, v128
  v_pk_mul_f32 v[192:193], v[192:193], v[116:117] op_sel:[0,1]
  v_mul_f32 v129, v147, v129
  v_pk_mul_f32 v[194:195], v[194:195], v[116:117] op_sel:[0,1]
  s_waitcnt vmcnt(14)
  buffer_load_dwordx4 v[8:11], v92, s[12:15], s61 offen offset:256 nt
  v_cvt_f32_i32 v196, v36
  v_cvt_f32_i32 v197, v37
  v_cvt_f32_i32 v198, v38
  v_cvt_f32_i32 v199, v39
  v_pk_add_f32 v[196:197], v[196:197], v[116:117] op_sel_hi:[1,0] neg_lo:[0,1] neg_hi:[0,1]
  v_pk_add_f32 v[198:199], v[198:199], v[116:117] op_sel_hi:[1,0] neg_lo:[0,1] neg_hi:[0,1]
  v_cvt_pk_bf16_f32 v196, 0, v196
  v_mul_f32 v130, v147, v130
  v_cvt_pk_bf16_f32 v197, 0, v197
  v_mul_f32 v131, v147, v131
  v_cvt_pk_bf16_f32 v198, 0, v198
  v_mul_f32 v132, v147, v132
  v_cvt_pk_bf16_f32 v199, 0, v199
  v_mul_f32 v133, v147, v133
  v_pk_mul_f32 v[196:197], v[196:197], v[116:117] op_sel:[0,1]
  v_mul_f32 v134, v147, v134
  v_pk_mul_f32 v[198:199], v[198:199], v[116:117] op_sel:[0,1]
  s_waitcnt vmcnt(14)
  buffer_load_dwordx4 v[12:15], v92, s[12:15], s61 offen offset:512 nt
  v_cvt_f32_i32 v200, v40
  v_cvt_f32_i32 v201, v41
  v_cvt_f32_i32 v202, v42
  v_cvt_f32_i32 v203, v43
  v_pk_add_f32 v[200:201], v[200:201], v[116:117] op_sel_hi:[1,0] neg_lo:[0,1] neg_hi:[0,1]
  v_pk_add_f32 v[202:203], v[202:203], v[116:117] op_sel_hi:[1,0] neg_lo:[0,1] neg_hi:[0,1]
  v_cvt_pk_bf16_f32 v200, 0, v200
  v_mul_f32 v135, v147, v135
  v_cvt_pk_bf16_f32 v201, 0, v201
  v_mul_f32 v136, v147, v136
  v_cvt_pk_bf16_f32 v202, 0, v202
  v_mul_f32 v137, v147, v137
  v_cvt_pk_bf16_f32 v203, 0, v203
  v_mul_f32 v138, v147, v138
  v_pk_mul_f32 v[200:201], v[200:201], v[116:117] op_sel:[0,1]
  v_mul_f32 v139, v147, v139
  v_pk_mul_f32 v[202:203], v[202:203], v[116:117] op_sel:[0,1]
  s_waitcnt vmcnt(14)
  s_cbranch_vccnz L_vw1_21
  s_waitcnt vmcnt(9)
L_vw1_21:
  buffer_load_dwordx4 v[16:19], v93, s[12:15], s61 offen offset:0 nt
  v_cvt_f32_i32 v108, v44
  v_cvt_f32_i32 v109, v45
  v_mov_b32_dpp v116, v114 row_newbcast:7 row_mask:0xf bank_mask:0xf
  v_mov_b32_dpp v117, v115 row_newbcast:7 row_mask:0xf bank_mask:0xf
  v_cvt_f32_i32 v110, v46
  v_cvt_f32_i32 v111, v47
  v_pk_add_f32 v[108:109], v[108:109], v[116:117] op_sel_hi:[1,0] neg_lo:[0,1] neg_hi:[0,1]
  v_pk_add_f32 v[110:111], v[110:111], v[116:117] op_sel_hi:[1,0] neg_lo:[0,1] neg_hi:[0,1]
  v_cvt_pk_bf16_f32 v108, 0, v108
  v_cvt_pk_bf16_f32 v109, 0, v109
  v_cvt_pk_bf16_f32 v110, 0, v110
  v_cvt_pk_bf16_f32 v111, 0, v111
  v_pk_mul_f32 v[108:109], v[108:109], v[116:117] op_sel:[0,1]
  v_pk_mul_f32 v[110:111], v[110:111], v[116:117] op_sel:[0,1]
  v_cvt_pk_bf16_f32 v207, v192, v108
  v_cvt_pk_bf16_f32 v211, v193, v109
  v_cvt_pk_bf16_f32 v215, v194, v110
  v_cvt_pk_bf16_f32 v219, v195, v111
  v_mfma_f32_16x16x32_bf16 v[128:131], v[168:171], v[204:207], v[128:131]
  v_mfma_f32_16x16x32_bf16 v[128:131], v[172:175], v[208:211], v[128:131]
  v_mfma_f32_16x16x32_bf16 v[128:131], v[176:179], v[212:215], v[128:131]
  v_mfma_f32_16x16x32_bf16 v[128:131], v[180:183], v[216:219], v[128:131]
  s_waitcnt vmcnt(14)
  buffer_load_dwordx4 v[20:23], v93, s[12:15], s61 offen offset:256 nt
  v_cvt_f32_i32 v108, v48
  v_cvt_f32_i32 v109, v49
  v_cvt_f32_i32 v110, v50
  v_cvt_f32_i32 v111, v51
  v_pk_add_f32 v[108:109], v[108:109], v[116:117] op_sel_hi:[1,0] neg_lo:[0,1] neg_hi:[0,1]
  v_pk_add_f32 v[110:111], v[110:111], v[116:117] op_sel_hi:[1,0] neg_lo:[0,1] neg_hi:[0,1]
  v_cvt_pk_bf16_f32 v108, 0, v108
  v_cvt_pk_bf16_f32 v109, 0, v109
  v_cvt_pk_bf16_f32 v110, 0, v110
  v_cvt_pk_bf16_f32 v111, 0, v111
  v_pk_mul_f32 v[108:109], v[108:109], v[116:117] op_sel:[0,1]
  v_pk_mul_f32 v[110:111], v[110:111], v[116:117] op_sel:[0,1]
  v_cvt_pk_bf16_f32 v223, v196, v108
  v_cvt_pk_bf16_f32 v227, v197, v109
  v_cvt_pk_bf16_f32 v231, v198, v110
  v_cvt_pk_bf16_f32 v235, v199, v111
  v_mfma_f32_16x16x32_bf16 v[132:135], v[168:171], v[220:223], v[132:135]
  v_mfma_f32_16x16x32_bf16 v[132:135], v[172:175], v[224:227], v[132:135]
  v_mfma_f32_16x16x32_bf16 v[132:135], v[176:179], v[228:231], v[132:135]
  v_mfma_f32_16x16x32_bf16 v[132:135], v[180:183], v[232:235], v[132:135]
  s_waitcnt vmcnt(14)
  buffer_load_dwordx4 v[24:27], v93, s[12:15], s61 offen offset:512 nt
  v_cvt_f32_i32 v108, v52
  v_cvt_f32_i32 v109, v53
  v_cvt_f32_i32 v110, v54
  v_cvt_f32_i32 v111, v55
  v_pk_add_f32 v[108:109], v[108:109], v[116:117] op_sel_hi:[1,0] neg_lo:[0,1] neg_hi:[0,1]
  v_pk_add_f32 v[110:111], v[110:111], v[116:117] op_sel_hi:[1,0] neg_lo:[0,1] neg_hi:[0,1]
  v_cvt_pk_bf16_f32 v108, 0, v108
  v_cvt_pk_bf16_f32 v109, 0, v109
  v_cvt_pk_bf16_f32 v110, 0, v110
  v_cvt_pk_bf16_f32 v111, 0, v111
  v_pk_mul_f32 v[108:109], v[108:109], v[116:117] op_sel:[0,1]
  v_pk_mul_f32 v[110:111], v[110:111], v[116:117] op_sel:[0,1]
  v_cvt_pk_bf16_f32 v239, v200, v108
  v_cvt_pk_bf16_f32 v243, v201, v109
  v_cvt_pk_bf16_f32 v247, v202, v110
  v_cvt_pk_bf16_f32 v251, v203, v111
  v_mfma_f32_16x16x32_bf16 v[136:139], v[168:171], v[236:239], v[136:139]
  v_mfma_f32_16x16x32_bf16 v[136:139], v[172:175], v[240:243], v[136:139]
  v_mfma_f32_16x16x32_bf16 v[136:139], v[176:179], v[244:247], v[136:139]
  v_mfma_f32_16x16x32_bf16 v[136:139], v[180:183], v[248:251], v[136:139]
  s_waitcnt vmcnt(14)
  s_cbranch_vccnz L_vw1_24
  s_waitcnt vmcnt(9)
L_vw1_24:
  buffer_load_dwordx4 v[28:31], v93, s[12:15], s61 offen offset:768 nt
  v_cvt_f32_i32 v192, v56
  v_cvt_f32_i32 v193, v57
  v_mov_b32_dpp v116, v114 row_newbcast:8 row_mask:0xf bank_mask:0xf
  v_mov_b32_dpp v117, v115 row_newbcast:8 row_mask:0xf bank_mask:0xf
  v_cvt_f32_i32 v194, v58
  v_cvt_f32_i32 v195, v59
  v_pk_add_f32 v[192:193], v[192:193], v[116:117] op_sel_hi:[1,0] neg_lo:[0,1] neg_hi:[0,1]
  v_pk_add_f32 v[194:195], v[194:195], v[116:117] op_sel_hi:[1,0] neg_lo:[0,1] neg_hi:[0,1]
  v_cvt_pk_bf16_f32 v192, 0, v192
  v_cndmask_b32 v184, 0, v163, s[72:73]
  v_cvt_pk_bf16_f32 v193, 0, v193
  v_cndmask_b32 v185, 0, v164, s[72:73]
  v_cvt_pk_bf16_f32 v194, 0, v194
  v_cndmask_b32 v186, 0, v163, s[74:75]
  v_cvt_pk_bf16_f32 v195, 0, v195
  v_cndmask_b32 v187, 0, v164, s[74:75]
  v_pk_mul_f32 v[192:193], v[192:193], v[116:117] op_sel:[0,1]
  v_cndmask_b32 v188, 0, v163, s[76:77]
  v_pk_mul_f32 v[194:195], v[194:195], v[116:117] op_sel:[0,1]
  s_waitcnt vmcnt(14)
  buffer_load_dwordx4 v[32:35], v93, s[12:15], s61 offen offset:1024 nt
  v_cvt_f32_i32 v196, v60
  v_cvt_f32_i32 v197, v61
  v_cvt_f32_i32 v198, v62
  v_cvt_f32_i32 v199, v63
  v_pk_add_f32 v[196:197], v[196:197], v[116:117] op_sel_hi:[1,0] neg_lo:[0,1] neg_hi:[0,1]
  v_pk_add_f32 v[198:199], v[198:199], v[116:117] op_sel_hi:[1,0] neg_lo:[0,1] neg_hi:[0,1]
  v_cvt_pk_bf16_f32 v196, 0, v196
  v_cndmask_b32 v189, 0, v164, s[76:77]
  v_cvt_pk_bf16_f32 v197, 0, v197
  v_cndmask_b32 v190, 0, v163, s[78:79]
  v_cvt_pk_bf16_f32 v198, 0, v198
  v_cndmask_b32 v191, 0, v164, s[78:79]
  v_cvt_pk_bf16_f32 v199, 0, v199
  v_pk_mul_f32 v[196:197], v[196:197], v[116:117] op_sel:[0,1]
  v_pk_mul_f32 v[198:199], v[198:199], v[116:117] op_sel:[0,1]
  s_waitcnt vmcnt(14)
  buffer_load_dwordx4 v[36:39], v93, s[12:15], s61 offen offset:1280 nt
  v_cvt_f32_i32 v200, v64
  v_cvt_f32_i32 v201, v65
  v_cvt_f32_i32 v202, v66
  v_cvt_f32_i32 v203, v67
  v_pk_add_f32 v[200:201], v[200:201], v[116:117] op_sel_hi:[1,0] neg_lo:[0,1] neg_hi:[0,1]
  v_pk_add_f32 v[202:203], v[202:203], v[116:117] op_sel_hi:[1,0] neg_lo:[0,1] neg_hi:[0,1]
  v_cvt_pk_bf16_f32 v200, 0, v200
  v_cvt_pk_bf16_f32 v201, 0, v201
  v_cvt_pk_bf16_f32 v202, 0, v202
  v_cvt_pk_bf16_f32 v203, 0, v203
  v_pk_mul_f32 v[200:201], v[200:201], v[116:117] op_sel:[0,1]
  v_pk_mul_f32 v[202:203], v[202:203], v[116:117] op_sel:[0,1]
  s_waitcnt vmcnt(14)
  s_cbranch_vccnz L_vw1_27
  s_waitcnt vmcnt(9)
L_vw1_27:
  buffer_load_dwordx4 v[40:43], v93, s[12:15], s61 offen offset:1536 nt
  v_cvt_f32_i32 v108, v68
  v_cvt_f32_i32 v109, v69
  v_mov_b32_dpp v116, v114 row_newbcast:9 row_mask:0xf bank_mask:0xf
  v_mov_b32_dpp v117, v115 row_newbcast:9 row_mask:0xf bank_mask:0xf
  v_cvt_f32_i32 v110, v70
  v_cvt_f32_i32 v111, v71
  v_pk_add_f32 v[108:109], v[108:109], v[116:117] op_sel_hi:[1,0] neg_lo:[0,1] neg_hi:[0,1]
  v_pk_add_f32 v[110:111], v[110:111], v[116:117] op_sel_hi:[1,0] neg_lo:[0,1] neg_hi:[0,1]
  v_cvt_pk_bf16_f32 v108, 0, v108
  v_cvt_pk_bf16_f32 v109, 0, v109
  v_cvt_pk_bf16_f32 v110, 0, v110
  v_cvt_pk_bf16_f32 v111, 0, v111
  v_pk_mul_f32 v[108:109], v[108:109], v[116:117] op_sel:[0,1]
  v_pk_mul_f32 v[110:111], v[110:111], v[116:117] op_sel:[0,1]
  v_cvt_pk_bf16_f32 v204, v192, v108
  v_cvt_pk_bf16_f32 v208, v193, v109
  v_cvt_pk_bf16_f32 v212, v194, v110
  v_cvt_pk_bf16_f32 v216, v195, v111
  s_waitcnt vmcnt(14)
  buffer_load_dwordx4 v[44:47], v93, s[12:15], s61 offen offset:1792 nt
  v_cvt_f32_i32 v108, v72
  v_cvt_f32_i32 v109, v73
  v_cvt_f32_i32 v110, v74
  v_cvt_f32_i32 v111, v75
  v_pk_add_f32 v[108:109], v[108:109], v[116:117] op_sel_hi:[1,0] neg_lo:[0,1] neg_hi:[0,1]
  v_pk_add_f32 v[110:111], v[110:111], v[116:117] op_sel_hi:[1,0] neg_lo:[0,1] neg_hi:[0,1]
  v_cvt_pk_bf16_f32 v108, 0, v108
  v_cvt_pk_bf16_f32 v109, 0, v109
  v_cvt_pk_bf16_f32 v110, 0, v110
  v_cvt_pk_bf16_f32 v111, 0, v111
  v_pk_mul_f32 v[108:109], v[108:109], v[116:117] op_sel:[0,1]
  v_pk_mul_f32 v[110:111], v[110:111], v[116:117] op_sel:[0,1]
  v_cvt_pk_bf16_f32 v220, v196, v108
  v_cvt_pk_bf16_f32 v224, v197, v109
  v_cvt_pk_bf16_f32 v228, v198, v110
  v_cvt_pk_bf16_f32 v232, v199, v111
  s_waitcnt vmcnt(14)
  buffer_load_dwordx4 v[48:51], v93, s[12:15], s61 offen offset:2048 nt
  v_cvt_f32_i32 v108, v76
  v_cvt_f32_i32 v109, v77
  v_cvt_f32_i32 v110, v78
  v_cvt_f32_i32 v111, v79
  v_pk_add_f32 v[108:109], v[108:109], v[116:117] op_sel_hi:[1,0] neg_lo:[0,1] neg_hi:[0,1]
  v_pk_add_f32 v[110:111], v[110:111], v[116:117] op_sel_hi:[1,0] neg_lo:[0,1] neg_hi:[0,1]
  v_cvt_pk_bf16_f32 v108, 0, v108
  v_cvt_pk_bf16_f32 v109, 0, v109
  v_cvt_pk_bf16_f32 v110, 0, v110
  v_cvt_pk_bf16_f32 v111, 0, v111
  v_pk_mul_f32 v[108:109], v[108:109], v[116:117] op_sel:[0,1]
  v_pk_mul_f32 v[110:111], v[110:111], v[116:117] op_sel:[0,1]
  v_cvt_pk_bf16_f32 v236, v200, v108
  v_cvt_pk_bf16_f32 v240, v201, v109
  v_cvt_pk_bf16_f32 v244, v202, v110
  v_cvt_pk_bf16_f32 v248, v203, v111
  s_waitcnt vmcnt(14)
  s_cbranch_vccnz L_vw1_30
  s_waitcnt vmcnt(9)
L_vw1_30:
  buffer_load_dwordx4 v[52:55], v93, s[12:15], s61 offen offset:2304 nt
  v_cvt_f32_i32 v192, v80
  v_cvt_f32_i32 v193, v81
  v_mov_b32_dpp v116, v114 row_newbcast:10 row_mask:0xf bank_mask:0xf
  v_mov_b32_dpp v117, v115 row_newbcast:10 row_mask:0xf bank_mask:0xf
  v_cvt_f32_i32 v194, v82
  v_cvt_f32_i32 v195, v83
  v_pk_add_f32 v[192:193], v[192:193], v[116:117] op_sel_hi:[1,0] neg_lo:[0,1] neg_hi:[0,1]
  v_pk_add_f32 v[194:195], v[194:195], v[116:117] op_sel_hi:[1,0] neg_lo:[0,1] neg_hi:[0,1]
  v_cvt_pk_bf16_f32 v192, 0, v192
  v_cvt_pk_bf16_f32 v193, 0, v193
  v_cvt_pk_bf16_f32 v194, 0, v194
  v_cvt_pk_bf16_f32 v195, 0, v195
  v_pk_mul_f32 v[192:193], v[192:193], v[116:117] op_sel:[0,1]
  v_pk_mul_f32 v[194:195], v[194:195], v[116:117] op_sel:[0,1]
  v_cvt_pk_bf16_f32 v205, v192, 0
  v_cvt_pk_bf16_f32 v209, v193, 0
  v_cvt_pk_bf16_f32 v213, v194, 0
  v_cvt_pk_bf16_f32 v217, v195, 0
  v_mfma_f32_16x16x16_bf16 v[128:131], v[184:185], v[204:205], v[128:131]
  v_mfma_f32_16x16x16_bf16 v[128:131], v[186:187], v[208:209], v[128:131]
  v_mfma_f32_16x16x16_bf16 v[128:131], v[188:189], v[212:213], v[128:131]
  v_mfma_f32_16x16x16_bf16 v[128:131], v[190:191], v[216:217], v[128:131]
  s_waitcnt vmcnt(14)
  buffer_load_dwordx4 v[56:59], v93, s[12:15], s61 offen offset:2560 nt
  v_cvt_f32_i32 v196, v84
  v_cvt_f32_i32 v197, v85
  v_cvt_f32_i32 v198, v86
  v_cvt_f32_i32 v199, v87
  v_pk_add_f32 v[196:197], v[196:197], v[116:117] op_sel_hi:[1,0] neg_lo:[0,1] neg_hi:[0,1]
  v_pk_add_f32 v[198:199], v[198:199], v[116:117] op_sel_hi:[1,0] neg_lo:[0,1] neg_hi:[0,1]
  v_cvt_pk_bf16_f32 v196, 0, v196
  v_cvt_pk_bf16_f32 v197, 0, v197
  v_cvt_pk_bf16_f32 v198, 0, v198
  v_cvt_pk_bf16_f32 v199, 0, v199
  v_pk_mul_f32 v[196:197], v[196:197], v[116:117] op_sel:[0,1]
  v_pk_mul_f32 v[198:199], v[198:199], v[116:117] op_sel:[0,1]
  v_cvt_pk_bf16_f32 v221, v196, 0
  v_cvt_pk_bf16_f32 v225, v197, 0
  v_cvt_pk_bf16_f32 v229, v198, 0
  v_cvt_pk_bf16_f32 v233, v199, 0
  v_mfma_f32_16x16x16_bf16 v[132:135], v[184:185], v[220:221], v[132:135]
  v_mfma_f32_16x16x16_bf16 v[132:135], v[186:187], v[224:225], v[132:135]
  v_mfma_f32_16x16x16_bf16 v[132:135], v[188:189], v[228:229], v[132:135]
  v_mfma_f32_16x16x16_bf16 v[132:135], v[190:191], v[232:233], v[132:135]
  s_waitcnt vmcnt(14)
  buffer_load_dwordx4 v[60:63], v93, s[12:15], s61 offen offset:2816 nt
  v_cvt_f32_i32 v200, v88
  v_cvt_f32_i32 v201, v89
  v_cvt_f32_i32 v202, v90
  v_cvt_f32_i32 v203, v91
  v_pk_add_f32 v[200:201], v[200:201], v[116:117] op_sel_hi:[1,0] neg_lo:[0,1] neg_hi:[0,1]
  v_pk_add_f32 v[202:203], v[202:203], v[116:117] op_sel_hi:[1,0] neg_lo:[0,1] neg_hi:[0,1]
  v_cvt_pk_bf16_f32 v200, 0, v200
  v_cvt_pk_bf16_f32 v201, 0, v201
  v_cvt_pk_bf16_f32 v202, 0, v202
  v_cvt_pk_bf16_f32 v203, 0, v203
  v_pk_mul_f32 v[200:201], v[200:201], v[116:117] op_sel:[0,1]
  v_pk_mul_f32 v[202:203], v[202:203], v[116:117] op_sel:[0,1]
  v_cvt_pk_bf16_f32 v237, v200, 0
  v_cvt_pk_bf16_f32 v241, v201, 0
  v_cvt_pk_bf16_f32 v245, v202, 0
  v_cvt_pk_bf16_f32 v249, v203, 0
  v_mfma_f32_16x16x16_bf16 v[136:139], v[184:185], v[236:237], v[136:139]
  v_mfma_f32_16x16x16_bf16 v[136:139], v[186:187], v[240:241], v[136:139]
  v_mfma_f32_16x16x16_bf16 v[136:139], v[188:189], v[244:245], v[136:139]
  v_mfma_f32_16x16x16_bf16 v[136:139], v[190:191], v[248:249], v[136:139]
  s_mov_b32 s60, s61
  s_cmp_ge_u32 s64, 96
  s_cbranch_scc1 L_v_done
  s_cmp_eq_u32 s89, s88
  s_cbranch_scc1 L_v0
  s_mov_b32 s88, s89
  s_and_b32 s70, s86, 15
  s_cmp_ge_u32 s70, 12
  s_cselect_b32 s70, 6208, 0
  s_bitcmp1_b32 s86, 4
  s_cselect_b32 s71, 12416, 0
  s_add_u32 s70, s70, s71
  v_mov_b32 v145, v143
  v_add_u32 v144, s70, v102
  v_add_u32 v147, s70, v103
  v_permlane32_swap_b32 v143, v145
  v_add_f32 v143, v143, v145
  v_mov_b32 v145, v143
  ds_write_b128 v144, v[128:131] offset:0
  ds_write_b128 v144, v[132:135] offset:1024
  ds_write_b128 v144, v[136:139] offset:2048
  v_permlane16_swap_b32 v143, v145
  v_add_f32 v143, v143, v145
  ds_write_b64 v147, v[142:143]
  s_waitcnt lgkmcnt(0)
  v_mov_b32 v128, 0
  v_mov_b32 v129, 0
  v_mov_b32 v130, 0
  v_mov_b32 v131, 0
  v_mov_b32 v132, 0
  v_mov_b32 v133, 0
  v_mov_b32 v134, 0
  v_mov_b32 v135, 0
  v_mov_b32 v136, 0
  v_mov_b32 v137, 0
  v_mov_b32 v138, 0
  v_mov_b32 v139, 0
  v_mov_b32 v140, 0xff800000
  v_mov_b32 v142, 0x7f800000
  v_mov_b32 v143, 0
  s_branch L_v0
L_v_done:
  s_and_b32 s70, s86, 15
  s_cmp_ge_u32 s70, 12
  s_cselect_b32 s70, 6208, 0
  s_bitcmp1_b32 s86, 4
  s_cselect_b32 s71, 12416, 0
  s_add_u32 s70, s70, s71
  v_mov_b32 v145, v143
  v_add_u32 v144, s70, v102
  v_add_u32 v147, s70, v103
  v_permlane32_swap_b32 v143, v145
  v_add_f32 v143, v143, v145
  v_mov_b32 v145, v143
  ds_write_b128 v144, v[128:131] offset:0
  ds_write_b128 v144, v[132:135] offset:1024
  ds_write_b128 v144, v[136:139] offset:2048
  v_permlane16_swap_b32 v143, v145
  v_add_f32 v143, v143, v145
  ds_write_b64 v147, v[142:143]
L_finish:
  v_mov_b32 v144, 61728
  ds_read_b128 v[168:171], v144
  ds_read_b128 v[172:175], v144 offset:16
  s_mul_i32 s70, s4, 6208
  s_lshl_b32 s71, s3, 10
  v_lshl_add_u32 v152, v0, 4, s71
  v_lshrrev_b32 v145, 4, v0
  v_lshlrev_b32 v154, 3, v145
  v_add_u32 v154, 43008, v154
  s_sub_u32 s97, 6208, s70
  v_add_u32 v153, s97, v152
  v_add_u32 v140, s70, v152
  s_sub_u32 s97, 12416, s70
  v_add_u32 v112, s97, v154
  s_add_u32 s97, s70, 6208
  v_add_u32 v113, s97, v154
  v_add_u32 v155, 18624, v154
  s_mul_i32 s70, s3, 1152
  v_lshl_add_u32 v156, v0, 4, s70
  v_lshl_add_u32 v157, v145, 4, s70
  v_mul_u32_u24 v146, 384, v145
  v_and_b32 v145, 15, v0
  v_lshl_add_u32 v146, v145, 3, v146
  s_movk_i32 s65, 0xff00
  s_mov_b32 s48, 0x10001
  s_mov_b32 s49, 0x10001
  s_mov_b32 s50, 0x0c0c0400
  s_mov_b32 s51, 0x05040100
  s_mov_b32 s64, 0
  s_waitcnt vmcnt(0) lgkmcnt(0)
  s_barrier
  ds_read2_b64 v[176:179], v154 offset1:4
  ds_read_b128 v[192:195], v152 offset:36864
  ds_read_b128 v[196:199], v152 offset:39936
  ds_read2_b64 v[180:183], v155 offset1:4
  ds_read_b128 v[200:203], v152 offset:55488
  ds_read_b128 v[204:207], v152 offset:58560
  ds_read2_b64 v[184:187], v112 offset1:4
  ds_read_b128 v[208:211], v153 offset:43072
  ds_read_b128 v[212:215], v153 offset:46144
  ds_read2_b64 v[188:191], v113 offset1:4
  ds_read_b128 v[216:219], v140 offset:43072
  ds_read_b128 v[220:223], v140 offset:46144
  v_readfirstlane_b32 s72, v168
  v_readfirstlane_b32 s73, v169
  v_readfirstlane_b32 s74, v170
  v_readfirstlane_b32 s75, v171
  v_readfirstlane_b32 s76, v172
  v_readfirstlane_b32 s77, v173
  v_readfirstlane_b32 s78, v174
  v_bfe_u32 v148, v175, 0, 8
  v_bfe_u32 v149, v175, 8, 8
  v_bfe_u32 v150, v175, 16, 8
  v_bfe_u32 v151, v175, 24, 8
  s_waitcnt lgkmcnt(9)
  v_min_f32 v144, v176, v178
  v_sub_f32 v176, v144, v176
  v_sub_f32 v178, v144, v178
  v_exp_f32 v176, v176
  v_exp_f32 v178, v178
  v_mul_f32 v145, v176, v177
  v_pk_mul_f32 v[192:193], v[192:193], v[176:177] op_sel_hi:[1,0]
  v_pk_mul_f32 v[194:195], v[194:195], v[176:177] op_sel_hi:[1,0]
  v_pk_fma_f32 v[192:193], v[196:197], v[178:179], v[192:193] op_sel_hi:[1,0,1]
  v_pk_fma_f32 v[194:195], v[198:199], v[178:179], v[194:195] op_sel_hi:[1,0,1]
  v_fma_f32 v197, v178, v179, v145
  v_mov_b32 v196, v144
  v_and_or_b32 v192, v192, s65, v148
  v_and_or_b32 v193, v193, s65, v149
  v_and_or_b32 v194, v194, s65, v150
  v_and_or_b32 v195, v195, s65, v151
  v_mov_b32 v199, v175
  buffer_store_dwordx4 v[192:195], v156, s[40:43], s72 offen sc1
  s_mov_b64 exec, s[48:49]
  buffer_store_dwordx4 v[196:199], v157, s[40:43], s72 offen offset:1024 sc1
  s_mov_b64 exec, -1
  s_waitcnt lgkmcnt(6)
  v_min_f32 v144, v180, v182
  v_sub_f32 v180, v144, v180
  v_sub_f32 v182, v144, v182
  v_exp_f32 v180, v180
  v_exp_f32 v182, v182
  v_mul_f32 v145, v180, v181
  v_pk_mul_f32 v[200:201], v[200:201], v[180:181] op_sel_hi:[1,0]
  v_pk_mul_f32 v[202:203], v[202:203], v[180:181] op_sel_hi:[1,0]
  v_pk_fma_f32 v[200:201], v[204:205], v[182:183], v[200:201] op_sel_hi:[1,0,1]
  v_pk_fma_f32 v[202:203], v[206:207], v[182:183], v[202:203] op_sel_hi:[1,0,1]
  v_fma_f32 v205, v182, v183, v145
  v_mov_b32 v204, v144
  v_and_or_b32 v200, v200, s65, v148
  v_and_or_b32 v201, v201, s65, v149
  v_and_or_b32 v202, v202, s65, v150
  v_and_or_b32 v203, v203, s65, v151
  v_mov_b32 v207, v175
  buffer_store_dwordx4 v[200:203], v156, s[40:43], s73 offen sc1
  s_mov_b64 exec, s[48:49]
  buffer_store_dwordx4 v[204:207], v157, s[40:43], s73 offen offset:1024 sc1
  s_mov_b64 exec, -1
  s_waitcnt lgkmcnt(3)
  v_min_f32 v144, v184, v186
  v_sub_f32 v184, v144, v184
  v_sub_f32 v186, v144, v186
  v_exp_f32 v184, v184
  v_exp_f32 v186, v186
  v_mul_f32 v145, v184, v185
  v_pk_mul_f32 v[208:209], v[208:209], v[184:185] op_sel_hi:[1,0]
  v_pk_mul_f32 v[210:211], v[210:211], v[184:185] op_sel_hi:[1,0]
  v_pk_fma_f32 v[208:209], v[212:213], v[186:187], v[208:209] op_sel_hi:[1,0,1]
  v_pk_fma_f32 v[210:211], v[214:215], v[186:187], v[210:211] op_sel_hi:[1,0,1]
  v_fma_f32 v213, v186, v187, v145
  v_mov_b32 v212, v144
  v_and_or_b32 v208, v208, s65, v148
  v_and_or_b32 v209, v209, s65, v149
  v_and_or_b32 v210, v210, s65, v150
  v_and_or_b32 v211, v211, s65, v151
  v_mov_b32 v215, v175
  buffer_store_dwordx4 v[208:211], v156, s[40:43], s74 offen sc1
  s_mov_b64 exec, s[48:49]
  buffer_store_dwordx4 v[212:215], v157, s[40:43], s74 offen offset:1024 sc1
  s_mov_b64 exec, -1
  buffer_load_dwordx4 v[224:227], v156, s[40:43], s75 offen sc1
  buffer_load_dwordx4 v[228:231], v157, s[40:43], s75 offen offset:1024 sc1
  buffer_load_dwordx4 v[232:235], v156, s[40:43], s76 offen sc1
  buffer_load_dwordx4 v[236:239], v157, s[40:43], s76 offen offset:1024 sc1
  buffer_load_dwordx4 v[240:243], v156, s[40:43], s77 offen sc1
  buffer_load_dwordx4 v[244:247], v157, s[40:43], s77 offen offset:1024 sc1
  s_waitcnt lgkmcnt(0)
  v_min_f32 v144, v188, v190
  v_sub_f32 v188, v144, v188
  v_sub_f32 v190, v144, v190
  v_exp_f32 v188, v188
  v_exp_f32 v190, v190
  v_mul_f32 v145, v188, v189
  v_pk_mul_f32 v[216:217], v[216:217], v[188:189] op_sel_hi:[1,0]
  v_pk_mul_f32 v[218:219], v[218:219], v[188:189] op_sel_hi:[1,0]
  v_pk_fma_f32 v[216:217], v[220:221], v[190:191], v[216:217] op_sel_hi:[1,0,1]
  v_pk_fma_f32 v[218:219], v[222:223], v[190:191], v[218:219] op_sel_hi:[1,0,1]
  v_fma_f32 v221, v190, v191, v145
  v_mov_b32 v220, v144
  s_branch L_check
L_gather:
  s_add_u32 s64, s64, 1
  s_cmp_gt_u32 s64, 20000
  s_cbranch_scc1 L_end
  s_bitcmp0_b32 s87, 0
  s_cbranch_scc1 L_have0
  buffer_load_dwordx4 v[224:227], v156, s[40:43], s75 offen sc1
  buffer_load_dwordx4 v[228:231], v157, s[40:43], s75 offen offset:1024 sc1
L_have0:
  s_bitcmp0_b32 s87, 1
  s_cbranch_scc1 L_have1
  buffer_load_dwordx4 v[232:235], v156, s[40:43], s76 offen sc1
  buffer_load_dwordx4 v[236:239], v157, s[40:43], s76 offen offset:1024 sc1
L_have1:
  s_bitcmp0_b32 s87, 2
  s_cbranch_scc1 L_have2
  buffer_load_dwordx4 v[240:243], v156, s[40:43], s77 offen sc1
  buffer_load_dwordx4 v[244:247], v157, s[40:43], s77 offen offset:1024 sc1
L_have2:
L_check:
  s_mov_b32 s87, 0
  s_waitcnt vmcnt(0)
  v_perm_b32 v144, v225, v224, s50
  v_perm_b32 v145, v227, v226, s50
  v_cmp_ne_u32 vcc, v175, v231
  v_perm_b32 v144, v145, v144, s51
  v_cmp_ne_u32 s[70:71], v175, v144
  s_nop 1
  s_or_b64 s[70:71], s[70:71], vcc
  s_cselect_b32 s70, 1, 0
  s_or_b32 s87, s87, s70
  v_perm_b32 v144, v233, v232, s50
  v_perm_b32 v145, v235, v234, s50
  v_cmp_ne_u32 vcc, v175, v239
  v_perm_b32 v144, v145, v144, s51
  v_cmp_ne_u32 s[70:71], v175, v144
  s_nop 1
  s_or_b64 s[70:71], s[70:71], vcc
  s_cselect_b32 s70, 2, 0
  s_or_b32 s87, s87, s70
  v_perm_b32 v144, v241, v240, s50
  v_perm_b32 v145, v243, v242, s50
  v_cmp_ne_u32 vcc, v175, v247
  v_perm_b32 v144, v145, v144, s51
  v_cmp_ne_u32 s[70:71], v175, v144
  s_nop 1
  s_or_b64 s[70:71], s[70:71], vcc
  s_cselect_b32 s70, 4, 0
  s_or_b32 s87, s87, s70
  s_cbranch_scc1 L_gather
  v_min_f32 v144, v220, v228
  v_min3_f32 v144, v144, v236, v244
  v_sub_f32 v220, v144, v220
  v_sub_f32 v228, v144, v228
  v_sub_f32 v236, v144, v236
  v_sub_f32 v244, v144, v244
  v_exp_f32 v220, v220
  v_exp_f32 v228, v228
  v_exp_f32 v236, v236
  v_exp_f32 v244, v244
  v_and_b32 v216, s65, v216
  v_and_b32 v217, s65, v217
  v_and_b32 v218, s65, v218
  v_and_b32 v219, s65, v219
  v_and_b32 v224, s65, v224
  v_and_b32 v225, s65, v225
  v_and_b32 v226, s65, v226
  v_and_b32 v227, s65, v227
  v_and_b32 v232, s65, v232
  v_and_b32 v233, s65, v233
  v_and_b32 v234, s65, v234
  v_and_b32 v235, s65, v235
  v_and_b32 v240, s65, v240
  v_and_b32 v241, s65, v241
  v_and_b32 v242, s65, v242
  v_and_b32 v243, s65, v243
  v_mul_f32 v221, v220, v221
  v_mul_f32 v229, v228, v229
  v_mul_f32 v237, v236, v237
  v_mul_f32 v245, v244, v245
  v_add_f32 v221, v221, v229
  v_add_f32 v237, v237, v245
  v_add_f32 v144, v221, v237
  v_rcp_f32 v144, v144
  s_lshl_b32 s70, s3, 7
  s_add_u32 s70, s70, s78
  v_pk_mul_f32 v[216:217], v[216:217], v[220:221] op_sel_hi:[1,0]
  v_pk_mul_f32 v[224:225], v[224:225], v[228:229] op_sel_hi:[1,0]
  v_pk_mul_f32 v[232:233], v[232:233], v[236:237] op_sel_hi:[1,0]
  v_pk_mul_f32 v[240:241], v[240:241], v[244:245] op_sel_hi:[1,0]
  v_pk_add_f32 v[216:217], v[216:217], v[224:225]
  v_pk_add_f32 v[232:233], v[232:233], v[240:241]
  v_pk_add_f32 v[216:217], v[216:217], v[232:233]
  v_pk_mul_f32 v[216:217], v[216:217], v[144:145] op_sel_hi:[1,0]
  v_cvt_pk_bf16_f32 v128, v216, v217
  v_pk_mul_f32 v[218:219], v[218:219], v[220:221] op_sel_hi:[1,0]
  v_pk_mul_f32 v[226:227], v[226:227], v[228:229] op_sel_hi:[1,0]
  v_pk_mul_f32 v[234:235], v[234:235], v[236:237] op_sel_hi:[1,0]
  v_pk_mul_f32 v[242:243], v[242:243], v[244:245] op_sel_hi:[1,0]
  v_pk_add_f32 v[218:219], v[218:219], v[226:227]
  v_pk_add_f32 v[234:235], v[234:235], v[242:243]
  v_pk_add_f32 v[218:219], v[218:219], v[234:235]
  v_pk_mul_f32 v[218:219], v[218:219], v[144:145] op_sel_hi:[1,0]
  v_cvt_pk_bf16_f32 v129, v218, v219
  buffer_store_dwordx2 v[128:129], v146, s[36:39], s70 offen
L_fin:
L_end:
  s_endpgm
L_helper:
  v_lshlrev_b32 v1, 2, v0
  v_add_u32 v1, 61696, v1
  v_mov_b32 v2, 0
  s_mov_b64 exec, 0xff
  ds_write_b32 v1, v2
  s_mov_b64 exec, -1
  s_waitcnt lgkmcnt(0)
  s_mov_b32 s8, s46
  s_and_b32 s9, s47, 0xffff
  s_mov_b32 s36, s44
  s_and_b32 s37, s45, 0xffff
  s_mov_b32 s16, s46
  s_and_b32 s17, s47, 0xffff
  s_mov_b32 s12, s48
  s_and_b32 s13, s49, 0xffff
  s_mov_b32 s40, s82
  s_and_b32 s41, s83, 0xffff
  s_mov_b32 s36, s58
  s_and_b32 s37, s59, 0xffff
  s_barrier
  s_memrealtime s[72:73]
  s_getpc_b64 s[54:55]
L_h_pc:
  s_add_u32 s86, s54, L_h_cp - L_h_pc
  s_addc_u32 s87, s55, 0
  s_sub_u32 s54, s54, L_h_pc - L_k
  s_subb_u32 s55, s55, 0
  s_and_b32 s54, s54, -16
  s_lshr_b32 s70, s2, 3
  s_lshl_b32 s70, s70, 10
  v_lshl_add_u32 v106, v0, 4, s70
  v_mov_b32 v107, s55
  v_add_co_u32 v106, vcc, s54, v106
  s_nop 1
  v_addc_co_u32 v107, vcc, 0, v107, vcc
  s_lshr_b32 s70, s2, 3
  s_cmp_lt_u32 s70, (L_code_end - L_k) / 1024
  s_cbranch_scc0 L_h_cta
  global_load_dwordx4 v[108:111], v[106:107], off
L_h_cta:
  s_lshr_b32 s70, s2, 4
  s_and_b32 s70, s70, 8
  s_and_b32 s71, s2, 7
  s_add_u32 s70, s70, s71
  s_lshl_b32 s70, s70, 4
  v_lshl_add_u32 v104, v0, 3, s70
  v_and_b32 v105, 31, v0
  v_lshlrev_b32 v105, 3, v105
  v_and_b32 v112, 1, v0
  v_lshlrev_b32 v112, 2, v112
  v_add_u32 v112, 61712, v112
  v_mov_b32 v113, 0
  v_lshlrev_b32 v3, 4, v0
  s_mov_b32 s76, 12
  s_mov_b32 s77, 7340032
  s_getreg_b32 s50, hwreg(HW_REG_XCC_ID)
  s_bfe_u32 s50, s50, 0x10002
  s_bfe_u32 s52, s2, 0x30003
  s_cmp_eq_u32 s52, 7
  s_cbranch_scc1 L_h_voted
  s_lshr_b32 s70, s2, 6
  s_xor_b32 s70, s70, s2
  s_and_b32 s70, s70, 3
  s_cbranch_scc1 L_h_voted
  s_cmp_eq_u32 s52, 6
  s_cbranch_scc0 L_h_probe
  s_xor_b32 s48, s50, s4
  s_and_b32 s52, s2, 3
  s_lshl2_add_u32 s52, s52, 36
  s_branch L_h_vote
L_h_probe:
  s_cmp_ge_u32 s52, 3
  s_cselect_b32 s16, s12, s8
  s_cselect_b32 s17, s13, s9
  s_cselect_b32 s70, 3, 0
  s_sub_u32 s70, s52, s70
  s_lshl_b32 s70, s70, 28
  s_add_u32 s44, s5, s4
  s_lshl_b32 s44, s44, 16
  s_add_u32 s44, s44, s70
  s_add_u32 s44, s44, 0x1c0000
  s_mul_i32 s70, s2, 0x2a95
  s_and_b32 s70, s70, 0x7f80
  s_add_u32 s44, s44, s70
  s_add_u32 s70, s44, 0x8000
  s_buffer_load_dword s58, s[16:19], s70
  s_mov_b32 s45, -1
  s_mov_b32 s46, -1
  s_mul_i32 s52, s52, 6
L_h_progp:
  s_sleep 2
  ds_read_b32 v8, v112
  s_waitcnt lgkmcnt(0)
  v_cmp_gt_u32 vcc, 1, v8
  s_nop 1
  s_cmp_lg_u32 vcc_lo, 0
  s_cbranch_scc1 L_h_progp
  s_xor_b32 s70, s44, 0
  s_memtime s[54:55]
  s_waitcnt lgkmcnt(0)
  s_buffer_load_dword s58, s[16:19], s70
  s_waitcnt lgkmcnt(0)
  s_memtime s[56:57]
  s_waitcnt lgkmcnt(0)
  s_sub_u32 s56, s56, s54
  s_min_u32 s45, s45, s56
  s_xor_b32 s70, s44, 8192
  s_memtime s[54:55]
  s_waitcnt lgkmcnt(0)
  s_buffer_load_dword s58, s[16:19], s70
  s_waitcnt lgkmcnt(0)
  s_memtime s[56:57]
  s_waitcnt lgkmcnt(0)
  s_sub_u32 s56, s56, s54
  s_min_u32 s46, s46, s56
  s_xor_b32 s70, s44, 25472
  s_memtime s[54:55]
  s_waitcnt lgkmcnt(0)
  s_buffer_load_dword s58, s[16:19], s70
  s_waitcnt lgkmcnt(0)
  s_memtime s[56:57]
  s_waitcnt lgkmcnt(0)
  s_sub_u32 s56, s56, s54
  s_min_u32 s46, s46, s56
  s_xor_b32 s70, s44, 17280
  s_memtime s[54:55]
  s_waitcnt lgkmcnt(0)
  s_buffer_load_dword s58, s[16:19], s70
  s_waitcnt lgkmcnt(0)
  s_memtime s[56:57]
  s_waitcnt lgkmcnt(0)
  s_sub_u32 s56, s56, s54
  s_min_u32 s45, s45, s56
  s_xor_b32 s70, s44, 5888
  s_memtime s[54:55]
  s_waitcnt lgkmcnt(0)
  s_buffer_load_dword s58, s[16:19], s70
  s_waitcnt lgkmcnt(0)
  s_memtime s[56:57]
  s_waitcnt lgkmcnt(0)
  s_sub_u32 s56, s56, s54
  s_min_u32 s45, s45, s56
  s_xor_b32 s70, s44, 14080
  s_memtime s[54:55]
  s_waitcnt lgkmcnt(0)
  s_buffer_load_dword s58, s[16:19], s70
  s_waitcnt lgkmcnt(0)
  s_memtime s[56:57]
  s_waitcnt lgkmcnt(0)
  s_sub_u32 s56, s56, s54
  s_min_u32 s46, s46, s56
  s_cmp_lt_u32 s46, s45
  s_cselect_b32 s48, 1, 0
  s_lshr_b32 s70, s44, 13
  s_xor_b32 s70, s70, s2
  s_xor_b32 s70, s70, s50
  s_and_b32 s70, s70, 1
  s_xor_b32 s48, s48, s70
L_h_vote:
  s_mov_b32 s49, 0
  s_lshl_b64 s[48:49], s[48:49], s52
  s_or_b32 s49, s49, 0x1000000
  s_atomic_add_x2 s[48:49], s[80:81], 0
L_h_voted:
  s_waitcnt lgkmcnt(0)
  s_cmp_lg_u32 s2, 56
  s_cbranch_scc1 L_h_nonce
  s_lshl_b64 s[54:55], s[72:73], 2
  s_atomic_add_x2 s[54:55], s[80:81], 8
  s_waitcnt lgkmcnt(0)
L_h_nonce:
L_h_progv:
  s_sleep 8
  ds_read_b32 v8, v112
  s_waitcnt lgkmcnt(0)
  v_cmp_gt_u32 vcc, 6, v8
  s_nop 1
  s_cmp_lg_u32 vcc_lo, 0
  s_cbranch_scc1 L_h_progv
  s_load_dwordx2 s[48:49], s[80:81], 0
  s_mov_b32 s59, 0
L_h_votes:
  s_waitcnt lgkmcnt(0)
  s_lshr_b32 s70, s49, 24
  s_cmp_eq_u32 s70, 56
  s_cbranch_scc1 L_h_votes_done
  s_add_u32 s59, s59, 1
  s_cmp_gt_u32 s59, 2000
  s_cbranch_scc1 L_h_votes_done
  s_sleep 64
  s_mov_b64 s[48:49], 0
  s_atomic_or_x2 s[48:49], s[80:81], 0 glc
  s_branch L_h_votes
L_h_votes_done:
  s_mov_b32 s96, 0x80
  s_bfe_u64 s[54:55], s[48:49], 0x60000
  s_cmp_gt_u32 s54, 4
  s_cselect_b32 s56, 1, 0
  s_or_b32 s96, s96, s56
  s_bfe_u64 s[54:55], s[48:49], 0x60006
  s_cmp_gt_u32 s54, 4
  s_cselect_b32 s56, 2, 0
  s_or_b32 s96, s96, s56
  s_bfe_u64 s[54:55], s[48:49], 0x6000c
  s_cmp_gt_u32 s54, 4
  s_cselect_b32 s56, 4, 0
  s_or_b32 s96, s96, s56
  s_bfe_u64 s[54:55], s[48:49], 0x60012
  s_cmp_gt_u32 s54, 4
  s_cselect_b32 s56, 8, 0
  s_or_b32 s96, s96, s56
  s_bfe_u64 s[54:55], s[48:49], 0x60018
  s_cmp_gt_u32 s54, 4
  s_cselect_b32 s56, 16, 0
  s_or_b32 s96, s96, s56
  s_bfe_u64 s[54:55], s[48:49], 0x6001e
  s_cmp_gt_u32 s54, 4
  s_cselect_b32 s56, 32, 0
  s_or_b32 s96, s96, s56
  s_and_b32 s70, s2, 3
  s_lshl2_add_u32 s70, s70, 5
  s_lshr_b32 s54, s49, s70
  s_xor_b32 s54, s54, s2
  s_xor_b32 s54, s54, s4
  s_and_b32 s54, s54, 1
  s_mul_i32 s54, s54, 63
  s_xor_b32 s96, s96, s54
  v_mov_b32 v1, 61696
  v_mov_b32 v5, s96
  ds_write_b32 v1, v5
  s_load_dwordx2 s[74:75], s[80:81], 8
  s_mov_b32 s59, 0
L_h_getnonce:
  s_waitcnt lgkmcnt(0)
  s_cmp_lg_u64 s[74:75], 0
  s_cbranch_scc1 L_h_gotnonce
  s_add_u32 s59, s59, 1
  s_cmp_gt_u32 s59, 2000
  s_cbranch_scc1 L_h_gotnonce
  s_sleep 64
  s_atomic_or_x2 s[74:75], s[80:81], 8 glc
  s_branch L_h_getnonce
L_h_gotnonce:
  s_lshr_b64 s[54:55], s[74:75], 2
  v_writelane_b32 v8, s54, 7
  s_lshr_b32 s64, s5, 5
  s_mov_b32 s50, 0xaaaaaaab
  s_add_u32 s54, s64, 0
  s_mul_hi_u32 s56, s54, s50
  s_lshr_b32 s56, s56, 1
  s_mul_i32 s56, s56, 3
  s_sub_u32 s54, s54, s56
  s_lshr_b32 s56, s96, s54
  s_bfe_u32 s56, s56, 0x10003
  s_lshl_b32 s54, s54, 7
  s_add_u32 s54, s54, s64
  s_mul_hi_u32 s54, s54, s50
  s_lshr_b32 s54, s54, 1
  s_lshl3_add_u32 s54, s54, s56
  s_mul_i32 s70, s54, 3456
  s_add_u32 s70, s70, 1048576
  v_writelane_b32 v8, s70, 0
  s_add_u32 s54, s64, 4
  s_mul_hi_u32 s56, s54, s50
  s_lshr_b32 s56, s56, 1
  s_mul_i32 s56, s56, 3
  s_sub_u32 s54, s54, s56
  s_lshr_b32 s56, s96, s54
  s_bfe_u32 s56, s56, 0x10003
  s_lshl_b32 s54, s54, 7
  s_add_u32 s54, s54, s64
  s_mul_hi_u32 s54, s54, s50
  s_lshr_b32 s54, s54, 1
  s_lshl3_add_u32 s54, s54, s56
  s_add_u32 s54, s54, 6
  s_mul_i32 s70, s54, 3456
  s_add_u32 s70, s70, 1048576
  v_writelane_b32 v8, s70, 1
  s_add_u32 s54, s64, 2
  s_mul_hi_u32 s56, s54, s50
  s_lshr_b32 s56, s56, 1
  s_mul_i32 s56, s56, 3
  s_sub_u32 s54, s54, s56
  s_lshr_b32 s56, s96, s54
  s_bfe_u32 s56, s56, 0x10003
  s_lshl_b32 s54, s54, 7
  s_add_u32 s54, s54, s64
  s_mul_hi_u32 s54, s54, s50
  s_lshr_b32 s54, s54, 1
  s_lshl3_add_u32 s54, s54, s56
  s_lshl_b32 s56, s4, 1
  s_sub_u32 s57, s54, s56
  s_add_u32 s57, s57, 4
  s_mul_i32 s70, s57, 3456
  s_add_u32 s70, s70, 1048576
  v_writelane_b32 v8, s70, 2
  s_add_u32 s54, s54, s56
  s_add_u32 s54, s54, 2
  s_xor_b32 s56, s54, 1
  s_mul_i32 s70, s56, 3456
  s_add_u32 s70, s70, 1048576
  v_writelane_b32 v8, s70, 3
  s_andn2_b32 s56, s54, 1
  s_xor_b32 s56, s56, 2
  s_mul_i32 s70, s56, 3456
  s_add_u32 s70, s70, 1048576
  v_writelane_b32 v8, s70, 4
  s_add_u32 s56, s56, 1
  s_mul_i32 s70, s56, 3456
  s_add_u32 s70, s70, 1048576
  v_writelane_b32 v8, s70, 5
  s_lshr_b32 s54, s54, 2
  s_mul_i32 s54, s54, 1536
  v_writelane_b32 v8, s54, 6
  v_lshlrev_b32 v1, 2, v0
  s_mov_b64 exec, 0xff
  ds_write_b32 v1, v8 offset:61728
  s_mov_b64 exec, -1
  s_lshl_b32 s62, s2, 8
  s_add_u32 s62, s62, 7405568
  s_xor_b32 s63, s62, 1024
  s_lshr_b32 s58, s96, 3
  s_xor_b32 s58, s58, s96
  s_lshr_b32 s70, s5, 4
  s_lshr_b32 s44, s70, 5
  s_lshl_b32 s44, s44, 21
  s_add_u32 s44, s44, 8388608
  s_and_b32 s64, s70, 31
  s_add_u32 s70, s64, s4
  s_lshl_b32 s70, s70, 10
  s_add_u32 s60, s44, s70
  s_xor_b32 s61, s60, 1024
  s_mov_b32 s78, 60
  s_swappc_b64 s[84:85], s[86:87]
L_h_proga:
  s_sleep 4
  ds_read_b32 v8, v112
  s_waitcnt lgkmcnt(0)
  v_cmp_gt_u32 vcc, 64, v8
  s_nop 1
  s_cmp_lg_u32 vcc_lo, 0
  s_cbranch_scc1 L_h_proga
  ds_read_b128 v[8:11], v3 offset:0
  ds_read_b128 v[12:15], v3 offset:1024
  ds_read_b128 v[16:19], v3 offset:2048
  s_waitcnt lgkmcnt(0)
  s_xor_b32 s70, s60, 0
  buffer_store_dwordx4 v[8:11], v3, s[40:43], s70 offen sc1
  s_xor_b32 s70, s60, 32768
  buffer_store_dwordx4 v[12:15], v3, s[40:43], s70 offen sc1
  s_xor_b32 s70, s60, 65536
  buffer_store_dwordx4 v[16:19], v3, s[40:43], s70 offen sc1
  s_bitcmp0_b32 s58, 2
  s_cbranch_scc1 L_h_e0
  ds_read_b128 v[20:23], v3 offset:3072
  ds_read_b128 v[24:27], v3 offset:4096
  ds_read_b128 v[28:31], v3 offset:5120
  ds_read_b128 v[32:35], v3 offset:6144
  ds_read_b128 v[36:39], v3 offset:7168
  ds_read_b128 v[40:43], v3 offset:8192
  ds_read_b128 v[44:47], v3 offset:9216
  ds_read_b128 v[48:51], v3 offset:10240
  ds_read_b128 v[52:55], v3 offset:11264
  s_waitcnt lgkmcnt(0)
  s_xor_b32 s70, s60, 98304
  buffer_store_dwordx4 v[20:23], v3, s[40:43], s70 offen sc1
  s_xor_b32 s70, s60, 132096
  buffer_store_dwordx4 v[24:27], v3, s[40:43], s70 offen sc1
  s_xor_b32 s70, s60, 164864
  buffer_store_dwordx4 v[28:31], v3, s[40:43], s70 offen sc1
  s_xor_b32 s70, s60, 197632
  buffer_store_dwordx4 v[32:35], v3, s[40:43], s70 offen sc1
  s_xor_b32 s70, s60, 230400
  buffer_store_dwordx4 v[36:39], v3, s[40:43], s70 offen sc1
  s_xor_b32 s70, s60, 264192
  buffer_store_dwordx4 v[40:43], v3, s[40:43], s70 offen sc1
  s_xor_b32 s70, s60, 296960
  buffer_store_dwordx4 v[44:47], v3, s[40:43], s70 offen sc1
  s_xor_b32 s70, s60, 329728
  buffer_store_dwordx4 v[48:51], v3, s[40:43], s70 offen sc1
  s_xor_b32 s70, s60, 362496
  buffer_store_dwordx4 v[52:55], v3, s[40:43], s70 offen sc1
L_h_e0:
  s_bitcmp0_b32 s58, 0
  s_cbranch_scc1 L_h_e1
  ds_read_b128 v[56:59], v3 offset:12288
  ds_read_b128 v[60:63], v3 offset:13312
  ds_read_b128 v[64:67], v3 offset:14336
  ds_read_b128 v[68:71], v3 offset:15360
  ds_read_b128 v[72:75], v3 offset:16384
  ds_read_b128 v[76:79], v3 offset:17408
  ds_read_b128 v[80:83], v3 offset:18432
  ds_read_b128 v[84:87], v3 offset:19456
  ds_read_b128 v[88:91], v3 offset:20480
  ds_read_b128 v[92:95], v3 offset:21504
  ds_read_b128 v[96:99], v3 offset:22528
  ds_read_b128 v[100:103], v3 offset:23552
  s_waitcnt lgkmcnt(0)
  s_xor_b32 s70, s60, 396288
  buffer_store_dwordx4 v[56:59], v3, s[40:43], s70 offen sc1
  s_xor_b32 s70, s60, 429056
  buffer_store_dwordx4 v[60:63], v3, s[40:43], s70 offen sc1
  s_xor_b32 s70, s60, 461824
  buffer_store_dwordx4 v[64:67], v3, s[40:43], s70 offen sc1
  s_xor_b32 s70, s60, 494592
  buffer_store_dwordx4 v[68:71], v3, s[40:43], s70 offen sc1
  s_xor_b32 s70, s60, 541696
  buffer_store_dwordx4 v[72:75], v3, s[40:43], s70 offen sc1
  s_xor_b32 s70, s60, 574464
  buffer_store_dwordx4 v[76:79], v3, s[40:43], s70 offen sc1
  s_xor_b32 s70, s60, 607232
  buffer_store_dwordx4 v[80:83], v3, s[40:43], s70 offen sc1
  s_xor_b32 s70, s60, 640000
  buffer_store_dwordx4 v[84:87], v3, s[40:43], s70 offen sc1
  s_xor_b32 s70, s60, 671744
  buffer_store_dwordx4 v[88:91], v3, s[40:43], s70 offen sc1
  s_xor_b32 s70, s60, 704512
  buffer_store_dwordx4 v[92:95], v3, s[40:43], s70 offen sc1
  s_xor_b32 s70, s60, 737280
  buffer_store_dwordx4 v[96:99], v3, s[40:43], s70 offen sc1
  s_xor_b32 s70, s60, 770048
  buffer_store_dwordx4 v[100:103], v3, s[40:43], s70 offen sc1
L_h_e1:
  s_add_u32 s54, s74, 1
  v_mov_b32 v5, 0
  s_waitcnt vmcnt(0)
  v_mov_b32 v8, s54
  v_mov_b32 v9, s75
  s_mov_b64 exec, 1
  buffer_store_dwordx2 v[8:9], v5, s[40:43], s62 offen sc1
  s_mov_b32 s59, 0
L_h_flaga:
  buffer_load_dwordx2 v[10:11], v5, s[40:43], s63 offen sc1
  s_waitcnt vmcnt(0)
  v_readfirstlane_b32 s56, v10
  v_readfirstlane_b32 s57, v11
  s_nop 0
  s_sub_u32 s56, s56, s54
  s_xor_b32 s57, s57, s75
  s_lshr_b32 s56, s56, 1
  s_or_b32 s56, s56, s57
  s_cbranch_scc0 L_h_flaga_done
  s_add_u32 s59, s59, 1
  s_cmp_gt_u32 s59, 10000
  s_cbranch_scc1 L_h_flaga_done
  s_sleep 8
  s_branch L_h_flaga
L_h_flaga_done:
  s_mov_b64 exec, -1
  s_bfe_u32 s54, s96, 0x10005
  s_mul_i32 s54, s54, 384
  v_lshrrev_b32 v4, 3, v0
  v_add_u32 v5, 0, v4
  v_mul_u32_u24 v5, 21846, v5
  v_bfe_u32 v5, v5, 16, 1
  v_mul_u32_u24 v6, 384, v5
  v_sub_u32 v6, v3, v6
  v_add_u32 v6, s54, v6
  v_add_u32 v6, 0, v6
  v_add_u32 v5, s64, v5
  v_lshrrev_b32 v2, 12, v6
  v_xor_b32 v5, v5, v2
  v_lshrrev_b32 v2, 10, v6
  v_lshl_add_u32 v5, v2, 5, v5
  v_and_b32 v6, 1023, v6
  v_lshl_add_u32 v5, v5, 10, v6
  buffer_load_dwordx4 v[8:11], v5, s[40:43], s44 offen sc1
  v_add_u32 v5, 8, v4
  v_mul_u32_u24 v5, 21846, v5
  v_bfe_u32 v5, v5, 16, 1
  v_mul_u32_u24 v6, 384, v5
  v_sub_u32 v6, v3, v6
  v_add_u32 v6, s54, v6
  v_add_u32 v6, 1024, v6
  v_add_u32 v5, s64, v5
  v_lshrrev_b32 v2, 12, v6
  v_xor_b32 v5, v5, v2
  v_lshrrev_b32 v2, 10, v6
  v_lshl_add_u32 v5, v2, 5, v5
  v_and_b32 v6, 1023, v6
  v_lshl_add_u32 v5, v5, 10, v6
  buffer_load_dwordx4 v[12:15], v5, s[40:43], s44 offen sc1
  v_add_u32 v5, 16, v4
  v_mul_u32_u24 v5, 21846, v5
  v_bfe_u32 v5, v5, 16, 1
  v_mul_u32_u24 v6, 384, v5
  v_sub_u32 v6, v3, v6
  v_add_u32 v6, s54, v6
  v_add_u32 v6, 2048, v6
  v_add_u32 v5, s64, v5
  v_lshrrev_b32 v2, 12, v6
  v_xor_b32 v5, v5, v2
  v_lshrrev_b32 v2, 10, v6
  v_lshl_add_u32 v5, v2, 5, v5
  v_and_b32 v6, 1023, v6
  v_lshl_add_u32 v5, v5, 10, v6
  buffer_load_dwordx4 v[16:19], v5, s[40:43], s44 offen sc1
  s_bitcmp0_b32 s58, 2
  s_cbranch_scc1 L_h_i0
  s_xor_b32 s70, s61, 98304
  buffer_load_dwordx4 v[20:23], v3, s[40:43], s70 offen sc1
  s_xor_b32 s70, s61, 132096
  buffer_load_dwordx4 v[24:27], v3, s[40:43], s70 offen sc1
  s_xor_b32 s70, s61, 164864
  buffer_load_dwordx4 v[28:31], v3, s[40:43], s70 offen sc1
  s_xor_b32 s70, s61, 197632
  buffer_load_dwordx4 v[32:35], v3, s[40:43], s70 offen sc1
  s_xor_b32 s70, s61, 230400
  buffer_load_dwordx4 v[36:39], v3, s[40:43], s70 offen sc1
  s_xor_b32 s70, s61, 264192
  buffer_load_dwordx4 v[40:43], v3, s[40:43], s70 offen sc1
  s_xor_b32 s70, s61, 296960
  buffer_load_dwordx4 v[44:47], v3, s[40:43], s70 offen sc1
  s_xor_b32 s70, s61, 329728
  buffer_load_dwordx4 v[48:51], v3, s[40:43], s70 offen sc1
  s_xor_b32 s70, s61, 362496
  buffer_load_dwordx4 v[52:55], v3, s[40:43], s70 offen sc1
  s_waitcnt vmcnt(0)
  ds_write_b128 v3, v[20:23] offset:3072
  ds_write_b128 v3, v[24:27] offset:4096
  ds_write_b128 v3, v[28:31] offset:5120
  ds_write_b128 v3, v[32:35] offset:6144
  ds_write_b128 v3, v[36:39] offset:7168
  ds_write_b128 v3, v[40:43] offset:8192
  ds_write_b128 v3, v[44:47] offset:9216
  ds_write_b128 v3, v[48:51] offset:10240
  ds_write_b128 v3, v[52:55] offset:11264
L_h_i0:
  s_bitcmp0_b32 s58, 0
  s_cbranch_scc1 L_h_i1
  s_xor_b32 s70, s61, 396288
  buffer_load_dwordx4 v[56:59], v3, s[40:43], s70 offen sc1
  s_xor_b32 s70, s61, 429056
  buffer_load_dwordx4 v[60:63], v3, s[40:43], s70 offen sc1
  s_xor_b32 s70, s61, 461824
  buffer_load_dwordx4 v[64:67], v3, s[40:43], s70 offen sc1
  s_xor_b32 s70, s61, 494592
  buffer_load_dwordx4 v[68:71], v3, s[40:43], s70 offen sc1
  s_xor_b32 s70, s61, 541696
  buffer_load_dwordx4 v[72:75], v3, s[40:43], s70 offen sc1
  s_xor_b32 s70, s61, 574464
  buffer_load_dwordx4 v[76:79], v3, s[40:43], s70 offen sc1
  s_xor_b32 s70, s61, 607232
  buffer_load_dwordx4 v[80:83], v3, s[40:43], s70 offen sc1
  s_xor_b32 s70, s61, 640000
  buffer_load_dwordx4 v[84:87], v3, s[40:43], s70 offen sc1
  s_xor_b32 s70, s61, 671744
  buffer_load_dwordx4 v[88:91], v3, s[40:43], s70 offen sc1
  s_xor_b32 s70, s61, 704512
  buffer_load_dwordx4 v[92:95], v3, s[40:43], s70 offen sc1
  s_xor_b32 s70, s61, 737280
  buffer_load_dwordx4 v[96:99], v3, s[40:43], s70 offen sc1
  s_xor_b32 s70, s61, 770048
  buffer_load_dwordx4 v[100:103], v3, s[40:43], s70 offen sc1
  s_waitcnt vmcnt(0)
  ds_write_b128 v3, v[56:59] offset:12288
  ds_write_b128 v3, v[60:63] offset:13312
  ds_write_b128 v3, v[64:67] offset:14336
  ds_write_b128 v3, v[68:71] offset:15360
  ds_write_b128 v3, v[72:75] offset:16384
  ds_write_b128 v3, v[76:79] offset:17408
  ds_write_b128 v3, v[80:83] offset:18432
  ds_write_b128 v3, v[84:87] offset:19456
  ds_write_b128 v3, v[88:91] offset:20480
  ds_write_b128 v3, v[92:95] offset:21504
  ds_write_b128 v3, v[96:99] offset:22528
  ds_write_b128 v3, v[100:103] offset:23552
L_h_i1:
  s_waitcnt vmcnt(0)
  ds_write_b128 v3, v[8:11] offset:0
  ds_write_b128 v3, v[12:15] offset:1024
  ds_write_b128 v3, v[16:19] offset:2048
  s_bitcmp0_b32 s58, 1
  s_cselect_b32 s70, 255, 32
  v_mov_b32 v1, 61700
  v_mov_b32 v5, s70
  ds_write_b32 v1, v5
  s_mov_b32 s78, 92
  s_swappc_b64 s[84:85], s[86:87]
  s_bitcmp0_b32 s58, 1
  s_cbranch_scc1 L_h_all
L_h_progb:
  s_sleep 4
  ds_read_b32 v8, v112
  s_waitcnt lgkmcnt(0)
  v_cmp_gt_u32 vcc, 96, v8
  s_nop 1
  s_cmp_lg_u32 vcc_lo, 0
  s_cbranch_scc1 L_h_progb
  ds_read_b128 v[8:11], v3 offset:24576
  ds_read_b128 v[12:15], v3 offset:25600
  ds_read_b128 v[16:19], v3 offset:26624
  ds_read_b128 v[20:23], v3 offset:27648
  ds_read_b128 v[24:27], v3 offset:28672
  ds_read_b128 v[28:31], v3 offset:29696
  ds_read_b128 v[32:35], v3 offset:30720
  ds_read_b128 v[36:39], v3 offset:31744
  ds_read_b128 v[40:43], v3 offset:32768
  ds_read_b128 v[44:47], v3 offset:33792
  ds_read_b128 v[48:51], v3 offset:34816
  ds_read_b128 v[52:55], v3 offset:35840
  s_waitcnt lgkmcnt(0)
  s_xor_b32 s70, s60, 805888
  buffer_store_dwordx4 v[8:11], v3, s[40:43], s70 offen sc1
  s_xor_b32 s70, s60, 838656
  buffer_store_dwordx4 v[12:15], v3, s[40:43], s70 offen sc1
  s_xor_b32 s70, s60, 871424
  buffer_store_dwordx4 v[16:19], v3, s[40:43], s70 offen sc1
  s_xor_b32 s70, s60, 904192
  buffer_store_dwordx4 v[20:23], v3, s[40:43], s70 offen sc1
  s_xor_b32 s70, s60, 935936
  buffer_store_dwordx4 v[24:27], v3, s[40:43], s70 offen sc1
  s_xor_b32 s70, s60, 968704
  buffer_store_dwordx4 v[28:31], v3, s[40:43], s70 offen sc1
  s_xor_b32 s70, s60, 1001472
  buffer_store_dwordx4 v[32:35], v3, s[40:43], s70 offen sc1
  s_xor_b32 s70, s60, 1034240
  buffer_store_dwordx4 v[36:39], v3, s[40:43], s70 offen sc1
  s_xor_b32 s70, s60, 1052672
  buffer_store_dwordx4 v[40:43], v3, s[40:43], s70 offen sc1
  s_xor_b32 s70, s60, 1085440
  buffer_store_dwordx4 v[44:47], v3, s[40:43], s70 offen sc1
  s_xor_b32 s70, s60, 1118208
  buffer_store_dwordx4 v[48:51], v3, s[40:43], s70 offen sc1
  s_xor_b32 s70, s60, 1150976
  buffer_store_dwordx4 v[52:55], v3, s[40:43], s70 offen sc1
  s_add_u32 s54, s74, 2
  v_mov_b32 v5, 0
  s_waitcnt vmcnt(0)
  v_mov_b32 v8, s54
  v_mov_b32 v9, s75
  s_mov_b64 exec, 1
  buffer_store_dwordx2 v[8:9], v5, s[40:43], s62 offen sc1
  s_mov_b32 s59, 0
L_h_flagb:
  buffer_load_dwordx2 v[10:11], v5, s[40:43], s63 offen sc1
  s_waitcnt vmcnt(0)
  v_readfirstlane_b32 s56, v10
  v_readfirstlane_b32 s57, v11
  s_nop 0
  s_sub_u32 s56, s56, s54
  s_xor_b32 s57, s57, s75
  s_lshr_b32 s56, s56, 1
  s_or_b32 s56, s56, s57
  s_cbranch_scc0 L_h_flagb_done
  s_add_u32 s59, s59, 1
  s_cmp_gt_u32 s59, 10000
  s_cbranch_scc1 L_h_flagb_done
  s_sleep 8
  s_branch L_h_flagb
L_h_flagb_done:
  s_mov_b64 exec, -1
  s_xor_b32 s70, s61, 805888
  buffer_load_dwordx4 v[8:11], v3, s[40:43], s70 offen sc1
  s_xor_b32 s70, s61, 838656
  buffer_load_dwordx4 v[12:15], v3, s[40:43], s70 offen sc1
  s_xor_b32 s70, s61, 871424
  buffer_load_dwordx4 v[16:19], v3, s[40:43], s70 offen sc1
  s_xor_b32 s70, s61, 904192
  buffer_load_dwordx4 v[20:23], v3, s[40:43], s70 offen sc1
  s_xor_b32 s70, s61, 935936
  buffer_load_dwordx4 v[24:27], v3, s[40:43], s70 offen sc1
  s_xor_b32 s70, s61, 968704
  buffer_load_dwordx4 v[28:31], v3, s[40:43], s70 offen sc1
  s_xor_b32 s70, s61, 1001472
  buffer_load_dwordx4 v[32:35], v3, s[40:43], s70 offen sc1
  s_xor_b32 s70, s61, 1034240
  buffer_load_dwordx4 v[36:39], v3, s[40:43], s70 offen sc1
  s_xor_b32 s70, s61, 1052672
  buffer_load_dwordx4 v[40:43], v3, s[40:43], s70 offen sc1
  s_xor_b32 s70, s61, 1085440
  buffer_load_dwordx4 v[44:47], v3, s[40:43], s70 offen sc1
  s_xor_b32 s70, s61, 1118208
  buffer_load_dwordx4 v[48:51], v3, s[40:43], s70 offen sc1
  s_xor_b32 s70, s61, 1150976
  buffer_load_dwordx4 v[52:55], v3, s[40:43], s70 offen sc1
  s_waitcnt vmcnt(0)
  ds_write_b128 v3, v[8:11] offset:24576
  ds_write_b128 v3, v[12:15] offset:25600
  ds_write_b128 v3, v[16:19] offset:26624
  ds_write_b128 v3, v[20:23] offset:27648
  ds_write_b128 v3, v[24:27] offset:28672
  ds_write_b128 v3, v[28:31] offset:29696
  ds_write_b128 v3, v[32:35] offset:30720
  ds_write_b128 v3, v[36:39] offset:31744
  ds_write_b128 v3, v[40:43] offset:32768
  ds_write_b128 v3, v[44:47] offset:33792
  ds_write_b128 v3, v[48:51] offset:34816
  ds_write_b128 v3, v[52:55] offset:35840
  v_mov_b32 v1, 61700
  v_mov_b32 v5, 255
  ds_write_b32 v1, v5
L_h_all:
  s_mov_b32 s78, 182
  s_swappc_b64 s[84:85], s[86:87]
L_h_progt:
  s_sleep 4
  ds_read_b32 v8, v112
  s_waitcnt lgkmcnt(0)
  v_cmp_gt_u32 vcc, 188, v8
  s_nop 1
  s_cmp_lg_u32 vcc_lo, 0
  s_cbranch_scc1 L_h_progt
  v_mov_b32 v8, 255
  ds_write_b32 v112, v8 offset:8
  s_branch L_finish
L_h_cp:
  s_cmp_gt_u32 s76, s78
  s_cbranch_scc0 L_h_cpgo
  s_setpc_b64 s[84:85]
L_h_cpgo:
  ds_read_b32 v8, v112
  s_waitcnt lgkmcnt(0)
  v_cmp_gt_u32 vcc, s76, v8
  s_nop 1
  s_cmp_eq_u32 vcc_lo, 0
  s_cbranch_scc1 L_h_cpnext
L_h_first:
  s_sleep 2
  ds_read_b32 v8, v112
  s_waitcnt lgkmcnt(0)
  v_cmp_gt_u32 s[48:49], s76, v8
  s_nop 1
  s_cmp_eq_u32 s48, -1
  s_cbranch_scc1 L_h_first
  s_memrealtime s[54:55]
L_h_progm:
  s_sleep 2
  ds_read_b32 v8, v112
  s_waitcnt lgkmcnt(0)
  v_cmp_gt_u32 vcc, s76, v8
  s_nop 1
  s_cmp_lg_u32 vcc_lo, 0
  s_cbranch_scc1 L_h_progm
  s_memrealtime s[56:57]
  v_mov_b32 v114, s54
  v_mov_b32 v115, s55
  s_mov_b64 exec, s[48:49]
  s_waitcnt lgkmcnt(0)
  v_mov_b32 v114, s56
  v_mov_b32 v115, s57
  s_mov_b64 exec, -1
  s_and_b32 s70, s2, 0x78
  s_cbranch_scc1 L_h_np
  s_mov_b64 exec, 3
  buffer_store_dwordx2 v[114:115], v104, s[40:43], s77 offen sc1
  s_mov_b64 exec, -1
L_h_np:
  s_add_u32 s50, s76, 4
L_h_progc:
  s_sleep 4
  ds_read_b32 v8, v112
  s_waitcnt lgkmcnt(0)
  v_cmp_gt_u32 vcc, s50, v8
  s_nop 1
  s_cmp_lg_u32 vcc_lo, 0
  s_cbranch_scc1 L_h_progc
  buffer_load_dwordx2 v[8:9], v105, s[40:43], s77 offen
  v_mov_b32 v10, s73
  s_waitcnt vmcnt(0)
  ds_read_b32 v12, v112
  v_subrev_co_u32 v8, vcc, s72, v8
  s_nop 1
  v_subb_co_u32 v9, vcc, v9, v10, vcc
  v_lshrrev_b32 v10, 24, v8
  v_or_b32 v9, v9, v10
  v_cmp_eq_u32 vcc, 0, v9
  s_nop 1
  v_cndmask_b32 v8, 0, v8, vcc
  s_bcnt1_i32_b32 s56, vcc_lo
  s_nop 0
  v_add_u32_dpp v8, v8, v8 row_ror:8 row_mask:0xf bank_mask:0xf
  s_nop 1
  v_add_u32_dpp v8, v8, v8 row_ror:4 row_mask:0xf bank_mask:0xf
  s_nop 1
  v_add_u32_dpp v8, v8, v8 row_ror:2 row_mask:0xf bank_mask:0xf
  s_nop 1
  v_add_u32_dpp v8, v8, v8 row_ror:1 row_mask:0xf bank_mask:0xf
  s_nop 0
  v_readlane_b32 s54, v8, 0
  v_readlane_b32 s70, v8, 16
  v_subrev_u32 v8, s72, v114
  v_mul_lo_u32 v8, v8, s56
  s_add_u32 s54, s54, s70
  s_max_u32 s56, s56, 1
  v_subrev_u32 v8, s54, v8
  v_cvt_f32_u32 v9, s56
  v_cvt_f32_i32 v8, v8
  v_rcp_f32 v9, v9
  s_nop 0
  v_mul_f32 v8, v8, v9
  v_cvt_i32_f32 v8, v8
  s_waitcnt lgkmcnt(0)
  v_add_u32 v12, 2, v12
  v_min_u32 v9, v113, v12
  v_subrev_u32 v9, s76, v9
  v_max_i32 v9, 0, v9
  v_lshrrev_b32 v9, 1, v9
  v_mul_u32_u24 v9, 28, v9
  v_sub_u32 v8, v8, v9
  v_add_u32 v9, 14, v8
  v_max_i32 v9, 0, v9
  v_min_i32 v9, 2000, v9
  v_mul_u32_u24 v9, 2340, v9
  v_lshrrev_b32 v9, 16, v9
  v_cmp_ne_u32 vcc, 0, v9
  v_lshl_add_u32 v9, v9, 1, v12
  s_nop 0
  v_cndmask_b32 v113, 0, v9, vcc
  ds_write_b32 v112, v113 offset:8
L_h_cpnext:
  s_add_u32 s76, s76, 8
  s_add_u32 s77, s77, 256
  s_branch L_h_cp
L_code_end:
.section .rodata,"a"
.p2align 6
.amdhsa_kernel standalone__kv_cache_quant_int4_int2_kv_with_per_channel_or_per_token_scales__sampling_kernel
  .amdhsa_next_free_vgpr 256
  .amdhsa_next_free_sgpr 102
  .amdhsa_accum_offset 256
  .amdhsa_group_segment_fixed_size 0
  .amdhsa_kernarg_size 80
  .amdhsa_user_sgpr_count 2
  .amdhsa_user_sgpr_kernarg_segment_ptr 1
  .amdhsa_system_sgpr_workgroup_id_x 1
  .amdhsa_float_denorm_mode_32 3
.end_amdhsa_kernel
```

```asm
; @launch grid=(256,1,1) block=(192,1,1) lds=62464
.amdgcn_target "amdgcn-amd-amdhsa--gfx950"
.text
.globl standalone__kv_cache_quant_int4_int2_kv_with_per_channel_or_per_token_scales__sampling_kernel
.p2align 8
.type standalone__kv_cache_quant_int4_int2_kv_with_per_channel_or_per_token_scales__sampling_kernel,@function
standalone__kv_cache_quant_int4_int2_kv_with_per_channel_or_per_token_scales__sampling_kernel:
  s_cmp_ge_u32 s2, 256
  s_cbranch_scc1 L_end
  s_load_dwordx16 s[44:59], s[0:1], 0
  s_load_dwordx4 s[80:83], s[0:1], 64
  v_lshrrev_b32 v1, 6, v0
  v_and_b32 v0, 63, v0
  v_readfirstlane_b32 s3, v1
  s_bfe_u32 s4, s2, 0x10002
  s_lshr_b32 s5, s2, 3
  s_lshl_b32 s5, s5, 2
  s_and_b32 s70, s2, 3
  s_add_u32 s5, s5, s70
  s_lshl_b32 s5, s5, 5
  s_mov_b32 s22, 6291456
  s_mov_b32 s23, 0x20000
  s_mov_b32 s26, 6291456
  s_mov_b32 s27, 0x20000
  s_mov_b32 s30, 2097152
  s_mov_b32 s31, 0x20000
  s_mov_b32 s34, 2097152
  s_mov_b32 s35, 0x20000
  s_mov_b32 s10, 805306368
  s_mov_b32 s11, 0x20000
  s_mov_b32 s38, 393216
  s_mov_b32 s39, 0x20000
  s_mov_b32 s18, 805306368
  s_mov_b32 s19, 0x20000
  s_mov_b32 s14, 805306368
  s_mov_b32 s15, 0x20000
  s_mov_b32 s42, 25165824
  s_mov_b32 s43, 0x20000
  s_cmp_eq_u32 s3, 2
  s_cbranch_scc1 L_helper
  v_and_b32 v108, 3, v0
  v_bfe_u32 v109, v0, 2, 2
  v_lshrrev_b32 v110, 4, v0
  v_and_b32 v111, 15, v0
  v_lshlrev_b32 v144, 4, v108
  v_lshl_add_u32 v144, v110, 6, v144
  v_lshrrev_b32 v233, 1, v144
  v_and_b32 v231, 2, v109
  v_lshlrev_b32 v230, 5, v231
  v_add_u32 v230, 129, v230
  v_and_b32 v145, 1, v109
  v_lshl_add_u32 v231, v145, 2, v231
  v_mul_u32_u24 v145, 33024, v145
  v_add_u32 v232, v144, v145
  v_subrev_u32 v232, 33024, v232
  v_mul_u32_u24 v145, 384, v109
  v_add_u32 v235, v145, v233
  v_mov_b32 v105, 2147483632
  s_mov_b32 s90, 0xaaaaaaab
  s_mov_b32 s91, 0x492492
  s_movk_i32 s63, 768
  s_mov_b32 s64, s3
  s_mov_b32 s99, 8
  s_mov_b32 s96, 0
  v_lshlrev_b32 v114, 4, v0
  s_lshl1_add_u32 s70, s2, s3
  s_mul_i32 s88, s70, 4096
  s_mul_i32 s86, s70, 12288
  s_waitcnt lgkmcnt(0)
  s_mov_b32 s20, s50
  s_and_b32 s21, s51, 0xffff
  s_mov_b32 s24, s52
  s_and_b32 s25, s53, 0xffff
  s_mov_b32 s28, s54
  s_and_b32 s29, s55, 0xffff
  s_mov_b32 s32, s56
  s_and_b32 s33, s57, 0xffff
  buffer_load_dwordx4 v[128:131], v114, s[20:23], s86 offen offset:0
  buffer_load_dwordx4 v[128:131], v114, s[24:27], s86 offen offset:0
  buffer_load_dwordx4 v[128:131], v114, s[28:31], s88 offen offset:0
  buffer_load_dwordx4 v[128:131], v114, s[32:35], s88 offen offset:0
  buffer_load_dwordx4 v[128:131], v114, s[20:23], s86 offen offset:1024
  buffer_load_dwordx4 v[128:131], v114, s[24:27], s86 offen offset:1024
  buffer_load_dwordx4 v[128:131], v114, s[28:31], s88 offen offset:1024
  buffer_load_dwordx4 v[128:131], v114, s[32:35], s88 offen offset:1024
  s_mov_b32 s8, s46
  s_and_b32 s9, s47, 0xffff
  s_mov_b32 s36, s44
  s_and_b32 s37, s45, 0xffff
  s_mov_b32 s16, s46
  s_and_b32 s17, s47, 0xffff
  s_mov_b32 s12, s48
  s_and_b32 s13, s49, 0xffff
  s_mov_b32 s40, s82
  s_and_b32 s41, s83, 0xffff
  s_mov_b64 s[46:47], s[58:59]
  s_mov_b32 s56, 0x0f0f0f0f
  s_mov_b32 s57, 0x0f0f0f0f
  s_mov_b32 s58, 0xffff
  s_mov_b32 s59, 0xffff
  s_lshr_b32 s71, s64, 4
  s_andn2_b32 s71, s71, 1
  s_lshr_b32 s71, 0x12, s71
  s_and_b32 s71, s71, 3
  s_lshr_b32 s85, s96, s71
  s_andn2_b32 s70, s64, 1
  s_or_b32 s70, s70, s4
  s_cmp_lt_u32 s64, 8
  s_cselect_b32 s70, s70, s64
  s_cselect_b32 s85, s64, s85
  s_and_b32 s85, s85, 1
  s_and_b32 s70, s70, 31
  s_lshl_b32 s71, s71, 12
  s_add_u32 s70, s70, s5
  s_add_u32 s70, s70, s71
  s_mul_hi_u32 s84, s70, s90
  s_lshr_b32 s84, s84, 1
  s_mul_i32 s71, s84, 3
  s_sub_u32 s70, s70, s71
  s_lshl3_add_u32 s85, s70, s85
  s_mul_i32 s61, s84, 196608
  s_lshr_b32 s89, s84, 4
  s_lshl_b32 s70, s85, 5
  v_add_u32 v97, s70, v230
  v_mul_u32_u24 v97, 21846, v97
  v_lshrrev_b32 v97, 16, v97
  v_add_u32 v144, s85, v231
  v_lshrrev_b32 v145, v144, s91
  v_and_b32 v145, 1, v145
  v_cmp_eq_u32 s[54:55], 1, v145
  s_nop 1
  s_and_b64 s[52:53], s[54:55], s[56:57]
  s_andn2_b64 s[54:55], s[54:55], s[56:57]
  v_mul_u32_u24 v144, 43, v144
  v_lshrrev_b32 v144, 8, v144
  v_mul_u32_u24 v144, 384, v144
  v_add_u32 v234, v144, v233
  v_mad_u32_u24 v92, v97, s63, v232
  v_add_u32 v93, 768, v92
  v_add_u32 v94, 4608, v92
  v_add_u32 v95, 7680, v92
  v_cndmask_b32 v92, v92, v105, s[52:53]
  v_cndmask_b32 v95, v95, v105, s[54:55]
  s_mov_b32 s60, s61
  s_mul_i32 s70, s89, 1536
  buffer_load_dwordx2 v[174:175], v235, s[36:39], s70 offen offset:0
  buffer_load_dwordx2 v[176:177], v235, s[36:39], s70 offen offset:128
  buffer_load_dwordx2 v[178:179], v235, s[36:39], s70 offen offset:256
  buffer_load_dwordx4 v[4:7], v92, s[8:11], s60 offen offset:0 nt
  buffer_load_dwordx4 v[128:131], v114, s[20:23], s86 offen offset:2048
  buffer_load_dwordx4 v[128:131], v114, s[24:27], s86 offen offset:2048
  buffer_load_dwordx4 v[128:131], v114, s[28:31], s88 offen offset:2048
  buffer_load_dwordx4 v[128:131], v114, s[32:35], s88 offen offset:2048
  buffer_load_dwordx4 v[128:131], v114, s[20:23], s86 offen offset:3072
  buffer_load_dwordx4 v[128:131], v114, s[24:27], s86 offen offset:3072
  buffer_load_dwordx4 v[128:131], v114, s[28:31], s88 offen offset:3072
  buffer_load_dwordx4 v[128:131], v114, s[32:35], s88 offen offset:3072
  s_barrier
  s_mov_b64 vcc, 0
  v_lshlrev_b32 v144, 4, v111
  v_and_b32 v2, 2, v110
  v_lshlrev_b32 v1, 5, v2
  v_add_u32 v1, 129, v1
  v_and_b32 v145, 1, v110
  v_lshl_add_u32 v2, v145, 2, v2
  v_mul_u32_u24 v145, 33024, v145
  v_add_u32 v3, v144, v145
  v_subrev_u32 v3, 33024, v3
  v_and_b32 v145, 1, v110
  v_mul_u32_u24 v145, 86, v145
  v_lshl_add_u32 v96, v111, 1, v145
  v_subrev_u32 v96, 86, v96
  v_lshlrev_b32 v101, 4, v110
  v_lshrrev_b32 v144, 2, v0
  s_mul_i32 s70, s3, 384
  v_lshl_add_u32 v99, v144, 4, s70
  v_lshl_add_u32 v100, v144, 3, s70
  s_mul_i32 s70, s3, 3072
  s_add_u32 s70, s70, 36864
  v_lshl_add_u32 v102, v0, 4, s70
  s_lshl_b32 s70, s3, 5
  s_add_u32 s70, s70, 43008
  v_lshl_add_u32 v103, v109, 3, s70
  s_lshl2_add_u32 s70, s3, 61712
  v_mov_b32 v104, s70
  v_mov_b32 v112, 0
  v_mov_b32 v113, 0
  v_mov_b32 v236, 0xff800000
  v_mov_b32 v146, 1
  s_mov_b32 s65, 0xffff0000
  s_mov_b32 s66, 0x3fb8aa3b
  s_mov_b32 s68, 0x3d93cd3a
  s_mov_b32 s69, 0x3d93cd3a
  s_mov_b32 s72, 0x11111111
  s_mov_b32 s73, 0x11111111
  s_mov_b32 s74, 0x22222222
  s_mov_b32 s75, 0x22222222
  s_mov_b32 s76, 0x44444444
  s_mov_b32 s77, 0x44444444
  s_mov_b32 s78, 0x88888888
  s_mov_b32 s79, 0x88888888
  s_add_u32 s86, s86, 4096
  s_waitcnt vmcnt(15)
  buffer_load_dwordx4 v[128:131], v114, s[20:23], s86 offen offset:0
  s_waitcnt vmcnt(15)
  buffer_load_dwordx4 v[128:131], v114, s[24:27], s86 offen offset:0
  s_waitcnt vmcnt(15)
  buffer_load_dwordx4 v[128:131], v114, s[20:23], s86 offen offset:1024
  s_waitcnt vmcnt(15)
  buffer_load_dwordx4 v[128:131], v114, s[24:27], s86 offen offset:1024
  s_waitcnt vmcnt(15)
  buffer_load_dwordx4 v[128:131], v114, s[20:23], s86 offen offset:2048
  s_waitcnt vmcnt(15)
  buffer_load_dwordx4 v[128:131], v114, s[24:27], s86 offen offset:2048
  s_waitcnt vmcnt(15)
  buffer_load_dwordx4 v[128:131], v114, s[20:23], s86 offen offset:3072
  s_waitcnt vmcnt(15)
  buffer_load_dwordx4 v[128:131], v114, s[24:27], s86 offen offset:3072
  s_add_u32 s86, s86, 4096
  s_waitcnt vmcnt(15)
  buffer_load_dwordx4 v[128:131], v114, s[20:23], s86 offen offset:0
  s_waitcnt vmcnt(15)
  buffer_load_dwordx4 v[128:131], v114, s[24:27], s86 offen offset:0
  s_waitcnt vmcnt(15)
  buffer_load_dwordx4 v[128:131], v114, s[20:23], s86 offen offset:1024
  s_waitcnt vmcnt(15)
  buffer_load_dwordx4 v[128:131], v114, s[24:27], s86 offen offset:1024
  s_waitcnt vmcnt(15)
  buffer_load_dwordx4 v[128:131], v114, s[20:23], s86 offen offset:2048
  s_waitcnt vmcnt(15)
  buffer_load_dwordx4 v[128:131], v114, s[24:27], s86 offen offset:2048
  s_waitcnt vmcnt(15)
  buffer_load_dwordx4 v[128:131], v114, s[20:23], s86 offen offset:3072
  s_waitcnt vmcnt(15)
  buffer_load_dwordx4 v[128:131], v114, s[24:27], s86 offen offset:3072
  s_mov_b32 s88, s89
  s_mul_i32 s62, s84, 1536
  buffer_load_dwordx2 v[180:181], v234, s[20:23], s62 offen offset:0
  buffer_load_dwordx2 v[186:187], v234, s[24:27], s62 offen offset:0
  buffer_load_dwordx2 v[182:183], v234, s[20:23], s62 offen offset:128
  buffer_load_dwordx2 v[188:189], v234, s[24:27], s62 offen offset:128
  buffer_load_dwordx2 v[184:185], v234, s[20:23], s62 offen offset:256
  buffer_load_dwordx2 v[190:191], v234, s[24:27], s62 offen offset:256
  s_waitcnt vmcnt(15)
  buffer_load_dwordx4 v[8:11], v92, s[8:11], s60 offen offset:256 nt
  s_waitcnt vmcnt(15)
  buffer_load_dwordx4 v[12:15], v92, s[8:11], s60 offen offset:512 nt
  s_waitcnt vmcnt(15)
  buffer_load_dwordx4 v[16:19], v93, s[8:11], s60 offen offset:0 nt
  s_waitcnt vmcnt(15)
  buffer_load_dwordx4 v[20:23], v93, s[8:11], s60 offen offset:256 nt
  s_waitcnt vmcnt(15)
  buffer_load_dwordx4 v[24:27], v93, s[8:11], s60 offen offset:512 nt
  s_waitcnt vmcnt(15)
  buffer_load_dwordx4 v[28:31], v93, s[8:11], s60 offen offset:768 nt
  s_waitcnt vmcnt(15)
  buffer_load_dwordx4 v[32:35], v93, s[8:11], s60 offen offset:1024 nt
  s_waitcnt vmcnt(15)
  buffer_load_dwordx4 v[36:39], v93, s[8:11], s60 offen offset:1280 nt
  s_waitcnt vmcnt(15)
  buffer_load_dwordx4 v[40:43], v93, s[8:11], s60 offen offset:1536 nt
  s_waitcnt vmcnt(15)
  buffer_load_dwordx4 v[44:47], v93, s[8:11], s60 offen offset:1792 nt
  s_waitcnt vmcnt(16)
  buffer_load_dwordx4 v[48:51], v93, s[8:11], s60 offen offset:2048 nt
  s_waitcnt vmcnt(17)
  buffer_load_dwordx4 v[52:55], v93, s[8:11], s60 offen offset:2304 nt
  s_waitcnt vmcnt(18)
  buffer_load_dwordx4 v[56:59], v93, s[8:11], s60 offen offset:2560 nt
  s_waitcnt vmcnt(19)
  buffer_load_dwordx4 v[60:63], v93, s[8:11], s60 offen offset:2816 nt
  s_waitcnt vmcnt(14)
  ds_write_b32 v104, v146
L_k:
  v_add_u32 v144, s85, v2
  v_lshrrev_b32 v145, v144, s91
  v_and_b32 v145, 1, v145
  v_cmp_eq_u32 s[50:51], 1, v145
  s_nop 1
  s_and_b64 s[48:49], s[50:51], s[58:59]
  s_andn2_b64 s[50:51], s[50:51], s[58:59]
  s_mov_b32 s97, s64
  s_add_u32 s64, s64, 2
  ds_read_b32 v106, v104 offset:8
  s_waitcnt vmcnt(14)
  s_cbranch_vccnz L_kw0_0
  s_waitcnt vmcnt(9)
L_kw0_0:
  buffer_load_dwordx4 v[64:67], v93, s[8:11], s60 offen offset:3072 nt
  v_lshlrev_b32 v204, 16, v186
  v_and_b32 v205, s65, v186
  v_lshlrev_b32 v206, 16, v187
  v_and_b32 v207, s65, v187
  v_lshlrev_b32 v192, 16, v180
  v_and_b32 v193, s65, v180
  v_lshlrev_b32 v194, 16, v181
  v_and_b32 v195, s65, v181
  v_mov_b32 v168, v174
  v_mov_b32 v169, v175
  v_cvt_f32_i32 v108, v4
  v_cvt_f32_i32 v109, v5
  v_cvt_f32_i32 v110, v6
  v_cvt_f32_i32 v111, v7
  v_pk_add_f32 v[108:109], v[108:109], v[204:205] neg_lo:[0,1] neg_hi:[0,1]
  v_pk_add_f32 v[110:111], v[110:111], v[206:207] neg_lo:[0,1] neg_hi:[0,1]
  v_cvt_pk_bf16_f32 v108, 0, v108
  v_cvt_pk_bf16_f32 v109, 0, v109
  v_cvt_pk_bf16_f32 v110, 0, v110
  v_cvt_pk_bf16_f32 v111, 0, v111
  v_pk_mul_f32 v[108:109], v[108:109], v[192:193]
  v_pk_mul_f32 v[110:111], v[110:111], v[194:195]
  v_cvt_pk_bf16_f32 v216, v108, v109
  v_cvt_pk_bf16_f32 v217, v110, v111
  s_waitcnt lgkmcnt(0)
  v_cmp_lt_u32 vcc, s97, v106
  s_waitcnt vmcnt(14)
  buffer_load_dwordx4 v[68:71], v93, s[8:11], s60 offen offset:3328 nt
  v_lshlrev_b32 v208, 16, v188
  v_and_b32 v209, s65, v188
  v_lshlrev_b32 v210, 16, v189
  v_and_b32 v211, s65, v189
  v_lshlrev_b32 v196, 16, v182
  v_and_b32 v197, s65, v182
  v_lshlrev_b32 v198, 16, v183
  v_and_b32 v199, s65, v183
  v_mov_b32 v170, v176
  v_mov_b32 v171, v177
  v_cvt_f32_i32 v108, v8
  v_cvt_f32_i32 v109, v9
  v_cvt_f32_i32 v110, v10
  v_cvt_f32_i32 v111, v11
  v_pk_add_f32 v[108:109], v[108:109], v[208:209] neg_lo:[0,1] neg_hi:[0,1]
  v_pk_add_f32 v[110:111], v[110:111], v[210:211] neg_lo:[0,1] neg_hi:[0,1]
  v_cvt_pk_bf16_f32 v108, 0, v108
  v_cvt_pk_bf16_f32 v109, 0, v109
  v_cvt_pk_bf16_f32 v110, 0, v110
  v_cvt_pk_bf16_f32 v111, 0, v111
  v_pk_mul_f32 v[108:109], v[108:109], v[196:197]
  v_pk_mul_f32 v[110:111], v[110:111], v[198:199]
  v_cvt_pk_bf16_f32 v218, v108, v109
  v_cvt_pk_bf16_f32 v219, v110, v111
  s_waitcnt vmcnt(14)
  buffer_load_dwordx4 v[72:75], v93, s[8:11], s60 offen offset:3584 nt
  v_mfma_f32_16x16x32_bf16 v[224:227], v[216:219], v[168:171], 0
  v_lshlrev_b32 v212, 16, v190
  v_and_b32 v213, s65, v190
  v_lshlrev_b32 v214, 16, v191
  v_and_b32 v215, s65, v191
  v_lshlrev_b32 v200, 16, v184
  v_and_b32 v201, s65, v184
  v_lshlrev_b32 v202, 16, v185
  v_and_b32 v203, s65, v185
  v_mov_b32 v172, v178
  v_mov_b32 v173, v179
  v_cvt_f32_i32 v108, v12
  v_cvt_f32_i32 v109, v13
  v_cvt_f32_i32 v110, v14
  v_cvt_f32_i32 v111, v15
  v_pk_add_f32 v[108:109], v[108:109], v[212:213] neg_lo:[0,1] neg_hi:[0,1]
  v_pk_add_f32 v[110:111], v[110:111], v[214:215] neg_lo:[0,1] neg_hi:[0,1]
  v_cvt_pk_bf16_f32 v108, 0, v108
  v_cvt_pk_bf16_f32 v109, 0, v109
  v_cvt_pk_bf16_f32 v110, 0, v110
  v_cvt_pk_bf16_f32 v111, 0, v111
  v_pk_mul_f32 v[108:109], v[108:109], v[200:201]
  v_pk_mul_f32 v[110:111], v[110:111], v[202:203]
  v_cvt_pk_bf16_f32 v220, v108, v109
  v_cvt_pk_bf16_f32 v221, v110, v111
  s_waitcnt vmcnt(14)
  s_cbranch_vccnz L_kw0_3
  s_waitcnt vmcnt(9)
L_kw0_3:
  buffer_load_dwordx4 v[76:79], v94, s[8:11], s60 offen offset:0 nt
  v_mfma_f32_16x16x16_bf16 v[224:227], v[220:221], v[172:173], v[224:227]
  v_cvt_f32_i32 v108, v16
  v_cvt_f32_i32 v109, v17
  v_cvt_f32_i32 v110, v18
  v_cvt_f32_i32 v111, v19
  v_pk_add_f32 v[108:109], v[108:109], v[204:205] neg_lo:[0,1] neg_hi:[0,1]
  v_pk_add_f32 v[110:111], v[110:111], v[206:207] neg_lo:[0,1] neg_hi:[0,1]
  v_cvt_pk_bf16_f32 v108, 0, v108
  v_cvt_pk_bf16_f32 v109, 0, v109
  v_cvt_pk_bf16_f32 v110, 0, v110
  v_cvt_pk_bf16_f32 v111, 0, v111
  v_pk_mul_f32 v[108:109], v[108:109], v[192:193]
  v_pk_mul_f32 v[110:111], v[110:111], v[194:195]
  v_cvt_pk_bf16_f32 v216, v108, v109
  v_cvt_pk_bf16_f32 v217, v110, v111
  s_waitcnt vmcnt(14)
  buffer_load_dwordx4 v[80:83], v94, s[8:11], s60 offen offset:256 nt
  v_cvt_f32_i32 v108, v20
  v_cvt_f32_i32 v109, v21
  v_cvt_f32_i32 v110, v22
  v_cvt_f32_i32 v111, v23
  v_pk_add_f32 v[108:109], v[108:109], v[208:209] neg_lo:[0,1] neg_hi:[0,1]
  v_pk_add_f32 v[110:111], v[110:111], v[210:211] neg_lo:[0,1] neg_hi:[0,1]
  v_mov_b32_dpp v144, v224 quad_perm:[0,0,0,0] row_mask:0xf bank_mask:0xf
  v_mov_b32_dpp v145, v226 quad_perm:[2,2,2,2] row_mask:0xf bank_mask:0xf
  v_cvt_pk_bf16_f32 v108, 0, v108
  v_cvt_pk_bf16_f32 v109, 0, v109
  v_add_f32_dpp v144, v225, v144 quad_perm:[1,1,1,1] row_mask:0xf bank_mask:0xf
  v_add_f32_dpp v145, v227, v145 quad_perm:[3,3,3,3] row_mask:0xf bank_mask:0xf
  v_cvt_pk_bf16_f32 v110, 0, v110
  v_cvt_pk_bf16_f32 v111, 0, v111
  v_add_f32 v228, v144, v145
  v_pk_mul_f32 v[108:109], v[108:109], v[196:197]
  v_pk_mul_f32 v[110:111], v[110:111], v[198:199]
  v_cvt_pk_bf16_f32 v218, v108, v109
  v_cvt_pk_bf16_f32 v219, v110, v111
  s_waitcnt vmcnt(14)
  buffer_load_dwordx4 v[84:87], v94, s[8:11], s60 offen offset:512 nt
  v_mfma_f32_16x16x32_bf16 v[224:227], v[216:219], v[168:171], 0
  v_cvt_f32_i32 v108, v24
  v_cvt_f32_i32 v109, v25
  v_cvt_f32_i32 v110, v26
  v_cvt_f32_i32 v111, v27
  v_pk_add_f32 v[108:109], v[108:109], v[212:213] neg_lo:[0,1] neg_hi:[0,1]
  v_pk_add_f32 v[110:111], v[110:111], v[214:215] neg_lo:[0,1] neg_hi:[0,1]
  v_cvt_pk_bf16_f32 v108, 0, v108
  v_cndmask_b32 v228, v228, v236, s[48:49]
  v_cvt_pk_bf16_f32 v109, 0, v109
  v_cvt_pk_bf16_f32 v110, 0, v110
  v_cvt_pk_bf16_f32 v111, 0, v111
  v_pk_mul_f32 v[108:109], v[108:109], v[200:201]
  v_pk_mul_f32 v[110:111], v[110:111], v[202:203]
  v_cvt_pk_bf16_f32 v220, v108, v109
  v_cvt_pk_bf16_f32 v221, v110, v111
  s_waitcnt vmcnt(14)
  s_cbranch_vccnz L_kw0_6
  s_waitcnt vmcnt(9)
L_kw0_6:
  buffer_load_dwordx4 v[88:91], v94, s[8:11], s60 offen offset:768 nt
  v_mfma_f32_16x16x16_bf16 v[224:227], v[220:221], v[172:173], v[224:227]
  v_cvt_f32_i32 v108, v28
  v_cvt_f32_i32 v109, v29
  v_cvt_f32_i32 v110, v30
  v_cvt_f32_i32 v111, v31
  v_pk_add_f32 v[108:109], v[108:109], v[204:205] neg_lo:[0,1] neg_hi:[0,1]
  v_pk_add_f32 v[110:111], v[110:111], v[206:207] neg_lo:[0,1] neg_hi:[0,1]
  v_cvt_pk_bf16_f32 v108, 0, v108
  v_cvt_pk_bf16_f32 v109, 0, v109
  v_cvt_pk_bf16_f32 v110, 0, v110
  v_cvt_pk_bf16_f32 v111, 0, v111
  v_pk_mul_f32 v[108:109], v[108:109], v[192:193]
  v_pk_mul_f32 v[110:111], v[110:111], v[194:195]
  v_cvt_pk_bf16_f32 v216, v108, v109
  v_cvt_pk_bf16_f32 v217, v110, v111
  s_waitcnt vmcnt(14)
  buffer_load_dwordx4 v[4:7], v94, s[8:11], s60 offen offset:1024 nt
  v_cvt_f32_i32 v108, v32
  v_cvt_f32_i32 v109, v33
  v_cvt_f32_i32 v110, v34
  v_cvt_f32_i32 v111, v35
  v_pk_add_f32 v[108:109], v[108:109], v[208:209] neg_lo:[0,1] neg_hi:[0,1]
  v_pk_add_f32 v[110:111], v[110:111], v[210:211] neg_lo:[0,1] neg_hi:[0,1]
  v_mov_b32_dpp v144, v224 quad_perm:[0,0,0,0] row_mask:0xf bank_mask:0xf
  v_mov_b32_dpp v145, v226 quad_perm:[2,2,2,2] row_mask:0xf bank_mask:0xf
  v_cvt_pk_bf16_f32 v108, 0, v108
  v_cvt_pk_bf16_f32 v109, 0, v109
  v_add_f32_dpp v144, v225, v144 quad_perm:[1,1,1,1] row_mask:0xf bank_mask:0xf
  v_add_f32_dpp v145, v227, v145 quad_perm:[3,3,3,3] row_mask:0xf bank_mask:0xf
  v_cvt_pk_bf16_f32 v110, 0, v110
  v_cvt_pk_bf16_f32 v111, 0, v111
  v_add_f32 v229, v144, v145
  v_pk_mul_f32 v[108:109], v[108:109], v[196:197]
  v_pk_mul_f32 v[110:111], v[110:111], v[198:199]
  v_cvt_pk_bf16_f32 v218, v108, v109
  v_cvt_pk_bf16_f32 v219, v110, v111
  s_waitcnt vmcnt(14)
  buffer_load_dwordx4 v[8:11], v94, s[8:11], s60 offen offset:1280 nt
  v_mfma_f32_16x16x32_bf16 v[224:227], v[216:219], v[168:171], 0
  v_cvt_f32_i32 v108, v36
  v_cvt_f32_i32 v109, v37
  v_cvt_f32_i32 v110, v38
  v_cvt_f32_i32 v111, v39
  v_pk_add_f32 v[108:109], v[108:109], v[212:213] neg_lo:[0,1] neg_hi:[0,1]
  v_pk_add_f32 v[110:111], v[110:111], v[214:215] neg_lo:[0,1] neg_hi:[0,1]
  v_cvt_pk_bf16_f32 v108, 0, v108
  v_cvt_pk_bf16_f32 v228, 0, v228
  v_cvt_pk_bf16_f32 v109, 0, v109
  v_cvt_pk_bf16_f32 v229, 0, v229
  v_cvt_pk_bf16_f32 v110, 0, v110
  v_pk_mul_f32 v[228:229], v[228:229], s[68:69]
  v_cvt_pk_bf16_f32 v111, 0, v111
  v_cvt_pk_bf16_f32 v120, v228, v229
  v_pk_mul_f32 v[108:109], v[108:109], v[200:201]
  v_pk_mul_f32 v[110:111], v[110:111], v[202:203]
  v_cvt_pk_bf16_f32 v220, v108, v109
  v_cvt_pk_bf16_f32 v221, v110, v111
  s_waitcnt vmcnt(14)
  s_cbranch_vccnz L_kw0_9
  s_waitcnt vmcnt(9)
L_kw0_9:
  buffer_load_dwordx4 v[12:15], v94, s[8:11], s60 offen offset:1536 nt
  v_mfma_f32_16x16x16_bf16 v[224:227], v[220:221], v[172:173], v[224:227]
  v_cvt_f32_i32 v108, v40
  v_cvt_f32_i32 v109, v41
  v_cvt_f32_i32 v110, v42
  v_cvt_f32_i32 v111, v43
  v_pk_add_f32 v[108:109], v[108:109], v[204:205] neg_lo:[0,1] neg_hi:[0,1]
  v_pk_add_f32 v[110:111], v[110:111], v[206:207] neg_lo:[0,1] neg_hi:[0,1]
  v_cvt_pk_bf16_f32 v108, 0, v108
  v_cvt_pk_bf16_f32 v109, 0, v109
  v_cvt_pk_bf16_f32 v110, 0, v110
  v_cvt_pk_bf16_f32 v111, 0, v111
  v_pk_mul_f32 v[108:109], v[108:109], v[192:193]
  v_pk_mul_f32 v[110:111], v[110:111], v[194:195]
  v_cvt_pk_bf16_f32 v216, v108, v109
  v_cvt_pk_bf16_f32 v217, v110, v111
  s_waitcnt vmcnt(14)
  buffer_load_dwordx4 v[16:19], v94, s[8:11], s60 offen offset:1792 nt
  v_cvt_f32_i32 v108, v44
  v_cvt_f32_i32 v109, v45
  v_cvt_f32_i32 v110, v46
  v_cvt_f32_i32 v111, v47
  v_pk_add_f32 v[108:109], v[108:109], v[208:209] neg_lo:[0,1] neg_hi:[0,1]
  v_pk_add_f32 v[110:111], v[110:111], v[210:211] neg_lo:[0,1] neg_hi:[0,1]
  v_mov_b32_dpp v144, v224 quad_perm:[0,0,0,0] row_mask:0xf bank_mask:0xf
  v_mov_b32_dpp v145, v226 quad_perm:[2,2,2,2] row_mask:0xf bank_mask:0xf
  v_cvt_pk_bf16_f32 v108, 0, v108
  v_cvt_pk_bf16_f32 v109, 0, v109
  v_add_f32_dpp v144, v225, v144 quad_perm:[1,1,1,1] row_mask:0xf bank_mask:0xf
  v_add_f32_dpp v145, v227, v145 quad_perm:[3,3,3,3] row_mask:0xf bank_mask:0xf
  v_cvt_pk_bf16_f32 v110, 0, v110
  v_cvt_pk_bf16_f32 v111, 0, v111
  v_add_f32 v228, v144, v145
  v_pk_mul_f32 v[108:109], v[108:109], v[196:197]
  v_pk_mul_f32 v[110:111], v[110:111], v[198:199]
  v_cvt_pk_bf16_f32 v218, v108, v109
  v_cvt_pk_bf16_f32 v219, v110, v111
  s_waitcnt vmcnt(14)
  buffer_load_dwordx4 v[20:23], v94, s[8:11], s60 offen offset:2048 nt
  v_mfma_f32_16x16x32_bf16 v[224:227], v[216:219], v[168:171], 0
  v_cvt_f32_i32 v108, v48
  v_cvt_f32_i32 v109, v49
  v_cvt_f32_i32 v110, v50
  v_cvt_f32_i32 v111, v51
  v_pk_add_f32 v[108:109], v[108:109], v[212:213] neg_lo:[0,1] neg_hi:[0,1]
  v_pk_add_f32 v[110:111], v[110:111], v[214:215] neg_lo:[0,1] neg_hi:[0,1]
  v_cvt_pk_bf16_f32 v108, 0, v108
  v_cvt_pk_bf16_f32 v109, 0, v109
  v_cvt_pk_bf16_f32 v110, 0, v110
  v_cvt_pk_bf16_f32 v111, 0, v111
  v_pk_mul_f32 v[108:109], v[108:109], v[200:201]
  v_pk_mul_f32 v[110:111], v[110:111], v[202:203]
  v_cvt_pk_bf16_f32 v220, v108, v109
  v_cvt_pk_bf16_f32 v221, v110, v111
  s_waitcnt vmcnt(14)
  s_cbranch_vccnz L_kw0_12
  s_waitcnt vmcnt(9)
L_kw0_12:
  buffer_load_dwordx4 v[24:27], v94, s[8:11], s60 offen offset:2304 nt
  v_mfma_f32_16x16x16_bf16 v[224:227], v[220:221], v[172:173], v[224:227]
  v_cvt_f32_i32 v108, v52
  v_cvt_f32_i32 v109, v53
  v_cvt_f32_i32 v110, v54
  v_cvt_f32_i32 v111, v55
  v_pk_add_f32 v[108:109], v[108:109], v[204:205] neg_lo:[0,1] neg_hi:[0,1]
  v_pk_add_f32 v[110:111], v[110:111], v[206:207] neg_lo:[0,1] neg_hi:[0,1]
  v_cvt_pk_bf16_f32 v108, 0, v108
  v_cvt_pk_bf16_f32 v109, 0, v109
  v_cvt_pk_bf16_f32 v110, 0, v110
  v_cvt_pk_bf16_f32 v111, 0, v111
  v_pk_mul_f32 v[108:109], v[108:109], v[192:193]
  v_pk_mul_f32 v[110:111], v[110:111], v[194:195]
  v_cvt_pk_bf16_f32 v216, v108, v109
  v_cvt_pk_bf16_f32 v217, v110, v111
  s_waitcnt vmcnt(14)
  buffer_load_dwordx4 v[28:31], v94, s[8:11], s60 offen offset:2560 nt
  v_cvt_f32_i32 v108, v56
  v_cvt_f32_i32 v109, v57
  v_cvt_f32_i32 v110, v58
  v_cvt_f32_i32 v111, v59
  v_pk_add_f32 v[108:109], v[108:109], v[208:209] neg_lo:[0,1] neg_hi:[0,1]
  v_pk_add_f32 v[110:111], v[110:111], v[210:211] neg_lo:[0,1] neg_hi:[0,1]
  v_mov_b32_dpp v144, v224 quad_perm:[0,0,0,0] row_mask:0xf bank_mask:0xf
  v_mov_b32_dpp v145, v226 quad_perm:[2,2,2,2] row_mask:0xf bank_mask:0xf
  v_cvt_pk_bf16_f32 v108, 0, v108
  v_cvt_pk_bf16_f32 v109, 0, v109
  v_add_f32_dpp v144, v225, v144 quad_perm:[1,1,1,1] row_mask:0xf bank_mask:0xf
  v_add_f32_dpp v145, v227, v145 quad_perm:[3,3,3,3] row_mask:0xf bank_mask:0xf
  v_cvt_pk_bf16_f32 v110, 0, v110
  v_cvt_pk_bf16_f32 v111, 0, v111
  v_add_f32 v229, v144, v145
  v_pk_mul_f32 v[108:109], v[108:109], v[196:197]
  v_pk_mul_f32 v[110:111], v[110:111], v[198:199]
  v_cvt_pk_bf16_f32 v218, v108, v109
  v_cvt_pk_bf16_f32 v219, v110, v111
  s_waitcnt vmcnt(14)
  buffer_load_dwordx4 v[32:35], v94, s[8:11], s60 offen offset:2816 nt
  v_mfma_f32_16x16x32_bf16 v[224:227], v[216:219], v[168:171], 0
  v_cvt_f32_i32 v108, v60
  v_cvt_f32_i32 v109, v61
  v_cvt_f32_i32 v110, v62
  v_cvt_f32_i32 v111, v63
  v_pk_add_f32 v[108:109], v[108:109], v[212:213] neg_lo:[0,1] neg_hi:[0,1]
  v_pk_add_f32 v[110:111], v[110:111], v[214:215] neg_lo:[0,1] neg_hi:[0,1]
  v_cvt_pk_bf16_f32 v108, 0, v108
  v_cvt_pk_bf16_f32 v228, 0, v228
  v_cvt_pk_bf16_f32 v109, 0, v109
  v_cvt_pk_bf16_f32 v229, 0, v229
  v_cvt_pk_bf16_f32 v110, 0, v110
  v_pk_mul_f32 v[228:229], v[228:229], s[68:69]
  v_cvt_pk_bf16_f32 v111, 0, v111
  v_cvt_pk_bf16_f32 v121, v228, v229
  v_pk_mul_f32 v[108:109], v[108:109], v[200:201]
  v_pk_mul_f32 v[110:111], v[110:111], v[202:203]
  v_cvt_pk_bf16_f32 v220, v108, v109
  v_cvt_pk_bf16_f32 v221, v110, v111
  s_waitcnt vmcnt(14)
  s_cbranch_vccnz L_kw0_15
  s_waitcnt vmcnt(9)
L_kw0_15:
  buffer_load_dwordx4 v[36:39], v95, s[8:11], s60 offen offset:0 nt
  v_mfma_f32_16x16x16_bf16 v[224:227], v[220:221], v[172:173], v[224:227]
  v_cvt_f32_i32 v108, v64
  v_cvt_f32_i32 v109, v65
  v_cvt_f32_i32 v110, v66
  v_cvt_f32_i32 v111, v67
  v_pk_add_f32 v[108:109], v[108:109], v[204:205] neg_lo:[0,1] neg_hi:[0,1]
  v_pk_add_f32 v[110:111], v[110:111], v[206:207] neg_lo:[0,1] neg_hi:[0,1]
  v_cvt_pk_bf16_f32 v108, 0, v108
  v_cvt_pk_bf16_f32 v109, 0, v109
  v_cvt_pk_bf16_f32 v110, 0, v110
  v_cvt_pk_bf16_f32 v111, 0, v111
  v_pk_mul_f32 v[108:109], v[108:109], v[192:193]
  v_pk_mul_f32 v[110:111], v[110:111], v[194:195]
  v_cvt_pk_bf16_f32 v216, v108, v109
  v_cvt_pk_bf16_f32 v217, v110, v111
  s_waitcnt vmcnt(14)
  buffer_load_dwordx4 v[40:43], v95, s[8:11], s60 offen offset:256 nt
  v_cvt_f32_i32 v108, v68
  v_cvt_f32_i32 v109, v69
  v_cvt_f32_i32 v110, v70
  v_cvt_f32_i32 v111, v71
  v_pk_add_f32 v[108:109], v[108:109], v[208:209] neg_lo:[0,1] neg_hi:[0,1]
  v_pk_add_f32 v[110:111], v[110:111], v[210:211] neg_lo:[0,1] neg_hi:[0,1]
  v_mov_b32_dpp v144, v224 quad_perm:[0,0,0,0] row_mask:0xf bank_mask:0xf
  v_mov_b32_dpp v145, v226 quad_perm:[2,2,2,2] row_mask:0xf bank_mask:0xf
  v_cvt_pk_bf16_f32 v108, 0, v108
  v_cvt_pk_bf16_f32 v109, 0, v109
  v_add_f32_dpp v144, v225, v144 quad_perm:[1,1,1,1] row_mask:0xf bank_mask:0xf
  v_add_f32_dpp v145, v227, v145 quad_perm:[3,3,3,3] row_mask:0xf bank_mask:0xf
  v_cvt_pk_bf16_f32 v110, 0, v110
  v_cvt_pk_bf16_f32 v111, 0, v111
  v_add_f32 v228, v144, v145
  v_pk_mul_f32 v[108:109], v[108:109], v[196:197]
  v_pk_mul_f32 v[110:111], v[110:111], v[198:199]
  v_cvt_pk_bf16_f32 v218, v108, v109
  v_cvt_pk_bf16_f32 v219, v110, v111
  s_waitcnt vmcnt(14)
  buffer_load_dwordx4 v[44:47], v95, s[8:11], s60 offen offset:512 nt
  v_mfma_f32_16x16x32_bf16 v[224:227], v[216:219], v[168:171], 0
  v_cvt_f32_i32 v108, v72
  v_cvt_f32_i32 v109, v73
  v_cvt_f32_i32 v110, v74
  v_cvt_f32_i32 v111, v75
  v_pk_add_f32 v[108:109], v[108:109], v[212:213] neg_lo:[0,1] neg_hi:[0,1]
  v_pk_add_f32 v[110:111], v[110:111], v[214:215] neg_lo:[0,1] neg_hi:[0,1]
  s_cmp_lt_u32 s64, s99
  s_cbranch_scc1 L_k_known0
L_k_spin0:
  v_mov_b32 v144, 61696
  ds_read_b32 v144, v144
  s_waitcnt lgkmcnt(0)
  v_readfirstlane_b32 s96, v144
  s_nop 1
  s_cmp_eq_u32 s96, 0
  s_cbranch_scc1 L_k_spin0
  s_mov_b32 s99, -1
L_k_known0:
  s_lshr_b32 s71, s64, 4
  s_andn2_b32 s71, s71, 1
  s_lshr_b32 s71, 0x12, s71
  s_and_b32 s71, s71, 3
  s_lshr_b32 s85, s96, s71
  s_andn2_b32 s70, s64, 1
  s_or_b32 s70, s70, s4
  s_cmp_lt_u32 s64, 8
  s_cselect_b32 s70, s70, s64
  s_cselect_b32 s85, s64, s85
  s_and_b32 s85, s85, 1
  s_and_b32 s70, s70, 31
  s_lshl_b32 s71, s71, 12
  s_add_u32 s70, s70, s5
  s_add_u32 s70, s70, s71
  s_mul_hi_u32 s84, s70, s90
  s_lshr_b32 s84, s84, 1
  s_mul_i32 s71, s84, 3
  s_sub_u32 s70, s70, s71
  s_lshl3_add_u32 s85, s70, s85
  s_mul_i32 s61, s84, 196608
  s_lshr_b32 s89, s84, 4
  s_lshl_b32 s70, s85, 5
  v_add_u32 v97, s70, v230
  v_mul_u32_u24 v97, 21846, v97
  v_lshrrev_b32 v97, 16, v97
  v_add_u32 v144, s85, v231
  v_lshrrev_b32 v145, v144, s91
  v_and_b32 v145, 1, v145
  v_cmp_eq_u32 s[54:55], 1, v145
  s_nop 1
  s_and_b64 s[52:53], s[54:55], s[56:57]
  s_andn2_b64 s[54:55], s[54:55], s[56:57]
  v_mul_u32_u24 v144, 43, v144
  v_lshrrev_b32 v144, 8, v144
  v_mul_u32_u24 v144, 384, v144
  v_add_u32 v234, v144, v233
  s_cmp_eq_u32 s89, s88
  s_cbranch_scc1 L_k_sameq0
  s_mul_i32 s70, s89, 1536
  buffer_load_dwordx2 v[174:175], v235, s[36:39], s70 offen offset:0
  buffer_load_dwordx2 v[176:177], v235, s[36:39], s70 offen offset:128
  buffer_load_dwordx2 v[178:179], v235, s[36:39], s70 offen offset:256
  s_mov_b32 s88, s89
L_k_sameq0:
  s_mul_i32 s62, s84, 1536
  buffer_load_dwordx2 v[180:181], v234, s[20:23], s62 offen offset:0
  buffer_load_dwordx2 v[186:187], v234, s[24:27], s62 offen offset:0
  buffer_load_dwordx2 v[182:183], v234, s[20:23], s62 offen offset:128
  buffer_load_dwordx2 v[188:189], v234, s[24:27], s62 offen offset:128
  buffer_load_dwordx2 v[184:185], v234, s[20:23], s62 offen offset:256
  buffer_load_dwordx2 v[190:191], v234, s[24:27], s62 offen offset:256
  v_cvt_pk_bf16_f32 v108, 0, v108
  v_cvt_pk_bf16_f32 v109, 0, v109
  v_cvt_pk_bf16_f32 v110, 0, v110
  v_cvt_pk_bf16_f32 v111, 0, v111
  v_pk_mul_f32 v[108:109], v[108:109], v[200:201]
  v_pk_mul_f32 v[110:111], v[110:111], v[202:203]
  v_cvt_pk_bf16_f32 v220, v108, v109
  v_cvt_pk_bf16_f32 v221, v110, v111
  v_mad_u32_u24 v92, v97, s63, v232
  v_add_u32 v93, 768, v92
  v_add_u32 v94, 4608, v92
  v_add_u32 v95, 7680, v92
  v_cndmask_b32 v92, v92, v105, s[52:53]
  v_cndmask_b32 v95, v95, v105, s[54:55]
  s_waitcnt vmcnt(20)
  s_cbranch_vccnz L_kw0_18
  s_waitcnt vmcnt(15)
L_kw0_18:
  buffer_load_dwordx4 v[48:51], v92, s[16:19], s61 offen offset:0 nt
  v_mfma_f32_16x16x16_bf16 v[224:227], v[220:221], v[172:173], v[224:227]
  v_cvt_f32_i32 v108, v76
  v_cvt_f32_i32 v109, v77
  v_cvt_f32_i32 v110, v78
  v_cvt_f32_i32 v111, v79
  v_pk_add_f32 v[108:109], v[108:109], v[204:205] neg_lo:[0,1] neg_hi:[0,1]
  v_pk_add_f32 v[110:111], v[110:111], v[206:207] neg_lo:[0,1] neg_hi:[0,1]
  v_cvt_pk_bf16_f32 v108, 0, v108
  v_cvt_pk_bf16_f32 v109, 0, v109
  v_cvt_pk_bf16_f32 v110, 0, v110
  v_cvt_pk_bf16_f32 v111, 0, v111
  v_pk_mul_f32 v[108:109], v[108:109], v[192:193]
  v_pk_mul_f32 v[110:111], v[110:111], v[194:195]
  v_cvt_pk_bf16_f32 v216, v108, v109
  v_cvt_pk_bf16_f32 v217, v110, v111
  s_waitcnt vmcnt(20)
  buffer_load_dwordx4 v[52:55], v92, s[16:19], s61 offen offset:256 nt
  v_cvt_f32_i32 v108, v80
  v_cvt_f32_i32 v109, v81
  v_cvt_f32_i32 v110, v82
  v_cvt_f32_i32 v111, v83
  v_pk_add_f32 v[108:109], v[108:109], v[208:209] neg_lo:[0,1] neg_hi:[0,1]
  v_pk_add_f32 v[110:111], v[110:111], v[210:211] neg_lo:[0,1] neg_hi:[0,1]
  v_mov_b32_dpp v144, v224 quad_perm:[0,0,0,0] row_mask:0xf bank_mask:0xf
  v_mov_b32_dpp v145, v226 quad_perm:[2,2,2,2] row_mask:0xf bank_mask:0xf
  v_cvt_pk_bf16_f32 v108, 0, v108
  v_cvt_pk_bf16_f32 v109, 0, v109
  v_add_f32_dpp v144, v225, v144 quad_perm:[1,1,1,1] row_mask:0xf bank_mask:0xf
  v_add_f32_dpp v145, v227, v145 quad_perm:[3,3,3,3] row_mask:0xf bank_mask:0xf
  v_cvt_pk_bf16_f32 v110, 0, v110
  v_cvt_pk_bf16_f32 v111, 0, v111
  v_add_f32 v229, v144, v145
  v_pk_mul_f32 v[108:109], v[108:109], v[196:197]
  v_pk_mul_f32 v[110:111], v[110:111], v[198:199]
  v_cvt_pk_bf16_f32 v218, v108, v109
  v_cvt_pk_bf16_f32 v219, v110, v111
  s_waitcnt vmcnt(20)
  buffer_load_dwordx4 v[56:59], v92, s[16:19], s61 offen offset:512 nt
  v_mfma_f32_16x16x32_bf16 v[224:227], v[216:219], v[168:171], 0
  v_cvt_f32_i32 v108, v84
  v_cvt_f32_i32 v109, v85
  v_cvt_f32_i32 v110, v86
  v_cvt_f32_i32 v111, v87
  v_pk_add_f32 v[108:109], v[108:109], v[212:213] neg_lo:[0,1] neg_hi:[0,1]
  v_pk_add_f32 v[110:111], v[110:111], v[214:215] neg_lo:[0,1] neg_hi:[0,1]
  v_cvt_pk_bf16_f32 v108, 0, v108
  v_cvt_pk_bf16_f32 v228, 0, v228
  v_cvt_pk_bf16_f32 v109, 0, v109
  v_cvt_pk_bf16_f32 v229, 0, v229
  v_cvt_pk_bf16_f32 v110, 0, v110
  v_pk_mul_f32 v[228:229], v[228:229], s[68:69]
  v_cvt_pk_bf16_f32 v111, 0, v111
  v_cvt_pk_bf16_f32 v122, v228, v229
  v_pk_mul_f32 v[108:109], v[108:109], v[200:201]
  v_pk_mul_f32 v[110:111], v[110:111], v[202:203]
  v_cvt_pk_bf16_f32 v220, v108, v109
  v_cvt_pk_bf16_f32 v221, v110, v111
  s_waitcnt vmcnt(20)
  s_cbranch_vccnz L_kw0_21
  s_waitcnt vmcnt(15)
L_kw0_21:
  buffer_load_dwordx4 v[60:63], v93, s[16:19], s61 offen offset:0 nt
  v_mfma_f32_16x16x16_bf16 v[224:227], v[220:221], v[172:173], v[224:227]
  v_cvt_f32_i32 v108, v88
  v_cvt_f32_i32 v109, v89
  v_cvt_f32_i32 v110, v90
  v_cvt_f32_i32 v111, v91
  v_pk_add_f32 v[108:109], v[108:109], v[204:205] neg_lo:[0,1] neg_hi:[0,1]
  v_pk_add_f32 v[110:111], v[110:111], v[206:207] neg_lo:[0,1] neg_hi:[0,1]
  v_cvt_pk_bf16_f32 v108, 0, v108
  v_cvt_pk_bf16_f32 v109, 0, v109
  v_cvt_pk_bf16_f32 v110, 0, v110
  v_cvt_pk_bf16_f32 v111, 0, v111
  v_pk_mul_f32 v[108:109], v[108:109], v[192:193]
  v_pk_mul_f32 v[110:111], v[110:111], v[194:195]
  v_cvt_pk_bf16_f32 v216, v108, v109
  v_cvt_pk_bf16_f32 v217, v110, v111
  s_waitcnt vmcnt(20)
  buffer_load_dwordx4 v[64:67], v93, s[16:19], s61 offen offset:256 nt
  v_cvt_f32_i32 v108, v4
  v_cvt_f32_i32 v109, v5
  v_cvt_f32_i32 v110, v6
  v_cvt_f32_i32 v111, v7
  v_pk_add_f32 v[108:109], v[108:109], v[208:209] neg_lo:[0,1] neg_hi:[0,1]
  v_pk_add_f32 v[110:111], v[110:111], v[210:211] neg_lo:[0,1] neg_hi:[0,1]
  v_mov_b32_dpp v144, v224 quad_perm:[0,0,0,0] row_mask:0xf bank_mask:0xf
  v_mov_b32_dpp v145, v226 quad_perm:[2,2,2,2] row_mask:0xf bank_mask:0xf
  v_cvt_pk_bf16_f32 v108, 0, v108
  v_cvt_pk_bf16_f32 v109, 0, v109
  v_add_f32_dpp v144, v225, v144 quad_perm:[1,1,1,1] row_mask:0xf bank_mask:0xf
  v_add_f32_dpp v145, v227, v145 quad_perm:[3,3,3,3] row_mask:0xf bank_mask:0xf
  v_cvt_pk_bf16_f32 v110, 0, v110
  v_cvt_pk_bf16_f32 v111, 0, v111
  v_add_f32 v228, v144, v145
  v_pk_mul_f32 v[108:109], v[108:109], v[196:197]
  v_pk_mul_f32 v[110:111], v[110:111], v[198:199]
  v_cvt_pk_bf16_f32 v218, v108, v109
  v_cvt_pk_bf16_f32 v219, v110, v111
  s_waitcnt vmcnt(20)
  buffer_load_dwordx4 v[68:71], v93, s[16:19], s61 offen offset:512 nt
  v_mfma_f32_16x16x32_bf16 v[224:227], v[216:219], v[168:171], 0
  v_cvt_f32_i32 v108, v8
  v_cvt_f32_i32 v109, v9
  v_cvt_f32_i32 v110, v10
  v_cvt_f32_i32 v111, v11
  v_pk_add_f32 v[108:109], v[108:109], v[212:213] neg_lo:[0,1] neg_hi:[0,1]
  v_pk_add_f32 v[110:111], v[110:111], v[214:215] neg_lo:[0,1] neg_hi:[0,1]
  v_cvt_pk_bf16_f32 v108, 0, v108
  v_cvt_pk_bf16_f32 v109, 0, v109
  v_cvt_pk_bf16_f32 v110, 0, v110
  v_cvt_pk_bf16_f32 v111, 0, v111
  v_pk_mul_f32 v[108:109], v[108:109], v[200:201]
  v_pk_mul_f32 v[110:111], v[110:111], v[202:203]
  v_cvt_pk_bf16_f32 v220, v108, v109
  v_cvt_pk_bf16_f32 v221, v110, v111
  s_waitcnt vmcnt(20)
  s_cbranch_vccnz L_kw0_24
  s_waitcnt vmcnt(15)
L_kw0_24:
  buffer_load_dwordx4 v[72:75], v93, s[16:19], s61 offen offset:768 nt
  v_mfma_f32_16x16x16_bf16 v[224:227], v[220:221], v[172:173], v[224:227]
  v_cvt_f32_i32 v108, v12
  v_cvt_f32_i32 v109, v13
  v_cvt_f32_i32 v110, v14
  v_cvt_f32_i32 v111, v15
  v_pk_add_f32 v[108:109], v[108:109], v[204:205] neg_lo:[0,1] neg_hi:[0,1]
  v_pk_add_f32 v[110:111], v[110:111], v[206:207] neg_lo:[0,1] neg_hi:[0,1]
  v_cvt_pk_bf16_f32 v108, 0, v108
  v_cvt_pk_bf16_f32 v109, 0, v109
  v_cvt_pk_bf16_f32 v110, 0, v110
  v_cvt_pk_bf16_f32 v111, 0, v111
  v_pk_mul_f32 v[108:109], v[108:109], v[192:193]
  v_pk_mul_f32 v[110:111], v[110:111], v[194:195]
  v_cvt_pk_bf16_f32 v216, v108, v109
  v_cvt_pk_bf16_f32 v217, v110, v111
  s_waitcnt vmcnt(20)
  buffer_load_dwordx4 v[76:79], v93, s[16:19], s61 offen offset:1024 nt
  v_cvt_f32_i32 v108, v16
  v_cvt_f32_i32 v109, v17
  v_cvt_f32_i32 v110, v18
  v_cvt_f32_i32 v111, v19
  v_pk_add_f32 v[108:109], v[108:109], v[208:209] neg_lo:[0,1] neg_hi:[0,1]
  v_pk_add_f32 v[110:111], v[110:111], v[210:211] neg_lo:[0,1] neg_hi:[0,1]
  v_mov_b32_dpp v144, v224 quad_perm:[0,0,0,0] row_mask:0xf bank_mask:0xf
  v_mov_b32_dpp v145, v226 quad_perm:[2,2,2,2] row_mask:0xf bank_mask:0xf
  v_cvt_pk_bf16_f32 v108, 0, v108
  v_cvt_pk_bf16_f32 v109, 0, v109
  v_add_f32_dpp v144, v225, v144 quad_perm:[1,1,1,1] row_mask:0xf bank_mask:0xf
  v_add_f32_dpp v145, v227, v145 quad_perm:[3,3,3,3] row_mask:0xf bank_mask:0xf
  v_cvt_pk_bf16_f32 v110, 0, v110
  v_cvt_pk_bf16_f32 v111, 0, v111
  v_add_f32 v229, v144, v145
  v_pk_mul_f32 v[108:109], v[108:109], v[196:197]
  v_pk_mul_f32 v[110:111], v[110:111], v[198:199]
  v_cvt_pk_bf16_f32 v218, v108, v109
  v_cvt_pk_bf16_f32 v219, v110, v111
  s_waitcnt vmcnt(20)
  buffer_load_dwordx4 v[80:83], v93, s[16:19], s61 offen offset:1280 nt
  v_mfma_f32_16x16x32_bf16 v[224:227], v[216:219], v[168:171], 0
  v_cvt_f32_i32 v108, v20
  v_cvt_f32_i32 v109, v21
  v_cvt_f32_i32 v110, v22
  v_cvt_f32_i32 v111, v23
  v_pk_add_f32 v[108:109], v[108:109], v[212:213] neg_lo:[0,1] neg_hi:[0,1]
  v_pk_add_f32 v[110:111], v[110:111], v[214:215] neg_lo:[0,1] neg_hi:[0,1]
  v_cvt_pk_bf16_f32 v108, 0, v108
  v_cvt_pk_bf16_f32 v228, 0, v228
  v_cvt_pk_bf16_f32 v109, 0, v109
  v_cvt_pk_bf16_f32 v229, 0, v229
  v_cvt_pk_bf16_f32 v110, 0, v110
  v_pk_mul_f32 v[228:229], v[228:229], s[68:69]
  v_cvt_pk_bf16_f32 v111, 0, v111
  v_cvt_pk_bf16_f32 v123, v228, v229
  v_pk_mul_f32 v[108:109], v[108:109], v[200:201]
  v_pk_mul_f32 v[110:111], v[110:111], v[202:203]
  v_cvt_pk_bf16_f32 v220, v108, v109
  v_cvt_pk_bf16_f32 v221, v110, v111
  s_waitcnt vmcnt(20)
  s_cbranch_vccnz L_kw0_27
  s_waitcnt vmcnt(15)
L_kw0_27:
  buffer_load_dwordx4 v[84:87], v93, s[16:19], s61 offen offset:1536 nt
  v_mfma_f32_16x16x16_bf16 v[224:227], v[220:221], v[172:173], v[224:227]
  v_cvt_f32_i32 v108, v24
  v_cvt_f32_i32 v109, v25
  v_cvt_f32_i32 v110, v26
  v_cvt_f32_i32 v111, v27
  v_pk_add_f32 v[108:109], v[108:109], v[204:205] neg_lo:[0,1] neg_hi:[0,1]
  v_pk_add_f32 v[110:111], v[110:111], v[206:207] neg_lo:[0,1] neg_hi:[0,1]
  v_cvt_pk_bf16_f32 v108, 0, v108
  v_cvt_pk_bf16_f32 v109, 0, v109
  v_cvt_pk_bf16_f32 v110, 0, v110
  v_cvt_pk_bf16_f32 v111, 0, v111
  v_pk_mul_f32 v[108:109], v[108:109], v[192:193]
  v_pk_mul_f32 v[110:111], v[110:111], v[194:195]
  v_cvt_pk_bf16_f32 v216, v108, v109
  v_cvt_pk_bf16_f32 v217, v110, v111
  s_waitcnt vmcnt(20)
  buffer_load_dwordx4 v[88:91], v93, s[16:19], s61 offen offset:1792 nt
  v_cvt_f32_i32 v108, v28
  v_cvt_f32_i32 v109, v29
  v_cvt_f32_i32 v110, v30
  v_cvt_f32_i32 v111, v31
  v_pk_add_f32 v[108:109], v[108:109], v[208:209] neg_lo:[0,1] neg_hi:[0,1]
  v_pk_add_f32 v[110:111], v[110:111], v[210:211] neg_lo:[0,1] neg_hi:[0,1]
  v_mov_b32_dpp v144, v224 quad_perm:[0,0,0,0] row_mask:0xf bank_mask:0xf
  v_mov_b32_dpp v145, v226 quad_perm:[2,2,2,2] row_mask:0xf bank_mask:0xf
  v_cvt_pk_bf16_f32 v108, 0, v108
  v_cvt_pk_bf16_f32 v109, 0, v109
  v_add_f32_dpp v144, v225, v144 quad_perm:[1,1,1,1] row_mask:0xf bank_mask:0xf
  v_add_f32_dpp v145, v227, v145 quad_perm:[3,3,3,3] row_mask:0xf bank_mask:0xf
  v_cvt_pk_bf16_f32 v110, 0, v110
  v_cvt_pk_bf16_f32 v111, 0, v111
  v_add_f32 v228, v144, v145
  v_pk_mul_f32 v[108:109], v[108:109], v[196:197]
  v_pk_mul_f32 v[110:111], v[110:111], v[198:199]
  v_cvt_pk_bf16_f32 v218, v108, v109
  v_cvt_pk_bf16_f32 v219, v110, v111
  s_waitcnt vmcnt(20)
  buffer_load_dwordx4 v[4:7], v93, s[16:19], s61 offen offset:2048 nt
  v_mfma_f32_16x16x32_bf16 v[224:227], v[216:219], v[168:171], 0
  v_cvt_f32_i32 v108, v32
  v_cvt_f32_i32 v109, v33
  v_cvt_f32_i32 v110, v34
  v_cvt_f32_i32 v111, v35
  v_pk_add_f32 v[108:109], v[108:109], v[212:213] neg_lo:[0,1] neg_hi:[0,1]
  v_pk_add_f32 v[110:111], v[110:111], v[214:215] neg_lo:[0,1] neg_hi:[0,1]
  v_cvt_pk_bf16_f32 v108, 0, v108
  v_cvt_pk_bf16_f32 v109, 0, v109
  v_cvt_pk_bf16_f32 v110, 0, v110
  v_cvt_pk_bf16_f32 v111, 0, v111
  v_pk_mul_f32 v[108:109], v[108:109], v[200:201]
  v_pk_mul_f32 v[110:111], v[110:111], v[202:203]
  v_cvt_pk_bf16_f32 v220, v108, v109
  v_cvt_pk_bf16_f32 v221, v110, v111
  s_waitcnt vmcnt(20)
  s_cbranch_vccnz L_kw0_30
  s_waitcnt vmcnt(9)
L_kw0_30:
  buffer_load_dwordx4 v[8:11], v93, s[16:19], s61 offen offset:2304 nt
  v_mfma_f32_16x16x16_bf16 v[224:227], v[220:221], v[172:173], v[224:227]
  v_cvt_f32_i32 v108, v36
  v_cvt_f32_i32 v109, v37
  v_cvt_f32_i32 v110, v38
  v_cvt_f32_i32 v111, v39
  v_pk_add_f32 v[108:109], v[108:109], v[204:205] neg_lo:[0,1] neg_hi:[0,1]
  v_pk_add_f32 v[110:111], v[110:111], v[206:207] neg_lo:[0,1] neg_hi:[0,1]
  v_cvt_pk_bf16_f32 v108, 0, v108
  v_cvt_pk_bf16_f32 v109, 0, v109
  v_cvt_pk_bf16_f32 v110, 0, v110
  v_cvt_pk_bf16_f32 v111, 0, v111
  v_pk_mul_f32 v[108:109], v[108:109], v[192:193]
  v_pk_mul_f32 v[110:111], v[110:111], v[194:195]
  v_cvt_pk_bf16_f32 v216, v108, v109
  v_cvt_pk_bf16_f32 v217, v110, v111
  s_waitcnt vmcnt(20)
  buffer_load_dwordx4 v[12:15], v93, s[16:19], s61 offen offset:2560 nt
  v_cvt_f32_i32 v108, v40
  v_cvt_f32_i32 v109, v41
  v_cvt_f32_i32 v110, v42
  v_cvt_f32_i32 v111, v43
  v_pk_add_f32 v[108:109], v[108:109], v[208:209] neg_lo:[0,1] neg_hi:[0,1]
  v_pk_add_f32 v[110:111], v[110:111], v[210:211] neg_lo:[0,1] neg_hi:[0,1]
  v_mov_b32_dpp v144, v224 quad_perm:[0,0,0,0] row_mask:0xf bank_mask:0xf
  v_mov_b32_dpp v145, v226 quad_perm:[2,2,2,2] row_mask:0xf bank_mask:0xf
  v_cvt_pk_bf16_f32 v108, 0, v108
  v_cvt_pk_bf16_f32 v109, 0, v109
  v_add_f32_dpp v144, v225, v144 quad_perm:[1,1,1,1] row_mask:0xf bank_mask:0xf
  v_add_f32_dpp v145, v227, v145 quad_perm:[3,3,3,3] row_mask:0xf bank_mask:0xf
  v_cvt_pk_bf16_f32 v110, 0, v110
  v_cvt_pk_bf16_f32 v111, 0, v111
  v_add_f32 v229, v144, v145
  v_pk_mul_f32 v[108:109], v[108:109], v[196:197]
  v_pk_mul_f32 v[110:111], v[110:111], v[198:199]
  v_cvt_pk_bf16_f32 v218, v108, v109
  v_cvt_pk_bf16_f32 v219, v110, v111
  s_waitcnt vmcnt(20)
  buffer_load_dwordx4 v[16:19], v93, s[16:19], s61 offen offset:2816 nt
  v_mfma_f32_16x16x32_bf16 v[224:227], v[216:219], v[168:171], 0
  v_cvt_f32_i32 v108, v44
  v_cvt_f32_i32 v109, v45
  v_cvt_f32_i32 v110, v46
  v_cvt_f32_i32 v111, v47
  v_pk_add_f32 v[108:109], v[108:109], v[212:213] neg_lo:[0,1] neg_hi:[0,1]
  v_pk_add_f32 v[110:111], v[110:111], v[214:215] neg_lo:[0,1] neg_hi:[0,1]
  v_cvt_pk_bf16_f32 v108, 0, v108
  v_cvt_pk_bf16_f32 v228, 0, v228
  v_cvt_pk_bf16_f32 v109, 0, v109
  v_cvt_pk_bf16_f32 v229, 0, v229
  v_cvt_pk_bf16_f32 v110, 0, v110
  v_pk_mul_f32 v[228:229], v[228:229], s[68:69]
  v_cvt_pk_bf16_f32 v111, 0, v111
  v_cvt_pk_bf16_f32 v124, v228, v229
  v_pk_mul_f32 v[108:109], v[108:109], v[200:201]
  v_pk_mul_f32 v[110:111], v[110:111], v[202:203]
  v_cvt_pk_bf16_f32 v220, v108, v109
  v_cvt_pk_bf16_f32 v221, v110, v111
  s_mov_b32 s60, s61
  v_mov_b32 v146, s64
  v_mfma_f32_16x16x16_bf16 v[224:227], v[220:221], v[172:173], v[224:227]
  ds_write_b128 v99, v[120:123]
  v_add_u32 v99, 768, v99
  s_nop 5
  v_mov_b32_dpp v144, v224 quad_perm:[0,0,0,0] row_mask:0xf bank_mask:0xf
  v_mov_b32_dpp v145, v226 quad_perm:[2,2,2,2] row_mask:0xf bank_mask:0xf
  s_nop 0
  v_add_f32_dpp v144, v225, v144 quad_perm:[1,1,1,1] row_mask:0xf bank_mask:0xf
  v_add_f32_dpp v145, v227, v145 quad_perm:[3,3,3,3] row_mask:0xf bank_mask:0xf
  v_add_f32 v228, v144, v145
  v_cndmask_b32 v228, v228, v236, s[50:51]
  v_cvt_pk_bf16_f32 v228, 0, v228
  v_cvt_pk_bf16_f32 v229, 0, v229
  v_pk_mul_f32 v[228:229], v[228:229], s[68:69]
  v_cvt_pk_bf16_f32 v125, v228, v229
  ds_write_b64 v100, v[124:125] offset:256
  ds_write_b32 v104, v146
  v_add_u32 v100, 768, v100
  v_add_u32 v144, s85, v2
  v_lshrrev_b32 v145, v144, s91
  v_and_b32 v145, 1, v145
  v_cmp_eq_u32 s[50:51], 1, v145
  s_nop 1
  s_and_b64 s[48:49], s[50:51], s[58:59]
  s_andn2_b64 s[50:51], s[50:51], s[58:59]
  s_mov_b32 s97, s64
  s_add_u32 s64, s64, 2
  ds_read_b32 v106, v104 offset:8
  s_waitcnt vmcnt(14)
  s_cbranch_vccnz L_kw1_0
  s_waitcnt vmcnt(9)
L_kw1_0:
  buffer_load_dwordx4 v[20:23], v93, s[8:11], s60 offen offset:3072 nt
  v_lshlrev_b32 v204, 16, v186
  v_and_b32 v205, s65, v186
  v_lshlrev_b32 v206, 16, v187
  v_and_b32 v207, s65, v187
  v_lshlrev_b32 v192, 16, v180
  v_and_b32 v193, s65, v180
  v_lshlrev_b32 v194, 16, v181
  v_and_b32 v195, s65, v181
  v_mov_b32 v168, v174
  v_mov_b32 v169, v175
  v_cvt_f32_i32 v108, v48
  v_cvt_f32_i32 v109, v49
  v_cvt_f32_i32 v110, v50
  v_cvt_f32_i32 v111, v51
  v_pk_add_f32 v[108:109], v[108:109], v[204:205] neg_lo:[0,1] neg_hi:[0,1]
  v_pk_add_f32 v[110:111], v[110:111], v[206:207] neg_lo:[0,1] neg_hi:[0,1]
  v_cvt_pk_bf16_f32 v108, 0, v108
  v_cvt_pk_bf16_f32 v109, 0, v109
  v_cvt_pk_bf16_f32 v110, 0, v110
  v_cvt_pk_bf16_f32 v111, 0, v111
  v_pk_mul_f32 v[108:109], v[108:109], v[192:193]
  v_pk_mul_f32 v[110:111], v[110:111], v[194:195]
  v_cvt_pk_bf16_f32 v216, v108, v109
  v_cvt_pk_bf16_f32 v217, v110, v111
  s_waitcnt lgkmcnt(0)
  v_cmp_lt_u32 vcc, s97, v106
  s_waitcnt vmcnt(14)
  buffer_load_dwordx4 v[24:27], v93, s[8:11], s60 offen offset:3328 nt
  v_lshlrev_b32 v208, 16, v188
  v_and_b32 v209, s65, v188
  v_lshlrev_b32 v210, 16, v189
  v_and_b32 v211, s65, v189
  v_lshlrev_b32 v196, 16, v182
  v_and_b32 v197, s65, v182
  v_lshlrev_b32 v198, 16, v183
  v_and_b32 v199, s65, v183
  v_mov_b32 v170, v176
  v_mov_b32 v171, v177
  v_cvt_f32_i32 v108, v52
  v_cvt_f32_i32 v109, v53
  v_cvt_f32_i32 v110, v54
  v_cvt_f32_i32 v111, v55
  v_pk_add_f32 v[108:109], v[108:109], v[208:209] neg_lo:[0,1] neg_hi:[0,1]
  v_pk_add_f32 v[110:111], v[110:111], v[210:211] neg_lo:[0,1] neg_hi:[0,1]
  v_cvt_pk_bf16_f32 v108, 0, v108
  v_cvt_pk_bf16_f32 v109, 0, v109
  v_cvt_pk_bf16_f32 v110, 0, v110
  v_cvt_pk_bf16_f32 v111, 0, v111
  v_pk_mul_f32 v[108:109], v[108:109], v[196:197]
  v_pk_mul_f32 v[110:111], v[110:111], v[198:199]
  v_cvt_pk_bf16_f32 v218, v108, v109
  v_cvt_pk_bf16_f32 v219, v110, v111
  s_waitcnt vmcnt(14)
  buffer_load_dwordx4 v[28:31], v93, s[8:11], s60 offen offset:3584 nt
  v_mfma_f32_16x16x32_bf16 v[224:227], v[216:219], v[168:171], 0
  v_lshlrev_b32 v212, 16, v190
  v_and_b32 v213, s65, v190
  v_lshlrev_b32 v214, 16, v191
  v_and_b32 v215, s65, v191
  v_lshlrev_b32 v200, 16, v184
  v_and_b32 v201, s65, v184
  v_lshlrev_b32 v202, 16, v185
  v_and_b32 v203, s65, v185
  v_mov_b32 v172, v178
  v_mov_b32 v173, v179
  v_cvt_f32_i32 v108, v56
  v_cvt_f32_i32 v109, v57
  v_cvt_f32_i32 v110, v58
  v_cvt_f32_i32 v111, v59
  v_pk_add_f32 v[108:109], v[108:109], v[212:213] neg_lo:[0,1] neg_hi:[0,1]
  v_pk_add_f32 v[110:111], v[110:111], v[214:215] neg_lo:[0,1] neg_hi:[0,1]
  v_cvt_pk_bf16_f32 v108, 0, v108
  v_cvt_pk_bf16_f32 v109, 0, v109
  v_cvt_pk_bf16_f32 v110, 0, v110
  v_cvt_pk_bf16_f32 v111, 0, v111
  v_pk_mul_f32 v[108:109], v[108:109], v[200:201]
  v_pk_mul_f32 v[110:111], v[110:111], v[202:203]
  v_cvt_pk_bf16_f32 v220, v108, v109
  v_cvt_pk_bf16_f32 v221, v110, v111
  s_waitcnt vmcnt(14)
  s_cbranch_vccnz L_kw1_3
  s_waitcnt vmcnt(9)
L_kw1_3:
  buffer_load_dwordx4 v[32:35], v94, s[8:11], s60 offen offset:0 nt
  v_mfma_f32_16x16x16_bf16 v[224:227], v[220:221], v[172:173], v[224:227]
  v_cvt_f32_i32 v108, v60
  v_cvt_f32_i32 v109, v61
  v_cvt_f32_i32 v110, v62
  v_cvt_f32_i32 v111, v63
  v_pk_add_f32 v[108:109], v[108:109], v[204:205] neg_lo:[0,1] neg_hi:[0,1]
  v_pk_add_f32 v[110:111], v[110:111], v[206:207] neg_lo:[0,1] neg_hi:[0,1]
  v_cvt_pk_bf16_f32 v108, 0, v108
  v_cvt_pk_bf16_f32 v109, 0, v109
  v_cvt_pk_bf16_f32 v110, 0, v110
  v_cvt_pk_bf16_f32 v111, 0, v111
  v_pk_mul_f32 v[108:109], v[108:109], v[192:193]
  v_pk_mul_f32 v[110:111], v[110:111], v[194:195]
  v_cvt_pk_bf16_f32 v216, v108, v109
  v_cvt_pk_bf16_f32 v217, v110, v111
  s_waitcnt vmcnt(14)
  buffer_load_dwordx4 v[36:39], v94, s[8:11], s60 offen offset:256 nt
  v_cvt_f32_i32 v108, v64
  v_cvt_f32_i32 v109, v65
  v_cvt_f32_i32 v110, v66
  v_cvt_f32_i32 v111, v67
  v_pk_add_f32 v[108:109], v[108:109], v[208:209] neg_lo:[0,1] neg_hi:[0,1]
  v_pk_add_f32 v[110:111], v[110:111], v[210:211] neg_lo:[0,1] neg_hi:[0,1]
  v_mov_b32_dpp v144, v224 quad_perm:[0,0,0,0] row_mask:0xf bank_mask:0xf
  v_mov_b32_dpp v145, v226 quad_perm:[2,2,2,2] row_mask:0xf bank_mask:0xf
  v_cvt_pk_bf16_f32 v108, 0, v108
  v_cvt_pk_bf16_f32 v109, 0, v109
  v_add_f32_dpp v144, v225, v144 quad_perm:[1,1,1,1] row_mask:0xf bank_mask:0xf
  v_add_f32_dpp v145, v227, v145 quad_perm:[3,3,3,3] row_mask:0xf bank_mask:0xf
  v_cvt_pk_bf16_f32 v110, 0, v110
  v_cvt_pk_bf16_f32 v111, 0, v111
  v_add_f32 v228, v144, v145
  v_pk_mul_f32 v[108:109], v[108:109], v[196:197]
  v_pk_mul_f32 v[110:111], v[110:111], v[198:199]
  v_cvt_pk_bf16_f32 v218, v108, v109
  v_cvt_pk_bf16_f32 v219, v110, v111
  s_waitcnt vmcnt(14)
  buffer_load_dwordx4 v[40:43], v94, s[8:11], s60 offen offset:512 nt
  v_mfma_f32_16x16x32_bf16 v[224:227], v[216:219], v[168:171], 0
  v_cvt_f32_i32 v108, v68
  v_cvt_f32_i32 v109, v69
  v_cvt_f32_i32 v110, v70
  v_cvt_f32_i32 v111, v71
  v_pk_add_f32 v[108:109], v[108:109], v[212:213] neg_lo:[0,1] neg_hi:[0,1]
  v_pk_add_f32 v[110:111], v[110:111], v[214:215] neg_lo:[0,1] neg_hi:[0,1]
  v_cvt_pk_bf16_f32 v108, 0, v108
  v_cndmask_b32 v228, v228, v236, s[48:49]
  v_cvt_pk_bf16_f32 v109, 0, v109
  v_cvt_pk_bf16_f32 v110, 0, v110
  v_cvt_pk_bf16_f32 v111, 0, v111
  v_pk_mul_f32 v[108:109], v[108:109], v[200:201]
  v_pk_mul_f32 v[110:111], v[110:111], v[202:203]
  v_cvt_pk_bf16_f32 v220, v108, v109
  v_cvt_pk_bf16_f32 v221, v110, v111
  s_waitcnt vmcnt(14)
  s_cbranch_vccnz L_kw1_6
  s_waitcnt vmcnt(9)
L_kw1_6:
  buffer_load_dwordx4 v[44:47], v94, s[8:11], s60 offen offset:768 nt
  v_mfma_f32_16x16x16_bf16 v[224:227], v[220:221], v[172:173], v[224:227]
  v_cvt_f32_i32 v108, v72
  v_cvt_f32_i32 v109, v73
  v_cvt_f32_i32 v110, v74
  v_cvt_f32_i32 v111, v75
  v_pk_add_f32 v[108:109], v[108:109], v[204:205] neg_lo:[0,1] neg_hi:[0,1]
  v_pk_add_f32 v[110:111], v[110:111], v[206:207] neg_lo:[0,1] neg_hi:[0,1]
  v_cvt_pk_bf16_f32 v108, 0, v108
  v_cvt_pk_bf16_f32 v109, 0, v109
  v_cvt_pk_bf16_f32 v110, 0, v110
  v_cvt_pk_bf16_f32 v111, 0, v111
  v_pk_mul_f32 v[108:109], v[108:109], v[192:193]
  v_pk_mul_f32 v[110:111], v[110:111], v[194:195]
  v_cvt_pk_bf16_f32 v216, v108, v109
  v_cvt_pk_bf16_f32 v217, v110, v111
  s_waitcnt vmcnt(14)
  buffer_load_dwordx4 v[48:51], v94, s[8:11], s60 offen offset:1024 nt
  v_cvt_f32_i32 v108, v76
  v_cvt_f32_i32 v109, v77
  v_cvt_f32_i32 v110, v78
  v_cvt_f32_i32 v111, v79
  v_pk_add_f32 v[108:109], v[108:109], v[208:209] neg_lo:[0,1] neg_hi:[0,1]
  v_pk_add_f32 v[110:111], v[110:111], v[210:211] neg_lo:[0,1] neg_hi:[0,1]
  v_mov_b32_dpp v144, v224 quad_perm:[0,0,0,0] row_mask:0xf bank_mask:0xf
  v_mov_b32_dpp v145, v226 quad_perm:[2,2,2,2] row_mask:0xf bank_mask:0xf
  v_cvt_pk_bf16_f32 v108, 0, v108
  v_cvt_pk_bf16_f32 v109, 0, v109
  v_add_f32_dpp v144, v225, v144 quad_perm:[1,1,1,1] row_mask:0xf bank_mask:0xf
  v_add_f32_dpp v145, v227, v145 quad_perm:[3,3,3,3] row_mask:0xf bank_mask:0xf
  v_cvt_pk_bf16_f32 v110, 0, v110
  v_cvt_pk_bf16_f32 v111, 0, v111
  v_add_f32 v229, v144, v145
  v_pk_mul_f32 v[108:109], v[108:109], v[196:197]
  v_pk_mul_f32 v[110:111], v[110:111], v[198:199]
  v_cvt_pk_bf16_f32 v218, v108, v109
  v_cvt_pk_bf16_f32 v219, v110, v111
  s_waitcnt vmcnt(14)
  buffer_load_dwordx4 v[52:55], v94, s[8:11], s60 offen offset:1280 nt
  v_mfma_f32_16x16x32_bf16 v[224:227], v[216:219], v[168:171], 0
  v_cvt_f32_i32 v108, v80
  v_cvt_f32_i32 v109, v81
  v_cvt_f32_i32 v110, v82
  v_cvt_f32_i32 v111, v83
  v_pk_add_f32 v[108:109], v[108:109], v[212:213] neg_lo:[0,1] neg_hi:[0,1]
  v_pk_add_f32 v[110:111], v[110:111], v[214:215] neg_lo:[0,1] neg_hi:[0,1]
  v_cvt_pk_bf16_f32 v108, 0, v108
  v_cvt_pk_bf16_f32 v228, 0, v228
  v_cvt_pk_bf16_f32 v109, 0, v109
  v_cvt_pk_bf16_f32 v229, 0, v229
  v_cvt_pk_bf16_f32 v110, 0, v110
  v_pk_mul_f32 v[228:229], v[228:229], s[68:69]
  v_cvt_pk_bf16_f32 v111, 0, v111
  v_cvt_pk_bf16_f32 v120, v228, v229
  v_pk_mul_f32 v[108:109], v[108:109], v[200:201]
  v_pk_mul_f32 v[110:111], v[110:111], v[202:203]
  v_cvt_pk_bf16_f32 v220, v108, v109
  v_cvt_pk_bf16_f32 v221, v110, v111
  s_waitcnt vmcnt(14)
  s_cbranch_vccnz L_kw1_9
  s_waitcnt vmcnt(9)
L_kw1_9:
  buffer_load_dwordx4 v[56:59], v94, s[8:11], s60 offen offset:1536 nt
  v_mfma_f32_16x16x16_bf16 v[224:227], v[220:221], v[172:173], v[224:227]
  v_cvt_f32_i32 v108, v84
  v_cvt_f32_i32 v109, v85
  v_cvt_f32_i32 v110, v86
  v_cvt_f32_i32 v111, v87
  v_pk_add_f32 v[108:109], v[108:109], v[204:205] neg_lo:[0,1] neg_hi:[0,1]
  v_pk_add_f32 v[110:111], v[110:111], v[206:207] neg_lo:[0,1] neg_hi:[0,1]
  v_cvt_pk_bf16_f32 v108, 0, v108
  v_cvt_pk_bf16_f32 v109, 0, v109
  v_cvt_pk_bf16_f32 v110, 0, v110
  v_cvt_pk_bf16_f32 v111, 0, v111
  v_pk_mul_f32 v[108:109], v[108:109], v[192:193]
  v_pk_mul_f32 v[110:111], v[110:111], v[194:195]
  v_cvt_pk_bf16_f32 v216, v108, v109
  v_cvt_pk_bf16_f32 v217, v110, v111
  s_waitcnt vmcnt(14)
  buffer_load_dwordx4 v[60:63], v94, s[8:11], s60 offen offset:1792 nt
  v_cvt_f32_i32 v108, v88
  v_cvt_f32_i32 v109, v89
  v_cvt_f32_i32 v110, v90
  v_cvt_f32_i32 v111, v91
  v_pk_add_f32 v[108:109], v[108:109], v[208:209] neg_lo:[0,1] neg_hi:[0,1]
  v_pk_add_f32 v[110:111], v[110:111], v[210:211] neg_lo:[0,1] neg_hi:[0,1]
  v_mov_b32_dpp v144, v224 quad_perm:[0,0,0,0] row_mask:0xf bank_mask:0xf
  v_mov_b32_dpp v145, v226 quad_perm:[2,2,2,2] row_mask:0xf bank_mask:0xf
  v_cvt_pk_bf16_f32 v108, 0, v108
  v_cvt_pk_bf16_f32 v109, 0, v109
  v_add_f32_dpp v144, v225, v144 quad_perm:[1,1,1,1] row_mask:0xf bank_mask:0xf
  v_add_f32_dpp v145, v227, v145 quad_perm:[3,3,3,3] row_mask:0xf bank_mask:0xf
  v_cvt_pk_bf16_f32 v110, 0, v110
  v_cvt_pk_bf16_f32 v111, 0, v111
  v_add_f32 v228, v144, v145
  v_pk_mul_f32 v[108:109], v[108:109], v[196:197]
  v_pk_mul_f32 v[110:111], v[110:111], v[198:199]
  v_cvt_pk_bf16_f32 v218, v108, v109
  v_cvt_pk_bf16_f32 v219, v110, v111
  s_waitcnt vmcnt(14)
  buffer_load_dwordx4 v[64:67], v94, s[8:11], s60 offen offset:2048 nt
  v_mfma_f32_16x16x32_bf16 v[224:227], v[216:219], v[168:171], 0
  v_cvt_f32_i32 v108, v4
  v_cvt_f32_i32 v109, v5
  v_cvt_f32_i32 v110, v6
  v_cvt_f32_i32 v111, v7
  v_pk_add_f32 v[108:109], v[108:109], v[212:213] neg_lo:[0,1] neg_hi:[0,1]
  v_pk_add_f32 v[110:111], v[110:111], v[214:215] neg_lo:[0,1] neg_hi:[0,1]
  v_cvt_pk_bf16_f32 v108, 0, v108
  v_cvt_pk_bf16_f32 v109, 0, v109
  v_cvt_pk_bf16_f32 v110, 0, v110
  v_cvt_pk_bf16_f32 v111, 0, v111
  v_pk_mul_f32 v[108:109], v[108:109], v[200:201]
  v_pk_mul_f32 v[110:111], v[110:111], v[202:203]
  v_cvt_pk_bf16_f32 v220, v108, v109
  v_cvt_pk_bf16_f32 v221, v110, v111
  s_waitcnt vmcnt(14)
  s_cbranch_vccnz L_kw1_12
  s_waitcnt vmcnt(9)
L_kw1_12:
  buffer_load_dwordx4 v[68:71], v94, s[8:11], s60 offen offset:2304 nt
  v_mfma_f32_16x16x16_bf16 v[224:227], v[220:221], v[172:173], v[224:227]
  v_cvt_f32_i32 v108, v8
  v_cvt_f32_i32 v109, v9
  v_cvt_f32_i32 v110, v10
  v_cvt_f32_i32 v111, v11
  v_pk_add_f32 v[108:109], v[108:109], v[204:205] neg_lo:[0,1] neg_hi:[0,1]
  v_pk_add_f32 v[110:111], v[110:111], v[206:207] neg_lo:[0,1] neg_hi:[0,1]
  v_cvt_pk_bf16_f32 v108, 0, v108
  v_cvt_pk_bf16_f32 v109, 0, v109
  v_cvt_pk_bf16_f32 v110, 0, v110
  v_cvt_pk_bf16_f32 v111, 0, v111
  v_pk_mul_f32 v[108:109], v[108:109], v[192:193]
  v_pk_mul_f32 v[110:111], v[110:111], v[194:195]
  v_cvt_pk_bf16_f32 v216, v108, v109
  v_cvt_pk_bf16_f32 v217, v110, v111
  s_waitcnt vmcnt(14)
  buffer_load_dwordx4 v[72:75], v94, s[8:11], s60 offen offset:2560 nt
  v_cvt_f32_i32 v108, v12
  v_cvt_f32_i32 v109, v13
  v_cvt_f32_i32 v110, v14
  v_cvt_f32_i32 v111, v15
  v_pk_add_f32 v[108:109], v[108:109], v[208:209] neg_lo:[0,1] neg_hi:[0,1]
  v_pk_add_f32 v[110:111], v[110:111], v[210:211] neg_lo:[0,1] neg_hi:[0,1]
  v_mov_b32_dpp v144, v224 quad_perm:[0,0,0,0] row_mask:0xf bank_mask:0xf
  v_mov_b32_dpp v145, v226 quad_perm:[2,2,2,2] row_mask:0xf bank_mask:0xf
  v_cvt_pk_bf16_f32 v108, 0, v108
  v_cvt_pk_bf16_f32 v109, 0, v109
  v_add_f32_dpp v144, v225, v144 quad_perm:[1,1,1,1] row_mask:0xf bank_mask:0xf
  v_add_f32_dpp v145, v227, v145 quad_perm:[3,3,3,3] row_mask:0xf bank_mask:0xf
  v_cvt_pk_bf16_f32 v110, 0, v110
  v_cvt_pk_bf16_f32 v111, 0, v111
  v_add_f32 v229, v144, v145
  v_pk_mul_f32 v[108:109], v[108:109], v[196:197]
  v_pk_mul_f32 v[110:111], v[110:111], v[198:199]
  v_cvt_pk_bf16_f32 v218, v108, v109
  v_cvt_pk_bf16_f32 v219, v110, v111
  s_waitcnt vmcnt(14)
  buffer_load_dwordx4 v[76:79], v94, s[8:11], s60 offen offset:2816 nt
  v_mfma_f32_16x16x32_bf16 v[224:227], v[216:219], v[168:171], 0
  v_cvt_f32_i32 v108, v16
  v_cvt_f32_i32 v109, v17
  v_cvt_f32_i32 v110, v18
  v_cvt_f32_i32 v111, v19
  v_pk_add_f32 v[108:109], v[108:109], v[212:213] neg_lo:[0,1] neg_hi:[0,1]
  v_pk_add_f32 v[110:111], v[110:111], v[214:215] neg_lo:[0,1] neg_hi:[0,1]
  v_cvt_pk_bf16_f32 v108, 0, v108
  v_cvt_pk_bf16_f32 v228, 0, v228
  v_cvt_pk_bf16_f32 v109, 0, v109
  v_cvt_pk_bf16_f32 v229, 0, v229
  v_cvt_pk_bf16_f32 v110, 0, v110
  v_pk_mul_f32 v[228:229], v[228:229], s[68:69]
  v_cvt_pk_bf16_f32 v111, 0, v111
  v_cvt_pk_bf16_f32 v121, v228, v229
  v_pk_mul_f32 v[108:109], v[108:109], v[200:201]
  v_pk_mul_f32 v[110:111], v[110:111], v[202:203]
  v_cvt_pk_bf16_f32 v220, v108, v109
  v_cvt_pk_bf16_f32 v221, v110, v111
  s_waitcnt vmcnt(14)
  s_cbranch_vccnz L_kw1_15
  s_waitcnt vmcnt(9)
L_kw1_15:
  buffer_load_dwordx4 v[80:83], v95, s[8:11], s60 offen offset:0 nt
  v_mfma_f32_16x16x16_bf16 v[224:227], v[220:221], v[172:173], v[224:227]
  v_cvt_f32_i32 v108, v20
  v_cvt_f32_i32 v109, v21
  v_cvt_f32_i32 v110, v22
  v_cvt_f32_i32 v111, v23
  v_pk_add_f32 v[108:109], v[108:109], v[204:205] neg_lo:[0,1] neg_hi:[0,1]
  v_pk_add_f32 v[110:111], v[110:111], v[206:207] neg_lo:[0,1] neg_hi:[0,1]
  v_cvt_pk_bf16_f32 v108, 0, v108
  v_cvt_pk_bf16_f32 v109, 0, v109
  v_cvt_pk_bf16_f32 v110, 0, v110
  v_cvt_pk_bf16_f32 v111, 0, v111
  v_pk_mul_f32 v[108:109], v[108:109], v[192:193]
  v_pk_mul_f32 v[110:111], v[110:111], v[194:195]
  v_cvt_pk_bf16_f32 v216, v108, v109
  v_cvt_pk_bf16_f32 v217, v110, v111
  s_waitcnt vmcnt(14)
  buffer_load_dwordx4 v[84:87], v95, s[8:11], s60 offen offset:256 nt
  v_cvt_f32_i32 v108, v24
  v_cvt_f32_i32 v109, v25
  v_cvt_f32_i32 v110, v26
  v_cvt_f32_i32 v111, v27
  v_pk_add_f32 v[108:109], v[108:109], v[208:209] neg_lo:[0,1] neg_hi:[0,1]
  v_pk_add_f32 v[110:111], v[110:111], v[210:211] neg_lo:[0,1] neg_hi:[0,1]
  v_mov_b32_dpp v144, v224 quad_perm:[0,0,0,0] row_mask:0xf bank_mask:0xf
  v_mov_b32_dpp v145, v226 quad_perm:[2,2,2,2] row_mask:0xf bank_mask:0xf
  v_cvt_pk_bf16_f32 v108, 0, v108
  v_cvt_pk_bf16_f32 v109, 0, v109
  v_add_f32_dpp v144, v225, v144 quad_perm:[1,1,1,1] row_mask:0xf bank_mask:0xf
  v_add_f32_dpp v145, v227, v145 quad_perm:[3,3,3,3] row_mask:0xf bank_mask:0xf
  v_cvt_pk_bf16_f32 v110, 0, v110
  v_cvt_pk_bf16_f32 v111, 0, v111
  v_add_f32 v228, v144, v145
  v_pk_mul_f32 v[108:109], v[108:109], v[196:197]
  v_pk_mul_f32 v[110:111], v[110:111], v[198:199]
  v_cvt_pk_bf16_f32 v218, v108, v109
  v_cvt_pk_bf16_f32 v219, v110, v111
  s_waitcnt vmcnt(14)
  buffer_load_dwordx4 v[88:91], v95, s[8:11], s60 offen offset:512 nt
  v_mfma_f32_16x16x32_bf16 v[224:227], v[216:219], v[168:171], 0
  v_cvt_f32_i32 v108, v28
  v_cvt_f32_i32 v109, v29
  v_cvt_f32_i32 v110, v30
  v_cvt_f32_i32 v111, v31
  v_pk_add_f32 v[108:109], v[108:109], v[212:213] neg_lo:[0,1] neg_hi:[0,1]
  v_pk_add_f32 v[110:111], v[110:111], v[214:215] neg_lo:[0,1] neg_hi:[0,1]
  s_cmp_lt_u32 s64, s99
  s_cbranch_scc1 L_k_known1
L_k_spin1:
  v_mov_b32 v144, 61696
  ds_read_b32 v144, v144
  s_waitcnt lgkmcnt(0)
  v_readfirstlane_b32 s96, v144
  s_nop 1
  s_cmp_eq_u32 s96, 0
  s_cbranch_scc1 L_k_spin1
  s_mov_b32 s99, -1
L_k_known1:
  s_lshr_b32 s71, s64, 4
  s_andn2_b32 s71, s71, 1
  s_lshr_b32 s71, 0x12, s71
  s_and_b32 s71, s71, 3
  s_lshr_b32 s85, s96, s71
  s_andn2_b32 s70, s64, 1
  s_or_b32 s70, s70, s4
  s_cmp_lt_u32 s64, 8
  s_cselect_b32 s70, s70, s64
  s_cselect_b32 s85, s64, s85
  s_and_b32 s85, s85, 1
  s_and_b32 s70, s70, 31
  s_lshl_b32 s71, s71, 12
  s_add_u32 s70, s70, s5
  s_add_u32 s70, s70, s71
  s_mul_hi_u32 s84, s70, s90
  s_lshr_b32 s84, s84, 1
  s_mul_i32 s71, s84, 3
  s_sub_u32 s70, s70, s71
  s_lshl3_add_u32 s85, s70, s85
  s_mul_i32 s61, s84, 196608
  s_lshr_b32 s89, s84, 4
  s_lshl_b32 s70, s85, 5
  v_add_u32 v97, s70, v230
  v_mul_u32_u24 v97, 21846, v97
  v_lshrrev_b32 v97, 16, v97
  v_add_u32 v144, s85, v231
  v_lshrrev_b32 v145, v144, s91
  v_and_b32 v145, 1, v145
  v_cmp_eq_u32 s[54:55], 1, v145
  s_nop 1
  s_and_b64 s[52:53], s[54:55], s[56:57]
  s_andn2_b64 s[54:55], s[54:55], s[56:57]
  v_mul_u32_u24 v144, 43, v144
  v_lshrrev_b32 v144, 8, v144
  v_mul_u32_u24 v144, 384, v144
  v_add_u32 v234, v144, v233
  s_cmp_eq_u32 s89, s88
  s_cbranch_scc1 L_k_sameq1
  s_mul_i32 s70, s89, 1536
  buffer_load_dwordx2 v[174:175], v235, s[36:39], s70 offen offset:0
  buffer_load_dwordx2 v[176:177], v235, s[36:39], s70 offen offset:128
  buffer_load_dwordx2 v[178:179], v235, s[36:39], s70 offen offset:256
  s_mov_b32 s88, s89
L_k_sameq1:
  s_mul_i32 s62, s84, 1536
  buffer_load_dwordx2 v[180:181], v234, s[20:23], s62 offen offset:0
  buffer_load_dwordx2 v[186:187], v234, s[24:27], s62 offen offset:0
  buffer_load_dwordx2 v[182:183], v234, s[20:23], s62 offen offset:128
  buffer_load_dwordx2 v[188:189], v234, s[24:27], s62 offen offset:128
  buffer_load_dwordx2 v[184:185], v234, s[20:23], s62 offen offset:256
  buffer_load_dwordx2 v[190:191], v234, s[24:27], s62 offen offset:256
  v_cvt_pk_bf16_f32 v108, 0, v108
  v_cvt_pk_bf16_f32 v109, 0, v109
  v_cvt_pk_bf16_f32 v110, 0, v110
  v_cvt_pk_bf16_f32 v111, 0, v111
  v_pk_mul_f32 v[108:109], v[108:109], v[200:201]
  v_pk_mul_f32 v[110:111], v[110:111], v[202:203]
  v_cvt_pk_bf16_f32 v220, v108, v109
  v_cvt_pk_bf16_f32 v221, v110, v111
  s_cmp_lt_u32 s64, 96
  s_cbranch_scc1 L_k_keep
  s_lshr_b32 s71, s3, 5
  s_lshr_b32 s85, s96, s71
  s_bfe_u32 s85, s85, 0x10003
  s_and_b32 s70, s3, 31
  s_lshl_b32 s71, s71, 12
  s_add_u32 s70, s70, s5
  s_add_u32 s70, s70, s71
  s_mul_hi_u32 s84, s70, s90
  s_lshr_b32 s84, s84, 1
  s_mul_i32 s71, s84, 3
  s_sub_u32 s70, s70, s71
  s_lshl3_add_u32 s85, s70, s85
  s_mul_i32 s61, s84, 196608
  s_lshr_b32 s89, s84, 4
  s_lshl_b32 s70, s85, 5
  v_add_u32 v97, s70, v1
  v_mul_u32_u24 v97, 21846, v97
  v_lshrrev_b32 v97, 16, v97
  v_add_u32 v144, s85, v2
  v_lshrrev_b32 v145, v144, s91
  v_and_b32 v145, 1, v145
  v_cmp_eq_u32 s[54:55], 1, v145
  s_nop 1
  s_and_b64 s[52:53], s[54:55], s[58:59]
  s_andn2_b64 s[54:55], s[54:55], s[58:59]
  s_mov_b32 s16, s12
  s_mov_b32 s17, s13
  s_lshl_b32 s62, s84, 9
  v_lshl_add_u32 v98, v97, 1, v96
  buffer_load_short_d16_hi v112, v98, s[32:35], s62 offen
  buffer_load_short_d16_hi v113, v98, s[28:31], s62 offen
  v_mov_b32 v232, v3
L_k_keep:
  v_mad_u32_u24 v92, v97, s63, v232
  v_add_u32 v93, 768, v92
  v_add_u32 v94, 4608, v92
  v_add_u32 v95, 7680, v92
  v_cndmask_b32 v92, v92, v105, s[52:53]
  v_cndmask_b32 v95, v95, v105, s[54:55]
  s_waitcnt vmcnt(20)
  s_cbranch_vccnz L_kw1_18
  s_waitcnt vmcnt(15)
L_kw1_18:
  buffer_load_dwordx4 v[4:7], v92, s[16:19], s61 offen offset:0 nt
  v_mfma_f32_16x16x16_bf16 v[224:227], v[220:221], v[172:173], v[224:227]
  v_cvt_f32_i32 v108, v32
  v_cvt_f32_i32 v109, v33
  v_cvt_f32_i32 v110, v34
  v_cvt_f32_i32 v111, v35
  v_pk_add_f32 v[108:109], v[108:109], v[204:205] neg_lo:[0,1] neg_hi:[0,1]
  v_pk_add_f32 v[110:111], v[110:111], v[206:207] neg_lo:[0,1] neg_hi:[0,1]
  v_cvt_pk_bf16_f32 v108, 0, v108
  v_cvt_pk_bf16_f32 v109, 0, v109
  v_cvt_pk_bf16_f32 v110, 0, v110
  v_cvt_pk_bf16_f32 v111, 0, v111
  v_pk_mul_f32 v[108:109], v[108:109], v[192:193]
  v_pk_mul_f32 v[110:111], v[110:111], v[194:195]
  v_cvt_pk_bf16_f32 v216, v108, v109
  v_cvt_pk_bf16_f32 v217, v110, v111
  s_waitcnt vmcnt(20)
  buffer_load_dwordx4 v[8:11], v92, s[16:19], s61 offen offset:256 nt
  v_cvt_f32_i32 v108, v36
  v_cvt_f32_i32 v109, v37
  v_cvt_f32_i32 v110, v38
  v_cvt_f32_i32 v111, v39
  v_pk_add_f32 v[108:109], v[108:109], v[208:209] neg_lo:[0,1] neg_hi:[0,1]
  v_pk_add_f32 v[110:111], v[110:111], v[210:211] neg_lo:[0,1] neg_hi:[0,1]
  v_mov_b32_dpp v144, v224 quad_perm:[0,0,0,0] row_mask:0xf bank_mask:0xf
  v_mov_b32_dpp v145, v226 quad_perm:[2,2,2,2] row_mask:0xf bank_mask:0xf
  v_cvt_pk_bf16_f32 v108, 0, v108
  v_cvt_pk_bf16_f32 v109, 0, v109
  v_add_f32_dpp v144, v225, v144 quad_perm:[1,1,1,1] row_mask:0xf bank_mask:0xf
  v_add_f32_dpp v145, v227, v145 quad_perm:[3,3,3,3] row_mask:0xf bank_mask:0xf
  v_cvt_pk_bf16_f32 v110, 0, v110
  v_cvt_pk_bf16_f32 v111, 0, v111
  v_add_f32 v229, v144, v145
  v_pk_mul_f32 v[108:109], v[108:109], v[196:197]
  v_pk_mul_f32 v[110:111], v[110:111], v[198:199]
  v_cvt_pk_bf16_f32 v218, v108, v109
  v_cvt_pk_bf16_f32 v219, v110, v111
  s_waitcnt vmcnt(20)
  buffer_load_dwordx4 v[12:15], v92, s[16:19], s61 offen offset:512 nt
  v_mfma_f32_16x16x32_bf16 v[224:227], v[216:219], v[168:171], 0
  v_cvt_f32_i32 v108, v40
  v_cvt_f32_i32 v109, v41
  v_cvt_f32_i32 v110, v42
  v_cvt_f32_i32 v111, v43
  v_pk_add_f32 v[108:109], v[108:109], v[212:213] neg_lo:[0,1] neg_hi:[0,1]
  v_pk_add_f32 v[110:111], v[110:111], v[214:215] neg_lo:[0,1] neg_hi:[0,1]
  v_cvt_pk_bf16_f32 v108, 0, v108
  v_cvt_pk_bf16_f32 v228, 0, v228
  v_cvt_pk_bf16_f32 v109, 0, v109
  v_cvt_pk_bf16_f32 v229, 0, v229
  v_cvt_pk_bf16_f32 v110, 0, v110
  v_pk_mul_f32 v[228:229], v[228:229], s[68:69]
  v_cvt_pk_bf16_f32 v111, 0, v111
  v_cvt_pk_bf16_f32 v122, v228, v229
  v_pk_mul_f32 v[108:109], v[108:109], v[200:201]
  v_pk_mul_f32 v[110:111], v[110:111], v[202:203]
  v_cvt_pk_bf16_f32 v220, v108, v109
  v_cvt_pk_bf16_f32 v221, v110, v111
  s_waitcnt vmcnt(20)
  s_cbranch_vccnz L_kw1_21
  s_waitcnt vmcnt(15)
L_kw1_21:
  buffer_load_dwordx4 v[16:19], v93, s[16:19], s61 offen offset:0 nt
  v_mfma_f32_16x16x16_bf16 v[224:227], v[220:221], v[172:173], v[224:227]
  v_cvt_f32_i32 v108, v44
  v_cvt_f32_i32 v109, v45
  v_cvt_f32_i32 v110, v46
  v_cvt_f32_i32 v111, v47
  v_pk_add_f32 v[108:109], v[108:109], v[204:205] neg_lo:[0,1] neg_hi:[0,1]
  v_pk_add_f32 v[110:111], v[110:111], v[206:207] neg_lo:[0,1] neg_hi:[0,1]
  v_cvt_pk_bf16_f32 v108, 0, v108
  v_cvt_pk_bf16_f32 v109, 0, v109
  v_cvt_pk_bf16_f32 v110, 0, v110
  v_cvt_pk_bf16_f32 v111, 0, v111
  v_pk_mul_f32 v[108:109], v[108:109], v[192:193]
  v_pk_mul_f32 v[110:111], v[110:111], v[194:195]
  v_cvt_pk_bf16_f32 v216, v108, v109
  v_cvt_pk_bf16_f32 v217, v110, v111
  s_waitcnt vmcnt(20)
  buffer_load_dwordx4 v[20:23], v93, s[16:19], s61 offen offset:256 nt
  v_cvt_f32_i32 v108, v48
  v_cvt_f32_i32 v109, v49
  v_cvt_f32_i32 v110, v50
  v_cvt_f32_i32 v111, v51
  v_pk_add_f32 v[108:109], v[108:109], v[208:209] neg_lo:[0,1] neg_hi:[0,1]
  v_pk_add_f32 v[110:111], v[110:111], v[210:211] neg_lo:[0,1] neg_hi:[0,1]
  v_mov_b32_dpp v144, v224 quad_perm:[0,0,0,0] row_mask:0xf bank_mask:0xf
  v_mov_b32_dpp v145, v226 quad_perm:[2,2,2,2] row_mask:0xf bank_mask:0xf
  v_cvt_pk_bf16_f32 v108, 0, v108
  v_cvt_pk_bf16_f32 v109, 0, v109
  v_add_f32_dpp v144, v225, v144 quad_perm:[1,1,1,1] row_mask:0xf bank_mask:0xf
  v_add_f32_dpp v145, v227, v145 quad_perm:[3,3,3,3] row_mask:0xf bank_mask:0xf
  v_cvt_pk_bf16_f32 v110, 0, v110
  v_cvt_pk_bf16_f32 v111, 0, v111
  v_add_f32 v228, v144, v145
  v_pk_mul_f32 v[108:109], v[108:109], v[196:197]
  v_pk_mul_f32 v[110:111], v[110:111], v[198:199]
  v_cvt_pk_bf16_f32 v218, v108, v109
  v_cvt_pk_bf16_f32 v219, v110, v111
  s_waitcnt vmcnt(20)
  buffer_load_dwordx4 v[24:27], v93, s[16:19], s61 offen offset:512 nt
  v_mfma_f32_16x16x32_bf16 v[224:227], v[216:219], v[168:171], 0
  v_cvt_f32_i32 v108, v52
  v_cvt_f32_i32 v109, v53
  v_cvt_f32_i32 v110, v54
  v_cvt_f32_i32 v111, v55
  v_pk_add_f32 v[108:109], v[108:109], v[212:213] neg_lo:[0,1] neg_hi:[0,1]
  v_pk_add_f32 v[110:111], v[110:111], v[214:215] neg_lo:[0,1] neg_hi:[0,1]
  v_cvt_pk_bf16_f32 v108, 0, v108
  v_cvt_pk_bf16_f32 v109, 0, v109
  v_cvt_pk_bf16_f32 v110, 0, v110
  v_cvt_pk_bf16_f32 v111, 0, v111
  v_pk_mul_f32 v[108:109], v[108:109], v[200:201]
  v_pk_mul_f32 v[110:111], v[110:111], v[202:203]
  v_cvt_pk_bf16_f32 v220, v108, v109
  v_cvt_pk_bf16_f32 v221, v110, v111
  s_waitcnt vmcnt(20)
  s_cbranch_vccnz L_kw1_24
  s_waitcnt vmcnt(15)
L_kw1_24:
  buffer_load_dwordx4 v[28:31], v93, s[16:19], s61 offen offset:768 nt
  v_mfma_f32_16x16x16_bf16 v[224:227], v[220:221], v[172:173], v[224:227]
  v_cvt_f32_i32 v108, v56
  v_cvt_f32_i32 v109, v57
  v_cvt_f32_i32 v110, v58
  v_cvt_f32_i32 v111, v59
  v_pk_add_f32 v[108:109], v[108:109], v[204:205] neg_lo:[0,1] neg_hi:[0,1]
  v_pk_add_f32 v[110:111], v[110:111], v[206:207] neg_lo:[0,1] neg_hi:[0,1]
  v_cvt_pk_bf16_f32 v108, 0, v108
  v_cvt_pk_bf16_f32 v109, 0, v109
  v_cvt_pk_bf16_f32 v110, 0, v110
  v_cvt_pk_bf16_f32 v111, 0, v111
  v_pk_mul_f32 v[108:109], v[108:109], v[192:193]
  v_pk_mul_f32 v[110:111], v[110:111], v[194:195]
  v_cvt_pk_bf16_f32 v216, v108, v109
  v_cvt_pk_bf16_f32 v217, v110, v111
  s_waitcnt vmcnt(20)
  buffer_load_dwordx4 v[32:35], v93, s[16:19], s61 offen offset:1024 nt
  v_cvt_f32_i32 v108, v60
  v_cvt_f32_i32 v109, v61
  v_cvt_f32_i32 v110, v62
  v_cvt_f32_i32 v111, v63
  v_pk_add_f32 v[108:109], v[108:109], v[208:209] neg_lo:[0,1] neg_hi:[0,1]
  v_pk_add_f32 v[110:111], v[110:111], v[210:211] neg_lo:[0,1] neg_hi:[0,1]
  v_mov_b32_dpp v144, v224 quad_perm:[0,0,0,0] row_mask:0xf bank_mask:0xf
  v_mov_b32_dpp v145, v226 quad_perm:[2,2,2,2] row_mask:0xf bank_mask:0xf
  v_cvt_pk_bf16_f32 v108, 0, v108
  v_cvt_pk_bf16_f32 v109, 0, v109
  v_add_f32_dpp v144, v225, v144 quad_perm:[1,1,1,1] row_mask:0xf bank_mask:0xf
  v_add_f32_dpp v145, v227, v145 quad_perm:[3,3,3,3] row_mask:0xf bank_mask:0xf
  v_cvt_pk_bf16_f32 v110, 0, v110
  v_cvt_pk_bf16_f32 v111, 0, v111
  v_add_f32 v229, v144, v145
  v_pk_mul_f32 v[108:109], v[108:109], v[196:197]
  v_pk_mul_f32 v[110:111], v[110:111], v[198:199]
  v_cvt_pk_bf16_f32 v218, v108, v109
  v_cvt_pk_bf16_f32 v219, v110, v111
  s_waitcnt vmcnt(20)
  buffer_load_dwordx4 v[36:39], v93, s[16:19], s61 offen offset:1280 nt
  v_mfma_f32_16x16x32_bf16 v[224:227], v[216:219], v[168:171], 0
  v_cvt_f32_i32 v108, v64
  v_cvt_f32_i32 v109, v65
  v_cvt_f32_i32 v110, v66
  v_cvt_f32_i32 v111, v67
  v_pk_add_f32 v[108:109], v[108:109], v[212:213] neg_lo:[0,1] neg_hi:[0,1]
  v_pk_add_f32 v[110:111], v[110:111], v[214:215] neg_lo:[0,1] neg_hi:[0,1]
  v_cvt_pk_bf16_f32 v108, 0, v108
  v_cvt_pk_bf16_f32 v228, 0, v228
  v_cvt_pk_bf16_f32 v109, 0, v109
  v_cvt_pk_bf16_f32 v229, 0, v229
  v_cvt_pk_bf16_f32 v110, 0, v110
  v_pk_mul_f32 v[228:229], v[228:229], s[68:69]
  v_cvt_pk_bf16_f32 v111, 0, v111
  v_cvt_pk_bf16_f32 v123, v228, v229
  v_pk_mul_f32 v[108:109], v[108:109], v[200:201]
  v_pk_mul_f32 v[110:111], v[110:111], v[202:203]
  v_cvt_pk_bf16_f32 v220, v108, v109
  v_cvt_pk_bf16_f32 v221, v110, v111
  s_waitcnt vmcnt(20)
  s_cbranch_vccnz L_kw1_27
  s_waitcnt vmcnt(15)
L_kw1_27:
  buffer_load_dwordx4 v[40:43], v93, s[16:19], s61 offen offset:1536 nt
  v_mfma_f32_16x16x16_bf16 v[224:227], v[220:221], v[172:173], v[224:227]
  v_cvt_f32_i32 v108, v68
  v_cvt_f32_i32 v109, v69
  v_cvt_f32_i32 v110, v70
  v_cvt_f32_i32 v111, v71
  v_pk_add_f32 v[108:109], v[108:109], v[204:205] neg_lo:[0,1] neg_hi:[0,1]
  v_pk_add_f32 v[110:111], v[110:111], v[206:207] neg_lo:[0,1] neg_hi:[0,1]
  v_cvt_pk_bf16_f32 v108, 0, v108
  v_cvt_pk_bf16_f32 v109, 0, v109
  v_cvt_pk_bf16_f32 v110, 0, v110
  v_cvt_pk_bf16_f32 v111, 0, v111
  v_pk_mul_f32 v[108:109], v[108:109], v[192:193]
  v_pk_mul_f32 v[110:111], v[110:111], v[194:195]
  v_cvt_pk_bf16_f32 v216, v108, v109
  v_cvt_pk_bf16_f32 v217, v110, v111
  s_waitcnt vmcnt(20)
  buffer_load_dwordx4 v[44:47], v93, s[16:19], s61 offen offset:1792 nt
  v_cvt_f32_i32 v108, v72
  v_cvt_f32_i32 v109, v73
  v_cvt_f32_i32 v110, v74
  v_cvt_f32_i32 v111, v75
  v_pk_add_f32 v[108:109], v[108:109], v[208:209] neg_lo:[0,1] neg_hi:[0,1]
  v_pk_add_f32 v[110:111], v[110:111], v[210:211] neg_lo:[0,1] neg_hi:[0,1]
  v_mov_b32_dpp v144, v224 quad_perm:[0,0,0,0] row_mask:0xf bank_mask:0xf
  v_mov_b32_dpp v145, v226 quad_perm:[2,2,2,2] row_mask:0xf bank_mask:0xf
  v_cvt_pk_bf16_f32 v108, 0, v108
  v_cvt_pk_bf16_f32 v109, 0, v109
  v_add_f32_dpp v144, v225, v144 quad_perm:[1,1,1,1] row_mask:0xf bank_mask:0xf
  v_add_f32_dpp v145, v227, v145 quad_perm:[3,3,3,3] row_mask:0xf bank_mask:0xf
  v_cvt_pk_bf16_f32 v110, 0, v110
  v_cvt_pk_bf16_f32 v111, 0, v111
  v_add_f32 v228, v144, v145
  v_pk_mul_f32 v[108:109], v[108:109], v[196:197]
  v_pk_mul_f32 v[110:111], v[110:111], v[198:199]
  v_cvt_pk_bf16_f32 v218, v108, v109
  v_cvt_pk_bf16_f32 v219, v110, v111
  s_waitcnt vmcnt(20)
  buffer_load_dwordx4 v[48:51], v93, s[16:19], s61 offen offset:2048 nt
  v_mfma_f32_16x16x32_bf16 v[224:227], v[216:219], v[168:171], 0
  v_cvt_f32_i32 v108, v76
  v_cvt_f32_i32 v109, v77
  v_cvt_f32_i32 v110, v78
  v_cvt_f32_i32 v111, v79
  v_pk_add_f32 v[108:109], v[108:109], v[212:213] neg_lo:[0,1] neg_hi:[0,1]
  v_pk_add_f32 v[110:111], v[110:111], v[214:215] neg_lo:[0,1] neg_hi:[0,1]
  v_cvt_pk_bf16_f32 v108, 0, v108
  v_cvt_pk_bf16_f32 v109, 0, v109
  v_cvt_pk_bf16_f32 v110, 0, v110
  v_cvt_pk_bf16_f32 v111, 0, v111
  v_pk_mul_f32 v[108:109], v[108:109], v[200:201]
  v_pk_mul_f32 v[110:111], v[110:111], v[202:203]
  v_cvt_pk_bf16_f32 v220, v108, v109
  v_cvt_pk_bf16_f32 v221, v110, v111
  s_waitcnt vmcnt(20)
  s_cbranch_vccnz L_kw1_30
  s_waitcnt vmcnt(9)
L_kw1_30:
  buffer_load_dwordx4 v[52:55], v93, s[16:19], s61 offen offset:2304 nt
  v_mfma_f32_16x16x16_bf16 v[224:227], v[220:221], v[172:173], v[224:227]
  v_cvt_f32_i32 v108, v80
  v_cvt_f32_i32 v109, v81
  v_cvt_f32_i32 v110, v82
  v_cvt_f32_i32 v111, v83
  v_pk_add_f32 v[108:109], v[108:109], v[204:205] neg_lo:[0,1] neg_hi:[0,1]
  v_pk_add_f32 v[110:111], v[110:111], v[206:207] neg_lo:[0,1] neg_hi:[0,1]
  v_cvt_pk_bf16_f32 v108, 0, v108
  v_cvt_pk_bf16_f32 v109, 0, v109
  v_cvt_pk_bf16_f32 v110, 0, v110
  v_cvt_pk_bf16_f32 v111, 0, v111
  v_pk_mul_f32 v[108:109], v[108:109], v[192:193]
  v_pk_mul_f32 v[110:111], v[110:111], v[194:195]
  v_cvt_pk_bf16_f32 v216, v108, v109
  v_cvt_pk_bf16_f32 v217, v110, v111
  s_waitcnt vmcnt(20)
  buffer_load_dwordx4 v[56:59], v93, s[16:19], s61 offen offset:2560 nt
  v_cvt_f32_i32 v108, v84
  v_cvt_f32_i32 v109, v85
  v_cvt_f32_i32 v110, v86
  v_cvt_f32_i32 v111, v87
  v_pk_add_f32 v[108:109], v[108:109], v[208:209] neg_lo:[0,1] neg_hi:[0,1]
  v_pk_add_f32 v[110:111], v[110:111], v[210:211] neg_lo:[0,1] neg_hi:[0,1]
  v_mov_b32_dpp v144, v224 quad_perm:[0,0,0,0] row_mask:0xf bank_mask:0xf
  v_mov_b32_dpp v145, v226 quad_perm:[2,2,2,2] row_mask:0xf bank_mask:0xf
  v_cvt_pk_bf16_f32 v108, 0, v108
  v_cvt_pk_bf16_f32 v109, 0, v109
  v_add_f32_dpp v144, v225, v144 quad_perm:[1,1,1,1] row_mask:0xf bank_mask:0xf
  v_add_f32_dpp v145, v227, v145 quad_perm:[3,3,3,3] row_mask:0xf bank_mask:0xf
  v_cvt_pk_bf16_f32 v110, 0, v110
  v_cvt_pk_bf16_f32 v111, 0, v111
  v_add_f32 v229, v144, v145
  v_pk_mul_f32 v[108:109], v[108:109], v[196:197]
  v_pk_mul_f32 v[110:111], v[110:111], v[198:199]
  v_cvt_pk_bf16_f32 v218, v108, v109
  v_cvt_pk_bf16_f32 v219, v110, v111
  s_waitcnt vmcnt(20)
  buffer_load_dwordx4 v[60:63], v93, s[16:19], s61 offen offset:2816 nt
  v_mfma_f32_16x16x32_bf16 v[224:227], v[216:219], v[168:171], 0
  v_cvt_f32_i32 v108, v88
  v_cvt_f32_i32 v109, v89
  v_cvt_f32_i32 v110, v90
  v_cvt_f32_i32 v111, v91
  v_pk_add_f32 v[108:109], v[108:109], v[212:213] neg_lo:[0,1] neg_hi:[0,1]
  v_pk_add_f32 v[110:111], v[110:111], v[214:215] neg_lo:[0,1] neg_hi:[0,1]
  v_cvt_pk_bf16_f32 v108, 0, v108
  v_cvt_pk_bf16_f32 v228, 0, v228
  v_cvt_pk_bf16_f32 v109, 0, v109
  v_cvt_pk_bf16_f32 v229, 0, v229
  v_cvt_pk_bf16_f32 v110, 0, v110
  v_pk_mul_f32 v[228:229], v[228:229], s[68:69]
  v_cvt_pk_bf16_f32 v111, 0, v111
  v_cvt_pk_bf16_f32 v124, v228, v229
  v_pk_mul_f32 v[108:109], v[108:109], v[200:201]
  v_pk_mul_f32 v[110:111], v[110:111], v[202:203]
  v_cvt_pk_bf16_f32 v220, v108, v109
  v_cvt_pk_bf16_f32 v221, v110, v111
  s_mov_b32 s60, s61
  v_mov_b32 v146, s64
  v_mfma_f32_16x16x16_bf16 v[224:227], v[220:221], v[172:173], v[224:227]
  ds_write_b128 v99, v[120:123]
  v_add_u32 v99, 768, v99
  s_nop 5
  v_mov_b32_dpp v144, v224 quad_perm:[0,0,0,0] row_mask:0xf bank_mask:0xf
  v_mov_b32_dpp v145, v226 quad_perm:[2,2,2,2] row_mask:0xf bank_mask:0xf
  s_nop 0
  v_add_f32_dpp v144, v225, v144 quad_perm:[1,1,1,1] row_mask:0xf bank_mask:0xf
  v_add_f32_dpp v145, v227, v145 quad_perm:[3,3,3,3] row_mask:0xf bank_mask:0xf
  v_add_f32 v228, v144, v145
  v_cndmask_b32 v228, v228, v236, s[50:51]
  v_cvt_pk_bf16_f32 v228, 0, v228
  v_cvt_pk_bf16_f32 v229, 0, v229
  v_pk_mul_f32 v[228:229], v[228:229], s[68:69]
  v_cvt_pk_bf16_f32 v125, v228, v229
  ds_write_b64 v100, v[124:125] offset:256
  ds_write_b32 v104, v146
  v_add_u32 v100, 768, v100
  s_cmp_lt_u32 s64, 96
  s_cbranch_scc1 L_k
  v_subrev_u32 v99, 24576, v99
  v_subrev_u32 v100, 24576, v100
  s_mov_b32 s64, s3
  s_mov_b32 s88, s89
  s_mov_b32 s99, 0
  s_mov_b32 s36, s46
  s_and_b32 s37, s47, 0xffff
  s_cmp_lt_u32 s64, s99
  s_cbranch_scc1 L_v0_ok
L_v0_spin:
  v_mov_b32 v144, 61700
  ds_read_b32 v144, v144
  s_waitcnt lgkmcnt(0)
  v_readfirstlane_b32 s99, v144
  s_nop 1
  s_cmp_lt_u32 s64, s99
  s_cbranch_scc0 L_v0_spin
L_v0_ok:
  ds_read_b128 v[120:123], v99
  ds_read_b64 v[124:125], v100 offset:256
  v_mov_b32 v128, 0
  v_mov_b32 v129, 0
  v_mov_b32 v130, 0
  v_mov_b32 v131, 0
  v_mov_b32 v132, 0
  v_mov_b32 v133, 0
  v_mov_b32 v134, 0
  v_mov_b32 v135, 0
  v_mov_b32 v136, 0
  v_mov_b32 v137, 0
  v_mov_b32 v138, 0
  v_mov_b32 v139, 0
  v_mov_b32 v140, 0xff800000
  v_mov_b32 v142, 0x7f800000
  v_mov_b32 v143, 0
L_v0:
  s_add_u32 s97, s64, 96
  v_mov_b32 v146, s97
  s_mov_b32 s86, s84
  ds_write_b32 v104, v146
  s_add_u32 s64, s64, 2
  s_cmp_lt_u32 s64, s99
  s_cbranch_scc1 L_v10_ok
L_v10_spin:
  v_mov_b32 v144, 61700
  ds_read_b32 v144, v144
  s_waitcnt lgkmcnt(0)
  v_readfirstlane_b32 s99, v144
  s_nop 1
  s_cmp_lt_u32 s64, s99
  s_cbranch_scc0 L_v10_spin
L_v10_ok:
  s_lshr_b32 s71, s64, 5
  s_lshr_b32 s85, s96, s71
  s_bfe_u32 s85, s85, 0x10003
  s_and_b32 s70, s64, 31
  s_lshl_b32 s71, s71, 12
  s_add_u32 s70, s70, s5
  s_add_u32 s70, s70, s71
  s_mul_hi_u32 s84, s70, s90
  s_lshr_b32 s84, s84, 1
  s_mul_i32 s71, s84, 3
  s_sub_u32 s70, s70, s71
  s_lshl3_add_u32 s85, s70, s85
  s_mul_i32 s61, s84, 196608
  s_lshr_b32 s89, s84, 4
  s_lshl_b32 s70, s85, 5
  v_add_u32 v97, s70, v1
  v_mul_u32_u24 v97, 21846, v97
  v_lshrrev_b32 v97, 16, v97
  v_add_u32 v144, s85, v2
  v_lshrrev_b32 v145, v144, s91
  v_and_b32 v145, 1, v145
  v_cmp_eq_u32 s[54:55], 1, v145
  s_nop 1
  s_and_b64 s[52:53], s[54:55], s[58:59]
  s_andn2_b64 s[54:55], s[54:55], s[58:59]
  s_cmp_lt_u32 s64, 96
  s_cselect_b32 s61, s61, 805306368
  ds_read_b32 v106, v104 offset:8
  s_waitcnt vmcnt(14)
  s_cbranch_vccnz L_vw0_0
  s_waitcnt vmcnt(9)
L_vw0_0:
  buffer_load_dwordx4 v[64:67], v93, s[12:15], s60 offen offset:3072 nt
  v_mov_b32 v114, v112
  v_mov_b32 v115, v113
  v_cvt_f32_i32 v192, v4
  v_cvt_f32_i32 v193, v5
  v_mov_b32_dpp v116, v114 row_newbcast:0 row_mask:0xf bank_mask:0xf
  v_mov_b32_dpp v117, v115 row_newbcast:0 row_mask:0xf bank_mask:0xf
  v_cvt_f32_i32 v194, v6
  v_cvt_f32_i32 v195, v7
  v_pk_add_f32 v[192:193], v[192:193], v[116:117] op_sel_hi:[1,0] neg_lo:[0,1] neg_hi:[0,1]
  v_pk_add_f32 v[194:195], v[194:195], v[116:117] op_sel_hi:[1,0] neg_lo:[0,1] neg_hi:[0,1]
  v_cvt_pk_bf16_f32 v192, 0, v192
  v_cvt_pk_bf16_f32 v193, 0, v193
  v_cvt_pk_bf16_f32 v194, 0, v194
  v_cvt_pk_bf16_f32 v195, 0, v195
  v_pk_mul_f32 v[192:193], v[192:193], v[116:117] op_sel:[0,1]
  v_pk_mul_f32 v[194:195], v[194:195], v[116:117] op_sel:[0,1]
  s_waitcnt lgkmcnt(0)
  v_cmp_lt_u32 vcc, s97, v106
  s_waitcnt vmcnt(14)
  buffer_load_dwordx4 v[68:71], v93, s[12:15], s60 offen offset:3328 nt
  v_cvt_f32_i32 v196, v8
  v_cvt_f32_i32 v197, v9
  v_cvt_f32_i32 v198, v10
  v_cvt_f32_i32 v199, v11
  v_pk_add_f32 v[196:197], v[196:197], v[116:117] op_sel_hi:[1,0] neg_lo:[0,1] neg_hi:[0,1]
  v_pk_add_f32 v[198:199], v[198:199], v[116:117] op_sel_hi:[1,0] neg_lo:[0,1] neg_hi:[0,1]
  v_cvt_pk_bf16_f32 v196, 0, v196
  v_lshlrev_b32 v148, 16, v120
  v_cvt_pk_bf16_f32 v197, 0, v197
  v_and_b32 v149, s65, v120
  v_cvt_pk_bf16_f32 v198, 0, v198
  v_lshlrev_b32 v150, 16, v121
  v_cvt_pk_bf16_f32 v199, 0, v199
  v_and_b32 v151, s65, v121
  v_pk_mul_f32 v[196:197], v[196:197], v[116:117] op_sel:[0,1]
  v_lshlrev_b32 v152, 16, v122
  v_pk_mul_f32 v[198:199], v[198:199], v[116:117] op_sel:[0,1]
  s_waitcnt vmcnt(14)
  buffer_load_dwordx4 v[72:75], v93, s[12:15], s60 offen offset:3584 nt
  v_cvt_f32_i32 v200, v12
  v_cvt_f32_i32 v201, v13
  v_cvt_f32_i32 v202, v14
  v_cvt_f32_i32 v203, v15
  v_pk_add_f32 v[200:201], v[200:201], v[116:117] op_sel_hi:[1,0] neg_lo:[0,1] neg_hi:[0,1]
  v_pk_add_f32 v[202:203], v[202:203], v[116:117] op_sel_hi:[1,0] neg_lo:[0,1] neg_hi:[0,1]
  v_cvt_pk_bf16_f32 v200, 0, v200
  v_and_b32 v153, s65, v122
  v_cvt_pk_bf16_f32 v201, 0, v201
  v_lshlrev_b32 v154, 16, v123
  v_cvt_pk_bf16_f32 v202, 0, v202
  v_and_b32 v155, s65, v123
  v_cvt_pk_bf16_f32 v203, 0, v203
  v_lshlrev_b32 v156, 16, v124
  v_pk_mul_f32 v[200:201], v[200:201], v[116:117] op_sel:[0,1]
  v_and_b32 v157, s65, v124
  v_pk_mul_f32 v[202:203], v[202:203], v[116:117] op_sel:[0,1]
  s_waitcnt vmcnt(14)
  s_cbranch_vccnz L_vw0_3
  s_waitcnt vmcnt(9)
L_vw0_3:
  buffer_load_dwordx4 v[76:79], v94, s[12:15], s60 offen offset:0 nt
  v_cvt_f32_i32 v108, v16
  v_cvt_f32_i32 v109, v17
  v_mov_b32_dpp v116, v114 row_newbcast:1 row_mask:0xf bank_mask:0xf
  v_mov_b32_dpp v117, v115 row_newbcast:1 row_mask:0xf bank_mask:0xf
  v_cvt_f32_i32 v110, v18
  v_cvt_f32_i32 v111, v19
  v_pk_add_f32 v[108:109], v[108:109], v[116:117] op_sel_hi:[1,0] neg_lo:[0,1] neg_hi:[0,1]
  v_pk_add_f32 v[110:111], v[110:111], v[116:117] op_sel_hi:[1,0] neg_lo:[0,1] neg_hi:[0,1]
  s_lshl_b32 s62, s84, 9
  v_lshl_add_u32 v98, v97, 1, v96
  buffer_load_short_d16_hi v112, v98, s[32:35], s62 offen
  buffer_load_short_d16_hi v113, v98, s[28:31], s62 offen
  v_cvt_pk_bf16_f32 v108, 0, v108
  v_lshlrev_b32 v158, 16, v125
  v_cvt_pk_bf16_f32 v109, 0, v109
  v_add_u32 v99, 768, v99
  v_cvt_pk_bf16_f32 v110, 0, v110
  v_add_u32 v100, 768, v100
  v_cvt_pk_bf16_f32 v111, 0, v111
  v_max3_f32 v144, v148, v149, v150
  v_pk_mul_f32 v[108:109], v[108:109], v[116:117] op_sel:[0,1]
  ds_read_b128 v[120:123], v99
  v_pk_mul_f32 v[110:111], v[110:111], v[116:117] op_sel:[0,1]
  v_cvt_pk_bf16_f32 v204, v192, v108
  v_cvt_pk_bf16_f32 v208, v193, v109
  v_cvt_pk_bf16_f32 v212, v194, v110
  v_cvt_pk_bf16_f32 v216, v195, v111
  s_waitcnt vmcnt(16)
  buffer_load_dwordx4 v[80:83], v94, s[12:15], s60 offen offset:256 nt
  v_cvt_f32_i32 v108, v20
  v_cvt_f32_i32 v109, v21
  v_cvt_f32_i32 v110, v22
  v_cvt_f32_i32 v111, v23
  v_pk_add_f32 v[108:109], v[108:109], v[116:117] op_sel_hi:[1,0] neg_lo:[0,1] neg_hi:[0,1]
  v_pk_add_f32 v[110:111], v[110:111], v[116:117] op_sel_hi:[1,0] neg_lo:[0,1] neg_hi:[0,1]
  v_cvt_pk_bf16_f32 v108, 0, v108
  ds_read_b64 v[124:125], v100 offset:256
  v_cvt_pk_bf16_f32 v109, 0, v109
  v_max3_f32 v145, v151, v152, v153
  v_cvt_pk_bf16_f32 v110, 0, v110
  v_max3_f32 v144, v144, v154, v155
  v_cvt_pk_bf16_f32 v111, 0, v111
  v_max3_f32 v145, v145, v156, v157
  v_pk_mul_f32 v[108:109], v[108:109], v[116:117] op_sel:[0,1]
  v_max3_f32 v144, v144, v158, v140
  v_pk_mul_f32 v[110:111], v[110:111], v[116:117] op_sel:[0,1]
  v_cvt_pk_bf16_f32 v220, v196, v108
  v_cvt_pk_bf16_f32 v224, v197, v109
  v_cvt_pk_bf16_f32 v228, v198, v110
  v_cvt_pk_bf16_f32 v232, v199, v111
  s_waitcnt vmcnt(16)
  buffer_load_dwordx4 v[84:87], v94, s[12:15], s60 offen offset:512 nt
  v_cvt_f32_i32 v108, v24
  v_cvt_f32_i32 v109, v25
  v_cvt_f32_i32 v110, v26
  v_cvt_f32_i32 v111, v27
  v_pk_add_f32 v[108:109], v[108:109], v[116:117] op_sel_hi:[1,0] neg_lo:[0,1] neg_hi:[0,1]
  v_pk_add_f32 v[110:111], v[110:111], v[116:117] op_sel_hi:[1,0] neg_lo:[0,1] neg_hi:[0,1]
  v_cvt_pk_bf16_f32 v108, 0, v108
  v_max_f32 v144, v144, v145
  v_cvt_pk_bf16_f32 v109, 0, v109
  v_mov_b32 v145, v144
  v_cvt_pk_bf16_f32 v110, 0, v110
  s_nop 0
  v_permlane32_swap_b32 v144, v145
  v_cvt_pk_bf16_f32 v111, 0, v111
  v_max_f32 v144, v144, v145
  v_pk_mul_f32 v[108:109], v[108:109], v[116:117] op_sel:[0,1]
  v_mov_b32 v145, v144
  v_pk_mul_f32 v[110:111], v[110:111], v[116:117] op_sel:[0,1]
  v_cvt_pk_bf16_f32 v236, v200, v108
  v_cvt_pk_bf16_f32 v240, v201, v109
  v_cvt_pk_bf16_f32 v244, v202, v110
  v_cvt_pk_bf16_f32 v248, v203, v111
  s_waitcnt vmcnt(16)
  s_cbranch_vccnz L_vw0_6
  s_waitcnt vmcnt(11)
L_vw0_6:
  buffer_load_dwordx4 v[88:91], v94, s[12:15], s60 offen offset:768 nt
  v_cvt_f32_i32 v192, v28
  v_cvt_f32_i32 v193, v29
  v_mov_b32_dpp v116, v114 row_newbcast:2 row_mask:0xf bank_mask:0xf
  v_mov_b32_dpp v117, v115 row_newbcast:2 row_mask:0xf bank_mask:0xf
  v_cvt_f32_i32 v194, v30
  v_cvt_f32_i32 v195, v31
  v_pk_add_f32 v[192:193], v[192:193], v[116:117] op_sel_hi:[1,0] neg_lo:[0,1] neg_hi:[0,1]
  v_pk_add_f32 v[194:195], v[194:195], v[116:117] op_sel_hi:[1,0] neg_lo:[0,1] neg_hi:[0,1]
  v_cvt_pk_bf16_f32 v192, 0, v192
  v_permlane16_swap_b32 v144, v145
  v_cvt_pk_bf16_f32 v193, 0, v193
  v_max_f32 v140, v144, v145
  v_cvt_pk_bf16_f32 v194, 0, v194
  v_mul_f32 v144, s66, v140
  v_cvt_pk_bf16_f32 v195, 0, v195
  v_add_f32 v146, v144, v142
  v_pk_mul_f32 v[192:193], v[192:193], v[116:117] op_sel:[0,1]
  v_sub_f32 v142, 0, v144
  v_pk_mul_f32 v[194:195], v[194:195], v[116:117] op_sel:[0,1]
  s_waitcnt vmcnt(16)
  buffer_load_dwordx4 v[4:7], v94, s[12:15], s60 offen offset:1024 nt
  v_cvt_f32_i32 v196, v32
  v_cvt_f32_i32 v197, v33
  v_cvt_f32_i32 v198, v34
  v_cvt_f32_i32 v199, v35
  v_pk_add_f32 v[196:197], v[196:197], v[116:117] op_sel_hi:[1,0] neg_lo:[0,1] neg_hi:[0,1]
  v_pk_add_f32 v[198:199], v[198:199], v[116:117] op_sel_hi:[1,0] neg_lo:[0,1] neg_hi:[0,1]
  v_cvt_pk_bf16_f32 v196, 0, v196
  v_exp_f32 v146, -v146
  v_cvt_pk_bf16_f32 v197, 0, v197
  ds_bpermute_b32 v147, v101, v146
  v_cvt_pk_bf16_f32 v198, 0, v198
  v_fma_f32 v148, v148, s66, v142
  v_cvt_pk_bf16_f32 v199, 0, v199
  v_exp_f32 v148, v148
  v_pk_mul_f32 v[196:197], v[196:197], v[116:117] op_sel:[0,1]
  v_fma_f32 v149, v149, s66, v142
  v_pk_mul_f32 v[198:199], v[198:199], v[116:117] op_sel:[0,1]
  s_waitcnt vmcnt(16)
  buffer_load_dwordx4 v[8:11], v94, s[12:15], s60 offen offset:1280 nt
  v_cvt_f32_i32 v200, v36
  v_cvt_f32_i32 v201, v37
  v_cvt_f32_i32 v202, v38
  v_cvt_f32_i32 v203, v39
  v_pk_add_f32 v[200:201], v[200:201], v[116:117] op_sel_hi:[1,0] neg_lo:[0,1] neg_hi:[0,1]
  v_pk_add_f32 v[202:203], v[202:203], v[116:117] op_sel_hi:[1,0] neg_lo:[0,1] neg_hi:[0,1]
  v_cvt_pk_bf16_f32 v200, 0, v200
  v_exp_f32 v149, v149
  v_cvt_pk_bf16_f32 v201, 0, v201
  v_fma_f32 v150, v150, s66, v142
  v_cvt_pk_bf16_f32 v202, 0, v202
  v_exp_f32 v150, v150
  v_cvt_pk_bf16_f32 v203, 0, v203
  v_fma_f32 v151, v151, s66, v142
  v_pk_mul_f32 v[200:201], v[200:201], v[116:117] op_sel:[0,1]
  v_exp_f32 v151, v151
  v_pk_mul_f32 v[202:203], v[202:203], v[116:117] op_sel:[0,1]
  s_waitcnt vmcnt(16)
  s_cbranch_vccnz L_vw0_9
  s_waitcnt vmcnt(11)
L_vw0_9:
  buffer_load_dwordx4 v[12:15], v94, s[12:15], s60 offen offset:1536 nt
  v_cvt_f32_i32 v108, v40
  v_cvt_f32_i32 v109, v41
  v_mov_b32_dpp v116, v114 row_newbcast:3 row_mask:0xf bank_mask:0xf
  v_mov_b32_dpp v117, v115 row_newbcast:3 row_mask:0xf bank_mask:0xf
  v_cvt_f32_i32 v110, v42
  v_cvt_f32_i32 v111, v43
  v_pk_add_f32 v[108:109], v[108:109], v[116:117] op_sel_hi:[1,0] neg_lo:[0,1] neg_hi:[0,1]
  v_pk_add_f32 v[110:111], v[110:111], v[116:117] op_sel_hi:[1,0] neg_lo:[0,1] neg_hi:[0,1]
  v_cvt_pk_bf16_f32 v108, 0, v108
  v_fma_f32 v152, v152, s66, v142
  v_cvt_pk_bf16_f32 v109, 0, v109
  v_exp_f32 v152, v152
  v_cvt_pk_bf16_f32 v110, 0, v110
  v_fma_f32 v153, v153, s66, v142
  v_cvt_pk_bf16_f32 v111, 0, v111
  v_exp_f32 v153, v153
  v_pk_mul_f32 v[108:109], v[108:109], v[116:117] op_sel:[0,1]
  v_fma_f32 v154, v154, s66, v142
  v_pk_mul_f32 v[110:111], v[110:111], v[116:117] op_sel:[0,1]
  v_cvt_pk_bf16_f32 v205, v192, v108
  v_cvt_pk_bf16_f32 v209, v193, v109
  v_cvt_pk_bf16_f32 v213, v194, v110
  v_cvt_pk_bf16_f32 v217, v195, v111
  s_waitcnt vmcnt(16)
  buffer_load_dwordx4 v[16:19], v94, s[12:15], s60 offen offset:1792 nt
  v_cvt_f32_i32 v108, v44
  v_cvt_f32_i32 v109, v45
  v_cvt_f32_i32 v110, v46
  v_cvt_f32_i32 v111, v47
  v_pk_add_f32 v[108:109], v[108:109], v[116:117] op_sel_hi:[1,0] neg_lo:[0,1] neg_hi:[0,1]
  v_pk_add_f32 v[110:111], v[110:111], v[116:117] op_sel_hi:[1,0] neg_lo:[0,1] neg_hi:[0,1]
  v_cvt_pk_bf16_f32 v108, 0, v108
  v_exp_f32 v154, v154
  v_cvt_pk_bf16_f32 v109, 0, v109
  v_fma_f32 v155, v155, s66, v142
  v_cvt_pk_bf16_f32 v110, 0, v110
  v_exp_f32 v155, v155
  v_cvt_pk_bf16_f32 v111, 0, v111
  v_fma_f32 v156, v156, s66, v142
  v_pk_mul_f32 v[108:109], v[108:109], v[116:117] op_sel:[0,1]
  v_exp_f32 v156, v156
  v_pk_mul_f32 v[110:111], v[110:111], v[116:117] op_sel:[0,1]
  v_cvt_pk_bf16_f32 v221, v196, v108
  v_cvt_pk_bf16_f32 v225, v197, v109
  v_cvt_pk_bf16_f32 v229, v198, v110
  v_cvt_pk_bf16_f32 v233, v199, v111
  s_waitcnt vmcnt(16)
  buffer_load_dwordx4 v[20:23], v94, s[12:15], s60 offen offset:2048 nt
  v_cvt_f32_i32 v108, v48
  v_cvt_f32_i32 v109, v49
  v_cvt_f32_i32 v110, v50
  v_cvt_f32_i32 v111, v51
  v_pk_add_f32 v[108:109], v[108:109], v[116:117] op_sel_hi:[1,0] neg_lo:[0,1] neg_hi:[0,1]
  v_pk_add_f32 v[110:111], v[110:111], v[116:117] op_sel_hi:[1,0] neg_lo:[0,1] neg_hi:[0,1]
  v_cvt_pk_bf16_f32 v108, 0, v108
  v_fma_f32 v157, v157, s66, v142
  v_cvt_pk_bf16_f32 v109, 0, v109
  v_exp_f32 v157, v157
  v_cvt_pk_bf16_f32 v110, 0, v110
  v_fma_f32 v158, v158, s66, v142
  v_cvt_pk_bf16_f32 v111, 0, v111
  v_exp_f32 v158, v158
  v_pk_mul_f32 v[108:109], v[108:109], v[116:117] op_sel:[0,1]
  v_add_f32 v144, v148, v149
  v_pk_mul_f32 v[110:111], v[110:111], v[116:117] op_sel:[0,1]
  v_cvt_pk_bf16_f32 v237, v200, v108
  v_cvt_pk_bf16_f32 v241, v201, v109
  v_cvt_pk_bf16_f32 v245, v202, v110
  v_cvt_pk_bf16_f32 v249, v203, v111
  s_waitcnt vmcnt(16)
  s_cbranch_vccnz L_vw0_12
  s_waitcnt vmcnt(11)
L_vw0_12:
  buffer_load_dwordx4 v[24:27], v94, s[12:15], s60 offen offset:2304 nt
  v_cvt_f32_i32 v192, v52
  v_cvt_f32_i32 v193, v53
  v_mov_b32_dpp v116, v114 row_newbcast:4 row_mask:0xf bank_mask:0xf
  v_mov_b32_dpp v117, v115 row_newbcast:4 row_mask:0xf bank_mask:0xf
  v_cvt_f32_i32 v194, v54
  v_cvt_f32_i32 v195, v55
  v_pk_add_f32 v[192:193], v[192:193], v[116:117] op_sel_hi:[1,0] neg_lo:[0,1] neg_hi:[0,1]
  v_pk_add_f32 v[194:195], v[194:195], v[116:117] op_sel_hi:[1,0] neg_lo:[0,1] neg_hi:[0,1]
  v_cvt_pk_bf16_f32 v192, 0, v192
  v_add_f32 v145, v150, v151
  v_cvt_pk_bf16_f32 v193, 0, v193
  v_add_f32 v144, v144, v152
  v_cvt_pk_bf16_f32 v194, 0, v194
  v_add_f32 v145, v145, v153
  v_cvt_pk_bf16_f32 v195, 0, v195
  v_add_f32 v144, v144, v154
  v_pk_mul_f32 v[192:193], v[192:193], v[116:117] op_sel:[0,1]
  v_add_f32 v145, v145, v155
  v_pk_mul_f32 v[194:195], v[194:195], v[116:117] op_sel:[0,1]
  s_waitcnt vmcnt(16)
  buffer_load_dwordx4 v[28:31], v94, s[12:15], s60 offen offset:2560 nt
  v_cvt_f32_i32 v196, v56
  v_cvt_f32_i32 v197, v57
  v_cvt_f32_i32 v198, v58
  v_cvt_f32_i32 v199, v59
  v_pk_add_f32 v[196:197], v[196:197], v[116:117] op_sel_hi:[1,0] neg_lo:[0,1] neg_hi:[0,1]
  v_pk_add_f32 v[198:199], v[198:199], v[116:117] op_sel_hi:[1,0] neg_lo:[0,1] neg_hi:[0,1]
  v_cvt_pk_bf16_f32 v196, 0, v196
  v_add_f32 v144, v144, v156
  v_cvt_pk_bf16_f32 v197, 0, v197
  v_add_f32 v145, v145, v157
  v_cvt_pk_bf16_f32 v198, 0, v198
  v_add_f32 v144, v144, v158
  v_cvt_pk_bf16_f32 v199, 0, v199
  v_add_f32 v144, v144, v145
  v_pk_mul_f32 v[196:197], v[196:197], v[116:117] op_sel:[0,1]
  v_fma_f32 v143, v143, v146, v144
  v_pk_mul_f32 v[198:199], v[198:199], v[116:117] op_sel:[0,1]
  s_waitcnt vmcnt(16)
  buffer_load_dwordx4 v[32:35], v94, s[12:15], s60 offen offset:2816 nt
  v_cvt_f32_i32 v200, v60
  v_cvt_f32_i32 v201, v61
  v_cvt_f32_i32 v202, v62
  v_cvt_f32_i32 v203, v63
  v_pk_add_f32 v[200:201], v[200:201], v[116:117] op_sel_hi:[1,0] neg_lo:[0,1] neg_hi:[0,1]
  v_pk_add_f32 v[202:203], v[202:203], v[116:117] op_sel_hi:[1,0] neg_lo:[0,1] neg_hi:[0,1]
  v_cvt_pk_bf16_f32 v200, 0, v200
  v_cvt_pk_bf16_f32 v159, v148, v149
  v_cvt_pk_bf16_f32 v201, 0, v201
  v_cvt_pk_bf16_f32 v160, v150, v151
  v_cvt_pk_bf16_f32 v202, 0, v202
  v_cvt_pk_bf16_f32 v161, v152, v153
  v_cvt_pk_bf16_f32 v203, 0, v203
  v_cvt_pk_bf16_f32 v162, v154, v155
  v_pk_mul_f32 v[200:201], v[200:201], v[116:117] op_sel:[0,1]
  v_cvt_pk_bf16_f32 v163, v156, v157
  v_pk_mul_f32 v[202:203], v[202:203], v[116:117] op_sel:[0,1]
  s_waitcnt vmcnt(16)
  s_cbranch_vccnz L_vw0_15
  s_waitcnt vmcnt(9)
L_vw0_15:
  buffer_load_dwordx4 v[36:39], v95, s[12:15], s60 offen offset:0 nt
  v_cvt_f32_i32 v108, v64
  v_cvt_f32_i32 v109, v65
  v_mov_b32_dpp v116, v114 row_newbcast:5 row_mask:0xf bank_mask:0xf
  v_mov_b32_dpp v117, v115 row_newbcast:5 row_mask:0xf bank_mask:0xf
  v_cvt_f32_i32 v110, v66
  v_cvt_f32_i32 v111, v67
  v_pk_add_f32 v[108:109], v[108:109], v[116:117] op_sel_hi:[1,0] neg_lo:[0,1] neg_hi:[0,1]
  v_pk_add_f32 v[110:111], v[110:111], v[116:117] op_sel_hi:[1,0] neg_lo:[0,1] neg_hi:[0,1]
  v_cvt_pk_bf16_f32 v108, 0, v108
  v_cvt_pk_bf16_f32 v164, v158, 0
  v_cvt_pk_bf16_f32 v109, 0, v109
  v_cndmask_b32 v168, 0, v159, s[72:73]
  v_cvt_pk_bf16_f32 v110, 0, v110
  v_cndmask_b32 v169, 0, v160, s[72:73]
  v_cvt_pk_bf16_f32 v111, 0, v111
  v_cndmask_b32 v170, 0, v161, s[72:73]
  v_pk_mul_f32 v[108:109], v[108:109], v[116:117] op_sel:[0,1]
  v_cndmask_b32 v171, 0, v162, s[72:73]
  v_pk_mul_f32 v[110:111], v[110:111], v[116:117] op_sel:[0,1]
  v_cvt_pk_bf16_f32 v206, v192, v108
  v_cvt_pk_bf16_f32 v210, v193, v109
  v_cvt_pk_bf16_f32 v214, v194, v110
  v_cvt_pk_bf16_f32 v218, v195, v111
  s_waitcnt vmcnt(16)
  buffer_load_dwordx4 v[40:43], v95, s[12:15], s60 offen offset:256 nt
  v_cvt_f32_i32 v108, v68
  v_cvt_f32_i32 v109, v69
  v_cvt_f32_i32 v110, v70
  v_cvt_f32_i32 v111, v71
  v_pk_add_f32 v[108:109], v[108:109], v[116:117] op_sel_hi:[1,0] neg_lo:[0,1] neg_hi:[0,1]
  v_pk_add_f32 v[110:111], v[110:111], v[116:117] op_sel_hi:[1,0] neg_lo:[0,1] neg_hi:[0,1]
  v_cvt_pk_bf16_f32 v108, 0, v108
  v_cndmask_b32 v172, 0, v159, s[74:75]
  v_cvt_pk_bf16_f32 v109, 0, v109
  v_cndmask_b32 v173, 0, v160, s[74:75]
  v_cvt_pk_bf16_f32 v110, 0, v110
  v_cndmask_b32 v174, 0, v161, s[74:75]
  v_cvt_pk_bf16_f32 v111, 0, v111
  v_cndmask_b32 v175, 0, v162, s[74:75]
  v_pk_mul_f32 v[108:109], v[108:109], v[116:117] op_sel:[0,1]
  v_cndmask_b32 v176, 0, v159, s[76:77]
  v_pk_mul_f32 v[110:111], v[110:111], v[116:117] op_sel:[0,1]
  v_cvt_pk_bf16_f32 v222, v196, v108
  v_cvt_pk_bf16_f32 v226, v197, v109
  v_cvt_pk_bf16_f32 v230, v198, v110
  v_cvt_pk_bf16_f32 v234, v199, v111
  s_waitcnt vmcnt(16)
  buffer_load_dwordx4 v[44:47], v95, s[12:15], s60 offen offset:512 nt
  v_cvt_f32_i32 v108, v72
  v_cvt_f32_i32 v109, v73
  v_cvt_f32_i32 v110, v74
  v_cvt_f32_i32 v111, v75
  v_pk_add_f32 v[108:109], v[108:109], v[116:117] op_sel_hi:[1,0] neg_lo:[0,1] neg_hi:[0,1]
  v_pk_add_f32 v[110:111], v[110:111], v[116:117] op_sel_hi:[1,0] neg_lo:[0,1] neg_hi:[0,1]
  v_cvt_pk_bf16_f32 v108, 0, v108
  v_cndmask_b32 v177, 0, v160, s[76:77]
  v_cvt_pk_bf16_f32 v109, 0, v109
  v_cndmask_b32 v178, 0, v161, s[76:77]
  v_cvt_pk_bf16_f32 v110, 0, v110
  v_cndmask_b32 v179, 0, v162, s[76:77]
  v_cvt_pk_bf16_f32 v111, 0, v111
  v_cndmask_b32 v180, 0, v159, s[78:79]
  v_pk_mul_f32 v[108:109], v[108:109], v[116:117] op_sel:[0,1]
  v_cndmask_b32 v181, 0, v160, s[78:79]
  v_pk_mul_f32 v[110:111], v[110:111], v[116:117] op_sel:[0,1]
  v_cvt_pk_bf16_f32 v238, v200, v108
  v_cvt_pk_bf16_f32 v242, v201, v109
  v_cvt_pk_bf16_f32 v246, v202, v110
  v_cvt_pk_bf16_f32 v250, v203, v111
  v_mad_u32_u24 v92, v97, s63, v3
  v_add_u32 v93, 768, v92
  v_add_u32 v94, 4608, v92
  v_add_u32 v95, 7680, v92
  v_cndmask_b32 v92, v92, v105, s[52:53]
  v_cndmask_b32 v95, v95, v105, s[54:55]
  s_waitcnt vmcnt(16)
  s_cbranch_vccnz L_vw0_18
  s_waitcnt vmcnt(9)
L_vw0_18:
  buffer_load_dwordx4 v[48:51], v92, s[12:15], s61 offen offset:0 nt
  v_cvt_f32_i32 v192, v76
  v_cvt_f32_i32 v193, v77
  v_mov_b32_dpp v116, v114 row_newbcast:6 row_mask:0xf bank_mask:0xf
  v_mov_b32_dpp v117, v115 row_newbcast:6 row_mask:0xf bank_mask:0xf
  v_cvt_f32_i32 v194, v78
  v_cvt_f32_i32 v195, v79
  v_pk_add_f32 v[192:193], v[192:193], v[116:117] op_sel_hi:[1,0] neg_lo:[0,1] neg_hi:[0,1]
  v_pk_add_f32 v[194:195], v[194:195], v[116:117] op_sel_hi:[1,0] neg_lo:[0,1] neg_hi:[0,1]
  v_cvt_pk_bf16_f32 v192, 0, v192
  v_cndmask_b32 v182, 0, v161, s[78:79]
  v_cvt_pk_bf16_f32 v193, 0, v193
  v_cndmask_b32 v183, 0, v162, s[78:79]
  v_cvt_pk_bf16_f32 v194, 0, v194
  s_waitcnt lgkmcnt(0)
  v_cvt_pk_bf16_f32 v195, 0, v195
  v_mul_f32 v128, v147, v128
  v_pk_mul_f32 v[192:193], v[192:193], v[116:117] op_sel:[0,1]
  v_mul_f32 v129, v147, v129
  v_pk_mul_f32 v[194:195], v[194:195], v[116:117] op_sel:[0,1]
  s_waitcnt vmcnt(14)
  buffer_load_dwordx4 v[52:55], v92, s[12:15], s61 offen offset:256 nt
  v_cvt_f32_i32 v196, v80
  v_cvt_f32_i32 v197, v81
  v_cvt_f32_i32 v198, v82
  v_cvt_f32_i32 v199, v83
  v_pk_add_f32 v[196:197], v[196:197], v[116:117] op_sel_hi:[1,0] neg_lo:[0,1] neg_hi:[0,1]
  v_pk_add_f32 v[198:199], v[198:199], v[116:117] op_sel_hi:[1,0] neg_lo:[0,1] neg_hi:[0,1]
  v_cvt_pk_bf16_f32 v196, 0, v196
  v_mul_f32 v130, v147, v130
  v_cvt_pk_bf16_f32 v197, 0, v197
  v_mul_f32 v131, v147, v131
  v_cvt_pk_bf16_f32 v198, 0, v198
  v_mul_f32 v132, v147, v132
  v_cvt_pk_bf16_f32 v199, 0, v199
  v_mul_f32 v133, v147, v133
  v_pk_mul_f32 v[196:197], v[196:197], v[116:117] op_sel:[0,1]
  v_mul_f32 v134, v147, v134
  v_pk_mul_f32 v[198:199], v[198:199], v[116:117] op_sel:[0,1]
  s_waitcnt vmcnt(14)
  buffer_load_dwordx4 v[56:59], v92, s[12:15], s61 offen offset:512 nt
  v_cvt_f32_i32 v200, v84
  v_cvt_f32_i32 v201, v85
  v_cvt_f32_i32 v202, v86
  v_cvt_f32_i32 v203, v87
  v_pk_add_f32 v[200:201], v[200:201], v[116:117] op_sel_hi:[1,0] neg_lo:[0,1] neg_hi:[0,1]
  v_pk_add_f32 v[202:203], v[202:203], v[116:117] op_sel_hi:[1,0] neg_lo:[0,1] neg_hi:[0,1]
  v_cvt_pk_bf16_f32 v200, 0, v200
  v_mul_f32 v135, v147, v135
  v_cvt_pk_bf16_f32 v201, 0, v201
  v_mul_f32 v136, v147, v136
  v_cvt_pk_bf16_f32 v202, 0, v202
  v_mul_f32 v137, v147, v137
  v_cvt_pk_bf16_f32 v203, 0, v203
  v_mul_f32 v138, v147, v138
  v_pk_mul_f32 v[200:201], v[200:201], v[116:117] op_sel:[0,1]
  v_mul_f32 v139, v147, v139
  v_pk_mul_f32 v[202:203], v[202:203], v[116:117] op_sel:[0,1]
  s_waitcnt vmcnt(14)
  s_cbranch_vccnz L_vw0_21
  s_waitcnt vmcnt(9)
L_vw0_21:
  buffer_load_dwordx4 v[60:63], v93, s[12:15], s61 offen offset:0 nt
  v_cvt_f32_i32 v108, v88
  v_cvt_f32_i32 v109, v89
  v_mov_b32_dpp v116, v114 row_newbcast:7 row_mask:0xf bank_mask:0xf
  v_mov_b32_dpp v117, v115 row_newbcast:7 row_mask:0xf bank_mask:0xf
  v_cvt_f32_i32 v110, v90
  v_cvt_f32_i32 v111, v91
  v_pk_add_f32 v[108:109], v[108:109], v[116:117] op_sel_hi:[1,0] neg_lo:[0,1] neg_hi:[0,1]
  v_pk_add_f32 v[110:111], v[110:111], v[116:117] op_sel_hi:[1,0] neg_lo:[0,1] neg_hi:[0,1]
  v_cvt_pk_bf16_f32 v108, 0, v108
  v_cvt_pk_bf16_f32 v109, 0, v109
  v_cvt_pk_bf16_f32 v110, 0, v110
  v_cvt_pk_bf16_f32 v111, 0, v111
  v_pk_mul_f32 v[108:109], v[108:109], v[116:117] op_sel:[0,1]
  v_pk_mul_f32 v[110:111], v[110:111], v[116:117] op_sel:[0,1]
  v_cvt_pk_bf16_f32 v207, v192, v108
  v_cvt_pk_bf16_f32 v211, v193, v109
  v_cvt_pk_bf16_f32 v215, v194, v110
  v_cvt_pk_bf16_f32 v219, v195, v111
  v_mfma_f32_16x16x32_bf16 v[128:131], v[168:171], v[204:207], v[128:131]
  v_mfma_f32_16x16x32_bf16 v[128:131], v[172:175], v[208:211], v[128:131]
  v_mfma_f32_16x16x32_bf16 v[128:131], v[176:179], v[212:215], v[128:131]
  v_mfma_f32_16x16x32_bf16 v[128:131], v[180:183], v[216:219], v[128:131]
  s_waitcnt vmcnt(14)
  buffer_load_dwordx4 v[64:67], v93, s[12:15], s61 offen offset:256 nt
  v_cvt_f32_i32 v108, v4
  v_cvt_f32_i32 v109, v5
  v_cvt_f32_i32 v110, v6
  v_cvt_f32_i32 v111, v7
  v_pk_add_f32 v[108:109], v[108:109], v[116:117] op_sel_hi:[1,0] neg_lo:[0,1] neg_hi:[0,1]
  v_pk_add_f32 v[110:111], v[110:111], v[116:117] op_sel_hi:[1,0] neg_lo:[0,1] neg_hi:[0,1]
  v_cvt_pk_bf16_f32 v108, 0, v108
  v_cvt_pk_bf16_f32 v109, 0, v109
  v_cvt_pk_bf16_f32 v110, 0, v110
  v_cvt_pk_bf16_f32 v111, 0, v111
  v_pk_mul_f32 v[108:109], v[108:109], v[116:117] op_sel:[0,1]
  v_pk_mul_f32 v[110:111], v[110:111], v[116:117] op_sel:[0,1]
  v_cvt_pk_bf16_f32 v223, v196, v108
  v_cvt_pk_bf16_f32 v227, v197, v109
  v_cvt_pk_bf16_f32 v231, v198, v110
  v_cvt_pk_bf16_f32 v235, v199, v111
  v_mfma_f32_16x16x32_bf16 v[132:135], v[168:171], v[220:223], v[132:135]
  v_mfma_f32_16x16x32_bf16 v[132:135], v[172:175], v[224:227], v[132:135]
  v_mfma_f32_16x16x32_bf16 v[132:135], v[176:179], v[228:231], v[132:135]
  v_mfma_f32_16x16x32_bf16 v[132:135], v[180:183], v[232:235], v[132:135]
  s_waitcnt vmcnt(14)
  buffer_load_dwordx4 v[68:71], v93, s[12:15], s61 offen offset:512 nt
  v_cvt_f32_i32 v108, v8
  v_cvt_f32_i32 v109, v9
  v_cvt_f32_i32 v110, v10
  v_cvt_f32_i32 v111, v11
  v_pk_add_f32 v[108:109], v[108:109], v[116:117] op_sel_hi:[1,0] neg_lo:[0,1] neg_hi:[0,1]
  v_pk_add_f32 v[110:111], v[110:111], v[116:117] op_sel_hi:[1,0] neg_lo:[0,1] neg_hi:[0,1]
  v_cvt_pk_bf16_f32 v108, 0, v108
  v_cvt_pk_bf16_f32 v109, 0, v109
  v_cvt_pk_bf16_f32 v110, 0, v110
  v_cvt_pk_bf16_f32 v111, 0, v111
  v_pk_mul_f32 v[108:109], v[108:109], v[116:117] op_sel:[0,1]
  v_pk_mul_f32 v[110:111], v[110:111], v[116:117] op_sel:[0,1]
  v_cvt_pk_bf16_f32 v239, v200, v108
  v_cvt_pk_bf16_f32 v243, v201, v109
  v_cvt_pk_bf16_f32 v247, v202, v110
  v_cvt_pk_bf16_f32 v251, v203, v111
  v_mfma_f32_16x16x32_bf16 v[136:139], v[168:171], v[236:239], v[136:139]
  v_mfma_f32_16x16x32_bf16 v[136:139], v[172:175], v[240:243], v[136:139]
  v_mfma_f32_16x16x32_bf16 v[136:139], v[176:179], v[244:247], v[136:139]
  v_mfma_f32_16x16x32_bf16 v[136:139], v[180:183], v[248:251], v[136:139]
  s_waitcnt vmcnt(14)
  s_cbranch_vccnz L_vw0_24
  s_waitcnt vmcnt(9)
L_vw0_24:
  buffer_load_dwordx4 v[72:75], v93, s[12:15], s61 offen offset:768 nt
  v_cvt_f32_i32 v192, v12
  v_cvt_f32_i32 v193, v13
  v_mov_b32_dpp v116, v114 row_newbcast:8 row_mask:0xf bank_mask:0xf
  v_mov_b32_dpp v117, v115 row_newbcast:8 row_mask:0xf bank_mask:0xf
  v_cvt_f32_i32 v194, v14
  v_cvt_f32_i32 v195, v15
  v_pk_add_f32 v[192:193], v[192:193], v[116:117] op_sel_hi:[1,0] neg_lo:[0,1] neg_hi:[0,1]
  v_pk_add_f32 v[194:195], v[194:195], v[116:117] op_sel_hi:[1,0] neg_lo:[0,1] neg_hi:[0,1]
  v_cvt_pk_bf16_f32 v192, 0, v192
  v_cndmask_b32 v184, 0, v163, s[72:73]
  v_cvt_pk_bf16_f32 v193, 0, v193
  v_cndmask_b32 v185, 0, v164, s[72:73]
  v_cvt_pk_bf16_f32 v194, 0, v194
  v_cndmask_b32 v186, 0, v163, s[74:75]
  v_cvt_pk_bf16_f32 v195, 0, v195
  v_cndmask_b32 v187, 0, v164, s[74:75]
  v_pk_mul_f32 v[192:193], v[192:193], v[116:117] op_sel:[0,1]
  v_cndmask_b32 v188, 0, v163, s[76:77]
  v_pk_mul_f32 v[194:195], v[194:195], v[116:117] op_sel:[0,1]
  s_waitcnt vmcnt(14)
  buffer_load_dwordx4 v[76:79], v93, s[12:15], s61 offen offset:1024 nt
  v_cvt_f32_i32 v196, v16
  v_cvt_f32_i32 v197, v17
  v_cvt_f32_i32 v198, v18
  v_cvt_f32_i32 v199, v19
  v_pk_add_f32 v[196:197], v[196:197], v[116:117] op_sel_hi:[1,0] neg_lo:[0,1] neg_hi:[0,1]
  v_pk_add_f32 v[198:199], v[198:199], v[116:117] op_sel_hi:[1,0] neg_lo:[0,1] neg_hi:[0,1]
  v_cvt_pk_bf16_f32 v196, 0, v196
  v_cndmask_b32 v189, 0, v164, s[76:77]
  v_cvt_pk_bf16_f32 v197, 0, v197
  v_cndmask_b32 v190, 0, v163, s[78:79]
  v_cvt_pk_bf16_f32 v198, 0, v198
  v_cndmask_b32 v191, 0, v164, s[78:79]
  v_cvt_pk_bf16_f32 v199, 0, v199
  v_pk_mul_f32 v[196:197], v[196:197], v[116:117] op_sel:[0,1]
  v_pk_mul_f32 v[198:199], v[198:199], v[116:117] op_sel:[0,1]
  s_waitcnt vmcnt(14)
  buffer_load_dwordx4 v[80:83], v93, s[12:15], s61 offen offset:1280 nt
  v_cvt_f32_i32 v200, v20
  v_cvt_f32_i32 v201, v21
  v_cvt_f32_i32 v202, v22
  v_cvt_f32_i32 v203, v23
  v_pk_add_f32 v[200:201], v[200:201], v[116:117] op_sel_hi:[1,0] neg_lo:[0,1] neg_hi:[0,1]
  v_pk_add_f32 v[202:203], v[202:203], v[116:117] op_sel_hi:[1,0] neg_lo:[0,1] neg_hi:[0,1]
  v_cvt_pk_bf16_f32 v200, 0, v200
  v_cvt_pk_bf16_f32 v201, 0, v201
  v_cvt_pk_bf16_f32 v202, 0, v202
  v_cvt_pk_bf16_f32 v203, 0, v203
  v_pk_mul_f32 v[200:201], v[200:201], v[116:117] op_sel:[0,1]
  v_pk_mul_f32 v[202:203], v[202:203], v[116:117] op_sel:[0,1]
  s_waitcnt vmcnt(14)
  s_cbranch_vccnz L_vw0_27
  s_waitcnt vmcnt(9)
L_vw0_27:
  buffer_load_dwordx4 v[84:87], v93, s[12:15], s61 offen offset:1536 nt
  v_cvt_f32_i32 v108, v24
  v_cvt_f32_i32 v109, v25
  v_mov_b32_dpp v116, v114 row_newbcast:9 row_mask:0xf bank_mask:0xf
  v_mov_b32_dpp v117, v115 row_newbcast:9 row_mask:0xf bank_mask:0xf
  v_cvt_f32_i32 v110, v26
  v_cvt_f32_i32 v111, v27
  v_pk_add_f32 v[108:109], v[108:109], v[116:117] op_sel_hi:[1,0] neg_lo:[0,1] neg_hi:[0,1]
  v_pk_add_f32 v[110:111], v[110:111], v[116:117] op_sel_hi:[1,0] neg_lo:[0,1] neg_hi:[0,1]
  v_cvt_pk_bf16_f32 v108, 0, v108
  v_cvt_pk_bf16_f32 v109, 0, v109
  v_cvt_pk_bf16_f32 v110, 0, v110
  v_cvt_pk_bf16_f32 v111, 0, v111
  v_pk_mul_f32 v[108:109], v[108:109], v[116:117] op_sel:[0,1]
  v_pk_mul_f32 v[110:111], v[110:111], v[116:117] op_sel:[0,1]
  v_cvt_pk_bf16_f32 v204, v192, v108
  v_cvt_pk_bf16_f32 v208, v193, v109
  v_cvt_pk_bf16_f32 v212, v194, v110
  v_cvt_pk_bf16_f32 v216, v195, v111
  s_waitcnt vmcnt(14)
  buffer_load_dwordx4 v[88:91], v93, s[12:15], s61 offen offset:1792 nt
  v_cvt_f32_i32 v108, v28
  v_cvt_f32_i32 v109, v29
  v_cvt_f32_i32 v110, v30
  v_cvt_f32_i32 v111, v31
  v_pk_add_f32 v[108:109], v[108:109], v[116:117] op_sel_hi:[1,0] neg_lo:[0,1] neg_hi:[0,1]
  v_pk_add_f32 v[110:111], v[110:111], v[116:117] op_sel_hi:[1,0] neg_lo:[0,1] neg_hi:[0,1]
  v_cvt_pk_bf16_f32 v108, 0, v108
  v_cvt_pk_bf16_f32 v109, 0, v109
  v_cvt_pk_bf16_f32 v110, 0, v110
  v_cvt_pk_bf16_f32 v111, 0, v111
  v_pk_mul_f32 v[108:109], v[108:109], v[116:117] op_sel:[0,1]
  v_pk_mul_f32 v[110:111], v[110:111], v[116:117] op_sel:[0,1]
  v_cvt_pk_bf16_f32 v220, v196, v108
  v_cvt_pk_bf16_f32 v224, v197, v109
  v_cvt_pk_bf16_f32 v228, v198, v110
  v_cvt_pk_bf16_f32 v232, v199, v111
  s_waitcnt vmcnt(14)
  buffer_load_dwordx4 v[4:7], v93, s[12:15], s61 offen offset:2048 nt
  v_cvt_f32_i32 v108, v32
  v_cvt_f32_i32 v109, v33
  v_cvt_f32_i32 v110, v34
  v_cvt_f32_i32 v111, v35
  v_pk_add_f32 v[108:109], v[108:109], v[116:117] op_sel_hi:[1,0] neg_lo:[0,1] neg_hi:[0,1]
  v_pk_add_f32 v[110:111], v[110:111], v[116:117] op_sel_hi:[1,0] neg_lo:[0,1] neg_hi:[0,1]
  v_cvt_pk_bf16_f32 v108, 0, v108
  v_cvt_pk_bf16_f32 v109, 0, v109
  v_cvt_pk_bf16_f32 v110, 0, v110
  v_cvt_pk_bf16_f32 v111, 0, v111
  v_pk_mul_f32 v[108:109], v[108:109], v[116:117] op_sel:[0,1]
  v_pk_mul_f32 v[110:111], v[110:111], v[116:117] op_sel:[0,1]
  v_cvt_pk_bf16_f32 v236, v200, v108
  v_cvt_pk_bf16_f32 v240, v201, v109
  v_cvt_pk_bf16_f32 v244, v202, v110
  v_cvt_pk_bf16_f32 v248, v203, v111
  s_waitcnt vmcnt(14)
  s_cbranch_vccnz L_vw0_30
  s_waitcnt vmcnt(9)
L_vw0_30:
  buffer_load_dwordx4 v[8:11], v93, s[12:15], s61 offen offset:2304 nt
  v_cvt_f32_i32 v192, v36
  v_cvt_f32_i32 v193, v37
  v_mov_b32_dpp v116, v114 row_newbcast:10 row_mask:0xf bank_mask:0xf
  v_mov_b32_dpp v117, v115 row_newbcast:10 row_mask:0xf bank_mask:0xf
  v_cvt_f32_i32 v194, v38
  v_cvt_f32_i32 v195, v39
  v_pk_add_f32 v[192:193], v[192:193], v[116:117] op_sel_hi:[1,0] neg_lo:[0,1] neg_hi:[0,1]
  v_pk_add_f32 v[194:195], v[194:195], v[116:117] op_sel_hi:[1,0] neg_lo:[0,1] neg_hi:[0,1]
  v_cvt_pk_bf16_f32 v192, 0, v192
  v_cvt_pk_bf16_f32 v193, 0, v193
  v_cvt_pk_bf16_f32 v194, 0, v194
  v_cvt_pk_bf16_f32 v195, 0, v195
  v_pk_mul_f32 v[192:193], v[192:193], v[116:117] op_sel:[0,1]
  v_pk_mul_f32 v[194:195], v[194:195], v[116:117] op_sel:[0,1]
  v_cvt_pk_bf16_f32 v205, v192, 0
  v_cvt_pk_bf16_f32 v209, v193, 0
  v_cvt_pk_bf16_f32 v213, v194, 0
  v_cvt_pk_bf16_f32 v217, v195, 0
  v_mfma_f32_16x16x16_bf16 v[128:131], v[184:185], v[204:205], v[128:131]
  v_mfma_f32_16x16x16_bf16 v[128:131], v[186:187], v[208:209], v[128:131]
  v_mfma_f32_16x16x16_bf16 v[128:131], v[188:189], v[212:213], v[128:131]
  v_mfma_f32_16x16x16_bf16 v[128:131], v[190:191], v[216:217], v[128:131]
  s_waitcnt vmcnt(14)
  buffer_load_dwordx4 v[12:15], v93, s[12:15], s61 offen offset:2560 nt
  v_cvt_f32_i32 v196, v40
  v_cvt_f32_i32 v197, v41
  v_cvt_f32_i32 v198, v42
  v_cvt_f32_i32 v199, v43
  v_pk_add_f32 v[196:197], v[196:197], v[116:117] op_sel_hi:[1,0] neg_lo:[0,1] neg_hi:[0,1]
  v_pk_add_f32 v[198:199], v[198:199], v[116:117] op_sel_hi:[1,0] neg_lo:[0,1] neg_hi:[0,1]
  v_cvt_pk_bf16_f32 v196, 0, v196
  v_cvt_pk_bf16_f32 v197, 0, v197
  v_cvt_pk_bf16_f32 v198, 0, v198
  v_cvt_pk_bf16_f32 v199, 0, v199
  v_pk_mul_f32 v[196:197], v[196:197], v[116:117] op_sel:[0,1]
  v_pk_mul_f32 v[198:199], v[198:199], v[116:117] op_sel:[0,1]
  v_cvt_pk_bf16_f32 v221, v196, 0
  v_cvt_pk_bf16_f32 v225, v197, 0
  v_cvt_pk_bf16_f32 v229, v198, 0
  v_cvt_pk_bf16_f32 v233, v199, 0
  v_mfma_f32_16x16x16_bf16 v[132:135], v[184:185], v[220:221], v[132:135]
  v_mfma_f32_16x16x16_bf16 v[132:135], v[186:187], v[224:225], v[132:135]
  v_mfma_f32_16x16x16_bf16 v[132:135], v[188:189], v[228:229], v[132:135]
  v_mfma_f32_16x16x16_bf16 v[132:135], v[190:191], v[232:233], v[132:135]
  s_waitcnt vmcnt(14)
  buffer_load_dwordx4 v[16:19], v93, s[12:15], s61 offen offset:2816 nt
  v_cvt_f32_i32 v200, v44
  v_cvt_f32_i32 v201, v45
  v_cvt_f32_i32 v202, v46
  v_cvt_f32_i32 v203, v47
  v_pk_add_f32 v[200:201], v[200:201], v[116:117] op_sel_hi:[1,0] neg_lo:[0,1] neg_hi:[0,1]
  v_pk_add_f32 v[202:203], v[202:203], v[116:117] op_sel_hi:[1,0] neg_lo:[0,1] neg_hi:[0,1]
  v_cvt_pk_bf16_f32 v200, 0, v200
  v_cvt_pk_bf16_f32 v201, 0, v201
  v_cvt_pk_bf16_f32 v202, 0, v202
  v_cvt_pk_bf16_f32 v203, 0, v203
  v_pk_mul_f32 v[200:201], v[200:201], v[116:117] op_sel:[0,1]
  v_pk_mul_f32 v[202:203], v[202:203], v[116:117] op_sel:[0,1]
  v_cvt_pk_bf16_f32 v237, v200, 0
  v_cvt_pk_bf16_f32 v241, v201, 0
  v_cvt_pk_bf16_f32 v245, v202, 0
  v_cvt_pk_bf16_f32 v249, v203, 0
  v_mfma_f32_16x16x16_bf16 v[136:139], v[184:185], v[236:237], v[136:139]
  v_mfma_f32_16x16x16_bf16 v[136:139], v[186:187], v[240:241], v[136:139]
  v_mfma_f32_16x16x16_bf16 v[136:139], v[188:189], v[244:245], v[136:139]
  v_mfma_f32_16x16x16_bf16 v[136:139], v[190:191], v[248:249], v[136:139]
  s_mov_b32 s60, s61
L_v1:
  s_add_u32 s97, s64, 96
  v_mov_b32 v146, s97
  s_mov_b32 s86, s84
  ds_write_b32 v104, v146
  s_add_u32 s64, s64, 2
  s_cmp_lt_u32 s64, s99
  s_cbranch_scc1 L_v11_ok
L_v11_spin:
  v_mov_b32 v144, 61700
  ds_read_b32 v144, v144
  s_waitcnt lgkmcnt(0)
  v_readfirstlane_b32 s99, v144
  s_nop 1
  s_cmp_lt_u32 s64, s99
  s_cbranch_scc0 L_v11_spin
L_v11_ok:
  s_lshr_b32 s71, s64, 5
  s_lshr_b32 s85, s96, s71
  s_bfe_u32 s85, s85, 0x10003
  s_and_b32 s70, s64, 31
  s_lshl_b32 s71, s71, 12
  s_add_u32 s70, s70, s5
  s_add_u32 s70, s70, s71
  s_mul_hi_u32 s84, s70, s90
  s_lshr_b32 s84, s84, 1
  s_mul_i32 s71, s84, 3
  s_sub_u32 s70, s70, s71
  s_lshl3_add_u32 s85, s70, s85
  s_mul_i32 s61, s84, 196608
  s_lshr_b32 s89, s84, 4
  s_lshl_b32 s70, s85, 5
  v_add_u32 v97, s70, v1
  v_mul_u32_u24 v97, 21846, v97
  v_lshrrev_b32 v97, 16, v97
  v_add_u32 v144, s85, v2
  v_lshrrev_b32 v145, v144, s91
  v_and_b32 v145, 1, v145
  v_cmp_eq_u32 s[54:55], 1, v145
  s_nop 1
  s_and_b64 s[52:53], s[54:55], s[58:59]
  s_andn2_b64 s[54:55], s[54:55], s[58:59]
  s_cmp_lt_u32 s64, 96
  s_cselect_b32 s61, s61, 805306368
  s_lshr_b32 s70, s64, 1
  s_cmp_eq_u32 s70, 32
  s_cselect_b32 s48, -36096, s63
  ds_read_b32 v106, v104 offset:8
  s_waitcnt vmcnt(14)
  s_cbranch_vccnz L_vw1_0
  s_waitcnt vmcnt(9)
L_vw1_0:
  buffer_load_dwordx4 v[20:23], v93, s[12:15], s60 offen offset:3072 nt
  v_mov_b32 v114, v112
  v_mov_b32 v115, v113
  v_cvt_f32_i32 v192, v48
  v_cvt_f32_i32 v193, v49
  v_mov_b32_dpp v116, v114 row_newbcast:0 row_mask:0xf bank_mask:0xf
  v_mov_b32_dpp v117, v115 row_newbcast:0 row_mask:0xf bank_mask:0xf
  v_cvt_f32_i32 v194, v50
  v_cvt_f32_i32 v195, v51
  v_pk_add_f32 v[192:193], v[192:193], v[116:117] op_sel_hi:[1,0] neg_lo:[0,1] neg_hi:[0,1]
  v_pk_add_f32 v[194:195], v[194:195], v[116:117] op_sel_hi:[1,0] neg_lo:[0,1] neg_hi:[0,1]
  v_cvt_pk_bf16_f32 v192, 0, v192
  v_cvt_pk_bf16_f32 v193, 0, v193
  v_cvt_pk_bf16_f32 v194, 0, v194
  v_cvt_pk_bf16_f32 v195, 0, v195
  v_pk_mul_f32 v[192:193], v[192:193], v[116:117] op_sel:[0,1]
  v_pk_mul_f32 v[194:195], v[194:195], v[116:117] op_sel:[0,1]
  s_waitcnt lgkmcnt(0)
  v_cmp_lt_u32 vcc, s97, v106
  s_waitcnt vmcnt(14)
  buffer_load_dwordx4 v[24:27], v93, s[12:15], s60 offen offset:3328 nt
  v_cvt_f32_i32 v196, v52
  v_cvt_f32_i32 v197, v53
  v_cvt_f32_i32 v198, v54
  v_cvt_f32_i32 v199, v55
  v_pk_add_f32 v[196:197], v[196:197], v[116:117] op_sel_hi:[1,0] neg_lo:[0,1] neg_hi:[0,1]
  v_pk_add_f32 v[198:199], v[198:199], v[116:117] op_sel_hi:[1,0] neg_lo:[0,1] neg_hi:[0,1]
  v_cvt_pk_bf16_f32 v196, 0, v196
  v_lshlrev_b32 v148, 16, v120
  v_cvt_pk_bf16_f32 v197, 0, v197
  v_and_b32 v149, s65, v120
  v_cvt_pk_bf16_f32 v198, 0, v198
  v_lshlrev_b32 v150, 16, v121
  v_cvt_pk_bf16_f32 v199, 0, v199
  v_and_b32 v151, s65, v121
  v_pk_mul_f32 v[196:197], v[196:197], v[116:117] op_sel:[0,1]
  v_lshlrev_b32 v152, 16, v122
  v_pk_mul_f32 v[198:199], v[198:199], v[116:117] op_sel:[0,1]
  s_waitcnt vmcnt(14)
  buffer_load_dwordx4 v[28:31], v93, s[12:15], s60 offen offset:3584 nt
  v_cvt_f32_i32 v200, v56
  v_cvt_f32_i32 v201, v57
  v_cvt_f32_i32 v202, v58
  v_cvt_f32_i32 v203, v59
  v_pk_add_f32 v[200:201], v[200:201], v[116:117] op_sel_hi:[1,0] neg_lo:[0,1] neg_hi:[0,1]
  v_pk_add_f32 v[202:203], v[202:203], v[116:117] op_sel_hi:[1,0] neg_lo:[0,1] neg_hi:[0,1]
  v_cvt_pk_bf16_f32 v200, 0, v200
  v_and_b32 v153, s65, v122
  v_cvt_pk_bf16_f32 v201, 0, v201
  v_lshlrev_b32 v154, 16, v123
  v_cvt_pk_bf16_f32 v202, 0, v202
  v_and_b32 v155, s65, v123
  v_cvt_pk_bf16_f32 v203, 0, v203
  v_lshlrev_b32 v156, 16, v124
  v_pk_mul_f32 v[200:201], v[200:201], v[116:117] op_sel:[0,1]
  v_and_b32 v157, s65, v124
  v_pk_mul_f32 v[202:203], v[202:203], v[116:117] op_sel:[0,1]
  s_waitcnt vmcnt(14)
  s_cbranch_vccnz L_vw1_3
  s_waitcnt vmcnt(9)
L_vw1_3:
  buffer_load_dwordx4 v[32:35], v94, s[12:15], s60 offen offset:0 nt
  v_cvt_f32_i32 v108, v60
  v_cvt_f32_i32 v109, v61
  v_mov_b32_dpp v116, v114 row_newbcast:1 row_mask:0xf bank_mask:0xf
  v_mov_b32_dpp v117, v115 row_newbcast:1 row_mask:0xf bank_mask:0xf
  v_cvt_f32_i32 v110, v62
  v_cvt_f32_i32 v111, v63
  v_pk_add_f32 v[108:109], v[108:109], v[116:117] op_sel_hi:[1,0] neg_lo:[0,1] neg_hi:[0,1]
  v_pk_add_f32 v[110:111], v[110:111], v[116:117] op_sel_hi:[1,0] neg_lo:[0,1] neg_hi:[0,1]
  s_lshl_b32 s62, s84, 9
  v_lshl_add_u32 v98, v97, 1, v96
  buffer_load_short_d16_hi v112, v98, s[32:35], s62 offen
  buffer_load_short_d16_hi v113, v98, s[28:31], s62 offen
  v_cvt_pk_bf16_f32 v108, 0, v108
  v_lshlrev_b32 v158, 16, v125
  v_cvt_pk_bf16_f32 v109, 0, v109
  v_add_u32 v99, s48, v99
  v_cvt_pk_bf16_f32 v110, 0, v110
  v_add_u32 v100, s48, v100
  v_cvt_pk_bf16_f32 v111, 0, v111
  v_max3_f32 v144, v148, v149, v150
  v_pk_mul_f32 v[108:109], v[108:109], v[116:117] op_sel:[0,1]
  ds_read_b128 v[120:123], v99
  v_pk_mul_f32 v[110:111], v[110:111], v[116:117] op_sel:[0,1]
  v_cvt_pk_bf16_f32 v204, v192, v108
  v_cvt_pk_bf16_f32 v208, v193, v109
  v_cvt_pk_bf16_f32 v212, v194, v110
  v_cvt_pk_bf16_f32 v216, v195, v111
  s_waitcnt vmcnt(16)
  buffer_load_dwordx4 v[36:39], v94, s[12:15], s60 offen offset:256 nt
  v_cvt_f32_i32 v108, v64
  v_cvt_f32_i32 v109, v65
  v_cvt_f32_i32 v110, v66
  v_cvt_f32_i32 v111, v67
  v_pk_add_f32 v[108:109], v[108:109], v[116:117] op_sel_hi:[1,0] neg_lo:[0,1] neg_hi:[0,1]
  v_pk_add_f32 v[110:111], v[110:111], v[116:117] op_sel_hi:[1,0] neg_lo:[0,1] neg_hi:[0,1]
  v_cvt_pk_bf16_f32 v108, 0, v108
  ds_read_b64 v[124:125], v100 offset:256
  v_cvt_pk_bf16_f32 v109, 0, v109
  v_max3_f32 v145, v151, v152, v153
  v_cvt_pk_bf16_f32 v110, 0, v110
  v_max3_f32 v144, v144, v154, v155
  v_cvt_pk_bf16_f32 v111, 0, v111
  v_max3_f32 v145, v145, v156, v157
  v_pk_mul_f32 v[108:109], v[108:109], v[116:117] op_sel:[0,1]
  v_max3_f32 v144, v144, v158, v140
  v_pk_mul_f32 v[110:111], v[110:111], v[116:117] op_sel:[0,1]
  v_cvt_pk_bf16_f32 v220, v196, v108
  v_cvt_pk_bf16_f32 v224, v197, v109
  v_cvt_pk_bf16_f32 v228, v198, v110
  v_cvt_pk_bf16_f32 v232, v199, v111
  s_waitcnt vmcnt(16)
  buffer_load_dwordx4 v[40:43], v94, s[12:15], s60 offen offset:512 nt
  v_cvt_f32_i32 v108, v68
  v_cvt_f32_i32 v109, v69
  v_cvt_f32_i32 v110, v70
  v_cvt_f32_i32 v111, v71
  v_pk_add_f32 v[108:109], v[108:109], v[116:117] op_sel_hi:[1,0] neg_lo:[0,1] neg_hi:[0,1]
  v_pk_add_f32 v[110:111], v[110:111], v[116:117] op_sel_hi:[1,0] neg_lo:[0,1] neg_hi:[0,1]
  v_cvt_pk_bf16_f32 v108, 0, v108
  v_max_f32 v144, v144, v145
  v_cvt_pk_bf16_f32 v109, 0, v109
  v_mov_b32 v145, v144
  v_cvt_pk_bf16_f32 v110, 0, v110
  s_nop 0
  v_permlane32_swap_b32 v144, v145
  v_cvt_pk_bf16_f32 v111, 0, v111
  v_max_f32 v144, v144, v145
  v_pk_mul_f32 v[108:109], v[108:109], v[116:117] op_sel:[0,1]
  v_mov_b32 v145, v144
  v_pk_mul_f32 v[110:111], v[110:111], v[116:117] op_sel:[0,1]
  v_cvt_pk_bf16_f32 v236, v200, v108
  v_cvt_pk_bf16_f32 v240, v201, v109
  v_cvt_pk_bf16_f32 v244, v202, v110
  v_cvt_pk_bf16_f32 v248, v203, v111
  s_waitcnt vmcnt(16)
  s_cbranch_vccnz L_vw1_6
  s_waitcnt vmcnt(11)
L_vw1_6:
  buffer_load_dwordx4 v[44:47], v94, s[12:15], s60 offen offset:768 nt
  v_cvt_f32_i32 v192, v72
  v_cvt_f32_i32 v193, v73
  v_mov_b32_dpp v116, v114 row_newbcast:2 row_mask:0xf bank_mask:0xf
  v_mov_b32_dpp v117, v115 row_newbcast:2 row_mask:0xf bank_mask:0xf
  v_cvt_f32_i32 v194, v74
  v_cvt_f32_i32 v195, v75
  v_pk_add_f32 v[192:193], v[192:193], v[116:117] op_sel_hi:[1,0] neg_lo:[0,1] neg_hi:[0,1]
  v_pk_add_f32 v[194:195], v[194:195], v[116:117] op_sel_hi:[1,0] neg_lo:[0,1] neg_hi:[0,1]
  v_cvt_pk_bf16_f32 v192, 0, v192
  v_permlane16_swap_b32 v144, v145
  v_cvt_pk_bf16_f32 v193, 0, v193
  v_max_f32 v140, v144, v145
  v_cvt_pk_bf16_f32 v194, 0, v194
  v_mul_f32 v144, s66, v140
  v_cvt_pk_bf16_f32 v195, 0, v195
  v_add_f32 v146, v144, v142
  v_pk_mul_f32 v[192:193], v[192:193], v[116:117] op_sel:[0,1]
  v_sub_f32 v142, 0, v144
  v_pk_mul_f32 v[194:195], v[194:195], v[116:117] op_sel:[0,1]
  s_waitcnt vmcnt(16)
  buffer_load_dwordx4 v[48:51], v94, s[12:15], s60 offen offset:1024 nt
  v_cvt_f32_i32 v196, v76
  v_cvt_f32_i32 v197, v77
  v_cvt_f32_i32 v198, v78
  v_cvt_f32_i32 v199, v79
  v_pk_add_f32 v[196:197], v[196:197], v[116:117] op_sel_hi:[1,0] neg_lo:[0,1] neg_hi:[0,1]
  v_pk_add_f32 v[198:199], v[198:199], v[116:117] op_sel_hi:[1,0] neg_lo:[0,1] neg_hi:[0,1]
  v_cvt_pk_bf16_f32 v196, 0, v196
  v_exp_f32 v146, -v146
  v_cvt_pk_bf16_f32 v197, 0, v197
  ds_bpermute_b32 v147, v101, v146
  v_cvt_pk_bf16_f32 v198, 0, v198
  v_fma_f32 v148, v148, s66, v142
  v_cvt_pk_bf16_f32 v199, 0, v199
  v_exp_f32 v148, v148
  v_pk_mul_f32 v[196:197], v[196:197], v[116:117] op_sel:[0,1]
  v_fma_f32 v149, v149, s66, v142
  v_pk_mul_f32 v[198:199], v[198:199], v[116:117] op_sel:[0,1]
  s_waitcnt vmcnt(16)
  buffer_load_dwordx4 v[52:55], v94, s[12:15], s60 offen offset:1280 nt
  v_cvt_f32_i32 v200, v80
  v_cvt_f32_i32 v201, v81
  v_cvt_f32_i32 v202, v82
  v_cvt_f32_i32 v203, v83
  v_pk_add_f32 v[200:201], v[200:201], v[116:117] op_sel_hi:[1,0] neg_lo:[0,1] neg_hi:[0,1]
  v_pk_add_f32 v[202:203], v[202:203], v[116:117] op_sel_hi:[1,0] neg_lo:[0,1] neg_hi:[0,1]
  v_cvt_pk_bf16_f32 v200, 0, v200
  v_exp_f32 v149, v149
  v_cvt_pk_bf16_f32 v201, 0, v201
  v_fma_f32 v150, v150, s66, v142
  v_cvt_pk_bf16_f32 v202, 0, v202
  v_exp_f32 v150, v150
  v_cvt_pk_bf16_f32 v203, 0, v203
  v_fma_f32 v151, v151, s66, v142
  v_pk_mul_f32 v[200:201], v[200:201], v[116:117] op_sel:[0,1]
  v_exp_f32 v151, v151
  v_pk_mul_f32 v[202:203], v[202:203], v[116:117] op_sel:[0,1]
  s_waitcnt vmcnt(16)
  s_cbranch_vccnz L_vw1_9
  s_waitcnt vmcnt(11)
L_vw1_9:
  buffer_load_dwordx4 v[56:59], v94, s[12:15], s60 offen offset:1536 nt
  v_cvt_f32_i32 v108, v84
  v_cvt_f32_i32 v109, v85
  v_mov_b32_dpp v116, v114 row_newbcast:3 row_mask:0xf bank_mask:0xf
  v_mov_b32_dpp v117, v115 row_newbcast:3 row_mask:0xf bank_mask:0xf
  v_cvt_f32_i32 v110, v86
  v_cvt_f32_i32 v111, v87
  v_pk_add_f32 v[108:109], v[108:109], v[116:117] op_sel_hi:[1,0] neg_lo:[0,1] neg_hi:[0,1]
  v_pk_add_f32 v[110:111], v[110:111], v[116:117] op_sel_hi:[1,0] neg_lo:[0,1] neg_hi:[0,1]
  v_cvt_pk_bf16_f32 v108, 0, v108
  v_fma_f32 v152, v152, s66, v142
  v_cvt_pk_bf16_f32 v109, 0, v109
  v_exp_f32 v152, v152
  v_cvt_pk_bf16_f32 v110, 0, v110
  v_fma_f32 v153, v153, s66, v142
  v_cvt_pk_bf16_f32 v111, 0, v111
  v_exp_f32 v153, v153
  v_pk_mul_f32 v[108:109], v[108:109], v[116:117] op_sel:[0,1]
  v_fma_f32 v154, v154, s66, v142
  v_pk_mul_f32 v[110:111], v[110:111], v[116:117] op_sel:[0,1]
  v_cvt_pk_bf16_f32 v205, v192, v108
  v_cvt_pk_bf16_f32 v209, v193, v109
  v_cvt_pk_bf16_f32 v213, v194, v110
  v_cvt_pk_bf16_f32 v217, v195, v111
  s_waitcnt vmcnt(16)
  buffer_load_dwordx4 v[60:63], v94, s[12:15], s60 offen offset:1792 nt
  v_cvt_f32_i32 v108, v88
  v_cvt_f32_i32 v109, v89
  v_cvt_f32_i32 v110, v90
  v_cvt_f32_i32 v111, v91
  v_pk_add_f32 v[108:109], v[108:109], v[116:117] op_sel_hi:[1,0] neg_lo:[0,1] neg_hi:[0,1]
  v_pk_add_f32 v[110:111], v[110:111], v[116:117] op_sel_hi:[1,0] neg_lo:[0,1] neg_hi:[0,1]
  v_cvt_pk_bf16_f32 v108, 0, v108
  v_exp_f32 v154, v154
  v_cvt_pk_bf16_f32 v109, 0, v109
  v_fma_f32 v155, v155, s66, v142
  v_cvt_pk_bf16_f32 v110, 0, v110
  v_exp_f32 v155, v155
  v_cvt_pk_bf16_f32 v111, 0, v111
  v_fma_f32 v156, v156, s66, v142
  v_pk_mul_f32 v[108:109], v[108:109], v[116:117] op_sel:[0,1]
  v_exp_f32 v156, v156
  v_pk_mul_f32 v[110:111], v[110:111], v[116:117] op_sel:[0,1]
  v_cvt_pk_bf16_f32 v221, v196, v108
  v_cvt_pk_bf16_f32 v225, v197, v109
  v_cvt_pk_bf16_f32 v229, v198, v110
  v_cvt_pk_bf16_f32 v233, v199, v111
  s_waitcnt vmcnt(16)
  buffer_load_dwordx4 v[64:67], v94, s[12:15], s60 offen offset:2048 nt
  v_cvt_f32_i32 v108, v4
  v_cvt_f32_i32 v109, v5
  v_cvt_f32_i32 v110, v6
  v_cvt_f32_i32 v111, v7
  v_pk_add_f32 v[108:109], v[108:109], v[116:117] op_sel_hi:[1,0] neg_lo:[0,1] neg_hi:[0,1]
  v_pk_add_f32 v[110:111], v[110:111], v[116:117] op_sel_hi:[1,0] neg_lo:[0,1] neg_hi:[0,1]
  v_cvt_pk_bf16_f32 v108, 0, v108
  v_fma_f32 v157, v157, s66, v142
  v_cvt_pk_bf16_f32 v109, 0, v109
  v_exp_f32 v157, v157
  v_cvt_pk_bf16_f32 v110, 0, v110
  v_fma_f32 v158, v158, s66, v142
  v_cvt_pk_bf16_f32 v111, 0, v111
  v_exp_f32 v158, v158
  v_pk_mul_f32 v[108:109], v[108:109], v[116:117] op_sel:[0,1]
  v_add_f32 v144, v148, v149
  v_pk_mul_f32 v[110:111], v[110:111], v[116:117] op_sel:[0,1]
  v_cvt_pk_bf16_f32 v237, v200, v108
  v_cvt_pk_bf16_f32 v241, v201, v109
  v_cvt_pk_bf16_f32 v245, v202, v110
  v_cvt_pk_bf16_f32 v249, v203, v111
  s_waitcnt vmcnt(16)
  s_cbranch_vccnz L_vw1_12
  s_waitcnt vmcnt(11)
L_vw1_12:
  buffer_load_dwordx4 v[68:71], v94, s[12:15], s60 offen offset:2304 nt
  v_cvt_f32_i32 v192, v8
  v_cvt_f32_i32 v193, v9
  v_mov_b32_dpp v116, v114 row_newbcast:4 row_mask:0xf bank_mask:0xf
  v_mov_b32_dpp v117, v115 row_newbcast:4 row_mask:0xf bank_mask:0xf
  v_cvt_f32_i32 v194, v10
  v_cvt_f32_i32 v195, v11
  v_pk_add_f32 v[192:193], v[192:193], v[116:117] op_sel_hi:[1,0] neg_lo:[0,1] neg_hi:[0,1]
  v_pk_add_f32 v[194:195], v[194:195], v[116:117] op_sel_hi:[1,0] neg_lo:[0,1] neg_hi:[0,1]
  v_cvt_pk_bf16_f32 v192, 0, v192
  v_add_f32 v145, v150, v151
  v_cvt_pk_bf16_f32 v193, 0, v193
  v_add_f32 v144, v144, v152
  v_cvt_pk_bf16_f32 v194, 0, v194
  v_add_f32 v145, v145, v153
  v_cvt_pk_bf16_f32 v195, 0, v195
  v_add_f32 v144, v144, v154
  v_pk_mul_f32 v[192:193], v[192:193], v[116:117] op_sel:[0,1]
  v_add_f32 v145, v145, v155
  v_pk_mul_f32 v[194:195], v[194:195], v[116:117] op_sel:[0,1]
  s_waitcnt vmcnt(16)
  buffer_load_dwordx4 v[72:75], v94, s[12:15], s60 offen offset:2560 nt
  v_cvt_f32_i32 v196, v12
  v_cvt_f32_i32 v197, v13
  v_cvt_f32_i32 v198, v14
  v_cvt_f32_i32 v199, v15
  v_pk_add_f32 v[196:197], v[196:197], v[116:117] op_sel_hi:[1,0] neg_lo:[0,1] neg_hi:[0,1]
  v_pk_add_f32 v[198:199], v[198:199], v[116:117] op_sel_hi:[1,0] neg_lo:[0,1] neg_hi:[0,1]
  v_cvt_pk_bf16_f32 v196, 0, v196
  v_add_f32 v144, v144, v156
  v_cvt_pk_bf16_f32 v197, 0, v197
  v_add_f32 v145, v145, v157
  v_cvt_pk_bf16_f32 v198, 0, v198
  v_add_f32 v144, v144, v158
  v_cvt_pk_bf16_f32 v199, 0, v199
  v_add_f32 v144, v144, v145
  v_pk_mul_f32 v[196:197], v[196:197], v[116:117] op_sel:[0,1]
  v_fma_f32 v143, v143, v146, v144
  v_pk_mul_f32 v[198:199], v[198:199], v[116:117] op_sel:[0,1]
  s_waitcnt vmcnt(16)
  buffer_load_dwordx4 v[76:79], v94, s[12:15], s60 offen offset:2816 nt
  v_cvt_f32_i32 v200, v16
  v_cvt_f32_i32 v201, v17
  v_cvt_f32_i32 v202, v18
  v_cvt_f32_i32 v203, v19
  v_pk_add_f32 v[200:201], v[200:201], v[116:117] op_sel_hi:[1,0] neg_lo:[0,1] neg_hi:[0,1]
  v_pk_add_f32 v[202:203], v[202:203], v[116:117] op_sel_hi:[1,0] neg_lo:[0,1] neg_hi:[0,1]
  v_cvt_pk_bf16_f32 v200, 0, v200
  v_cvt_pk_bf16_f32 v159, v148, v149
  v_cvt_pk_bf16_f32 v201, 0, v201
  v_cvt_pk_bf16_f32 v160, v150, v151
  v_cvt_pk_bf16_f32 v202, 0, v202
  v_cvt_pk_bf16_f32 v161, v152, v153
  v_cvt_pk_bf16_f32 v203, 0, v203
  v_cvt_pk_bf16_f32 v162, v154, v155
  v_pk_mul_f32 v[200:201], v[200:201], v[116:117] op_sel:[0,1]
  v_cvt_pk_bf16_f32 v163, v156, v157
  v_pk_mul_f32 v[202:203], v[202:203], v[116:117] op_sel:[0,1]
  s_waitcnt vmcnt(16)
  s_cbranch_vccnz L_vw1_15
  s_waitcnt vmcnt(9)
L_vw1_15:
  buffer_load_dwordx4 v[80:83], v95, s[12:15], s60 offen offset:0 nt
  v_cvt_f32_i32 v108, v20
  v_cvt_f32_i32 v109, v21
  v_mov_b32_dpp v116, v114 row_newbcast:5 row_mask:0xf bank_mask:0xf
  v_mov_b32_dpp v117, v115 row_newbcast:5 row_mask:0xf bank_mask:0xf
  v_cvt_f32_i32 v110, v22
  v_cvt_f32_i32 v111, v23
  v_pk_add_f32 v[108:109], v[108:109], v[116:117] op_sel_hi:[1,0] neg_lo:[0,1] neg_hi:[0,1]
  v_pk_add_f32 v[110:111], v[110:111], v[116:117] op_sel_hi:[1,0] neg_lo:[0,1] neg_hi:[0,1]
  v_cvt_pk_bf16_f32 v108, 0, v108
  v_cvt_pk_bf16_f32 v164, v158, 0
  v_cvt_pk_bf16_f32 v109, 0, v109
  v_cndmask_b32 v168, 0, v159, s[72:73]
  v_cvt_pk_bf16_f32 v110, 0, v110
  v_cndmask_b32 v169, 0, v160, s[72:73]
  v_cvt_pk_bf16_f32 v111, 0, v111
  v_cndmask_b32 v170, 0, v161, s[72:73]
  v_pk_mul_f32 v[108:109], v[108:109], v[116:117] op_sel:[0,1]
  v_cndmask_b32 v171, 0, v162, s[72:73]
  v_pk_mul_f32 v[110:111], v[110:111], v[116:117] op_sel:[0,1]
  v_cvt_pk_bf16_f32 v206, v192, v108
  v_cvt_pk_bf16_f32 v210, v193, v109
  v_cvt_pk_bf16_f32 v214, v194, v110
  v_cvt_pk_bf16_f32 v218, v195, v111
  s_waitcnt vmcnt(16)
  buffer_load_dwordx4 v[84:87], v95, s[12:15], s60 offen offset:256 nt
  v_cvt_f32_i32 v108, v24
  v_cvt_f32_i32 v109, v25
  v_cvt_f32_i32 v110, v26
  v_cvt_f32_i32 v111, v27
  v_pk_add_f32 v[108:109], v[108:109], v[116:117] op_sel_hi:[1,0] neg_lo:[0,1] neg_hi:[0,1]
  v_pk_add_f32 v[110:111], v[110:111], v[116:117] op_sel_hi:[1,0] neg_lo:[0,1] neg_hi:[0,1]
  v_cvt_pk_bf16_f32 v108, 0, v108
  v_cndmask_b32 v172, 0, v159, s[74:75]
  v_cvt_pk_bf16_f32 v109, 0, v109
  v_cndmask_b32 v173, 0, v160, s[74:75]
  v_cvt_pk_bf16_f32 v110, 0, v110
  v_cndmask_b32 v174, 0, v161, s[74:75]
  v_cvt_pk_bf16_f32 v111, 0, v111
  v_cndmask_b32 v175, 0, v162, s[74:75]
  v_pk_mul_f32 v[108:109], v[108:109], v[116:117] op_sel:[0,1]
  v_cndmask_b32 v176, 0, v159, s[76:77]
  v_pk_mul_f32 v[110:111], v[110:111], v[116:117] op_sel:[0,1]
  v_cvt_pk_bf16_f32 v222, v196, v108
  v_cvt_pk_bf16_f32 v226, v197, v109
  v_cvt_pk_bf16_f32 v230, v198, v110
  v_cvt_pk_bf16_f32 v234, v199, v111
  s_waitcnt vmcnt(16)
  buffer_load_dwordx4 v[88:91], v95, s[12:15], s60 offen offset:512 nt
  v_cvt_f32_i32 v108, v28
  v_cvt_f32_i32 v109, v29
  v_cvt_f32_i32 v110, v30
  v_cvt_f32_i32 v111, v31
  v_pk_add_f32 v[108:109], v[108:109], v[116:117] op_sel_hi:[1,0] neg_lo:[0,1] neg_hi:[0,1]
  v_pk_add_f32 v[110:111], v[110:111], v[116:117] op_sel_hi:[1,0] neg_lo:[0,1] neg_hi:[0,1]
  v_cvt_pk_bf16_f32 v108, 0, v108
  v_cndmask_b32 v177, 0, v160, s[76:77]
  v_cvt_pk_bf16_f32 v109, 0, v109
  v_cndmask_b32 v178, 0, v161, s[76:77]
  v_cvt_pk_bf16_f32 v110, 0, v110
  v_cndmask_b32 v179, 0, v162, s[76:77]
  v_cvt_pk_bf16_f32 v111, 0, v111
  v_cndmask_b32 v180, 0, v159, s[78:79]
  v_pk_mul_f32 v[108:109], v[108:109], v[116:117] op_sel:[0,1]
  v_cndmask_b32 v181, 0, v160, s[78:79]
  v_pk_mul_f32 v[110:111], v[110:111], v[116:117] op_sel:[0,1]
  v_cvt_pk_bf16_f32 v238, v200, v108
  v_cvt_pk_bf16_f32 v242, v201, v109
  v_cvt_pk_bf16_f32 v246, v202, v110
  v_cvt_pk_bf16_f32 v250, v203, v111
  v_mad_u32_u24 v92, v97, s63, v3
  v_add_u32 v93, 768, v92
  v_add_u32 v94, 4608, v92
  v_add_u32 v95, 7680, v92
  v_cndmask_b32 v92, v92, v105, s[52:53]
  v_cndmask_b32 v95, v95, v105, s[54:55]
  s_waitcnt vmcnt(16)
  s_cbranch_vccnz L_vw1_18
  s_waitcnt vmcnt(9)
L_vw1_18:
  buffer_load_dwordx4 v[4:7], v92, s[12:15], s61 offen offset:0 nt
  v_cvt_f32_i32 v192, v32
  v_cvt_f32_i32 v193, v33
  v_mov_b32_dpp v116, v114 row_newbcast:6 row_mask:0xf bank_mask:0xf
  v_mov_b32_dpp v117, v115 row_newbcast:6 row_mask:0xf bank_mask:0xf
  v_cvt_f32_i32 v194, v34
  v_cvt_f32_i32 v195, v35
  v_pk_add_f32 v[192:193], v[192:193], v[116:117] op_sel_hi:[1,0] neg_lo:[0,1] neg_hi:[0,1]
  v_pk_add_f32 v[194:195], v[194:195], v[116:117] op_sel_hi:[1,0] neg_lo:[0,1] neg_hi:[0,1]
  v_cvt_pk_bf16_f32 v192, 0, v192
  v_cndmask_b32 v182, 0, v161, s[78:79]
  v_cvt_pk_bf16_f32 v193, 0, v193
  v_cndmask_b32 v183, 0, v162, s[78:79]
  v_cvt_pk_bf16_f32 v194, 0, v194
  s_waitcnt lgkmcnt(0)
  v_cvt_pk_bf16_f32 v195, 0, v195
  v_mul_f32 v128, v147, v128
  v_pk_mul_f32 v[192:193], v[192:193], v[116:117] op_sel:[0,1]
  v_mul_f32 v129, v147, v129
  v_pk_mul_f32 v[194:195], v[194:195], v[116:117] op_sel:[0,1]
  s_waitcnt vmcnt(14)
  buffer_load_dwordx4 v[8:11], v92, s[12:15], s61 offen offset:256 nt
  v_cvt_f32_i32 v196, v36
  v_cvt_f32_i32 v197, v37
  v_cvt_f32_i32 v198, v38
  v_cvt_f32_i32 v199, v39
  v_pk_add_f32 v[196:197], v[196:197], v[116:117] op_sel_hi:[1,0] neg_lo:[0,1] neg_hi:[0,1]
  v_pk_add_f32 v[198:199], v[198:199], v[116:117] op_sel_hi:[1,0] neg_lo:[0,1] neg_hi:[0,1]
  v_cvt_pk_bf16_f32 v196, 0, v196
  v_mul_f32 v130, v147, v130
  v_cvt_pk_bf16_f32 v197, 0, v197
  v_mul_f32 v131, v147, v131
  v_cvt_pk_bf16_f32 v198, 0, v198
  v_mul_f32 v132, v147, v132
  v_cvt_pk_bf16_f32 v199, 0, v199
  v_mul_f32 v133, v147, v133
  v_pk_mul_f32 v[196:197], v[196:197], v[116:117] op_sel:[0,1]
  v_mul_f32 v134, v147, v134
  v_pk_mul_f32 v[198:199], v[198:199], v[116:117] op_sel:[0,1]
  s_waitcnt vmcnt(14)
  buffer_load_dwordx4 v[12:15], v92, s[12:15], s61 offen offset:512 nt
  v_cvt_f32_i32 v200, v40
  v_cvt_f32_i32 v201, v41
  v_cvt_f32_i32 v202, v42
  v_cvt_f32_i32 v203, v43
  v_pk_add_f32 v[200:201], v[200:201], v[116:117] op_sel_hi:[1,0] neg_lo:[0,1] neg_hi:[0,1]
  v_pk_add_f32 v[202:203], v[202:203], v[116:117] op_sel_hi:[1,0] neg_lo:[0,1] neg_hi:[0,1]
  v_cvt_pk_bf16_f32 v200, 0, v200
  v_mul_f32 v135, v147, v135
  v_cvt_pk_bf16_f32 v201, 0, v201
  v_mul_f32 v136, v147, v136
  v_cvt_pk_bf16_f32 v202, 0, v202
  v_mul_f32 v137, v147, v137
  v_cvt_pk_bf16_f32 v203, 0, v203
  v_mul_f32 v138, v147, v138
  v_pk_mul_f32 v[200:201], v[200:201], v[116:117] op_sel:[0,1]
  v_mul_f32 v139, v147, v139
  v_pk_mul_f32 v[202:203], v[202:203], v[116:117] op_sel:[0,1]
  s_waitcnt vmcnt(14)
  s_cbranch_vccnz L_vw1_21
  s_waitcnt vmcnt(9)
L_vw1_21:
  buffer_load_dwordx4 v[16:19], v93, s[12:15], s61 offen offset:0 nt
  v_cvt_f32_i32 v108, v44
  v_cvt_f32_i32 v109, v45
  v_mov_b32_dpp v116, v114 row_newbcast:7 row_mask:0xf bank_mask:0xf
  v_mov_b32_dpp v117, v115 row_newbcast:7 row_mask:0xf bank_mask:0xf
  v_cvt_f32_i32 v110, v46
  v_cvt_f32_i32 v111, v47
  v_pk_add_f32 v[108:109], v[108:109], v[116:117] op_sel_hi:[1,0] neg_lo:[0,1] neg_hi:[0,1]
  v_pk_add_f32 v[110:111], v[110:111], v[116:117] op_sel_hi:[1,0] neg_lo:[0,1] neg_hi:[0,1]
  v_cvt_pk_bf16_f32 v108, 0, v108
  v_cvt_pk_bf16_f32 v109, 0, v109
  v_cvt_pk_bf16_f32 v110, 0, v110
  v_cvt_pk_bf16_f32 v111, 0, v111
  v_pk_mul_f32 v[108:109], v[108:109], v[116:117] op_sel:[0,1]
  v_pk_mul_f32 v[110:111], v[110:111], v[116:117] op_sel:[0,1]
  v_cvt_pk_bf16_f32 v207, v192, v108
  v_cvt_pk_bf16_f32 v211, v193, v109
  v_cvt_pk_bf16_f32 v215, v194, v110
  v_cvt_pk_bf16_f32 v219, v195, v111
  v_mfma_f32_16x16x32_bf16 v[128:131], v[168:171], v[204:207], v[128:131]
  v_mfma_f32_16x16x32_bf16 v[128:131], v[172:175], v[208:211], v[128:131]
  v_mfma_f32_16x16x32_bf16 v[128:131], v[176:179], v[212:215], v[128:131]
  v_mfma_f32_16x16x32_bf16 v[128:131], v[180:183], v[216:219], v[128:131]
  s_waitcnt vmcnt(14)
  buffer_load_dwordx4 v[20:23], v93, s[12:15], s61 offen offset:256 nt
  v_cvt_f32_i32 v108, v48
  v_cvt_f32_i32 v109, v49
  v_cvt_f32_i32 v110, v50
  v_cvt_f32_i32 v111, v51
  v_pk_add_f32 v[108:109], v[108:109], v[116:117] op_sel_hi:[1,0] neg_lo:[0,1] neg_hi:[0,1]
  v_pk_add_f32 v[110:111], v[110:111], v[116:117] op_sel_hi:[1,0] neg_lo:[0,1] neg_hi:[0,1]
  v_cvt_pk_bf16_f32 v108, 0, v108
  v_cvt_pk_bf16_f32 v109, 0, v109
  v_cvt_pk_bf16_f32 v110, 0, v110
  v_cvt_pk_bf16_f32 v111, 0, v111
  v_pk_mul_f32 v[108:109], v[108:109], v[116:117] op_sel:[0,1]
  v_pk_mul_f32 v[110:111], v[110:111], v[116:117] op_sel:[0,1]
  v_cvt_pk_bf16_f32 v223, v196, v108
  v_cvt_pk_bf16_f32 v227, v197, v109
  v_cvt_pk_bf16_f32 v231, v198, v110
  v_cvt_pk_bf16_f32 v235, v199, v111
  v_mfma_f32_16x16x32_bf16 v[132:135], v[168:171], v[220:223], v[132:135]
  v_mfma_f32_16x16x32_bf16 v[132:135], v[172:175], v[224:227], v[132:135]
  v_mfma_f32_16x16x32_bf16 v[132:135], v[176:179], v[228:231], v[132:135]
  v_mfma_f32_16x16x32_bf16 v[132:135], v[180:183], v[232:235], v[132:135]
  s_waitcnt vmcnt(14)
  buffer_load_dwordx4 v[24:27], v93, s[12:15], s61 offen offset:512 nt
  v_cvt_f32_i32 v108, v52
  v_cvt_f32_i32 v109, v53
  v_cvt_f32_i32 v110, v54
  v_cvt_f32_i32 v111, v55
  v_pk_add_f32 v[108:109], v[108:109], v[116:117] op_sel_hi:[1,0] neg_lo:[0,1] neg_hi:[0,1]
  v_pk_add_f32 v[110:111], v[110:111], v[116:117] op_sel_hi:[1,0] neg_lo:[0,1] neg_hi:[0,1]
  v_cvt_pk_bf16_f32 v108, 0, v108
  v_cvt_pk_bf16_f32 v109, 0, v109
  v_cvt_pk_bf16_f32 v110, 0, v110
  v_cvt_pk_bf16_f32 v111, 0, v111
  v_pk_mul_f32 v[108:109], v[108:109], v[116:117] op_sel:[0,1]
  v_pk_mul_f32 v[110:111], v[110:111], v[116:117] op_sel:[0,1]
  v_cvt_pk_bf16_f32 v239, v200, v108
  v_cvt_pk_bf16_f32 v243, v201, v109
  v_cvt_pk_bf16_f32 v247, v202, v110
  v_cvt_pk_bf16_f32 v251, v203, v111
  v_mfma_f32_16x16x32_bf16 v[136:139], v[168:171], v[236:239], v[136:139]
  v_mfma_f32_16x16x32_bf16 v[136:139], v[172:175], v[240:243], v[136:139]
  v_mfma_f32_16x16x32_bf16 v[136:139], v[176:179], v[244:247], v[136:139]
  v_mfma_f32_16x16x32_bf16 v[136:139], v[180:183], v[248:251], v[136:139]
  s_waitcnt vmcnt(14)
  s_cbranch_vccnz L_vw1_24
  s_waitcnt vmcnt(9)
L_vw1_24:
  buffer_load_dwordx4 v[28:31], v93, s[12:15], s61 offen offset:768 nt
  v_cvt_f32_i32 v192, v56
  v_cvt_f32_i32 v193, v57
  v_mov_b32_dpp v116, v114 row_newbcast:8 row_mask:0xf bank_mask:0xf
  v_mov_b32_dpp v117, v115 row_newbcast:8 row_mask:0xf bank_mask:0xf
  v_cvt_f32_i32 v194, v58
  v_cvt_f32_i32 v195, v59
  v_pk_add_f32 v[192:193], v[192:193], v[116:117] op_sel_hi:[1,0] neg_lo:[0,1] neg_hi:[0,1]
  v_pk_add_f32 v[194:195], v[194:195], v[116:117] op_sel_hi:[1,0] neg_lo:[0,1] neg_hi:[0,1]
  v_cvt_pk_bf16_f32 v192, 0, v192
  v_cndmask_b32 v184, 0, v163, s[72:73]
  v_cvt_pk_bf16_f32 v193, 0, v193
  v_cndmask_b32 v185, 0, v164, s[72:73]
  v_cvt_pk_bf16_f32 v194, 0, v194
  v_cndmask_b32 v186, 0, v163, s[74:75]
  v_cvt_pk_bf16_f32 v195, 0, v195
  v_cndmask_b32 v187, 0, v164, s[74:75]
  v_pk_mul_f32 v[192:193], v[192:193], v[116:117] op_sel:[0,1]
  v_cndmask_b32 v188, 0, v163, s[76:77]
  v_pk_mul_f32 v[194:195], v[194:195], v[116:117] op_sel:[0,1]
  s_waitcnt vmcnt(14)
  buffer_load_dwordx4 v[32:35], v93, s[12:15], s61 offen offset:1024 nt
  v_cvt_f32_i32 v196, v60
  v_cvt_f32_i32 v197, v61
  v_cvt_f32_i32 v198, v62
  v_cvt_f32_i32 v199, v63
  v_pk_add_f32 v[196:197], v[196:197], v[116:117] op_sel_hi:[1,0] neg_lo:[0,1] neg_hi:[0,1]
  v_pk_add_f32 v[198:199], v[198:199], v[116:117] op_sel_hi:[1,0] neg_lo:[0,1] neg_hi:[0,1]
  v_cvt_pk_bf16_f32 v196, 0, v196
  v_cndmask_b32 v189, 0, v164, s[76:77]
  v_cvt_pk_bf16_f32 v197, 0, v197
  v_cndmask_b32 v190, 0, v163, s[78:79]
  v_cvt_pk_bf16_f32 v198, 0, v198
  v_cndmask_b32 v191, 0, v164, s[78:79]
  v_cvt_pk_bf16_f32 v199, 0, v199
  v_pk_mul_f32 v[196:197], v[196:197], v[116:117] op_sel:[0,1]
  v_pk_mul_f32 v[198:199], v[198:199], v[116:117] op_sel:[0,1]
  s_waitcnt vmcnt(14)
  buffer_load_dwordx4 v[36:39], v93, s[12:15], s61 offen offset:1280 nt
  v_cvt_f32_i32 v200, v64
  v_cvt_f32_i32 v201, v65
  v_cvt_f32_i32 v202, v66
  v_cvt_f32_i32 v203, v67
  v_pk_add_f32 v[200:201], v[200:201], v[116:117] op_sel_hi:[1,0] neg_lo:[0,1] neg_hi:[0,1]
  v_pk_add_f32 v[202:203], v[202:203], v[116:117] op_sel_hi:[1,0] neg_lo:[0,1] neg_hi:[0,1]
  v_cvt_pk_bf16_f32 v200, 0, v200
  v_cvt_pk_bf16_f32 v201, 0, v201
  v_cvt_pk_bf16_f32 v202, 0, v202
  v_cvt_pk_bf16_f32 v203, 0, v203
  v_pk_mul_f32 v[200:201], v[200:201], v[116:117] op_sel:[0,1]
  v_pk_mul_f32 v[202:203], v[202:203], v[116:117] op_sel:[0,1]
  s_waitcnt vmcnt(14)
  s_cbranch_vccnz L_vw1_27
  s_waitcnt vmcnt(9)
L_vw1_27:
  buffer_load_dwordx4 v[40:43], v93, s[12:15], s61 offen offset:1536 nt
  v_cvt_f32_i32 v108, v68
  v_cvt_f32_i32 v109, v69
  v_mov_b32_dpp v116, v114 row_newbcast:9 row_mask:0xf bank_mask:0xf
  v_mov_b32_dpp v117, v115 row_newbcast:9 row_mask:0xf bank_mask:0xf
  v_cvt_f32_i32 v110, v70
  v_cvt_f32_i32 v111, v71
  v_pk_add_f32 v[108:109], v[108:109], v[116:117] op_sel_hi:[1,0] neg_lo:[0,1] neg_hi:[0,1]
  v_pk_add_f32 v[110:111], v[110:111], v[116:117] op_sel_hi:[1,0] neg_lo:[0,1] neg_hi:[0,1]
  v_cvt_pk_bf16_f32 v108, 0, v108
  v_cvt_pk_bf16_f32 v109, 0, v109
  v_cvt_pk_bf16_f32 v110, 0, v110
  v_cvt_pk_bf16_f32 v111, 0, v111
  v_pk_mul_f32 v[108:109], v[108:109], v[116:117] op_sel:[0,1]
  v_pk_mul_f32 v[110:111], v[110:111], v[116:117] op_sel:[0,1]
  v_cvt_pk_bf16_f32 v204, v192, v108
  v_cvt_pk_bf16_f32 v208, v193, v109
  v_cvt_pk_bf16_f32 v212, v194, v110
  v_cvt_pk_bf16_f32 v216, v195, v111
  s_waitcnt vmcnt(14)
  buffer_load_dwordx4 v[44:47], v93, s[12:15], s61 offen offset:1792 nt
  v_cvt_f32_i32 v108, v72
  v_cvt_f32_i32 v109, v73
  v_cvt_f32_i32 v110, v74
  v_cvt_f32_i32 v111, v75
  v_pk_add_f32 v[108:109], v[108:109], v[116:117] op_sel_hi:[1,0] neg_lo:[0,1] neg_hi:[0,1]
  v_pk_add_f32 v[110:111], v[110:111], v[116:117] op_sel_hi:[1,0] neg_lo:[0,1] neg_hi:[0,1]
  v_cvt_pk_bf16_f32 v108, 0, v108
  v_cvt_pk_bf16_f32 v109, 0, v109
  v_cvt_pk_bf16_f32 v110, 0, v110
  v_cvt_pk_bf16_f32 v111, 0, v111
  v_pk_mul_f32 v[108:109], v[108:109], v[116:117] op_sel:[0,1]
  v_pk_mul_f32 v[110:111], v[110:111], v[116:117] op_sel:[0,1]
  v_cvt_pk_bf16_f32 v220, v196, v108
  v_cvt_pk_bf16_f32 v224, v197, v109
  v_cvt_pk_bf16_f32 v228, v198, v110
  v_cvt_pk_bf16_f32 v232, v199, v111
  s_waitcnt vmcnt(14)
  buffer_load_dwordx4 v[48:51], v93, s[12:15], s61 offen offset:2048 nt
  v_cvt_f32_i32 v108, v76
  v_cvt_f32_i32 v109, v77
  v_cvt_f32_i32 v110, v78
  v_cvt_f32_i32 v111, v79
  v_pk_add_f32 v[108:109], v[108:109], v[116:117] op_sel_hi:[1,0] neg_lo:[0,1] neg_hi:[0,1]
  v_pk_add_f32 v[110:111], v[110:111], v[116:117] op_sel_hi:[1,0] neg_lo:[0,1] neg_hi:[0,1]
  v_cvt_pk_bf16_f32 v108, 0, v108
  v_cvt_pk_bf16_f32 v109, 0, v109
  v_cvt_pk_bf16_f32 v110, 0, v110
  v_cvt_pk_bf16_f32 v111, 0, v111
  v_pk_mul_f32 v[108:109], v[108:109], v[116:117] op_sel:[0,1]
  v_pk_mul_f32 v[110:111], v[110:111], v[116:117] op_sel:[0,1]
  v_cvt_pk_bf16_f32 v236, v200, v108
  v_cvt_pk_bf16_f32 v240, v201, v109
  v_cvt_pk_bf16_f32 v244, v202, v110
  v_cvt_pk_bf16_f32 v248, v203, v111
  s_waitcnt vmcnt(14)
  s_cbranch_vccnz L_vw1_30
  s_waitcnt vmcnt(9)
L_vw1_30:
  buffer_load_dwordx4 v[52:55], v93, s[12:15], s61 offen offset:2304 nt
  v_cvt_f32_i32 v192, v80
  v_cvt_f32_i32 v193, v81
  v_mov_b32_dpp v116, v114 row_newbcast:10 row_mask:0xf bank_mask:0xf
  v_mov_b32_dpp v117, v115 row_newbcast:10 row_mask:0xf bank_mask:0xf
  v_cvt_f32_i32 v194, v82
  v_cvt_f32_i32 v195, v83
  v_pk_add_f32 v[192:193], v[192:193], v[116:117] op_sel_hi:[1,0] neg_lo:[0,1] neg_hi:[0,1]
  v_pk_add_f32 v[194:195], v[194:195], v[116:117] op_sel_hi:[1,0] neg_lo:[0,1] neg_hi:[0,1]
  v_cvt_pk_bf16_f32 v192, 0, v192
  v_cvt_pk_bf16_f32 v193, 0, v193
  v_cvt_pk_bf16_f32 v194, 0, v194
  v_cvt_pk_bf16_f32 v195, 0, v195
  v_pk_mul_f32 v[192:193], v[192:193], v[116:117] op_sel:[0,1]
  v_pk_mul_f32 v[194:195], v[194:195], v[116:117] op_sel:[0,1]
  v_cvt_pk_bf16_f32 v205, v192, 0
  v_cvt_pk_bf16_f32 v209, v193, 0
  v_cvt_pk_bf16_f32 v213, v194, 0
  v_cvt_pk_bf16_f32 v217, v195, 0
  v_mfma_f32_16x16x16_bf16 v[128:131], v[184:185], v[204:205], v[128:131]
  v_mfma_f32_16x16x16_bf16 v[128:131], v[186:187], v[208:209], v[128:131]
  v_mfma_f32_16x16x16_bf16 v[128:131], v[188:189], v[212:213], v[128:131]
  v_mfma_f32_16x16x16_bf16 v[128:131], v[190:191], v[216:217], v[128:131]
  s_waitcnt vmcnt(14)
  buffer_load_dwordx4 v[56:59], v93, s[12:15], s61 offen offset:2560 nt
  v_cvt_f32_i32 v196, v84
  v_cvt_f32_i32 v197, v85
  v_cvt_f32_i32 v198, v86
  v_cvt_f32_i32 v199, v87
  v_pk_add_f32 v[196:197], v[196:197], v[116:117] op_sel_hi:[1,0] neg_lo:[0,1] neg_hi:[0,1]
  v_pk_add_f32 v[198:199], v[198:199], v[116:117] op_sel_hi:[1,0] neg_lo:[0,1] neg_hi:[0,1]
  v_cvt_pk_bf16_f32 v196, 0, v196
  v_cvt_pk_bf16_f32 v197, 0, v197
  v_cvt_pk_bf16_f32 v198, 0, v198
  v_cvt_pk_bf16_f32 v199, 0, v199
  v_pk_mul_f32 v[196:197], v[196:197], v[116:117] op_sel:[0,1]
  v_pk_mul_f32 v[198:199], v[198:199], v[116:117] op_sel:[0,1]
  v_cvt_pk_bf16_f32 v221, v196, 0
  v_cvt_pk_bf16_f32 v225, v197, 0
  v_cvt_pk_bf16_f32 v229, v198, 0
  v_cvt_pk_bf16_f32 v233, v199, 0
  v_mfma_f32_16x16x16_bf16 v[132:135], v[184:185], v[220:221], v[132:135]
  v_mfma_f32_16x16x16_bf16 v[132:135], v[186:187], v[224:225], v[132:135]
  v_mfma_f32_16x16x16_bf16 v[132:135], v[188:189], v[228:229], v[132:135]
  v_mfma_f32_16x16x16_bf16 v[132:135], v[190:191], v[232:233], v[132:135]
  s_waitcnt vmcnt(14)
  buffer_load_dwordx4 v[60:63], v93, s[12:15], s61 offen offset:2816 nt
  v_cvt_f32_i32 v200, v88
  v_cvt_f32_i32 v201, v89
  v_cvt_f32_i32 v202, v90
  v_cvt_f32_i32 v203, v91
  v_pk_add_f32 v[200:201], v[200:201], v[116:117] op_sel_hi:[1,0] neg_lo:[0,1] neg_hi:[0,1]
  v_pk_add_f32 v[202:203], v[202:203], v[116:117] op_sel_hi:[1,0] neg_lo:[0,1] neg_hi:[0,1]
  v_cvt_pk_bf16_f32 v200, 0, v200
  v_cvt_pk_bf16_f32 v201, 0, v201
  v_cvt_pk_bf16_f32 v202, 0, v202
  v_cvt_pk_bf16_f32 v203, 0, v203
  v_pk_mul_f32 v[200:201], v[200:201], v[116:117] op_sel:[0,1]
  v_pk_mul_f32 v[202:203], v[202:203], v[116:117] op_sel:[0,1]
  v_cvt_pk_bf16_f32 v237, v200, 0
  v_cvt_pk_bf16_f32 v241, v201, 0
  v_cvt_pk_bf16_f32 v245, v202, 0
  v_cvt_pk_bf16_f32 v249, v203, 0
  v_mfma_f32_16x16x16_bf16 v[136:139], v[184:185], v[236:237], v[136:139]
  v_mfma_f32_16x16x16_bf16 v[136:139], v[186:187], v[240:241], v[136:139]
  v_mfma_f32_16x16x16_bf16 v[136:139], v[188:189], v[244:245], v[136:139]
  v_mfma_f32_16x16x16_bf16 v[136:139], v[190:191], v[248:249], v[136:139]
  s_mov_b32 s60, s61
  s_cmp_ge_u32 s64, 96
  s_cbranch_scc1 L_v_done
  s_cmp_eq_u32 s89, s88
  s_cbranch_scc1 L_v0
  s_mov_b32 s88, s89
  s_and_b32 s70, s86, 15
  s_cmp_ge_u32 s70, 12
  s_cselect_b32 s70, 6208, 0
  s_bitcmp1_b32 s86, 4
  s_cselect_b32 s71, 12416, 0
  s_add_u32 s70, s70, s71
  v_mov_b32 v145, v143
  v_add_u32 v144, s70, v102
  v_add_u32 v147, s70, v103
  v_permlane32_swap_b32 v143, v145
  v_add_f32 v143, v143, v145
  v_mov_b32 v145, v143
  ds_write_b128 v144, v[128:131] offset:0
  ds_write_b128 v144, v[132:135] offset:1024
  ds_write_b128 v144, v[136:139] offset:2048
  v_permlane16_swap_b32 v143, v145
  v_add_f32 v143, v143, v145
  ds_write_b64 v147, v[142:143]
  s_waitcnt lgkmcnt(0)
  v_mov_b32 v128, 0
  v_mov_b32 v129, 0
  v_mov_b32 v130, 0
  v_mov_b32 v131, 0
  v_mov_b32 v132, 0
  v_mov_b32 v133, 0
  v_mov_b32 v134, 0
  v_mov_b32 v135, 0
  v_mov_b32 v136, 0
  v_mov_b32 v137, 0
  v_mov_b32 v138, 0
  v_mov_b32 v139, 0
  v_mov_b32 v140, 0xff800000
  v_mov_b32 v142, 0x7f800000
  v_mov_b32 v143, 0
  s_branch L_v0
L_v_done:
  s_and_b32 s70, s86, 15
  s_cmp_ge_u32 s70, 12
  s_cselect_b32 s70, 6208, 0
  s_bitcmp1_b32 s86, 4
  s_cselect_b32 s71, 12416, 0
  s_add_u32 s70, s70, s71
  v_mov_b32 v145, v143
  v_add_u32 v144, s70, v102
  v_add_u32 v147, s70, v103
  v_permlane32_swap_b32 v143, v145
  v_add_f32 v143, v143, v145
  v_mov_b32 v145, v143
  ds_write_b128 v144, v[128:131] offset:0
  ds_write_b128 v144, v[132:135] offset:1024
  ds_write_b128 v144, v[136:139] offset:2048
  v_permlane16_swap_b32 v143, v145
  v_add_f32 v143, v143, v145
  ds_write_b64 v147, v[142:143]
L_finish:
  v_mov_b32 v144, 61728
  ds_read_b128 v[168:171], v144
  ds_read_b128 v[172:175], v144 offset:16
  s_mul_i32 s70, s4, 6208
  s_lshl_b32 s71, s3, 10
  v_lshl_add_u32 v152, v0, 4, s71
  v_lshrrev_b32 v145, 4, v0
  v_lshlrev_b32 v154, 3, v145
  v_add_u32 v154, 43008, v154
  s_sub_u32 s97, 6208, s70
  v_add_u32 v153, s97, v152
  v_add_u32 v140, s70, v152
  s_sub_u32 s97, 12416, s70
  v_add_u32 v112, s97, v154
  s_add_u32 s97, s70, 6208
  v_add_u32 v113, s97, v154
  v_add_u32 v155, 18624, v154
  s_mul_i32 s70, s3, 1152
  v_lshl_add_u32 v156, v0, 4, s70
  v_lshl_add_u32 v157, v145, 4, s70
  v_mul_u32_u24 v146, 384, v145
  v_and_b32 v145, 15, v0
  v_lshl_add_u32 v146, v145, 3, v146
  s_movk_i32 s65, 0xff00
  s_mov_b32 s48, 0x10001
  s_mov_b32 s49, 0x10001
  s_mov_b32 s50, 0x0c0c0400
  s_mov_b32 s51, 0x05040100
  s_mov_b32 s64, 0
  s_waitcnt vmcnt(0) lgkmcnt(0)
  s_barrier
  ds_read2_b64 v[176:179], v154 offset1:4
  ds_read_b128 v[192:195], v152 offset:36864
  ds_read_b128 v[196:199], v152 offset:39936
  ds_read2_b64 v[180:183], v155 offset1:4
  ds_read_b128 v[200:203], v152 offset:55488
  ds_read_b128 v[204:207], v152 offset:58560
  ds_read2_b64 v[184:187], v112 offset1:4
  ds_read_b128 v[208:211], v153 offset:43072
  ds_read_b128 v[212:215], v153 offset:46144
  ds_read2_b64 v[188:191], v113 offset1:4
  ds_read_b128 v[216:219], v140 offset:43072
  ds_read_b128 v[220:223], v140 offset:46144
  v_readfirstlane_b32 s72, v168
  v_readfirstlane_b32 s73, v169
  v_readfirstlane_b32 s74, v170
  v_readfirstlane_b32 s75, v171
  v_readfirstlane_b32 s76, v172
  v_readfirstlane_b32 s77, v173
  v_readfirstlane_b32 s78, v174
  v_bfe_u32 v148, v175, 0, 8
  v_bfe_u32 v149, v175, 8, 8
  v_bfe_u32 v150, v175, 16, 8
  v_bfe_u32 v151, v175, 24, 8
  s_waitcnt lgkmcnt(9)
  v_min_f32 v144, v176, v178
  v_sub_f32 v176, v144, v176
  v_sub_f32 v178, v144, v178
  v_exp_f32 v176, v176
  v_exp_f32 v178, v178
  v_mul_f32 v145, v176, v177
  v_pk_mul_f32 v[192:193], v[192:193], v[176:177] op_sel_hi:[1,0]
  v_pk_mul_f32 v[194:195], v[194:195], v[176:177] op_sel_hi:[1,0]
  v_pk_fma_f32 v[192:193], v[196:197], v[178:179], v[192:193] op_sel_hi:[1,0,1]
  v_pk_fma_f32 v[194:195], v[198:199], v[178:179], v[194:195] op_sel_hi:[1,0,1]
  v_fma_f32 v197, v178, v179, v145
  v_mov_b32 v196, v144
  v_and_or_b32 v192, v192, s65, v148
  v_and_or_b32 v193, v193, s65, v149
  v_and_or_b32 v194, v194, s65, v150
  v_and_or_b32 v195, v195, s65, v151
  v_mov_b32 v199, v175
  buffer_store_dwordx4 v[192:195], v156, s[40:43], s72 offen sc1
  s_mov_b64 exec, s[48:49]
  buffer_store_dwordx4 v[196:199], v157, s[40:43], s72 offen offset:1024 sc1
  s_mov_b64 exec, -1
  s_waitcnt lgkmcnt(6)
  v_min_f32 v144, v180, v182
  v_sub_f32 v180, v144, v180
  v_sub_f32 v182, v144, v182
  v_exp_f32 v180, v180
  v_exp_f32 v182, v182
  v_mul_f32 v145, v180, v181
  v_pk_mul_f32 v[200:201], v[200:201], v[180:181] op_sel_hi:[1,0]
  v_pk_mul_f32 v[202:203], v[202:203], v[180:181] op_sel_hi:[1,0]
  v_pk_fma_f32 v[200:201], v[204:205], v[182:183], v[200:201] op_sel_hi:[1,0,1]
  v_pk_fma_f32 v[202:203], v[206:207], v[182:183], v[202:203] op_sel_hi:[1,0,1]
  v_fma_f32 v205, v182, v183, v145
  v_mov_b32 v204, v144
  v_and_or_b32 v200, v200, s65, v148
  v_and_or_b32 v201, v201, s65, v149
  v_and_or_b32 v202, v202, s65, v150
  v_and_or_b32 v203, v203, s65, v151
  v_mov_b32 v207, v175
  buffer_store_dwordx4 v[200:203], v156, s[40:43], s73 offen sc1
  s_mov_b64 exec, s[48:49]
  buffer_store_dwordx4 v[204:207], v157, s[40:43], s73 offen offset:1024 sc1
  s_mov_b64 exec, -1
  s_waitcnt lgkmcnt(3)
  v_min_f32 v144, v184, v186
  v_sub_f32 v184, v144, v184
  v_sub_f32 v186, v144, v186
  v_exp_f32 v184, v184
  v_exp_f32 v186, v186
  v_mul_f32 v145, v184, v185
  v_pk_mul_f32 v[208:209], v[208:209], v[184:185] op_sel_hi:[1,0]
  v_pk_mul_f32 v[210:211], v[210:211], v[184:185] op_sel_hi:[1,0]
  v_pk_fma_f32 v[208:209], v[212:213], v[186:187], v[208:209] op_sel_hi:[1,0,1]
  v_pk_fma_f32 v[210:211], v[214:215], v[186:187], v[210:211] op_sel_hi:[1,0,1]
  v_fma_f32 v213, v186, v187, v145
  v_mov_b32 v212, v144
  v_and_or_b32 v208, v208, s65, v148
  v_and_or_b32 v209, v209, s65, v149
  v_and_or_b32 v210, v210, s65, v150
  v_and_or_b32 v211, v211, s65, v151
  v_mov_b32 v215, v175
  buffer_store_dwordx4 v[208:211], v156, s[40:43], s74 offen sc1
  s_mov_b64 exec, s[48:49]
  buffer_store_dwordx4 v[212:215], v157, s[40:43], s74 offen offset:1024 sc1
  s_mov_b64 exec, -1
  buffer_load_dwordx4 v[224:227], v156, s[40:43], s75 offen sc1
  buffer_load_dwordx4 v[228:231], v157, s[40:43], s75 offen offset:1024 sc1
  buffer_load_dwordx4 v[232:235], v156, s[40:43], s76 offen sc1
  buffer_load_dwordx4 v[236:239], v157, s[40:43], s76 offen offset:1024 sc1
  buffer_load_dwordx4 v[240:243], v156, s[40:43], s77 offen sc1
  buffer_load_dwordx4 v[244:247], v157, s[40:43], s77 offen offset:1024 sc1
  s_waitcnt lgkmcnt(0)
  v_min_f32 v144, v188, v190
  v_sub_f32 v188, v144, v188
  v_sub_f32 v190, v144, v190
  v_exp_f32 v188, v188
  v_exp_f32 v190, v190
  v_mul_f32 v145, v188, v189
  v_pk_mul_f32 v[216:217], v[216:217], v[188:189] op_sel_hi:[1,0]
  v_pk_mul_f32 v[218:219], v[218:219], v[188:189] op_sel_hi:[1,0]
  v_pk_fma_f32 v[216:217], v[220:221], v[190:191], v[216:217] op_sel_hi:[1,0,1]
  v_pk_fma_f32 v[218:219], v[222:223], v[190:191], v[218:219] op_sel_hi:[1,0,1]
  v_fma_f32 v221, v190, v191, v145
  v_mov_b32 v220, v144
  s_branch L_check
L_gather:
  s_add_u32 s64, s64, 1
  s_cmp_gt_u32 s64, 200000
  s_cbranch_scc1 L_end
  s_bitcmp0_b32 s87, 0
  s_cbranch_scc1 L_have0
  buffer_load_dwordx4 v[224:227], v156, s[40:43], s75 offen sc1
  buffer_load_dwordx4 v[228:231], v157, s[40:43], s75 offen offset:1024 sc1
L_have0:
  s_bitcmp0_b32 s87, 1
  s_cbranch_scc1 L_have1
  buffer_load_dwordx4 v[232:235], v156, s[40:43], s76 offen sc1
  buffer_load_dwordx4 v[236:239], v157, s[40:43], s76 offen offset:1024 sc1
L_have1:
  s_bitcmp0_b32 s87, 2
  s_cbranch_scc1 L_have2
  buffer_load_dwordx4 v[240:243], v156, s[40:43], s77 offen sc1
  buffer_load_dwordx4 v[244:247], v157, s[40:43], s77 offen offset:1024 sc1
L_have2:
L_check:
  s_mov_b32 s87, 0
  s_waitcnt vmcnt(0)
  v_perm_b32 v144, v225, v224, s50
  v_perm_b32 v145, v227, v226, s50
  v_cmp_ne_u32 vcc, v175, v231
  v_perm_b32 v144, v145, v144, s51
  v_cmp_ne_u32 s[70:71], v175, v144
  s_nop 1
  s_or_b64 s[70:71], s[70:71], vcc
  s_cselect_b32 s70, 1, 0
  s_or_b32 s87, s87, s70
  v_perm_b32 v144, v233, v232, s50
  v_perm_b32 v145, v235, v234, s50
  v_cmp_ne_u32 vcc, v175, v239
  v_perm_b32 v144, v145, v144, s51
  v_cmp_ne_u32 s[70:71], v175, v144
  s_nop 1
  s_or_b64 s[70:71], s[70:71], vcc
  s_cselect_b32 s70, 2, 0
  s_or_b32 s87, s87, s70
  v_perm_b32 v144, v241, v240, s50
  v_perm_b32 v145, v243, v242, s50
  v_cmp_ne_u32 vcc, v175, v247
  v_perm_b32 v144, v145, v144, s51
  v_cmp_ne_u32 s[70:71], v175, v144
  s_nop 1
  s_or_b64 s[70:71], s[70:71], vcc
  s_cselect_b32 s70, 4, 0
  s_or_b32 s87, s87, s70
  s_cbranch_scc1 L_gather
  v_min_f32 v144, v220, v228
  v_min3_f32 v144, v144, v236, v244
  v_sub_f32 v220, v144, v220
  v_sub_f32 v228, v144, v228
  v_sub_f32 v236, v144, v236
  v_sub_f32 v244, v144, v244
  v_exp_f32 v220, v220
  v_exp_f32 v228, v228
  v_exp_f32 v236, v236
  v_exp_f32 v244, v244
  v_and_b32 v216, s65, v216
  v_and_b32 v217, s65, v217
  v_and_b32 v218, s65, v218
  v_and_b32 v219, s65, v219
  v_and_b32 v224, s65, v224
  v_and_b32 v225, s65, v225
  v_and_b32 v226, s65, v226
  v_and_b32 v227, s65, v227
  v_and_b32 v232, s65, v232
  v_and_b32 v233, s65, v233
  v_and_b32 v234, s65, v234
  v_and_b32 v235, s65, v235
  v_and_b32 v240, s65, v240
  v_and_b32 v241, s65, v241
  v_and_b32 v242, s65, v242
  v_and_b32 v243, s65, v243
  v_mul_f32 v221, v220, v221
  v_mul_f32 v229, v228, v229
  v_mul_f32 v237, v236, v237
  v_mul_f32 v245, v244, v245
  v_add_f32 v221, v221, v229
  v_add_f32 v237, v237, v245
  v_add_f32 v144, v221, v237
  v_rcp_f32 v144, v144
  s_lshl_b32 s70, s3, 7
  s_add_u32 s70, s70, s78
  v_pk_mul_f32 v[216:217], v[216:217], v[220:221] op_sel_hi:[1,0]
  v_pk_mul_f32 v[224:225], v[224:225], v[228:229] op_sel_hi:[1,0]
  v_pk_mul_f32 v[232:233], v[232:233], v[236:237] op_sel_hi:[1,0]
  v_pk_mul_f32 v[240:241], v[240:241], v[244:245] op_sel_hi:[1,0]
  v_pk_add_f32 v[216:217], v[216:217], v[224:225]
  v_pk_add_f32 v[232:233], v[232:233], v[240:241]
  v_pk_add_f32 v[216:217], v[216:217], v[232:233]
  v_pk_mul_f32 v[216:217], v[216:217], v[144:145] op_sel_hi:[1,0]
  v_cvt_pk_bf16_f32 v128, v216, v217
  v_pk_mul_f32 v[218:219], v[218:219], v[220:221] op_sel_hi:[1,0]
  v_pk_mul_f32 v[226:227], v[226:227], v[228:229] op_sel_hi:[1,0]
  v_pk_mul_f32 v[234:235], v[234:235], v[236:237] op_sel_hi:[1,0]
  v_pk_mul_f32 v[242:243], v[242:243], v[244:245] op_sel_hi:[1,0]
  v_pk_add_f32 v[218:219], v[218:219], v[226:227]
  v_pk_add_f32 v[234:235], v[234:235], v[242:243]
  v_pk_add_f32 v[218:219], v[218:219], v[234:235]
  v_pk_mul_f32 v[218:219], v[218:219], v[144:145] op_sel_hi:[1,0]
  v_cvt_pk_bf16_f32 v129, v218, v219
  buffer_store_dwordx2 v[128:129], v146, s[36:39], s70 offen
L_fin:
L_end:
  s_endpgm
L_helper:
  v_lshlrev_b32 v1, 2, v0
  v_add_u32 v1, 61696, v1
  v_mov_b32 v2, 0
  s_mov_b64 exec, 0xff
  ds_write_b32 v1, v2
  s_mov_b64 exec, -1
  s_waitcnt lgkmcnt(0)
  s_mov_b32 s8, s46
  s_and_b32 s9, s47, 0xffff
  s_mov_b32 s36, s44
  s_and_b32 s37, s45, 0xffff
  s_mov_b32 s16, s46
  s_and_b32 s17, s47, 0xffff
  s_mov_b32 s12, s48
  s_and_b32 s13, s49, 0xffff
  s_mov_b32 s40, s82
  s_and_b32 s41, s83, 0xffff
  s_mov_b32 s36, s58
  s_and_b32 s37, s59, 0xffff
  s_barrier
  s_memrealtime s[72:73]
  s_getpc_b64 s[54:55]
L_h_pc:
  s_add_u32 s86, s54, L_h_cp - L_h_pc
  s_addc_u32 s87, s55, 0
  s_sub_u32 s54, s54, L_h_pc - L_k
  s_subb_u32 s55, s55, 0
  s_and_b32 s54, s54, -16
  s_lshr_b32 s70, s2, 3
  s_lshl_b32 s70, s70, 10
  v_lshl_add_u32 v106, v0, 4, s70
  v_mov_b32 v107, s55
  v_add_co_u32 v106, vcc, s54, v106
  s_nop 1
  v_addc_co_u32 v107, vcc, 0, v107, vcc
  s_lshr_b32 s70, s2, 3
  s_cmp_lt_u32 s70, (L_code_end - L_k) / 1024
  s_cbranch_scc0 L_h_cta
  global_load_dwordx4 v[108:111], v[106:107], off
L_h_cta:
  s_lshr_b32 s70, s2, 4
  s_and_b32 s70, s70, 8
  s_and_b32 s71, s2, 7
  s_add_u32 s70, s70, s71
  s_lshl_b32 s70, s70, 4
  v_lshl_add_u32 v104, v0, 3, s70
  v_and_b32 v105, 31, v0
  v_lshlrev_b32 v105, 3, v105
  v_and_b32 v112, 1, v0
  v_lshlrev_b32 v112, 2, v112
  v_add_u32 v112, 61712, v112
  v_mov_b32 v113, 0
  v_lshlrev_b32 v3, 4, v0
  s_mov_b32 s76, 12
  s_mov_b32 s77, 7340032
  s_getreg_b32 s50, hwreg(HW_REG_XCC_ID)
  s_bfe_u32 s50, s50, 0x10002
  s_bfe_u32 s52, s2, 0x30003
  s_cmp_eq_u32 s52, 7
  s_cbranch_scc1 L_h_voted
  s_lshr_b32 s70, s2, 6
  s_xor_b32 s70, s70, s2
  s_and_b32 s70, s70, 3
  s_cbranch_scc1 L_h_voted
  s_cmp_eq_u32 s52, 6
  s_cbranch_scc0 L_h_probe
  s_xor_b32 s48, s50, s4
  s_and_b32 s52, s2, 3
  s_lshl2_add_u32 s52, s52, 36
  s_branch L_h_vote
L_h_probe:
  s_cmp_ge_u32 s52, 3
  s_cselect_b32 s16, s12, s8
  s_cselect_b32 s17, s13, s9
  s_cselect_b32 s70, 3, 0
  s_sub_u32 s70, s52, s70
  s_lshl_b32 s70, s70, 28
  s_add_u32 s44, s5, s4
  s_lshl_b32 s44, s44, 16
  s_add_u32 s44, s44, s70
  s_add_u32 s44, s44, 0x1c0000
  s_mul_i32 s70, s2, 0x2a95
  s_and_b32 s70, s70, 0x7f80
  s_add_u32 s44, s44, s70
  s_add_u32 s70, s44, 0x8000
  s_buffer_load_dword s58, s[16:19], s70
  s_mov_b32 s45, -1
  s_mov_b32 s46, -1
  s_mul_i32 s52, s52, 6
L_h_progp:
  s_sleep 2
  ds_read_b32 v8, v112
  s_waitcnt lgkmcnt(0)
  v_cmp_gt_u32 vcc, 1, v8
  s_nop 1
  s_cmp_lg_u32 vcc_lo, 0
  s_cbranch_scc1 L_h_progp
  s_xor_b32 s70, s44, 0
  s_memtime s[54:55]
  s_waitcnt lgkmcnt(0)
  s_buffer_load_dword s58, s[16:19], s70
  s_waitcnt lgkmcnt(0)
  s_memtime s[56:57]
  s_waitcnt lgkmcnt(0)
  s_sub_u32 s56, s56, s54
  s_min_u32 s45, s45, s56
  s_xor_b32 s70, s44, 8192
  s_memtime s[54:55]
  s_waitcnt lgkmcnt(0)
  s_buffer_load_dword s58, s[16:19], s70
  s_waitcnt lgkmcnt(0)
  s_memtime s[56:57]
  s_waitcnt lgkmcnt(0)
  s_sub_u32 s56, s56, s54
  s_min_u32 s46, s46, s56
  s_xor_b32 s70, s44, 25472
  s_memtime s[54:55]
  s_waitcnt lgkmcnt(0)
  s_buffer_load_dword s58, s[16:19], s70
  s_waitcnt lgkmcnt(0)
  s_memtime s[56:57]
  s_waitcnt lgkmcnt(0)
  s_sub_u32 s56, s56, s54
  s_min_u32 s46, s46, s56
  s_xor_b32 s70, s44, 17280
  s_memtime s[54:55]
  s_waitcnt lgkmcnt(0)
  s_buffer_load_dword s58, s[16:19], s70
  s_waitcnt lgkmcnt(0)
  s_memtime s[56:57]
  s_waitcnt lgkmcnt(0)
  s_sub_u32 s56, s56, s54
  s_min_u32 s45, s45, s56
  s_xor_b32 s70, s44, 5888
  s_memtime s[54:55]
  s_waitcnt lgkmcnt(0)
  s_buffer_load_dword s58, s[16:19], s70
  s_waitcnt lgkmcnt(0)
  s_memtime s[56:57]
  s_waitcnt lgkmcnt(0)
  s_sub_u32 s56, s56, s54
  s_min_u32 s45, s45, s56
  s_xor_b32 s70, s44, 14080
  s_memtime s[54:55]
  s_waitcnt lgkmcnt(0)
  s_buffer_load_dword s58, s[16:19], s70
  s_waitcnt lgkmcnt(0)
  s_memtime s[56:57]
  s_waitcnt lgkmcnt(0)
  s_sub_u32 s56, s56, s54
  s_min_u32 s46, s46, s56
  s_cmp_lt_u32 s46, s45
  s_cselect_b32 s48, 1, 0
  s_lshr_b32 s70, s44, 13
  s_xor_b32 s70, s70, s2
  s_xor_b32 s70, s70, s50
  s_and_b32 s70, s70, 1
  s_xor_b32 s48, s48, s70
L_h_vote:
  s_mov_b32 s49, 0
  s_lshl_b64 s[48:49], s[48:49], s52
  s_or_b32 s49, s49, 0x100000
  s_atomic_add_x2 s[48:49], s[80:81], 0
L_h_voted:
  s_waitcnt lgkmcnt(0)
  s_cmp_lg_u32 s2, 56
  s_cbranch_scc1 L_h_nonce
  s_lshl_b64 s[54:55], s[72:73], 2
  s_atomic_add_x2 s[54:55], s[80:81], 8
  s_waitcnt lgkmcnt(0)
L_h_nonce:
L_h_progv:
  s_sleep 8
  ds_read_b32 v8, v112
  s_waitcnt lgkmcnt(0)
  v_cmp_gt_u32 vcc, 6, v8
  s_nop 1
  s_cmp_lg_u32 vcc_lo, 0
  s_cbranch_scc1 L_h_progv
  s_load_dwordx2 s[48:49], s[80:81], 0
  s_mov_b32 s59, 0
L_h_votes:
  s_waitcnt lgkmcnt(0)
  s_lshr_b32 s70, s49, 20
  s_cmp_ge_u32 s70, 56
  s_cbranch_scc1 L_h_votes_done
  s_add_u32 s59, s59, 1
  s_cmp_gt_u32 s59, 8000
  s_cbranch_scc1 L_h_votes_done
  s_sleep 64
  s_mov_b64 s[48:49], 0
  s_atomic_or_x2 s[48:49], s[80:81], 0 glc
  s_branch L_h_votes
L_h_votes_done:
  s_mov_b32 s96, 0x80
  s_bfe_u64 s[54:55], s[48:49], 0x60000
  s_cmp_gt_u32 s54, 4
  s_cselect_b32 s56, 1, 0
  s_or_b32 s96, s96, s56
  s_bfe_u64 s[54:55], s[48:49], 0x60006
  s_cmp_gt_u32 s54, 4
  s_cselect_b32 s56, 2, 0
  s_or_b32 s96, s96, s56
  s_bfe_u64 s[54:55], s[48:49], 0x6000c
  s_cmp_gt_u32 s54, 4
  s_cselect_b32 s56, 4, 0
  s_or_b32 s96, s96, s56
  s_bfe_u64 s[54:55], s[48:49], 0x60012
  s_cmp_gt_u32 s54, 4
  s_cselect_b32 s56, 8, 0
  s_or_b32 s96, s96, s56
  s_bfe_u64 s[54:55], s[48:49], 0x60018
  s_cmp_gt_u32 s54, 4
  s_cselect_b32 s56, 16, 0
  s_or_b32 s96, s96, s56
  s_bfe_u64 s[54:55], s[48:49], 0x6001e
  s_cmp_gt_u32 s54, 4
  s_cselect_b32 s56, 32, 0
  s_or_b32 s96, s96, s56
  s_and_b32 s70, s2, 3
  s_lshl2_add_u32 s70, s70, 5
  s_lshr_b32 s54, s49, s70
  s_xor_b32 s54, s54, s2
  s_xor_b32 s54, s54, s4
  s_and_b32 s54, s54, 1
  s_mul_i32 s54, s54, 63
  s_xor_b32 s96, s96, s54
  v_mov_b32 v1, 61696
  v_mov_b32 v5, s96
  ds_write_b32 v1, v5
  s_load_dwordx2 s[74:75], s[80:81], 8
  s_mov_b32 s59, 0
L_h_getnonce:
  s_waitcnt lgkmcnt(0)
  s_cmp_lg_u64 s[74:75], 0
  s_cbranch_scc1 L_h_gotnonce
  s_add_u32 s59, s59, 1
  s_cmp_gt_u32 s59, 8000
  s_cbranch_scc1 L_h_gotnonce
  s_sleep 64
  s_atomic_or_x2 s[74:75], s[80:81], 8 glc
  s_branch L_h_getnonce
L_h_gotnonce:
  s_lshr_b64 s[54:55], s[74:75], 2
  v_writelane_b32 v8, s54, 7
  s_lshr_b32 s64, s5, 5
  s_mov_b32 s50, 0xaaaaaaab
  s_add_u32 s54, s64, 0
  s_mul_hi_u32 s56, s54, s50
  s_lshr_b32 s56, s56, 1
  s_mul_i32 s56, s56, 3
  s_sub_u32 s54, s54, s56
  s_lshr_b32 s56, s96, s54
  s_bfe_u32 s56, s56, 0x10003
  s_lshl_b32 s54, s54, 7
  s_add_u32 s54, s54, s64
  s_mul_hi_u32 s54, s54, s50
  s_lshr_b32 s54, s54, 1
  s_lshl3_add_u32 s54, s54, s56
  s_mul_i32 s70, s54, 3456
  s_add_u32 s70, s70, 1048576
  v_writelane_b32 v8, s70, 0
  s_add_u32 s54, s64, 4
  s_mul_hi_u32 s56, s54, s50
  s_lshr_b32 s56, s56, 1
  s_mul_i32 s56, s56, 3
  s_sub_u32 s54, s54, s56
  s_lshr_b32 s56, s96, s54
  s_bfe_u32 s56, s56, 0x10003
  s_lshl_b32 s54, s54, 7
  s_add_u32 s54, s54, s64
  s_mul_hi_u32 s54, s54, s50
  s_lshr_b32 s54, s54, 1
  s_lshl3_add_u32 s54, s54, s56
  s_add_u32 s54, s54, 6
  s_mul_i32 s70, s54, 3456
  s_add_u32 s70, s70, 1048576
  v_writelane_b32 v8, s70, 1
  s_add_u32 s54, s64, 2
  s_mul_hi_u32 s56, s54, s50
  s_lshr_b32 s56, s56, 1
  s_mul_i32 s56, s56, 3
  s_sub_u32 s54, s54, s56
  s_lshr_b32 s56, s96, s54
  s_bfe_u32 s56, s56, 0x10003
  s_lshl_b32 s54, s54, 7
  s_add_u32 s54, s54, s64
  s_mul_hi_u32 s54, s54, s50
  s_lshr_b32 s54, s54, 1
  s_lshl3_add_u32 s54, s54, s56
  s_lshl_b32 s56, s4, 1
  s_sub_u32 s57, s54, s56
  s_add_u32 s57, s57, 4
  s_mul_i32 s70, s57, 3456
  s_add_u32 s70, s70, 1048576
  v_writelane_b32 v8, s70, 2
  s_add_u32 s54, s54, s56
  s_add_u32 s54, s54, 2
  s_xor_b32 s56, s54, 1
  s_mul_i32 s70, s56, 3456
  s_add_u32 s70, s70, 1048576
  v_writelane_b32 v8, s70, 3
  s_andn2_b32 s56, s54, 1
  s_xor_b32 s56, s56, 2
  s_mul_i32 s70, s56, 3456
  s_add_u32 s70, s70, 1048576
  v_writelane_b32 v8, s70, 4
  s_add_u32 s56, s56, 1
  s_mul_i32 s70, s56, 3456
  s_add_u32 s70, s70, 1048576
  v_writelane_b32 v8, s70, 5
  s_lshr_b32 s54, s54, 2
  s_mul_i32 s54, s54, 1536
  v_writelane_b32 v8, s54, 6
  v_lshlrev_b32 v1, 2, v0
  s_mov_b64 exec, 0xff
  ds_write_b32 v1, v8 offset:61728
  s_mov_b64 exec, -1
  s_lshl_b32 s62, s2, 8
  s_add_u32 s62, s62, 7405568
  s_xor_b32 s63, s62, 1024
  s_lshr_b32 s58, s96, 3
  s_xor_b32 s58, s58, s96
  s_lshr_b32 s70, s5, 4
  s_lshr_b32 s44, s70, 5
  s_lshl_b32 s44, s44, 21
  s_add_u32 s44, s44, 8388608
  s_and_b32 s64, s70, 31
  s_add_u32 s70, s64, s4
  s_lshl_b32 s70, s70, 10
  s_add_u32 s60, s44, s70
  s_xor_b32 s61, s60, 1024
  s_mov_b32 s78, 60
  s_swappc_b64 s[84:85], s[86:87]
L_h_proga:
  s_sleep 4
  ds_read_b32 v8, v112
  s_waitcnt lgkmcnt(0)
  v_cmp_gt_u32 vcc, 64, v8
  s_nop 1
  s_cmp_lg_u32 vcc_lo, 0
  s_cbranch_scc1 L_h_proga
  ds_read_b128 v[8:11], v3 offset:0
  ds_read_b128 v[12:15], v3 offset:1024
  ds_read_b128 v[16:19], v3 offset:2048
  s_waitcnt lgkmcnt(0)
  s_xor_b32 s70, s60, 0
  buffer_store_dwordx4 v[8:11], v3, s[40:43], s70 offen sc1
  s_xor_b32 s70, s60, 32768
  buffer_store_dwordx4 v[12:15], v3, s[40:43], s70 offen sc1
  s_xor_b32 s70, s60, 65536
  buffer_store_dwordx4 v[16:19], v3, s[40:43], s70 offen sc1
  s_bitcmp0_b32 s58, 2
  s_cbranch_scc1 L_h_e0
  ds_read_b128 v[20:23], v3 offset:3072
  ds_read_b128 v[24:27], v3 offset:4096
  ds_read_b128 v[28:31], v3 offset:5120
  ds_read_b128 v[32:35], v3 offset:6144
  ds_read_b128 v[36:39], v3 offset:7168
  ds_read_b128 v[40:43], v3 offset:8192
  ds_read_b128 v[44:47], v3 offset:9216
  ds_read_b128 v[48:51], v3 offset:10240
  ds_read_b128 v[52:55], v3 offset:11264
  s_waitcnt lgkmcnt(0)
  s_xor_b32 s70, s60, 98304
  buffer_store_dwordx4 v[20:23], v3, s[40:43], s70 offen sc1
  s_xor_b32 s70, s60, 132096
  buffer_store_dwordx4 v[24:27], v3, s[40:43], s70 offen sc1
  s_xor_b32 s70, s60, 164864
  buffer_store_dwordx4 v[28:31], v3, s[40:43], s70 offen sc1
  s_xor_b32 s70, s60, 197632
  buffer_store_dwordx4 v[32:35], v3, s[40:43], s70 offen sc1
  s_xor_b32 s70, s60, 230400
  buffer_store_dwordx4 v[36:39], v3, s[40:43], s70 offen sc1
  s_xor_b32 s70, s60, 264192
  buffer_store_dwordx4 v[40:43], v3, s[40:43], s70 offen sc1
  s_xor_b32 s70, s60, 296960
  buffer_store_dwordx4 v[44:47], v3, s[40:43], s70 offen sc1
  s_xor_b32 s70, s60, 329728
  buffer_store_dwordx4 v[48:51], v3, s[40:43], s70 offen sc1
  s_xor_b32 s70, s60, 362496
  buffer_store_dwordx4 v[52:55], v3, s[40:43], s70 offen sc1
L_h_e0:
  s_bitcmp0_b32 s58, 0
  s_cbranch_scc1 L_h_e1
  ds_read_b128 v[56:59], v3 offset:12288
  ds_read_b128 v[60:63], v3 offset:13312
  ds_read_b128 v[64:67], v3 offset:14336
  ds_read_b128 v[68:71], v3 offset:15360
  ds_read_b128 v[72:75], v3 offset:16384
  ds_read_b128 v[76:79], v3 offset:17408
  ds_read_b128 v[80:83], v3 offset:18432
  ds_read_b128 v[84:87], v3 offset:19456
  ds_read_b128 v[88:91], v3 offset:20480
  ds_read_b128 v[92:95], v3 offset:21504
  ds_read_b128 v[96:99], v3 offset:22528
  ds_read_b128 v[100:103], v3 offset:23552
  s_waitcnt lgkmcnt(0)
  s_xor_b32 s70, s60, 396288
  buffer_store_dwordx4 v[56:59], v3, s[40:43], s70 offen sc1
  s_xor_b32 s70, s60, 429056
  buffer_store_dwordx4 v[60:63], v3, s[40:43], s70 offen sc1
  s_xor_b32 s70, s60, 461824
  buffer_store_dwordx4 v[64:67], v3, s[40:43], s70 offen sc1
  s_xor_b32 s70, s60, 494592
  buffer_store_dwordx4 v[68:71], v3, s[40:43], s70 offen sc1
  s_xor_b32 s70, s60, 541696
  buffer_store_dwordx4 v[72:75], v3, s[40:43], s70 offen sc1
  s_xor_b32 s70, s60, 574464
  buffer_store_dwordx4 v[76:79], v3, s[40:43], s70 offen sc1
  s_xor_b32 s70, s60, 607232
  buffer_store_dwordx4 v[80:83], v3, s[40:43], s70 offen sc1
  s_xor_b32 s70, s60, 640000
  buffer_store_dwordx4 v[84:87], v3, s[40:43], s70 offen sc1
  s_xor_b32 s70, s60, 671744
  buffer_store_dwordx4 v[88:91], v3, s[40:43], s70 offen sc1
  s_xor_b32 s70, s60, 704512
  buffer_store_dwordx4 v[92:95], v3, s[40:43], s70 offen sc1
  s_xor_b32 s70, s60, 737280
  buffer_store_dwordx4 v[96:99], v3, s[40:43], s70 offen sc1
  s_xor_b32 s70, s60, 770048
  buffer_store_dwordx4 v[100:103], v3, s[40:43], s70 offen sc1
L_h_e1:
  s_add_u32 s54, s74, 1
  v_mov_b32 v5, 0
  s_waitcnt vmcnt(0)
  v_mov_b32 v8, s54
  v_mov_b32 v9, s75
  s_mov_b64 exec, 1
  buffer_store_dwordx2 v[8:9], v5, s[40:43], s62 offen sc1
  s_mov_b32 s59, 0
L_h_flaga:
  buffer_load_dwordx2 v[10:11], v5, s[40:43], s63 offen sc1
  s_waitcnt vmcnt(0)
  v_readfirstlane_b32 s56, v10
  v_readfirstlane_b32 s57, v11
  s_nop 0
  s_sub_u32 s56, s56, s54
  s_xor_b32 s57, s57, s75
  s_lshr_b32 s56, s56, 1
  s_or_b32 s56, s56, s57
  s_cbranch_scc0 L_h_flaga_done
  s_add_u32 s59, s59, 1
  s_cmp_gt_u32 s59, 100000
  s_cbranch_scc1 L_h_flaga_done
  s_sleep 8
  s_branch L_h_flaga
L_h_flaga_done:
  s_mov_b64 exec, -1
  s_bfe_u32 s54, s96, 0x10005
  s_mul_i32 s54, s54, 384
  v_lshrrev_b32 v4, 3, v0
  v_add_u32 v5, 0, v4
  v_mul_u32_u24 v5, 21846, v5
  v_bfe_u32 v5, v5, 16, 1
  v_mul_u32_u24 v6, 384, v5
  v_sub_u32 v6, v3, v6
  v_add_u32 v6, s54, v6
  v_add_u32 v6, 0, v6
  v_add_u32 v5, s64, v5
  v_lshrrev_b32 v2, 12, v6
  v_xor_b32 v5, v5, v2
  v_lshrrev_b32 v2, 10, v6
  v_lshl_add_u32 v5, v2, 5, v5
  v_and_b32 v6, 1023, v6
  v_lshl_add_u32 v5, v5, 10, v6
  buffer_load_dwordx4 v[8:11], v5, s[40:43], s44 offen sc1
  v_add_u32 v5, 8, v4
  v_mul_u32_u24 v5, 21846, v5
  v_bfe_u32 v5, v5, 16, 1
  v_mul_u32_u24 v6, 384, v5
  v_sub_u32 v6, v3, v6
  v_add_u32 v6, s54, v6
  v_add_u32 v6, 1024, v6
  v_add_u32 v5, s64, v5
  v_lshrrev_b32 v2, 12, v6
  v_xor_b32 v5, v5, v2
  v_lshrrev_b32 v2, 10, v6
  v_lshl_add_u32 v5, v2, 5, v5
  v_and_b32 v6, 1023, v6
  v_lshl_add_u32 v5, v5, 10, v6
  buffer_load_dwordx4 v[12:15], v5, s[40:43], s44 offen sc1
  v_add_u32 v5, 16, v4
  v_mul_u32_u24 v5, 21846, v5
  v_bfe_u32 v5, v5, 16, 1
  v_mul_u32_u24 v6, 384, v5
  v_sub_u32 v6, v3, v6
  v_add_u32 v6, s54, v6
  v_add_u32 v6, 2048, v6
  v_add_u32 v5, s64, v5
  v_lshrrev_b32 v2, 12, v6
  v_xor_b32 v5, v5, v2
  v_lshrrev_b32 v2, 10, v6
  v_lshl_add_u32 v5, v2, 5, v5
  v_and_b32 v6, 1023, v6
  v_lshl_add_u32 v5, v5, 10, v6
  buffer_load_dwordx4 v[16:19], v5, s[40:43], s44 offen sc1
  s_bitcmp0_b32 s58, 2
  s_cbranch_scc1 L_h_i0
  s_xor_b32 s70, s61, 98304
  buffer_load_dwordx4 v[20:23], v3, s[40:43], s70 offen sc1
  s_xor_b32 s70, s61, 132096
  buffer_load_dwordx4 v[24:27], v3, s[40:43], s70 offen sc1
  s_xor_b32 s70, s61, 164864
  buffer_load_dwordx4 v[28:31], v3, s[40:43], s70 offen sc1
  s_xor_b32 s70, s61, 197632
  buffer_load_dwordx4 v[32:35], v3, s[40:43], s70 offen sc1
  s_xor_b32 s70, s61, 230400
  buffer_load_dwordx4 v[36:39], v3, s[40:43], s70 offen sc1
  s_xor_b32 s70, s61, 264192
  buffer_load_dwordx4 v[40:43], v3, s[40:43], s70 offen sc1
  s_xor_b32 s70, s61, 296960
  buffer_load_dwordx4 v[44:47], v3, s[40:43], s70 offen sc1
  s_xor_b32 s70, s61, 329728
  buffer_load_dwordx4 v[48:51], v3, s[40:43], s70 offen sc1
  s_xor_b32 s70, s61, 362496
  buffer_load_dwordx4 v[52:55], v3, s[40:43], s70 offen sc1
  s_waitcnt vmcnt(0)
  ds_write_b128 v3, v[20:23] offset:3072
  ds_write_b128 v3, v[24:27] offset:4096
  ds_write_b128 v3, v[28:31] offset:5120
  ds_write_b128 v3, v[32:35] offset:6144
  ds_write_b128 v3, v[36:39] offset:7168
  ds_write_b128 v3, v[40:43] offset:8192
  ds_write_b128 v3, v[44:47] offset:9216
  ds_write_b128 v3, v[48:51] offset:10240
  ds_write_b128 v3, v[52:55] offset:11264
L_h_i0:
  s_bitcmp0_b32 s58, 0
  s_cbranch_scc1 L_h_i1
  s_xor_b32 s70, s61, 396288
  buffer_load_dwordx4 v[56:59], v3, s[40:43], s70 offen sc1
  s_xor_b32 s70, s61, 429056
  buffer_load_dwordx4 v[60:63], v3, s[40:43], s70 offen sc1
  s_xor_b32 s70, s61, 461824
  buffer_load_dwordx4 v[64:67], v3, s[40:43], s70 offen sc1
  s_xor_b32 s70, s61, 494592
  buffer_load_dwordx4 v[68:71], v3, s[40:43], s70 offen sc1
  s_xor_b32 s70, s61, 541696
  buffer_load_dwordx4 v[72:75], v3, s[40:43], s70 offen sc1
  s_xor_b32 s70, s61, 574464
  buffer_load_dwordx4 v[76:79], v3, s[40:43], s70 offen sc1
  s_xor_b32 s70, s61, 607232
  buffer_load_dwordx4 v[80:83], v3, s[40:43], s70 offen sc1
  s_xor_b32 s70, s61, 640000
  buffer_load_dwordx4 v[84:87], v3, s[40:43], s70 offen sc1
  s_xor_b32 s70, s61, 671744
  buffer_load_dwordx4 v[88:91], v3, s[40:43], s70 offen sc1
  s_xor_b32 s70, s61, 704512
  buffer_load_dwordx4 v[92:95], v3, s[40:43], s70 offen sc1
  s_xor_b32 s70, s61, 737280
  buffer_load_dwordx4 v[96:99], v3, s[40:43], s70 offen sc1
  s_xor_b32 s70, s61, 770048
  buffer_load_dwordx4 v[100:103], v3, s[40:43], s70 offen sc1
  s_waitcnt vmcnt(0)
  ds_write_b128 v3, v[56:59] offset:12288
  ds_write_b128 v3, v[60:63] offset:13312
  ds_write_b128 v3, v[64:67] offset:14336
  ds_write_b128 v3, v[68:71] offset:15360
  ds_write_b128 v3, v[72:75] offset:16384
  ds_write_b128 v3, v[76:79] offset:17408
  ds_write_b128 v3, v[80:83] offset:18432
  ds_write_b128 v3, v[84:87] offset:19456
  ds_write_b128 v3, v[88:91] offset:20480
  ds_write_b128 v3, v[92:95] offset:21504
  ds_write_b128 v3, v[96:99] offset:22528
  ds_write_b128 v3, v[100:103] offset:23552
L_h_i1:
  s_waitcnt vmcnt(0)
  ds_write_b128 v3, v[8:11] offset:0
  ds_write_b128 v3, v[12:15] offset:1024
  ds_write_b128 v3, v[16:19] offset:2048
  s_bitcmp0_b32 s58, 1
  s_cselect_b32 s70, 255, 32
  v_mov_b32 v1, 61700
  v_mov_b32 v5, s70
  ds_write_b32 v1, v5
  s_mov_b32 s78, 92
  s_swappc_b64 s[84:85], s[86:87]
  s_bitcmp0_b32 s58, 1
  s_cbranch_scc1 L_h_all
L_h_progb:
  s_sleep 4
  ds_read_b32 v8, v112
  s_waitcnt lgkmcnt(0)
  v_cmp_gt_u32 vcc, 96, v8
  s_nop 1
  s_cmp_lg_u32 vcc_lo, 0
  s_cbranch_scc1 L_h_progb
  ds_read_b128 v[8:11], v3 offset:24576
  ds_read_b128 v[12:15], v3 offset:25600
  ds_read_b128 v[16:19], v3 offset:26624
  ds_read_b128 v[20:23], v3 offset:27648
  ds_read_b128 v[24:27], v3 offset:28672
  ds_read_b128 v[28:31], v3 offset:29696
  ds_read_b128 v[32:35], v3 offset:30720
  ds_read_b128 v[36:39], v3 offset:31744
  ds_read_b128 v[40:43], v3 offset:32768
  ds_read_b128 v[44:47], v3 offset:33792
  ds_read_b128 v[48:51], v3 offset:34816
  ds_read_b128 v[52:55], v3 offset:35840
  s_waitcnt lgkmcnt(0)
  s_xor_b32 s70, s60, 805888
  buffer_store_dwordx4 v[8:11], v3, s[40:43], s70 offen sc1
  s_xor_b32 s70, s60, 838656
  buffer_store_dwordx4 v[12:15], v3, s[40:43], s70 offen sc1
  s_xor_b32 s70, s60, 871424
  buffer_store_dwordx4 v[16:19], v3, s[40:43], s70 offen sc1
  s_xor_b32 s70, s60, 904192
  buffer_store_dwordx4 v[20:23], v3, s[40:43], s70 offen sc1
  s_xor_b32 s70, s60, 935936
  buffer_store_dwordx4 v[24:27], v3, s[40:43], s70 offen sc1
  s_xor_b32 s70, s60, 968704
  buffer_store_dwordx4 v[28:31], v3, s[40:43], s70 offen sc1
  s_xor_b32 s70, s60, 1001472
  buffer_store_dwordx4 v[32:35], v3, s[40:43], s70 offen sc1
  s_xor_b32 s70, s60, 1034240
  buffer_store_dwordx4 v[36:39], v3, s[40:43], s70 offen sc1
  s_xor_b32 s70, s60, 1052672
  buffer_store_dwordx4 v[40:43], v3, s[40:43], s70 offen sc1
  s_xor_b32 s70, s60, 1085440
  buffer_store_dwordx4 v[44:47], v3, s[40:43], s70 offen sc1
  s_xor_b32 s70, s60, 1118208
  buffer_store_dwordx4 v[48:51], v3, s[40:43], s70 offen sc1
  s_xor_b32 s70, s60, 1150976
  buffer_store_dwordx4 v[52:55], v3, s[40:43], s70 offen sc1
  s_add_u32 s54, s74, 2
  v_mov_b32 v5, 0
  s_waitcnt vmcnt(0)
  v_mov_b32 v8, s54
  v_mov_b32 v9, s75
  s_mov_b64 exec, 1
  buffer_store_dwordx2 v[8:9], v5, s[40:43], s62 offen sc1
  s_mov_b32 s59, 0
L_h_flagb:
  buffer_load_dwordx2 v[10:11], v5, s[40:43], s63 offen sc1
  s_waitcnt vmcnt(0)
  v_readfirstlane_b32 s56, v10
  v_readfirstlane_b32 s57, v11
  s_nop 0
  s_sub_u32 s56, s56, s54
  s_xor_b32 s57, s57, s75
  s_lshr_b32 s56, s56, 1
  s_or_b32 s56, s56, s57
  s_cbranch_scc0 L_h_flagb_done
  s_add_u32 s59, s59, 1
  s_cmp_gt_u32 s59, 100000
  s_cbranch_scc1 L_h_flagb_done
  s_sleep 8
  s_branch L_h_flagb
L_h_flagb_done:
  s_mov_b64 exec, -1
  s_xor_b32 s70, s61, 805888
  buffer_load_dwordx4 v[8:11], v3, s[40:43], s70 offen sc1
  s_xor_b32 s70, s61, 838656
  buffer_load_dwordx4 v[12:15], v3, s[40:43], s70 offen sc1
  s_xor_b32 s70, s61, 871424
  buffer_load_dwordx4 v[16:19], v3, s[40:43], s70 offen sc1
  s_xor_b32 s70, s61, 904192
  buffer_load_dwordx4 v[20:23], v3, s[40:43], s70 offen sc1
  s_xor_b32 s70, s61, 935936
  buffer_load_dwordx4 v[24:27], v3, s[40:43], s70 offen sc1
  s_xor_b32 s70, s61, 968704
  buffer_load_dwordx4 v[28:31], v3, s[40:43], s70 offen sc1
  s_xor_b32 s70, s61, 1001472
  buffer_load_dwordx4 v[32:35], v3, s[40:43], s70 offen sc1
  s_xor_b32 s70, s61, 1034240
  buffer_load_dwordx4 v[36:39], v3, s[40:43], s70 offen sc1
  s_xor_b32 s70, s61, 1052672
  buffer_load_dwordx4 v[40:43], v3, s[40:43], s70 offen sc1
  s_xor_b32 s70, s61, 1085440
  buffer_load_dwordx4 v[44:47], v3, s[40:43], s70 offen sc1
  s_xor_b32 s70, s61, 1118208
  buffer_load_dwordx4 v[48:51], v3, s[40:43], s70 offen sc1
  s_xor_b32 s70, s61, 1150976
  buffer_load_dwordx4 v[52:55], v3, s[40:43], s70 offen sc1
  s_waitcnt vmcnt(0)
  ds_write_b128 v3, v[8:11] offset:24576
  ds_write_b128 v3, v[12:15] offset:25600
  ds_write_b128 v3, v[16:19] offset:26624
  ds_write_b128 v3, v[20:23] offset:27648
  ds_write_b128 v3, v[24:27] offset:28672
  ds_write_b128 v3, v[28:31] offset:29696
  ds_write_b128 v3, v[32:35] offset:30720
  ds_write_b128 v3, v[36:39] offset:31744
  ds_write_b128 v3, v[40:43] offset:32768
  ds_write_b128 v3, v[44:47] offset:33792
  ds_write_b128 v3, v[48:51] offset:34816
  ds_write_b128 v3, v[52:55] offset:35840
  v_mov_b32 v1, 61700
  v_mov_b32 v5, 255
  ds_write_b32 v1, v5
L_h_all:
  s_mov_b32 s78, 182
  s_swappc_b64 s[84:85], s[86:87]
L_h_progt:
  s_sleep 4
  ds_read_b32 v8, v112
  s_waitcnt lgkmcnt(0)
  v_cmp_gt_u32 vcc, 188, v8
  s_nop 1
  s_cmp_lg_u32 vcc_lo, 0
  s_cbranch_scc1 L_h_progt
  v_mov_b32 v8, 255
  ds_write_b32 v112, v8 offset:8
  s_branch L_finish
L_h_cp:
  s_cmp_gt_u32 s76, s78
  s_cbranch_scc0 L_h_cpgo
  s_setpc_b64 s[84:85]
L_h_cpgo:
  ds_read_b32 v8, v112
  s_waitcnt lgkmcnt(0)
  v_cmp_gt_u32 vcc, s76, v8
  s_nop 1
  s_cmp_eq_u32 vcc_lo, 0
  s_cbranch_scc1 L_h_cpnext
L_h_first:
  s_sleep 2
  ds_read_b32 v8, v112
  s_waitcnt lgkmcnt(0)
  v_cmp_gt_u32 s[48:49], s76, v8
  s_nop 1
  s_cmp_eq_u32 s48, -1
  s_cbranch_scc1 L_h_first
  s_memrealtime s[54:55]
L_h_progm:
  s_sleep 2
  ds_read_b32 v8, v112
  s_waitcnt lgkmcnt(0)
  v_cmp_gt_u32 vcc, s76, v8
  s_nop 1
  s_cmp_lg_u32 vcc_lo, 0
  s_cbranch_scc1 L_h_progm
  s_memrealtime s[56:57]
  v_mov_b32 v114, s54
  v_mov_b32 v115, s55
  s_mov_b64 exec, s[48:49]
  s_waitcnt lgkmcnt(0)
  v_mov_b32 v114, s56
  v_mov_b32 v115, s57
  s_mov_b64 exec, -1
  s_and_b32 s70, s2, 0x78
  s_cbranch_scc1 L_h_np
  s_mov_b64 exec, 3
  buffer_store_dwordx2 v[114:115], v104, s[40:43], s77 offen sc1
  s_mov_b64 exec, -1
L_h_np:
  s_add_u32 s50, s76, 4
L_h_progc:
  s_sleep 4
  ds_read_b32 v8, v112
  s_waitcnt lgkmcnt(0)
  v_cmp_gt_u32 vcc, s50, v8
  s_nop 1
  s_cmp_lg_u32 vcc_lo, 0
  s_cbranch_scc1 L_h_progc
  buffer_load_dwordx2 v[8:9], v105, s[40:43], s77 offen
  v_mov_b32 v10, s73
  s_waitcnt vmcnt(0)
  ds_read_b32 v12, v112
  v_subrev_co_u32 v8, vcc, s72, v8
  s_nop 1
  v_subb_co_u32 v9, vcc, v9, v10, vcc
  v_lshrrev_b32 v10, 24, v8
  v_or_b32 v9, v9, v10
  v_cmp_eq_u32 vcc, 0, v9
  s_nop 1
  v_cndmask_b32 v8, 0, v8, vcc
  s_bcnt1_i32_b32 s56, vcc_lo
  s_nop 0
  v_add_u32_dpp v8, v8, v8 row_ror:8 row_mask:0xf bank_mask:0xf
  s_nop 1
  v_add_u32_dpp v8, v8, v8 row_ror:4 row_mask:0xf bank_mask:0xf
  s_nop 1
  v_add_u32_dpp v8, v8, v8 row_ror:2 row_mask:0xf bank_mask:0xf
  s_nop 1
  v_add_u32_dpp v8, v8, v8 row_ror:1 row_mask:0xf bank_mask:0xf
  s_nop 0
  v_readlane_b32 s54, v8, 0
  v_readlane_b32 s70, v8, 16
  v_subrev_u32 v8, s72, v114
  v_mul_lo_u32 v8, v8, s56
  s_add_u32 s54, s54, s70
  s_max_u32 s56, s56, 1
  v_subrev_u32 v8, s54, v8
  v_cvt_f32_u32 v9, s56
  v_cvt_f32_i32 v8, v8
  v_rcp_f32 v9, v9
  s_nop 0
  v_mul_f32 v8, v8, v9
  v_cvt_i32_f32 v8, v8
  s_waitcnt lgkmcnt(0)
  v_add_u32 v12, 2, v12
  v_min_u32 v9, v113, v12
  v_subrev_u32 v9, s76, v9
  v_max_i32 v9, 0, v9
  v_lshrrev_b32 v9, 1, v9
  v_mul_u32_u24 v9, 28, v9
  v_sub_u32 v8, v8, v9
  v_add_u32 v9, 14, v8
  v_max_i32 v9, 0, v9
  v_min_i32 v9, 2000, v9
  v_mul_u32_u24 v9, 2340, v9
  v_lshrrev_b32 v9, 16, v9
  v_cmp_ne_u32 vcc, 0, v9
  v_lshl_add_u32 v9, v9, 1, v12
  s_nop 0
  v_cndmask_b32 v113, 0, v9, vcc
  ds_write_b32 v112, v113 offset:8
L_h_cpnext:
  s_add_u32 s76, s76, 8
  s_add_u32 s77, s77, 256
  s_branch L_h_cp
L_code_end:
.section .rodata,"a"
.p2align 6
.amdhsa_kernel standalone__kv_cache_quant_int4_int2_kv_with_per_channel_or_per_token_scales__sampling_kernel
  .amdhsa_next_free_vgpr 256
  .amdhsa_next_free_sgpr 102
  .amdhsa_accum_offset 256
  .amdhsa_group_segment_fixed_size 0
  .amdhsa_kernarg_size 80
  .amdhsa_user_sgpr_count 2
  .amdhsa_user_sgpr_kernarg_segment_ptr 1
  .amdhsa_system_sgpr_workgroup_id_x 1
  .amdhsa_float_denorm_mode_32 3
.end_amdhsa_kernel
```

```asm
; @launch grid=(256,1,1) block=(192,1,1) lds=62464
.amdgcn_target "amdgcn-amd-amdhsa--gfx950"
.text
.globl standalone__kv_cache_quant_int4_int2_kv_with_per_channel_or_per_token_scales__sampling_kernel
.p2align 8
.type standalone__kv_cache_quant_int4_int2_kv_with_per_channel_or_per_token_scales__sampling_kernel,@function
standalone__kv_cache_quant_int4_int2_kv_with_per_channel_or_per_token_scales__sampling_kernel:
  s_cmp_ge_u32 s2, 256
  s_cbranch_scc1 L_end
  s_load_dwordx16 s[44:59], s[0:1], 0
  s_load_dwordx4 s[80:83], s[0:1], 64
  v_lshrrev_b32 v1, 6, v0
  v_and_b32 v0, 63, v0
  v_readfirstlane_b32 s3, v1
  s_bfe_u32 s4, s2, 0x10002
  s_lshr_b32 s5, s2, 3
  s_lshl_b32 s5, s5, 2
  s_and_b32 s70, s2, 3
  s_add_u32 s5, s5, s70
  s_lshl_b32 s5, s5, 5
  s_mov_b32 s22, 6291456
  s_mov_b32 s23, 0x20000
  s_mov_b32 s26, 6291456
  s_mov_b32 s27, 0x20000
  s_mov_b32 s30, 2097152
  s_mov_b32 s31, 0x20000
  s_mov_b32 s34, 2097152
  s_mov_b32 s35, 0x20000
  s_mov_b32 s10, 805306368
  s_mov_b32 s11, 0x20000
  s_mov_b32 s38, 393216
  s_mov_b32 s39, 0x20000
  s_mov_b32 s18, 805306368
  s_mov_b32 s19, 0x20000
  s_mov_b32 s14, 805306368
  s_mov_b32 s15, 0x20000
  s_mov_b32 s42, 33554432
  s_mov_b32 s43, 0x20000
  s_cmp_eq_u32 s3, 2
  s_cbranch_scc1 L_helper
  v_and_b32 v108, 3, v0
  v_bfe_u32 v109, v0, 2, 2
  v_lshrrev_b32 v110, 4, v0
  v_and_b32 v111, 15, v0
  v_lshlrev_b32 v144, 4, v108
  v_lshl_add_u32 v144, v110, 6, v144
  v_lshrrev_b32 v233, 1, v144
  v_and_b32 v231, 2, v109
  v_lshlrev_b32 v230, 5, v231
  v_add_u32 v230, 129, v230
  v_and_b32 v145, 1, v109
  v_lshl_add_u32 v231, v145, 2, v231
  v_mul_u32_u24 v145, 33024, v145
  v_add_u32 v232, v144, v145
  v_subrev_u32 v232, 33024, v232
  v_mul_u32_u24 v145, 384, v109
  v_add_u32 v235, v145, v233
  v_mov_b32 v105, 2147483632
  s_mov_b32 s90, 0xaaaaaaab
  s_mov_b32 s91, 0x492492
  s_movk_i32 s63, 768
  s_mov_b32 s64, s3
  s_mov_b32 s99, 8
  s_mov_b32 s96, 0
  v_lshlrev_b32 v114, 4, v0
  s_lshl1_add_u32 s70, s2, s3
  s_mul_i32 s88, s70, 4096
  s_mul_i32 s86, s70, 12288
  s_waitcnt lgkmcnt(0)
  s_mov_b32 s20, s50
  s_and_b32 s21, s51, 0xffff
  s_mov_b32 s24, s52
  s_and_b32 s25, s53, 0xffff
  s_mov_b32 s28, s54
  s_and_b32 s29, s55, 0xffff
  s_mov_b32 s32, s56
  s_and_b32 s33, s57, 0xffff
  buffer_load_dwordx4 v[128:131], v114, s[20:23], s86 offen offset:0
  buffer_load_dwordx4 v[128:131], v114, s[24:27], s86 offen offset:0
  buffer_load_dwordx4 v[128:131], v114, s[28:31], s88 offen offset:0
  buffer_load_dwordx4 v[128:131], v114, s[32:35], s88 offen offset:0
  buffer_load_dwordx4 v[128:131], v114, s[20:23], s86 offen offset:1024
  buffer_load_dwordx4 v[128:131], v114, s[24:27], s86 offen offset:1024
  buffer_load_dwordx4 v[128:131], v114, s[28:31], s88 offen offset:1024
  buffer_load_dwordx4 v[128:131], v114, s[32:35], s88 offen offset:1024
  s_mov_b32 s8, s46
  s_and_b32 s9, s47, 0xffff
  s_mov_b32 s36, s44
  s_and_b32 s37, s45, 0xffff
  s_mov_b32 s16, s46
  s_and_b32 s17, s47, 0xffff
  s_mov_b32 s12, s48
  s_and_b32 s13, s49, 0xffff
  s_mov_b32 s40, s82
  s_and_b32 s41, s83, 0xffff
  s_mov_b64 s[46:47], s[58:59]
  s_mov_b32 s56, 0x0f0f0f0f
  s_mov_b32 s57, 0x0f0f0f0f
  s_mov_b32 s58, 0xffff
  s_mov_b32 s59, 0xffff
  s_lshr_b32 s71, s64, 4
  s_andn2_b32 s71, s71, 1
  s_lshr_b32 s71, 0x12, s71
  s_and_b32 s71, s71, 3
  s_lshr_b32 s85, s96, s71
  s_andn2_b32 s70, s64, 1
  s_or_b32 s70, s70, s4
  s_cmp_lt_u32 s64, 8
  s_cselect_b32 s70, s70, s64
  s_cselect_b32 s85, s64, s85
  s_and_b32 s85, s85, 1
  s_and_b32 s70, s70, 31
  s_lshl_b32 s71, s71, 12
  s_add_u32 s70, s70, s5
  s_add_u32 s70, s70, s71
  s_mul_hi_u32 s84, s70, s90
  s_lshr_b32 s84, s84, 1
  s_mul_i32 s71, s84, 3
  s_sub_u32 s70, s70, s71
  s_lshl3_add_u32 s85, s70, s85
  s_mul_i32 s61, s84, 196608
  s_lshr_b32 s89, s84, 4
  s_lshl_b32 s70, s85, 5
  v_add_u32 v97, s70, v230
  v_mul_u32_u24 v97, 21846, v97
  v_lshrrev_b32 v97, 16, v97
  v_add_u32 v144, s85, v231
  v_lshrrev_b32 v145, v144, s91
  v_and_b32 v145, 1, v145
  v_cmp_eq_u32 s[54:55], 1, v145
  s_nop 1
  s_and_b64 s[52:53], s[54:55], s[56:57]
  s_andn2_b64 s[54:55], s[54:55], s[56:57]
  v_mul_u32_u24 v144, 43, v144
  v_lshrrev_b32 v144, 8, v144
  v_mul_u32_u24 v144, 384, v144
  v_add_u32 v234, v144, v233
  v_mad_u32_u24 v92, v97, s63, v232
  v_add_u32 v93, 768, v92
  v_add_u32 v94, 4608, v92
  v_add_u32 v95, 7680, v92
  v_cndmask_b32 v92, v92, v105, s[52:53]
  v_cndmask_b32 v95, v95, v105, s[54:55]
  s_mov_b32 s60, s61
  s_mul_i32 s70, s89, 1536
  buffer_load_dwordx2 v[174:175], v235, s[36:39], s70 offen offset:0
  buffer_load_dwordx2 v[176:177], v235, s[36:39], s70 offen offset:128
  buffer_load_dwordx2 v[178:179], v235, s[36:39], s70 offen offset:256
  buffer_load_dwordx4 v[4:7], v92, s[8:11], s60 offen offset:0 nt
  buffer_load_dwordx4 v[128:131], v114, s[20:23], s86 offen offset:2048
  buffer_load_dwordx4 v[128:131], v114, s[24:27], s86 offen offset:2048
  buffer_load_dwordx4 v[128:131], v114, s[28:31], s88 offen offset:2048
  buffer_load_dwordx4 v[128:131], v114, s[32:35], s88 offen offset:2048
  buffer_load_dwordx4 v[128:131], v114, s[20:23], s86 offen offset:3072
  buffer_load_dwordx4 v[128:131], v114, s[24:27], s86 offen offset:3072
  buffer_load_dwordx4 v[128:131], v114, s[28:31], s88 offen offset:3072
  buffer_load_dwordx4 v[128:131], v114, s[32:35], s88 offen offset:3072
  s_barrier
  s_mov_b64 vcc, 0
  v_lshlrev_b32 v144, 4, v111
  v_and_b32 v2, 2, v110
  v_lshlrev_b32 v1, 5, v2
  v_add_u32 v1, 129, v1
  v_and_b32 v145, 1, v110
  v_lshl_add_u32 v2, v145, 2, v2
  v_mul_u32_u24 v145, 33024, v145
  v_add_u32 v3, v144, v145
  v_subrev_u32 v3, 33024, v3
  v_and_b32 v145, 1, v110
  v_mul_u32_u24 v145, 86, v145
  v_lshl_add_u32 v96, v111, 1, v145
  v_subrev_u32 v96, 86, v96
  v_lshlrev_b32 v101, 4, v110
  v_lshrrev_b32 v144, 2, v0
  s_mul_i32 s70, s3, 384
  v_lshl_add_u32 v99, v144, 4, s70
  v_lshl_add_u32 v100, v144, 3, s70
  s_mul_i32 s70, s3, 3072
  s_add_u32 s70, s70, 36864
  v_lshl_add_u32 v102, v0, 4, s70
  s_lshl_b32 s70, s3, 5
  s_add_u32 s70, s70, 43008
  v_lshl_add_u32 v103, v109, 3, s70
  s_lshl2_add_u32 s70, s3, 61712
  v_mov_b32 v104, s70
  v_mov_b32 v112, 0
  v_mov_b32 v113, 0
  v_mov_b32 v236, 0xff800000
  v_mov_b32 v146, 1
  s_mov_b32 s65, 0xffff0000
  s_mov_b32 s66, 0x3fb8aa3b
  s_mov_b32 s68, 0x3d93cd3a
  s_mov_b32 s69, 0x3d93cd3a
  s_mov_b32 s72, 0x11111111
  s_mov_b32 s73, 0x11111111
  s_mov_b32 s74, 0x22222222
  s_mov_b32 s75, 0x22222222
  s_mov_b32 s76, 0x44444444
  s_mov_b32 s77, 0x44444444
  s_mov_b32 s78, 0x88888888
  s_mov_b32 s79, 0x88888888
  s_add_u32 s86, s86, 4096
  s_waitcnt vmcnt(15)
  buffer_load_dwordx4 v[128:131], v114, s[20:23], s86 offen offset:0
  s_waitcnt vmcnt(15)
  buffer_load_dwordx4 v[128:131], v114, s[24:27], s86 offen offset:0
  s_waitcnt vmcnt(15)
  buffer_load_dwordx4 v[128:131], v114, s[20:23], s86 offen offset:1024
  s_waitcnt vmcnt(15)
  buffer_load_dwordx4 v[128:131], v114, s[24:27], s86 offen offset:1024
  s_waitcnt vmcnt(15)
  buffer_load_dwordx4 v[128:131], v114, s[20:23], s86 offen offset:2048
  s_waitcnt vmcnt(15)
  buffer_load_dwordx4 v[128:131], v114, s[24:27], s86 offen offset:2048
  s_waitcnt vmcnt(15)
  buffer_load_dwordx4 v[128:131], v114, s[20:23], s86 offen offset:3072
  s_waitcnt vmcnt(15)
  buffer_load_dwordx4 v[128:131], v114, s[24:27], s86 offen offset:3072
  s_add_u32 s86, s86, 4096
  s_waitcnt vmcnt(15)
  buffer_load_dwordx4 v[128:131], v114, s[20:23], s86 offen offset:0
  s_waitcnt vmcnt(15)
  buffer_load_dwordx4 v[128:131], v114, s[24:27], s86 offen offset:0
  s_waitcnt vmcnt(15)
  buffer_load_dwordx4 v[128:131], v114, s[20:23], s86 offen offset:1024
  s_waitcnt vmcnt(15)
  buffer_load_dwordx4 v[128:131], v114, s[24:27], s86 offen offset:1024
  s_waitcnt vmcnt(15)
  buffer_load_dwordx4 v[128:131], v114, s[20:23], s86 offen offset:2048
  s_waitcnt vmcnt(15)
  buffer_load_dwordx4 v[128:131], v114, s[24:27], s86 offen offset:2048
  s_waitcnt vmcnt(15)
  buffer_load_dwordx4 v[128:131], v114, s[20:23], s86 offen offset:3072
  s_waitcnt vmcnt(15)
  buffer_load_dwordx4 v[128:131], v114, s[24:27], s86 offen offset:3072
  s_mov_b32 s88, s89
  s_mul_i32 s62, s84, 1536
  buffer_load_dwordx2 v[180:181], v234, s[20:23], s62 offen offset:0
  buffer_load_dwordx2 v[186:187], v234, s[24:27], s62 offen offset:0
  buffer_load_dwordx2 v[182:183], v234, s[20:23], s62 offen offset:128
  buffer_load_dwordx2 v[188:189], v234, s[24:27], s62 offen offset:128
  buffer_load_dwordx2 v[184:185], v234, s[20:23], s62 offen offset:256
  buffer_load_dwordx2 v[190:191], v234, s[24:27], s62 offen offset:256
  s_waitcnt vmcnt(15)
  buffer_load_dwordx4 v[8:11], v92, s[8:11], s60 offen offset:256 nt
  s_waitcnt vmcnt(15)
  buffer_load_dwordx4 v[12:15], v92, s[8:11], s60 offen offset:512 nt
  s_waitcnt vmcnt(15)
  buffer_load_dwordx4 v[16:19], v93, s[8:11], s60 offen offset:0 nt
  s_waitcnt vmcnt(15)
  buffer_load_dwordx4 v[20:23], v93, s[8:11], s60 offen offset:256 nt
  s_waitcnt vmcnt(15)
  buffer_load_dwordx4 v[24:27], v93, s[8:11], s60 offen offset:512 nt
  s_waitcnt vmcnt(15)
  buffer_load_dwordx4 v[28:31], v93, s[8:11], s60 offen offset:768 nt
  s_waitcnt vmcnt(15)
  buffer_load_dwordx4 v[32:35], v93, s[8:11], s60 offen offset:1024 nt
  s_waitcnt vmcnt(15)
  buffer_load_dwordx4 v[36:39], v93, s[8:11], s60 offen offset:1280 nt
  s_waitcnt vmcnt(15)
  buffer_load_dwordx4 v[40:43], v93, s[8:11], s60 offen offset:1536 nt
  s_waitcnt vmcnt(15)
  buffer_load_dwordx4 v[44:47], v93, s[8:11], s60 offen offset:1792 nt
  s_waitcnt vmcnt(16)
  buffer_load_dwordx4 v[48:51], v93, s[8:11], s60 offen offset:2048 nt
  s_waitcnt vmcnt(17)
  buffer_load_dwordx4 v[52:55], v93, s[8:11], s60 offen offset:2304 nt
  s_waitcnt vmcnt(18)
  buffer_load_dwordx4 v[56:59], v93, s[8:11], s60 offen offset:2560 nt
  s_waitcnt vmcnt(19)
  buffer_load_dwordx4 v[60:63], v93, s[8:11], s60 offen offset:2816 nt
  s_waitcnt vmcnt(14)
  ds_write_b32 v104, v146
L_k:
  v_add_u32 v144, s85, v2
  v_lshrrev_b32 v145, v144, s91
  v_and_b32 v145, 1, v145
  v_cmp_eq_u32 s[50:51], 1, v145
  s_nop 1
  s_and_b64 s[48:49], s[50:51], s[58:59]
  s_andn2_b64 s[50:51], s[50:51], s[58:59]
  s_mov_b32 s97, s64
  s_add_u32 s64, s64, 2
  ds_read_b32 v106, v104 offset:8
  s_waitcnt vmcnt(14)
  s_cbranch_vccnz L_kw0_0
  s_waitcnt vmcnt(9)
L_kw0_0:
  buffer_load_dwordx4 v[64:67], v93, s[8:11], s60 offen offset:3072 nt
  v_lshlrev_b32 v204, 16, v186
  v_and_b32 v205, s65, v186
  v_lshlrev_b32 v206, 16, v187
  v_and_b32 v207, s65, v187
  v_lshlrev_b32 v192, 16, v180
  v_and_b32 v193, s65, v180
  v_lshlrev_b32 v194, 16, v181
  v_and_b32 v195, s65, v181
  v_mov_b32 v168, v174
  v_mov_b32 v169, v175
  v_cvt_f32_i32 v108, v4
  v_cvt_f32_i32 v109, v5
  v_cvt_f32_i32 v110, v6
  v_cvt_f32_i32 v111, v7
  v_pk_add_f32 v[108:109], v[108:109], v[204:205] neg_lo:[0,1] neg_hi:[0,1]
  v_pk_add_f32 v[110:111], v[110:111], v[206:207] neg_lo:[0,1] neg_hi:[0,1]
  v_cvt_pk_bf16_f32 v108, 0, v108
  v_cvt_pk_bf16_f32 v109, 0, v109
  v_cvt_pk_bf16_f32 v110, 0, v110
  v_cvt_pk_bf16_f32 v111, 0, v111
  v_pk_mul_f32 v[108:109], v[108:109], v[192:193]
  v_pk_mul_f32 v[110:111], v[110:111], v[194:195]
  v_cvt_pk_bf16_f32 v216, v108, v109
  v_cvt_pk_bf16_f32 v217, v110, v111
  s_waitcnt lgkmcnt(0)
  v_cmp_lt_u32 vcc, s97, v106
  s_waitcnt vmcnt(14)
  buffer_load_dwordx4 v[68:71], v93, s[8:11], s60 offen offset:3328 nt
  v_lshlrev_b32 v208, 16, v188
  v_and_b32 v209, s65, v188
  v_lshlrev_b32 v210, 16, v189
  v_and_b32 v211, s65, v189
  v_lshlrev_b32 v196, 16, v182
  v_and_b32 v197, s65, v182
  v_lshlrev_b32 v198, 16, v183
  v_and_b32 v199, s65, v183
  v_mov_b32 v170, v176
  v_mov_b32 v171, v177
  v_cvt_f32_i32 v108, v8
  v_cvt_f32_i32 v109, v9
  v_cvt_f32_i32 v110, v10
  v_cvt_f32_i32 v111, v11
  v_pk_add_f32 v[108:109], v[108:109], v[208:209] neg_lo:[0,1] neg_hi:[0,1]
  v_pk_add_f32 v[110:111], v[110:111], v[210:211] neg_lo:[0,1] neg_hi:[0,1]
  v_cvt_pk_bf16_f32 v108, 0, v108
  v_cvt_pk_bf16_f32 v109, 0, v109
  v_cvt_pk_bf16_f32 v110, 0, v110
  v_cvt_pk_bf16_f32 v111, 0, v111
  v_pk_mul_f32 v[108:109], v[108:109], v[196:197]
  v_pk_mul_f32 v[110:111], v[110:111], v[198:199]
  v_cvt_pk_bf16_f32 v218, v108, v109
  v_cvt_pk_bf16_f32 v219, v110, v111
  s_waitcnt vmcnt(14)
  buffer_load_dwordx4 v[72:75], v93, s[8:11], s60 offen offset:3584 nt
  v_mfma_f32_16x16x32_bf16 v[224:227], v[216:219], v[168:171], 0
  v_lshlrev_b32 v212, 16, v190
  v_and_b32 v213, s65, v190
  v_lshlrev_b32 v214, 16, v191
  v_and_b32 v215, s65, v191
  v_lshlrev_b32 v200, 16, v184
  v_and_b32 v201, s65, v184
  v_lshlrev_b32 v202, 16, v185
  v_and_b32 v203, s65, v185
  v_mov_b32 v172, v178
  v_mov_b32 v173, v179
  v_cvt_f32_i32 v108, v12
  v_cvt_f32_i32 v109, v13
  v_cvt_f32_i32 v110, v14
  v_cvt_f32_i32 v111, v15
  v_pk_add_f32 v[108:109], v[108:109], v[212:213] neg_lo:[0,1] neg_hi:[0,1]
  v_pk_add_f32 v[110:111], v[110:111], v[214:215] neg_lo:[0,1] neg_hi:[0,1]
  v_cvt_pk_bf16_f32 v108, 0, v108
  v_cvt_pk_bf16_f32 v109, 0, v109
  v_cvt_pk_bf16_f32 v110, 0, v110
  v_cvt_pk_bf16_f32 v111, 0, v111
  v_pk_mul_f32 v[108:109], v[108:109], v[200:201]
  v_pk_mul_f32 v[110:111], v[110:111], v[202:203]
  v_cvt_pk_bf16_f32 v220, v108, v109
  v_cvt_pk_bf16_f32 v221, v110, v111
  s_waitcnt vmcnt(14)
  s_cbranch_vccnz L_kw0_3
  s_waitcnt vmcnt(9)
L_kw0_3:
  buffer_load_dwordx4 v[76:79], v94, s[8:11], s60 offen offset:0 nt
  v_mfma_f32_16x16x16_bf16 v[224:227], v[220:221], v[172:173], v[224:227]
  v_cvt_f32_i32 v108, v16
  v_cvt_f32_i32 v109, v17
  v_cvt_f32_i32 v110, v18
  v_cvt_f32_i32 v111, v19
  v_pk_add_f32 v[108:109], v[108:109], v[204:205] neg_lo:[0,1] neg_hi:[0,1]
  v_pk_add_f32 v[110:111], v[110:111], v[206:207] neg_lo:[0,1] neg_hi:[0,1]
  v_cvt_pk_bf16_f32 v108, 0, v108
  v_cvt_pk_bf16_f32 v109, 0, v109
  v_cvt_pk_bf16_f32 v110, 0, v110
  v_cvt_pk_bf16_f32 v111, 0, v111
  v_pk_mul_f32 v[108:109], v[108:109], v[192:193]
  v_pk_mul_f32 v[110:111], v[110:111], v[194:195]
  v_cvt_pk_bf16_f32 v216, v108, v109
  v_cvt_pk_bf16_f32 v217, v110, v111
  s_waitcnt vmcnt(14)
  buffer_load_dwordx4 v[80:83], v94, s[8:11], s60 offen offset:256 nt
  v_cvt_f32_i32 v108, v20
  v_cvt_f32_i32 v109, v21
  v_cvt_f32_i32 v110, v22
  v_cvt_f32_i32 v111, v23
  v_pk_add_f32 v[108:109], v[108:109], v[208:209] neg_lo:[0,1] neg_hi:[0,1]
  v_pk_add_f32 v[110:111], v[110:111], v[210:211] neg_lo:[0,1] neg_hi:[0,1]
  v_mov_b32_dpp v144, v224 quad_perm:[0,0,0,0] row_mask:0xf bank_mask:0xf
  v_mov_b32_dpp v145, v226 quad_perm:[2,2,2,2] row_mask:0xf bank_mask:0xf
  v_cvt_pk_bf16_f32 v108, 0, v108
  v_cvt_pk_bf16_f32 v109, 0, v109
  v_add_f32_dpp v144, v225, v144 quad_perm:[1,1,1,1] row_mask:0xf bank_mask:0xf
  v_add_f32_dpp v145, v227, v145 quad_perm:[3,3,3,3] row_mask:0xf bank_mask:0xf
  v_cvt_pk_bf16_f32 v110, 0, v110
  v_cvt_pk_bf16_f32 v111, 0, v111
  v_add_f32 v228, v144, v145
  v_pk_mul_f32 v[108:109], v[108:109], v[196:197]
  v_pk_mul_f32 v[110:111], v[110:111], v[198:199]
  v_cvt_pk_bf16_f32 v218, v108, v109
  v_cvt_pk_bf16_f32 v219, v110, v111
  s_waitcnt vmcnt(14)
  buffer_load_dwordx4 v[84:87], v94, s[8:11], s60 offen offset:512 nt
  v_mfma_f32_16x16x32_bf16 v[224:227], v[216:219], v[168:171], 0
  v_cvt_f32_i32 v108, v24
  v_cvt_f32_i32 v109, v25
  v_cvt_f32_i32 v110, v26
  v_cvt_f32_i32 v111, v27
  v_pk_add_f32 v[108:109], v[108:109], v[212:213] neg_lo:[0,1] neg_hi:[0,1]
  v_pk_add_f32 v[110:111], v[110:111], v[214:215] neg_lo:[0,1] neg_hi:[0,1]
  v_cvt_pk_bf16_f32 v108, 0, v108
  v_cndmask_b32 v228, v228, v236, s[48:49]
  v_cvt_pk_bf16_f32 v109, 0, v109
  v_cvt_pk_bf16_f32 v110, 0, v110
  v_cvt_pk_bf16_f32 v111, 0, v111
  v_pk_mul_f32 v[108:109], v[108:109], v[200:201]
  v_pk_mul_f32 v[110:111], v[110:111], v[202:203]
  v_cvt_pk_bf16_f32 v220, v108, v109
  v_cvt_pk_bf16_f32 v221, v110, v111
  s_waitcnt vmcnt(14)
  s_cbranch_vccnz L_kw0_6
  s_waitcnt vmcnt(9)
L_kw0_6:
  buffer_load_dwordx4 v[88:91], v94, s[8:11], s60 offen offset:768 nt
  v_mfma_f32_16x16x16_bf16 v[224:227], v[220:221], v[172:173], v[224:227]
  v_cvt_f32_i32 v108, v28
  v_cvt_f32_i32 v109, v29
  v_cvt_f32_i32 v110, v30
  v_cvt_f32_i32 v111, v31
  v_pk_add_f32 v[108:109], v[108:109], v[204:205] neg_lo:[0,1] neg_hi:[0,1]
  v_pk_add_f32 v[110:111], v[110:111], v[206:207] neg_lo:[0,1] neg_hi:[0,1]
  v_cvt_pk_bf16_f32 v108, 0, v108
  v_cvt_pk_bf16_f32 v109, 0, v109
  v_cvt_pk_bf16_f32 v110, 0, v110
  v_cvt_pk_bf16_f32 v111, 0, v111
  v_pk_mul_f32 v[108:109], v[108:109], v[192:193]
  v_pk_mul_f32 v[110:111], v[110:111], v[194:195]
  v_cvt_pk_bf16_f32 v216, v108, v109
  v_cvt_pk_bf16_f32 v217, v110, v111
  s_waitcnt vmcnt(14)
  buffer_load_dwordx4 v[4:7], v94, s[8:11], s60 offen offset:1024 nt
  v_cvt_f32_i32 v108, v32
  v_cvt_f32_i32 v109, v33
  v_cvt_f32_i32 v110, v34
  v_cvt_f32_i32 v111, v35
  v_pk_add_f32 v[108:109], v[108:109], v[208:209] neg_lo:[0,1] neg_hi:[0,1]
  v_pk_add_f32 v[110:111], v[110:111], v[210:211] neg_lo:[0,1] neg_hi:[0,1]
  v_mov_b32_dpp v144, v224 quad_perm:[0,0,0,0] row_mask:0xf bank_mask:0xf
  v_mov_b32_dpp v145, v226 quad_perm:[2,2,2,2] row_mask:0xf bank_mask:0xf
  v_cvt_pk_bf16_f32 v108, 0, v108
  v_cvt_pk_bf16_f32 v109, 0, v109
  v_add_f32_dpp v144, v225, v144 quad_perm:[1,1,1,1] row_mask:0xf bank_mask:0xf
  v_add_f32_dpp v145, v227, v145 quad_perm:[3,3,3,3] row_mask:0xf bank_mask:0xf
  v_cvt_pk_bf16_f32 v110, 0, v110
  v_cvt_pk_bf16_f32 v111, 0, v111
  v_add_f32 v229, v144, v145
  v_pk_mul_f32 v[108:109], v[108:109], v[196:197]
  v_pk_mul_f32 v[110:111], v[110:111], v[198:199]
  v_cvt_pk_bf16_f32 v218, v108, v109
  v_cvt_pk_bf16_f32 v219, v110, v111
  s_waitcnt vmcnt(14)
  buffer_load_dwordx4 v[8:11], v94, s[8:11], s60 offen offset:1280 nt
  v_mfma_f32_16x16x32_bf16 v[224:227], v[216:219], v[168:171], 0
  v_cvt_f32_i32 v108, v36
  v_cvt_f32_i32 v109, v37
  v_cvt_f32_i32 v110, v38
  v_cvt_f32_i32 v111, v39
  v_pk_add_f32 v[108:109], v[108:109], v[212:213] neg_lo:[0,1] neg_hi:[0,1]
  v_pk_add_f32 v[110:111], v[110:111], v[214:215] neg_lo:[0,1] neg_hi:[0,1]
  v_cvt_pk_bf16_f32 v108, 0, v108
  v_cvt_pk_bf16_f32 v228, 0, v228
  v_cvt_pk_bf16_f32 v109, 0, v109
  v_cvt_pk_bf16_f32 v229, 0, v229
  v_cvt_pk_bf16_f32 v110, 0, v110
  v_pk_mul_f32 v[228:229], v[228:229], s[68:69]
  v_cvt_pk_bf16_f32 v111, 0, v111
  v_cvt_pk_bf16_f32 v120, v228, v229
  v_pk_mul_f32 v[108:109], v[108:109], v[200:201]
  v_pk_mul_f32 v[110:111], v[110:111], v[202:203]
  v_cvt_pk_bf16_f32 v220, v108, v109
  v_cvt_pk_bf16_f32 v221, v110, v111
  s_waitcnt vmcnt(14)
  s_cbranch_vccnz L_kw0_9
  s_waitcnt vmcnt(9)
L_kw0_9:
  buffer_load_dwordx4 v[12:15], v94, s[8:11], s60 offen offset:1536 nt
  v_mfma_f32_16x16x16_bf16 v[224:227], v[220:221], v[172:173], v[224:227]
  v_cvt_f32_i32 v108, v40
  v_cvt_f32_i32 v109, v41
  v_cvt_f32_i32 v110, v42
  v_cvt_f32_i32 v111, v43
  v_pk_add_f32 v[108:109], v[108:109], v[204:205] neg_lo:[0,1] neg_hi:[0,1]
  v_pk_add_f32 v[110:111], v[110:111], v[206:207] neg_lo:[0,1] neg_hi:[0,1]
  v_cvt_pk_bf16_f32 v108, 0, v108
  v_cvt_pk_bf16_f32 v109, 0, v109
  v_cvt_pk_bf16_f32 v110, 0, v110
  v_cvt_pk_bf16_f32 v111, 0, v111
  v_pk_mul_f32 v[108:109], v[108:109], v[192:193]
  v_pk_mul_f32 v[110:111], v[110:111], v[194:195]
  v_cvt_pk_bf16_f32 v216, v108, v109
  v_cvt_pk_bf16_f32 v217, v110, v111
  s_waitcnt vmcnt(14)
  buffer_load_dwordx4 v[16:19], v94, s[8:11], s60 offen offset:1792 nt
  v_cvt_f32_i32 v108, v44
  v_cvt_f32_i32 v109, v45
  v_cvt_f32_i32 v110, v46
  v_cvt_f32_i32 v111, v47
  v_pk_add_f32 v[108:109], v[108:109], v[208:209] neg_lo:[0,1] neg_hi:[0,1]
  v_pk_add_f32 v[110:111], v[110:111], v[210:211] neg_lo:[0,1] neg_hi:[0,1]
  v_mov_b32_dpp v144, v224 quad_perm:[0,0,0,0] row_mask:0xf bank_mask:0xf
  v_mov_b32_dpp v145, v226 quad_perm:[2,2,2,2] row_mask:0xf bank_mask:0xf
  v_cvt_pk_bf16_f32 v108, 0, v108
  v_cvt_pk_bf16_f32 v109, 0, v109
  v_add_f32_dpp v144, v225, v144 quad_perm:[1,1,1,1] row_mask:0xf bank_mask:0xf
  v_add_f32_dpp v145, v227, v145 quad_perm:[3,3,3,3] row_mask:0xf bank_mask:0xf
  v_cvt_pk_bf16_f32 v110, 0, v110
  v_cvt_pk_bf16_f32 v111, 0, v111
  v_add_f32 v228, v144, v145
  v_pk_mul_f32 v[108:109], v[108:109], v[196:197]
  v_pk_mul_f32 v[110:111], v[110:111], v[198:199]
  v_cvt_pk_bf16_f32 v218, v108, v109
  v_cvt_pk_bf16_f32 v219, v110, v111
  s_waitcnt vmcnt(14)
  buffer_load_dwordx4 v[20:23], v94, s[8:11], s60 offen offset:2048 nt
  v_mfma_f32_16x16x32_bf16 v[224:227], v[216:219], v[168:171], 0
  v_cvt_f32_i32 v108, v48
  v_cvt_f32_i32 v109, v49
  v_cvt_f32_i32 v110, v50
  v_cvt_f32_i32 v111, v51
  v_pk_add_f32 v[108:109], v[108:109], v[212:213] neg_lo:[0,1] neg_hi:[0,1]
  v_pk_add_f32 v[110:111], v[110:111], v[214:215] neg_lo:[0,1] neg_hi:[0,1]
  v_cvt_pk_bf16_f32 v108, 0, v108
  v_cvt_pk_bf16_f32 v109, 0, v109
  v_cvt_pk_bf16_f32 v110, 0, v110
  v_cvt_pk_bf16_f32 v111, 0, v111
  v_pk_mul_f32 v[108:109], v[108:109], v[200:201]
  v_pk_mul_f32 v[110:111], v[110:111], v[202:203]
  v_cvt_pk_bf16_f32 v220, v108, v109
  v_cvt_pk_bf16_f32 v221, v110, v111
  s_waitcnt vmcnt(14)
  s_cbranch_vccnz L_kw0_12
  s_waitcnt vmcnt(9)
L_kw0_12:
  buffer_load_dwordx4 v[24:27], v94, s[8:11], s60 offen offset:2304 nt
  v_mfma_f32_16x16x16_bf16 v[224:227], v[220:221], v[172:173], v[224:227]
  v_cvt_f32_i32 v108, v52
  v_cvt_f32_i32 v109, v53
  v_cvt_f32_i32 v110, v54
  v_cvt_f32_i32 v111, v55
  v_pk_add_f32 v[108:109], v[108:109], v[204:205] neg_lo:[0,1] neg_hi:[0,1]
  v_pk_add_f32 v[110:111], v[110:111], v[206:207] neg_lo:[0,1] neg_hi:[0,1]
  v_cvt_pk_bf16_f32 v108, 0, v108
  v_cvt_pk_bf16_f32 v109, 0, v109
  v_cvt_pk_bf16_f32 v110, 0, v110
  v_cvt_pk_bf16_f32 v111, 0, v111
  v_pk_mul_f32 v[108:109], v[108:109], v[192:193]
  v_pk_mul_f32 v[110:111], v[110:111], v[194:195]
  v_cvt_pk_bf16_f32 v216, v108, v109
  v_cvt_pk_bf16_f32 v217, v110, v111
  s_waitcnt vmcnt(14)
  buffer_load_dwordx4 v[28:31], v94, s[8:11], s60 offen offset:2560 nt
  v_cvt_f32_i32 v108, v56
  v_cvt_f32_i32 v109, v57
  v_cvt_f32_i32 v110, v58
  v_cvt_f32_i32 v111, v59
  v_pk_add_f32 v[108:109], v[108:109], v[208:209] neg_lo:[0,1] neg_hi:[0,1]
  v_pk_add_f32 v[110:111], v[110:111], v[210:211] neg_lo:[0,1] neg_hi:[0,1]
  v_mov_b32_dpp v144, v224 quad_perm:[0,0,0,0] row_mask:0xf bank_mask:0xf
  v_mov_b32_dpp v145, v226 quad_perm:[2,2,2,2] row_mask:0xf bank_mask:0xf
  v_cvt_pk_bf16_f32 v108, 0, v108
  v_cvt_pk_bf16_f32 v109, 0, v109
  v_add_f32_dpp v144, v225, v144 quad_perm:[1,1,1,1] row_mask:0xf bank_mask:0xf
  v_add_f32_dpp v145, v227, v145 quad_perm:[3,3,3,3] row_mask:0xf bank_mask:0xf
  v_cvt_pk_bf16_f32 v110, 0, v110
  v_cvt_pk_bf16_f32 v111, 0, v111
  v_add_f32 v229, v144, v145
  v_pk_mul_f32 v[108:109], v[108:109], v[196:197]
  v_pk_mul_f32 v[110:111], v[110:111], v[198:199]
  v_cvt_pk_bf16_f32 v218, v108, v109
  v_cvt_pk_bf16_f32 v219, v110, v111
  s_waitcnt vmcnt(14)
  buffer_load_dwordx4 v[32:35], v94, s[8:11], s60 offen offset:2816 nt
  v_mfma_f32_16x16x32_bf16 v[224:227], v[216:219], v[168:171], 0
  v_cvt_f32_i32 v108, v60
  v_cvt_f32_i32 v109, v61
  v_cvt_f32_i32 v110, v62
  v_cvt_f32_i32 v111, v63
  v_pk_add_f32 v[108:109], v[108:109], v[212:213] neg_lo:[0,1] neg_hi:[0,1]
  v_pk_add_f32 v[110:111], v[110:111], v[214:215] neg_lo:[0,1] neg_hi:[0,1]
  v_cvt_pk_bf16_f32 v108, 0, v108
  v_cvt_pk_bf16_f32 v228, 0, v228
  v_cvt_pk_bf16_f32 v109, 0, v109
  v_cvt_pk_bf16_f32 v229, 0, v229
  v_cvt_pk_bf16_f32 v110, 0, v110
  v_pk_mul_f32 v[228:229], v[228:229], s[68:69]
  v_cvt_pk_bf16_f32 v111, 0, v111
  v_cvt_pk_bf16_f32 v121, v228, v229
  v_pk_mul_f32 v[108:109], v[108:109], v[200:201]
  v_pk_mul_f32 v[110:111], v[110:111], v[202:203]
  v_cvt_pk_bf16_f32 v220, v108, v109
  v_cvt_pk_bf16_f32 v221, v110, v111
  s_waitcnt vmcnt(14)
  s_cbranch_vccnz L_kw0_15
  s_waitcnt vmcnt(9)
L_kw0_15:
  buffer_load_dwordx4 v[36:39], v95, s[8:11], s60 offen offset:0 nt
  v_mfma_f32_16x16x16_bf16 v[224:227], v[220:221], v[172:173], v[224:227]
  v_cvt_f32_i32 v108, v64
  v_cvt_f32_i32 v109, v65
  v_cvt_f32_i32 v110, v66
  v_cvt_f32_i32 v111, v67
  v_pk_add_f32 v[108:109], v[108:109], v[204:205] neg_lo:[0,1] neg_hi:[0,1]
  v_pk_add_f32 v[110:111], v[110:111], v[206:207] neg_lo:[0,1] neg_hi:[0,1]
  v_cvt_pk_bf16_f32 v108, 0, v108
  v_cvt_pk_bf16_f32 v109, 0, v109
  v_cvt_pk_bf16_f32 v110, 0, v110
  v_cvt_pk_bf16_f32 v111, 0, v111
  v_pk_mul_f32 v[108:109], v[108:109], v[192:193]
  v_pk_mul_f32 v[110:111], v[110:111], v[194:195]
  v_cvt_pk_bf16_f32 v216, v108, v109
  v_cvt_pk_bf16_f32 v217, v110, v111
  s_waitcnt vmcnt(14)
  buffer_load_dwordx4 v[40:43], v95, s[8:11], s60 offen offset:256 nt
  v_cvt_f32_i32 v108, v68
  v_cvt_f32_i32 v109, v69
  v_cvt_f32_i32 v110, v70
  v_cvt_f32_i32 v111, v71
  v_pk_add_f32 v[108:109], v[108:109], v[208:209] neg_lo:[0,1] neg_hi:[0,1]
  v_pk_add_f32 v[110:111], v[110:111], v[210:211] neg_lo:[0,1] neg_hi:[0,1]
  v_mov_b32_dpp v144, v224 quad_perm:[0,0,0,0] row_mask:0xf bank_mask:0xf
  v_mov_b32_dpp v145, v226 quad_perm:[2,2,2,2] row_mask:0xf bank_mask:0xf
  v_cvt_pk_bf16_f32 v108, 0, v108
  v_cvt_pk_bf16_f32 v109, 0, v109
  v_add_f32_dpp v144, v225, v144 quad_perm:[1,1,1,1] row_mask:0xf bank_mask:0xf
  v_add_f32_dpp v145, v227, v145 quad_perm:[3,3,3,3] row_mask:0xf bank_mask:0xf
  v_cvt_pk_bf16_f32 v110, 0, v110
  v_cvt_pk_bf16_f32 v111, 0, v111
  v_add_f32 v228, v144, v145
  v_pk_mul_f32 v[108:109], v[108:109], v[196:197]
  v_pk_mul_f32 v[110:111], v[110:111], v[198:199]
  v_cvt_pk_bf16_f32 v218, v108, v109
  v_cvt_pk_bf16_f32 v219, v110, v111
  s_waitcnt vmcnt(14)
  buffer_load_dwordx4 v[44:47], v95, s[8:11], s60 offen offset:512 nt
  v_mfma_f32_16x16x32_bf16 v[224:227], v[216:219], v[168:171], 0
  v_cvt_f32_i32 v108, v72
  v_cvt_f32_i32 v109, v73
  v_cvt_f32_i32 v110, v74
  v_cvt_f32_i32 v111, v75
  v_pk_add_f32 v[108:109], v[108:109], v[212:213] neg_lo:[0,1] neg_hi:[0,1]
  v_pk_add_f32 v[110:111], v[110:111], v[214:215] neg_lo:[0,1] neg_hi:[0,1]
  s_cmp_lt_u32 s64, s99
  s_cbranch_scc1 L_k_known0
L_k_spin0:
  v_mov_b32 v144, 61696
  ds_read_b32 v144, v144
  s_waitcnt lgkmcnt(0)
  v_readfirstlane_b32 s96, v144
  s_nop 1
  s_cmp_eq_u32 s96, 0
  s_cbranch_scc1 L_k_spin0
  s_mov_b32 s99, -1
L_k_known0:
  s_lshr_b32 s71, s64, 4
  s_andn2_b32 s71, s71, 1
  s_lshr_b32 s71, 0x12, s71
  s_and_b32 s71, s71, 3
  s_lshr_b32 s85, s96, s71
  s_andn2_b32 s70, s64, 1
  s_or_b32 s70, s70, s4
  s_cmp_lt_u32 s64, 8
  s_cselect_b32 s70, s70, s64
  s_cselect_b32 s85, s64, s85
  s_and_b32 s85, s85, 1
  s_and_b32 s70, s70, 31
  s_lshl_b32 s71, s71, 12
  s_add_u32 s70, s70, s5
  s_add_u32 s70, s70, s71
  s_mul_hi_u32 s84, s70, s90
  s_lshr_b32 s84, s84, 1
  s_mul_i32 s71, s84, 3
  s_sub_u32 s70, s70, s71
  s_lshl3_add_u32 s85, s70, s85
  s_mul_i32 s61, s84, 196608
  s_lshr_b32 s89, s84, 4
  s_lshl_b32 s70, s85, 5
  v_add_u32 v97, s70, v230
  v_mul_u32_u24 v97, 21846, v97
  v_lshrrev_b32 v97, 16, v97
  v_add_u32 v144, s85, v231
  v_lshrrev_b32 v145, v144, s91
  v_and_b32 v145, 1, v145
  v_cmp_eq_u32 s[54:55], 1, v145
  s_nop 1
  s_and_b64 s[52:53], s[54:55], s[56:57]
  s_andn2_b64 s[54:55], s[54:55], s[56:57]
  v_mul_u32_u24 v144, 43, v144
  v_lshrrev_b32 v144, 8, v144
  v_mul_u32_u24 v144, 384, v144
  v_add_u32 v234, v144, v233
  s_cmp_eq_u32 s89, s88
  s_cbranch_scc1 L_k_sameq0
  s_mul_i32 s70, s89, 1536
  buffer_load_dwordx2 v[174:175], v235, s[36:39], s70 offen offset:0
  buffer_load_dwordx2 v[176:177], v235, s[36:39], s70 offen offset:128
  buffer_load_dwordx2 v[178:179], v235, s[36:39], s70 offen offset:256
  s_mov_b32 s88, s89
L_k_sameq0:
  s_mul_i32 s62, s84, 1536
  buffer_load_dwordx2 v[180:181], v234, s[20:23], s62 offen offset:0
  buffer_load_dwordx2 v[186:187], v234, s[24:27], s62 offen offset:0
  buffer_load_dwordx2 v[182:183], v234, s[20:23], s62 offen offset:128
  buffer_load_dwordx2 v[188:189], v234, s[24:27], s62 offen offset:128
  buffer_load_dwordx2 v[184:185], v234, s[20:23], s62 offen offset:256
  buffer_load_dwordx2 v[190:191], v234, s[24:27], s62 offen offset:256
  v_cvt_pk_bf16_f32 v108, 0, v108
  v_cvt_pk_bf16_f32 v109, 0, v109
  v_cvt_pk_bf16_f32 v110, 0, v110
  v_cvt_pk_bf16_f32 v111, 0, v111
  v_pk_mul_f32 v[108:109], v[108:109], v[200:201]
  v_pk_mul_f32 v[110:111], v[110:111], v[202:203]
  v_cvt_pk_bf16_f32 v220, v108, v109
  v_cvt_pk_bf16_f32 v221, v110, v111
  v_mad_u32_u24 v92, v97, s63, v232
  v_add_u32 v93, 768, v92
  v_add_u32 v94, 4608, v92
  v_add_u32 v95, 7680, v92
  v_cndmask_b32 v92, v92, v105, s[52:53]
  v_cndmask_b32 v95, v95, v105, s[54:55]
  s_waitcnt vmcnt(20)
  s_cbranch_vccnz L_kw0_18
  s_waitcnt vmcnt(15)
L_kw0_18:
  buffer_load_dwordx4 v[48:51], v92, s[16:19], s61 offen offset:0 nt
  v_mfma_f32_16x16x16_bf16 v[224:227], v[220:221], v[172:173], v[224:227]
  v_cvt_f32_i32 v108, v76
  v_cvt_f32_i32 v109, v77
  v_cvt_f32_i32 v110, v78
  v_cvt_f32_i32 v111, v79
  v_pk_add_f32 v[108:109], v[108:109], v[204:205] neg_lo:[0,1] neg_hi:[0,1]
  v_pk_add_f32 v[110:111], v[110:111], v[206:207] neg_lo:[0,1] neg_hi:[0,1]
  v_cvt_pk_bf16_f32 v108, 0, v108
  v_cvt_pk_bf16_f32 v109, 0, v109
  v_cvt_pk_bf16_f32 v110, 0, v110
  v_cvt_pk_bf16_f32 v111, 0, v111
  v_pk_mul_f32 v[108:109], v[108:109], v[192:193]
  v_pk_mul_f32 v[110:111], v[110:111], v[194:195]
  v_cvt_pk_bf16_f32 v216, v108, v109
  v_cvt_pk_bf16_f32 v217, v110, v111
  s_waitcnt vmcnt(20)
  buffer_load_dwordx4 v[52:55], v92, s[16:19], s61 offen offset:256 nt
  v_cvt_f32_i32 v108, v80
  v_cvt_f32_i32 v109, v81
  v_cvt_f32_i32 v110, v82
  v_cvt_f32_i32 v111, v83
  v_pk_add_f32 v[108:109], v[108:109], v[208:209] neg_lo:[0,1] neg_hi:[0,1]
  v_pk_add_f32 v[110:111], v[110:111], v[210:211] neg_lo:[0,1] neg_hi:[0,1]
  v_mov_b32_dpp v144, v224 quad_perm:[0,0,0,0] row_mask:0xf bank_mask:0xf
  v_mov_b32_dpp v145, v226 quad_perm:[2,2,2,2] row_mask:0xf bank_mask:0xf
  v_cvt_pk_bf16_f32 v108, 0, v108
  v_cvt_pk_bf16_f32 v109, 0, v109
  v_add_f32_dpp v144, v225, v144 quad_perm:[1,1,1,1] row_mask:0xf bank_mask:0xf
  v_add_f32_dpp v145, v227, v145 quad_perm:[3,3,3,3] row_mask:0xf bank_mask:0xf
  v_cvt_pk_bf16_f32 v110, 0, v110
  v_cvt_pk_bf16_f32 v111, 0, v111
  v_add_f32 v229, v144, v145
  v_pk_mul_f32 v[108:109], v[108:109], v[196:197]
  v_pk_mul_f32 v[110:111], v[110:111], v[198:199]
  v_cvt_pk_bf16_f32 v218, v108, v109
  v_cvt_pk_bf16_f32 v219, v110, v111
  s_waitcnt vmcnt(20)
  buffer_load_dwordx4 v[56:59], v92, s[16:19], s61 offen offset:512 nt
  v_mfma_f32_16x16x32_bf16 v[224:227], v[216:219], v[168:171], 0
  v_cvt_f32_i32 v108, v84
  v_cvt_f32_i32 v109, v85
  v_cvt_f32_i32 v110, v86
  v_cvt_f32_i32 v111, v87
  v_pk_add_f32 v[108:109], v[108:109], v[212:213] neg_lo:[0,1] neg_hi:[0,1]
  v_pk_add_f32 v[110:111], v[110:111], v[214:215] neg_lo:[0,1] neg_hi:[0,1]
  v_cvt_pk_bf16_f32 v108, 0, v108
  v_cvt_pk_bf16_f32 v228, 0, v228
  v_cvt_pk_bf16_f32 v109, 0, v109
  v_cvt_pk_bf16_f32 v229, 0, v229
  v_cvt_pk_bf16_f32 v110, 0, v110
  v_pk_mul_f32 v[228:229], v[228:229], s[68:69]
  v_cvt_pk_bf16_f32 v111, 0, v111
  v_cvt_pk_bf16_f32 v122, v228, v229
  v_pk_mul_f32 v[108:109], v[108:109], v[200:201]
  v_pk_mul_f32 v[110:111], v[110:111], v[202:203]
  v_cvt_pk_bf16_f32 v220, v108, v109
  v_cvt_pk_bf16_f32 v221, v110, v111
  s_waitcnt vmcnt(20)
  s_cbranch_vccnz L_kw0_21
  s_waitcnt vmcnt(15)
L_kw0_21:
  buffer_load_dwordx4 v[60:63], v93, s[16:19], s61 offen offset:0 nt
  v_mfma_f32_16x16x16_bf16 v[224:227], v[220:221], v[172:173], v[224:227]
  v_cvt_f32_i32 v108, v88
  v_cvt_f32_i32 v109, v89
  v_cvt_f32_i32 v110, v90
  v_cvt_f32_i32 v111, v91
  v_pk_add_f32 v[108:109], v[108:109], v[204:205] neg_lo:[0,1] neg_hi:[0,1]
  v_pk_add_f32 v[110:111], v[110:111], v[206:207] neg_lo:[0,1] neg_hi:[0,1]
  v_cvt_pk_bf16_f32 v108, 0, v108
  v_cvt_pk_bf16_f32 v109, 0, v109
  v_cvt_pk_bf16_f32 v110, 0, v110
  v_cvt_pk_bf16_f32 v111, 0, v111
  v_pk_mul_f32 v[108:109], v[108:109], v[192:193]
  v_pk_mul_f32 v[110:111], v[110:111], v[194:195]
  v_cvt_pk_bf16_f32 v216, v108, v109
  v_cvt_pk_bf16_f32 v217, v110, v111
  s_waitcnt vmcnt(20)
  buffer_load_dwordx4 v[64:67], v93, s[16:19], s61 offen offset:256 nt
  v_cvt_f32_i32 v108, v4
  v_cvt_f32_i32 v109, v5
  v_cvt_f32_i32 v110, v6
  v_cvt_f32_i32 v111, v7
  v_pk_add_f32 v[108:109], v[108:109], v[208:209] neg_lo:[0,1] neg_hi:[0,1]
  v_pk_add_f32 v[110:111], v[110:111], v[210:211] neg_lo:[0,1] neg_hi:[0,1]
  v_mov_b32_dpp v144, v224 quad_perm:[0,0,0,0] row_mask:0xf bank_mask:0xf
  v_mov_b32_dpp v145, v226 quad_perm:[2,2,2,2] row_mask:0xf bank_mask:0xf
  v_cvt_pk_bf16_f32 v108, 0, v108
  v_cvt_pk_bf16_f32 v109, 0, v109
  v_add_f32_dpp v144, v225, v144 quad_perm:[1,1,1,1] row_mask:0xf bank_mask:0xf
  v_add_f32_dpp v145, v227, v145 quad_perm:[3,3,3,3] row_mask:0xf bank_mask:0xf
  v_cvt_pk_bf16_f32 v110, 0, v110
  v_cvt_pk_bf16_f32 v111, 0, v111
  v_add_f32 v228, v144, v145
  v_pk_mul_f32 v[108:109], v[108:109], v[196:197]
  v_pk_mul_f32 v[110:111], v[110:111], v[198:199]
  v_cvt_pk_bf16_f32 v218, v108, v109
  v_cvt_pk_bf16_f32 v219, v110, v111
  s_waitcnt vmcnt(20)
  buffer_load_dwordx4 v[68:71], v93, s[16:19], s61 offen offset:512 nt
  v_mfma_f32_16x16x32_bf16 v[224:227], v[216:219], v[168:171], 0
  v_cvt_f32_i32 v108, v8
  v_cvt_f32_i32 v109, v9
  v_cvt_f32_i32 v110, v10
  v_cvt_f32_i32 v111, v11
  v_pk_add_f32 v[108:109], v[108:109], v[212:213] neg_lo:[0,1] neg_hi:[0,1]
  v_pk_add_f32 v[110:111], v[110:111], v[214:215] neg_lo:[0,1] neg_hi:[0,1]
  v_cvt_pk_bf16_f32 v108, 0, v108
  v_cvt_pk_bf16_f32 v109, 0, v109
  v_cvt_pk_bf16_f32 v110, 0, v110
  v_cvt_pk_bf16_f32 v111, 0, v111
  v_pk_mul_f32 v[108:109], v[108:109], v[200:201]
  v_pk_mul_f32 v[110:111], v[110:111], v[202:203]
  v_cvt_pk_bf16_f32 v220, v108, v109
  v_cvt_pk_bf16_f32 v221, v110, v111
  s_waitcnt vmcnt(20)
  s_cbranch_vccnz L_kw0_24
  s_waitcnt vmcnt(15)
L_kw0_24:
  buffer_load_dwordx4 v[72:75], v93, s[16:19], s61 offen offset:768 nt
  v_mfma_f32_16x16x16_bf16 v[224:227], v[220:221], v[172:173], v[224:227]
  v_cvt_f32_i32 v108, v12
  v_cvt_f32_i32 v109, v13
  v_cvt_f32_i32 v110, v14
  v_cvt_f32_i32 v111, v15
  v_pk_add_f32 v[108:109], v[108:109], v[204:205] neg_lo:[0,1] neg_hi:[0,1]
  v_pk_add_f32 v[110:111], v[110:111], v[206:207] neg_lo:[0,1] neg_hi:[0,1]
  v_cvt_pk_bf16_f32 v108, 0, v108
  v_cvt_pk_bf16_f32 v109, 0, v109
  v_cvt_pk_bf16_f32 v110, 0, v110
  v_cvt_pk_bf16_f32 v111, 0, v111
  v_pk_mul_f32 v[108:109], v[108:109], v[192:193]
  v_pk_mul_f32 v[110:111], v[110:111], v[194:195]
  v_cvt_pk_bf16_f32 v216, v108, v109
  v_cvt_pk_bf16_f32 v217, v110, v111
  s_waitcnt vmcnt(20)
  buffer_load_dwordx4 v[76:79], v93, s[16:19], s61 offen offset:1024 nt
  v_cvt_f32_i32 v108, v16
  v_cvt_f32_i32 v109, v17
  v_cvt_f32_i32 v110, v18
  v_cvt_f32_i32 v111, v19
  v_pk_add_f32 v[108:109], v[108:109], v[208:209] neg_lo:[0,1] neg_hi:[0,1]
  v_pk_add_f32 v[110:111], v[110:111], v[210:211] neg_lo:[0,1] neg_hi:[0,1]
  v_mov_b32_dpp v144, v224 quad_perm:[0,0,0,0] row_mask:0xf bank_mask:0xf
  v_mov_b32_dpp v145, v226 quad_perm:[2,2,2,2] row_mask:0xf bank_mask:0xf
  v_cvt_pk_bf16_f32 v108, 0, v108
  v_cvt_pk_bf16_f32 v109, 0, v109
  v_add_f32_dpp v144, v225, v144 quad_perm:[1,1,1,1] row_mask:0xf bank_mask:0xf
  v_add_f32_dpp v145, v227, v145 quad_perm:[3,3,3,3] row_mask:0xf bank_mask:0xf
  v_cvt_pk_bf16_f32 v110, 0, v110
  v_cvt_pk_bf16_f32 v111, 0, v111
  v_add_f32 v229, v144, v145
  v_pk_mul_f32 v[108:109], v[108:109], v[196:197]
  v_pk_mul_f32 v[110:111], v[110:111], v[198:199]
  v_cvt_pk_bf16_f32 v218, v108, v109
  v_cvt_pk_bf16_f32 v219, v110, v111
  s_waitcnt vmcnt(20)
  buffer_load_dwordx4 v[80:83], v93, s[16:19], s61 offen offset:1280 nt
  v_mfma_f32_16x16x32_bf16 v[224:227], v[216:219], v[168:171], 0
  v_cvt_f32_i32 v108, v20
  v_cvt_f32_i32 v109, v21
  v_cvt_f32_i32 v110, v22
  v_cvt_f32_i32 v111, v23
  v_pk_add_f32 v[108:109], v[108:109], v[212:213] neg_lo:[0,1] neg_hi:[0,1]
  v_pk_add_f32 v[110:111], v[110:111], v[214:215] neg_lo:[0,1] neg_hi:[0,1]
  v_cvt_pk_bf16_f32 v108, 0, v108
  v_cvt_pk_bf16_f32 v228, 0, v228
  v_cvt_pk_bf16_f32 v109, 0, v109
  v_cvt_pk_bf16_f32 v229, 0, v229
  v_cvt_pk_bf16_f32 v110, 0, v110
  v_pk_mul_f32 v[228:229], v[228:229], s[68:69]
  v_cvt_pk_bf16_f32 v111, 0, v111
  v_cvt_pk_bf16_f32 v123, v228, v229
  v_pk_mul_f32 v[108:109], v[108:109], v[200:201]
  v_pk_mul_f32 v[110:111], v[110:111], v[202:203]
  v_cvt_pk_bf16_f32 v220, v108, v109
  v_cvt_pk_bf16_f32 v221, v110, v111
  s_waitcnt vmcnt(20)
  s_cbranch_vccnz L_kw0_27
  s_waitcnt vmcnt(15)
L_kw0_27:
  buffer_load_dwordx4 v[84:87], v93, s[16:19], s61 offen offset:1536 nt
  v_mfma_f32_16x16x16_bf16 v[224:227], v[220:221], v[172:173], v[224:227]
  v_cvt_f32_i32 v108, v24
  v_cvt_f32_i32 v109, v25
  v_cvt_f32_i32 v110, v26
  v_cvt_f32_i32 v111, v27
  v_pk_add_f32 v[108:109], v[108:109], v[204:205] neg_lo:[0,1] neg_hi:[0,1]
  v_pk_add_f32 v[110:111], v[110:111], v[206:207] neg_lo:[0,1] neg_hi:[0,1]
  v_cvt_pk_bf16_f32 v108, 0, v108
  v_cvt_pk_bf16_f32 v109, 0, v109
  v_cvt_pk_bf16_f32 v110, 0, v110
  v_cvt_pk_bf16_f32 v111, 0, v111
  v_pk_mul_f32 v[108:109], v[108:109], v[192:193]
  v_pk_mul_f32 v[110:111], v[110:111], v[194:195]
  v_cvt_pk_bf16_f32 v216, v108, v109
  v_cvt_pk_bf16_f32 v217, v110, v111
  s_waitcnt vmcnt(20)
  buffer_load_dwordx4 v[88:91], v93, s[16:19], s61 offen offset:1792 nt
  v_cvt_f32_i32 v108, v28
  v_cvt_f32_i32 v109, v29
  v_cvt_f32_i32 v110, v30
  v_cvt_f32_i32 v111, v31
  v_pk_add_f32 v[108:109], v[108:109], v[208:209] neg_lo:[0,1] neg_hi:[0,1]
  v_pk_add_f32 v[110:111], v[110:111], v[210:211] neg_lo:[0,1] neg_hi:[0,1]
  v_mov_b32_dpp v144, v224 quad_perm:[0,0,0,0] row_mask:0xf bank_mask:0xf
  v_mov_b32_dpp v145, v226 quad_perm:[2,2,2,2] row_mask:0xf bank_mask:0xf
  v_cvt_pk_bf16_f32 v108, 0, v108
  v_cvt_pk_bf16_f32 v109, 0, v109
  v_add_f32_dpp v144, v225, v144 quad_perm:[1,1,1,1] row_mask:0xf bank_mask:0xf
  v_add_f32_dpp v145, v227, v145 quad_perm:[3,3,3,3] row_mask:0xf bank_mask:0xf
  v_cvt_pk_bf16_f32 v110, 0, v110
  v_cvt_pk_bf16_f32 v111, 0, v111
  v_add_f32 v228, v144, v145
  v_pk_mul_f32 v[108:109], v[108:109], v[196:197]
  v_pk_mul_f32 v[110:111], v[110:111], v[198:199]
  v_cvt_pk_bf16_f32 v218, v108, v109
  v_cvt_pk_bf16_f32 v219, v110, v111
  s_waitcnt vmcnt(20)
  buffer_load_dwordx4 v[4:7], v93, s[16:19], s61 offen offset:2048 nt
  v_mfma_f32_16x16x32_bf16 v[224:227], v[216:219], v[168:171], 0
  v_cvt_f32_i32 v108, v32
  v_cvt_f32_i32 v109, v33
  v_cvt_f32_i32 v110, v34
  v_cvt_f32_i32 v111, v35
  v_pk_add_f32 v[108:109], v[108:109], v[212:213] neg_lo:[0,1] neg_hi:[0,1]
  v_pk_add_f32 v[110:111], v[110:111], v[214:215] neg_lo:[0,1] neg_hi:[0,1]
  v_cvt_pk_bf16_f32 v108, 0, v108
  v_cvt_pk_bf16_f32 v109, 0, v109
  v_cvt_pk_bf16_f32 v110, 0, v110
  v_cvt_pk_bf16_f32 v111, 0, v111
  v_pk_mul_f32 v[108:109], v[108:109], v[200:201]
  v_pk_mul_f32 v[110:111], v[110:111], v[202:203]
  v_cvt_pk_bf16_f32 v220, v108, v109
  v_cvt_pk_bf16_f32 v221, v110, v111
  s_waitcnt vmcnt(20)
  s_cbranch_vccnz L_kw0_30
  s_waitcnt vmcnt(9)
L_kw0_30:
  buffer_load_dwordx4 v[8:11], v93, s[16:19], s61 offen offset:2304 nt
  v_mfma_f32_16x16x16_bf16 v[224:227], v[220:221], v[172:173], v[224:227]
  v_cvt_f32_i32 v108, v36
  v_cvt_f32_i32 v109, v37
  v_cvt_f32_i32 v110, v38
  v_cvt_f32_i32 v111, v39
  v_pk_add_f32 v[108:109], v[108:109], v[204:205] neg_lo:[0,1] neg_hi:[0,1]
  v_pk_add_f32 v[110:111], v[110:111], v[206:207] neg_lo:[0,1] neg_hi:[0,1]
  v_cvt_pk_bf16_f32 v108, 0, v108
  v_cvt_pk_bf16_f32 v109, 0, v109
  v_cvt_pk_bf16_f32 v110, 0, v110
  v_cvt_pk_bf16_f32 v111, 0, v111
  v_pk_mul_f32 v[108:109], v[108:109], v[192:193]
  v_pk_mul_f32 v[110:111], v[110:111], v[194:195]
  v_cvt_pk_bf16_f32 v216, v108, v109
  v_cvt_pk_bf16_f32 v217, v110, v111
  s_waitcnt vmcnt(20)
  buffer_load_dwordx4 v[12:15], v93, s[16:19], s61 offen offset:2560 nt
  v_cvt_f32_i32 v108, v40
  v_cvt_f32_i32 v109, v41
  v_cvt_f32_i32 v110, v42
  v_cvt_f32_i32 v111, v43
  v_pk_add_f32 v[108:109], v[108:109], v[208:209] neg_lo:[0,1] neg_hi:[0,1]
  v_pk_add_f32 v[110:111], v[110:111], v[210:211] neg_lo:[0,1] neg_hi:[0,1]
  v_mov_b32_dpp v144, v224 quad_perm:[0,0,0,0] row_mask:0xf bank_mask:0xf
  v_mov_b32_dpp v145, v226 quad_perm:[2,2,2,2] row_mask:0xf bank_mask:0xf
  v_cvt_pk_bf16_f32 v108, 0, v108
  v_cvt_pk_bf16_f32 v109, 0, v109
  v_add_f32_dpp v144, v225, v144 quad_perm:[1,1,1,1] row_mask:0xf bank_mask:0xf
  v_add_f32_dpp v145, v227, v145 quad_perm:[3,3,3,3] row_mask:0xf bank_mask:0xf
  v_cvt_pk_bf16_f32 v110, 0, v110
  v_cvt_pk_bf16_f32 v111, 0, v111
  v_add_f32 v229, v144, v145
  v_pk_mul_f32 v[108:109], v[108:109], v[196:197]
  v_pk_mul_f32 v[110:111], v[110:111], v[198:199]
  v_cvt_pk_bf16_f32 v218, v108, v109
  v_cvt_pk_bf16_f32 v219, v110, v111
  s_waitcnt vmcnt(20)
  buffer_load_dwordx4 v[16:19], v93, s[16:19], s61 offen offset:2816 nt
  v_mfma_f32_16x16x32_bf16 v[224:227], v[216:219], v[168:171], 0
  v_cvt_f32_i32 v108, v44
  v_cvt_f32_i32 v109, v45
  v_cvt_f32_i32 v110, v46
  v_cvt_f32_i32 v111, v47
  v_pk_add_f32 v[108:109], v[108:109], v[212:213] neg_lo:[0,1] neg_hi:[0,1]
  v_pk_add_f32 v[110:111], v[110:111], v[214:215] neg_lo:[0,1] neg_hi:[0,1]
  v_cvt_pk_bf16_f32 v108, 0, v108
  v_cvt_pk_bf16_f32 v228, 0, v228
  v_cvt_pk_bf16_f32 v109, 0, v109
  v_cvt_pk_bf16_f32 v229, 0, v229
  v_cvt_pk_bf16_f32 v110, 0, v110
  v_pk_mul_f32 v[228:229], v[228:229], s[68:69]
  v_cvt_pk_bf16_f32 v111, 0, v111
  v_cvt_pk_bf16_f32 v124, v228, v229
  v_pk_mul_f32 v[108:109], v[108:109], v[200:201]
  v_pk_mul_f32 v[110:111], v[110:111], v[202:203]
  v_cvt_pk_bf16_f32 v220, v108, v109
  v_cvt_pk_bf16_f32 v221, v110, v111
  s_mov_b32 s60, s61
  v_mov_b32 v146, s64
  v_mfma_f32_16x16x16_bf16 v[224:227], v[220:221], v[172:173], v[224:227]
  ds_write_b128 v99, v[120:123]
  v_add_u32 v99, 768, v99
  s_nop 5
  v_mov_b32_dpp v144, v224 quad_perm:[0,0,0,0] row_mask:0xf bank_mask:0xf
  v_mov_b32_dpp v145, v226 quad_perm:[2,2,2,2] row_mask:0xf bank_mask:0xf
  s_nop 0
  v_add_f32_dpp v144, v225, v144 quad_perm:[1,1,1,1] row_mask:0xf bank_mask:0xf
  v_add_f32_dpp v145, v227, v145 quad_perm:[3,3,3,3] row_mask:0xf bank_mask:0xf
  v_add_f32 v228, v144, v145
  v_cndmask_b32 v228, v228, v236, s[50:51]
  v_cvt_pk_bf16_f32 v228, 0, v228
  v_cvt_pk_bf16_f32 v229, 0, v229
  v_pk_mul_f32 v[228:229], v[228:229], s[68:69]
  v_cvt_pk_bf16_f32 v125, v228, v229
  ds_write_b64 v100, v[124:125] offset:256
  ds_write_b32 v104, v146
  v_add_u32 v100, 768, v100
  v_add_u32 v144, s85, v2
  v_lshrrev_b32 v145, v144, s91
  v_and_b32 v145, 1, v145
  v_cmp_eq_u32 s[50:51], 1, v145
  s_nop 1
  s_and_b64 s[48:49], s[50:51], s[58:59]
  s_andn2_b64 s[50:51], s[50:51], s[58:59]
  s_mov_b32 s97, s64
  s_add_u32 s64, s64, 2
  ds_read_b32 v106, v104 offset:8
  s_waitcnt vmcnt(14)
  s_cbranch_vccnz L_kw1_0
  s_waitcnt vmcnt(9)
L_kw1_0:
  buffer_load_dwordx4 v[20:23], v93, s[8:11], s60 offen offset:3072 nt
  v_lshlrev_b32 v204, 16, v186
  v_and_b32 v205, s65, v186
  v_lshlrev_b32 v206, 16, v187
  v_and_b32 v207, s65, v187
  v_lshlrev_b32 v192, 16, v180
  v_and_b32 v193, s65, v180
  v_lshlrev_b32 v194, 16, v181
  v_and_b32 v195, s65, v181
  v_mov_b32 v168, v174
  v_mov_b32 v169, v175
  v_cvt_f32_i32 v108, v48
  v_cvt_f32_i32 v109, v49
  v_cvt_f32_i32 v110, v50
  v_cvt_f32_i32 v111, v51
  v_pk_add_f32 v[108:109], v[108:109], v[204:205] neg_lo:[0,1] neg_hi:[0,1]
  v_pk_add_f32 v[110:111], v[110:111], v[206:207] neg_lo:[0,1] neg_hi:[0,1]
  v_cvt_pk_bf16_f32 v108, 0, v108
  v_cvt_pk_bf16_f32 v109, 0, v109
  v_cvt_pk_bf16_f32 v110, 0, v110
  v_cvt_pk_bf16_f32 v111, 0, v111
  v_pk_mul_f32 v[108:109], v[108:109], v[192:193]
  v_pk_mul_f32 v[110:111], v[110:111], v[194:195]
  v_cvt_pk_bf16_f32 v216, v108, v109
  v_cvt_pk_bf16_f32 v217, v110, v111
  s_waitcnt lgkmcnt(0)
  v_cmp_lt_u32 vcc, s97, v106
  s_waitcnt vmcnt(14)
  buffer_load_dwordx4 v[24:27], v93, s[8:11], s60 offen offset:3328 nt
  v_lshlrev_b32 v208, 16, v188
  v_and_b32 v209, s65, v188
  v_lshlrev_b32 v210, 16, v189
  v_and_b32 v211, s65, v189
  v_lshlrev_b32 v196, 16, v182
  v_and_b32 v197, s65, v182
  v_lshlrev_b32 v198, 16, v183
  v_and_b32 v199, s65, v183
  v_mov_b32 v170, v176
  v_mov_b32 v171, v177
  v_cvt_f32_i32 v108, v52
  v_cvt_f32_i32 v109, v53
  v_cvt_f32_i32 v110, v54
  v_cvt_f32_i32 v111, v55
  v_pk_add_f32 v[108:109], v[108:109], v[208:209] neg_lo:[0,1] neg_hi:[0,1]
  v_pk_add_f32 v[110:111], v[110:111], v[210:211] neg_lo:[0,1] neg_hi:[0,1]
  v_cvt_pk_bf16_f32 v108, 0, v108
  v_cvt_pk_bf16_f32 v109, 0, v109
  v_cvt_pk_bf16_f32 v110, 0, v110
  v_cvt_pk_bf16_f32 v111, 0, v111
  v_pk_mul_f32 v[108:109], v[108:109], v[196:197]
  v_pk_mul_f32 v[110:111], v[110:111], v[198:199]
  v_cvt_pk_bf16_f32 v218, v108, v109
  v_cvt_pk_bf16_f32 v219, v110, v111
  s_waitcnt vmcnt(14)
  buffer_load_dwordx4 v[28:31], v93, s[8:11], s60 offen offset:3584 nt
  v_mfma_f32_16x16x32_bf16 v[224:227], v[216:219], v[168:171], 0
  v_lshlrev_b32 v212, 16, v190
  v_and_b32 v213, s65, v190
  v_lshlrev_b32 v214, 16, v191
  v_and_b32 v215, s65, v191
  v_lshlrev_b32 v200, 16, v184
  v_and_b32 v201, s65, v184
  v_lshlrev_b32 v202, 16, v185
  v_and_b32 v203, s65, v185
  v_mov_b32 v172, v178
  v_mov_b32 v173, v179
  v_cvt_f32_i32 v108, v56
  v_cvt_f32_i32 v109, v57
  v_cvt_f32_i32 v110, v58
  v_cvt_f32_i32 v111, v59
  v_pk_add_f32 v[108:109], v[108:109], v[212:213] neg_lo:[0,1] neg_hi:[0,1]
  v_pk_add_f32 v[110:111], v[110:111], v[214:215] neg_lo:[0,1] neg_hi:[0,1]
  v_cvt_pk_bf16_f32 v108, 0, v108
  v_cvt_pk_bf16_f32 v109, 0, v109
  v_cvt_pk_bf16_f32 v110, 0, v110
  v_cvt_pk_bf16_f32 v111, 0, v111
  v_pk_mul_f32 v[108:109], v[108:109], v[200:201]
  v_pk_mul_f32 v[110:111], v[110:111], v[202:203]
  v_cvt_pk_bf16_f32 v220, v108, v109
  v_cvt_pk_bf16_f32 v221, v110, v111
  s_waitcnt vmcnt(14)
  s_cbranch_vccnz L_kw1_3
  s_waitcnt vmcnt(9)
L_kw1_3:
  buffer_load_dwordx4 v[32:35], v94, s[8:11], s60 offen offset:0 nt
  v_mfma_f32_16x16x16_bf16 v[224:227], v[220:221], v[172:173], v[224:227]
  v_cvt_f32_i32 v108, v60
  v_cvt_f32_i32 v109, v61
  v_cvt_f32_i32 v110, v62
  v_cvt_f32_i32 v111, v63
  v_pk_add_f32 v[108:109], v[108:109], v[204:205] neg_lo:[0,1] neg_hi:[0,1]
  v_pk_add_f32 v[110:111], v[110:111], v[206:207] neg_lo:[0,1] neg_hi:[0,1]
  v_cvt_pk_bf16_f32 v108, 0, v108
  v_cvt_pk_bf16_f32 v109, 0, v109
  v_cvt_pk_bf16_f32 v110, 0, v110
  v_cvt_pk_bf16_f32 v111, 0, v111
  v_pk_mul_f32 v[108:109], v[108:109], v[192:193]
  v_pk_mul_f32 v[110:111], v[110:111], v[194:195]
  v_cvt_pk_bf16_f32 v216, v108, v109
  v_cvt_pk_bf16_f32 v217, v110, v111
  s_waitcnt vmcnt(14)
  buffer_load_dwordx4 v[36:39], v94, s[8:11], s60 offen offset:256 nt
  v_cvt_f32_i32 v108, v64
  v_cvt_f32_i32 v109, v65
  v_cvt_f32_i32 v110, v66
  v_cvt_f32_i32 v111, v67
  v_pk_add_f32 v[108:109], v[108:109], v[208:209] neg_lo:[0,1] neg_hi:[0,1]
  v_pk_add_f32 v[110:111], v[110:111], v[210:211] neg_lo:[0,1] neg_hi:[0,1]
  v_mov_b32_dpp v144, v224 quad_perm:[0,0,0,0] row_mask:0xf bank_mask:0xf
  v_mov_b32_dpp v145, v226 quad_perm:[2,2,2,2] row_mask:0xf bank_mask:0xf
  v_cvt_pk_bf16_f32 v108, 0, v108
  v_cvt_pk_bf16_f32 v109, 0, v109
  v_add_f32_dpp v144, v225, v144 quad_perm:[1,1,1,1] row_mask:0xf bank_mask:0xf
  v_add_f32_dpp v145, v227, v145 quad_perm:[3,3,3,3] row_mask:0xf bank_mask:0xf
  v_cvt_pk_bf16_f32 v110, 0, v110
  v_cvt_pk_bf16_f32 v111, 0, v111
  v_add_f32 v228, v144, v145
  v_pk_mul_f32 v[108:109], v[108:109], v[196:197]
  v_pk_mul_f32 v[110:111], v[110:111], v[198:199]
  v_cvt_pk_bf16_f32 v218, v108, v109
  v_cvt_pk_bf16_f32 v219, v110, v111
  s_waitcnt vmcnt(14)
  buffer_load_dwordx4 v[40:43], v94, s[8:11], s60 offen offset:512 nt
  v_mfma_f32_16x16x32_bf16 v[224:227], v[216:219], v[168:171], 0
  v_cvt_f32_i32 v108, v68
  v_cvt_f32_i32 v109, v69
  v_cvt_f32_i32 v110, v70
  v_cvt_f32_i32 v111, v71
  v_pk_add_f32 v[108:109], v[108:109], v[212:213] neg_lo:[0,1] neg_hi:[0,1]
  v_pk_add_f32 v[110:111], v[110:111], v[214:215] neg_lo:[0,1] neg_hi:[0,1]
  v_cvt_pk_bf16_f32 v108, 0, v108
  v_cndmask_b32 v228, v228, v236, s[48:49]
  v_cvt_pk_bf16_f32 v109, 0, v109
  v_cvt_pk_bf16_f32 v110, 0, v110
  v_cvt_pk_bf16_f32 v111, 0, v111
  v_pk_mul_f32 v[108:109], v[108:109], v[200:201]
  v_pk_mul_f32 v[110:111], v[110:111], v[202:203]
  v_cvt_pk_bf16_f32 v220, v108, v109
  v_cvt_pk_bf16_f32 v221, v110, v111
  s_waitcnt vmcnt(14)
  s_cbranch_vccnz L_kw1_6
  s_waitcnt vmcnt(9)
L_kw1_6:
  buffer_load_dwordx4 v[44:47], v94, s[8:11], s60 offen offset:768 nt
  v_mfma_f32_16x16x16_bf16 v[224:227], v[220:221], v[172:173], v[224:227]
  v_cvt_f32_i32 v108, v72
  v_cvt_f32_i32 v109, v73
  v_cvt_f32_i32 v110, v74
  v_cvt_f32_i32 v111, v75
  v_pk_add_f32 v[108:109], v[108:109], v[204:205] neg_lo:[0,1] neg_hi:[0,1]
  v_pk_add_f32 v[110:111], v[110:111], v[206:207] neg_lo:[0,1] neg_hi:[0,1]
  v_cvt_pk_bf16_f32 v108, 0, v108
  v_cvt_pk_bf16_f32 v109, 0, v109
  v_cvt_pk_bf16_f32 v110, 0, v110
  v_cvt_pk_bf16_f32 v111, 0, v111
  v_pk_mul_f32 v[108:109], v[108:109], v[192:193]
  v_pk_mul_f32 v[110:111], v[110:111], v[194:195]
  v_cvt_pk_bf16_f32 v216, v108, v109
  v_cvt_pk_bf16_f32 v217, v110, v111
  s_waitcnt vmcnt(14)
  buffer_load_dwordx4 v[48:51], v94, s[8:11], s60 offen offset:1024 nt
  v_cvt_f32_i32 v108, v76
  v_cvt_f32_i32 v109, v77
  v_cvt_f32_i32 v110, v78
  v_cvt_f32_i32 v111, v79
  v_pk_add_f32 v[108:109], v[108:109], v[208:209] neg_lo:[0,1] neg_hi:[0,1]
  v_pk_add_f32 v[110:111], v[110:111], v[210:211] neg_lo:[0,1] neg_hi:[0,1]
  v_mov_b32_dpp v144, v224 quad_perm:[0,0,0,0] row_mask:0xf bank_mask:0xf
  v_mov_b32_dpp v145, v226 quad_perm:[2,2,2,2] row_mask:0xf bank_mask:0xf
  v_cvt_pk_bf16_f32 v108, 0, v108
  v_cvt_pk_bf16_f32 v109, 0, v109
  v_add_f32_dpp v144, v225, v144 quad_perm:[1,1,1,1] row_mask:0xf bank_mask:0xf
  v_add_f32_dpp v145, v227, v145 quad_perm:[3,3,3,3] row_mask:0xf bank_mask:0xf
  v_cvt_pk_bf16_f32 v110, 0, v110
  v_cvt_pk_bf16_f32 v111, 0, v111
  v_add_f32 v229, v144, v145
  v_pk_mul_f32 v[108:109], v[108:109], v[196:197]
  v_pk_mul_f32 v[110:111], v[110:111], v[198:199]
  v_cvt_pk_bf16_f32 v218, v108, v109
  v_cvt_pk_bf16_f32 v219, v110, v111
  s_waitcnt vmcnt(14)
  buffer_load_dwordx4 v[52:55], v94, s[8:11], s60 offen offset:1280 nt
  v_mfma_f32_16x16x32_bf16 v[224:227], v[216:219], v[168:171], 0
  v_cvt_f32_i32 v108, v80
  v_cvt_f32_i32 v109, v81
  v_cvt_f32_i32 v110, v82
  v_cvt_f32_i32 v111, v83
  v_pk_add_f32 v[108:109], v[108:109], v[212:213] neg_lo:[0,1] neg_hi:[0,1]
  v_pk_add_f32 v[110:111], v[110:111], v[214:215] neg_lo:[0,1] neg_hi:[0,1]
  v_cvt_pk_bf16_f32 v108, 0, v108
  v_cvt_pk_bf16_f32 v228, 0, v228
  v_cvt_pk_bf16_f32 v109, 0, v109
  v_cvt_pk_bf16_f32 v229, 0, v229
  v_cvt_pk_bf16_f32 v110, 0, v110
  v_pk_mul_f32 v[228:229], v[228:229], s[68:69]
  v_cvt_pk_bf16_f32 v111, 0, v111
  v_cvt_pk_bf16_f32 v120, v228, v229
  v_pk_mul_f32 v[108:109], v[108:109], v[200:201]
  v_pk_mul_f32 v[110:111], v[110:111], v[202:203]
  v_cvt_pk_bf16_f32 v220, v108, v109
  v_cvt_pk_bf16_f32 v221, v110, v111
  s_waitcnt vmcnt(14)
  s_cbranch_vccnz L_kw1_9
  s_waitcnt vmcnt(9)
L_kw1_9:
  buffer_load_dwordx4 v[56:59], v94, s[8:11], s60 offen offset:1536 nt
  v_mfma_f32_16x16x16_bf16 v[224:227], v[220:221], v[172:173], v[224:227]
  v_cvt_f32_i32 v108, v84
  v_cvt_f32_i32 v109, v85
  v_cvt_f32_i32 v110, v86
  v_cvt_f32_i32 v111, v87
  v_pk_add_f32 v[108:109], v[108:109], v[204:205] neg_lo:[0,1] neg_hi:[0,1]
  v_pk_add_f32 v[110:111], v[110:111], v[206:207] neg_lo:[0,1] neg_hi:[0,1]
  v_cvt_pk_bf16_f32 v108, 0, v108
  v_cvt_pk_bf16_f32 v109, 0, v109
  v_cvt_pk_bf16_f32 v110, 0, v110
  v_cvt_pk_bf16_f32 v111, 0, v111
  v_pk_mul_f32 v[108:109], v[108:109], v[192:193]
  v_pk_mul_f32 v[110:111], v[110:111], v[194:195]
  v_cvt_pk_bf16_f32 v216, v108, v109
  v_cvt_pk_bf16_f32 v217, v110, v111
  s_waitcnt vmcnt(14)
  buffer_load_dwordx4 v[60:63], v94, s[8:11], s60 offen offset:1792 nt
  v_cvt_f32_i32 v108, v88
  v_cvt_f32_i32 v109, v89
  v_cvt_f32_i32 v110, v90
  v_cvt_f32_i32 v111, v91
  v_pk_add_f32 v[108:109], v[108:109], v[208:209] neg_lo:[0,1] neg_hi:[0,1]
  v_pk_add_f32 v[110:111], v[110:111], v[210:211] neg_lo:[0,1] neg_hi:[0,1]
  v_mov_b32_dpp v144, v224 quad_perm:[0,0,0,0] row_mask:0xf bank_mask:0xf
  v_mov_b32_dpp v145, v226 quad_perm:[2,2,2,2] row_mask:0xf bank_mask:0xf
  v_cvt_pk_bf16_f32 v108, 0, v108
  v_cvt_pk_bf16_f32 v109, 0, v109
  v_add_f32_dpp v144, v225, v144 quad_perm:[1,1,1,1] row_mask:0xf bank_mask:0xf
  v_add_f32_dpp v145, v227, v145 quad_perm:[3,3,3,3] row_mask:0xf bank_mask:0xf
  v_cvt_pk_bf16_f32 v110, 0, v110
  v_cvt_pk_bf16_f32 v111, 0, v111
  v_add_f32 v228, v144, v145
  v_pk_mul_f32 v[108:109], v[108:109], v[196:197]
  v_pk_mul_f32 v[110:111], v[110:111], v[198:199]
  v_cvt_pk_bf16_f32 v218, v108, v109
  v_cvt_pk_bf16_f32 v219, v110, v111
  s_waitcnt vmcnt(14)
  buffer_load_dwordx4 v[64:67], v94, s[8:11], s60 offen offset:2048 nt
  v_mfma_f32_16x16x32_bf16 v[224:227], v[216:219], v[168:171], 0
  v_cvt_f32_i32 v108, v4
  v_cvt_f32_i32 v109, v5
  v_cvt_f32_i32 v110, v6
  v_cvt_f32_i32 v111, v7
  v_pk_add_f32 v[108:109], v[108:109], v[212:213] neg_lo:[0,1] neg_hi:[0,1]
  v_pk_add_f32 v[110:111], v[110:111], v[214:215] neg_lo:[0,1] neg_hi:[0,1]
  v_cvt_pk_bf16_f32 v108, 0, v108
  v_cvt_pk_bf16_f32 v109, 0, v109
  v_cvt_pk_bf16_f32 v110, 0, v110
  v_cvt_pk_bf16_f32 v111, 0, v111
  v_pk_mul_f32 v[108:109], v[108:109], v[200:201]
  v_pk_mul_f32 v[110:111], v[110:111], v[202:203]
  v_cvt_pk_bf16_f32 v220, v108, v109
  v_cvt_pk_bf16_f32 v221, v110, v111
  s_waitcnt vmcnt(14)
  s_cbranch_vccnz L_kw1_12
  s_waitcnt vmcnt(9)
L_kw1_12:
  buffer_load_dwordx4 v[68:71], v94, s[8:11], s60 offen offset:2304 nt
  v_mfma_f32_16x16x16_bf16 v[224:227], v[220:221], v[172:173], v[224:227]
  v_cvt_f32_i32 v108, v8
  v_cvt_f32_i32 v109, v9
  v_cvt_f32_i32 v110, v10
  v_cvt_f32_i32 v111, v11
  v_pk_add_f32 v[108:109], v[108:109], v[204:205] neg_lo:[0,1] neg_hi:[0,1]
  v_pk_add_f32 v[110:111], v[110:111], v[206:207] neg_lo:[0,1] neg_hi:[0,1]
  v_cvt_pk_bf16_f32 v108, 0, v108
  v_cvt_pk_bf16_f32 v109, 0, v109
  v_cvt_pk_bf16_f32 v110, 0, v110
  v_cvt_pk_bf16_f32 v111, 0, v111
  v_pk_mul_f32 v[108:109], v[108:109], v[192:193]
  v_pk_mul_f32 v[110:111], v[110:111], v[194:195]
  v_cvt_pk_bf16_f32 v216, v108, v109
  v_cvt_pk_bf16_f32 v217, v110, v111
  s_waitcnt vmcnt(14)
  buffer_load_dwordx4 v[72:75], v94, s[8:11], s60 offen offset:2560 nt
  v_cvt_f32_i32 v108, v12
  v_cvt_f32_i32 v109, v13
  v_cvt_f32_i32 v110, v14
  v_cvt_f32_i32 v111, v15
  v_pk_add_f32 v[108:109], v[108:109], v[208:209] neg_lo:[0,1] neg_hi:[0,1]
  v_pk_add_f32 v[110:111], v[110:111], v[210:211] neg_lo:[0,1] neg_hi:[0,1]
  v_mov_b32_dpp v144, v224 quad_perm:[0,0,0,0] row_mask:0xf bank_mask:0xf
  v_mov_b32_dpp v145, v226 quad_perm:[2,2,2,2] row_mask:0xf bank_mask:0xf
  v_cvt_pk_bf16_f32 v108, 0, v108
  v_cvt_pk_bf16_f32 v109, 0, v109
  v_add_f32_dpp v144, v225, v144 quad_perm:[1,1,1,1] row_mask:0xf bank_mask:0xf
  v_add_f32_dpp v145, v227, v145 quad_perm:[3,3,3,3] row_mask:0xf bank_mask:0xf
  v_cvt_pk_bf16_f32 v110, 0, v110
  v_cvt_pk_bf16_f32 v111, 0, v111
  v_add_f32 v229, v144, v145
  v_pk_mul_f32 v[108:109], v[108:109], v[196:197]
  v_pk_mul_f32 v[110:111], v[110:111], v[198:199]
  v_cvt_pk_bf16_f32 v218, v108, v109
  v_cvt_pk_bf16_f32 v219, v110, v111
  s_waitcnt vmcnt(14)
  buffer_load_dwordx4 v[76:79], v94, s[8:11], s60 offen offset:2816 nt
  v_mfma_f32_16x16x32_bf16 v[224:227], v[216:219], v[168:171], 0
  v_cvt_f32_i32 v108, v16
  v_cvt_f32_i32 v109, v17
  v_cvt_f32_i32 v110, v18
  v_cvt_f32_i32 v111, v19
  v_pk_add_f32 v[108:109], v[108:109], v[212:213] neg_lo:[0,1] neg_hi:[0,1]
  v_pk_add_f32 v[110:111], v[110:111], v[214:215] neg_lo:[0,1] neg_hi:[0,1]
  v_cvt_pk_bf16_f32 v108, 0, v108
  v_cvt_pk_bf16_f32 v228, 0, v228
  v_cvt_pk_bf16_f32 v109, 0, v109
  v_cvt_pk_bf16_f32 v229, 0, v229
  v_cvt_pk_bf16_f32 v110, 0, v110
  v_pk_mul_f32 v[228:229], v[228:229], s[68:69]
  v_cvt_pk_bf16_f32 v111, 0, v111
  v_cvt_pk_bf16_f32 v121, v228, v229
  v_pk_mul_f32 v[108:109], v[108:109], v[200:201]
  v_pk_mul_f32 v[110:111], v[110:111], v[202:203]
  v_cvt_pk_bf16_f32 v220, v108, v109
  v_cvt_pk_bf16_f32 v221, v110, v111
  s_waitcnt vmcnt(14)
  s_cbranch_vccnz L_kw1_15
  s_waitcnt vmcnt(9)
L_kw1_15:
  buffer_load_dwordx4 v[80:83], v95, s[8:11], s60 offen offset:0 nt
  v_mfma_f32_16x16x16_bf16 v[224:227], v[220:221], v[172:173], v[224:227]
  v_cvt_f32_i32 v108, v20
  v_cvt_f32_i32 v109, v21
  v_cvt_f32_i32 v110, v22
  v_cvt_f32_i32 v111, v23
  v_pk_add_f32 v[108:109], v[108:109], v[204:205] neg_lo:[0,1] neg_hi:[0,1]
  v_pk_add_f32 v[110:111], v[110:111], v[206:207] neg_lo:[0,1] neg_hi:[0,1]
  v_cvt_pk_bf16_f32 v108, 0, v108
  v_cvt_pk_bf16_f32 v109, 0, v109
  v_cvt_pk_bf16_f32 v110, 0, v110
  v_cvt_pk_bf16_f32 v111, 0, v111
  v_pk_mul_f32 v[108:109], v[108:109], v[192:193]
  v_pk_mul_f32 v[110:111], v[110:111], v[194:195]
  v_cvt_pk_bf16_f32 v216, v108, v109
  v_cvt_pk_bf16_f32 v217, v110, v111
  s_waitcnt vmcnt(14)
  buffer_load_dwordx4 v[84:87], v95, s[8:11], s60 offen offset:256 nt
  v_cvt_f32_i32 v108, v24
  v_cvt_f32_i32 v109, v25
  v_cvt_f32_i32 v110, v26
  v_cvt_f32_i32 v111, v27
  v_pk_add_f32 v[108:109], v[108:109], v[208:209] neg_lo:[0,1] neg_hi:[0,1]
  v_pk_add_f32 v[110:111], v[110:111], v[210:211] neg_lo:[0,1] neg_hi:[0,1]
  v_mov_b32_dpp v144, v224 quad_perm:[0,0,0,0] row_mask:0xf bank_mask:0xf
  v_mov_b32_dpp v145, v226 quad_perm:[2,2,2,2] row_mask:0xf bank_mask:0xf
  v_cvt_pk_bf16_f32 v108, 0, v108
  v_cvt_pk_bf16_f32 v109, 0, v109
  v_add_f32_dpp v144, v225, v144 quad_perm:[1,1,1,1] row_mask:0xf bank_mask:0xf
  v_add_f32_dpp v145, v227, v145 quad_perm:[3,3,3,3] row_mask:0xf bank_mask:0xf
  v_cvt_pk_bf16_f32 v110, 0, v110
  v_cvt_pk_bf16_f32 v111, 0, v111
  v_add_f32 v228, v144, v145
  v_pk_mul_f32 v[108:109], v[108:109], v[196:197]
  v_pk_mul_f32 v[110:111], v[110:111], v[198:199]
  v_cvt_pk_bf16_f32 v218, v108, v109
  v_cvt_pk_bf16_f32 v219, v110, v111
  s_waitcnt vmcnt(14)
  buffer_load_dwordx4 v[88:91], v95, s[8:11], s60 offen offset:512 nt
  v_mfma_f32_16x16x32_bf16 v[224:227], v[216:219], v[168:171], 0
  v_cvt_f32_i32 v108, v28
  v_cvt_f32_i32 v109, v29
  v_cvt_f32_i32 v110, v30
  v_cvt_f32_i32 v111, v31
  v_pk_add_f32 v[108:109], v[108:109], v[212:213] neg_lo:[0,1] neg_hi:[0,1]
  v_pk_add_f32 v[110:111], v[110:111], v[214:215] neg_lo:[0,1] neg_hi:[0,1]
  s_cmp_lt_u32 s64, s99
  s_cbranch_scc1 L_k_known1
L_k_spin1:
  v_mov_b32 v144, 61696
  ds_read_b32 v144, v144
  s_waitcnt lgkmcnt(0)
  v_readfirstlane_b32 s96, v144
  s_nop 1
  s_cmp_eq_u32 s96, 0
  s_cbranch_scc1 L_k_spin1
  s_mov_b32 s99, -1
L_k_known1:
  s_lshr_b32 s71, s64, 4
  s_andn2_b32 s71, s71, 1
  s_lshr_b32 s71, 0x12, s71
  s_and_b32 s71, s71, 3
  s_lshr_b32 s85, s96, s71
  s_andn2_b32 s70, s64, 1
  s_or_b32 s70, s70, s4
  s_cmp_lt_u32 s64, 8
  s_cselect_b32 s70, s70, s64
  s_cselect_b32 s85, s64, s85
  s_and_b32 s85, s85, 1
  s_and_b32 s70, s70, 31
  s_lshl_b32 s71, s71, 12
  s_add_u32 s70, s70, s5
  s_add_u32 s70, s70, s71
  s_mul_hi_u32 s84, s70, s90
  s_lshr_b32 s84, s84, 1
  s_mul_i32 s71, s84, 3
  s_sub_u32 s70, s70, s71
  s_lshl3_add_u32 s85, s70, s85
  s_mul_i32 s61, s84, 196608
  s_lshr_b32 s89, s84, 4
  s_lshl_b32 s70, s85, 5
  v_add_u32 v97, s70, v230
  v_mul_u32_u24 v97, 21846, v97
  v_lshrrev_b32 v97, 16, v97
  v_add_u32 v144, s85, v231
  v_lshrrev_b32 v145, v144, s91
  v_and_b32 v145, 1, v145
  v_cmp_eq_u32 s[54:55], 1, v145
  s_nop 1
  s_and_b64 s[52:53], s[54:55], s[56:57]
  s_andn2_b64 s[54:55], s[54:55], s[56:57]
  v_mul_u32_u24 v144, 43, v144
  v_lshrrev_b32 v144, 8, v144
  v_mul_u32_u24 v144, 384, v144
  v_add_u32 v234, v144, v233
  s_cmp_eq_u32 s89, s88
  s_cbranch_scc1 L_k_sameq1
  s_mul_i32 s70, s89, 1536
  buffer_load_dwordx2 v[174:175], v235, s[36:39], s70 offen offset:0
  buffer_load_dwordx2 v[176:177], v235, s[36:39], s70 offen offset:128
  buffer_load_dwordx2 v[178:179], v235, s[36:39], s70 offen offset:256
  s_mov_b32 s88, s89
L_k_sameq1:
  s_mul_i32 s62, s84, 1536
  buffer_load_dwordx2 v[180:181], v234, s[20:23], s62 offen offset:0
  buffer_load_dwordx2 v[186:187], v234, s[24:27], s62 offen offset:0
  buffer_load_dwordx2 v[182:183], v234, s[20:23], s62 offen offset:128
  buffer_load_dwordx2 v[188:189], v234, s[24:27], s62 offen offset:128
  buffer_load_dwordx2 v[184:185], v234, s[20:23], s62 offen offset:256
  buffer_load_dwordx2 v[190:191], v234, s[24:27], s62 offen offset:256
  v_cvt_pk_bf16_f32 v108, 0, v108
  v_cvt_pk_bf16_f32 v109, 0, v109
  v_cvt_pk_bf16_f32 v110, 0, v110
  v_cvt_pk_bf16_f32 v111, 0, v111
  v_pk_mul_f32 v[108:109], v[108:109], v[200:201]
  v_pk_mul_f32 v[110:111], v[110:111], v[202:203]
  v_cvt_pk_bf16_f32 v220, v108, v109
  v_cvt_pk_bf16_f32 v221, v110, v111
  s_cmp_lt_u32 s64, 96
  s_cbranch_scc1 L_k_keep
  s_lshr_b32 s71, s3, 5
  s_lshr_b32 s85, s96, s71
  s_bfe_u32 s85, s85, 0x10003
  s_and_b32 s70, s3, 31
  s_lshl_b32 s71, s71, 12
  s_add_u32 s70, s70, s5
  s_add_u32 s70, s70, s71
  s_mul_hi_u32 s84, s70, s90
  s_lshr_b32 s84, s84, 1
  s_mul_i32 s71, s84, 3
  s_sub_u32 s70, s70, s71
  s_lshl3_add_u32 s85, s70, s85
  s_mul_i32 s61, s84, 196608
  s_lshr_b32 s89, s84, 4
  s_lshl_b32 s70, s85, 5
  v_add_u32 v97, s70, v1
  v_mul_u32_u24 v97, 21846, v97
  v_lshrrev_b32 v97, 16, v97
  v_add_u32 v144, s85, v2
  v_lshrrev_b32 v145, v144, s91
  v_and_b32 v145, 1, v145
  v_cmp_eq_u32 s[54:55], 1, v145
  s_nop 1
  s_and_b64 s[52:53], s[54:55], s[58:59]
  s_andn2_b64 s[54:55], s[54:55], s[58:59]
  s_mov_b32 s16, s12
  s_mov_b32 s17, s13
  s_lshl_b32 s62, s84, 9
  v_lshl_add_u32 v98, v97, 1, v96
  buffer_load_short_d16_hi v112, v98, s[32:35], s62 offen
  buffer_load_short_d16_hi v113, v98, s[28:31], s62 offen
  v_mov_b32 v232, v3
L_k_keep:
  v_mad_u32_u24 v92, v97, s63, v232
  v_add_u32 v93, 768, v92
  v_add_u32 v94, 4608, v92
  v_add_u32 v95, 7680, v92
  v_cndmask_b32 v92, v92, v105, s[52:53]
  v_cndmask_b32 v95, v95, v105, s[54:55]
  s_waitcnt vmcnt(20)
  s_cbranch_vccnz L_kw1_18
  s_waitcnt vmcnt(15)
L_kw1_18:
  buffer_load_dwordx4 v[4:7], v92, s[16:19], s61 offen offset:0 nt
  v_mfma_f32_16x16x16_bf16 v[224:227], v[220:221], v[172:173], v[224:227]
  v_cvt_f32_i32 v108, v32
  v_cvt_f32_i32 v109, v33
  v_cvt_f32_i32 v110, v34
  v_cvt_f32_i32 v111, v35
  v_pk_add_f32 v[108:109], v[108:109], v[204:205] neg_lo:[0,1] neg_hi:[0,1]
  v_pk_add_f32 v[110:111], v[110:111], v[206:207] neg_lo:[0,1] neg_hi:[0,1]
  v_cvt_pk_bf16_f32 v108, 0, v108
  v_cvt_pk_bf16_f32 v109, 0, v109
  v_cvt_pk_bf16_f32 v110, 0, v110
  v_cvt_pk_bf16_f32 v111, 0, v111
  v_pk_mul_f32 v[108:109], v[108:109], v[192:193]
  v_pk_mul_f32 v[110:111], v[110:111], v[194:195]
  v_cvt_pk_bf16_f32 v216, v108, v109
  v_cvt_pk_bf16_f32 v217, v110, v111
  s_waitcnt vmcnt(20)
  buffer_load_dwordx4 v[8:11], v92, s[16:19], s61 offen offset:256 nt
  v_cvt_f32_i32 v108, v36
  v_cvt_f32_i32 v109, v37
  v_cvt_f32_i32 v110, v38
  v_cvt_f32_i32 v111, v39
  v_pk_add_f32 v[108:109], v[108:109], v[208:209] neg_lo:[0,1] neg_hi:[0,1]
  v_pk_add_f32 v[110:111], v[110:111], v[210:211] neg_lo:[0,1] neg_hi:[0,1]
  v_mov_b32_dpp v144, v224 quad_perm:[0,0,0,0] row_mask:0xf bank_mask:0xf
  v_mov_b32_dpp v145, v226 quad_perm:[2,2,2,2] row_mask:0xf bank_mask:0xf
  v_cvt_pk_bf16_f32 v108, 0, v108
  v_cvt_pk_bf16_f32 v109, 0, v109
  v_add_f32_dpp v144, v225, v144 quad_perm:[1,1,1,1] row_mask:0xf bank_mask:0xf
  v_add_f32_dpp v145, v227, v145 quad_perm:[3,3,3,3] row_mask:0xf bank_mask:0xf
  v_cvt_pk_bf16_f32 v110, 0, v110
  v_cvt_pk_bf16_f32 v111, 0, v111
  v_add_f32 v229, v144, v145
  v_pk_mul_f32 v[108:109], v[108:109], v[196:197]
  v_pk_mul_f32 v[110:111], v[110:111], v[198:199]
  v_cvt_pk_bf16_f32 v218, v108, v109
  v_cvt_pk_bf16_f32 v219, v110, v111
  s_waitcnt vmcnt(20)
  buffer_load_dwordx4 v[12:15], v92, s[16:19], s61 offen offset:512 nt
  v_mfma_f32_16x16x32_bf16 v[224:227], v[216:219], v[168:171], 0
  v_cvt_f32_i32 v108, v40
  v_cvt_f32_i32 v109, v41
  v_cvt_f32_i32 v110, v42
  v_cvt_f32_i32 v111, v43
  v_pk_add_f32 v[108:109], v[108:109], v[212:213] neg_lo:[0,1] neg_hi:[0,1]
  v_pk_add_f32 v[110:111], v[110:111], v[214:215] neg_lo:[0,1] neg_hi:[0,1]
  v_cvt_pk_bf16_f32 v108, 0, v108
  v_cvt_pk_bf16_f32 v228, 0, v228
  v_cvt_pk_bf16_f32 v109, 0, v109
  v_cvt_pk_bf16_f32 v229, 0, v229
  v_cvt_pk_bf16_f32 v110, 0, v110
  v_pk_mul_f32 v[228:229], v[228:229], s[68:69]
  v_cvt_pk_bf16_f32 v111, 0, v111
  v_cvt_pk_bf16_f32 v122, v228, v229
  v_pk_mul_f32 v[108:109], v[108:109], v[200:201]
  v_pk_mul_f32 v[110:111], v[110:111], v[202:203]
  v_cvt_pk_bf16_f32 v220, v108, v109
  v_cvt_pk_bf16_f32 v221, v110, v111
  s_waitcnt vmcnt(20)
  s_cbranch_vccnz L_kw1_21
  s_waitcnt vmcnt(15)
L_kw1_21:
  buffer_load_dwordx4 v[16:19], v93, s[16:19], s61 offen offset:0 nt
  v_mfma_f32_16x16x16_bf16 v[224:227], v[220:221], v[172:173], v[224:227]
  v_cvt_f32_i32 v108, v44
  v_cvt_f32_i32 v109, v45
  v_cvt_f32_i32 v110, v46
  v_cvt_f32_i32 v111, v47
  v_pk_add_f32 v[108:109], v[108:109], v[204:205] neg_lo:[0,1] neg_hi:[0,1]
  v_pk_add_f32 v[110:111], v[110:111], v[206:207] neg_lo:[0,1] neg_hi:[0,1]
  v_cvt_pk_bf16_f32 v108, 0, v108
  v_cvt_pk_bf16_f32 v109, 0, v109
  v_cvt_pk_bf16_f32 v110, 0, v110
  v_cvt_pk_bf16_f32 v111, 0, v111
  v_pk_mul_f32 v[108:109], v[108:109], v[192:193]
  v_pk_mul_f32 v[110:111], v[110:111], v[194:195]
  v_cvt_pk_bf16_f32 v216, v108, v109
  v_cvt_pk_bf16_f32 v217, v110, v111
  s_waitcnt vmcnt(20)
  buffer_load_dwordx4 v[20:23], v93, s[16:19], s61 offen offset:256 nt
  v_cvt_f32_i32 v108, v48
  v_cvt_f32_i32 v109, v49
  v_cvt_f32_i32 v110, v50
  v_cvt_f32_i32 v111, v51
  v_pk_add_f32 v[108:109], v[108:109], v[208:209] neg_lo:[0,1] neg_hi:[0,1]
  v_pk_add_f32 v[110:111], v[110:111], v[210:211] neg_lo:[0,1] neg_hi:[0,1]
  v_mov_b32_dpp v144, v224 quad_perm:[0,0,0,0] row_mask:0xf bank_mask:0xf
  v_mov_b32_dpp v145, v226 quad_perm:[2,2,2,2] row_mask:0xf bank_mask:0xf
  v_cvt_pk_bf16_f32 v108, 0, v108
  v_cvt_pk_bf16_f32 v109, 0, v109
  v_add_f32_dpp v144, v225, v144 quad_perm:[1,1,1,1] row_mask:0xf bank_mask:0xf
  v_add_f32_dpp v145, v227, v145 quad_perm:[3,3,3,3] row_mask:0xf bank_mask:0xf
  v_cvt_pk_bf16_f32 v110, 0, v110
  v_cvt_pk_bf16_f32 v111, 0, v111
  v_add_f32 v228, v144, v145
  v_pk_mul_f32 v[108:109], v[108:109], v[196:197]
  v_pk_mul_f32 v[110:111], v[110:111], v[198:199]
  v_cvt_pk_bf16_f32 v218, v108, v109
  v_cvt_pk_bf16_f32 v219, v110, v111
  s_waitcnt vmcnt(20)
  buffer_load_dwordx4 v[24:27], v93, s[16:19], s61 offen offset:512 nt
  v_mfma_f32_16x16x32_bf16 v[224:227], v[216:219], v[168:171], 0
  v_cvt_f32_i32 v108, v52
  v_cvt_f32_i32 v109, v53
  v_cvt_f32_i32 v110, v54
  v_cvt_f32_i32 v111, v55
  v_pk_add_f32 v[108:109], v[108:109], v[212:213] neg_lo:[0,1] neg_hi:[0,1]
  v_pk_add_f32 v[110:111], v[110:111], v[214:215] neg_lo:[0,1] neg_hi:[0,1]
  v_cvt_pk_bf16_f32 v108, 0, v108
  v_cvt_pk_bf16_f32 v109, 0, v109
  v_cvt_pk_bf16_f32 v110, 0, v110
  v_cvt_pk_bf16_f32 v111, 0, v111
  v_pk_mul_f32 v[108:109], v[108:109], v[200:201]
  v_pk_mul_f32 v[110:111], v[110:111], v[202:203]
  v_cvt_pk_bf16_f32 v220, v108, v109
  v_cvt_pk_bf16_f32 v221, v110, v111
  s_waitcnt vmcnt(20)
  s_cbranch_vccnz L_kw1_24
  s_waitcnt vmcnt(15)
L_kw1_24:
  buffer_load_dwordx4 v[28:31], v93, s[16:19], s61 offen offset:768 nt
  v_mfma_f32_16x16x16_bf16 v[224:227], v[220:221], v[172:173], v[224:227]
  v_cvt_f32_i32 v108, v56
  v_cvt_f32_i32 v109, v57
  v_cvt_f32_i32 v110, v58
  v_cvt_f32_i32 v111, v59
  v_pk_add_f32 v[108:109], v[108:109], v[204:205] neg_lo:[0,1] neg_hi:[0,1]
  v_pk_add_f32 v[110:111], v[110:111], v[206:207] neg_lo:[0,1] neg_hi:[0,1]
  v_cvt_pk_bf16_f32 v108, 0, v108
  v_cvt_pk_bf16_f32 v109, 0, v109
  v_cvt_pk_bf16_f32 v110, 0, v110
  v_cvt_pk_bf16_f32 v111, 0, v111
  v_pk_mul_f32 v[108:109], v[108:109], v[192:193]
  v_pk_mul_f32 v[110:111], v[110:111], v[194:195]
  v_cvt_pk_bf16_f32 v216, v108, v109
  v_cvt_pk_bf16_f32 v217, v110, v111
  s_waitcnt vmcnt(20)
  buffer_load_dwordx4 v[32:35], v93, s[16:19], s61 offen offset:1024 nt
  v_cvt_f32_i32 v108, v60
  v_cvt_f32_i32 v109, v61
  v_cvt_f32_i32 v110, v62
  v_cvt_f32_i32 v111, v63
  v_pk_add_f32 v[108:109], v[108:109], v[208:209] neg_lo:[0,1] neg_hi:[0,1]
  v_pk_add_f32 v[110:111], v[110:111], v[210:211] neg_lo:[0,1] neg_hi:[0,1]
  v_mov_b32_dpp v144, v224 quad_perm:[0,0,0,0] row_mask:0xf bank_mask:0xf
  v_mov_b32_dpp v145, v226 quad_perm:[2,2,2,2] row_mask:0xf bank_mask:0xf
  v_cvt_pk_bf16_f32 v108, 0, v108
  v_cvt_pk_bf16_f32 v109, 0, v109
  v_add_f32_dpp v144, v225, v144 quad_perm:[1,1,1,1] row_mask:0xf bank_mask:0xf
  v_add_f32_dpp v145, v227, v145 quad_perm:[3,3,3,3] row_mask:0xf bank_mask:0xf
  v_cvt_pk_bf16_f32 v110, 0, v110
  v_cvt_pk_bf16_f32 v111, 0, v111
  v_add_f32 v229, v144, v145
  v_pk_mul_f32 v[108:109], v[108:109], v[196:197]
  v_pk_mul_f32 v[110:111], v[110:111], v[198:199]
  v_cvt_pk_bf16_f32 v218, v108, v109
  v_cvt_pk_bf16_f32 v219, v110, v111
  s_waitcnt vmcnt(20)
  buffer_load_dwordx4 v[36:39], v93, s[16:19], s61 offen offset:1280 nt
  v_mfma_f32_16x16x32_bf16 v[224:227], v[216:219], v[168:171], 0
  v_cvt_f32_i32 v108, v64
  v_cvt_f32_i32 v109, v65
  v_cvt_f32_i32 v110, v66
  v_cvt_f32_i32 v111, v67
  v_pk_add_f32 v[108:109], v[108:109], v[212:213] neg_lo:[0,1] neg_hi:[0,1]
  v_pk_add_f32 v[110:111], v[110:111], v[214:215] neg_lo:[0,1] neg_hi:[0,1]
  v_cvt_pk_bf16_f32 v108, 0, v108
  v_cvt_pk_bf16_f32 v228, 0, v228
  v_cvt_pk_bf16_f32 v109, 0, v109
  v_cvt_pk_bf16_f32 v229, 0, v229
  v_cvt_pk_bf16_f32 v110, 0, v110
  v_pk_mul_f32 v[228:229], v[228:229], s[68:69]
  v_cvt_pk_bf16_f32 v111, 0, v111
  v_cvt_pk_bf16_f32 v123, v228, v229
  v_pk_mul_f32 v[108:109], v[108:109], v[200:201]
  v_pk_mul_f32 v[110:111], v[110:111], v[202:203]
  v_cvt_pk_bf16_f32 v220, v108, v109
  v_cvt_pk_bf16_f32 v221, v110, v111
  s_waitcnt vmcnt(20)
  s_cbranch_vccnz L_kw1_27
  s_waitcnt vmcnt(15)
L_kw1_27:
  buffer_load_dwordx4 v[40:43], v93, s[16:19], s61 offen offset:1536 nt
  v_mfma_f32_16x16x16_bf16 v[224:227], v[220:221], v[172:173], v[224:227]
  v_cvt_f32_i32 v108, v68
  v_cvt_f32_i32 v109, v69
  v_cvt_f32_i32 v110, v70
  v_cvt_f32_i32 v111, v71
  v_pk_add_f32 v[108:109], v[108:109], v[204:205] neg_lo:[0,1] neg_hi:[0,1]
  v_pk_add_f32 v[110:111], v[110:111], v[206:207] neg_lo:[0,1] neg_hi:[0,1]
  v_cvt_pk_bf16_f32 v108, 0, v108
  v_cvt_pk_bf16_f32 v109, 0, v109
  v_cvt_pk_bf16_f32 v110, 0, v110
  v_cvt_pk_bf16_f32 v111, 0, v111
  v_pk_mul_f32 v[108:109], v[108:109], v[192:193]
  v_pk_mul_f32 v[110:111], v[110:111], v[194:195]
  v_cvt_pk_bf16_f32 v216, v108, v109
  v_cvt_pk_bf16_f32 v217, v110, v111
  s_waitcnt vmcnt(20)
  buffer_load_dwordx4 v[44:47], v93, s[16:19], s61 offen offset:1792 nt
  v_cvt_f32_i32 v108, v72
  v_cvt_f32_i32 v109, v73
  v_cvt_f32_i32 v110, v74
  v_cvt_f32_i32 v111, v75
  v_pk_add_f32 v[108:109], v[108:109], v[208:209] neg_lo:[0,1] neg_hi:[0,1]
  v_pk_add_f32 v[110:111], v[110:111], v[210:211] neg_lo:[0,1] neg_hi:[0,1]
  v_mov_b32_dpp v144, v224 quad_perm:[0,0,0,0] row_mask:0xf bank_mask:0xf
  v_mov_b32_dpp v145, v226 quad_perm:[2,2,2,2] row_mask:0xf bank_mask:0xf
  v_cvt_pk_bf16_f32 v108, 0, v108
  v_cvt_pk_bf16_f32 v109, 0, v109
  v_add_f32_dpp v144, v225, v144 quad_perm:[1,1,1,1] row_mask:0xf bank_mask:0xf
  v_add_f32_dpp v145, v227, v145 quad_perm:[3,3,3,3] row_mask:0xf bank_mask:0xf
  v_cvt_pk_bf16_f32 v110, 0, v110
  v_cvt_pk_bf16_f32 v111, 0, v111
  v_add_f32 v228, v144, v145
  v_pk_mul_f32 v[108:109], v[108:109], v[196:197]
  v_pk_mul_f32 v[110:111], v[110:111], v[198:199]
  v_cvt_pk_bf16_f32 v218, v108, v109
  v_cvt_pk_bf16_f32 v219, v110, v111
  s_waitcnt vmcnt(20)
  buffer_load_dwordx4 v[48:51], v93, s[16:19], s61 offen offset:2048 nt
  v_mfma_f32_16x16x32_bf16 v[224:227], v[216:219], v[168:171], 0
  v_cvt_f32_i32 v108, v76
  v_cvt_f32_i32 v109, v77
  v_cvt_f32_i32 v110, v78
  v_cvt_f32_i32 v111, v79
  v_pk_add_f32 v[108:109], v[108:109], v[212:213] neg_lo:[0,1] neg_hi:[0,1]
  v_pk_add_f32 v[110:111], v[110:111], v[214:215] neg_lo:[0,1] neg_hi:[0,1]
  v_cvt_pk_bf16_f32 v108, 0, v108
  v_cvt_pk_bf16_f32 v109, 0, v109
  v_cvt_pk_bf16_f32 v110, 0, v110
  v_cvt_pk_bf16_f32 v111, 0, v111
  v_pk_mul_f32 v[108:109], v[108:109], v[200:201]
  v_pk_mul_f32 v[110:111], v[110:111], v[202:203]
  v_cvt_pk_bf16_f32 v220, v108, v109
  v_cvt_pk_bf16_f32 v221, v110, v111
  s_waitcnt vmcnt(20)
  s_cbranch_vccnz L_kw1_30
  s_waitcnt vmcnt(9)
L_kw1_30:
  buffer_load_dwordx4 v[52:55], v93, s[16:19], s61 offen offset:2304 nt
  v_mfma_f32_16x16x16_bf16 v[224:227], v[220:221], v[172:173], v[224:227]
  v_cvt_f32_i32 v108, v80
  v_cvt_f32_i32 v109, v81
  v_cvt_f32_i32 v110, v82
  v_cvt_f32_i32 v111, v83
  v_pk_add_f32 v[108:109], v[108:109], v[204:205] neg_lo:[0,1] neg_hi:[0,1]
  v_pk_add_f32 v[110:111], v[110:111], v[206:207] neg_lo:[0,1] neg_hi:[0,1]
  v_cvt_pk_bf16_f32 v108, 0, v108
  v_cvt_pk_bf16_f32 v109, 0, v109
  v_cvt_pk_bf16_f32 v110, 0, v110
  v_cvt_pk_bf16_f32 v111, 0, v111
  v_pk_mul_f32 v[108:109], v[108:109], v[192:193]
  v_pk_mul_f32 v[110:111], v[110:111], v[194:195]
  v_cvt_pk_bf16_f32 v216, v108, v109
  v_cvt_pk_bf16_f32 v217, v110, v111
  s_waitcnt vmcnt(20)
  buffer_load_dwordx4 v[56:59], v93, s[16:19], s61 offen offset:2560 nt
  v_cvt_f32_i32 v108, v84
  v_cvt_f32_i32 v109, v85
  v_cvt_f32_i32 v110, v86
  v_cvt_f32_i32 v111, v87
  v_pk_add_f32 v[108:109], v[108:109], v[208:209] neg_lo:[0,1] neg_hi:[0,1]
  v_pk_add_f32 v[110:111], v[110:111], v[210:211] neg_lo:[0,1] neg_hi:[0,1]
  v_mov_b32_dpp v144, v224 quad_perm:[0,0,0,0] row_mask:0xf bank_mask:0xf
  v_mov_b32_dpp v145, v226 quad_perm:[2,2,2,2] row_mask:0xf bank_mask:0xf
  v_cvt_pk_bf16_f32 v108, 0, v108
  v_cvt_pk_bf16_f32 v109, 0, v109
  v_add_f32_dpp v144, v225, v144 quad_perm:[1,1,1,1] row_mask:0xf bank_mask:0xf
  v_add_f32_dpp v145, v227, v145 quad_perm:[3,3,3,3] row_mask:0xf bank_mask:0xf
  v_cvt_pk_bf16_f32 v110, 0, v110
  v_cvt_pk_bf16_f32 v111, 0, v111
  v_add_f32 v229, v144, v145
  v_pk_mul_f32 v[108:109], v[108:109], v[196:197]
  v_pk_mul_f32 v[110:111], v[110:111], v[198:199]
  v_cvt_pk_bf16_f32 v218, v108, v109
  v_cvt_pk_bf16_f32 v219, v110, v111
  s_waitcnt vmcnt(20)
  buffer_load_dwordx4 v[60:63], v93, s[16:19], s61 offen offset:2816 nt
  v_mfma_f32_16x16x32_bf16 v[224:227], v[216:219], v[168:171], 0
  v_cvt_f32_i32 v108, v88
  v_cvt_f32_i32 v109, v89
  v_cvt_f32_i32 v110, v90
  v_cvt_f32_i32 v111, v91
  v_pk_add_f32 v[108:109], v[108:109], v[212:213] neg_lo:[0,1] neg_hi:[0,1]
  v_pk_add_f32 v[110:111], v[110:111], v[214:215] neg_lo:[0,1] neg_hi:[0,1]
  v_cvt_pk_bf16_f32 v108, 0, v108
  v_cvt_pk_bf16_f32 v228, 0, v228
  v_cvt_pk_bf16_f32 v109, 0, v109
  v_cvt_pk_bf16_f32 v229, 0, v229
  v_cvt_pk_bf16_f32 v110, 0, v110
  v_pk_mul_f32 v[228:229], v[228:229], s[68:69]
  v_cvt_pk_bf16_f32 v111, 0, v111
  v_cvt_pk_bf16_f32 v124, v228, v229
  v_pk_mul_f32 v[108:109], v[108:109], v[200:201]
  v_pk_mul_f32 v[110:111], v[110:111], v[202:203]
  v_cvt_pk_bf16_f32 v220, v108, v109
  v_cvt_pk_bf16_f32 v221, v110, v111
  s_mov_b32 s60, s61
  v_mov_b32 v146, s64
  v_mfma_f32_16x16x16_bf16 v[224:227], v[220:221], v[172:173], v[224:227]
  ds_write_b128 v99, v[120:123]
  v_add_u32 v99, 768, v99
  s_nop 5
  v_mov_b32_dpp v144, v224 quad_perm:[0,0,0,0] row_mask:0xf bank_mask:0xf
  v_mov_b32_dpp v145, v226 quad_perm:[2,2,2,2] row_mask:0xf bank_mask:0xf
  s_nop 0
  v_add_f32_dpp v144, v225, v144 quad_perm:[1,1,1,1] row_mask:0xf bank_mask:0xf
  v_add_f32_dpp v145, v227, v145 quad_perm:[3,3,3,3] row_mask:0xf bank_mask:0xf
  v_add_f32 v228, v144, v145
  v_cndmask_b32 v228, v228, v236, s[50:51]
  v_cvt_pk_bf16_f32 v228, 0, v228
  v_cvt_pk_bf16_f32 v229, 0, v229
  v_pk_mul_f32 v[228:229], v[228:229], s[68:69]
  v_cvt_pk_bf16_f32 v125, v228, v229
  ds_write_b64 v100, v[124:125] offset:256
  ds_write_b32 v104, v146
  v_add_u32 v100, 768, v100
  s_cmp_lt_u32 s64, 96
  s_cbranch_scc1 L_k
  v_subrev_u32 v99, 24576, v99
  v_subrev_u32 v100, 24576, v100
  s_mov_b32 s64, s3
  s_mov_b32 s88, s89
  s_mov_b32 s99, 0
  s_mov_b32 s36, s46
  s_and_b32 s37, s47, 0xffff
  s_cmp_lt_u32 s64, s99
  s_cbranch_scc1 L_v0_ok
L_v0_spin:
  v_mov_b32 v144, 61700
  ds_read_b32 v144, v144
  s_waitcnt lgkmcnt(0)
  v_readfirstlane_b32 s99, v144
  s_nop 1
  s_cmp_lt_u32 s64, s99
  s_cbranch_scc0 L_v0_spin
L_v0_ok:
  ds_read_b128 v[120:123], v99
  ds_read_b64 v[124:125], v100 offset:256
  v_mov_b32 v128, 0
  v_mov_b32 v129, 0
  v_mov_b32 v130, 0
  v_mov_b32 v131, 0
  v_mov_b32 v132, 0
  v_mov_b32 v133, 0
  v_mov_b32 v134, 0
  v_mov_b32 v135, 0
  v_mov_b32 v136, 0
  v_mov_b32 v137, 0
  v_mov_b32 v138, 0
  v_mov_b32 v139, 0
  v_mov_b32 v140, 0xff800000
  v_mov_b32 v142, 0x7f800000
  v_mov_b32 v143, 0
L_v0:
  s_add_u32 s97, s64, 96
  v_mov_b32 v146, s97
  s_mov_b32 s86, s84
  ds_write_b32 v104, v146
  s_add_u32 s64, s64, 2
  s_cmp_lt_u32 s64, s99
  s_cbranch_scc1 L_v10_ok
L_v10_spin:
  v_mov_b32 v144, 61700
  ds_read_b32 v144, v144
  s_waitcnt lgkmcnt(0)
  v_readfirstlane_b32 s99, v144
  s_nop 1
  s_cmp_lt_u32 s64, s99
  s_cbranch_scc0 L_v10_spin
L_v10_ok:
  s_lshr_b32 s71, s64, 5
  s_lshr_b32 s85, s96, s71
  s_bfe_u32 s85, s85, 0x10003
  s_and_b32 s70, s64, 31
  s_lshl_b32 s71, s71, 12
  s_add_u32 s70, s70, s5
  s_add_u32 s70, s70, s71
  s_mul_hi_u32 s84, s70, s90
  s_lshr_b32 s84, s84, 1
  s_mul_i32 s71, s84, 3
  s_sub_u32 s70, s70, s71
  s_lshl3_add_u32 s85, s70, s85
  s_mul_i32 s61, s84, 196608
  s_lshr_b32 s89, s84, 4
  s_lshl_b32 s70, s85, 5
  v_add_u32 v97, s70, v1
  v_mul_u32_u24 v97, 21846, v97
  v_lshrrev_b32 v97, 16, v97
  v_add_u32 v144, s85, v2
  v_lshrrev_b32 v145, v144, s91
  v_and_b32 v145, 1, v145
  v_cmp_eq_u32 s[54:55], 1, v145
  s_nop 1
  s_and_b64 s[52:53], s[54:55], s[58:59]
  s_andn2_b64 s[54:55], s[54:55], s[58:59]
  s_cmp_lt_u32 s64, 96
  s_cselect_b32 s61, s61, 805306368
  ds_read_b32 v106, v104 offset:8
  s_waitcnt vmcnt(14)
  s_cbranch_vccnz L_vw0_0
  s_waitcnt vmcnt(9)
L_vw0_0:
  buffer_load_dwordx4 v[64:67], v93, s[12:15], s60 offen offset:3072 nt
  v_mov_b32 v114, v112
  v_mov_b32 v115, v113
  v_cvt_f32_i32 v192, v4
  v_cvt_f32_i32 v193, v5
  v_mov_b32_dpp v116, v114 row_newbcast:0 row_mask:0xf bank_mask:0xf
  v_mov_b32_dpp v117, v115 row_newbcast:0 row_mask:0xf bank_mask:0xf
  v_cvt_f32_i32 v194, v6
  v_cvt_f32_i32 v195, v7
  v_pk_add_f32 v[192:193], v[192:193], v[116:117] op_sel_hi:[1,0] neg_lo:[0,1] neg_hi:[0,1]
  v_pk_add_f32 v[194:195], v[194:195], v[116:117] op_sel_hi:[1,0] neg_lo:[0,1] neg_hi:[0,1]
  v_cvt_pk_bf16_f32 v192, 0, v192
  v_cvt_pk_bf16_f32 v193, 0, v193
  v_cvt_pk_bf16_f32 v194, 0, v194
  v_cvt_pk_bf16_f32 v195, 0, v195
  v_pk_mul_f32 v[192:193], v[192:193], v[116:117] op_sel:[0,1]
  v_pk_mul_f32 v[194:195], v[194:195], v[116:117] op_sel:[0,1]
  s_waitcnt lgkmcnt(0)
  v_cmp_lt_u32 vcc, s97, v106
  s_waitcnt vmcnt(14)
  buffer_load_dwordx4 v[68:71], v93, s[12:15], s60 offen offset:3328 nt
  v_cvt_f32_i32 v196, v8
  v_cvt_f32_i32 v197, v9
  v_cvt_f32_i32 v198, v10
  v_cvt_f32_i32 v199, v11
  v_pk_add_f32 v[196:197], v[196:197], v[116:117] op_sel_hi:[1,0] neg_lo:[0,1] neg_hi:[0,1]
  v_pk_add_f32 v[198:199], v[198:199], v[116:117] op_sel_hi:[1,0] neg_lo:[0,1] neg_hi:[0,1]
  v_cvt_pk_bf16_f32 v196, 0, v196
  v_lshlrev_b32 v148, 16, v120
  v_cvt_pk_bf16_f32 v197, 0, v197
  v_and_b32 v149, s65, v120
  v_cvt_pk_bf16_f32 v198, 0, v198
  v_lshlrev_b32 v150, 16, v121
  v_cvt_pk_bf16_f32 v199, 0, v199
  v_and_b32 v151, s65, v121
  v_pk_mul_f32 v[196:197], v[196:197], v[116:117] op_sel:[0,1]
  v_lshlrev_b32 v152, 16, v122
  v_pk_mul_f32 v[198:199], v[198:199], v[116:117] op_sel:[0,1]
  s_waitcnt vmcnt(14)
  buffer_load_dwordx4 v[72:75], v93, s[12:15], s60 offen offset:3584 nt
  v_cvt_f32_i32 v200, v12
  v_cvt_f32_i32 v201, v13
  v_cvt_f32_i32 v202, v14
  v_cvt_f32_i32 v203, v15
  v_pk_add_f32 v[200:201], v[200:201], v[116:117] op_sel_hi:[1,0] neg_lo:[0,1] neg_hi:[0,1]
  v_pk_add_f32 v[202:203], v[202:203], v[116:117] op_sel_hi:[1,0] neg_lo:[0,1] neg_hi:[0,1]
  v_cvt_pk_bf16_f32 v200, 0, v200
  v_and_b32 v153, s65, v122
  v_cvt_pk_bf16_f32 v201, 0, v201
  v_lshlrev_b32 v154, 16, v123
  v_cvt_pk_bf16_f32 v202, 0, v202
  v_and_b32 v155, s65, v123
  v_cvt_pk_bf16_f32 v203, 0, v203
  v_lshlrev_b32 v156, 16, v124
  v_pk_mul_f32 v[200:201], v[200:201], v[116:117] op_sel:[0,1]
  v_and_b32 v157, s65, v124
  v_pk_mul_f32 v[202:203], v[202:203], v[116:117] op_sel:[0,1]
  s_waitcnt vmcnt(14)
  s_cbranch_vccnz L_vw0_3
  s_waitcnt vmcnt(9)
L_vw0_3:
  buffer_load_dwordx4 v[76:79], v94, s[12:15], s60 offen offset:0 nt
  v_cvt_f32_i32 v108, v16
  v_cvt_f32_i32 v109, v17
  v_mov_b32_dpp v116, v114 row_newbcast:1 row_mask:0xf bank_mask:0xf
  v_mov_b32_dpp v117, v115 row_newbcast:1 row_mask:0xf bank_mask:0xf
  v_cvt_f32_i32 v110, v18
  v_cvt_f32_i32 v111, v19
  v_pk_add_f32 v[108:109], v[108:109], v[116:117] op_sel_hi:[1,0] neg_lo:[0,1] neg_hi:[0,1]
  v_pk_add_f32 v[110:111], v[110:111], v[116:117] op_sel_hi:[1,0] neg_lo:[0,1] neg_hi:[0,1]
  s_lshl_b32 s62, s84, 9
  v_lshl_add_u32 v98, v97, 1, v96
  buffer_load_short_d16_hi v112, v98, s[32:35], s62 offen
  buffer_load_short_d16_hi v113, v98, s[28:31], s62 offen
  v_cvt_pk_bf16_f32 v108, 0, v108
  v_lshlrev_b32 v158, 16, v125
  v_cvt_pk_bf16_f32 v109, 0, v109
  v_add_u32 v99, 768, v99
  v_cvt_pk_bf16_f32 v110, 0, v110
  v_add_u32 v100, 768, v100
  v_cvt_pk_bf16_f32 v111, 0, v111
  v_max3_f32 v144, v148, v149, v150
  v_pk_mul_f32 v[108:109], v[108:109], v[116:117] op_sel:[0,1]
  ds_read_b128 v[120:123], v99
  v_pk_mul_f32 v[110:111], v[110:111], v[116:117] op_sel:[0,1]
  v_cvt_pk_bf16_f32 v204, v192, v108
  v_cvt_pk_bf16_f32 v208, v193, v109
  v_cvt_pk_bf16_f32 v212, v194, v110
  v_cvt_pk_bf16_f32 v216, v195, v111
  s_waitcnt vmcnt(16)
  buffer_load_dwordx4 v[80:83], v94, s[12:15], s60 offen offset:256 nt
  v_cvt_f32_i32 v108, v20
  v_cvt_f32_i32 v109, v21
  v_cvt_f32_i32 v110, v22
  v_cvt_f32_i32 v111, v23
  v_pk_add_f32 v[108:109], v[108:109], v[116:117] op_sel_hi:[1,0] neg_lo:[0,1] neg_hi:[0,1]
  v_pk_add_f32 v[110:111], v[110:111], v[116:117] op_sel_hi:[1,0] neg_lo:[0,1] neg_hi:[0,1]
  v_cvt_pk_bf16_f32 v108, 0, v108
  ds_read_b64 v[124:125], v100 offset:256
  v_cvt_pk_bf16_f32 v109, 0, v109
  v_max3_f32 v145, v151, v152, v153
  v_cvt_pk_bf16_f32 v110, 0, v110
  v_max3_f32 v144, v144, v154, v155
  v_cvt_pk_bf16_f32 v111, 0, v111
  v_max3_f32 v145, v145, v156, v157
  v_pk_mul_f32 v[108:109], v[108:109], v[116:117] op_sel:[0,1]
  v_max3_f32 v144, v144, v158, v140
  v_pk_mul_f32 v[110:111], v[110:111], v[116:117] op_sel:[0,1]
  v_cvt_pk_bf16_f32 v220, v196, v108
  v_cvt_pk_bf16_f32 v224, v197, v109
  v_cvt_pk_bf16_f32 v228, v198, v110
  v_cvt_pk_bf16_f32 v232, v199, v111
  s_waitcnt vmcnt(16)
  buffer_load_dwordx4 v[84:87], v94, s[12:15], s60 offen offset:512 nt
  v_cvt_f32_i32 v108, v24
  v_cvt_f32_i32 v109, v25
  v_cvt_f32_i32 v110, v26
  v_cvt_f32_i32 v111, v27
  v_pk_add_f32 v[108:109], v[108:109], v[116:117] op_sel_hi:[1,0] neg_lo:[0,1] neg_hi:[0,1]
  v_pk_add_f32 v[110:111], v[110:111], v[116:117] op_sel_hi:[1,0] neg_lo:[0,1] neg_hi:[0,1]
  v_cvt_pk_bf16_f32 v108, 0, v108
  v_max_f32 v144, v144, v145
  v_cvt_pk_bf16_f32 v109, 0, v109
  v_mov_b32 v145, v144
  v_cvt_pk_bf16_f32 v110, 0, v110
  s_nop 0
  v_permlane32_swap_b32 v144, v145
  v_cvt_pk_bf16_f32 v111, 0, v111
  v_max_f32 v144, v144, v145
  v_pk_mul_f32 v[108:109], v[108:109], v[116:117] op_sel:[0,1]
  v_mov_b32 v145, v144
  v_pk_mul_f32 v[110:111], v[110:111], v[116:117] op_sel:[0,1]
  v_cvt_pk_bf16_f32 v236, v200, v108
  v_cvt_pk_bf16_f32 v240, v201, v109
  v_cvt_pk_bf16_f32 v244, v202, v110
  v_cvt_pk_bf16_f32 v248, v203, v111
  s_waitcnt vmcnt(16)
  s_cbranch_vccnz L_vw0_6
  s_waitcnt vmcnt(11)
L_vw0_6:
  buffer_load_dwordx4 v[88:91], v94, s[12:15], s60 offen offset:768 nt
  v_cvt_f32_i32 v192, v28
  v_cvt_f32_i32 v193, v29
  v_mov_b32_dpp v116, v114 row_newbcast:2 row_mask:0xf bank_mask:0xf
  v_mov_b32_dpp v117, v115 row_newbcast:2 row_mask:0xf bank_mask:0xf
  v_cvt_f32_i32 v194, v30
  v_cvt_f32_i32 v195, v31
  v_pk_add_f32 v[192:193], v[192:193], v[116:117] op_sel_hi:[1,0] neg_lo:[0,1] neg_hi:[0,1]
  v_pk_add_f32 v[194:195], v[194:195], v[116:117] op_sel_hi:[1,0] neg_lo:[0,1] neg_hi:[0,1]
  v_cvt_pk_bf16_f32 v192, 0, v192
  v_permlane16_swap_b32 v144, v145
  v_cvt_pk_bf16_f32 v193, 0, v193
  v_max_f32 v140, v144, v145
  v_cvt_pk_bf16_f32 v194, 0, v194
  v_mul_f32 v144, s66, v140
  v_cvt_pk_bf16_f32 v195, 0, v195
  v_add_f32 v146, v144, v142
  v_pk_mul_f32 v[192:193], v[192:193], v[116:117] op_sel:[0,1]
  v_sub_f32 v142, 0, v144
  v_pk_mul_f32 v[194:195], v[194:195], v[116:117] op_sel:[0,1]
  s_waitcnt vmcnt(16)
  buffer_load_dwordx4 v[4:7], v94, s[12:15], s60 offen offset:1024 nt
  v_cvt_f32_i32 v196, v32
  v_cvt_f32_i32 v197, v33
  v_cvt_f32_i32 v198, v34
  v_cvt_f32_i32 v199, v35
  v_pk_add_f32 v[196:197], v[196:197], v[116:117] op_sel_hi:[1,0] neg_lo:[0,1] neg_hi:[0,1]
  v_pk_add_f32 v[198:199], v[198:199], v[116:117] op_sel_hi:[1,0] neg_lo:[0,1] neg_hi:[0,1]
  v_cvt_pk_bf16_f32 v196, 0, v196
  v_exp_f32 v146, -v146
  v_cvt_pk_bf16_f32 v197, 0, v197
  ds_bpermute_b32 v147, v101, v146
  v_cvt_pk_bf16_f32 v198, 0, v198
  v_fma_f32 v148, v148, s66, v142
  v_cvt_pk_bf16_f32 v199, 0, v199
  v_exp_f32 v148, v148
  v_pk_mul_f32 v[196:197], v[196:197], v[116:117] op_sel:[0,1]
  v_fma_f32 v149, v149, s66, v142
  v_pk_mul_f32 v[198:199], v[198:199], v[116:117] op_sel:[0,1]
  s_waitcnt vmcnt(16)
  buffer_load_dwordx4 v[8:11], v94, s[12:15], s60 offen offset:1280 nt
  v_cvt_f32_i32 v200, v36
  v_cvt_f32_i32 v201, v37
  v_cvt_f32_i32 v202, v38
  v_cvt_f32_i32 v203, v39
  v_pk_add_f32 v[200:201], v[200:201], v[116:117] op_sel_hi:[1,0] neg_lo:[0,1] neg_hi:[0,1]
  v_pk_add_f32 v[202:203], v[202:203], v[116:117] op_sel_hi:[1,0] neg_lo:[0,1] neg_hi:[0,1]
  v_cvt_pk_bf16_f32 v200, 0, v200
  v_exp_f32 v149, v149
  v_cvt_pk_bf16_f32 v201, 0, v201
  v_fma_f32 v150, v150, s66, v142
  v_cvt_pk_bf16_f32 v202, 0, v202
  v_exp_f32 v150, v150
  v_cvt_pk_bf16_f32 v203, 0, v203
  v_fma_f32 v151, v151, s66, v142
  v_pk_mul_f32 v[200:201], v[200:201], v[116:117] op_sel:[0,1]
  v_exp_f32 v151, v151
  v_pk_mul_f32 v[202:203], v[202:203], v[116:117] op_sel:[0,1]
  s_waitcnt vmcnt(16)
  s_cbranch_vccnz L_vw0_9
  s_waitcnt vmcnt(11)
L_vw0_9:
  buffer_load_dwordx4 v[12:15], v94, s[12:15], s60 offen offset:1536 nt
  v_cvt_f32_i32 v108, v40
  v_cvt_f32_i32 v109, v41
  v_mov_b32_dpp v116, v114 row_newbcast:3 row_mask:0xf bank_mask:0xf
  v_mov_b32_dpp v117, v115 row_newbcast:3 row_mask:0xf bank_mask:0xf
  v_cvt_f32_i32 v110, v42
  v_cvt_f32_i32 v111, v43
  v_pk_add_f32 v[108:109], v[108:109], v[116:117] op_sel_hi:[1,0] neg_lo:[0,1] neg_hi:[0,1]
  v_pk_add_f32 v[110:111], v[110:111], v[116:117] op_sel_hi:[1,0] neg_lo:[0,1] neg_hi:[0,1]
  v_cvt_pk_bf16_f32 v108, 0, v108
  v_fma_f32 v152, v152, s66, v142
  v_cvt_pk_bf16_f32 v109, 0, v109
  v_exp_f32 v152, v152
  v_cvt_pk_bf16_f32 v110, 0, v110
  v_fma_f32 v153, v153, s66, v142
  v_cvt_pk_bf16_f32 v111, 0, v111
  v_exp_f32 v153, v153
  v_pk_mul_f32 v[108:109], v[108:109], v[116:117] op_sel:[0,1]
  v_fma_f32 v154, v154, s66, v142
  v_pk_mul_f32 v[110:111], v[110:111], v[116:117] op_sel:[0,1]
  v_cvt_pk_bf16_f32 v205, v192, v108
  v_cvt_pk_bf16_f32 v209, v193, v109
  v_cvt_pk_bf16_f32 v213, v194, v110
  v_cvt_pk_bf16_f32 v217, v195, v111
  s_waitcnt vmcnt(16)
  buffer_load_dwordx4 v[16:19], v94, s[12:15], s60 offen offset:1792 nt
  v_cvt_f32_i32 v108, v44
  v_cvt_f32_i32 v109, v45
  v_cvt_f32_i32 v110, v46
  v_cvt_f32_i32 v111, v47
  v_pk_add_f32 v[108:109], v[108:109], v[116:117] op_sel_hi:[1,0] neg_lo:[0,1] neg_hi:[0,1]
  v_pk_add_f32 v[110:111], v[110:111], v[116:117] op_sel_hi:[1,0] neg_lo:[0,1] neg_hi:[0,1]
  v_cvt_pk_bf16_f32 v108, 0, v108
  v_exp_f32 v154, v154
  v_cvt_pk_bf16_f32 v109, 0, v109
  v_fma_f32 v155, v155, s66, v142
  v_cvt_pk_bf16_f32 v110, 0, v110
  v_exp_f32 v155, v155
  v_cvt_pk_bf16_f32 v111, 0, v111
  v_fma_f32 v156, v156, s66, v142
  v_pk_mul_f32 v[108:109], v[108:109], v[116:117] op_sel:[0,1]
  v_exp_f32 v156, v156
  v_pk_mul_f32 v[110:111], v[110:111], v[116:117] op_sel:[0,1]
  v_cvt_pk_bf16_f32 v221, v196, v108
  v_cvt_pk_bf16_f32 v225, v197, v109
  v_cvt_pk_bf16_f32 v229, v198, v110
  v_cvt_pk_bf16_f32 v233, v199, v111
  s_waitcnt vmcnt(16)
  buffer_load_dwordx4 v[20:23], v94, s[12:15], s60 offen offset:2048 nt
  v_cvt_f32_i32 v108, v48
  v_cvt_f32_i32 v109, v49
  v_cvt_f32_i32 v110, v50
  v_cvt_f32_i32 v111, v51
  v_pk_add_f32 v[108:109], v[108:109], v[116:117] op_sel_hi:[1,0] neg_lo:[0,1] neg_hi:[0,1]
  v_pk_add_f32 v[110:111], v[110:111], v[116:117] op_sel_hi:[1,0] neg_lo:[0,1] neg_hi:[0,1]
  v_cvt_pk_bf16_f32 v108, 0, v108
  v_fma_f32 v157, v157, s66, v142
  v_cvt_pk_bf16_f32 v109, 0, v109
  v_exp_f32 v157, v157
  v_cvt_pk_bf16_f32 v110, 0, v110
  v_fma_f32 v158, v158, s66, v142
  v_cvt_pk_bf16_f32 v111, 0, v111
  v_exp_f32 v158, v158
  v_pk_mul_f32 v[108:109], v[108:109], v[116:117] op_sel:[0,1]
  v_add_f32 v144, v148, v149
  v_pk_mul_f32 v[110:111], v[110:111], v[116:117] op_sel:[0,1]
  v_cvt_pk_bf16_f32 v237, v200, v108
  v_cvt_pk_bf16_f32 v241, v201, v109
  v_cvt_pk_bf16_f32 v245, v202, v110
  v_cvt_pk_bf16_f32 v249, v203, v111
  s_waitcnt vmcnt(16)
  s_cbranch_vccnz L_vw0_12
  s_waitcnt vmcnt(11)
L_vw0_12:
  buffer_load_dwordx4 v[24:27], v94, s[12:15], s60 offen offset:2304 nt
  v_cvt_f32_i32 v192, v52
  v_cvt_f32_i32 v193, v53
  v_mov_b32_dpp v116, v114 row_newbcast:4 row_mask:0xf bank_mask:0xf
  v_mov_b32_dpp v117, v115 row_newbcast:4 row_mask:0xf bank_mask:0xf
  v_cvt_f32_i32 v194, v54
  v_cvt_f32_i32 v195, v55
  v_pk_add_f32 v[192:193], v[192:193], v[116:117] op_sel_hi:[1,0] neg_lo:[0,1] neg_hi:[0,1]
  v_pk_add_f32 v[194:195], v[194:195], v[116:117] op_sel_hi:[1,0] neg_lo:[0,1] neg_hi:[0,1]
  v_cvt_pk_bf16_f32 v192, 0, v192
  v_add_f32 v145, v150, v151
  v_cvt_pk_bf16_f32 v193, 0, v193
  v_add_f32 v144, v144, v152
  v_cvt_pk_bf16_f32 v194, 0, v194
  v_add_f32 v145, v145, v153
  v_cvt_pk_bf16_f32 v195, 0, v195
  v_add_f32 v144, v144, v154
  v_pk_mul_f32 v[192:193], v[192:193], v[116:117] op_sel:[0,1]
  v_add_f32 v145, v145, v155
  v_pk_mul_f32 v[194:195], v[194:195], v[116:117] op_sel:[0,1]
  s_waitcnt vmcnt(16)
  buffer_load_dwordx4 v[28:31], v94, s[12:15], s60 offen offset:2560 nt
  v_cvt_f32_i32 v196, v56
  v_cvt_f32_i32 v197, v57
  v_cvt_f32_i32 v198, v58
  v_cvt_f32_i32 v199, v59
  v_pk_add_f32 v[196:197], v[196:197], v[116:117] op_sel_hi:[1,0] neg_lo:[0,1] neg_hi:[0,1]
  v_pk_add_f32 v[198:199], v[198:199], v[116:117] op_sel_hi:[1,0] neg_lo:[0,1] neg_hi:[0,1]
  v_cvt_pk_bf16_f32 v196, 0, v196
  v_add_f32 v144, v144, v156
  v_cvt_pk_bf16_f32 v197, 0, v197
  v_add_f32 v145, v145, v157
  v_cvt_pk_bf16_f32 v198, 0, v198
  v_add_f32 v144, v144, v158
  v_cvt_pk_bf16_f32 v199, 0, v199
  v_add_f32 v144, v144, v145
  v_pk_mul_f32 v[196:197], v[196:197], v[116:117] op_sel:[0,1]
  v_fma_f32 v143, v143, v146, v144
  v_pk_mul_f32 v[198:199], v[198:199], v[116:117] op_sel:[0,1]
  s_waitcnt vmcnt(16)
  buffer_load_dwordx4 v[32:35], v94, s[12:15], s60 offen offset:2816 nt
  v_cvt_f32_i32 v200, v60
  v_cvt_f32_i32 v201, v61
  v_cvt_f32_i32 v202, v62
  v_cvt_f32_i32 v203, v63
  v_pk_add_f32 v[200:201], v[200:201], v[116:117] op_sel_hi:[1,0] neg_lo:[0,1] neg_hi:[0,1]
  v_pk_add_f32 v[202:203], v[202:203], v[116:117] op_sel_hi:[1,0] neg_lo:[0,1] neg_hi:[0,1]
  v_cvt_pk_bf16_f32 v200, 0, v200
  v_cvt_pk_bf16_f32 v159, v148, v149
  v_cvt_pk_bf16_f32 v201, 0, v201
  v_cvt_pk_bf16_f32 v160, v150, v151
  v_cvt_pk_bf16_f32 v202, 0, v202
  v_cvt_pk_bf16_f32 v161, v152, v153
  v_cvt_pk_bf16_f32 v203, 0, v203
  v_cvt_pk_bf16_f32 v162, v154, v155
  v_pk_mul_f32 v[200:201], v[200:201], v[116:117] op_sel:[0,1]
  v_cvt_pk_bf16_f32 v163, v156, v157
  v_pk_mul_f32 v[202:203], v[202:203], v[116:117] op_sel:[0,1]
  s_waitcnt vmcnt(16)
  s_cbranch_vccnz L_vw0_15
  s_waitcnt vmcnt(9)
L_vw0_15:
  buffer_load_dwordx4 v[36:39], v95, s[12:15], s60 offen offset:0 nt
  v_cvt_f32_i32 v108, v64
  v_cvt_f32_i32 v109, v65
  v_mov_b32_dpp v116, v114 row_newbcast:5 row_mask:0xf bank_mask:0xf
  v_mov_b32_dpp v117, v115 row_newbcast:5 row_mask:0xf bank_mask:0xf
  v_cvt_f32_i32 v110, v66
  v_cvt_f32_i32 v111, v67
  v_pk_add_f32 v[108:109], v[108:109], v[116:117] op_sel_hi:[1,0] neg_lo:[0,1] neg_hi:[0,1]
  v_pk_add_f32 v[110:111], v[110:111], v[116:117] op_sel_hi:[1,0] neg_lo:[0,1] neg_hi:[0,1]
  v_cvt_pk_bf16_f32 v108, 0, v108
  v_cvt_pk_bf16_f32 v164, v158, 0
  v_cvt_pk_bf16_f32 v109, 0, v109
  v_cndmask_b32 v168, 0, v159, s[72:73]
  v_cvt_pk_bf16_f32 v110, 0, v110
  v_cndmask_b32 v169, 0, v160, s[72:73]
  v_cvt_pk_bf16_f32 v111, 0, v111
  v_cndmask_b32 v170, 0, v161, s[72:73]
  v_pk_mul_f32 v[108:109], v[108:109], v[116:117] op_sel:[0,1]
  v_cndmask_b32 v171, 0, v162, s[72:73]
  v_pk_mul_f32 v[110:111], v[110:111], v[116:117] op_sel:[0,1]
  v_cvt_pk_bf16_f32 v206, v192, v108
  v_cvt_pk_bf16_f32 v210, v193, v109
  v_cvt_pk_bf16_f32 v214, v194, v110
  v_cvt_pk_bf16_f32 v218, v195, v111
  s_waitcnt vmcnt(16)
  buffer_load_dwordx4 v[40:43], v95, s[12:15], s60 offen offset:256 nt
  v_cvt_f32_i32 v108, v68
  v_cvt_f32_i32 v109, v69
  v_cvt_f32_i32 v110, v70
  v_cvt_f32_i32 v111, v71
  v_pk_add_f32 v[108:109], v[108:109], v[116:117] op_sel_hi:[1,0] neg_lo:[0,1] neg_hi:[0,1]
  v_pk_add_f32 v[110:111], v[110:111], v[116:117] op_sel_hi:[1,0] neg_lo:[0,1] neg_hi:[0,1]
  v_cvt_pk_bf16_f32 v108, 0, v108
  v_cndmask_b32 v172, 0, v159, s[74:75]
  v_cvt_pk_bf16_f32 v109, 0, v109
  v_cndmask_b32 v173, 0, v160, s[74:75]
  v_cvt_pk_bf16_f32 v110, 0, v110
  v_cndmask_b32 v174, 0, v161, s[74:75]
  v_cvt_pk_bf16_f32 v111, 0, v111
  v_cndmask_b32 v175, 0, v162, s[74:75]
  v_pk_mul_f32 v[108:109], v[108:109], v[116:117] op_sel:[0,1]
  v_cndmask_b32 v176, 0, v159, s[76:77]
  v_pk_mul_f32 v[110:111], v[110:111], v[116:117] op_sel:[0,1]
  v_cvt_pk_bf16_f32 v222, v196, v108
  v_cvt_pk_bf16_f32 v226, v197, v109
  v_cvt_pk_bf16_f32 v230, v198, v110
  v_cvt_pk_bf16_f32 v234, v199, v111
  s_waitcnt vmcnt(16)
  buffer_load_dwordx4 v[44:47], v95, s[12:15], s60 offen offset:512 nt
  v_cvt_f32_i32 v108, v72
  v_cvt_f32_i32 v109, v73
  v_cvt_f32_i32 v110, v74
  v_cvt_f32_i32 v111, v75
  v_pk_add_f32 v[108:109], v[108:109], v[116:117] op_sel_hi:[1,0] neg_lo:[0,1] neg_hi:[0,1]
  v_pk_add_f32 v[110:111], v[110:111], v[116:117] op_sel_hi:[1,0] neg_lo:[0,1] neg_hi:[0,1]
  v_cvt_pk_bf16_f32 v108, 0, v108
  v_cndmask_b32 v177, 0, v160, s[76:77]
  v_cvt_pk_bf16_f32 v109, 0, v109
  v_cndmask_b32 v178, 0, v161, s[76:77]
  v_cvt_pk_bf16_f32 v110, 0, v110
  v_cndmask_b32 v179, 0, v162, s[76:77]
  v_cvt_pk_bf16_f32 v111, 0, v111
  v_cndmask_b32 v180, 0, v159, s[78:79]
  v_pk_mul_f32 v[108:109], v[108:109], v[116:117] op_sel:[0,1]
  v_cndmask_b32 v181, 0, v160, s[78:79]
  v_pk_mul_f32 v[110:111], v[110:111], v[116:117] op_sel:[0,1]
  v_cvt_pk_bf16_f32 v238, v200, v108
  v_cvt_pk_bf16_f32 v242, v201, v109
  v_cvt_pk_bf16_f32 v246, v202, v110
  v_cvt_pk_bf16_f32 v250, v203, v111
  v_mad_u32_u24 v92, v97, s63, v3
  v_add_u32 v93, 768, v92
  v_add_u32 v94, 4608, v92
  v_add_u32 v95, 7680, v92
  v_cndmask_b32 v92, v92, v105, s[52:53]
  v_cndmask_b32 v95, v95, v105, s[54:55]
  s_waitcnt vmcnt(16)
  s_cbranch_vccnz L_vw0_18
  s_waitcnt vmcnt(9)
L_vw0_18:
  buffer_load_dwordx4 v[48:51], v92, s[12:15], s61 offen offset:0 nt
  v_cvt_f32_i32 v192, v76
  v_cvt_f32_i32 v193, v77
  v_mov_b32_dpp v116, v114 row_newbcast:6 row_mask:0xf bank_mask:0xf
  v_mov_b32_dpp v117, v115 row_newbcast:6 row_mask:0xf bank_mask:0xf
  v_cvt_f32_i32 v194, v78
  v_cvt_f32_i32 v195, v79
  v_pk_add_f32 v[192:193], v[192:193], v[116:117] op_sel_hi:[1,0] neg_lo:[0,1] neg_hi:[0,1]
  v_pk_add_f32 v[194:195], v[194:195], v[116:117] op_sel_hi:[1,0] neg_lo:[0,1] neg_hi:[0,1]
  v_cvt_pk_bf16_f32 v192, 0, v192
  v_cndmask_b32 v182, 0, v161, s[78:79]
  v_cvt_pk_bf16_f32 v193, 0, v193
  v_cndmask_b32 v183, 0, v162, s[78:79]
  v_cvt_pk_bf16_f32 v194, 0, v194
  s_waitcnt lgkmcnt(0)
  v_cvt_pk_bf16_f32 v195, 0, v195
  v_mul_f32 v128, v147, v128
  v_pk_mul_f32 v[192:193], v[192:193], v[116:117] op_sel:[0,1]
  v_mul_f32 v129, v147, v129
  v_pk_mul_f32 v[194:195], v[194:195], v[116:117] op_sel:[0,1]
  s_waitcnt vmcnt(14)
  buffer_load_dwordx4 v[52:55], v92, s[12:15], s61 offen offset:256 nt
  v_cvt_f32_i32 v196, v80
  v_cvt_f32_i32 v197, v81
  v_cvt_f32_i32 v198, v82
  v_cvt_f32_i32 v199, v83
  v_pk_add_f32 v[196:197], v[196:197], v[116:117] op_sel_hi:[1,0] neg_lo:[0,1] neg_hi:[0,1]
  v_pk_add_f32 v[198:199], v[198:199], v[116:117] op_sel_hi:[1,0] neg_lo:[0,1] neg_hi:[0,1]
  v_cvt_pk_bf16_f32 v196, 0, v196
  v_mul_f32 v130, v147, v130
  v_cvt_pk_bf16_f32 v197, 0, v197
  v_mul_f32 v131, v147, v131
  v_cvt_pk_bf16_f32 v198, 0, v198
  v_mul_f32 v132, v147, v132
  v_cvt_pk_bf16_f32 v199, 0, v199
  v_mul_f32 v133, v147, v133
  v_pk_mul_f32 v[196:197], v[196:197], v[116:117] op_sel:[0,1]
  v_mul_f32 v134, v147, v134
  v_pk_mul_f32 v[198:199], v[198:199], v[116:117] op_sel:[0,1]
  s_waitcnt vmcnt(14)
  buffer_load_dwordx4 v[56:59], v92, s[12:15], s61 offen offset:512 nt
  v_cvt_f32_i32 v200, v84
  v_cvt_f32_i32 v201, v85
  v_cvt_f32_i32 v202, v86
  v_cvt_f32_i32 v203, v87
  v_pk_add_f32 v[200:201], v[200:201], v[116:117] op_sel_hi:[1,0] neg_lo:[0,1] neg_hi:[0,1]
  v_pk_add_f32 v[202:203], v[202:203], v[116:117] op_sel_hi:[1,0] neg_lo:[0,1] neg_hi:[0,1]
  v_cvt_pk_bf16_f32 v200, 0, v200
  v_mul_f32 v135, v147, v135
  v_cvt_pk_bf16_f32 v201, 0, v201
  v_mul_f32 v136, v147, v136
  v_cvt_pk_bf16_f32 v202, 0, v202
  v_mul_f32 v137, v147, v137
  v_cvt_pk_bf16_f32 v203, 0, v203
  v_mul_f32 v138, v147, v138
  v_pk_mul_f32 v[200:201], v[200:201], v[116:117] op_sel:[0,1]
  v_mul_f32 v139, v147, v139
  v_pk_mul_f32 v[202:203], v[202:203], v[116:117] op_sel:[0,1]
  s_waitcnt vmcnt(14)
  s_cbranch_vccnz L_vw0_21
  s_waitcnt vmcnt(9)
L_vw0_21:
  buffer_load_dwordx4 v[60:63], v93, s[12:15], s61 offen offset:0 nt
  v_cvt_f32_i32 v108, v88
  v_cvt_f32_i32 v109, v89
  v_mov_b32_dpp v116, v114 row_newbcast:7 row_mask:0xf bank_mask:0xf
  v_mov_b32_dpp v117, v115 row_newbcast:7 row_mask:0xf bank_mask:0xf
  v_cvt_f32_i32 v110, v90
  v_cvt_f32_i32 v111, v91
  v_pk_add_f32 v[108:109], v[108:109], v[116:117] op_sel_hi:[1,0] neg_lo:[0,1] neg_hi:[0,1]
  v_pk_add_f32 v[110:111], v[110:111], v[116:117] op_sel_hi:[1,0] neg_lo:[0,1] neg_hi:[0,1]
  v_cvt_pk_bf16_f32 v108, 0, v108
  v_cvt_pk_bf16_f32 v109, 0, v109
  v_cvt_pk_bf16_f32 v110, 0, v110
  v_cvt_pk_bf16_f32 v111, 0, v111
  v_pk_mul_f32 v[108:109], v[108:109], v[116:117] op_sel:[0,1]
  v_pk_mul_f32 v[110:111], v[110:111], v[116:117] op_sel:[0,1]
  v_cvt_pk_bf16_f32 v207, v192, v108
  v_cvt_pk_bf16_f32 v211, v193, v109
  v_cvt_pk_bf16_f32 v215, v194, v110
  v_cvt_pk_bf16_f32 v219, v195, v111
  v_mfma_f32_16x16x32_bf16 v[128:131], v[168:171], v[204:207], v[128:131]
  v_mfma_f32_16x16x32_bf16 v[128:131], v[172:175], v[208:211], v[128:131]
  v_mfma_f32_16x16x32_bf16 v[128:131], v[176:179], v[212:215], v[128:131]
  v_mfma_f32_16x16x32_bf16 v[128:131], v[180:183], v[216:219], v[128:131]
  s_waitcnt vmcnt(14)
  buffer_load_dwordx4 v[64:67], v93, s[12:15], s61 offen offset:256 nt
  v_cvt_f32_i32 v108, v4
  v_cvt_f32_i32 v109, v5
  v_cvt_f32_i32 v110, v6
  v_cvt_f32_i32 v111, v7
  v_pk_add_f32 v[108:109], v[108:109], v[116:117] op_sel_hi:[1,0] neg_lo:[0,1] neg_hi:[0,1]
  v_pk_add_f32 v[110:111], v[110:111], v[116:117] op_sel_hi:[1,0] neg_lo:[0,1] neg_hi:[0,1]
  v_cvt_pk_bf16_f32 v108, 0, v108
  v_cvt_pk_bf16_f32 v109, 0, v109
  v_cvt_pk_bf16_f32 v110, 0, v110
  v_cvt_pk_bf16_f32 v111, 0, v111
  v_pk_mul_f32 v[108:109], v[108:109], v[116:117] op_sel:[0,1]
  v_pk_mul_f32 v[110:111], v[110:111], v[116:117] op_sel:[0,1]
  v_cvt_pk_bf16_f32 v223, v196, v108
  v_cvt_pk_bf16_f32 v227, v197, v109
  v_cvt_pk_bf16_f32 v231, v198, v110
  v_cvt_pk_bf16_f32 v235, v199, v111
  v_mfma_f32_16x16x32_bf16 v[132:135], v[168:171], v[220:223], v[132:135]
  v_mfma_f32_16x16x32_bf16 v[132:135], v[172:175], v[224:227], v[132:135]
  v_mfma_f32_16x16x32_bf16 v[132:135], v[176:179], v[228:231], v[132:135]
  v_mfma_f32_16x16x32_bf16 v[132:135], v[180:183], v[232:235], v[132:135]
  s_waitcnt vmcnt(14)
  buffer_load_dwordx4 v[68:71], v93, s[12:15], s61 offen offset:512 nt
  v_cvt_f32_i32 v108, v8
  v_cvt_f32_i32 v109, v9
  v_cvt_f32_i32 v110, v10
  v_cvt_f32_i32 v111, v11
  v_pk_add_f32 v[108:109], v[108:109], v[116:117] op_sel_hi:[1,0] neg_lo:[0,1] neg_hi:[0,1]
  v_pk_add_f32 v[110:111], v[110:111], v[116:117] op_sel_hi:[1,0] neg_lo:[0,1] neg_hi:[0,1]
  v_cvt_pk_bf16_f32 v108, 0, v108
  v_cvt_pk_bf16_f32 v109, 0, v109
  v_cvt_pk_bf16_f32 v110, 0, v110
  v_cvt_pk_bf16_f32 v111, 0, v111
  v_pk_mul_f32 v[108:109], v[108:109], v[116:117] op_sel:[0,1]
  v_pk_mul_f32 v[110:111], v[110:111], v[116:117] op_sel:[0,1]
  v_cvt_pk_bf16_f32 v239, v200, v108
  v_cvt_pk_bf16_f32 v243, v201, v109
  v_cvt_pk_bf16_f32 v247, v202, v110
  v_cvt_pk_bf16_f32 v251, v203, v111
  v_mfma_f32_16x16x32_bf16 v[136:139], v[168:171], v[236:239], v[136:139]
  v_mfma_f32_16x16x32_bf16 v[136:139], v[172:175], v[240:243], v[136:139]
  v_mfma_f32_16x16x32_bf16 v[136:139], v[176:179], v[244:247], v[136:139]
  v_mfma_f32_16x16x32_bf16 v[136:139], v[180:183], v[248:251], v[136:139]
  s_waitcnt vmcnt(14)
  s_cbranch_vccnz L_vw0_24
  s_waitcnt vmcnt(9)
L_vw0_24:
  buffer_load_dwordx4 v[72:75], v93, s[12:15], s61 offen offset:768 nt
  v_cvt_f32_i32 v192, v12
  v_cvt_f32_i32 v193, v13
  v_mov_b32_dpp v116, v114 row_newbcast:8 row_mask:0xf bank_mask:0xf
  v_mov_b32_dpp v117, v115 row_newbcast:8 row_mask:0xf bank_mask:0xf
  v_cvt_f32_i32 v194, v14
  v_cvt_f32_i32 v195, v15
  v_pk_add_f32 v[192:193], v[192:193], v[116:117] op_sel_hi:[1,0] neg_lo:[0,1] neg_hi:[0,1]
  v_pk_add_f32 v[194:195], v[194:195], v[116:117] op_sel_hi:[1,0] neg_lo:[0,1] neg_hi:[0,1]
  v_cvt_pk_bf16_f32 v192, 0, v192
  v_cndmask_b32 v184, 0, v163, s[72:73]
  v_cvt_pk_bf16_f32 v193, 0, v193
  v_cndmask_b32 v185, 0, v164, s[72:73]
  v_cvt_pk_bf16_f32 v194, 0, v194
  v_cndmask_b32 v186, 0, v163, s[74:75]
  v_cvt_pk_bf16_f32 v195, 0, v195
  v_cndmask_b32 v187, 0, v164, s[74:75]
  v_pk_mul_f32 v[192:193], v[192:193], v[116:117] op_sel:[0,1]
  v_cndmask_b32 v188, 0, v163, s[76:77]
  v_pk_mul_f32 v[194:195], v[194:195], v[116:117] op_sel:[0,1]
  s_waitcnt vmcnt(14)
  buffer_load_dwordx4 v[76:79], v93, s[12:15], s61 offen offset:1024 nt
  v_cvt_f32_i32 v196, v16
  v_cvt_f32_i32 v197, v17
  v_cvt_f32_i32 v198, v18
  v_cvt_f32_i32 v199, v19
  v_pk_add_f32 v[196:197], v[196:197], v[116:117] op_sel_hi:[1,0] neg_lo:[0,1] neg_hi:[0,1]
  v_pk_add_f32 v[198:199], v[198:199], v[116:117] op_sel_hi:[1,0] neg_lo:[0,1] neg_hi:[0,1]
  v_cvt_pk_bf16_f32 v196, 0, v196
  v_cndmask_b32 v189, 0, v164, s[76:77]
  v_cvt_pk_bf16_f32 v197, 0, v197
  v_cndmask_b32 v190, 0, v163, s[78:79]
  v_cvt_pk_bf16_f32 v198, 0, v198
  v_cndmask_b32 v191, 0, v164, s[78:79]
  v_cvt_pk_bf16_f32 v199, 0, v199
  v_pk_mul_f32 v[196:197], v[196:197], v[116:117] op_sel:[0,1]
  v_pk_mul_f32 v[198:199], v[198:199], v[116:117] op_sel:[0,1]
  s_waitcnt vmcnt(14)
  buffer_load_dwordx4 v[80:83], v93, s[12:15], s61 offen offset:1280 nt
  v_cvt_f32_i32 v200, v20
  v_cvt_f32_i32 v201, v21
  v_cvt_f32_i32 v202, v22
  v_cvt_f32_i32 v203, v23
  v_pk_add_f32 v[200:201], v[200:201], v[116:117] op_sel_hi:[1,0] neg_lo:[0,1] neg_hi:[0,1]
  v_pk_add_f32 v[202:203], v[202:203], v[116:117] op_sel_hi:[1,0] neg_lo:[0,1] neg_hi:[0,1]
  v_cvt_pk_bf16_f32 v200, 0, v200
  v_cvt_pk_bf16_f32 v201, 0, v201
  v_cvt_pk_bf16_f32 v202, 0, v202
  v_cvt_pk_bf16_f32 v203, 0, v203
  v_pk_mul_f32 v[200:201], v[200:201], v[116:117] op_sel:[0,1]
  v_pk_mul_f32 v[202:203], v[202:203], v[116:117] op_sel:[0,1]
  s_waitcnt vmcnt(14)
  s_cbranch_vccnz L_vw0_27
  s_waitcnt vmcnt(9)
L_vw0_27:
  buffer_load_dwordx4 v[84:87], v93, s[12:15], s61 offen offset:1536 nt
  v_cvt_f32_i32 v108, v24
  v_cvt_f32_i32 v109, v25
  v_mov_b32_dpp v116, v114 row_newbcast:9 row_mask:0xf bank_mask:0xf
  v_mov_b32_dpp v117, v115 row_newbcast:9 row_mask:0xf bank_mask:0xf
  v_cvt_f32_i32 v110, v26
  v_cvt_f32_i32 v111, v27
  v_pk_add_f32 v[108:109], v[108:109], v[116:117] op_sel_hi:[1,0] neg_lo:[0,1] neg_hi:[0,1]
  v_pk_add_f32 v[110:111], v[110:111], v[116:117] op_sel_hi:[1,0] neg_lo:[0,1] neg_hi:[0,1]
  v_cvt_pk_bf16_f32 v108, 0, v108
  v_cvt_pk_bf16_f32 v109, 0, v109
  v_cvt_pk_bf16_f32 v110, 0, v110
  v_cvt_pk_bf16_f32 v111, 0, v111
  v_pk_mul_f32 v[108:109], v[108:109], v[116:117] op_sel:[0,1]
  v_pk_mul_f32 v[110:111], v[110:111], v[116:117] op_sel:[0,1]
  v_cvt_pk_bf16_f32 v204, v192, v108
  v_cvt_pk_bf16_f32 v208, v193, v109
  v_cvt_pk_bf16_f32 v212, v194, v110
  v_cvt_pk_bf16_f32 v216, v195, v111
  s_waitcnt vmcnt(14)
  buffer_load_dwordx4 v[88:91], v93, s[12:15], s61 offen offset:1792 nt
  v_cvt_f32_i32 v108, v28
  v_cvt_f32_i32 v109, v29
  v_cvt_f32_i32 v110, v30
  v_cvt_f32_i32 v111, v31
  v_pk_add_f32 v[108:109], v[108:109], v[116:117] op_sel_hi:[1,0] neg_lo:[0,1] neg_hi:[0,1]
  v_pk_add_f32 v[110:111], v[110:111], v[116:117] op_sel_hi:[1,0] neg_lo:[0,1] neg_hi:[0,1]
  v_cvt_pk_bf16_f32 v108, 0, v108
  v_cvt_pk_bf16_f32 v109, 0, v109
  v_cvt_pk_bf16_f32 v110, 0, v110
  v_cvt_pk_bf16_f32 v111, 0, v111
  v_pk_mul_f32 v[108:109], v[108:109], v[116:117] op_sel:[0,1]
  v_pk_mul_f32 v[110:111], v[110:111], v[116:117] op_sel:[0,1]
  v_cvt_pk_bf16_f32 v220, v196, v108
  v_cvt_pk_bf16_f32 v224, v197, v109
  v_cvt_pk_bf16_f32 v228, v198, v110
  v_cvt_pk_bf16_f32 v232, v199, v111
  s_waitcnt vmcnt(14)
  buffer_load_dwordx4 v[4:7], v93, s[12:15], s61 offen offset:2048 nt
  v_cvt_f32_i32 v108, v32
  v_cvt_f32_i32 v109, v33
  v_cvt_f32_i32 v110, v34
  v_cvt_f32_i32 v111, v35
  v_pk_add_f32 v[108:109], v[108:109], v[116:117] op_sel_hi:[1,0] neg_lo:[0,1] neg_hi:[0,1]
  v_pk_add_f32 v[110:111], v[110:111], v[116:117] op_sel_hi:[1,0] neg_lo:[0,1] neg_hi:[0,1]
  v_cvt_pk_bf16_f32 v108, 0, v108
  v_cvt_pk_bf16_f32 v109, 0, v109
  v_cvt_pk_bf16_f32 v110, 0, v110
  v_cvt_pk_bf16_f32 v111, 0, v111
  v_pk_mul_f32 v[108:109], v[108:109], v[116:117] op_sel:[0,1]
  v_pk_mul_f32 v[110:111], v[110:111], v[116:117] op_sel:[0,1]
  v_cvt_pk_bf16_f32 v236, v200, v108
  v_cvt_pk_bf16_f32 v240, v201, v109
  v_cvt_pk_bf16_f32 v244, v202, v110
  v_cvt_pk_bf16_f32 v248, v203, v111
  s_waitcnt vmcnt(14)
  s_cbranch_vccnz L_vw0_30
  s_waitcnt vmcnt(9)
L_vw0_30:
  buffer_load_dwordx4 v[8:11], v93, s[12:15], s61 offen offset:2304 nt
  v_cvt_f32_i32 v192, v36
  v_cvt_f32_i32 v193, v37
  v_mov_b32_dpp v116, v114 row_newbcast:10 row_mask:0xf bank_mask:0xf
  v_mov_b32_dpp v117, v115 row_newbcast:10 row_mask:0xf bank_mask:0xf
  v_cvt_f32_i32 v194, v38
  v_cvt_f32_i32 v195, v39
  v_pk_add_f32 v[192:193], v[192:193], v[116:117] op_sel_hi:[1,0] neg_lo:[0,1] neg_hi:[0,1]
  v_pk_add_f32 v[194:195], v[194:195], v[116:117] op_sel_hi:[1,0] neg_lo:[0,1] neg_hi:[0,1]
  v_cvt_pk_bf16_f32 v192, 0, v192
  v_cvt_pk_bf16_f32 v193, 0, v193
  v_cvt_pk_bf16_f32 v194, 0, v194
  v_cvt_pk_bf16_f32 v195, 0, v195
  v_pk_mul_f32 v[192:193], v[192:193], v[116:117] op_sel:[0,1]
  v_pk_mul_f32 v[194:195], v[194:195], v[116:117] op_sel:[0,1]
  v_cvt_pk_bf16_f32 v205, v192, 0
  v_cvt_pk_bf16_f32 v209, v193, 0
  v_cvt_pk_bf16_f32 v213, v194, 0
  v_cvt_pk_bf16_f32 v217, v195, 0
  v_mfma_f32_16x16x16_bf16 v[128:131], v[184:185], v[204:205], v[128:131]
  v_mfma_f32_16x16x16_bf16 v[128:131], v[186:187], v[208:209], v[128:131]
  v_mfma_f32_16x16x16_bf16 v[128:131], v[188:189], v[212:213], v[128:131]
  v_mfma_f32_16x16x16_bf16 v[128:131], v[190:191], v[216:217], v[128:131]
  s_waitcnt vmcnt(14)
  buffer_load_dwordx4 v[12:15], v93, s[12:15], s61 offen offset:2560 nt
  v_cvt_f32_i32 v196, v40
  v_cvt_f32_i32 v197, v41
  v_cvt_f32_i32 v198, v42
  v_cvt_f32_i32 v199, v43
  v_pk_add_f32 v[196:197], v[196:197], v[116:117] op_sel_hi:[1,0] neg_lo:[0,1] neg_hi:[0,1]
  v_pk_add_f32 v[198:199], v[198:199], v[116:117] op_sel_hi:[1,0] neg_lo:[0,1] neg_hi:[0,1]
  v_cvt_pk_bf16_f32 v196, 0, v196
  v_cvt_pk_bf16_f32 v197, 0, v197
  v_cvt_pk_bf16_f32 v198, 0, v198
  v_cvt_pk_bf16_f32 v199, 0, v199
  v_pk_mul_f32 v[196:197], v[196:197], v[116:117] op_sel:[0,1]
  v_pk_mul_f32 v[198:199], v[198:199], v[116:117] op_sel:[0,1]
  v_cvt_pk_bf16_f32 v221, v196, 0
  v_cvt_pk_bf16_f32 v225, v197, 0
  v_cvt_pk_bf16_f32 v229, v198, 0
  v_cvt_pk_bf16_f32 v233, v199, 0
  v_mfma_f32_16x16x16_bf16 v[132:135], v[184:185], v[220:221], v[132:135]
  v_mfma_f32_16x16x16_bf16 v[132:135], v[186:187], v[224:225], v[132:135]
  v_mfma_f32_16x16x16_bf16 v[132:135], v[188:189], v[228:229], v[132:135]
  v_mfma_f32_16x16x16_bf16 v[132:135], v[190:191], v[232:233], v[132:135]
  s_waitcnt vmcnt(14)
  buffer_load_dwordx4 v[16:19], v93, s[12:15], s61 offen offset:2816 nt
  v_cvt_f32_i32 v200, v44
  v_cvt_f32_i32 v201, v45
  v_cvt_f32_i32 v202, v46
  v_cvt_f32_i32 v203, v47
  v_pk_add_f32 v[200:201], v[200:201], v[116:117] op_sel_hi:[1,0] neg_lo:[0,1] neg_hi:[0,1]
  v_pk_add_f32 v[202:203], v[202:203], v[116:117] op_sel_hi:[1,0] neg_lo:[0,1] neg_hi:[0,1]
  v_cvt_pk_bf16_f32 v200, 0, v200
  v_cvt_pk_bf16_f32 v201, 0, v201
  v_cvt_pk_bf16_f32 v202, 0, v202
  v_cvt_pk_bf16_f32 v203, 0, v203
  v_pk_mul_f32 v[200:201], v[200:201], v[116:117] op_sel:[0,1]
  v_pk_mul_f32 v[202:203], v[202:203], v[116:117] op_sel:[0,1]
  v_cvt_pk_bf16_f32 v237, v200, 0
  v_cvt_pk_bf16_f32 v241, v201, 0
  v_cvt_pk_bf16_f32 v245, v202, 0
  v_cvt_pk_bf16_f32 v249, v203, 0
  v_mfma_f32_16x16x16_bf16 v[136:139], v[184:185], v[236:237], v[136:139]
  v_mfma_f32_16x16x16_bf16 v[136:139], v[186:187], v[240:241], v[136:139]
  v_mfma_f32_16x16x16_bf16 v[136:139], v[188:189], v[244:245], v[136:139]
  v_mfma_f32_16x16x16_bf16 v[136:139], v[190:191], v[248:249], v[136:139]
  s_mov_b32 s60, s61
L_v1:
  s_add_u32 s97, s64, 96
  v_mov_b32 v146, s97
  s_mov_b32 s86, s84
  ds_write_b32 v104, v146
  s_add_u32 s64, s64, 2
  s_cmp_lt_u32 s64, s99
  s_cbranch_scc1 L_v11_ok
L_v11_spin:
  v_mov_b32 v144, 61700
  ds_read_b32 v144, v144
  s_waitcnt lgkmcnt(0)
  v_readfirstlane_b32 s99, v144
  s_nop 1
  s_cmp_lt_u32 s64, s99
  s_cbranch_scc0 L_v11_spin
L_v11_ok:
  s_lshr_b32 s71, s64, 5
  s_lshr_b32 s85, s96, s71
  s_bfe_u32 s85, s85, 0x10003
  s_and_b32 s70, s64, 31
  s_lshl_b32 s71, s71, 12
  s_add_u32 s70, s70, s5
  s_add_u32 s70, s70, s71
  s_mul_hi_u32 s84, s70, s90
  s_lshr_b32 s84, s84, 1
  s_mul_i32 s71, s84, 3
  s_sub_u32 s70, s70, s71
  s_lshl3_add_u32 s85, s70, s85
  s_mul_i32 s61, s84, 196608
  s_lshr_b32 s89, s84, 4
  s_lshl_b32 s70, s85, 5
  v_add_u32 v97, s70, v1
  v_mul_u32_u24 v97, 21846, v97
  v_lshrrev_b32 v97, 16, v97
  v_add_u32 v144, s85, v2
  v_lshrrev_b32 v145, v144, s91
  v_and_b32 v145, 1, v145
  v_cmp_eq_u32 s[54:55], 1, v145
  s_nop 1
  s_and_b64 s[52:53], s[54:55], s[58:59]
  s_andn2_b64 s[54:55], s[54:55], s[58:59]
  s_cmp_lt_u32 s64, 96
  s_cselect_b32 s61, s61, 805306368
  s_lshr_b32 s70, s64, 1
  s_cmp_eq_u32 s70, 32
  s_cselect_b32 s48, -36096, s63
  ds_read_b32 v106, v104 offset:8
  s_waitcnt vmcnt(14)
  s_cbranch_vccnz L_vw1_0
  s_waitcnt vmcnt(9)
L_vw1_0:
  buffer_load_dwordx4 v[20:23], v93, s[12:15], s60 offen offset:3072 nt
  v_mov_b32 v114, v112
  v_mov_b32 v115, v113
  v_cvt_f32_i32 v192, v48
  v_cvt_f32_i32 v193, v49
  v_mov_b32_dpp v116, v114 row_newbcast:0 row_mask:0xf bank_mask:0xf
  v_mov_b32_dpp v117, v115 row_newbcast:0 row_mask:0xf bank_mask:0xf
  v_cvt_f32_i32 v194, v50
  v_cvt_f32_i32 v195, v51
  v_pk_add_f32 v[192:193], v[192:193], v[116:117] op_sel_hi:[1,0] neg_lo:[0,1] neg_hi:[0,1]
  v_pk_add_f32 v[194:195], v[194:195], v[116:117] op_sel_hi:[1,0] neg_lo:[0,1] neg_hi:[0,1]
  v_cvt_pk_bf16_f32 v192, 0, v192
  v_cvt_pk_bf16_f32 v193, 0, v193
  v_cvt_pk_bf16_f32 v194, 0, v194
  v_cvt_pk_bf16_f32 v195, 0, v195
  v_pk_mul_f32 v[192:193], v[192:193], v[116:117] op_sel:[0,1]
  v_pk_mul_f32 v[194:195], v[194:195], v[116:117] op_sel:[0,1]
  s_waitcnt lgkmcnt(0)
  v_cmp_lt_u32 vcc, s97, v106
  s_waitcnt vmcnt(14)
  buffer_load_dwordx4 v[24:27], v93, s[12:15], s60 offen offset:3328 nt
  v_cvt_f32_i32 v196, v52
  v_cvt_f32_i32 v197, v53
  v_cvt_f32_i32 v198, v54
  v_cvt_f32_i32 v199, v55
  v_pk_add_f32 v[196:197], v[196:197], v[116:117] op_sel_hi:[1,0] neg_lo:[0,1] neg_hi:[0,1]
  v_pk_add_f32 v[198:199], v[198:199], v[116:117] op_sel_hi:[1,0] neg_lo:[0,1] neg_hi:[0,1]
  v_cvt_pk_bf16_f32 v196, 0, v196
  v_lshlrev_b32 v148, 16, v120
  v_cvt_pk_bf16_f32 v197, 0, v197
  v_and_b32 v149, s65, v120
  v_cvt_pk_bf16_f32 v198, 0, v198
  v_lshlrev_b32 v150, 16, v121
  v_cvt_pk_bf16_f32 v199, 0, v199
  v_and_b32 v151, s65, v121
  v_pk_mul_f32 v[196:197], v[196:197], v[116:117] op_sel:[0,1]
  v_lshlrev_b32 v152, 16, v122
  v_pk_mul_f32 v[198:199], v[198:199], v[116:117] op_sel:[0,1]
  s_waitcnt vmcnt(14)
  buffer_load_dwordx4 v[28:31], v93, s[12:15], s60 offen offset:3584 nt
  v_cvt_f32_i32 v200, v56
  v_cvt_f32_i32 v201, v57
  v_cvt_f32_i32 v202, v58
  v_cvt_f32_i32 v203, v59
  v_pk_add_f32 v[200:201], v[200:201], v[116:117] op_sel_hi:[1,0] neg_lo:[0,1] neg_hi:[0,1]
  v_pk_add_f32 v[202:203], v[202:203], v[116:117] op_sel_hi:[1,0] neg_lo:[0,1] neg_hi:[0,1]
  v_cvt_pk_bf16_f32 v200, 0, v200
  v_and_b32 v153, s65, v122
  v_cvt_pk_bf16_f32 v201, 0, v201
  v_lshlrev_b32 v154, 16, v123
  v_cvt_pk_bf16_f32 v202, 0, v202
  v_and_b32 v155, s65, v123
  v_cvt_pk_bf16_f32 v203, 0, v203
  v_lshlrev_b32 v156, 16, v124
  v_pk_mul_f32 v[200:201], v[200:201], v[116:117] op_sel:[0,1]
  v_and_b32 v157, s65, v124
  v_pk_mul_f32 v[202:203], v[202:203], v[116:117] op_sel:[0,1]
  s_waitcnt vmcnt(14)
  s_cbranch_vccnz L_vw1_3
  s_waitcnt vmcnt(9)
L_vw1_3:
  buffer_load_dwordx4 v[32:35], v94, s[12:15], s60 offen offset:0 nt
  v_cvt_f32_i32 v108, v60
  v_cvt_f32_i32 v109, v61
  v_mov_b32_dpp v116, v114 row_newbcast:1 row_mask:0xf bank_mask:0xf
  v_mov_b32_dpp v117, v115 row_newbcast:1 row_mask:0xf bank_mask:0xf
  v_cvt_f32_i32 v110, v62
  v_cvt_f32_i32 v111, v63
  v_pk_add_f32 v[108:109], v[108:109], v[116:117] op_sel_hi:[1,0] neg_lo:[0,1] neg_hi:[0,1]
  v_pk_add_f32 v[110:111], v[110:111], v[116:117] op_sel_hi:[1,0] neg_lo:[0,1] neg_hi:[0,1]
  s_lshl_b32 s62, s84, 9
  v_lshl_add_u32 v98, v97, 1, v96
  buffer_load_short_d16_hi v112, v98, s[32:35], s62 offen
  buffer_load_short_d16_hi v113, v98, s[28:31], s62 offen
  v_cvt_pk_bf16_f32 v108, 0, v108
  v_lshlrev_b32 v158, 16, v125
  v_cvt_pk_bf16_f32 v109, 0, v109
  v_add_u32 v99, s48, v99
  v_cvt_pk_bf16_f32 v110, 0, v110
  v_add_u32 v100, s48, v100
  v_cvt_pk_bf16_f32 v111, 0, v111
  v_max3_f32 v144, v148, v149, v150
  v_pk_mul_f32 v[108:109], v[108:109], v[116:117] op_sel:[0,1]
  ds_read_b128 v[120:123], v99
  v_pk_mul_f32 v[110:111], v[110:111], v[116:117] op_sel:[0,1]
  v_cvt_pk_bf16_f32 v204, v192, v108
  v_cvt_pk_bf16_f32 v208, v193, v109
  v_cvt_pk_bf16_f32 v212, v194, v110
  v_cvt_pk_bf16_f32 v216, v195, v111
  s_waitcnt vmcnt(16)
  buffer_load_dwordx4 v[36:39], v94, s[12:15], s60 offen offset:256 nt
  v_cvt_f32_i32 v108, v64
  v_cvt_f32_i32 v109, v65
  v_cvt_f32_i32 v110, v66
  v_cvt_f32_i32 v111, v67
  v_pk_add_f32 v[108:109], v[108:109], v[116:117] op_sel_hi:[1,0] neg_lo:[0,1] neg_hi:[0,1]
  v_pk_add_f32 v[110:111], v[110:111], v[116:117] op_sel_hi:[1,0] neg_lo:[0,1] neg_hi:[0,1]
  v_cvt_pk_bf16_f32 v108, 0, v108
  ds_read_b64 v[124:125], v100 offset:256
  v_cvt_pk_bf16_f32 v109, 0, v109
  v_max3_f32 v145, v151, v152, v153
  v_cvt_pk_bf16_f32 v110, 0, v110
  v_max3_f32 v144, v144, v154, v155
  v_cvt_pk_bf16_f32 v111, 0, v111
  v_max3_f32 v145, v145, v156, v157
  v_pk_mul_f32 v[108:109], v[108:109], v[116:117] op_sel:[0,1]
  v_max3_f32 v144, v144, v158, v140
  v_pk_mul_f32 v[110:111], v[110:111], v[116:117] op_sel:[0,1]
  v_cvt_pk_bf16_f32 v220, v196, v108
  v_cvt_pk_bf16_f32 v224, v197, v109
  v_cvt_pk_bf16_f32 v228, v198, v110
  v_cvt_pk_bf16_f32 v232, v199, v111
  s_waitcnt vmcnt(16)
  buffer_load_dwordx4 v[40:43], v94, s[12:15], s60 offen offset:512 nt
  v_cvt_f32_i32 v108, v68
  v_cvt_f32_i32 v109, v69
  v_cvt_f32_i32 v110, v70
  v_cvt_f32_i32 v111, v71
  v_pk_add_f32 v[108:109], v[108:109], v[116:117] op_sel_hi:[1,0] neg_lo:[0,1] neg_hi:[0,1]
  v_pk_add_f32 v[110:111], v[110:111], v[116:117] op_sel_hi:[1,0] neg_lo:[0,1] neg_hi:[0,1]
  v_cvt_pk_bf16_f32 v108, 0, v108
  v_max_f32 v144, v144, v145
  v_cvt_pk_bf16_f32 v109, 0, v109
  v_mov_b32 v145, v144
  v_cvt_pk_bf16_f32 v110, 0, v110
  s_nop 0
  v_permlane32_swap_b32 v144, v145
  v_cvt_pk_bf16_f32 v111, 0, v111
  v_max_f32 v144, v144, v145
  v_pk_mul_f32 v[108:109], v[108:109], v[116:117] op_sel:[0,1]
  v_mov_b32 v145, v144
  v_pk_mul_f32 v[110:111], v[110:111], v[116:117] op_sel:[0,1]
  v_cvt_pk_bf16_f32 v236, v200, v108
  v_cvt_pk_bf16_f32 v240, v201, v109
  v_cvt_pk_bf16_f32 v244, v202, v110
  v_cvt_pk_bf16_f32 v248, v203, v111
  s_waitcnt vmcnt(16)
  s_cbranch_vccnz L_vw1_6
  s_waitcnt vmcnt(11)
L_vw1_6:
  buffer_load_dwordx4 v[44:47], v94, s[12:15], s60 offen offset:768 nt
  v_cvt_f32_i32 v192, v72
  v_cvt_f32_i32 v193, v73
  v_mov_b32_dpp v116, v114 row_newbcast:2 row_mask:0xf bank_mask:0xf
  v_mov_b32_dpp v117, v115 row_newbcast:2 row_mask:0xf bank_mask:0xf
  v_cvt_f32_i32 v194, v74
  v_cvt_f32_i32 v195, v75
  v_pk_add_f32 v[192:193], v[192:193], v[116:117] op_sel_hi:[1,0] neg_lo:[0,1] neg_hi:[0,1]
  v_pk_add_f32 v[194:195], v[194:195], v[116:117] op_sel_hi:[1,0] neg_lo:[0,1] neg_hi:[0,1]
  v_cvt_pk_bf16_f32 v192, 0, v192
  v_permlane16_swap_b32 v144, v145
  v_cvt_pk_bf16_f32 v193, 0, v193
  v_max_f32 v140, v144, v145
  v_cvt_pk_bf16_f32 v194, 0, v194
  v_mul_f32 v144, s66, v140
  v_cvt_pk_bf16_f32 v195, 0, v195
  v_add_f32 v146, v144, v142
  v_pk_mul_f32 v[192:193], v[192:193], v[116:117] op_sel:[0,1]
  v_sub_f32 v142, 0, v144
  v_pk_mul_f32 v[194:195], v[194:195], v[116:117] op_sel:[0,1]
  s_waitcnt vmcnt(16)
  buffer_load_dwordx4 v[48:51], v94, s[12:15], s60 offen offset:1024 nt
  v_cvt_f32_i32 v196, v76
  v_cvt_f32_i32 v197, v77
  v_cvt_f32_i32 v198, v78
  v_cvt_f32_i32 v199, v79
  v_pk_add_f32 v[196:197], v[196:197], v[116:117] op_sel_hi:[1,0] neg_lo:[0,1] neg_hi:[0,1]
  v_pk_add_f32 v[198:199], v[198:199], v[116:117] op_sel_hi:[1,0] neg_lo:[0,1] neg_hi:[0,1]
  v_cvt_pk_bf16_f32 v196, 0, v196
  v_exp_f32 v146, -v146
  v_cvt_pk_bf16_f32 v197, 0, v197
  ds_bpermute_b32 v147, v101, v146
  v_cvt_pk_bf16_f32 v198, 0, v198
  v_fma_f32 v148, v148, s66, v142
  v_cvt_pk_bf16_f32 v199, 0, v199
  v_exp_f32 v148, v148
  v_pk_mul_f32 v[196:197], v[196:197], v[116:117] op_sel:[0,1]
  v_fma_f32 v149, v149, s66, v142
  v_pk_mul_f32 v[198:199], v[198:199], v[116:117] op_sel:[0,1]
  s_waitcnt vmcnt(16)
  buffer_load_dwordx4 v[52:55], v94, s[12:15], s60 offen offset:1280 nt
  v_cvt_f32_i32 v200, v80
  v_cvt_f32_i32 v201, v81
  v_cvt_f32_i32 v202, v82
  v_cvt_f32_i32 v203, v83
  v_pk_add_f32 v[200:201], v[200:201], v[116:117] op_sel_hi:[1,0] neg_lo:[0,1] neg_hi:[0,1]
  v_pk_add_f32 v[202:203], v[202:203], v[116:117] op_sel_hi:[1,0] neg_lo:[0,1] neg_hi:[0,1]
  v_cvt_pk_bf16_f32 v200, 0, v200
  v_exp_f32 v149, v149
  v_cvt_pk_bf16_f32 v201, 0, v201
  v_fma_f32 v150, v150, s66, v142
  v_cvt_pk_bf16_f32 v202, 0, v202
  v_exp_f32 v150, v150
  v_cvt_pk_bf16_f32 v203, 0, v203
  v_fma_f32 v151, v151, s66, v142
  v_pk_mul_f32 v[200:201], v[200:201], v[116:117] op_sel:[0,1]
  v_exp_f32 v151, v151
  v_pk_mul_f32 v[202:203], v[202:203], v[116:117] op_sel:[0,1]
  s_waitcnt vmcnt(16)
  s_cbranch_vccnz L_vw1_9
  s_waitcnt vmcnt(11)
L_vw1_9:
  buffer_load_dwordx4 v[56:59], v94, s[12:15], s60 offen offset:1536 nt
  v_cvt_f32_i32 v108, v84
  v_cvt_f32_i32 v109, v85
  v_mov_b32_dpp v116, v114 row_newbcast:3 row_mask:0xf bank_mask:0xf
  v_mov_b32_dpp v117, v115 row_newbcast:3 row_mask:0xf bank_mask:0xf
  v_cvt_f32_i32 v110, v86
  v_cvt_f32_i32 v111, v87
  v_pk_add_f32 v[108:109], v[108:109], v[116:117] op_sel_hi:[1,0] neg_lo:[0,1] neg_hi:[0,1]
  v_pk_add_f32 v[110:111], v[110:111], v[116:117] op_sel_hi:[1,0] neg_lo:[0,1] neg_hi:[0,1]
  v_cvt_pk_bf16_f32 v108, 0, v108
  v_fma_f32 v152, v152, s66, v142
  v_cvt_pk_bf16_f32 v109, 0, v109
  v_exp_f32 v152, v152
  v_cvt_pk_bf16_f32 v110, 0, v110
  v_fma_f32 v153, v153, s66, v142
  v_cvt_pk_bf16_f32 v111, 0, v111
  v_exp_f32 v153, v153
  v_pk_mul_f32 v[108:109], v[108:109], v[116:117] op_sel:[0,1]
  v_fma_f32 v154, v154, s66, v142
  v_pk_mul_f32 v[110:111], v[110:111], v[116:117] op_sel:[0,1]
  v_cvt_pk_bf16_f32 v205, v192, v108
  v_cvt_pk_bf16_f32 v209, v193, v109
  v_cvt_pk_bf16_f32 v213, v194, v110
  v_cvt_pk_bf16_f32 v217, v195, v111
  s_waitcnt vmcnt(16)
  buffer_load_dwordx4 v[60:63], v94, s[12:15], s60 offen offset:1792 nt
  v_cvt_f32_i32 v108, v88
  v_cvt_f32_i32 v109, v89
  v_cvt_f32_i32 v110, v90
  v_cvt_f32_i32 v111, v91
  v_pk_add_f32 v[108:109], v[108:109], v[116:117] op_sel_hi:[1,0] neg_lo:[0,1] neg_hi:[0,1]
  v_pk_add_f32 v[110:111], v[110:111], v[116:117] op_sel_hi:[1,0] neg_lo:[0,1] neg_hi:[0,1]
  v_cvt_pk_bf16_f32 v108, 0, v108
  v_exp_f32 v154, v154
  v_cvt_pk_bf16_f32 v109, 0, v109
  v_fma_f32 v155, v155, s66, v142
  v_cvt_pk_bf16_f32 v110, 0, v110
  v_exp_f32 v155, v155
  v_cvt_pk_bf16_f32 v111, 0, v111
  v_fma_f32 v156, v156, s66, v142
  v_pk_mul_f32 v[108:109], v[108:109], v[116:117] op_sel:[0,1]
  v_exp_f32 v156, v156
  v_pk_mul_f32 v[110:111], v[110:111], v[116:117] op_sel:[0,1]
  v_cvt_pk_bf16_f32 v221, v196, v108
  v_cvt_pk_bf16_f32 v225, v197, v109
  v_cvt_pk_bf16_f32 v229, v198, v110
  v_cvt_pk_bf16_f32 v233, v199, v111
  s_waitcnt vmcnt(16)
  buffer_load_dwordx4 v[64:67], v94, s[12:15], s60 offen offset:2048 nt
  v_cvt_f32_i32 v108, v4
  v_cvt_f32_i32 v109, v5
  v_cvt_f32_i32 v110, v6
  v_cvt_f32_i32 v111, v7
  v_pk_add_f32 v[108:109], v[108:109], v[116:117] op_sel_hi:[1,0] neg_lo:[0,1] neg_hi:[0,1]
  v_pk_add_f32 v[110:111], v[110:111], v[116:117] op_sel_hi:[1,0] neg_lo:[0,1] neg_hi:[0,1]
  v_cvt_pk_bf16_f32 v108, 0, v108
  v_fma_f32 v157, v157, s66, v142
  v_cvt_pk_bf16_f32 v109, 0, v109
  v_exp_f32 v157, v157
  v_cvt_pk_bf16_f32 v110, 0, v110
  v_fma_f32 v158, v158, s66, v142
  v_cvt_pk_bf16_f32 v111, 0, v111
  v_exp_f32 v158, v158
  v_pk_mul_f32 v[108:109], v[108:109], v[116:117] op_sel:[0,1]
  v_add_f32 v144, v148, v149
  v_pk_mul_f32 v[110:111], v[110:111], v[116:117] op_sel:[0,1]
  v_cvt_pk_bf16_f32 v237, v200, v108
  v_cvt_pk_bf16_f32 v241, v201, v109
  v_cvt_pk_bf16_f32 v245, v202, v110
  v_cvt_pk_bf16_f32 v249, v203, v111
  s_waitcnt vmcnt(16)
  s_cbranch_vccnz L_vw1_12
  s_waitcnt vmcnt(11)
L_vw1_12:
  buffer_load_dwordx4 v[68:71], v94, s[12:15], s60 offen offset:2304 nt
  v_cvt_f32_i32 v192, v8
  v_cvt_f32_i32 v193, v9
  v_mov_b32_dpp v116, v114 row_newbcast:4 row_mask:0xf bank_mask:0xf
  v_mov_b32_dpp v117, v115 row_newbcast:4 row_mask:0xf bank_mask:0xf
  v_cvt_f32_i32 v194, v10
  v_cvt_f32_i32 v195, v11
  v_pk_add_f32 v[192:193], v[192:193], v[116:117] op_sel_hi:[1,0] neg_lo:[0,1] neg_hi:[0,1]
  v_pk_add_f32 v[194:195], v[194:195], v[116:117] op_sel_hi:[1,0] neg_lo:[0,1] neg_hi:[0,1]
  v_cvt_pk_bf16_f32 v192, 0, v192
  v_add_f32 v145, v150, v151
  v_cvt_pk_bf16_f32 v193, 0, v193
  v_add_f32 v144, v144, v152
  v_cvt_pk_bf16_f32 v194, 0, v194
  v_add_f32 v145, v145, v153
  v_cvt_pk_bf16_f32 v195, 0, v195
  v_add_f32 v144, v144, v154
  v_pk_mul_f32 v[192:193], v[192:193], v[116:117] op_sel:[0,1]
  v_add_f32 v145, v145, v155
  v_pk_mul_f32 v[194:195], v[194:195], v[116:117] op_sel:[0,1]
  s_waitcnt vmcnt(16)
  buffer_load_dwordx4 v[72:75], v94, s[12:15], s60 offen offset:2560 nt
  v_cvt_f32_i32 v196, v12
  v_cvt_f32_i32 v197, v13
  v_cvt_f32_i32 v198, v14
  v_cvt_f32_i32 v199, v15
  v_pk_add_f32 v[196:197], v[196:197], v[116:117] op_sel_hi:[1,0] neg_lo:[0,1] neg_hi:[0,1]
  v_pk_add_f32 v[198:199], v[198:199], v[116:117] op_sel_hi:[1,0] neg_lo:[0,1] neg_hi:[0,1]
  v_cvt_pk_bf16_f32 v196, 0, v196
  v_add_f32 v144, v144, v156
  v_cvt_pk_bf16_f32 v197, 0, v197
  v_add_f32 v145, v145, v157
  v_cvt_pk_bf16_f32 v198, 0, v198
  v_add_f32 v144, v144, v158
  v_cvt_pk_bf16_f32 v199, 0, v199
  v_add_f32 v144, v144, v145
  v_pk_mul_f32 v[196:197], v[196:197], v[116:117] op_sel:[0,1]
  v_fma_f32 v143, v143, v146, v144
  v_pk_mul_f32 v[198:199], v[198:199], v[116:117] op_sel:[0,1]
  s_waitcnt vmcnt(16)
  buffer_load_dwordx4 v[76:79], v94, s[12:15], s60 offen offset:2816 nt
  v_cvt_f32_i32 v200, v16
  v_cvt_f32_i32 v201, v17
  v_cvt_f32_i32 v202, v18
  v_cvt_f32_i32 v203, v19
  v_pk_add_f32 v[200:201], v[200:201], v[116:117] op_sel_hi:[1,0] neg_lo:[0,1] neg_hi:[0,1]
  v_pk_add_f32 v[202:203], v[202:203], v[116:117] op_sel_hi:[1,0] neg_lo:[0,1] neg_hi:[0,1]
  v_cvt_pk_bf16_f32 v200, 0, v200
  v_cvt_pk_bf16_f32 v159, v148, v149
  v_cvt_pk_bf16_f32 v201, 0, v201
  v_cvt_pk_bf16_f32 v160, v150, v151
  v_cvt_pk_bf16_f32 v202, 0, v202
  v_cvt_pk_bf16_f32 v161, v152, v153
  v_cvt_pk_bf16_f32 v203, 0, v203
  v_cvt_pk_bf16_f32 v162, v154, v155
  v_pk_mul_f32 v[200:201], v[200:201], v[116:117] op_sel:[0,1]
  v_cvt_pk_bf16_f32 v163, v156, v157
  v_pk_mul_f32 v[202:203], v[202:203], v[116:117] op_sel:[0,1]
  s_waitcnt vmcnt(16)
  s_cbranch_vccnz L_vw1_15
  s_waitcnt vmcnt(9)
L_vw1_15:
  buffer_load_dwordx4 v[80:83], v95, s[12:15], s60 offen offset:0 nt
  v_cvt_f32_i32 v108, v20
  v_cvt_f32_i32 v109, v21
  v_mov_b32_dpp v116, v114 row_newbcast:5 row_mask:0xf bank_mask:0xf
  v_mov_b32_dpp v117, v115 row_newbcast:5 row_mask:0xf bank_mask:0xf
  v_cvt_f32_i32 v110, v22
  v_cvt_f32_i32 v111, v23
  v_pk_add_f32 v[108:109], v[108:109], v[116:117] op_sel_hi:[1,0] neg_lo:[0,1] neg_hi:[0,1]
  v_pk_add_f32 v[110:111], v[110:111], v[116:117] op_sel_hi:[1,0] neg_lo:[0,1] neg_hi:[0,1]
  v_cvt_pk_bf16_f32 v108, 0, v108
  v_cvt_pk_bf16_f32 v164, v158, 0
  v_cvt_pk_bf16_f32 v109, 0, v109
  v_cndmask_b32 v168, 0, v159, s[72:73]
  v_cvt_pk_bf16_f32 v110, 0, v110
  v_cndmask_b32 v169, 0, v160, s[72:73]
  v_cvt_pk_bf16_f32 v111, 0, v111
  v_cndmask_b32 v170, 0, v161, s[72:73]
  v_pk_mul_f32 v[108:109], v[108:109], v[116:117] op_sel:[0,1]
  v_cndmask_b32 v171, 0, v162, s[72:73]
  v_pk_mul_f32 v[110:111], v[110:111], v[116:117] op_sel:[0,1]
  v_cvt_pk_bf16_f32 v206, v192, v108
  v_cvt_pk_bf16_f32 v210, v193, v109
  v_cvt_pk_bf16_f32 v214, v194, v110
  v_cvt_pk_bf16_f32 v218, v195, v111
  s_waitcnt vmcnt(16)
  buffer_load_dwordx4 v[84:87], v95, s[12:15], s60 offen offset:256 nt
  v_cvt_f32_i32 v108, v24
  v_cvt_f32_i32 v109, v25
  v_cvt_f32_i32 v110, v26
  v_cvt_f32_i32 v111, v27
  v_pk_add_f32 v[108:109], v[108:109], v[116:117] op_sel_hi:[1,0] neg_lo:[0,1] neg_hi:[0,1]
  v_pk_add_f32 v[110:111], v[110:111], v[116:117] op_sel_hi:[1,0] neg_lo:[0,1] neg_hi:[0,1]
  v_cvt_pk_bf16_f32 v108, 0, v108
  v_cndmask_b32 v172, 0, v159, s[74:75]
  v_cvt_pk_bf16_f32 v109, 0, v109
  v_cndmask_b32 v173, 0, v160, s[74:75]
  v_cvt_pk_bf16_f32 v110, 0, v110
  v_cndmask_b32 v174, 0, v161, s[74:75]
  v_cvt_pk_bf16_f32 v111, 0, v111
  v_cndmask_b32 v175, 0, v162, s[74:75]
  v_pk_mul_f32 v[108:109], v[108:109], v[116:117] op_sel:[0,1]
  v_cndmask_b32 v176, 0, v159, s[76:77]
  v_pk_mul_f32 v[110:111], v[110:111], v[116:117] op_sel:[0,1]
  v_cvt_pk_bf16_f32 v222, v196, v108
  v_cvt_pk_bf16_f32 v226, v197, v109
  v_cvt_pk_bf16_f32 v230, v198, v110
  v_cvt_pk_bf16_f32 v234, v199, v111
  s_waitcnt vmcnt(16)
  buffer_load_dwordx4 v[88:91], v95, s[12:15], s60 offen offset:512 nt
  v_cvt_f32_i32 v108, v28
  v_cvt_f32_i32 v109, v29
  v_cvt_f32_i32 v110, v30
  v_cvt_f32_i32 v111, v31
  v_pk_add_f32 v[108:109], v[108:109], v[116:117] op_sel_hi:[1,0] neg_lo:[0,1] neg_hi:[0,1]
  v_pk_add_f32 v[110:111], v[110:111], v[116:117] op_sel_hi:[1,0] neg_lo:[0,1] neg_hi:[0,1]
  v_cvt_pk_bf16_f32 v108, 0, v108
  v_cndmask_b32 v177, 0, v160, s[76:77]
  v_cvt_pk_bf16_f32 v109, 0, v109
  v_cndmask_b32 v178, 0, v161, s[76:77]
  v_cvt_pk_bf16_f32 v110, 0, v110
  v_cndmask_b32 v179, 0, v162, s[76:77]
  v_cvt_pk_bf16_f32 v111, 0, v111
  v_cndmask_b32 v180, 0, v159, s[78:79]
  v_pk_mul_f32 v[108:109], v[108:109], v[116:117] op_sel:[0,1]
  v_cndmask_b32 v181, 0, v160, s[78:79]
  v_pk_mul_f32 v[110:111], v[110:111], v[116:117] op_sel:[0,1]
  v_cvt_pk_bf16_f32 v238, v200, v108
  v_cvt_pk_bf16_f32 v242, v201, v109
  v_cvt_pk_bf16_f32 v246, v202, v110
  v_cvt_pk_bf16_f32 v250, v203, v111
  v_mad_u32_u24 v92, v97, s63, v3
  v_add_u32 v93, 768, v92
  v_add_u32 v94, 4608, v92
  v_add_u32 v95, 7680, v92
  v_cndmask_b32 v92, v92, v105, s[52:53]
  v_cndmask_b32 v95, v95, v105, s[54:55]
  s_waitcnt vmcnt(16)
  s_cbranch_vccnz L_vw1_18
  s_waitcnt vmcnt(9)
L_vw1_18:
  buffer_load_dwordx4 v[4:7], v92, s[12:15], s61 offen offset:0 nt
  v_cvt_f32_i32 v192, v32
  v_cvt_f32_i32 v193, v33
  v_mov_b32_dpp v116, v114 row_newbcast:6 row_mask:0xf bank_mask:0xf
  v_mov_b32_dpp v117, v115 row_newbcast:6 row_mask:0xf bank_mask:0xf
  v_cvt_f32_i32 v194, v34
  v_cvt_f32_i32 v195, v35
  v_pk_add_f32 v[192:193], v[192:193], v[116:117] op_sel_hi:[1,0] neg_lo:[0,1] neg_hi:[0,1]
  v_pk_add_f32 v[194:195], v[194:195], v[116:117] op_sel_hi:[1,0] neg_lo:[0,1] neg_hi:[0,1]
  v_cvt_pk_bf16_f32 v192, 0, v192
  v_cndmask_b32 v182, 0, v161, s[78:79]
  v_cvt_pk_bf16_f32 v193, 0, v193
  v_cndmask_b32 v183, 0, v162, s[78:79]
  v_cvt_pk_bf16_f32 v194, 0, v194
  s_waitcnt lgkmcnt(0)
  v_cvt_pk_bf16_f32 v195, 0, v195
  v_mul_f32 v128, v147, v128
  v_pk_mul_f32 v[192:193], v[192:193], v[116:117] op_sel:[0,1]
  v_mul_f32 v129, v147, v129
  v_pk_mul_f32 v[194:195], v[194:195], v[116:117] op_sel:[0,1]
  s_waitcnt vmcnt(14)
  buffer_load_dwordx4 v[8:11], v92, s[12:15], s61 offen offset:256 nt
  v_cvt_f32_i32 v196, v36
  v_cvt_f32_i32 v197, v37
  v_cvt_f32_i32 v198, v38
  v_cvt_f32_i32 v199, v39
  v_pk_add_f32 v[196:197], v[196:197], v[116:117] op_sel_hi:[1,0] neg_lo:[0,1] neg_hi:[0,1]
  v_pk_add_f32 v[198:199], v[198:199], v[116:117] op_sel_hi:[1,0] neg_lo:[0,1] neg_hi:[0,1]
  v_cvt_pk_bf16_f32 v196, 0, v196
  v_mul_f32 v130, v147, v130
  v_cvt_pk_bf16_f32 v197, 0, v197
  v_mul_f32 v131, v147, v131
  v_cvt_pk_bf16_f32 v198, 0, v198
  v_mul_f32 v132, v147, v132
  v_cvt_pk_bf16_f32 v199, 0, v199
  v_mul_f32 v133, v147, v133
  v_pk_mul_f32 v[196:197], v[196:197], v[116:117] op_sel:[0,1]
  v_mul_f32 v134, v147, v134
  v_pk_mul_f32 v[198:199], v[198:199], v[116:117] op_sel:[0,1]
  s_waitcnt vmcnt(14)
  buffer_load_dwordx4 v[12:15], v92, s[12:15], s61 offen offset:512 nt
  v_cvt_f32_i32 v200, v40
  v_cvt_f32_i32 v201, v41
  v_cvt_f32_i32 v202, v42
  v_cvt_f32_i32 v203, v43
  v_pk_add_f32 v[200:201], v[200:201], v[116:117] op_sel_hi:[1,0] neg_lo:[0,1] neg_hi:[0,1]
  v_pk_add_f32 v[202:203], v[202:203], v[116:117] op_sel_hi:[1,0] neg_lo:[0,1] neg_hi:[0,1]
  v_cvt_pk_bf16_f32 v200, 0, v200
  v_mul_f32 v135, v147, v135
  v_cvt_pk_bf16_f32 v201, 0, v201
  v_mul_f32 v136, v147, v136
  v_cvt_pk_bf16_f32 v202, 0, v202
  v_mul_f32 v137, v147, v137
  v_cvt_pk_bf16_f32 v203, 0, v203
  v_mul_f32 v138, v147, v138
  v_pk_mul_f32 v[200:201], v[200:201], v[116:117] op_sel:[0,1]
  v_mul_f32 v139, v147, v139
  v_pk_mul_f32 v[202:203], v[202:203], v[116:117] op_sel:[0,1]
  s_waitcnt vmcnt(14)
  s_cbranch_vccnz L_vw1_21
  s_waitcnt vmcnt(9)
L_vw1_21:
  buffer_load_dwordx4 v[16:19], v93, s[12:15], s61 offen offset:0 nt
  v_cvt_f32_i32 v108, v44
  v_cvt_f32_i32 v109, v45
  v_mov_b32_dpp v116, v114 row_newbcast:7 row_mask:0xf bank_mask:0xf
  v_mov_b32_dpp v117, v115 row_newbcast:7 row_mask:0xf bank_mask:0xf
  v_cvt_f32_i32 v110, v46
  v_cvt_f32_i32 v111, v47
  v_pk_add_f32 v[108:109], v[108:109], v[116:117] op_sel_hi:[1,0] neg_lo:[0,1] neg_hi:[0,1]
  v_pk_add_f32 v[110:111], v[110:111], v[116:117] op_sel_hi:[1,0] neg_lo:[0,1] neg_hi:[0,1]
  v_cvt_pk_bf16_f32 v108, 0, v108
  v_cvt_pk_bf16_f32 v109, 0, v109
  v_cvt_pk_bf16_f32 v110, 0, v110
  v_cvt_pk_bf16_f32 v111, 0, v111
  v_pk_mul_f32 v[108:109], v[108:109], v[116:117] op_sel:[0,1]
  v_pk_mul_f32 v[110:111], v[110:111], v[116:117] op_sel:[0,1]
  v_cvt_pk_bf16_f32 v207, v192, v108
  v_cvt_pk_bf16_f32 v211, v193, v109
  v_cvt_pk_bf16_f32 v215, v194, v110
  v_cvt_pk_bf16_f32 v219, v195, v111
  v_mfma_f32_16x16x32_bf16 v[128:131], v[168:171], v[204:207], v[128:131]
  v_mfma_f32_16x16x32_bf16 v[128:131], v[172:175], v[208:211], v[128:131]
  v_mfma_f32_16x16x32_bf16 v[128:131], v[176:179], v[212:215], v[128:131]
  v_mfma_f32_16x16x32_bf16 v[128:131], v[180:183], v[216:219], v[128:131]
  s_waitcnt vmcnt(14)
  buffer_load_dwordx4 v[20:23], v93, s[12:15], s61 offen offset:256 nt
  v_cvt_f32_i32 v108, v48
  v_cvt_f32_i32 v109, v49
  v_cvt_f32_i32 v110, v50
  v_cvt_f32_i32 v111, v51
  v_pk_add_f32 v[108:109], v[108:109], v[116:117] op_sel_hi:[1,0] neg_lo:[0,1] neg_hi:[0,1]
  v_pk_add_f32 v[110:111], v[110:111], v[116:117] op_sel_hi:[1,0] neg_lo:[0,1] neg_hi:[0,1]
  v_cvt_pk_bf16_f32 v108, 0, v108
  v_cvt_pk_bf16_f32 v109, 0, v109
  v_cvt_pk_bf16_f32 v110, 0, v110
  v_cvt_pk_bf16_f32 v111, 0, v111
  v_pk_mul_f32 v[108:109], v[108:109], v[116:117] op_sel:[0,1]
  v_pk_mul_f32 v[110:111], v[110:111], v[116:117] op_sel:[0,1]
  v_cvt_pk_bf16_f32 v223, v196, v108
  v_cvt_pk_bf16_f32 v227, v197, v109
  v_cvt_pk_bf16_f32 v231, v198, v110
  v_cvt_pk_bf16_f32 v235, v199, v111
  v_mfma_f32_16x16x32_bf16 v[132:135], v[168:171], v[220:223], v[132:135]
  v_mfma_f32_16x16x32_bf16 v[132:135], v[172:175], v[224:227], v[132:135]
  v_mfma_f32_16x16x32_bf16 v[132:135], v[176:179], v[228:231], v[132:135]
  v_mfma_f32_16x16x32_bf16 v[132:135], v[180:183], v[232:235], v[132:135]
  s_waitcnt vmcnt(14)
  buffer_load_dwordx4 v[24:27], v93, s[12:15], s61 offen offset:512 nt
  v_cvt_f32_i32 v108, v52
  v_cvt_f32_i32 v109, v53
  v_cvt_f32_i32 v110, v54
  v_cvt_f32_i32 v111, v55
  v_pk_add_f32 v[108:109], v[108:109], v[116:117] op_sel_hi:[1,0] neg_lo:[0,1] neg_hi:[0,1]
  v_pk_add_f32 v[110:111], v[110:111], v[116:117] op_sel_hi:[1,0] neg_lo:[0,1] neg_hi:[0,1]
  v_cvt_pk_bf16_f32 v108, 0, v108
  v_cvt_pk_bf16_f32 v109, 0, v109
  v_cvt_pk_bf16_f32 v110, 0, v110
  v_cvt_pk_bf16_f32 v111, 0, v111
  v_pk_mul_f32 v[108:109], v[108:109], v[116:117] op_sel:[0,1]
  v_pk_mul_f32 v[110:111], v[110:111], v[116:117] op_sel:[0,1]
  v_cvt_pk_bf16_f32 v239, v200, v108
  v_cvt_pk_bf16_f32 v243, v201, v109
  v_cvt_pk_bf16_f32 v247, v202, v110
  v_cvt_pk_bf16_f32 v251, v203, v111
  v_mfma_f32_16x16x32_bf16 v[136:139], v[168:171], v[236:239], v[136:139]
  v_mfma_f32_16x16x32_bf16 v[136:139], v[172:175], v[240:243], v[136:139]
  v_mfma_f32_16x16x32_bf16 v[136:139], v[176:179], v[244:247], v[136:139]
  v_mfma_f32_16x16x32_bf16 v[136:139], v[180:183], v[248:251], v[136:139]
  s_waitcnt vmcnt(14)
  s_cbranch_vccnz L_vw1_24
  s_waitcnt vmcnt(9)
L_vw1_24:
  buffer_load_dwordx4 v[28:31], v93, s[12:15], s61 offen offset:768 nt
  v_cvt_f32_i32 v192, v56
  v_cvt_f32_i32 v193, v57
  v_mov_b32_dpp v116, v114 row_newbcast:8 row_mask:0xf bank_mask:0xf
  v_mov_b32_dpp v117, v115 row_newbcast:8 row_mask:0xf bank_mask:0xf
  v_cvt_f32_i32 v194, v58
  v_cvt_f32_i32 v195, v59
  v_pk_add_f32 v[192:193], v[192:193], v[116:117] op_sel_hi:[1,0] neg_lo:[0,1] neg_hi:[0,1]
  v_pk_add_f32 v[194:195], v[194:195], v[116:117] op_sel_hi:[1,0] neg_lo:[0,1] neg_hi:[0,1]
  v_cvt_pk_bf16_f32 v192, 0, v192
  v_cndmask_b32 v184, 0, v163, s[72:73]
  v_cvt_pk_bf16_f32 v193, 0, v193
  v_cndmask_b32 v185, 0, v164, s[72:73]
  v_cvt_pk_bf16_f32 v194, 0, v194
  v_cndmask_b32 v186, 0, v163, s[74:75]
  v_cvt_pk_bf16_f32 v195, 0, v195
  v_cndmask_b32 v187, 0, v164, s[74:75]
  v_pk_mul_f32 v[192:193], v[192:193], v[116:117] op_sel:[0,1]
  v_cndmask_b32 v188, 0, v163, s[76:77]
  v_pk_mul_f32 v[194:195], v[194:195], v[116:117] op_sel:[0,1]
  s_waitcnt vmcnt(14)
  buffer_load_dwordx4 v[32:35], v93, s[12:15], s61 offen offset:1024 nt
  v_cvt_f32_i32 v196, v60
  v_cvt_f32_i32 v197, v61
  v_cvt_f32_i32 v198, v62
  v_cvt_f32_i32 v199, v63
  v_pk_add_f32 v[196:197], v[196:197], v[116:117] op_sel_hi:[1,0] neg_lo:[0,1] neg_hi:[0,1]
  v_pk_add_f32 v[198:199], v[198:199], v[116:117] op_sel_hi:[1,0] neg_lo:[0,1] neg_hi:[0,1]
  v_cvt_pk_bf16_f32 v196, 0, v196
  v_cndmask_b32 v189, 0, v164, s[76:77]
  v_cvt_pk_bf16_f32 v197, 0, v197
  v_cndmask_b32 v190, 0, v163, s[78:79]
  v_cvt_pk_bf16_f32 v198, 0, v198
  v_cndmask_b32 v191, 0, v164, s[78:79]
  v_cvt_pk_bf16_f32 v199, 0, v199
  v_pk_mul_f32 v[196:197], v[196:197], v[116:117] op_sel:[0,1]
  v_pk_mul_f32 v[198:199], v[198:199], v[116:117] op_sel:[0,1]
  s_waitcnt vmcnt(14)
  buffer_load_dwordx4 v[36:39], v93, s[12:15], s61 offen offset:1280 nt
  v_cvt_f32_i32 v200, v64
  v_cvt_f32_i32 v201, v65
  v_cvt_f32_i32 v202, v66
  v_cvt_f32_i32 v203, v67
  v_pk_add_f32 v[200:201], v[200:201], v[116:117] op_sel_hi:[1,0] neg_lo:[0,1] neg_hi:[0,1]
  v_pk_add_f32 v[202:203], v[202:203], v[116:117] op_sel_hi:[1,0] neg_lo:[0,1] neg_hi:[0,1]
  v_cvt_pk_bf16_f32 v200, 0, v200
  v_cvt_pk_bf16_f32 v201, 0, v201
  v_cvt_pk_bf16_f32 v202, 0, v202
  v_cvt_pk_bf16_f32 v203, 0, v203
  v_pk_mul_f32 v[200:201], v[200:201], v[116:117] op_sel:[0,1]
  v_pk_mul_f32 v[202:203], v[202:203], v[116:117] op_sel:[0,1]
  s_waitcnt vmcnt(14)
  s_cbranch_vccnz L_vw1_27
  s_waitcnt vmcnt(9)
L_vw1_27:
  buffer_load_dwordx4 v[40:43], v93, s[12:15], s61 offen offset:1536 nt
  v_cvt_f32_i32 v108, v68
  v_cvt_f32_i32 v109, v69
  v_mov_b32_dpp v116, v114 row_newbcast:9 row_mask:0xf bank_mask:0xf
  v_mov_b32_dpp v117, v115 row_newbcast:9 row_mask:0xf bank_mask:0xf
  v_cvt_f32_i32 v110, v70
  v_cvt_f32_i32 v111, v71
  v_pk_add_f32 v[108:109], v[108:109], v[116:117] op_sel_hi:[1,0] neg_lo:[0,1] neg_hi:[0,1]
  v_pk_add_f32 v[110:111], v[110:111], v[116:117] op_sel_hi:[1,0] neg_lo:[0,1] neg_hi:[0,1]
  v_cvt_pk_bf16_f32 v108, 0, v108
  v_cvt_pk_bf16_f32 v109, 0, v109
  v_cvt_pk_bf16_f32 v110, 0, v110
  v_cvt_pk_bf16_f32 v111, 0, v111
  v_pk_mul_f32 v[108:109], v[108:109], v[116:117] op_sel:[0,1]
  v_pk_mul_f32 v[110:111], v[110:111], v[116:117] op_sel:[0,1]
  v_cvt_pk_bf16_f32 v204, v192, v108
  v_cvt_pk_bf16_f32 v208, v193, v109
  v_cvt_pk_bf16_f32 v212, v194, v110
  v_cvt_pk_bf16_f32 v216, v195, v111
  s_waitcnt vmcnt(14)
  buffer_load_dwordx4 v[44:47], v93, s[12:15], s61 offen offset:1792 nt
  v_cvt_f32_i32 v108, v72
  v_cvt_f32_i32 v109, v73
  v_cvt_f32_i32 v110, v74
  v_cvt_f32_i32 v111, v75
  v_pk_add_f32 v[108:109], v[108:109], v[116:117] op_sel_hi:[1,0] neg_lo:[0,1] neg_hi:[0,1]
  v_pk_add_f32 v[110:111], v[110:111], v[116:117] op_sel_hi:[1,0] neg_lo:[0,1] neg_hi:[0,1]
  v_cvt_pk_bf16_f32 v108, 0, v108
  v_cvt_pk_bf16_f32 v109, 0, v109
  v_cvt_pk_bf16_f32 v110, 0, v110
  v_cvt_pk_bf16_f32 v111, 0, v111
  v_pk_mul_f32 v[108:109], v[108:109], v[116:117] op_sel:[0,1]
  v_pk_mul_f32 v[110:111], v[110:111], v[116:117] op_sel:[0,1]
  v_cvt_pk_bf16_f32 v220, v196, v108
  v_cvt_pk_bf16_f32 v224, v197, v109
  v_cvt_pk_bf16_f32 v228, v198, v110
  v_cvt_pk_bf16_f32 v232, v199, v111
  s_waitcnt vmcnt(14)
  buffer_load_dwordx4 v[48:51], v93, s[12:15], s61 offen offset:2048 nt
  v_cvt_f32_i32 v108, v76
  v_cvt_f32_i32 v109, v77
  v_cvt_f32_i32 v110, v78
  v_cvt_f32_i32 v111, v79
  v_pk_add_f32 v[108:109], v[108:109], v[116:117] op_sel_hi:[1,0] neg_lo:[0,1] neg_hi:[0,1]
  v_pk_add_f32 v[110:111], v[110:111], v[116:117] op_sel_hi:[1,0] neg_lo:[0,1] neg_hi:[0,1]
  v_cvt_pk_bf16_f32 v108, 0, v108
  v_cvt_pk_bf16_f32 v109, 0, v109
  v_cvt_pk_bf16_f32 v110, 0, v110
  v_cvt_pk_bf16_f32 v111, 0, v111
  v_pk_mul_f32 v[108:109], v[108:109], v[116:117] op_sel:[0,1]
  v_pk_mul_f32 v[110:111], v[110:111], v[116:117] op_sel:[0,1]
  v_cvt_pk_bf16_f32 v236, v200, v108
  v_cvt_pk_bf16_f32 v240, v201, v109
  v_cvt_pk_bf16_f32 v244, v202, v110
  v_cvt_pk_bf16_f32 v248, v203, v111
  s_waitcnt vmcnt(14)
  s_cbranch_vccnz L_vw1_30
  s_waitcnt vmcnt(9)
L_vw1_30:
  buffer_load_dwordx4 v[52:55], v93, s[12:15], s61 offen offset:2304 nt
  v_cvt_f32_i32 v192, v80
  v_cvt_f32_i32 v193, v81
  v_mov_b32_dpp v116, v114 row_newbcast:10 row_mask:0xf bank_mask:0xf
  v_mov_b32_dpp v117, v115 row_newbcast:10 row_mask:0xf bank_mask:0xf
  v_cvt_f32_i32 v194, v82
  v_cvt_f32_i32 v195, v83
  v_pk_add_f32 v[192:193], v[192:193], v[116:117] op_sel_hi:[1,0] neg_lo:[0,1] neg_hi:[0,1]
  v_pk_add_f32 v[194:195], v[194:195], v[116:117] op_sel_hi:[1,0] neg_lo:[0,1] neg_hi:[0,1]
  v_cvt_pk_bf16_f32 v192, 0, v192
  v_cvt_pk_bf16_f32 v193, 0, v193
  v_cvt_pk_bf16_f32 v194, 0, v194
  v_cvt_pk_bf16_f32 v195, 0, v195
  v_pk_mul_f32 v[192:193], v[192:193], v[116:117] op_sel:[0,1]
  v_pk_mul_f32 v[194:195], v[194:195], v[116:117] op_sel:[0,1]
  v_cvt_pk_bf16_f32 v205, v192, 0
  v_cvt_pk_bf16_f32 v209, v193, 0
  v_cvt_pk_bf16_f32 v213, v194, 0
  v_cvt_pk_bf16_f32 v217, v195, 0
  v_mfma_f32_16x16x16_bf16 v[128:131], v[184:185], v[204:205], v[128:131]
  v_mfma_f32_16x16x16_bf16 v[128:131], v[186:187], v[208:209], v[128:131]
  v_mfma_f32_16x16x16_bf16 v[128:131], v[188:189], v[212:213], v[128:131]
  v_mfma_f32_16x16x16_bf16 v[128:131], v[190:191], v[216:217], v[128:131]
  s_waitcnt vmcnt(14)
  buffer_load_dwordx4 v[56:59], v93, s[12:15], s61 offen offset:2560 nt
  v_cvt_f32_i32 v196, v84
  v_cvt_f32_i32 v197, v85
  v_cvt_f32_i32 v198, v86
  v_cvt_f32_i32 v199, v87
  v_pk_add_f32 v[196:197], v[196:197], v[116:117] op_sel_hi:[1,0] neg_lo:[0,1] neg_hi:[0,1]
  v_pk_add_f32 v[198:199], v[198:199], v[116:117] op_sel_hi:[1,0] neg_lo:[0,1] neg_hi:[0,1]
  v_cvt_pk_bf16_f32 v196, 0, v196
  v_cvt_pk_bf16_f32 v197, 0, v197
  v_cvt_pk_bf16_f32 v198, 0, v198
  v_cvt_pk_bf16_f32 v199, 0, v199
  v_pk_mul_f32 v[196:197], v[196:197], v[116:117] op_sel:[0,1]
  v_pk_mul_f32 v[198:199], v[198:199], v[116:117] op_sel:[0,1]
  v_cvt_pk_bf16_f32 v221, v196, 0
  v_cvt_pk_bf16_f32 v225, v197, 0
  v_cvt_pk_bf16_f32 v229, v198, 0
  v_cvt_pk_bf16_f32 v233, v199, 0
  v_mfma_f32_16x16x16_bf16 v[132:135], v[184:185], v[220:221], v[132:135]
  v_mfma_f32_16x16x16_bf16 v[132:135], v[186:187], v[224:225], v[132:135]
  v_mfma_f32_16x16x16_bf16 v[132:135], v[188:189], v[228:229], v[132:135]
  v_mfma_f32_16x16x16_bf16 v[132:135], v[190:191], v[232:233], v[132:135]
  s_waitcnt vmcnt(14)
  buffer_load_dwordx4 v[60:63], v93, s[12:15], s61 offen offset:2816 nt
  v_cvt_f32_i32 v200, v88
  v_cvt_f32_i32 v201, v89
  v_cvt_f32_i32 v202, v90
  v_cvt_f32_i32 v203, v91
  v_pk_add_f32 v[200:201], v[200:201], v[116:117] op_sel_hi:[1,0] neg_lo:[0,1] neg_hi:[0,1]
  v_pk_add_f32 v[202:203], v[202:203], v[116:117] op_sel_hi:[1,0] neg_lo:[0,1] neg_hi:[0,1]
  v_cvt_pk_bf16_f32 v200, 0, v200
  v_cvt_pk_bf16_f32 v201, 0, v201
  v_cvt_pk_bf16_f32 v202, 0, v202
  v_cvt_pk_bf16_f32 v203, 0, v203
  v_pk_mul_f32 v[200:201], v[200:201], v[116:117] op_sel:[0,1]
  v_pk_mul_f32 v[202:203], v[202:203], v[116:117] op_sel:[0,1]
  v_cvt_pk_bf16_f32 v237, v200, 0
  v_cvt_pk_bf16_f32 v241, v201, 0
  v_cvt_pk_bf16_f32 v245, v202, 0
  v_cvt_pk_bf16_f32 v249, v203, 0
  v_mfma_f32_16x16x16_bf16 v[136:139], v[184:185], v[236:237], v[136:139]
  v_mfma_f32_16x16x16_bf16 v[136:139], v[186:187], v[240:241], v[136:139]
  v_mfma_f32_16x16x16_bf16 v[136:139], v[188:189], v[244:245], v[136:139]
  v_mfma_f32_16x16x16_bf16 v[136:139], v[190:191], v[248:249], v[136:139]
  s_mov_b32 s60, s61
  s_cmp_ge_u32 s64, 96
  s_cbranch_scc1 L_v_done
  s_cmp_eq_u32 s89, s88
  s_cbranch_scc1 L_v0
  s_mov_b32 s88, s89
  s_and_b32 s70, s86, 15
  s_cmp_ge_u32 s70, 12
  s_cselect_b32 s70, 6208, 0
  s_bitcmp1_b32 s86, 4
  s_cselect_b32 s71, 12416, 0
  s_add_u32 s70, s70, s71
  v_mov_b32 v145, v143
  v_add_u32 v144, s70, v102
  v_add_u32 v147, s70, v103
  v_permlane32_swap_b32 v143, v145
  v_add_f32 v143, v143, v145
  v_mov_b32 v145, v143
  ds_write_b128 v144, v[128:131] offset:0
  ds_write_b128 v144, v[132:135] offset:1024
  ds_write_b128 v144, v[136:139] offset:2048
  v_permlane16_swap_b32 v143, v145
  v_add_f32 v143, v143, v145
  ds_write_b64 v147, v[142:143]
  s_waitcnt lgkmcnt(0)
  v_mov_b32 v128, 0
  v_mov_b32 v129, 0
  v_mov_b32 v130, 0
  v_mov_b32 v131, 0
  v_mov_b32 v132, 0
  v_mov_b32 v133, 0
  v_mov_b32 v134, 0
  v_mov_b32 v135, 0
  v_mov_b32 v136, 0
  v_mov_b32 v137, 0
  v_mov_b32 v138, 0
  v_mov_b32 v139, 0
  v_mov_b32 v140, 0xff800000
  v_mov_b32 v142, 0x7f800000
  v_mov_b32 v143, 0
  s_branch L_v0
L_v_done:
  s_and_b32 s70, s86, 15
  s_cmp_ge_u32 s70, 12
  s_cselect_b32 s70, 6208, 0
  s_bitcmp1_b32 s86, 4
  s_cselect_b32 s71, 12416, 0
  s_add_u32 s70, s70, s71
  v_mov_b32 v145, v143
  v_add_u32 v144, s70, v102
  v_add_u32 v147, s70, v103
  v_permlane32_swap_b32 v143, v145
  v_add_f32 v143, v143, v145
  v_mov_b32 v145, v143
  ds_write_b128 v144, v[128:131] offset:0
  ds_write_b128 v144, v[132:135] offset:1024
  ds_write_b128 v144, v[136:139] offset:2048
  v_permlane16_swap_b32 v143, v145
  v_add_f32 v143, v143, v145
  ds_write_b64 v147, v[142:143]
L_finish:
  v_mov_b32 v144, 61728
  ds_read_b128 v[168:171], v144
  ds_read_b128 v[172:175], v144 offset:16
  s_mul_i32 s70, s4, 6208
  s_lshl_b32 s71, s3, 10
  v_lshl_add_u32 v152, v0, 4, s71
  v_lshrrev_b32 v145, 4, v0
  v_lshlrev_b32 v154, 3, v145
  v_add_u32 v154, 43008, v154
  s_sub_u32 s97, 6208, s70
  v_add_u32 v153, s97, v152
  v_add_u32 v140, s70, v152
  s_sub_u32 s97, 12416, s70
  v_add_u32 v112, s97, v154
  s_add_u32 s97, s70, 6208
  v_add_u32 v113, s97, v154
  v_add_u32 v155, 18624, v154
  s_mul_i32 s70, s3, 1152
  v_lshl_add_u32 v156, v0, 4, s70
  v_lshl_add_u32 v157, v145, 5, s70
  v_and_b32 v146, 1, v0
  v_lshl_add_u32 v157, v146, 4, v157
  v_mul_u32_u24 v146, 384, v145
  v_and_b32 v145, 15, v0
  v_lshl_add_u32 v146, v145, 3, v146
  s_movk_i32 s65, 0xff00
  s_mov_b32 s48, 0x30003
  s_mov_b32 s49, 0x30003
  s_mov_b32 s50, 0x0c0c0400
  s_mov_b32 s51, 0x05040100
  s_mov_b32 s64, 0
  s_waitcnt vmcnt(0) lgkmcnt(0)
  s_barrier
  ds_read2_b64 v[176:179], v154 offset1:4
  ds_read_b128 v[192:195], v152 offset:36864
  ds_read_b128 v[196:199], v152 offset:39936
  ds_read2_b64 v[180:183], v155 offset1:4
  ds_read_b128 v[200:203], v152 offset:55488
  ds_read_b128 v[204:207], v152 offset:58560
  ds_read2_b64 v[184:187], v112 offset1:4
  ds_read_b128 v[208:211], v153 offset:43072
  ds_read_b128 v[212:215], v153 offset:46144
  ds_read2_b64 v[188:191], v113 offset1:4
  ds_read_b128 v[216:219], v140 offset:43072
  ds_read_b128 v[220:223], v140 offset:46144
  v_readfirstlane_b32 s72, v168
  v_readfirstlane_b32 s73, v169
  v_readfirstlane_b32 s74, v170
  v_readfirstlane_b32 s75, v171
  v_readfirstlane_b32 s76, v172
  v_readfirstlane_b32 s77, v173
  v_readfirstlane_b32 s78, v174
  v_bfe_u32 v148, v175, 0, 8
  v_bfe_u32 v149, v175, 8, 8
  v_bfe_u32 v150, v175, 16, 8
  v_bfe_u32 v151, v175, 24, 8
  s_waitcnt lgkmcnt(9)
  v_min_f32 v144, v176, v178
  v_sub_f32 v176, v144, v176
  v_sub_f32 v178, v144, v178
  v_exp_f32 v176, v176
  v_exp_f32 v178, v178
  v_mul_f32 v145, v176, v177
  v_pk_mul_f32 v[192:193], v[192:193], v[176:177] op_sel_hi:[1,0]
  v_pk_mul_f32 v[194:195], v[194:195], v[176:177] op_sel_hi:[1,0]
  v_pk_fma_f32 v[192:193], v[196:197], v[178:179], v[192:193] op_sel_hi:[1,0,1]
  v_pk_fma_f32 v[194:195], v[198:199], v[178:179], v[194:195] op_sel_hi:[1,0,1]
  v_fma_f32 v197, v178, v179, v145
  v_mov_b32 v196, v144
  v_and_or_b32 v192, v192, s65, v148
  v_and_or_b32 v193, v193, s65, v149
  v_and_or_b32 v194, v194, s65, v150
  v_and_or_b32 v195, v195, s65, v151
  v_mov_b32 v199, v175
  buffer_store_dwordx4 v[192:195], v156, s[40:43], s72 offen sc1
  s_mov_b64 exec, s[48:49]
  buffer_store_dwordx4 v[196:199], v157, s[40:43], s72 offen offset:1024 sc1
  s_mov_b64 exec, -1
  s_waitcnt lgkmcnt(6)
  v_min_f32 v144, v180, v182
  v_sub_f32 v180, v144, v180
  v_sub_f32 v182, v144, v182
  v_exp_f32 v180, v180
  v_exp_f32 v182, v182
  v_mul_f32 v145, v180, v181
  v_pk_mul_f32 v[200:201], v[200:201], v[180:181] op_sel_hi:[1,0]
  v_pk_mul_f32 v[202:203], v[202:203], v[180:181] op_sel_hi:[1,0]
  v_pk_fma_f32 v[200:201], v[204:205], v[182:183], v[200:201] op_sel_hi:[1,0,1]
  v_pk_fma_f32 v[202:203], v[206:207], v[182:183], v[202:203] op_sel_hi:[1,0,1]
  v_fma_f32 v205, v182, v183, v145
  v_mov_b32 v204, v144
  v_and_or_b32 v200, v200, s65, v148
  v_and_or_b32 v201, v201, s65, v149
  v_and_or_b32 v202, v202, s65, v150
  v_and_or_b32 v203, v203, s65, v151
  v_mov_b32 v207, v175
  buffer_store_dwordx4 v[200:203], v156, s[40:43], s73 offen sc1
  s_mov_b64 exec, s[48:49]
  buffer_store_dwordx4 v[204:207], v157, s[40:43], s73 offen offset:1024 sc1
  s_mov_b64 exec, -1
  s_waitcnt lgkmcnt(3)
  v_min_f32 v144, v184, v186
  v_sub_f32 v184, v144, v184
  v_sub_f32 v186, v144, v186
  v_exp_f32 v184, v184
  v_exp_f32 v186, v186
  v_mul_f32 v145, v184, v185
  v_pk_mul_f32 v[208:209], v[208:209], v[184:185] op_sel_hi:[1,0]
  v_pk_mul_f32 v[210:211], v[210:211], v[184:185] op_sel_hi:[1,0]
  v_pk_fma_f32 v[208:209], v[212:213], v[186:187], v[208:209] op_sel_hi:[1,0,1]
  v_pk_fma_f32 v[210:211], v[214:215], v[186:187], v[210:211] op_sel_hi:[1,0,1]
  v_fma_f32 v213, v186, v187, v145
  v_mov_b32 v212, v144
  v_and_or_b32 v208, v208, s65, v148
  v_and_or_b32 v209, v209, s65, v149
  v_and_or_b32 v210, v210, s65, v150
  v_and_or_b32 v211, v211, s65, v151
  v_mov_b32 v215, v175
  buffer_store_dwordx4 v[208:211], v156, s[40:43], s74 offen sc1
  s_mov_b64 exec, s[48:49]
  buffer_store_dwordx4 v[212:215], v157, s[40:43], s74 offen offset:1024 sc1
  s_mov_b64 exec, -1
  buffer_load_dwordx4 v[224:227], v156, s[40:43], s75 offen sc1
  buffer_load_dwordx4 v[228:231], v157, s[40:43], s75 offen offset:1024 sc1
  buffer_load_dwordx4 v[232:235], v156, s[40:43], s76 offen sc1
  buffer_load_dwordx4 v[236:239], v157, s[40:43], s76 offen offset:1024 sc1
  buffer_load_dwordx4 v[240:243], v156, s[40:43], s77 offen sc1
  buffer_load_dwordx4 v[244:247], v157, s[40:43], s77 offen offset:1024 sc1
  s_waitcnt lgkmcnt(0)
  v_min_f32 v144, v188, v190
  v_sub_f32 v188, v144, v188
  v_sub_f32 v190, v144, v190
  v_exp_f32 v188, v188
  v_exp_f32 v190, v190
  v_mul_f32 v145, v188, v189
  v_pk_mul_f32 v[216:217], v[216:217], v[188:189] op_sel_hi:[1,0]
  v_pk_mul_f32 v[218:219], v[218:219], v[188:189] op_sel_hi:[1,0]
  v_pk_fma_f32 v[216:217], v[220:221], v[190:191], v[216:217] op_sel_hi:[1,0,1]
  v_pk_fma_f32 v[218:219], v[222:223], v[190:191], v[218:219] op_sel_hi:[1,0,1]
  v_fma_f32 v221, v190, v191, v145
  v_mov_b32 v220, v144
  s_branch L_check
L_gather:
  s_add_u32 s64, s64, 1
  s_cmp_gt_u32 s64, 200000
  s_cbranch_scc1 L_end
  s_bitcmp0_b32 s87, 0
  s_cbranch_scc1 L_have0
  buffer_load_dwordx4 v[224:227], v156, s[40:43], s75 offen sc1
  buffer_load_dwordx4 v[228:231], v157, s[40:43], s75 offen offset:1024 sc1
L_have0:
  s_bitcmp0_b32 s87, 1
  s_cbranch_scc1 L_have1
  buffer_load_dwordx4 v[232:235], v156, s[40:43], s76 offen sc1
  buffer_load_dwordx4 v[236:239], v157, s[40:43], s76 offen offset:1024 sc1
L_have1:
  s_bitcmp0_b32 s87, 2
  s_cbranch_scc1 L_have2
  buffer_load_dwordx4 v[240:243], v156, s[40:43], s77 offen sc1
  buffer_load_dwordx4 v[244:247], v157, s[40:43], s77 offen offset:1024 sc1
L_have2:
L_check:
  s_mov_b32 s87, 0
  s_waitcnt vmcnt(0)
  v_perm_b32 v144, v225, v224, s50
  v_perm_b32 v145, v227, v226, s50
  v_cmp_ne_u32 vcc, v175, v231
  v_perm_b32 v144, v145, v144, s51
  v_cmp_ne_u32 s[70:71], v175, v144
  s_nop 1
  s_or_b64 s[70:71], s[70:71], vcc
  s_cselect_b32 s70, 1, 0
  s_or_b32 s87, s87, s70
  v_perm_b32 v144, v233, v232, s50
  v_perm_b32 v145, v235, v234, s50
  v_cmp_ne_u32 vcc, v175, v239
  v_perm_b32 v144, v145, v144, s51
  v_cmp_ne_u32 s[70:71], v175, v144
  s_nop 1
  s_or_b64 s[70:71], s[70:71], vcc
  s_cselect_b32 s70, 2, 0
  s_or_b32 s87, s87, s70
  v_perm_b32 v144, v241, v240, s50
  v_perm_b32 v145, v243, v242, s50
  v_cmp_ne_u32 vcc, v175, v247
  v_perm_b32 v144, v145, v144, s51
  v_cmp_ne_u32 s[70:71], v175, v144
  s_nop 1
  s_or_b64 s[70:71], s[70:71], vcc
  s_cselect_b32 s70, 4, 0
  s_or_b32 s87, s87, s70
  s_cbranch_scc1 L_gather
  v_min_f32 v144, v220, v228
  v_min3_f32 v144, v144, v236, v244
  v_sub_f32 v220, v144, v220
  v_sub_f32 v228, v144, v228
  v_sub_f32 v236, v144, v236
  v_sub_f32 v244, v144, v244
  v_exp_f32 v220, v220
  v_exp_f32 v228, v228
  v_exp_f32 v236, v236
  v_exp_f32 v244, v244
  v_and_b32 v216, s65, v216
  v_and_b32 v217, s65, v217
  v_and_b32 v218, s65, v218
  v_and_b32 v219, s65, v219
  v_and_b32 v224, s65, v224
  v_and_b32 v225, s65, v225
  v_and_b32 v226, s65, v226
  v_and_b32 v227, s65, v227
  v_and_b32 v232, s65, v232
  v_and_b32 v233, s65, v233
  v_and_b32 v234, s65, v234
  v_and_b32 v235, s65, v235
  v_and_b32 v240, s65, v240
  v_and_b32 v241, s65, v241
  v_and_b32 v242, s65, v242
  v_and_b32 v243, s65, v243
  v_mul_f32 v221, v220, v221
  v_mul_f32 v229, v228, v229
  v_mul_f32 v237, v236, v237
  v_mul_f32 v245, v244, v245
  v_add_f32 v221, v221, v229
  v_add_f32 v237, v237, v245
  v_add_f32 v144, v221, v237
  v_rcp_f32 v144, v144
  s_lshl_b32 s70, s3, 7
  s_add_u32 s70, s70, s78
  v_pk_mul_f32 v[216:217], v[216:217], v[220:221] op_sel_hi:[1,0]
  v_pk_mul_f32 v[224:225], v[224:225], v[228:229] op_sel_hi:[1,0]
  v_pk_mul_f32 v[232:233], v[232:233], v[236:237] op_sel_hi:[1,0]
  v_pk_mul_f32 v[240:241], v[240:241], v[244:245] op_sel_hi:[1,0]
  v_pk_add_f32 v[216:217], v[216:217], v[224:225]
  v_pk_add_f32 v[232:233], v[232:233], v[240:241]
  v_pk_add_f32 v[216:217], v[216:217], v[232:233]
  v_pk_mul_f32 v[216:217], v[216:217], v[144:145] op_sel_hi:[1,0]
  v_cvt_pk_bf16_f32 v128, v216, v217
  v_pk_mul_f32 v[218:219], v[218:219], v[220:221] op_sel_hi:[1,0]
  v_pk_mul_f32 v[226:227], v[226:227], v[228:229] op_sel_hi:[1,0]
  v_pk_mul_f32 v[234:235], v[234:235], v[236:237] op_sel_hi:[1,0]
  v_pk_mul_f32 v[242:243], v[242:243], v[244:245] op_sel_hi:[1,0]
  v_pk_add_f32 v[218:219], v[218:219], v[226:227]
  v_pk_add_f32 v[234:235], v[234:235], v[242:243]
  v_pk_add_f32 v[218:219], v[218:219], v[234:235]
  v_pk_mul_f32 v[218:219], v[218:219], v[144:145] op_sel_hi:[1,0]
  v_cvt_pk_bf16_f32 v129, v218, v219
  buffer_store_dwordx2 v[128:129], v146, s[36:39], s70 offen
L_fin:
L_end:
  s_endpgm
L_helper:
  v_lshlrev_b32 v1, 2, v0
  v_add_u32 v1, 61696, v1
  v_mov_b32 v2, 0
  s_mov_b64 exec, 0xff
  ds_write_b32 v1, v2
  s_mov_b64 exec, -1
  s_waitcnt lgkmcnt(0)
  s_mov_b32 s8, s46
  s_and_b32 s9, s47, 0xffff
  s_mov_b32 s36, s44
  s_and_b32 s37, s45, 0xffff
  s_mov_b32 s16, s46
  s_and_b32 s17, s47, 0xffff
  s_mov_b32 s12, s48
  s_and_b32 s13, s49, 0xffff
  s_mov_b32 s40, s82
  s_and_b32 s41, s83, 0xffff
  s_mov_b32 s36, s58
  s_and_b32 s37, s59, 0xffff
  s_barrier
  s_memrealtime s[72:73]
  s_getpc_b64 s[54:55]
L_h_pc:
  s_add_u32 s86, s54, L_h_cp - L_h_pc
  s_addc_u32 s87, s55, 0
  s_sub_u32 s54, s54, L_h_pc - L_k
  s_subb_u32 s55, s55, 0
  s_and_b32 s54, s54, -16
  s_lshr_b32 s70, s2, 3
  s_lshl_b32 s70, s70, 10
  v_lshl_add_u32 v106, v0, 4, s70
  v_mov_b32 v107, s55
  v_add_co_u32 v106, vcc, s54, v106
  s_nop 1
  v_addc_co_u32 v107, vcc, 0, v107, vcc
  s_lshr_b32 s70, s2, 3
  s_cmp_lt_u32 s70, (L_code_end - L_k) / 1024
  s_cbranch_scc0 L_h_cta
  global_load_dwordx4 v[108:111], v[106:107], off
L_h_cta:
  s_lshl_b32 s70, s2, 6
  v_lshl_add_u32 v104, v0, 3, s70
  v_bfe_u32 v105, v0, 1, 3
  v_lshlrev_b32 v105, 6, v105
  v_and_b32 v112, 1, v0
  v_lshl_add_u32 v105, v112, 3, v105
  v_lshlrev_b32 v112, 2, v112
  v_add_u32 v112, 61712, v112
  v_mov_b32 v113, 0
  v_lshlrev_b32 v3, 4, v0
  s_mov_b32 s76, 10
  s_mov_b32 s77, 7340032
  s_getreg_b32 s50, hwreg(HW_REG_XCC_ID)
  s_bfe_u32 s50, s50, 0x10002
  s_bfe_u32 s52, s2, 0x30003
  s_cmp_eq_u32 s52, 7
  s_cbranch_scc1 L_h_voted
  s_lshr_b32 s70, s2, 6
  s_xor_b32 s70, s70, s2
  s_and_b32 s70, s70, 3
  s_cbranch_scc1 L_h_voted
  s_cmp_eq_u32 s52, 6
  s_cbranch_scc0 L_h_probe
  s_xor_b32 s48, s50, s4
  s_and_b32 s52, s2, 3
  s_lshl2_add_u32 s52, s52, 36
  s_branch L_h_vote
L_h_probe:
  s_cmp_ge_u32 s52, 3
  s_cselect_b32 s16, s12, s8
  s_cselect_b32 s17, s13, s9
  s_cselect_b32 s70, 3, 0
  s_sub_u32 s70, s52, s70
  s_lshl_b32 s70, s70, 28
  s_add_u32 s44, s5, s4
  s_lshl_b32 s44, s44, 16
  s_add_u32 s44, s44, s70
  s_add_u32 s44, s44, 0x1c0000
  s_mul_i32 s70, s2, 0x2a95
  s_and_b32 s70, s70, 0x7f80
  s_add_u32 s44, s44, s70
  s_add_u32 s70, s44, 0x8000
  s_buffer_load_dword s58, s[16:19], s70
  s_mov_b32 s45, -1
  s_mov_b32 s46, -1
  s_mul_i32 s52, s52, 6
L_h_progp:
  s_sleep 2
  ds_read_b32 v8, v112
  s_waitcnt lgkmcnt(0)
  v_cmp_gt_u32 vcc, 1, v8
  s_nop 1
  s_cmp_lg_u32 vcc_lo, 0
  s_cbranch_scc1 L_h_progp
  s_xor_b32 s70, s44, 0
  s_memtime s[54:55]
  s_waitcnt lgkmcnt(0)
  s_buffer_load_dword s58, s[16:19], s70
  s_waitcnt lgkmcnt(0)
  s_memtime s[56:57]
  s_waitcnt lgkmcnt(0)
  s_sub_u32 s56, s56, s54
  s_min_u32 s45, s45, s56
  s_xor_b32 s70, s44, 8192
  s_memtime s[54:55]
  s_waitcnt lgkmcnt(0)
  s_buffer_load_dword s58, s[16:19], s70
  s_waitcnt lgkmcnt(0)
  s_memtime s[56:57]
  s_waitcnt lgkmcnt(0)
  s_sub_u32 s56, s56, s54
  s_min_u32 s46, s46, s56
  s_xor_b32 s70, s44, 25472
  s_memtime s[54:55]
  s_waitcnt lgkmcnt(0)
  s_buffer_load_dword s58, s[16:19], s70
  s_waitcnt lgkmcnt(0)
  s_memtime s[56:57]
  s_waitcnt lgkmcnt(0)
  s_sub_u32 s56, s56, s54
  s_min_u32 s46, s46, s56
  s_xor_b32 s70, s44, 17280
  s_memtime s[54:55]
  s_waitcnt lgkmcnt(0)
  s_buffer_load_dword s58, s[16:19], s70
  s_waitcnt lgkmcnt(0)
  s_memtime s[56:57]
  s_waitcnt lgkmcnt(0)
  s_sub_u32 s56, s56, s54
  s_min_u32 s45, s45, s56
  s_xor_b32 s70, s44, 5888
  s_memtime s[54:55]
  s_waitcnt lgkmcnt(0)
  s_buffer_load_dword s58, s[16:19], s70
  s_waitcnt lgkmcnt(0)
  s_memtime s[56:57]
  s_waitcnt lgkmcnt(0)
  s_sub_u32 s56, s56, s54
  s_min_u32 s45, s45, s56
  s_xor_b32 s70, s44, 14080
  s_memtime s[54:55]
  s_waitcnt lgkmcnt(0)
  s_buffer_load_dword s58, s[16:19], s70
  s_waitcnt lgkmcnt(0)
  s_memtime s[56:57]
  s_waitcnt lgkmcnt(0)
  s_sub_u32 s56, s56, s54
  s_min_u32 s46, s46, s56
  s_cmp_lt_u32 s46, s45
  s_cselect_b32 s48, 1, 0
  s_lshr_b32 s70, s44, 13
  s_xor_b32 s70, s70, s2
  s_xor_b32 s70, s70, s50
  s_and_b32 s70, s70, 1
  s_xor_b32 s48, s48, s70
L_h_vote:
  s_mov_b32 s49, 0
  s_lshl_b64 s[48:49], s[48:49], s52
  s_or_b32 s49, s49, 0x100000
  s_atomic_add_x2 s[48:49], s[80:81], 0
L_h_voted:
  s_waitcnt lgkmcnt(0)
  s_cmp_lg_u32 s2, 56
  s_cbranch_scc1 L_h_nonce
  s_lshl_b64 s[54:55], s[72:73], 2
  s_atomic_add_x2 s[54:55], s[80:81], 8
  s_waitcnt lgkmcnt(0)
L_h_nonce:
L_h_progv:
  s_sleep 8
  ds_read_b32 v8, v112
  s_waitcnt lgkmcnt(0)
  v_cmp_gt_u32 vcc, 6, v8
  s_nop 1
  s_cmp_lg_u32 vcc_lo, 0
  s_cbranch_scc1 L_h_progv
  s_load_dwordx2 s[48:49], s[80:81], 0
  s_mov_b32 s59, 0
L_h_votes:
  s_waitcnt lgkmcnt(0)
  s_lshr_b32 s70, s49, 20
  s_cmp_ge_u32 s70, 56
  s_cbranch_scc1 L_h_votes_done
  s_add_u32 s59, s59, 1
  s_cmp_gt_u32 s59, 8000
  s_cbranch_scc1 L_h_votes_done
  s_sleep 64
  s_mov_b64 s[48:49], 0
  s_atomic_or_x2 s[48:49], s[80:81], 0 glc
  s_branch L_h_votes
L_h_votes_done:
  s_mov_b32 s96, 0x80
  s_bfe_u64 s[54:55], s[48:49], 0x60000
  s_cmp_gt_u32 s54, 4
  s_cselect_b32 s56, 1, 0
  s_or_b32 s96, s96, s56
  s_bfe_u64 s[54:55], s[48:49], 0x60006
  s_cmp_gt_u32 s54, 4
  s_cselect_b32 s56, 2, 0
  s_or_b32 s96, s96, s56
  s_bfe_u64 s[54:55], s[48:49], 0x6000c
  s_cmp_gt_u32 s54, 4
  s_cselect_b32 s56, 4, 0
  s_or_b32 s96, s96, s56
  s_bfe_u64 s[54:55], s[48:49], 0x60012
  s_cmp_gt_u32 s54, 4
  s_cselect_b32 s56, 8, 0
  s_or_b32 s96, s96, s56
  s_bfe_u64 s[54:55], s[48:49], 0x60018
  s_cmp_gt_u32 s54, 4
  s_cselect_b32 s56, 16, 0
  s_or_b32 s96, s96, s56
  s_bfe_u64 s[54:55], s[48:49], 0x6001e
  s_cmp_gt_u32 s54, 4
  s_cselect_b32 s56, 32, 0
  s_or_b32 s96, s96, s56
  s_and_b32 s70, s2, 3
  s_lshl2_add_u32 s70, s70, 5
  s_lshr_b32 s54, s49, s70
  s_xor_b32 s54, s54, s2
  s_xor_b32 s54, s54, s4
  s_and_b32 s54, s54, 1
  s_mul_i32 s54, s54, 63
  s_xor_b32 s96, s96, s54
  v_mov_b32 v1, 61696
  v_mov_b32 v5, s96
  ds_write_b32 v1, v5
  s_load_dwordx2 s[74:75], s[80:81], 8
  s_mov_b32 s59, 0
L_h_getnonce:
  s_waitcnt lgkmcnt(0)
  s_cmp_lg_u64 s[74:75], 0
  s_cbranch_scc1 L_h_gotnonce
  s_add_u32 s59, s59, 1
  s_cmp_gt_u32 s59, 8000
  s_cbranch_scc1 L_h_gotnonce
  s_sleep 64
  s_atomic_or_x2 s[74:75], s[80:81], 8 glc
  s_branch L_h_getnonce
L_h_gotnonce:
  s_lshr_b64 s[54:55], s[74:75], 2
  v_writelane_b32 v8, s54, 7
  s_lshr_b32 s64, s5, 5
  s_mov_b32 s50, 0xaaaaaaab
  s_add_u32 s54, s64, 0
  s_mul_hi_u32 s56, s54, s50
  s_lshr_b32 s56, s56, 1
  s_mul_i32 s56, s56, 3
  s_sub_u32 s54, s54, s56
  s_lshr_b32 s56, s96, s54
  s_bfe_u32 s56, s56, 0x10003
  s_lshl_b32 s54, s54, 7
  s_add_u32 s54, s54, s64
  s_mul_hi_u32 s54, s54, s50
  s_lshr_b32 s54, s54, 1
  s_lshl3_add_u32 s54, s54, s56
  s_mul_i32 s70, s54, 3456
  s_add_u32 s70, s70, 1048576
  v_writelane_b32 v8, s70, 0
  s_add_u32 s54, s64, 4
  s_mul_hi_u32 s56, s54, s50
  s_lshr_b32 s56, s56, 1
  s_mul_i32 s56, s56, 3
  s_sub_u32 s54, s54, s56
  s_lshr_b32 s56, s96, s54
  s_bfe_u32 s56, s56, 0x10003
  s_lshl_b32 s54, s54, 7
  s_add_u32 s54, s54, s64
  s_mul_hi_u32 s54, s54, s50
  s_lshr_b32 s54, s54, 1
  s_lshl3_add_u32 s54, s54, s56
  s_add_u32 s54, s54, 6
  s_mul_i32 s70, s54, 3456
  s_add_u32 s70, s70, 1048576
  v_writelane_b32 v8, s70, 1
  s_add_u32 s54, s64, 2
  s_mul_hi_u32 s56, s54, s50
  s_lshr_b32 s56, s56, 1
  s_mul_i32 s56, s56, 3
  s_sub_u32 s54, s54, s56
  s_lshr_b32 s56, s96, s54
  s_bfe_u32 s56, s56, 0x10003
  s_lshl_b32 s54, s54, 7
  s_add_u32 s54, s54, s64
  s_mul_hi_u32 s54, s54, s50
  s_lshr_b32 s54, s54, 1
  s_lshl3_add_u32 s54, s54, s56
  s_lshl_b32 s56, s4, 1
  s_sub_u32 s57, s54, s56
  s_add_u32 s57, s57, 4
  s_mul_i32 s70, s57, 3456
  s_add_u32 s70, s70, 1048576
  v_writelane_b32 v8, s70, 2
  s_add_u32 s54, s54, s56
  s_add_u32 s54, s54, 2
  s_xor_b32 s56, s54, 1
  s_mul_i32 s70, s56, 3456
  s_add_u32 s70, s70, 1048576
  v_writelane_b32 v8, s70, 3
  s_andn2_b32 s56, s54, 1
  s_xor_b32 s56, s56, 2
  s_mul_i32 s70, s56, 3456
  s_add_u32 s70, s70, 1048576
  v_writelane_b32 v8, s70, 4
  s_add_u32 s56, s56, 1
  s_mul_i32 s70, s56, 3456
  s_add_u32 s70, s70, 1048576
  v_writelane_b32 v8, s70, 5
  s_lshr_b32 s54, s54, 2
  s_mul_i32 s54, s54, 1536
  v_writelane_b32 v8, s54, 6
  v_lshlrev_b32 v1, 2, v0
  s_mov_b64 exec, 0xff
  ds_write_b32 v1, v8 offset:61728
  s_mov_b64 exec, -1
  s_lshl_b32 s62, s2, 8
  s_add_u32 s62, s62, 6291456
  s_xor_b32 s63, s62, 1024
  s_lshr_b32 s58, s96, 3
  s_xor_b32 s58, s58, s96
  s_mov_b32 s44, 16777216
  s_bitcmp1_b32 s5, 5
  s_cselect_b32 s70, 2048, 0
  s_xor_b32 s44, s44, s70
  s_bitcmp1_b32 s5, 6
  s_cselect_b32 s70, 4096, 0
  s_xor_b32 s44, s44, s70
  s_bitcmp1_b32 s5, 7
  s_cselect_b32 s70, 8192, 0
  s_xor_b32 s44, s44, s70
  s_bitcmp1_b32 s5, 8
  s_cselect_b32 s70, 16384, 0
  s_xor_b32 s44, s44, s70
  s_bitcmp1_b32 s5, 9
  s_cselect_b32 s70, 2097152, 0
  s_xor_b32 s44, s44, s70
  s_bitcmp1_b32 s5, 10
  s_cselect_b32 s70, 4194304, 0
  s_xor_b32 s44, s44, s70
  s_bitcmp1_b32 s5, 11
  s_cselect_b32 s70, 8388608, 0
  s_xor_b32 s44, s44, s70
  s_mul_i32 s70, s4, 1024
  s_xor_b32 s60, s44, s70
  s_xor_b32 s61, s60, 1024
  s_mov_b32 s78, 62
  s_swappc_b64 s[84:85], s[86:87]
L_h_proga:
  s_sleep 4
  ds_read_b32 v8, v112
  s_waitcnt lgkmcnt(0)
  v_cmp_gt_u32 vcc, 64, v8
  s_nop 1
  s_cmp_lg_u32 vcc_lo, 0
  s_cbranch_scc1 L_h_proga
  ds_read_b128 v[8:11], v3 offset:0
  ds_read_b128 v[12:15], v3 offset:1024
  ds_read_b128 v[16:19], v3 offset:2048
  s_waitcnt lgkmcnt(0)
  s_xor_b32 s70, s60, 0
  buffer_store_dwordx4 v[8:11], v3, s[40:43], s70 offen sc1
  s_xor_b32 s70, s60, 32768
  buffer_store_dwordx4 v[12:15], v3, s[40:43], s70 offen sc1
  s_xor_b32 s70, s60, 67584
  buffer_store_dwordx4 v[16:19], v3, s[40:43], s70 offen sc1
  s_bitcmp0_b32 s58, 2
  s_cbranch_scc1 L_h_e0
  ds_read_b128 v[20:23], v3 offset:3072
  ds_read_b128 v[24:27], v3 offset:4096
  ds_read_b128 v[28:31], v3 offset:5120
  ds_read_b128 v[32:35], v3 offset:6144
  ds_read_b128 v[36:39], v3 offset:7168
  ds_read_b128 v[40:43], v3 offset:8192
  ds_read_b128 v[44:47], v3 offset:9216
  ds_read_b128 v[48:51], v3 offset:10240
  ds_read_b128 v[52:55], v3 offset:11264
  s_waitcnt lgkmcnt(0)
  s_xor_b32 s70, s60, 100352
  buffer_store_dwordx4 v[20:23], v3, s[40:43], s70 offen sc1
  s_xor_b32 s70, s60, 136192
  buffer_store_dwordx4 v[24:27], v3, s[40:43], s70 offen sc1
  s_xor_b32 s70, s60, 168960
  buffer_store_dwordx4 v[28:31], v3, s[40:43], s70 offen sc1
  s_xor_b32 s70, s60, 203776
  buffer_store_dwordx4 v[32:35], v3, s[40:43], s70 offen sc1
  s_xor_b32 s70, s60, 236544
  buffer_store_dwordx4 v[36:39], v3, s[40:43], s70 offen sc1
  s_xor_b32 s70, s60, 272384
  buffer_store_dwordx4 v[40:43], v3, s[40:43], s70 offen sc1
  s_xor_b32 s70, s60, 305152
  buffer_store_dwordx4 v[44:47], v3, s[40:43], s70 offen sc1
  s_xor_b32 s70, s60, 335872
  buffer_store_dwordx4 v[48:51], v3, s[40:43], s70 offen sc1
  s_xor_b32 s70, s60, 368640
  buffer_store_dwordx4 v[52:55], v3, s[40:43], s70 offen sc1
L_h_e0:
  s_bitcmp0_b32 s58, 0
  s_cbranch_scc1 L_h_e1
  ds_read_b128 v[56:59], v3 offset:12288
  ds_read_b128 v[60:63], v3 offset:13312
  ds_read_b128 v[64:67], v3 offset:14336
  ds_read_b128 v[68:71], v3 offset:15360
  ds_read_b128 v[72:75], v3 offset:16384
  ds_read_b128 v[76:79], v3 offset:17408
  ds_read_b128 v[80:83], v3 offset:18432
  ds_read_b128 v[84:87], v3 offset:19456
  ds_read_b128 v[88:91], v3 offset:20480
  ds_read_b128 v[92:95], v3 offset:21504
  ds_read_b128 v[96:99], v3 offset:22528
  ds_read_b128 v[100:103], v3 offset:23552
  s_waitcnt lgkmcnt(0)
  s_xor_b32 s70, s60, 408576
  buffer_store_dwordx4 v[56:59], v3, s[40:43], s70 offen sc1
  s_xor_b32 s70, s60, 441344
  buffer_store_dwordx4 v[60:63], v3, s[40:43], s70 offen sc1
  s_xor_b32 s70, s60, 472064
  buffer_store_dwordx4 v[64:67], v3, s[40:43], s70 offen sc1
  s_xor_b32 s70, s60, 504832
  buffer_store_dwordx4 v[68:71], v3, s[40:43], s70 offen sc1
  s_xor_b32 s70, s60, 525312
  buffer_store_dwordx4 v[72:75], v3, s[40:43], s70 offen sc1
  s_xor_b32 s70, s60, 558080
  buffer_store_dwordx4 v[76:79], v3, s[40:43], s70 offen sc1
  s_xor_b32 s70, s60, 592896
  buffer_store_dwordx4 v[80:83], v3, s[40:43], s70 offen sc1
  s_xor_b32 s70, s60, 625664
  buffer_store_dwordx4 v[84:87], v3, s[40:43], s70 offen sc1
  s_xor_b32 s70, s60, 659456
  buffer_store_dwordx4 v[88:91], v3, s[40:43], s70 offen sc1
  s_xor_b32 s70, s60, 692224
  buffer_store_dwordx4 v[92:95], v3, s[40:43], s70 offen sc1
  s_xor_b32 s70, s60, 727040
  buffer_store_dwordx4 v[96:99], v3, s[40:43], s70 offen sc1
  s_xor_b32 s70, s60, 759808
  buffer_store_dwordx4 v[100:103], v3, s[40:43], s70 offen sc1
L_h_e1:
  s_add_u32 s54, s74, 1
  v_lshlrev_b32 v5, 3, v0
  s_waitcnt vmcnt(0)
  v_mov_b32 v8, s54
  v_mov_b32 v9, s75
  s_mov_b64 exec, 0xffff
  buffer_store_dwordx2 v[8:9], v5, s[40:43], s62 offen sc1
  s_mov_b64 exec, 1
  s_mov_b32 s59, 0
L_h_flaga:
  buffer_load_dwordx2 v[10:11], v5, s[40:43], s63 offen sc1
  s_waitcnt vmcnt(0)
  v_readfirstlane_b32 s56, v10
  v_readfirstlane_b32 s57, v11
  s_nop 0
  s_sub_u32 s56, s56, s54
  s_xor_b32 s57, s57, s75
  s_lshr_b32 s56, s56, 1
  s_or_b32 s56, s56, s57
  s_cbranch_scc0 L_h_flaga_done
  s_add_u32 s59, s59, 1
  s_cmp_gt_u32 s59, 100000
  s_cbranch_scc1 L_h_flaga_done
  s_sleep 8
  s_branch L_h_flaga
L_h_flaga_done:
  s_mov_b64 exec, -1
  s_bfe_u32 s54, s96, 0x10005
  s_mul_i32 s54, s54, 384
  v_lshrrev_b32 v4, 3, v0
  v_add_u32 v5, 0, v4
  v_mul_u32_u24 v5, 21846, v5
  v_bfe_u32 v5, v5, 16, 1
  v_mul_u32_u24 v6, 384, v5
  v_sub_u32 v6, v3, v6
  v_add_u32 v6, s54, v6
  v_add_u32 v6, 0, v6
  v_mul_u32_u24 v5, 1024, v5
  v_xor_b32 v5, s44, v5
  v_bfe_u32 v2, v6, 10, 1
  v_mul_u32_u24 v2, 32768, v2
  v_xor_b32 v5, v5, v2
  v_bfe_u32 v2, v6, 11, 1
  v_mul_u32_u24 v2, 67584, v2
  v_xor_b32 v5, v5, v2
  v_and_b32 v6, 1023, v6
  v_add_u32 v5, v5, v6
  buffer_load_dwordx4 v[8:11], v5, s[40:43], 0 offen sc1
  v_add_u32 v5, 8, v4
  v_mul_u32_u24 v5, 21846, v5
  v_bfe_u32 v5, v5, 16, 1
  v_mul_u32_u24 v6, 384, v5
  v_sub_u32 v6, v3, v6
  v_add_u32 v6, s54, v6
  v_add_u32 v6, 1024, v6
  v_mul_u32_u24 v5, 1024, v5
  v_xor_b32 v5, s44, v5
  v_bfe_u32 v2, v6, 10, 1
  v_mul_u32_u24 v2, 32768, v2
  v_xor_b32 v5, v5, v2
  v_bfe_u32 v2, v6, 11, 1
  v_mul_u32_u24 v2, 67584, v2
  v_xor_b32 v5, v5, v2
  v_and_b32 v6, 1023, v6
  v_add_u32 v5, v5, v6
  buffer_load_dwordx4 v[12:15], v5, s[40:43], 0 offen sc1
  v_add_u32 v5, 16, v4
  v_mul_u32_u24 v5, 21846, v5
  v_bfe_u32 v5, v5, 16, 1
  v_mul_u32_u24 v6, 384, v5
  v_sub_u32 v6, v3, v6
  v_add_u32 v6, s54, v6
  v_add_u32 v6, 2048, v6
  v_mul_u32_u24 v5, 1024, v5
  v_xor_b32 v5, s44, v5
  v_bfe_u32 v2, v6, 10, 1
  v_mul_u32_u24 v2, 32768, v2
  v_xor_b32 v5, v5, v2
  v_bfe_u32 v2, v6, 11, 1
  v_mul_u32_u24 v2, 67584, v2
  v_xor_b32 v5, v5, v2
  v_and_b32 v6, 1023, v6
  v_add_u32 v5, v5, v6
  buffer_load_dwordx4 v[16:19], v5, s[40:43], 0 offen sc1
  s_bitcmp0_b32 s58, 2
  s_cbranch_scc1 L_h_i0
  s_xor_b32 s70, s61, 100352
  buffer_load_dwordx4 v[20:23], v3, s[40:43], s70 offen sc1
  s_xor_b32 s70, s61, 136192
  buffer_load_dwordx4 v[24:27], v3, s[40:43], s70 offen sc1
  s_xor_b32 s70, s61, 168960
  buffer_load_dwordx4 v[28:31], v3, s[40:43], s70 offen sc1
  s_xor_b32 s70, s61, 203776
  buffer_load_dwordx4 v[32:35], v3, s[40:43], s70 offen sc1
  s_xor_b32 s70, s61, 236544
  buffer_load_dwordx4 v[36:39], v3, s[40:43], s70 offen sc1
  s_xor_b32 s70, s61, 272384
  buffer_load_dwordx4 v[40:43], v3, s[40:43], s70 offen sc1
  s_xor_b32 s70, s61, 305152
  buffer_load_dwordx4 v[44:47], v3, s[40:43], s70 offen sc1
  s_xor_b32 s70, s61, 335872
  buffer_load_dwordx4 v[48:51], v3, s[40:43], s70 offen sc1
  s_xor_b32 s70, s61, 368640
  buffer_load_dwordx4 v[52:55], v3, s[40:43], s70 offen sc1
  s_waitcnt vmcnt(0)
  ds_write_b128 v3, v[20:23] offset:3072
  ds_write_b128 v3, v[24:27] offset:4096
  ds_write_b128 v3, v[28:31] offset:5120
  ds_write_b128 v3, v[32:35] offset:6144
  ds_write_b128 v3, v[36:39] offset:7168
  ds_write_b128 v3, v[40:43] offset:8192
  ds_write_b128 v3, v[44:47] offset:9216
  ds_write_b128 v3, v[48:51] offset:10240
  ds_write_b128 v3, v[52:55] offset:11264
L_h_i0:
  s_bitcmp0_b32 s58, 0
  s_cbranch_scc1 L_h_i1
  s_xor_b32 s70, s61, 408576
  buffer_load_dwordx4 v[56:59], v3, s[40:43], s70 offen sc1
  s_xor_b32 s70, s61, 441344
  buffer_load_dwordx4 v[60:63], v3, s[40:43], s70 offen sc1
  s_xor_b32 s70, s61, 472064
  buffer_load_dwordx4 v[64:67], v3, s[40:43], s70 offen sc1
  s_xor_b32 s70, s61, 504832
  buffer_load_dwordx4 v[68:71], v3, s[40:43], s70 offen sc1
  s_xor_b32 s70, s61, 525312
  buffer_load_dwordx4 v[72:75], v3, s[40:43], s70 offen sc1
  s_xor_b32 s70, s61, 558080
  buffer_load_dwordx4 v[76:79], v3, s[40:43], s70 offen sc1
  s_xor_b32 s70, s61, 592896
  buffer_load_dwordx4 v[80:83], v3, s[40:43], s70 offen sc1
  s_xor_b32 s70, s61, 625664
  buffer_load_dwordx4 v[84:87], v3, s[40:43], s70 offen sc1
  s_xor_b32 s70, s61, 659456
  buffer_load_dwordx4 v[88:91], v3, s[40:43], s70 offen sc1
  s_xor_b32 s70, s61, 692224
  buffer_load_dwordx4 v[92:95], v3, s[40:43], s70 offen sc1
  s_xor_b32 s70, s61, 727040
  buffer_load_dwordx4 v[96:99], v3, s[40:43], s70 offen sc1
  s_xor_b32 s70, s61, 759808
  buffer_load_dwordx4 v[100:103], v3, s[40:43], s70 offen sc1
  s_waitcnt vmcnt(0)
  ds_write_b128 v3, v[56:59] offset:12288
  ds_write_b128 v3, v[60:63] offset:13312
  ds_write_b128 v3, v[64:67] offset:14336
  ds_write_b128 v3, v[68:71] offset:15360
  ds_write_b128 v3, v[72:75] offset:16384
  ds_write_b128 v3, v[76:79] offset:17408
  ds_write_b128 v3, v[80:83] offset:18432
  ds_write_b128 v3, v[84:87] offset:19456
  ds_write_b128 v3, v[88:91] offset:20480
  ds_write_b128 v3, v[92:95] offset:21504
  ds_write_b128 v3, v[96:99] offset:22528
  ds_write_b128 v3, v[100:103] offset:23552
L_h_i1:
  s_waitcnt vmcnt(0)
  ds_write_b128 v3, v[8:11] offset:0
  ds_write_b128 v3, v[12:15] offset:1024
  ds_write_b128 v3, v[16:19] offset:2048
  s_bitcmp0_b32 s58, 1
  s_cselect_b32 s70, 255, 32
  v_mov_b32 v1, 61700
  v_mov_b32 v5, s70
  ds_write_b32 v1, v5
  s_mov_b32 s78, 94
  s_swappc_b64 s[84:85], s[86:87]
  s_bitcmp0_b32 s58, 1
  s_cbranch_scc1 L_h_all
L_h_progb:
  s_sleep 4
  ds_read_b32 v8, v112
  s_waitcnt lgkmcnt(0)
  v_cmp_gt_u32 vcc, 96, v8
  s_nop 1
  s_cmp_lg_u32 vcc_lo, 0
  s_cbranch_scc1 L_h_progb
  ds_read_b128 v[8:11], v3 offset:24576
  ds_read_b128 v[12:15], v3 offset:25600
  ds_read_b128 v[16:19], v3 offset:26624
  ds_read_b128 v[20:23], v3 offset:27648
  ds_read_b128 v[24:27], v3 offset:28672
  ds_read_b128 v[28:31], v3 offset:29696
  ds_read_b128 v[32:35], v3 offset:30720
  ds_read_b128 v[36:39], v3 offset:31744
  ds_read_b128 v[40:43], v3 offset:32768
  ds_read_b128 v[44:47], v3 offset:33792
  ds_read_b128 v[48:51], v3 offset:34816
  ds_read_b128 v[52:55], v3 offset:35840
  s_waitcnt lgkmcnt(0)
  s_xor_b32 s70, s60, 797696
  buffer_store_dwordx4 v[8:11], v3, s[40:43], s70 offen sc1
  s_xor_b32 s70, s60, 830464
  buffer_store_dwordx4 v[12:15], v3, s[40:43], s70 offen sc1
  s_xor_b32 s70, s60, 861184
  buffer_store_dwordx4 v[16:19], v3, s[40:43], s70 offen sc1
  s_xor_b32 s70, s60, 893952
  buffer_store_dwordx4 v[20:23], v3, s[40:43], s70 offen sc1
  s_xor_b32 s70, s60, 931840
  buffer_store_dwordx4 v[24:27], v3, s[40:43], s70 offen sc1
  s_xor_b32 s70, s60, 964608
  buffer_store_dwordx4 v[28:31], v3, s[40:43], s70 offen sc1
  s_xor_b32 s70, s60, 995328
  buffer_store_dwordx4 v[32:35], v3, s[40:43], s70 offen sc1
  s_xor_b32 s70, s60, 1028096
  buffer_store_dwordx4 v[36:39], v3, s[40:43], s70 offen sc1
  s_xor_b32 s70, s60, 1052672
  buffer_store_dwordx4 v[40:43], v3, s[40:43], s70 offen sc1
  s_xor_b32 s70, s60, 1085440
  buffer_store_dwordx4 v[44:47], v3, s[40:43], s70 offen sc1
  s_xor_b32 s70, s60, 1120256
  buffer_store_dwordx4 v[48:51], v3, s[40:43], s70 offen sc1
  s_xor_b32 s70, s60, 1153024
  buffer_store_dwordx4 v[52:55], v3, s[40:43], s70 offen sc1
  s_add_u32 s54, s74, 2
  v_lshlrev_b32 v5, 3, v0
  s_waitcnt vmcnt(0)
  v_mov_b32 v8, s54
  v_mov_b32 v9, s75
  s_mov_b64 exec, 0xffff
  buffer_store_dwordx2 v[8:9], v5, s[40:43], s62 offen sc1
  s_mov_b64 exec, 1
  s_mov_b32 s59, 0
L_h_flagb:
  buffer_load_dwordx2 v[10:11], v5, s[40:43], s63 offen sc1
  s_waitcnt vmcnt(0)
  v_readfirstlane_b32 s56, v10
  v_readfirstlane_b32 s57, v11
  s_nop 0
  s_sub_u32 s56, s56, s54
  s_xor_b32 s57, s57, s75
  s_lshr_b32 s56, s56, 1
  s_or_b32 s56, s56, s57
  s_cbranch_scc0 L_h_flagb_done
  s_add_u32 s59, s59, 1
  s_cmp_gt_u32 s59, 100000
  s_cbranch_scc1 L_h_flagb_done
  s_sleep 8
  s_branch L_h_flagb
L_h_flagb_done:
  s_mov_b64 exec, -1
  s_xor_b32 s70, s61, 797696
  buffer_load_dwordx4 v[8:11], v3, s[40:43], s70 offen sc1
  s_xor_b32 s70, s61, 830464
  buffer_load_dwordx4 v[12:15], v3, s[40:43], s70 offen sc1
  s_xor_b32 s70, s61, 861184
  buffer_load_dwordx4 v[16:19], v3, s[40:43], s70 offen sc1
  s_xor_b32 s70, s61, 893952
  buffer_load_dwordx4 v[20:23], v3, s[40:43], s70 offen sc1
  s_xor_b32 s70, s61, 931840
  buffer_load_dwordx4 v[24:27], v3, s[40:43], s70 offen sc1
  s_xor_b32 s70, s61, 964608
  buffer_load_dwordx4 v[28:31], v3, s[40:43], s70 offen sc1
  s_xor_b32 s70, s61, 995328
  buffer_load_dwordx4 v[32:35], v3, s[40:43], s70 offen sc1
  s_xor_b32 s70, s61, 1028096
  buffer_load_dwordx4 v[36:39], v3, s[40:43], s70 offen sc1
  s_xor_b32 s70, s61, 1052672
  buffer_load_dwordx4 v[40:43], v3, s[40:43], s70 offen sc1
  s_xor_b32 s70, s61, 1085440
  buffer_load_dwordx4 v[44:47], v3, s[40:43], s70 offen sc1
  s_xor_b32 s70, s61, 1120256
  buffer_load_dwordx4 v[48:51], v3, s[40:43], s70 offen sc1
  s_xor_b32 s70, s61, 1153024
  buffer_load_dwordx4 v[52:55], v3, s[40:43], s70 offen sc1
  s_waitcnt vmcnt(0)
  ds_write_b128 v3, v[8:11] offset:24576
  ds_write_b128 v3, v[12:15] offset:25600
  ds_write_b128 v3, v[16:19] offset:26624
  ds_write_b128 v3, v[20:23] offset:27648
  ds_write_b128 v3, v[24:27] offset:28672
  ds_write_b128 v3, v[28:31] offset:29696
  ds_write_b128 v3, v[32:35] offset:30720
  ds_write_b128 v3, v[36:39] offset:31744
  ds_write_b128 v3, v[40:43] offset:32768
  ds_write_b128 v3, v[44:47] offset:33792
  ds_write_b128 v3, v[48:51] offset:34816
  ds_write_b128 v3, v[52:55] offset:35840
  v_mov_b32 v1, 61700
  v_mov_b32 v5, 255
  ds_write_b32 v1, v5
L_h_all:
  s_mov_b32 s78, 186
  s_swappc_b64 s[84:85], s[86:87]
L_h_progt:
  s_sleep 4
  ds_read_b32 v8, v112
  s_waitcnt lgkmcnt(0)
  v_cmp_gt_u32 vcc, 188, v8
  s_nop 1
  s_cmp_lg_u32 vcc_lo, 0
  s_cbranch_scc1 L_h_progt
  v_mov_b32 v8, 255
  ds_write_b32 v112, v8 offset:8
  s_branch L_finish
L_h_cp:
  s_cmp_gt_u32 s76, s78
  s_cbranch_scc0 L_h_cpgo
  s_setpc_b64 s[84:85]
L_h_cpgo:
  ds_read_b32 v8, v112
  s_waitcnt lgkmcnt(0)
  v_cmp_gt_u32 vcc, s76, v8
  s_nop 1
  s_cmp_eq_u32 vcc_lo, 0
  s_cbranch_scc1 L_h_cpnext
L_h_first:
  s_sleep 2
  ds_read_b32 v8, v112
  s_waitcnt lgkmcnt(0)
  v_cmp_gt_u32 s[48:49], s76, v8
  s_nop 1
  s_cmp_eq_u32 s48, -1
  s_cbranch_scc1 L_h_first
  s_memrealtime s[54:55]
L_h_progm:
  s_sleep 2
  ds_read_b32 v8, v112
  s_waitcnt lgkmcnt(0)
  v_cmp_gt_u32 vcc, s76, v8
  s_nop 1
  s_cmp_lg_u32 vcc_lo, 0
  s_cbranch_scc1 L_h_progm
  s_memrealtime s[56:57]
  v_mov_b32 v114, s54
  v_mov_b32 v115, s55
  s_mov_b64 exec, s[48:49]
  s_waitcnt lgkmcnt(0)
  v_mov_b32 v114, s56
  v_mov_b32 v115, s57
  s_mov_b64 exec, -1
  s_cmp_ge_u32 s2, 8
  s_cbranch_scc1 L_h_np
  s_mov_b64 exec, 0xff
  buffer_store_dwordx2 v[114:115], v104, s[40:43], s77 offen sc1
  s_mov_b64 exec, -1
L_h_np:
  s_add_u32 s50, s76, 2
L_h_progc:
  s_sleep 4
  ds_read_b32 v8, v112
  s_waitcnt lgkmcnt(0)
  v_cmp_gt_u32 vcc, s50, v8
  s_nop 1
  s_cmp_lg_u32 vcc_lo, 0
  s_cbranch_scc1 L_h_progc
  buffer_load_dwordx2 v[8:9], v105, s[40:43], s77 offen
  v_mov_b32 v10, s73
  s_waitcnt vmcnt(0)
  ds_read_b32 v12, v112
  v_subrev_co_u32 v8, vcc, s72, v8
  s_nop 1
  v_subb_co_u32 v9, vcc, v9, v10, vcc
  v_lshrrev_b32 v10, 24, v8
  v_or_b32 v9, v9, v10
  v_cmp_eq_u32 vcc, 0, v9
  s_nop 1
  v_cndmask_b32 v8, 0, v8, vcc
  s_and_b32 s56, vcc_lo, 0xffff
  s_bcnt1_i32_b32 s56, s56
  v_add_u32_dpp v8, v8, v8 row_ror:8 row_mask:0xf bank_mask:0xf
  s_nop 1
  v_add_u32_dpp v8, v8, v8 row_ror:4 row_mask:0xf bank_mask:0xf
  s_nop 1
  v_add_u32_dpp v8, v8, v8 row_ror:2 row_mask:0xf bank_mask:0xf
  s_nop 1
  v_add_u32_dpp v8, v8, v8 row_ror:1 row_mask:0xf bank_mask:0xf
  v_subrev_u32 v9, s72, v114
  v_mul_lo_u32 v9, v9, s56
  s_max_u32 s56, s56, 1
  v_sub_u32 v8, v9, v8
  v_cvt_f32_u32 v9, s56
  v_cvt_f32_i32 v8, v8
  v_rcp_f32 v9, v9
  s_nop 0
  v_mul_f32 v8, v8, v9
  v_cvt_i32_f32 v8, v8
  s_waitcnt lgkmcnt(0)
  v_add_u32 v12, 2, v12
  v_min_u32 v9, v113, v12
  v_subrev_u32 v9, s76, v9
  v_max_i32 v9, 0, v9
  v_lshrrev_b32 v9, 1, v9
  v_mul_u32_u24 v9, 36, v9
  v_sub_u32 v8, v8, v9
  v_add_u32 v9, 28, v8
  v_max_i32 v9, 0, v9
  v_min_i32 v9, 2000, v9
  v_mul_u32_u24 v9, 1820, v9
  v_lshrrev_b32 v9, 16, v9
  v_cmp_ne_u32 vcc, 0, v9
  v_lshl_add_u32 v9, v9, 1, v12
  s_nop 0
  v_cndmask_b32 v113, 0, v9, vcc
  ds_write_b32 v112, v113 offset:8
L_h_cpnext:
  s_add_u32 s76, s76, 4
  s_add_u32 s77, s77, 512
  s_branch L_h_cp
L_code_end:
.section .rodata,"a"
.p2align 6
.amdhsa_kernel standalone__kv_cache_quant_int4_int2_kv_with_per_channel_or_per_token_scales__sampling_kernel
  .amdhsa_next_free_vgpr 256
  .amdhsa_next_free_sgpr 102
  .amdhsa_accum_offset 256
  .amdhsa_group_segment_fixed_size 0
  .amdhsa_kernarg_size 80
  .amdhsa_user_sgpr_count 2
  .amdhsa_user_sgpr_kernarg_segment_ptr 1
  .amdhsa_system_sgpr_workgroup_id_x 1
  .amdhsa_float_denorm_mode_32 3
.end_amdhsa_kernel
```

```asm
; @launch grid=(256,1,1) block=(192,1,1) lds=62464
.amdgcn_target "amdgcn-amd-amdhsa--gfx950"
.text
.globl standalone__kv_cache_quant_int4_int2_kv_with_per_channel_or_per_token_scales__sampling_kernel
.p2align 8
.type standalone__kv_cache_quant_int4_int2_kv_with_per_channel_or_per_token_scales__sampling_kernel,@function
standalone__kv_cache_quant_int4_int2_kv_with_per_channel_or_per_token_scales__sampling_kernel:
  s_cmp_ge_u32 s2, 256
  s_cbranch_scc1 L_end
  s_load_dwordx16 s[44:59], s[0:1], 0
  s_load_dwordx4 s[80:83], s[0:1], 64
  v_lshrrev_b32 v1, 6, v0
  v_and_b32 v0, 63, v0
  v_readfirstlane_b32 s3, v1
  s_bfe_u32 s4, s2, 0x10002
  s_lshr_b32 s5, s2, 3
  s_lshl_b32 s5, s5, 2
  s_and_b32 s70, s2, 3
  s_add_u32 s5, s5, s70
  s_lshl_b32 s5, s5, 5
  s_mov_b32 s22, 6291456
  s_mov_b32 s23, 0x20000
  s_mov_b32 s26, 6291456
  s_mov_b32 s27, 0x20000
  s_mov_b32 s30, 2097152
  s_mov_b32 s31, 0x20000
  s_mov_b32 s34, 2097152
  s_mov_b32 s35, 0x20000
  s_mov_b32 s10, 805306368
  s_mov_b32 s11, 0x20000
  s_mov_b32 s38, 393216
  s_mov_b32 s39, 0x20000
  s_mov_b32 s18, 805306368
  s_mov_b32 s19, 0x20000
  s_mov_b32 s14, 805306368
  s_mov_b32 s15, 0x20000
  s_mov_b32 s42, 33554432
  s_mov_b32 s43, 0x20000
  s_cmp_eq_u32 s3, 2
  s_cbranch_scc1 L_helper
  v_and_b32 v108, 3, v0
  v_bfe_u32 v109, v0, 2, 2
  v_lshrrev_b32 v110, 4, v0
  v_and_b32 v111, 15, v0
  v_lshlrev_b32 v144, 4, v108
  v_lshl_add_u32 v144, v110, 6, v144
  v_lshrrev_b32 v233, 1, v144
  v_and_b32 v231, 2, v109
  v_lshlrev_b32 v230, 5, v231
  v_add_u32 v230, 129, v230
  v_and_b32 v145, 1, v109
  v_lshl_add_u32 v231, v145, 2, v231
  v_mul_u32_u24 v145, 33024, v145
  v_add_u32 v232, v144, v145
  v_subrev_u32 v232, 33024, v232
  v_mul_u32_u24 v145, 384, v109
  v_add_u32 v235, v145, v233
  v_mov_b32 v105, 2147483632
  s_mov_b32 s90, 0xaaaaaaab
  s_mov_b32 s91, 0x492492
  s_movk_i32 s63, 768
  s_mov_b32 s64, s3
  s_mov_b32 s99, 8
  s_mov_b32 s96, 0
  v_lshlrev_b32 v114, 4, v0
  s_lshl1_add_u32 s70, s2, s3
  s_mul_i32 s88, s70, 4096
  s_mul_i32 s86, s70, 12288
  s_waitcnt lgkmcnt(0)
  s_mov_b32 s20, s50
  s_and_b32 s21, s51, 0xffff
  s_mov_b32 s24, s52
  s_and_b32 s25, s53, 0xffff
  s_mov_b32 s28, s54
  s_and_b32 s29, s55, 0xffff
  s_mov_b32 s32, s56
  s_and_b32 s33, s57, 0xffff
  buffer_load_dwordx4 v[128:131], v114, s[20:23], s86 offen offset:0
  buffer_load_dwordx4 v[128:131], v114, s[24:27], s86 offen offset:0
  buffer_load_dwordx4 v[128:131], v114, s[28:31], s88 offen offset:0
  buffer_load_dwordx4 v[128:131], v114, s[32:35], s88 offen offset:0
  buffer_load_dwordx4 v[128:131], v114, s[20:23], s86 offen offset:1024
  buffer_load_dwordx4 v[128:131], v114, s[24:27], s86 offen offset:1024
  buffer_load_dwordx4 v[128:131], v114, s[28:31], s88 offen offset:1024
  buffer_load_dwordx4 v[128:131], v114, s[32:35], s88 offen offset:1024
  s_mov_b32 s8, s46
  s_and_b32 s9, s47, 0xffff
  s_mov_b32 s36, s44
  s_and_b32 s37, s45, 0xffff
  s_mov_b32 s16, s46
  s_and_b32 s17, s47, 0xffff
  s_mov_b32 s12, s48
  s_and_b32 s13, s49, 0xffff
  s_mov_b32 s40, s82
  s_and_b32 s41, s83, 0xffff
  s_mov_b64 s[46:47], s[58:59]
  s_mov_b32 s56, 0x0f0f0f0f
  s_mov_b32 s57, 0x0f0f0f0f
  s_mov_b32 s58, 0xffff
  s_mov_b32 s59, 0xffff
  s_lshr_b32 s71, s64, 4
  s_andn2_b32 s71, s71, 1
  s_lshr_b32 s71, 0x12, s71
  s_and_b32 s71, s71, 3
  s_lshr_b32 s85, s96, s71
  s_andn2_b32 s70, s64, 1
  s_or_b32 s70, s70, s4
  s_cmp_lt_u32 s64, 8
  s_cselect_b32 s70, s70, s64
  s_cselect_b32 s85, s64, s85
  s_and_b32 s85, s85, 1
  s_and_b32 s70, s70, 31
  s_lshl_b32 s71, s71, 12
  s_add_u32 s70, s70, s5
  s_add_u32 s70, s70, s71
  s_mul_hi_u32 s84, s70, s90
  s_lshr_b32 s84, s84, 1
  s_mul_i32 s71, s84, 3
  s_sub_u32 s70, s70, s71
  s_lshl3_add_u32 s85, s70, s85
  s_mul_i32 s61, s84, 196608
  s_lshr_b32 s89, s84, 4
  s_lshl_b32 s70, s85, 5
  v_add_u32 v97, s70, v230
  v_mul_u32_u24 v97, 21846, v97
  v_lshrrev_b32 v97, 16, v97
  v_add_u32 v144, s85, v231
  v_lshrrev_b32 v145, v144, s91
  v_and_b32 v145, 1, v145
  v_cmp_eq_u32 s[54:55], 1, v145
  s_nop 1
  s_and_b64 s[52:53], s[54:55], s[56:57]
  s_andn2_b64 s[54:55], s[54:55], s[56:57]
  v_mul_u32_u24 v144, 43, v144
  v_lshrrev_b32 v144, 8, v144
  v_mul_u32_u24 v144, 384, v144
  v_add_u32 v234, v144, v233
  v_mad_u32_u24 v92, v97, s63, v232
  v_add_u32 v93, 768, v92
  v_add_u32 v94, 4608, v92
  v_add_u32 v95, 7680, v92
  v_cndmask_b32 v92, v92, v105, s[52:53]
  v_cndmask_b32 v95, v95, v105, s[54:55]
  s_mov_b32 s60, s61
  s_mul_i32 s70, s89, 1536
  buffer_load_dwordx2 v[174:175], v235, s[36:39], s70 offen offset:0
  buffer_load_dwordx2 v[176:177], v235, s[36:39], s70 offen offset:128
  buffer_load_dwordx2 v[178:179], v235, s[36:39], s70 offen offset:256
  buffer_load_dwordx4 v[4:7], v92, s[8:11], s60 offen offset:0 nt
  buffer_load_dwordx4 v[128:131], v114, s[20:23], s86 offen offset:2048
  buffer_load_dwordx4 v[128:131], v114, s[24:27], s86 offen offset:2048
  buffer_load_dwordx4 v[128:131], v114, s[28:31], s88 offen offset:2048
  buffer_load_dwordx4 v[128:131], v114, s[32:35], s88 offen offset:2048
  buffer_load_dwordx4 v[128:131], v114, s[20:23], s86 offen offset:3072
  buffer_load_dwordx4 v[128:131], v114, s[24:27], s86 offen offset:3072
  buffer_load_dwordx4 v[128:131], v114, s[28:31], s88 offen offset:3072
  buffer_load_dwordx4 v[128:131], v114, s[32:35], s88 offen offset:3072
  s_add_u32 s86, s86, 4096
  buffer_load_dwordx4 v[128:131], v114, s[20:23], s86 offen offset:0
  buffer_load_dwordx4 v[128:131], v114, s[24:27], s86 offen offset:0
  buffer_load_dwordx4 v[128:131], v114, s[20:23], s86 offen offset:1024
  buffer_load_dwordx4 v[128:131], v114, s[24:27], s86 offen offset:1024
  buffer_load_dwordx4 v[128:131], v114, s[20:23], s86 offen offset:2048
  buffer_load_dwordx4 v[128:131], v114, s[24:27], s86 offen offset:2048
  buffer_load_dwordx4 v[128:131], v114, s[20:23], s86 offen offset:3072
  buffer_load_dwordx4 v[128:131], v114, s[24:27], s86 offen offset:3072
  s_barrier
  s_mov_b64 vcc, 0
  v_lshlrev_b32 v144, 4, v111
  v_and_b32 v2, 2, v110
  v_lshlrev_b32 v1, 5, v2
  v_add_u32 v1, 129, v1
  v_and_b32 v145, 1, v110
  v_lshl_add_u32 v2, v145, 2, v2
  v_mul_u32_u24 v145, 33024, v145
  v_add_u32 v3, v144, v145
  v_subrev_u32 v3, 33024, v3
  v_and_b32 v145, 1, v110
  v_mul_u32_u24 v145, 86, v145
  v_lshl_add_u32 v96, v111, 1, v145
  v_subrev_u32 v96, 86, v96
  v_lshlrev_b32 v101, 4, v110
  v_lshrrev_b32 v144, 2, v0
  s_mul_i32 s70, s3, 384
  v_lshl_add_u32 v99, v144, 4, s70
  v_lshl_add_u32 v100, v144, 3, s70
  s_mul_i32 s70, s3, 3072
  s_add_u32 s70, s70, 36864
  v_lshl_add_u32 v102, v0, 4, s70
  s_lshl_b32 s70, s3, 5
  s_add_u32 s70, s70, 43008
  v_lshl_add_u32 v103, v109, 3, s70
  s_lshl2_add_u32 s70, s3, 61712
  v_mov_b32 v104, s70
  v_mov_b32 v112, 0
  v_mov_b32 v113, 0
  v_mov_b32 v236, 0xff800000
  v_mov_b32 v146, 1
  s_mov_b32 s65, 0xffff0000
  s_mov_b32 s66, 0x3fb8aa3b
  s_mov_b32 s68, 0x3d93cd3a
  s_mov_b32 s69, 0x3d93cd3a
  s_mov_b32 s72, 0x11111111
  s_mov_b32 s73, 0x11111111
  s_mov_b32 s74, 0x22222222
  s_mov_b32 s75, 0x22222222
  s_mov_b32 s76, 0x44444444
  s_mov_b32 s77, 0x44444444
  s_mov_b32 s78, 0x88888888
  s_mov_b32 s79, 0x88888888
  s_add_u32 s86, s86, 4096
  s_waitcnt vmcnt(23)
  buffer_load_dwordx4 v[128:131], v114, s[20:23], s86 offen offset:0
  s_waitcnt vmcnt(23)
  buffer_load_dwordx4 v[128:131], v114, s[24:27], s86 offen offset:0
  s_waitcnt vmcnt(23)
  buffer_load_dwordx4 v[128:131], v114, s[20:23], s86 offen offset:1024
  s_waitcnt vmcnt(23)
  buffer_load_dwordx4 v[128:131], v114, s[24:27], s86 offen offset:1024
  s_waitcnt vmcnt(23)
  buffer_load_dwordx4 v[128:131], v114, s[20:23], s86 offen offset:2048
  s_waitcnt vmcnt(23)
  buffer_load_dwordx4 v[128:131], v114, s[24:27], s86 offen offset:2048
  s_waitcnt vmcnt(23)
  buffer_load_dwordx4 v[128:131], v114, s[20:23], s86 offen offset:3072
  s_waitcnt vmcnt(23)
  buffer_load_dwordx4 v[128:131], v114, s[24:27], s86 offen offset:3072
  s_mov_b32 s88, s89
  s_mul_i32 s62, s84, 1536
  buffer_load_dwordx2 v[180:181], v234, s[20:23], s62 offen offset:0
  buffer_load_dwordx2 v[186:187], v234, s[24:27], s62 offen offset:0
  buffer_load_dwordx2 v[182:183], v234, s[20:23], s62 offen offset:128
  buffer_load_dwordx2 v[188:189], v234, s[24:27], s62 offen offset:128
  buffer_load_dwordx2 v[184:185], v234, s[20:23], s62 offen offset:256
  buffer_load_dwordx2 v[190:191], v234, s[24:27], s62 offen offset:256
  s_waitcnt vmcnt(15)
  buffer_load_dwordx4 v[8:11], v92, s[8:11], s60 offen offset:256 nt
  s_waitcnt vmcnt(15)
  buffer_load_dwordx4 v[12:15], v92, s[8:11], s60 offen offset:512 nt
  s_waitcnt vmcnt(15)
  buffer_load_dwordx4 v[16:19], v93, s[8:11], s60 offen offset:0 nt
  s_waitcnt vmcnt(15)
  buffer_load_dwordx4 v[20:23], v93, s[8:11], s60 offen offset:256 nt
  s_waitcnt vmcnt(15)
  buffer_load_dwordx4 v[24:27], v93, s[8:11], s60 offen offset:512 nt
  s_waitcnt vmcnt(15)
  buffer_load_dwordx4 v[28:31], v93, s[8:11], s60 offen offset:768 nt
  s_waitcnt vmcnt(15)
  buffer_load_dwordx4 v[32:35], v93, s[8:11], s60 offen offset:1024 nt
  s_waitcnt vmcnt(15)
  buffer_load_dwordx4 v[36:39], v93, s[8:11], s60 offen offset:1280 nt
  s_waitcnt vmcnt(15)
  buffer_load_dwordx4 v[40:43], v93, s[8:11], s60 offen offset:1536 nt
  s_waitcnt vmcnt(15)
  buffer_load_dwordx4 v[44:47], v93, s[8:11], s60 offen offset:1792 nt
  s_waitcnt vmcnt(16)
  buffer_load_dwordx4 v[48:51], v93, s[8:11], s60 offen offset:2048 nt
  s_waitcnt vmcnt(17)
  buffer_load_dwordx4 v[52:55], v93, s[8:11], s60 offen offset:2304 nt
  s_waitcnt vmcnt(18)
  buffer_load_dwordx4 v[56:59], v93, s[8:11], s60 offen offset:2560 nt
  s_waitcnt vmcnt(19)
  buffer_load_dwordx4 v[60:63], v93, s[8:11], s60 offen offset:2816 nt
  s_waitcnt vmcnt(14)
  ds_write_b32 v104, v146
L_k:
  v_add_u32 v144, s85, v2
  v_lshrrev_b32 v145, v144, s91
  v_and_b32 v145, 1, v145
  v_cmp_eq_u32 s[50:51], 1, v145
  s_nop 1
  s_and_b64 s[48:49], s[50:51], s[58:59]
  s_andn2_b64 s[50:51], s[50:51], s[58:59]
  s_mov_b32 s97, s64
  s_add_u32 s64, s64, 2
  ds_read_b32 v106, v104 offset:8
  s_waitcnt vmcnt(14)
  s_cbranch_vccnz L_kw0_0
  s_waitcnt vmcnt(9)
L_kw0_0:
  buffer_load_dwordx4 v[64:67], v93, s[8:11], s60 offen offset:3072 nt
  v_lshlrev_b32 v204, 16, v186
  v_and_b32 v205, s65, v186
  v_lshlrev_b32 v206, 16, v187
  v_and_b32 v207, s65, v187
  v_lshlrev_b32 v192, 16, v180
  v_and_b32 v193, s65, v180
  v_lshlrev_b32 v194, 16, v181
  v_and_b32 v195, s65, v181
  v_mov_b32 v168, v174
  v_mov_b32 v169, v175
  v_cvt_f32_i32 v108, v4
  v_cvt_f32_i32 v109, v5
  v_cvt_f32_i32 v110, v6
  v_cvt_f32_i32 v111, v7
  v_pk_add_f32 v[108:109], v[108:109], v[204:205] neg_lo:[0,1] neg_hi:[0,1]
  v_pk_add_f32 v[110:111], v[110:111], v[206:207] neg_lo:[0,1] neg_hi:[0,1]
  v_cvt_pk_bf16_f32 v108, 0, v108
  v_cvt_pk_bf16_f32 v109, 0, v109
  v_cvt_pk_bf16_f32 v110, 0, v110
  v_cvt_pk_bf16_f32 v111, 0, v111
  v_pk_mul_f32 v[108:109], v[108:109], v[192:193]
  v_pk_mul_f32 v[110:111], v[110:111], v[194:195]
  v_cvt_pk_bf16_f32 v216, v108, v109
  v_cvt_pk_bf16_f32 v217, v110, v111
  s_waitcnt lgkmcnt(0)
  v_cmp_lt_u32 vcc, s97, v106
  s_waitcnt vmcnt(14)
  buffer_load_dwordx4 v[68:71], v93, s[8:11], s60 offen offset:3328 nt
  v_lshlrev_b32 v208, 16, v188
  v_and_b32 v209, s65, v188
  v_lshlrev_b32 v210, 16, v189
  v_and_b32 v211, s65, v189
  v_lshlrev_b32 v196, 16, v182
  v_and_b32 v197, s65, v182
  v_lshlrev_b32 v198, 16, v183
  v_and_b32 v199, s65, v183
  v_mov_b32 v170, v176
  v_mov_b32 v171, v177
  v_cvt_f32_i32 v108, v8
  v_cvt_f32_i32 v109, v9
  v_cvt_f32_i32 v110, v10
  v_cvt_f32_i32 v111, v11
  v_pk_add_f32 v[108:109], v[108:109], v[208:209] neg_lo:[0,1] neg_hi:[0,1]
  v_pk_add_f32 v[110:111], v[110:111], v[210:211] neg_lo:[0,1] neg_hi:[0,1]
  v_cvt_pk_bf16_f32 v108, 0, v108
  v_cvt_pk_bf16_f32 v109, 0, v109
  v_cvt_pk_bf16_f32 v110, 0, v110
  v_cvt_pk_bf16_f32 v111, 0, v111
  v_pk_mul_f32 v[108:109], v[108:109], v[196:197]
  v_pk_mul_f32 v[110:111], v[110:111], v[198:199]
  v_cvt_pk_bf16_f32 v218, v108, v109
  v_cvt_pk_bf16_f32 v219, v110, v111
  s_waitcnt vmcnt(14)
  buffer_load_dwordx4 v[72:75], v93, s[8:11], s60 offen offset:3584 nt
  v_mfma_f32_16x16x32_bf16 v[224:227], v[216:219], v[168:171], 0
  v_lshlrev_b32 v212, 16, v190
  v_and_b32 v213, s65, v190
  v_lshlrev_b32 v214, 16, v191
  v_and_b32 v215, s65, v191
  v_lshlrev_b32 v200, 16, v184
  v_and_b32 v201, s65, v184
  v_lshlrev_b32 v202, 16, v185
  v_and_b32 v203, s65, v185
  v_mov_b32 v172, v178
  v_mov_b32 v173, v179
  v_cvt_f32_i32 v108, v12
  v_cvt_f32_i32 v109, v13
  v_cvt_f32_i32 v110, v14
  v_cvt_f32_i32 v111, v15
  v_pk_add_f32 v[108:109], v[108:109], v[212:213] neg_lo:[0,1] neg_hi:[0,1]
  v_pk_add_f32 v[110:111], v[110:111], v[214:215] neg_lo:[0,1] neg_hi:[0,1]
  v_cvt_pk_bf16_f32 v108, 0, v108
  v_cvt_pk_bf16_f32 v109, 0, v109
  v_cvt_pk_bf16_f32 v110, 0, v110
  v_cvt_pk_bf16_f32 v111, 0, v111
  v_pk_mul_f32 v[108:109], v[108:109], v[200:201]
  v_pk_mul_f32 v[110:111], v[110:111], v[202:203]
  v_cvt_pk_bf16_f32 v220, v108, v109
  v_cvt_pk_bf16_f32 v221, v110, v111
  s_waitcnt vmcnt(14)
  s_cbranch_vccnz L_kw0_3
  s_waitcnt vmcnt(9)
L_kw0_3:
  buffer_load_dwordx4 v[76:79], v94, s[8:11], s60 offen offset:0 nt
  v_mfma_f32_16x16x16_bf16 v[224:227], v[220:221], v[172:173], v[224:227]
  v_cvt_f32_i32 v108, v16
  v_cvt_f32_i32 v109, v17
  v_cvt_f32_i32 v110, v18
  v_cvt_f32_i32 v111, v19
  v_pk_add_f32 v[108:109], v[108:109], v[204:205] neg_lo:[0,1] neg_hi:[0,1]
  v_pk_add_f32 v[110:111], v[110:111], v[206:207] neg_lo:[0,1] neg_hi:[0,1]
  v_cvt_pk_bf16_f32 v108, 0, v108
  v_cvt_pk_bf16_f32 v109, 0, v109
  v_cvt_pk_bf16_f32 v110, 0, v110
  v_cvt_pk_bf16_f32 v111, 0, v111
  v_pk_mul_f32 v[108:109], v[108:109], v[192:193]
  v_pk_mul_f32 v[110:111], v[110:111], v[194:195]
  v_cvt_pk_bf16_f32 v216, v108, v109
  v_cvt_pk_bf16_f32 v217, v110, v111
  s_waitcnt vmcnt(14)
  buffer_load_dwordx4 v[80:83], v94, s[8:11], s60 offen offset:256 nt
  v_cvt_f32_i32 v108, v20
  v_cvt_f32_i32 v109, v21
  v_cvt_f32_i32 v110, v22
  v_cvt_f32_i32 v111, v23
  v_pk_add_f32 v[108:109], v[108:109], v[208:209] neg_lo:[0,1] neg_hi:[0,1]
  v_pk_add_f32 v[110:111], v[110:111], v[210:211] neg_lo:[0,1] neg_hi:[0,1]
  v_mov_b32_dpp v144, v224 quad_perm:[0,0,0,0] row_mask:0xf bank_mask:0xf
  v_mov_b32_dpp v145, v226 quad_perm:[2,2,2,2] row_mask:0xf bank_mask:0xf
  v_cvt_pk_bf16_f32 v108, 0, v108
  v_cvt_pk_bf16_f32 v109, 0, v109
  v_add_f32_dpp v144, v225, v144 quad_perm:[1,1,1,1] row_mask:0xf bank_mask:0xf
  v_add_f32_dpp v145, v227, v145 quad_perm:[3,3,3,3] row_mask:0xf bank_mask:0xf
  v_cvt_pk_bf16_f32 v110, 0, v110
  v_cvt_pk_bf16_f32 v111, 0, v111
  v_add_f32 v228, v144, v145
  v_pk_mul_f32 v[108:109], v[108:109], v[196:197]
  v_pk_mul_f32 v[110:111], v[110:111], v[198:199]
  v_cvt_pk_bf16_f32 v218, v108, v109
  v_cvt_pk_bf16_f32 v219, v110, v111
  s_waitcnt vmcnt(14)
  buffer_load_dwordx4 v[84:87], v94, s[8:11], s60 offen offset:512 nt
  v_mfma_f32_16x16x32_bf16 v[224:227], v[216:219], v[168:171], 0
  v_cvt_f32_i32 v108, v24
  v_cvt_f32_i32 v109, v25
  v_cvt_f32_i32 v110, v26
  v_cvt_f32_i32 v111, v27
  v_pk_add_f32 v[108:109], v[108:109], v[212:213] neg_lo:[0,1] neg_hi:[0,1]
  v_pk_add_f32 v[110:111], v[110:111], v[214:215] neg_lo:[0,1] neg_hi:[0,1]
  v_cvt_pk_bf16_f32 v108, 0, v108
  v_cndmask_b32 v228, v228, v236, s[48:49]
  v_cvt_pk_bf16_f32 v109, 0, v109
  v_cvt_pk_bf16_f32 v110, 0, v110
  v_cvt_pk_bf16_f32 v111, 0, v111
  v_pk_mul_f32 v[108:109], v[108:109], v[200:201]
  v_pk_mul_f32 v[110:111], v[110:111], v[202:203]
  v_cvt_pk_bf16_f32 v220, v108, v109
  v_cvt_pk_bf16_f32 v221, v110, v111
  s_waitcnt vmcnt(14)
  s_cbranch_vccnz L_kw0_6
  s_waitcnt vmcnt(9)
L_kw0_6:
  buffer_load_dwordx4 v[88:91], v94, s[8:11], s60 offen offset:768 nt
  v_mfma_f32_16x16x16_bf16 v[224:227], v[220:221], v[172:173], v[224:227]
  v_cvt_f32_i32 v108, v28
  v_cvt_f32_i32 v109, v29
  v_cvt_f32_i32 v110, v30
  v_cvt_f32_i32 v111, v31
  v_pk_add_f32 v[108:109], v[108:109], v[204:205] neg_lo:[0,1] neg_hi:[0,1]
  v_pk_add_f32 v[110:111], v[110:111], v[206:207] neg_lo:[0,1] neg_hi:[0,1]
  v_cvt_pk_bf16_f32 v108, 0, v108
  v_cvt_pk_bf16_f32 v109, 0, v109
  v_cvt_pk_bf16_f32 v110, 0, v110
  v_cvt_pk_bf16_f32 v111, 0, v111
  v_pk_mul_f32 v[108:109], v[108:109], v[192:193]
  v_pk_mul_f32 v[110:111], v[110:111], v[194:195]
  v_cvt_pk_bf16_f32 v216, v108, v109
  v_cvt_pk_bf16_f32 v217, v110, v111
  s_waitcnt vmcnt(14)
  buffer_load_dwordx4 v[4:7], v94, s[8:11], s60 offen offset:1024 nt
  v_cvt_f32_i32 v108, v32
  v_cvt_f32_i32 v109, v33
  v_cvt_f32_i32 v110, v34
  v_cvt_f32_i32 v111, v35
  v_pk_add_f32 v[108:109], v[108:109], v[208:209] neg_lo:[0,1] neg_hi:[0,1]
  v_pk_add_f32 v[110:111], v[110:111], v[210:211] neg_lo:[0,1] neg_hi:[0,1]
  v_mov_b32_dpp v144, v224 quad_perm:[0,0,0,0] row_mask:0xf bank_mask:0xf
  v_mov_b32_dpp v145, v226 quad_perm:[2,2,2,2] row_mask:0xf bank_mask:0xf
  v_cvt_pk_bf16_f32 v108, 0, v108
  v_cvt_pk_bf16_f32 v109, 0, v109
  v_add_f32_dpp v144, v225, v144 quad_perm:[1,1,1,1] row_mask:0xf bank_mask:0xf
  v_add_f32_dpp v145, v227, v145 quad_perm:[3,3,3,3] row_mask:0xf bank_mask:0xf
  v_cvt_pk_bf16_f32 v110, 0, v110
  v_cvt_pk_bf16_f32 v111, 0, v111
  v_add_f32 v229, v144, v145
  v_pk_mul_f32 v[108:109], v[108:109], v[196:197]
  v_pk_mul_f32 v[110:111], v[110:111], v[198:199]
  v_cvt_pk_bf16_f32 v218, v108, v109
  v_cvt_pk_bf16_f32 v219, v110, v111
  s_waitcnt vmcnt(14)
  buffer_load_dwordx4 v[8:11], v94, s[8:11], s60 offen offset:1280 nt
  v_mfma_f32_16x16x32_bf16 v[224:227], v[216:219], v[168:171], 0
  v_cvt_f32_i32 v108, v36
  v_cvt_f32_i32 v109, v37
  v_cvt_f32_i32 v110, v38
  v_cvt_f32_i32 v111, v39
  v_pk_add_f32 v[108:109], v[108:109], v[212:213] neg_lo:[0,1] neg_hi:[0,1]
  v_pk_add_f32 v[110:111], v[110:111], v[214:215] neg_lo:[0,1] neg_hi:[0,1]
  v_cvt_pk_bf16_f32 v108, 0, v108
  v_cvt_pk_bf16_f32 v228, 0, v228
  v_cvt_pk_bf16_f32 v109, 0, v109
  v_cvt_pk_bf16_f32 v229, 0, v229
  v_cvt_pk_bf16_f32 v110, 0, v110
  v_pk_mul_f32 v[228:229], v[228:229], s[68:69]
  v_cvt_pk_bf16_f32 v111, 0, v111
  v_cvt_pk_bf16_f32 v120, v228, v229
  v_pk_mul_f32 v[108:109], v[108:109], v[200:201]
  v_pk_mul_f32 v[110:111], v[110:111], v[202:203]
  v_cvt_pk_bf16_f32 v220, v108, v109
  v_cvt_pk_bf16_f32 v221, v110, v111
  s_waitcnt vmcnt(14)
  s_cbranch_vccnz L_kw0_9
  s_waitcnt vmcnt(9)
L_kw0_9:
  buffer_load_dwordx4 v[12:15], v94, s[8:11], s60 offen offset:1536 nt
  v_mfma_f32_16x16x16_bf16 v[224:227], v[220:221], v[172:173], v[224:227]
  v_cvt_f32_i32 v108, v40
  v_cvt_f32_i32 v109, v41
  v_cvt_f32_i32 v110, v42
  v_cvt_f32_i32 v111, v43
  v_pk_add_f32 v[108:109], v[108:109], v[204:205] neg_lo:[0,1] neg_hi:[0,1]
  v_pk_add_f32 v[110:111], v[110:111], v[206:207] neg_lo:[0,1] neg_hi:[0,1]
  v_cvt_pk_bf16_f32 v108, 0, v108
  v_cvt_pk_bf16_f32 v109, 0, v109
  v_cvt_pk_bf16_f32 v110, 0, v110
  v_cvt_pk_bf16_f32 v111, 0, v111
  v_pk_mul_f32 v[108:109], v[108:109], v[192:193]
  v_pk_mul_f32 v[110:111], v[110:111], v[194:195]
  v_cvt_pk_bf16_f32 v216, v108, v109
  v_cvt_pk_bf16_f32 v217, v110, v111
  s_waitcnt vmcnt(14)
  buffer_load_dwordx4 v[16:19], v94, s[8:11], s60 offen offset:1792 nt
  v_cvt_f32_i32 v108, v44
  v_cvt_f32_i32 v109, v45
  v_cvt_f32_i32 v110, v46
  v_cvt_f32_i32 v111, v47
  v_pk_add_f32 v[108:109], v[108:109], v[208:209] neg_lo:[0,1] neg_hi:[0,1]
  v_pk_add_f32 v[110:111], v[110:111], v[210:211] neg_lo:[0,1] neg_hi:[0,1]
  v_mov_b32_dpp v144, v224 quad_perm:[0,0,0,0] row_mask:0xf bank_mask:0xf
  v_mov_b32_dpp v145, v226 quad_perm:[2,2,2,2] row_mask:0xf bank_mask:0xf
  v_cvt_pk_bf16_f32 v108, 0, v108
  v_cvt_pk_bf16_f32 v109, 0, v109
  v_add_f32_dpp v144, v225, v144 quad_perm:[1,1,1,1] row_mask:0xf bank_mask:0xf
  v_add_f32_dpp v145, v227, v145 quad_perm:[3,3,3,3] row_mask:0xf bank_mask:0xf
  v_cvt_pk_bf16_f32 v110, 0, v110
  v_cvt_pk_bf16_f32 v111, 0, v111
  v_add_f32 v228, v144, v145
  v_pk_mul_f32 v[108:109], v[108:109], v[196:197]
  v_pk_mul_f32 v[110:111], v[110:111], v[198:199]
  v_cvt_pk_bf16_f32 v218, v108, v109
  v_cvt_pk_bf16_f32 v219, v110, v111
  s_waitcnt vmcnt(14)
  buffer_load_dwordx4 v[20:23], v94, s[8:11], s60 offen offset:2048 nt
  v_mfma_f32_16x16x32_bf16 v[224:227], v[216:219], v[168:171], 0
  v_cvt_f32_i32 v108, v48
  v_cvt_f32_i32 v109, v49
  v_cvt_f32_i32 v110, v50
  v_cvt_f32_i32 v111, v51
  v_pk_add_f32 v[108:109], v[108:109], v[212:213] neg_lo:[0,1] neg_hi:[0,1]
  v_pk_add_f32 v[110:111], v[110:111], v[214:215] neg_lo:[0,1] neg_hi:[0,1]
  v_cvt_pk_bf16_f32 v108, 0, v108
  v_cvt_pk_bf16_f32 v109, 0, v109
  v_cvt_pk_bf16_f32 v110, 0, v110
  v_cvt_pk_bf16_f32 v111, 0, v111
  v_pk_mul_f32 v[108:109], v[108:109], v[200:201]
  v_pk_mul_f32 v[110:111], v[110:111], v[202:203]
  v_cvt_pk_bf16_f32 v220, v108, v109
  v_cvt_pk_bf16_f32 v221, v110, v111
  s_waitcnt vmcnt(14)
  s_cbranch_vccnz L_kw0_12
  s_waitcnt vmcnt(9)
L_kw0_12:
  buffer_load_dwordx4 v[24:27], v94, s[8:11], s60 offen offset:2304 nt
  v_mfma_f32_16x16x16_bf16 v[224:227], v[220:221], v[172:173], v[224:227]
  v_cvt_f32_i32 v108, v52
  v_cvt_f32_i32 v109, v53
  v_cvt_f32_i32 v110, v54
  v_cvt_f32_i32 v111, v55
  v_pk_add_f32 v[108:109], v[108:109], v[204:205] neg_lo:[0,1] neg_hi:[0,1]
  v_pk_add_f32 v[110:111], v[110:111], v[206:207] neg_lo:[0,1] neg_hi:[0,1]
  v_cvt_pk_bf16_f32 v108, 0, v108
  v_cvt_pk_bf16_f32 v109, 0, v109
  v_cvt_pk_bf16_f32 v110, 0, v110
  v_cvt_pk_bf16_f32 v111, 0, v111
  v_pk_mul_f32 v[108:109], v[108:109], v[192:193]
  v_pk_mul_f32 v[110:111], v[110:111], v[194:195]
  v_cvt_pk_bf16_f32 v216, v108, v109
  v_cvt_pk_bf16_f32 v217, v110, v111
  s_waitcnt vmcnt(14)
  buffer_load_dwordx4 v[28:31], v94, s[8:11], s60 offen offset:2560 nt
  v_cvt_f32_i32 v108, v56
  v_cvt_f32_i32 v109, v57
  v_cvt_f32_i32 v110, v58
  v_cvt_f32_i32 v111, v59
  v_pk_add_f32 v[108:109], v[108:109], v[208:209] neg_lo:[0,1] neg_hi:[0,1]
  v_pk_add_f32 v[110:111], v[110:111], v[210:211] neg_lo:[0,1] neg_hi:[0,1]
  v_mov_b32_dpp v144, v224 quad_perm:[0,0,0,0] row_mask:0xf bank_mask:0xf
  v_mov_b32_dpp v145, v226 quad_perm:[2,2,2,2] row_mask:0xf bank_mask:0xf
  v_cvt_pk_bf16_f32 v108, 0, v108
  v_cvt_pk_bf16_f32 v109, 0, v109
  v_add_f32_dpp v144, v225, v144 quad_perm:[1,1,1,1] row_mask:0xf bank_mask:0xf
  v_add_f32_dpp v145, v227, v145 quad_perm:[3,3,3,3] row_mask:0xf bank_mask:0xf
  v_cvt_pk_bf16_f32 v110, 0, v110
  v_cvt_pk_bf16_f32 v111, 0, v111
  v_add_f32 v229, v144, v145
  v_pk_mul_f32 v[108:109], v[108:109], v[196:197]
  v_pk_mul_f32 v[110:111], v[110:111], v[198:199]
  v_cvt_pk_bf16_f32 v218, v108, v109
  v_cvt_pk_bf16_f32 v219, v110, v111
  s_waitcnt vmcnt(14)
  buffer_load_dwordx4 v[32:35], v94, s[8:11], s60 offen offset:2816 nt
  v_mfma_f32_16x16x32_bf16 v[224:227], v[216:219], v[168:171], 0
  v_cvt_f32_i32 v108, v60
  v_cvt_f32_i32 v109, v61
  v_cvt_f32_i32 v110, v62
  v_cvt_f32_i32 v111, v63
  v_pk_add_f32 v[108:109], v[108:109], v[212:213] neg_lo:[0,1] neg_hi:[0,1]
  v_pk_add_f32 v[110:111], v[110:111], v[214:215] neg_lo:[0,1] neg_hi:[0,1]
  v_cvt_pk_bf16_f32 v108, 0, v108
  v_cvt_pk_bf16_f32 v228, 0, v228
  v_cvt_pk_bf16_f32 v109, 0, v109
  v_cvt_pk_bf16_f32 v229, 0, v229
  v_cvt_pk_bf16_f32 v110, 0, v110
  v_pk_mul_f32 v[228:229], v[228:229], s[68:69]
  v_cvt_pk_bf16_f32 v111, 0, v111
  v_cvt_pk_bf16_f32 v121, v228, v229
  v_pk_mul_f32 v[108:109], v[108:109], v[200:201]
  v_pk_mul_f32 v[110:111], v[110:111], v[202:203]
  v_cvt_pk_bf16_f32 v220, v108, v109
  v_cvt_pk_bf16_f32 v221, v110, v111
  s_waitcnt vmcnt(14)
  s_cbranch_vccnz L_kw0_15
  s_waitcnt vmcnt(9)
L_kw0_15:
  buffer_load_dwordx4 v[36:39], v95, s[8:11], s60 offen offset:0 nt
  v_mfma_f32_16x16x16_bf16 v[224:227], v[220:221], v[172:173], v[224:227]
  v_cvt_f32_i32 v108, v64
  v_cvt_f32_i32 v109, v65
  v_cvt_f32_i32 v110, v66
  v_cvt_f32_i32 v111, v67
  v_pk_add_f32 v[108:109], v[108:109], v[204:205] neg_lo:[0,1] neg_hi:[0,1]
  v_pk_add_f32 v[110:111], v[110:111], v[206:207] neg_lo:[0,1] neg_hi:[0,1]
  v_cvt_pk_bf16_f32 v108, 0, v108
  v_cvt_pk_bf16_f32 v109, 0, v109
  v_cvt_pk_bf16_f32 v110, 0, v110
  v_cvt_pk_bf16_f32 v111, 0, v111
  v_pk_mul_f32 v[108:109], v[108:109], v[192:193]
  v_pk_mul_f32 v[110:111], v[110:111], v[194:195]
  v_cvt_pk_bf16_f32 v216, v108, v109
  v_cvt_pk_bf16_f32 v217, v110, v111
  s_waitcnt vmcnt(14)
  buffer_load_dwordx4 v[40:43], v95, s[8:11], s60 offen offset:256 nt
  v_cvt_f32_i32 v108, v68
  v_cvt_f32_i32 v109, v69
  v_cvt_f32_i32 v110, v70
  v_cvt_f32_i32 v111, v71
  v_pk_add_f32 v[108:109], v[108:109], v[208:209] neg_lo:[0,1] neg_hi:[0,1]
  v_pk_add_f32 v[110:111], v[110:111], v[210:211] neg_lo:[0,1] neg_hi:[0,1]
  v_mov_b32_dpp v144, v224 quad_perm:[0,0,0,0] row_mask:0xf bank_mask:0xf
  v_mov_b32_dpp v145, v226 quad_perm:[2,2,2,2] row_mask:0xf bank_mask:0xf
  v_cvt_pk_bf16_f32 v108, 0, v108
  v_cvt_pk_bf16_f32 v109, 0, v109
  v_add_f32_dpp v144, v225, v144 quad_perm:[1,1,1,1] row_mask:0xf bank_mask:0xf
  v_add_f32_dpp v145, v227, v145 quad_perm:[3,3,3,3] row_mask:0xf bank_mask:0xf
  v_cvt_pk_bf16_f32 v110, 0, v110
  v_cvt_pk_bf16_f32 v111, 0, v111
  v_add_f32 v228, v144, v145
  v_pk_mul_f32 v[108:109], v[108:109], v[196:197]
  v_pk_mul_f32 v[110:111], v[110:111], v[198:199]
  v_cvt_pk_bf16_f32 v218, v108, v109
  v_cvt_pk_bf16_f32 v219, v110, v111
  s_waitcnt vmcnt(14)
  buffer_load_dwordx4 v[44:47], v95, s[8:11], s60 offen offset:512 nt
  v_mfma_f32_16x16x32_bf16 v[224:227], v[216:219], v[168:171], 0
  v_cvt_f32_i32 v108, v72
  v_cvt_f32_i32 v109, v73
  v_cvt_f32_i32 v110, v74
  v_cvt_f32_i32 v111, v75
  v_pk_add_f32 v[108:109], v[108:109], v[212:213] neg_lo:[0,1] neg_hi:[0,1]
  v_pk_add_f32 v[110:111], v[110:111], v[214:215] neg_lo:[0,1] neg_hi:[0,1]
  s_cmp_lt_u32 s64, s99
  s_cbranch_scc1 L_k_known0
L_k_spin0:
  v_mov_b32 v144, 61696
  ds_read_b32 v144, v144
  s_waitcnt lgkmcnt(0)
  v_readfirstlane_b32 s96, v144
  s_nop 1
  s_cmp_eq_u32 s96, 0
  s_cbranch_scc1 L_k_spin0
  s_mov_b32 s99, -1
L_k_known0:
  s_lshr_b32 s71, s64, 4
  s_andn2_b32 s71, s71, 1
  s_lshr_b32 s71, 0x12, s71
  s_and_b32 s71, s71, 3
  s_lshr_b32 s85, s96, s71
  s_andn2_b32 s70, s64, 1
  s_or_b32 s70, s70, s4
  s_cmp_lt_u32 s64, 8
  s_cselect_b32 s70, s70, s64
  s_cselect_b32 s85, s64, s85
  s_and_b32 s85, s85, 1
  s_and_b32 s70, s70, 31
  s_lshl_b32 s71, s71, 12
  s_add_u32 s70, s70, s5
  s_add_u32 s70, s70, s71
  s_mul_hi_u32 s84, s70, s90
  s_lshr_b32 s84, s84, 1
  s_mul_i32 s71, s84, 3
  s_sub_u32 s70, s70, s71
  s_lshl3_add_u32 s85, s70, s85
  s_mul_i32 s61, s84, 196608
  s_lshr_b32 s89, s84, 4
  s_lshl_b32 s70, s85, 5
  v_add_u32 v97, s70, v230
  v_mul_u32_u24 v97, 21846, v97
  v_lshrrev_b32 v97, 16, v97
  v_add_u32 v144, s85, v231
  v_lshrrev_b32 v145, v144, s91
  v_and_b32 v145, 1, v145
  v_cmp_eq_u32 s[54:55], 1, v145
  s_nop 1
  s_and_b64 s[52:53], s[54:55], s[56:57]
  s_andn2_b64 s[54:55], s[54:55], s[56:57]
  v_mul_u32_u24 v144, 43, v144
  v_lshrrev_b32 v144, 8, v144
  v_mul_u32_u24 v144, 384, v144
  v_add_u32 v234, v144, v233
  s_cmp_eq_u32 s89, s88
  s_cbranch_scc1 L_k_sameq0
  s_mul_i32 s70, s89, 1536
  buffer_load_dwordx2 v[174:175], v235, s[36:39], s70 offen offset:0
  buffer_load_dwordx2 v[176:177], v235, s[36:39], s70 offen offset:128
  buffer_load_dwordx2 v[178:179], v235, s[36:39], s70 offen offset:256
  s_mov_b32 s88, s89
L_k_sameq0:
  s_mul_i32 s62, s84, 1536
  buffer_load_dwordx2 v[180:181], v234, s[20:23], s62 offen offset:0
  buffer_load_dwordx2 v[186:187], v234, s[24:27], s62 offen offset:0
  buffer_load_dwordx2 v[182:183], v234, s[20:23], s62 offen offset:128
  buffer_load_dwordx2 v[188:189], v234, s[24:27], s62 offen offset:128
  buffer_load_dwordx2 v[184:185], v234, s[20:23], s62 offen offset:256
  buffer_load_dwordx2 v[190:191], v234, s[24:27], s62 offen offset:256
  v_cvt_pk_bf16_f32 v108, 0, v108
  v_cvt_pk_bf16_f32 v109, 0, v109
  v_cvt_pk_bf16_f32 v110, 0, v110
  v_cvt_pk_bf16_f32 v111, 0, v111
  v_pk_mul_f32 v[108:109], v[108:109], v[200:201]
  v_pk_mul_f32 v[110:111], v[110:111], v[202:203]
  v_cvt_pk_bf16_f32 v220, v108, v109
  v_cvt_pk_bf16_f32 v221, v110, v111
  v_mad_u32_u24 v92, v97, s63, v232
  v_add_u32 v93, 768, v92
  v_add_u32 v94, 4608, v92
  v_add_u32 v95, 7680, v92
  v_cndmask_b32 v92, v92, v105, s[52:53]
  v_cndmask_b32 v95, v95, v105, s[54:55]
  s_waitcnt vmcnt(20)
  s_cbranch_vccnz L_kw0_18
  s_waitcnt vmcnt(15)
L_kw0_18:
  buffer_load_dwordx4 v[48:51], v92, s[16:19], s61 offen offset:0 nt
  v_mfma_f32_16x16x16_bf16 v[224:227], v[220:221], v[172:173], v[224:227]
  v_cvt_f32_i32 v108, v76
  v_cvt_f32_i32 v109, v77
  v_cvt_f32_i32 v110, v78
  v_cvt_f32_i32 v111, v79
  v_pk_add_f32 v[108:109], v[108:109], v[204:205] neg_lo:[0,1] neg_hi:[0,1]
  v_pk_add_f32 v[110:111], v[110:111], v[206:207] neg_lo:[0,1] neg_hi:[0,1]
  v_cvt_pk_bf16_f32 v108, 0, v108
  v_cvt_pk_bf16_f32 v109, 0, v109
  v_cvt_pk_bf16_f32 v110, 0, v110
  v_cvt_pk_bf16_f32 v111, 0, v111
  v_pk_mul_f32 v[108:109], v[108:109], v[192:193]
  v_pk_mul_f32 v[110:111], v[110:111], v[194:195]
  v_cvt_pk_bf16_f32 v216, v108, v109
  v_cvt_pk_bf16_f32 v217, v110, v111
  s_waitcnt vmcnt(20)
  buffer_load_dwordx4 v[52:55], v92, s[16:19], s61 offen offset:256 nt
  v_cvt_f32_i32 v108, v80
  v_cvt_f32_i32 v109, v81
  v_cvt_f32_i32 v110, v82
  v_cvt_f32_i32 v111, v83
  v_pk_add_f32 v[108:109], v[108:109], v[208:209] neg_lo:[0,1] neg_hi:[0,1]
  v_pk_add_f32 v[110:111], v[110:111], v[210:211] neg_lo:[0,1] neg_hi:[0,1]
  v_mov_b32_dpp v144, v224 quad_perm:[0,0,0,0] row_mask:0xf bank_mask:0xf
  v_mov_b32_dpp v145, v226 quad_perm:[2,2,2,2] row_mask:0xf bank_mask:0xf
  v_cvt_pk_bf16_f32 v108, 0, v108
  v_cvt_pk_bf16_f32 v109, 0, v109
  v_add_f32_dpp v144, v225, v144 quad_perm:[1,1,1,1] row_mask:0xf bank_mask:0xf
  v_add_f32_dpp v145, v227, v145 quad_perm:[3,3,3,3] row_mask:0xf bank_mask:0xf
  v_cvt_pk_bf16_f32 v110, 0, v110
  v_cvt_pk_bf16_f32 v111, 0, v111
  v_add_f32 v229, v144, v145
  v_pk_mul_f32 v[108:109], v[108:109], v[196:197]
  v_pk_mul_f32 v[110:111], v[110:111], v[198:199]
  v_cvt_pk_bf16_f32 v218, v108, v109
  v_cvt_pk_bf16_f32 v219, v110, v111
  s_waitcnt vmcnt(20)
  buffer_load_dwordx4 v[56:59], v92, s[16:19], s61 offen offset:512 nt
  v_mfma_f32_16x16x32_bf16 v[224:227], v[216:219], v[168:171], 0
  v_cvt_f32_i32 v108, v84
  v_cvt_f32_i32 v109, v85
  v_cvt_f32_i32 v110, v86
  v_cvt_f32_i32 v111, v87
  v_pk_add_f32 v[108:109], v[108:109], v[212:213] neg_lo:[0,1] neg_hi:[0,1]
  v_pk_add_f32 v[110:111], v[110:111], v[214:215] neg_lo:[0,1] neg_hi:[0,1]
  v_cvt_pk_bf16_f32 v108, 0, v108
  v_cvt_pk_bf16_f32 v228, 0, v228
  v_cvt_pk_bf16_f32 v109, 0, v109
  v_cvt_pk_bf16_f32 v229, 0, v229
  v_cvt_pk_bf16_f32 v110, 0, v110
  v_pk_mul_f32 v[228:229], v[228:229], s[68:69]
  v_cvt_pk_bf16_f32 v111, 0, v111
  v_cvt_pk_bf16_f32 v122, v228, v229
  v_pk_mul_f32 v[108:109], v[108:109], v[200:201]
  v_pk_mul_f32 v[110:111], v[110:111], v[202:203]
  v_cvt_pk_bf16_f32 v220, v108, v109
  v_cvt_pk_bf16_f32 v221, v110, v111
  s_waitcnt vmcnt(20)
  s_cbranch_vccnz L_kw0_21
  s_waitcnt vmcnt(15)
L_kw0_21:
  buffer_load_dwordx4 v[60:63], v93, s[16:19], s61 offen offset:0 nt
  v_mfma_f32_16x16x16_bf16 v[224:227], v[220:221], v[172:173], v[224:227]
  v_cvt_f32_i32 v108, v88
  v_cvt_f32_i32 v109, v89
  v_cvt_f32_i32 v110, v90
  v_cvt_f32_i32 v111, v91
  v_pk_add_f32 v[108:109], v[108:109], v[204:205] neg_lo:[0,1] neg_hi:[0,1]
  v_pk_add_f32 v[110:111], v[110:111], v[206:207] neg_lo:[0,1] neg_hi:[0,1]
  v_cvt_pk_bf16_f32 v108, 0, v108
  v_cvt_pk_bf16_f32 v109, 0, v109
  v_cvt_pk_bf16_f32 v110, 0, v110
  v_cvt_pk_bf16_f32 v111, 0, v111
  v_pk_mul_f32 v[108:109], v[108:109], v[192:193]
  v_pk_mul_f32 v[110:111], v[110:111], v[194:195]
  v_cvt_pk_bf16_f32 v216, v108, v109
  v_cvt_pk_bf16_f32 v217, v110, v111
  s_waitcnt vmcnt(20)
  buffer_load_dwordx4 v[64:67], v93, s[16:19], s61 offen offset:256 nt
  v_cvt_f32_i32 v108, v4
  v_cvt_f32_i32 v109, v5
  v_cvt_f32_i32 v110, v6
  v_cvt_f32_i32 v111, v7
  v_pk_add_f32 v[108:109], v[108:109], v[208:209] neg_lo:[0,1] neg_hi:[0,1]
  v_pk_add_f32 v[110:111], v[110:111], v[210:211] neg_lo:[0,1] neg_hi:[0,1]
  v_mov_b32_dpp v144, v224 quad_perm:[0,0,0,0] row_mask:0xf bank_mask:0xf
  v_mov_b32_dpp v145, v226 quad_perm:[2,2,2,2] row_mask:0xf bank_mask:0xf
  v_cvt_pk_bf16_f32 v108, 0, v108
  v_cvt_pk_bf16_f32 v109, 0, v109
  v_add_f32_dpp v144, v225, v144 quad_perm:[1,1,1,1] row_mask:0xf bank_mask:0xf
  v_add_f32_dpp v145, v227, v145 quad_perm:[3,3,3,3] row_mask:0xf bank_mask:0xf
  v_cvt_pk_bf16_f32 v110, 0, v110
  v_cvt_pk_bf16_f32 v111, 0, v111
  v_add_f32 v228, v144, v145
  v_pk_mul_f32 v[108:109], v[108:109], v[196:197]
  v_pk_mul_f32 v[110:111], v[110:111], v[198:199]
  v_cvt_pk_bf16_f32 v218, v108, v109
  v_cvt_pk_bf16_f32 v219, v110, v111
  s_waitcnt vmcnt(20)
  buffer_load_dwordx4 v[68:71], v93, s[16:19], s61 offen offset:512 nt
  v_mfma_f32_16x16x32_bf16 v[224:227], v[216:219], v[168:171], 0
  v_cvt_f32_i32 v108, v8
  v_cvt_f32_i32 v109, v9
  v_cvt_f32_i32 v110, v10
  v_cvt_f32_i32 v111, v11
  v_pk_add_f32 v[108:109], v[108:109], v[212:213] neg_lo:[0,1] neg_hi:[0,1]
  v_pk_add_f32 v[110:111], v[110:111], v[214:215] neg_lo:[0,1] neg_hi:[0,1]
  v_cvt_pk_bf16_f32 v108, 0, v108
  v_cvt_pk_bf16_f32 v109, 0, v109
  v_cvt_pk_bf16_f32 v110, 0, v110
  v_cvt_pk_bf16_f32 v111, 0, v111
  v_pk_mul_f32 v[108:109], v[108:109], v[200:201]
  v_pk_mul_f32 v[110:111], v[110:111], v[202:203]
  v_cvt_pk_bf16_f32 v220, v108, v109
  v_cvt_pk_bf16_f32 v221, v110, v111
  s_waitcnt vmcnt(20)
  s_cbranch_vccnz L_kw0_24
  s_waitcnt vmcnt(15)
L_kw0_24:
  buffer_load_dwordx4 v[72:75], v93, s[16:19], s61 offen offset:768 nt
  v_mfma_f32_16x16x16_bf16 v[224:227], v[220:221], v[172:173], v[224:227]
  v_cvt_f32_i32 v108, v12
  v_cvt_f32_i32 v109, v13
  v_cvt_f32_i32 v110, v14
  v_cvt_f32_i32 v111, v15
  v_pk_add_f32 v[108:109], v[108:109], v[204:205] neg_lo:[0,1] neg_hi:[0,1]
  v_pk_add_f32 v[110:111], v[110:111], v[206:207] neg_lo:[0,1] neg_hi:[0,1]
  v_cvt_pk_bf16_f32 v108, 0, v108
  v_cvt_pk_bf16_f32 v109, 0, v109
  v_cvt_pk_bf16_f32 v110, 0, v110
  v_cvt_pk_bf16_f32 v111, 0, v111
  v_pk_mul_f32 v[108:109], v[108:109], v[192:193]
  v_pk_mul_f32 v[110:111], v[110:111], v[194:195]
  v_cvt_pk_bf16_f32 v216, v108, v109
  v_cvt_pk_bf16_f32 v217, v110, v111
  s_waitcnt vmcnt(20)
  buffer_load_dwordx4 v[76:79], v93, s[16:19], s61 offen offset:1024 nt
  v_cvt_f32_i32 v108, v16
  v_cvt_f32_i32 v109, v17
  v_cvt_f32_i32 v110, v18
  v_cvt_f32_i32 v111, v19
  v_pk_add_f32 v[108:109], v[108:109], v[208:209] neg_lo:[0,1] neg_hi:[0,1]
  v_pk_add_f32 v[110:111], v[110:111], v[210:211] neg_lo:[0,1] neg_hi:[0,1]
  v_mov_b32_dpp v144, v224 quad_perm:[0,0,0,0] row_mask:0xf bank_mask:0xf
  v_mov_b32_dpp v145, v226 quad_perm:[2,2,2,2] row_mask:0xf bank_mask:0xf
  v_cvt_pk_bf16_f32 v108, 0, v108
  v_cvt_pk_bf16_f32 v109, 0, v109
  v_add_f32_dpp v144, v225, v144 quad_perm:[1,1,1,1] row_mask:0xf bank_mask:0xf
  v_add_f32_dpp v145, v227, v145 quad_perm:[3,3,3,3] row_mask:0xf bank_mask:0xf
  v_cvt_pk_bf16_f32 v110, 0, v110
  v_cvt_pk_bf16_f32 v111, 0, v111
  v_add_f32 v229, v144, v145
  v_pk_mul_f32 v[108:109], v[108:109], v[196:197]
  v_pk_mul_f32 v[110:111], v[110:111], v[198:199]
  v_cvt_pk_bf16_f32 v218, v108, v109
  v_cvt_pk_bf16_f32 v219, v110, v111
  s_waitcnt vmcnt(20)
  buffer_load_dwordx4 v[80:83], v93, s[16:19], s61 offen offset:1280 nt
  v_mfma_f32_16x16x32_bf16 v[224:227], v[216:219], v[168:171], 0
  v_cvt_f32_i32 v108, v20
  v_cvt_f32_i32 v109, v21
  v_cvt_f32_i32 v110, v22
  v_cvt_f32_i32 v111, v23
  v_pk_add_f32 v[108:109], v[108:109], v[212:213] neg_lo:[0,1] neg_hi:[0,1]
  v_pk_add_f32 v[110:111], v[110:111], v[214:215] neg_lo:[0,1] neg_hi:[0,1]
  v_cvt_pk_bf16_f32 v108, 0, v108
  v_cvt_pk_bf16_f32 v228, 0, v228
  v_cvt_pk_bf16_f32 v109, 0, v109
  v_cvt_pk_bf16_f32 v229, 0, v229
  v_cvt_pk_bf16_f32 v110, 0, v110
  v_pk_mul_f32 v[228:229], v[228:229], s[68:69]
  v_cvt_pk_bf16_f32 v111, 0, v111
  v_cvt_pk_bf16_f32 v123, v228, v229
  v_pk_mul_f32 v[108:109], v[108:109], v[200:201]
  v_pk_mul_f32 v[110:111], v[110:111], v[202:203]
  v_cvt_pk_bf16_f32 v220, v108, v109
  v_cvt_pk_bf16_f32 v221, v110, v111
  s_waitcnt vmcnt(20)
  s_cbranch_vccnz L_kw0_27
  s_waitcnt vmcnt(15)
L_kw0_27:
  buffer_load_dwordx4 v[84:87], v93, s[16:19], s61 offen offset:1536 nt
  v_mfma_f32_16x16x16_bf16 v[224:227], v[220:221], v[172:173], v[224:227]
  v_cvt_f32_i32 v108, v24
  v_cvt_f32_i32 v109, v25
  v_cvt_f32_i32 v110, v26
  v_cvt_f32_i32 v111, v27
  v_pk_add_f32 v[108:109], v[108:109], v[204:205] neg_lo:[0,1] neg_hi:[0,1]
  v_pk_add_f32 v[110:111], v[110:111], v[206:207] neg_lo:[0,1] neg_hi:[0,1]
  v_cvt_pk_bf16_f32 v108, 0, v108
  v_cvt_pk_bf16_f32 v109, 0, v109
  v_cvt_pk_bf16_f32 v110, 0, v110
  v_cvt_pk_bf16_f32 v111, 0, v111
  v_pk_mul_f32 v[108:109], v[108:109], v[192:193]
  v_pk_mul_f32 v[110:111], v[110:111], v[194:195]
  v_cvt_pk_bf16_f32 v216, v108, v109
  v_cvt_pk_bf16_f32 v217, v110, v111
  s_waitcnt vmcnt(20)
  buffer_load_dwordx4 v[88:91], v93, s[16:19], s61 offen offset:1792 nt
  v_cvt_f32_i32 v108, v28
  v_cvt_f32_i32 v109, v29
  v_cvt_f32_i32 v110, v30
  v_cvt_f32_i32 v111, v31
  v_pk_add_f32 v[108:109], v[108:109], v[208:209] neg_lo:[0,1] neg_hi:[0,1]
  v_pk_add_f32 v[110:111], v[110:111], v[210:211] neg_lo:[0,1] neg_hi:[0,1]
  v_mov_b32_dpp v144, v224 quad_perm:[0,0,0,0] row_mask:0xf bank_mask:0xf
  v_mov_b32_dpp v145, v226 quad_perm:[2,2,2,2] row_mask:0xf bank_mask:0xf
  v_cvt_pk_bf16_f32 v108, 0, v108
  v_cvt_pk_bf16_f32 v109, 0, v109
  v_add_f32_dpp v144, v225, v144 quad_perm:[1,1,1,1] row_mask:0xf bank_mask:0xf
  v_add_f32_dpp v145, v227, v145 quad_perm:[3,3,3,3] row_mask:0xf bank_mask:0xf
  v_cvt_pk_bf16_f32 v110, 0, v110
  v_cvt_pk_bf16_f32 v111, 0, v111
  v_add_f32 v228, v144, v145
  v_pk_mul_f32 v[108:109], v[108:109], v[196:197]
  v_pk_mul_f32 v[110:111], v[110:111], v[198:199]
  v_cvt_pk_bf16_f32 v218, v108, v109
  v_cvt_pk_bf16_f32 v219, v110, v111
  s_waitcnt vmcnt(20)
  buffer_load_dwordx4 v[4:7], v93, s[16:19], s61 offen offset:2048 nt
  v_mfma_f32_16x16x32_bf16 v[224:227], v[216:219], v[168:171], 0
  v_cvt_f32_i32 v108, v32
  v_cvt_f32_i32 v109, v33
  v_cvt_f32_i32 v110, v34
  v_cvt_f32_i32 v111, v35
  v_pk_add_f32 v[108:109], v[108:109], v[212:213] neg_lo:[0,1] neg_hi:[0,1]
  v_pk_add_f32 v[110:111], v[110:111], v[214:215] neg_lo:[0,1] neg_hi:[0,1]
  v_cvt_pk_bf16_f32 v108, 0, v108
  v_cvt_pk_bf16_f32 v109, 0, v109
  v_cvt_pk_bf16_f32 v110, 0, v110
  v_cvt_pk_bf16_f32 v111, 0, v111
  v_pk_mul_f32 v[108:109], v[108:109], v[200:201]
  v_pk_mul_f32 v[110:111], v[110:111], v[202:203]
  v_cvt_pk_bf16_f32 v220, v108, v109
  v_cvt_pk_bf16_f32 v221, v110, v111
  s_waitcnt vmcnt(20)
  s_cbranch_vccnz L_kw0_30
  s_waitcnt vmcnt(9)
L_kw0_30:
  buffer_load_dwordx4 v[8:11], v93, s[16:19], s61 offen offset:2304 nt
  v_mfma_f32_16x16x16_bf16 v[224:227], v[220:221], v[172:173], v[224:227]
  v_cvt_f32_i32 v108, v36
  v_cvt_f32_i32 v109, v37
  v_cvt_f32_i32 v110, v38
  v_cvt_f32_i32 v111, v39
  v_pk_add_f32 v[108:109], v[108:109], v[204:205] neg_lo:[0,1] neg_hi:[0,1]
  v_pk_add_f32 v[110:111], v[110:111], v[206:207] neg_lo:[0,1] neg_hi:[0,1]
  v_cvt_pk_bf16_f32 v108, 0, v108
  v_cvt_pk_bf16_f32 v109, 0, v109
  v_cvt_pk_bf16_f32 v110, 0, v110
  v_cvt_pk_bf16_f32 v111, 0, v111
  v_pk_mul_f32 v[108:109], v[108:109], v[192:193]
  v_pk_mul_f32 v[110:111], v[110:111], v[194:195]
  v_cvt_pk_bf16_f32 v216, v108, v109
  v_cvt_pk_bf16_f32 v217, v110, v111
  s_waitcnt vmcnt(20)
  buffer_load_dwordx4 v[12:15], v93, s[16:19], s61 offen offset:2560 nt
  v_cvt_f32_i32 v108, v40
  v_cvt_f32_i32 v109, v41
  v_cvt_f32_i32 v110, v42
  v_cvt_f32_i32 v111, v43
  v_pk_add_f32 v[108:109], v[108:109], v[208:209] neg_lo:[0,1] neg_hi:[0,1]
  v_pk_add_f32 v[110:111], v[110:111], v[210:211] neg_lo:[0,1] neg_hi:[0,1]
  v_mov_b32_dpp v144, v224 quad_perm:[0,0,0,0] row_mask:0xf bank_mask:0xf
  v_mov_b32_dpp v145, v226 quad_perm:[2,2,2,2] row_mask:0xf bank_mask:0xf
  v_cvt_pk_bf16_f32 v108, 0, v108
  v_cvt_pk_bf16_f32 v109, 0, v109
  v_add_f32_dpp v144, v225, v144 quad_perm:[1,1,1,1] row_mask:0xf bank_mask:0xf
  v_add_f32_dpp v145, v227, v145 quad_perm:[3,3,3,3] row_mask:0xf bank_mask:0xf
  v_cvt_pk_bf16_f32 v110, 0, v110
  v_cvt_pk_bf16_f32 v111, 0, v111
  v_add_f32 v229, v144, v145
  v_pk_mul_f32 v[108:109], v[108:109], v[196:197]
  v_pk_mul_f32 v[110:111], v[110:111], v[198:199]
  v_cvt_pk_bf16_f32 v218, v108, v109
  v_cvt_pk_bf16_f32 v219, v110, v111
  s_waitcnt vmcnt(20)
  buffer_load_dwordx4 v[16:19], v93, s[16:19], s61 offen offset:2816 nt
  v_mfma_f32_16x16x32_bf16 v[224:227], v[216:219], v[168:171], 0
  v_cvt_f32_i32 v108, v44
  v_cvt_f32_i32 v109, v45
  v_cvt_f32_i32 v110, v46
  v_cvt_f32_i32 v111, v47
  v_pk_add_f32 v[108:109], v[108:109], v[212:213] neg_lo:[0,1] neg_hi:[0,1]
  v_pk_add_f32 v[110:111], v[110:111], v[214:215] neg_lo:[0,1] neg_hi:[0,1]
  v_cvt_pk_bf16_f32 v108, 0, v108
  v_cvt_pk_bf16_f32 v228, 0, v228
  v_cvt_pk_bf16_f32 v109, 0, v109
  v_cvt_pk_bf16_f32 v229, 0, v229
  v_cvt_pk_bf16_f32 v110, 0, v110
  v_pk_mul_f32 v[228:229], v[228:229], s[68:69]
  v_cvt_pk_bf16_f32 v111, 0, v111
  v_cvt_pk_bf16_f32 v124, v228, v229
  v_pk_mul_f32 v[108:109], v[108:109], v[200:201]
  v_pk_mul_f32 v[110:111], v[110:111], v[202:203]
  v_cvt_pk_bf16_f32 v220, v108, v109
  v_cvt_pk_bf16_f32 v221, v110, v111
  s_mov_b32 s60, s61
  v_mov_b32 v146, s64
  v_mfma_f32_16x16x16_bf16 v[224:227], v[220:221], v[172:173], v[224:227]
  ds_write_b128 v99, v[120:123]
  v_add_u32 v99, 768, v99
  s_nop 5
  v_mov_b32_dpp v144, v224 quad_perm:[0,0,0,0] row_mask:0xf bank_mask:0xf
  v_mov_b32_dpp v145, v226 quad_perm:[2,2,2,2] row_mask:0xf bank_mask:0xf
  s_nop 0
  v_add_f32_dpp v144, v225, v144 quad_perm:[1,1,1,1] row_mask:0xf bank_mask:0xf
  v_add_f32_dpp v145, v227, v145 quad_perm:[3,3,3,3] row_mask:0xf bank_mask:0xf
  v_add_f32 v228, v144, v145
  v_cndmask_b32 v228, v228, v236, s[50:51]
  v_cvt_pk_bf16_f32 v228, 0, v228
  v_cvt_pk_bf16_f32 v229, 0, v229
  v_pk_mul_f32 v[228:229], v[228:229], s[68:69]
  v_cvt_pk_bf16_f32 v125, v228, v229
  ds_write_b64 v100, v[124:125] offset:256
  ds_write_b32 v104, v146
  v_add_u32 v100, 768, v100
  v_add_u32 v144, s85, v2
  v_lshrrev_b32 v145, v144, s91
  v_and_b32 v145, 1, v145
  v_cmp_eq_u32 s[50:51], 1, v145
  s_nop 1
  s_and_b64 s[48:49], s[50:51], s[58:59]
  s_andn2_b64 s[50:51], s[50:51], s[58:59]
  s_mov_b32 s97, s64
  s_add_u32 s64, s64, 2
  ds_read_b32 v106, v104 offset:8
  s_waitcnt vmcnt(14)
  s_cbranch_vccnz L_kw1_0
  s_waitcnt vmcnt(9)
L_kw1_0:
  buffer_load_dwordx4 v[20:23], v93, s[8:11], s60 offen offset:3072 nt
  v_lshlrev_b32 v204, 16, v186
  v_and_b32 v205, s65, v186
  v_lshlrev_b32 v206, 16, v187
  v_and_b32 v207, s65, v187
  v_lshlrev_b32 v192, 16, v180
  v_and_b32 v193, s65, v180
  v_lshlrev_b32 v194, 16, v181
  v_and_b32 v195, s65, v181
  v_mov_b32 v168, v174
  v_mov_b32 v169, v175
  v_cvt_f32_i32 v108, v48
  v_cvt_f32_i32 v109, v49
  v_cvt_f32_i32 v110, v50
  v_cvt_f32_i32 v111, v51
  v_pk_add_f32 v[108:109], v[108:109], v[204:205] neg_lo:[0,1] neg_hi:[0,1]
  v_pk_add_f32 v[110:111], v[110:111], v[206:207] neg_lo:[0,1] neg_hi:[0,1]
  v_cvt_pk_bf16_f32 v108, 0, v108
  v_cvt_pk_bf16_f32 v109, 0, v109
  v_cvt_pk_bf16_f32 v110, 0, v110
  v_cvt_pk_bf16_f32 v111, 0, v111
  v_pk_mul_f32 v[108:109], v[108:109], v[192:193]
  v_pk_mul_f32 v[110:111], v[110:111], v[194:195]
  v_cvt_pk_bf16_f32 v216, v108, v109
  v_cvt_pk_bf16_f32 v217, v110, v111
  s_waitcnt lgkmcnt(0)
  v_cmp_lt_u32 vcc, s97, v106
  s_waitcnt vmcnt(14)
  buffer_load_dwordx4 v[24:27], v93, s[8:11], s60 offen offset:3328 nt
  v_lshlrev_b32 v208, 16, v188
  v_and_b32 v209, s65, v188
  v_lshlrev_b32 v210, 16, v189
  v_and_b32 v211, s65, v189
  v_lshlrev_b32 v196, 16, v182
  v_and_b32 v197, s65, v182
  v_lshlrev_b32 v198, 16, v183
  v_and_b32 v199, s65, v183
  v_mov_b32 v170, v176
  v_mov_b32 v171, v177
  v_cvt_f32_i32 v108, v52
  v_cvt_f32_i32 v109, v53
  v_cvt_f32_i32 v110, v54
  v_cvt_f32_i32 v111, v55
  v_pk_add_f32 v[108:109], v[108:109], v[208:209] neg_lo:[0,1] neg_hi:[0,1]
  v_pk_add_f32 v[110:111], v[110:111], v[210:211] neg_lo:[0,1] neg_hi:[0,1]
  v_cvt_pk_bf16_f32 v108, 0, v108
  v_cvt_pk_bf16_f32 v109, 0, v109
  v_cvt_pk_bf16_f32 v110, 0, v110
  v_cvt_pk_bf16_f32 v111, 0, v111
  v_pk_mul_f32 v[108:109], v[108:109], v[196:197]
  v_pk_mul_f32 v[110:111], v[110:111], v[198:199]
  v_cvt_pk_bf16_f32 v218, v108, v109
  v_cvt_pk_bf16_f32 v219, v110, v111
  s_waitcnt vmcnt(14)
  buffer_load_dwordx4 v[28:31], v93, s[8:11], s60 offen offset:3584 nt
  v_mfma_f32_16x16x32_bf16 v[224:227], v[216:219], v[168:171], 0
  v_lshlrev_b32 v212, 16, v190
  v_and_b32 v213, s65, v190
  v_lshlrev_b32 v214, 16, v191
  v_and_b32 v215, s65, v191
  v_lshlrev_b32 v200, 16, v184
  v_and_b32 v201, s65, v184
  v_lshlrev_b32 v202, 16, v185
  v_and_b32 v203, s65, v185
  v_mov_b32 v172, v178
  v_mov_b32 v173, v179
  v_cvt_f32_i32 v108, v56
  v_cvt_f32_i32 v109, v57
  v_cvt_f32_i32 v110, v58
  v_cvt_f32_i32 v111, v59
  v_pk_add_f32 v[108:109], v[108:109], v[212:213] neg_lo:[0,1] neg_hi:[0,1]
  v_pk_add_f32 v[110:111], v[110:111], v[214:215] neg_lo:[0,1] neg_hi:[0,1]
  v_cvt_pk_bf16_f32 v108, 0, v108
  v_cvt_pk_bf16_f32 v109, 0, v109
  v_cvt_pk_bf16_f32 v110, 0, v110
  v_cvt_pk_bf16_f32 v111, 0, v111
  v_pk_mul_f32 v[108:109], v[108:109], v[200:201]
  v_pk_mul_f32 v[110:111], v[110:111], v[202:203]
  v_cvt_pk_bf16_f32 v220, v108, v109
  v_cvt_pk_bf16_f32 v221, v110, v111
  s_waitcnt vmcnt(14)
  s_cbranch_vccnz L_kw1_3
  s_waitcnt vmcnt(9)
L_kw1_3:
  buffer_load_dwordx4 v[32:35], v94, s[8:11], s60 offen offset:0 nt
  v_mfma_f32_16x16x16_bf16 v[224:227], v[220:221], v[172:173], v[224:227]
  v_cvt_f32_i32 v108, v60
  v_cvt_f32_i32 v109, v61
  v_cvt_f32_i32 v110, v62
  v_cvt_f32_i32 v111, v63
  v_pk_add_f32 v[108:109], v[108:109], v[204:205] neg_lo:[0,1] neg_hi:[0,1]
  v_pk_add_f32 v[110:111], v[110:111], v[206:207] neg_lo:[0,1] neg_hi:[0,1]
  v_cvt_pk_bf16_f32 v108, 0, v108
  v_cvt_pk_bf16_f32 v109, 0, v109
  v_cvt_pk_bf16_f32 v110, 0, v110
  v_cvt_pk_bf16_f32 v111, 0, v111
  v_pk_mul_f32 v[108:109], v[108:109], v[192:193]
  v_pk_mul_f32 v[110:111], v[110:111], v[194:195]
  v_cvt_pk_bf16_f32 v216, v108, v109
  v_cvt_pk_bf16_f32 v217, v110, v111
  s_waitcnt vmcnt(14)
  buffer_load_dwordx4 v[36:39], v94, s[8:11], s60 offen offset:256 nt
  v_cvt_f32_i32 v108, v64
  v_cvt_f32_i32 v109, v65
  v_cvt_f32_i32 v110, v66
  v_cvt_f32_i32 v111, v67
  v_pk_add_f32 v[108:109], v[108:109], v[208:209] neg_lo:[0,1] neg_hi:[0,1]
  v_pk_add_f32 v[110:111], v[110:111], v[210:211] neg_lo:[0,1] neg_hi:[0,1]
  v_mov_b32_dpp v144, v224 quad_perm:[0,0,0,0] row_mask:0xf bank_mask:0xf
  v_mov_b32_dpp v145, v226 quad_perm:[2,2,2,2] row_mask:0xf bank_mask:0xf
  v_cvt_pk_bf16_f32 v108, 0, v108
  v_cvt_pk_bf16_f32 v109, 0, v109
  v_add_f32_dpp v144, v225, v144 quad_perm:[1,1,1,1] row_mask:0xf bank_mask:0xf
  v_add_f32_dpp v145, v227, v145 quad_perm:[3,3,3,3] row_mask:0xf bank_mask:0xf
  v_cvt_pk_bf16_f32 v110, 0, v110
  v_cvt_pk_bf16_f32 v111, 0, v111
  v_add_f32 v228, v144, v145
  v_pk_mul_f32 v[108:109], v[108:109], v[196:197]
  v_pk_mul_f32 v[110:111], v[110:111], v[198:199]
  v_cvt_pk_bf16_f32 v218, v108, v109
  v_cvt_pk_bf16_f32 v219, v110, v111
  s_waitcnt vmcnt(14)
  buffer_load_dwordx4 v[40:43], v94, s[8:11], s60 offen offset:512 nt
  v_mfma_f32_16x16x32_bf16 v[224:227], v[216:219], v[168:171], 0
  v_cvt_f32_i32 v108, v68
  v_cvt_f32_i32 v109, v69
  v_cvt_f32_i32 v110, v70
  v_cvt_f32_i32 v111, v71
  v_pk_add_f32 v[108:109], v[108:109], v[212:213] neg_lo:[0,1] neg_hi:[0,1]
  v_pk_add_f32 v[110:111], v[110:111], v[214:215] neg_lo:[0,1] neg_hi:[0,1]
  v_cvt_pk_bf16_f32 v108, 0, v108
  v_cndmask_b32 v228, v228, v236, s[48:49]
  v_cvt_pk_bf16_f32 v109, 0, v109
  v_cvt_pk_bf16_f32 v110, 0, v110
  v_cvt_pk_bf16_f32 v111, 0, v111
  v_pk_mul_f32 v[108:109], v[108:109], v[200:201]
  v_pk_mul_f32 v[110:111], v[110:111], v[202:203]
  v_cvt_pk_bf16_f32 v220, v108, v109
  v_cvt_pk_bf16_f32 v221, v110, v111
  s_waitcnt vmcnt(14)
  s_cbranch_vccnz L_kw1_6
  s_waitcnt vmcnt(9)
L_kw1_6:
  buffer_load_dwordx4 v[44:47], v94, s[8:11], s60 offen offset:768 nt
  v_mfma_f32_16x16x16_bf16 v[224:227], v[220:221], v[172:173], v[224:227]
  v_cvt_f32_i32 v108, v72
  v_cvt_f32_i32 v109, v73
  v_cvt_f32_i32 v110, v74
  v_cvt_f32_i32 v111, v75
  v_pk_add_f32 v[108:109], v[108:109], v[204:205] neg_lo:[0,1] neg_hi:[0,1]
  v_pk_add_f32 v[110:111], v[110:111], v[206:207] neg_lo:[0,1] neg_hi:[0,1]
  v_cvt_pk_bf16_f32 v108, 0, v108
  v_cvt_pk_bf16_f32 v109, 0, v109
  v_cvt_pk_bf16_f32 v110, 0, v110
  v_cvt_pk_bf16_f32 v111, 0, v111
  v_pk_mul_f32 v[108:109], v[108:109], v[192:193]
  v_pk_mul_f32 v[110:111], v[110:111], v[194:195]
  v_cvt_pk_bf16_f32 v216, v108, v109
  v_cvt_pk_bf16_f32 v217, v110, v111
  s_waitcnt vmcnt(14)
  buffer_load_dwordx4 v[48:51], v94, s[8:11], s60 offen offset:1024 nt
  v_cvt_f32_i32 v108, v76
  v_cvt_f32_i32 v109, v77
  v_cvt_f32_i32 v110, v78
  v_cvt_f32_i32 v111, v79
  v_pk_add_f32 v[108:109], v[108:109], v[208:209] neg_lo:[0,1] neg_hi:[0,1]
  v_pk_add_f32 v[110:111], v[110:111], v[210:211] neg_lo:[0,1] neg_hi:[0,1]
  v_mov_b32_dpp v144, v224 quad_perm:[0,0,0,0] row_mask:0xf bank_mask:0xf
  v_mov_b32_dpp v145, v226 quad_perm:[2,2,2,2] row_mask:0xf bank_mask:0xf
  v_cvt_pk_bf16_f32 v108, 0, v108
  v_cvt_pk_bf16_f32 v109, 0, v109
  v_add_f32_dpp v144, v225, v144 quad_perm:[1,1,1,1] row_mask:0xf bank_mask:0xf
  v_add_f32_dpp v145, v227, v145 quad_perm:[3,3,3,3] row_mask:0xf bank_mask:0xf
  v_cvt_pk_bf16_f32 v110, 0, v110
  v_cvt_pk_bf16_f32 v111, 0, v111
  v_add_f32 v229, v144, v145
  v_pk_mul_f32 v[108:109], v[108:109], v[196:197]
  v_pk_mul_f32 v[110:111], v[110:111], v[198:199]
  v_cvt_pk_bf16_f32 v218, v108, v109
  v_cvt_pk_bf16_f32 v219, v110, v111
  s_waitcnt vmcnt(14)
  buffer_load_dwordx4 v[52:55], v94, s[8:11], s60 offen offset:1280 nt
  v_mfma_f32_16x16x32_bf16 v[224:227], v[216:219], v[168:171], 0
  v_cvt_f32_i32 v108, v80
  v_cvt_f32_i32 v109, v81
  v_cvt_f32_i32 v110, v82
  v_cvt_f32_i32 v111, v83
  v_pk_add_f32 v[108:109], v[108:109], v[212:213] neg_lo:[0,1] neg_hi:[0,1]
  v_pk_add_f32 v[110:111], v[110:111], v[214:215] neg_lo:[0,1] neg_hi:[0,1]
  v_cvt_pk_bf16_f32 v108, 0, v108
  v_cvt_pk_bf16_f32 v228, 0, v228
  v_cvt_pk_bf16_f32 v109, 0, v109
  v_cvt_pk_bf16_f32 v229, 0, v229
  v_cvt_pk_bf16_f32 v110, 0, v110
  v_pk_mul_f32 v[228:229], v[228:229], s[68:69]
  v_cvt_pk_bf16_f32 v111, 0, v111
  v_cvt_pk_bf16_f32 v120, v228, v229
  v_pk_mul_f32 v[108:109], v[108:109], v[200:201]
  v_pk_mul_f32 v[110:111], v[110:111], v[202:203]
  v_cvt_pk_bf16_f32 v220, v108, v109
  v_cvt_pk_bf16_f32 v221, v110, v111
  s_waitcnt vmcnt(14)
  s_cbranch_vccnz L_kw1_9
  s_waitcnt vmcnt(9)
L_kw1_9:
  buffer_load_dwordx4 v[56:59], v94, s[8:11], s60 offen offset:1536 nt
  v_mfma_f32_16x16x16_bf16 v[224:227], v[220:221], v[172:173], v[224:227]
  v_cvt_f32_i32 v108, v84
  v_cvt_f32_i32 v109, v85
  v_cvt_f32_i32 v110, v86
  v_cvt_f32_i32 v111, v87
  v_pk_add_f32 v[108:109], v[108:109], v[204:205] neg_lo:[0,1] neg_hi:[0,1]
  v_pk_add_f32 v[110:111], v[110:111], v[206:207] neg_lo:[0,1] neg_hi:[0,1]
  v_cvt_pk_bf16_f32 v108, 0, v108
  v_cvt_pk_bf16_f32 v109, 0, v109
  v_cvt_pk_bf16_f32 v110, 0, v110
  v_cvt_pk_bf16_f32 v111, 0, v111
  v_pk_mul_f32 v[108:109], v[108:109], v[192:193]
  v_pk_mul_f32 v[110:111], v[110:111], v[194:195]
  v_cvt_pk_bf16_f32 v216, v108, v109
  v_cvt_pk_bf16_f32 v217, v110, v111
  s_waitcnt vmcnt(14)
  buffer_load_dwordx4 v[60:63], v94, s[8:11], s60 offen offset:1792 nt
  v_cvt_f32_i32 v108, v88
  v_cvt_f32_i32 v109, v89
  v_cvt_f32_i32 v110, v90
  v_cvt_f32_i32 v111, v91
  v_pk_add_f32 v[108:109], v[108:109], v[208:209] neg_lo:[0,1] neg_hi:[0,1]
  v_pk_add_f32 v[110:111], v[110:111], v[210:211] neg_lo:[0,1] neg_hi:[0,1]
  v_mov_b32_dpp v144, v224 quad_perm:[0,0,0,0] row_mask:0xf bank_mask:0xf
  v_mov_b32_dpp v145, v226 quad_perm:[2,2,2,2] row_mask:0xf bank_mask:0xf
  v_cvt_pk_bf16_f32 v108, 0, v108
  v_cvt_pk_bf16_f32 v109, 0, v109
  v_add_f32_dpp v144, v225, v144 quad_perm:[1,1,1,1] row_mask:0xf bank_mask:0xf
  v_add_f32_dpp v145, v227, v145 quad_perm:[3,3,3,3] row_mask:0xf bank_mask:0xf
  v_cvt_pk_bf16_f32 v110, 0, v110
  v_cvt_pk_bf16_f32 v111, 0, v111
  v_add_f32 v228, v144, v145
  v_pk_mul_f32 v[108:109], v[108:109], v[196:197]
  v_pk_mul_f32 v[110:111], v[110:111], v[198:199]
  v_cvt_pk_bf16_f32 v218, v108, v109
  v_cvt_pk_bf16_f32 v219, v110, v111
  s_waitcnt vmcnt(14)
  buffer_load_dwordx4 v[64:67], v94, s[8:11], s60 offen offset:2048 nt
  v_mfma_f32_16x16x32_bf16 v[224:227], v[216:219], v[168:171], 0
  v_cvt_f32_i32 v108, v4
  v_cvt_f32_i32 v109, v5
  v_cvt_f32_i32 v110, v6
  v_cvt_f32_i32 v111, v7
  v_pk_add_f32 v[108:109], v[108:109], v[212:213] neg_lo:[0,1] neg_hi:[0,1]
  v_pk_add_f32 v[110:111], v[110:111], v[214:215] neg_lo:[0,1] neg_hi:[0,1]
  v_cvt_pk_bf16_f32 v108, 0, v108
  v_cvt_pk_bf16_f32 v109, 0, v109
  v_cvt_pk_bf16_f32 v110, 0, v110
  v_cvt_pk_bf16_f32 v111, 0, v111
  v_pk_mul_f32 v[108:109], v[108:109], v[200:201]
  v_pk_mul_f32 v[110:111], v[110:111], v[202:203]
  v_cvt_pk_bf16_f32 v220, v108, v109
  v_cvt_pk_bf16_f32 v221, v110, v111
  s_waitcnt vmcnt(14)
  s_cbranch_vccnz L_kw1_12
  s_waitcnt vmcnt(9)
L_kw1_12:
  buffer_load_dwordx4 v[68:71], v94, s[8:11], s60 offen offset:2304 nt
  v_mfma_f32_16x16x16_bf16 v[224:227], v[220:221], v[172:173], v[224:227]
  v_cvt_f32_i32 v108, v8
  v_cvt_f32_i32 v109, v9
  v_cvt_f32_i32 v110, v10
  v_cvt_f32_i32 v111, v11
  v_pk_add_f32 v[108:109], v[108:109], v[204:205] neg_lo:[0,1] neg_hi:[0,1]
  v_pk_add_f32 v[110:111], v[110:111], v[206:207] neg_lo:[0,1] neg_hi:[0,1]
  v_cvt_pk_bf16_f32 v108, 0, v108
  v_cvt_pk_bf16_f32 v109, 0, v109
  v_cvt_pk_bf16_f32 v110, 0, v110
  v_cvt_pk_bf16_f32 v111, 0, v111
  v_pk_mul_f32 v[108:109], v[108:109], v[192:193]
  v_pk_mul_f32 v[110:111], v[110:111], v[194:195]
  v_cvt_pk_bf16_f32 v216, v108, v109
  v_cvt_pk_bf16_f32 v217, v110, v111
  s_waitcnt vmcnt(14)
  buffer_load_dwordx4 v[72:75], v94, s[8:11], s60 offen offset:2560 nt
  v_cvt_f32_i32 v108, v12
  v_cvt_f32_i32 v109, v13
  v_cvt_f32_i32 v110, v14
  v_cvt_f32_i32 v111, v15
  v_pk_add_f32 v[108:109], v[108:109], v[208:209] neg_lo:[0,1] neg_hi:[0,1]
  v_pk_add_f32 v[110:111], v[110:111], v[210:211] neg_lo:[0,1] neg_hi:[0,1]
  v_mov_b32_dpp v144, v224 quad_perm:[0,0,0,0] row_mask:0xf bank_mask:0xf
  v_mov_b32_dpp v145, v226 quad_perm:[2,2,2,2] row_mask:0xf bank_mask:0xf
  v_cvt_pk_bf16_f32 v108, 0, v108
  v_cvt_pk_bf16_f32 v109, 0, v109
  v_add_f32_dpp v144, v225, v144 quad_perm:[1,1,1,1] row_mask:0xf bank_mask:0xf
  v_add_f32_dpp v145, v227, v145 quad_perm:[3,3,3,3] row_mask:0xf bank_mask:0xf
  v_cvt_pk_bf16_f32 v110, 0, v110
  v_cvt_pk_bf16_f32 v111, 0, v111
  v_add_f32 v229, v144, v145
  v_pk_mul_f32 v[108:109], v[108:109], v[196:197]
  v_pk_mul_f32 v[110:111], v[110:111], v[198:199]
  v_cvt_pk_bf16_f32 v218, v108, v109
  v_cvt_pk_bf16_f32 v219, v110, v111
  s_waitcnt vmcnt(14)
  buffer_load_dwordx4 v[76:79], v94, s[8:11], s60 offen offset:2816 nt
  v_mfma_f32_16x16x32_bf16 v[224:227], v[216:219], v[168:171], 0
  v_cvt_f32_i32 v108, v16
  v_cvt_f32_i32 v109, v17
  v_cvt_f32_i32 v110, v18
  v_cvt_f32_i32 v111, v19
  v_pk_add_f32 v[108:109], v[108:109], v[212:213] neg_lo:[0,1] neg_hi:[0,1]
  v_pk_add_f32 v[110:111], v[110:111], v[214:215] neg_lo:[0,1] neg_hi:[0,1]
  v_cvt_pk_bf16_f32 v108, 0, v108
  v_cvt_pk_bf16_f32 v228, 0, v228
  v_cvt_pk_bf16_f32 v109, 0, v109
  v_cvt_pk_bf16_f32 v229, 0, v229
  v_cvt_pk_bf16_f32 v110, 0, v110
  v_pk_mul_f32 v[228:229], v[228:229], s[68:69]
  v_cvt_pk_bf16_f32 v111, 0, v111
  v_cvt_pk_bf16_f32 v121, v228, v229
  v_pk_mul_f32 v[108:109], v[108:109], v[200:201]
  v_pk_mul_f32 v[110:111], v[110:111], v[202:203]
  v_cvt_pk_bf16_f32 v220, v108, v109
  v_cvt_pk_bf16_f32 v221, v110, v111
  s_waitcnt vmcnt(14)
  s_cbranch_vccnz L_kw1_15
  s_waitcnt vmcnt(9)
L_kw1_15:
  buffer_load_dwordx4 v[80:83], v95, s[8:11], s60 offen offset:0 nt
  v_mfma_f32_16x16x16_bf16 v[224:227], v[220:221], v[172:173], v[224:227]
  v_cvt_f32_i32 v108, v20
  v_cvt_f32_i32 v109, v21
  v_cvt_f32_i32 v110, v22
  v_cvt_f32_i32 v111, v23
  v_pk_add_f32 v[108:109], v[108:109], v[204:205] neg_lo:[0,1] neg_hi:[0,1]
  v_pk_add_f32 v[110:111], v[110:111], v[206:207] neg_lo:[0,1] neg_hi:[0,1]
  v_cvt_pk_bf16_f32 v108, 0, v108
  v_cvt_pk_bf16_f32 v109, 0, v109
  v_cvt_pk_bf16_f32 v110, 0, v110
  v_cvt_pk_bf16_f32 v111, 0, v111
  v_pk_mul_f32 v[108:109], v[108:109], v[192:193]
  v_pk_mul_f32 v[110:111], v[110:111], v[194:195]
  v_cvt_pk_bf16_f32 v216, v108, v109
  v_cvt_pk_bf16_f32 v217, v110, v111
  s_waitcnt vmcnt(14)
  buffer_load_dwordx4 v[84:87], v95, s[8:11], s60 offen offset:256 nt
  v_cvt_f32_i32 v108, v24
  v_cvt_f32_i32 v109, v25
  v_cvt_f32_i32 v110, v26
  v_cvt_f32_i32 v111, v27
  v_pk_add_f32 v[108:109], v[108:109], v[208:209] neg_lo:[0,1] neg_hi:[0,1]
  v_pk_add_f32 v[110:111], v[110:111], v[210:211] neg_lo:[0,1] neg_hi:[0,1]
  v_mov_b32_dpp v144, v224 quad_perm:[0,0,0,0] row_mask:0xf bank_mask:0xf
  v_mov_b32_dpp v145, v226 quad_perm:[2,2,2,2] row_mask:0xf bank_mask:0xf
  v_cvt_pk_bf16_f32 v108, 0, v108
  v_cvt_pk_bf16_f32 v109, 0, v109
  v_add_f32_dpp v144, v225, v144 quad_perm:[1,1,1,1] row_mask:0xf bank_mask:0xf
  v_add_f32_dpp v145, v227, v145 quad_perm:[3,3,3,3] row_mask:0xf bank_mask:0xf
  v_cvt_pk_bf16_f32 v110, 0, v110
  v_cvt_pk_bf16_f32 v111, 0, v111
  v_add_f32 v228, v144, v145
  v_pk_mul_f32 v[108:109], v[108:109], v[196:197]
  v_pk_mul_f32 v[110:111], v[110:111], v[198:199]
  v_cvt_pk_bf16_f32 v218, v108, v109
  v_cvt_pk_bf16_f32 v219, v110, v111
  s_waitcnt vmcnt(14)
  buffer_load_dwordx4 v[88:91], v95, s[8:11], s60 offen offset:512 nt
  v_mfma_f32_16x16x32_bf16 v[224:227], v[216:219], v[168:171], 0
  v_cvt_f32_i32 v108, v28
  v_cvt_f32_i32 v109, v29
  v_cvt_f32_i32 v110, v30
  v_cvt_f32_i32 v111, v31
  v_pk_add_f32 v[108:109], v[108:109], v[212:213] neg_lo:[0,1] neg_hi:[0,1]
  v_pk_add_f32 v[110:111], v[110:111], v[214:215] neg_lo:[0,1] neg_hi:[0,1]
  s_cmp_lt_u32 s64, s99
  s_cbranch_scc1 L_k_known1
L_k_spin1:
  v_mov_b32 v144, 61696
  ds_read_b32 v144, v144
  s_waitcnt lgkmcnt(0)
  v_readfirstlane_b32 s96, v144
  s_nop 1
  s_cmp_eq_u32 s96, 0
  s_cbranch_scc1 L_k_spin1
  s_mov_b32 s99, -1
L_k_known1:
  s_lshr_b32 s71, s64, 4
  s_andn2_b32 s71, s71, 1
  s_lshr_b32 s71, 0x12, s71
  s_and_b32 s71, s71, 3
  s_lshr_b32 s85, s96, s71
  s_andn2_b32 s70, s64, 1
  s_or_b32 s70, s70, s4
  s_cmp_lt_u32 s64, 8
  s_cselect_b32 s70, s70, s64
  s_cselect_b32 s85, s64, s85
  s_and_b32 s85, s85, 1
  s_and_b32 s70, s70, 31
  s_lshl_b32 s71, s71, 12
  s_add_u32 s70, s70, s5
  s_add_u32 s70, s70, s71
  s_mul_hi_u32 s84, s70, s90
  s_lshr_b32 s84, s84, 1
  s_mul_i32 s71, s84, 3
  s_sub_u32 s70, s70, s71
  s_lshl3_add_u32 s85, s70, s85
  s_mul_i32 s61, s84, 196608
  s_lshr_b32 s89, s84, 4
  s_lshl_b32 s70, s85, 5
  v_add_u32 v97, s70, v230
  v_mul_u32_u24 v97, 21846, v97
  v_lshrrev_b32 v97, 16, v97
  v_add_u32 v144, s85, v231
  v_lshrrev_b32 v145, v144, s91
  v_and_b32 v145, 1, v145
  v_cmp_eq_u32 s[54:55], 1, v145
  s_nop 1
  s_and_b64 s[52:53], s[54:55], s[56:57]
  s_andn2_b64 s[54:55], s[54:55], s[56:57]
  v_mul_u32_u24 v144, 43, v144
  v_lshrrev_b32 v144, 8, v144
  v_mul_u32_u24 v144, 384, v144
  v_add_u32 v234, v144, v233
  s_cmp_eq_u32 s89, s88
  s_cbranch_scc1 L_k_sameq1
  s_mul_i32 s70, s89, 1536
  buffer_load_dwordx2 v[174:175], v235, s[36:39], s70 offen offset:0
  buffer_load_dwordx2 v[176:177], v235, s[36:39], s70 offen offset:128
  buffer_load_dwordx2 v[178:179], v235, s[36:39], s70 offen offset:256
  s_mov_b32 s88, s89
L_k_sameq1:
  s_mul_i32 s62, s84, 1536
  buffer_load_dwordx2 v[180:181], v234, s[20:23], s62 offen offset:0
  buffer_load_dwordx2 v[186:187], v234, s[24:27], s62 offen offset:0
  buffer_load_dwordx2 v[182:183], v234, s[20:23], s62 offen offset:128
  buffer_load_dwordx2 v[188:189], v234, s[24:27], s62 offen offset:128
  buffer_load_dwordx2 v[184:185], v234, s[20:23], s62 offen offset:256
  buffer_load_dwordx2 v[190:191], v234, s[24:27], s62 offen offset:256
  v_cvt_pk_bf16_f32 v108, 0, v108
  v_cvt_pk_bf16_f32 v109, 0, v109
  v_cvt_pk_bf16_f32 v110, 0, v110
  v_cvt_pk_bf16_f32 v111, 0, v111
  v_pk_mul_f32 v[108:109], v[108:109], v[200:201]
  v_pk_mul_f32 v[110:111], v[110:111], v[202:203]
  v_cvt_pk_bf16_f32 v220, v108, v109
  v_cvt_pk_bf16_f32 v221, v110, v111
  s_cmp_lt_u32 s64, 96
  s_cbranch_scc1 L_k_keep
  s_lshr_b32 s71, s3, 5
  s_lshr_b32 s85, s96, s71
  s_bfe_u32 s85, s85, 0x10003
  s_and_b32 s70, s3, 31
  s_lshl_b32 s71, s71, 12
  s_add_u32 s70, s70, s5
  s_add_u32 s70, s70, s71
  s_mul_hi_u32 s84, s70, s90
  s_lshr_b32 s84, s84, 1
  s_mul_i32 s71, s84, 3
  s_sub_u32 s70, s70, s71
  s_lshl3_add_u32 s85, s70, s85
  s_mul_i32 s61, s84, 196608
  s_lshr_b32 s89, s84, 4
  s_lshl_b32 s70, s85, 5
  v_add_u32 v97, s70, v1
  v_mul_u32_u24 v97, 21846, v97
  v_lshrrev_b32 v97, 16, v97
  v_add_u32 v144, s85, v2
  v_lshrrev_b32 v145, v144, s91
  v_and_b32 v145, 1, v145
  v_cmp_eq_u32 s[54:55], 1, v145
  s_nop 1
  s_and_b64 s[52:53], s[54:55], s[58:59]
  s_andn2_b64 s[54:55], s[54:55], s[58:59]
  s_mov_b32 s16, s12
  s_mov_b32 s17, s13
  s_lshl_b32 s62, s84, 9
  v_lshl_add_u32 v98, v97, 1, v96
  buffer_load_short_d16_hi v112, v98, s[32:35], s62 offen
  buffer_load_short_d16_hi v113, v98, s[28:31], s62 offen
  v_mov_b32 v232, v3
L_k_keep:
  v_mad_u32_u24 v92, v97, s63, v232
  v_add_u32 v93, 768, v92
  v_add_u32 v94, 4608, v92
  v_add_u32 v95, 7680, v92
  v_cndmask_b32 v92, v92, v105, s[52:53]
  v_cndmask_b32 v95, v95, v105, s[54:55]
  s_waitcnt vmcnt(20)
  s_cbranch_vccnz L_kw1_18
  s_waitcnt vmcnt(15)
L_kw1_18:
  buffer_load_dwordx4 v[4:7], v92, s[16:19], s61 offen offset:0 nt
  v_mfma_f32_16x16x16_bf16 v[224:227], v[220:221], v[172:173], v[224:227]
  v_cvt_f32_i32 v108, v32
  v_cvt_f32_i32 v109, v33
  v_cvt_f32_i32 v110, v34
  v_cvt_f32_i32 v111, v35
  v_pk_add_f32 v[108:109], v[108:109], v[204:205] neg_lo:[0,1] neg_hi:[0,1]
  v_pk_add_f32 v[110:111], v[110:111], v[206:207] neg_lo:[0,1] neg_hi:[0,1]
  v_cvt_pk_bf16_f32 v108, 0, v108
  v_cvt_pk_bf16_f32 v109, 0, v109
  v_cvt_pk_bf16_f32 v110, 0, v110
  v_cvt_pk_bf16_f32 v111, 0, v111
  v_pk_mul_f32 v[108:109], v[108:109], v[192:193]
  v_pk_mul_f32 v[110:111], v[110:111], v[194:195]
  v_cvt_pk_bf16_f32 v216, v108, v109
  v_cvt_pk_bf16_f32 v217, v110, v111
  s_waitcnt vmcnt(20)
  buffer_load_dwordx4 v[8:11], v92, s[16:19], s61 offen offset:256 nt
  v_cvt_f32_i32 v108, v36
  v_cvt_f32_i32 v109, v37
  v_cvt_f32_i32 v110, v38
  v_cvt_f32_i32 v111, v39
  v_pk_add_f32 v[108:109], v[108:109], v[208:209] neg_lo:[0,1] neg_hi:[0,1]
  v_pk_add_f32 v[110:111], v[110:111], v[210:211] neg_lo:[0,1] neg_hi:[0,1]
  v_mov_b32_dpp v144, v224 quad_perm:[0,0,0,0] row_mask:0xf bank_mask:0xf
  v_mov_b32_dpp v145, v226 quad_perm:[2,2,2,2] row_mask:0xf bank_mask:0xf
  v_cvt_pk_bf16_f32 v108, 0, v108
  v_cvt_pk_bf16_f32 v109, 0, v109
  v_add_f32_dpp v144, v225, v144 quad_perm:[1,1,1,1] row_mask:0xf bank_mask:0xf
  v_add_f32_dpp v145, v227, v145 quad_perm:[3,3,3,3] row_mask:0xf bank_mask:0xf
  v_cvt_pk_bf16_f32 v110, 0, v110
  v_cvt_pk_bf16_f32 v111, 0, v111
  v_add_f32 v229, v144, v145
  v_pk_mul_f32 v[108:109], v[108:109], v[196:197]
  v_pk_mul_f32 v[110:111], v[110:111], v[198:199]
  v_cvt_pk_bf16_f32 v218, v108, v109
  v_cvt_pk_bf16_f32 v219, v110, v111
  s_waitcnt vmcnt(20)
  buffer_load_dwordx4 v[12:15], v92, s[16:19], s61 offen offset:512 nt
  v_mfma_f32_16x16x32_bf16 v[224:227], v[216:219], v[168:171], 0
  v_cvt_f32_i32 v108, v40
  v_cvt_f32_i32 v109, v41
  v_cvt_f32_i32 v110, v42
  v_cvt_f32_i32 v111, v43
  v_pk_add_f32 v[108:109], v[108:109], v[212:213] neg_lo:[0,1] neg_hi:[0,1]
  v_pk_add_f32 v[110:111], v[110:111], v[214:215] neg_lo:[0,1] neg_hi:[0,1]
  v_cvt_pk_bf16_f32 v108, 0, v108
  v_cvt_pk_bf16_f32 v228, 0, v228
  v_cvt_pk_bf16_f32 v109, 0, v109
  v_cvt_pk_bf16_f32 v229, 0, v229
  v_cvt_pk_bf16_f32 v110, 0, v110
  v_pk_mul_f32 v[228:229], v[228:229], s[68:69]
  v_cvt_pk_bf16_f32 v111, 0, v111
  v_cvt_pk_bf16_f32 v122, v228, v229
  v_pk_mul_f32 v[108:109], v[108:109], v[200:201]
  v_pk_mul_f32 v[110:111], v[110:111], v[202:203]
  v_cvt_pk_bf16_f32 v220, v108, v109
  v_cvt_pk_bf16_f32 v221, v110, v111
  s_waitcnt vmcnt(20)
  s_cbranch_vccnz L_kw1_21
  s_waitcnt vmcnt(15)
L_kw1_21:
  buffer_load_dwordx4 v[16:19], v93, s[16:19], s61 offen offset:0 nt
  v_mfma_f32_16x16x16_bf16 v[224:227], v[220:221], v[172:173], v[224:227]
  v_cvt_f32_i32 v108, v44
  v_cvt_f32_i32 v109, v45
  v_cvt_f32_i32 v110, v46
  v_cvt_f32_i32 v111, v47
  v_pk_add_f32 v[108:109], v[108:109], v[204:205] neg_lo:[0,1] neg_hi:[0,1]
  v_pk_add_f32 v[110:111], v[110:111], v[206:207] neg_lo:[0,1] neg_hi:[0,1]
  v_cvt_pk_bf16_f32 v108, 0, v108
  v_cvt_pk_bf16_f32 v109, 0, v109
  v_cvt_pk_bf16_f32 v110, 0, v110
  v_cvt_pk_bf16_f32 v111, 0, v111
  v_pk_mul_f32 v[108:109], v[108:109], v[192:193]
  v_pk_mul_f32 v[110:111], v[110:111], v[194:195]
  v_cvt_pk_bf16_f32 v216, v108, v109
  v_cvt_pk_bf16_f32 v217, v110, v111
  s_waitcnt vmcnt(20)
  buffer_load_dwordx4 v[20:23], v93, s[16:19], s61 offen offset:256 nt
  v_cvt_f32_i32 v108, v48
  v_cvt_f32_i32 v109, v49
  v_cvt_f32_i32 v110, v50
  v_cvt_f32_i32 v111, v51
  v_pk_add_f32 v[108:109], v[108:109], v[208:209] neg_lo:[0,1] neg_hi:[0,1]
  v_pk_add_f32 v[110:111], v[110:111], v[210:211] neg_lo:[0,1] neg_hi:[0,1]
  v_mov_b32_dpp v144, v224 quad_perm:[0,0,0,0] row_mask:0xf bank_mask:0xf
  v_mov_b32_dpp v145, v226 quad_perm:[2,2,2,2] row_mask:0xf bank_mask:0xf
  v_cvt_pk_bf16_f32 v108, 0, v108
  v_cvt_pk_bf16_f32 v109, 0, v109
  v_add_f32_dpp v144, v225, v144 quad_perm:[1,1,1,1] row_mask:0xf bank_mask:0xf
  v_add_f32_dpp v145, v227, v145 quad_perm:[3,3,3,3] row_mask:0xf bank_mask:0xf
  v_cvt_pk_bf16_f32 v110, 0, v110
  v_cvt_pk_bf16_f32 v111, 0, v111
  v_add_f32 v228, v144, v145
  v_pk_mul_f32 v[108:109], v[108:109], v[196:197]
  v_pk_mul_f32 v[110:111], v[110:111], v[198:199]
  v_cvt_pk_bf16_f32 v218, v108, v109
  v_cvt_pk_bf16_f32 v219, v110, v111
  s_waitcnt vmcnt(20)
  buffer_load_dwordx4 v[24:27], v93, s[16:19], s61 offen offset:512 nt
  v_mfma_f32_16x16x32_bf16 v[224:227], v[216:219], v[168:171], 0
  v_cvt_f32_i32 v108, v52
  v_cvt_f32_i32 v109, v53
  v_cvt_f32_i32 v110, v54
  v_cvt_f32_i32 v111, v55
  v_pk_add_f32 v[108:109], v[108:109], v[212:213] neg_lo:[0,1] neg_hi:[0,1]
  v_pk_add_f32 v[110:111], v[110:111], v[214:215] neg_lo:[0,1] neg_hi:[0,1]
  v_cvt_pk_bf16_f32 v108, 0, v108
  v_cvt_pk_bf16_f32 v109, 0, v109
  v_cvt_pk_bf16_f32 v110, 0, v110
  v_cvt_pk_bf16_f32 v111, 0, v111
  v_pk_mul_f32 v[108:109], v[108:109], v[200:201]
  v_pk_mul_f32 v[110:111], v[110:111], v[202:203]
  v_cvt_pk_bf16_f32 v220, v108, v109
  v_cvt_pk_bf16_f32 v221, v110, v111
  s_waitcnt vmcnt(20)
  s_cbranch_vccnz L_kw1_24
  s_waitcnt vmcnt(15)
L_kw1_24:
  buffer_load_dwordx4 v[28:31], v93, s[16:19], s61 offen offset:768 nt
  v_mfma_f32_16x16x16_bf16 v[224:227], v[220:221], v[172:173], v[224:227]
  v_cvt_f32_i32 v108, v56
  v_cvt_f32_i32 v109, v57
  v_cvt_f32_i32 v110, v58
  v_cvt_f32_i32 v111, v59
  v_pk_add_f32 v[108:109], v[108:109], v[204:205] neg_lo:[0,1] neg_hi:[0,1]
  v_pk_add_f32 v[110:111], v[110:111], v[206:207] neg_lo:[0,1] neg_hi:[0,1]
  v_cvt_pk_bf16_f32 v108, 0, v108
  v_cvt_pk_bf16_f32 v109, 0, v109
  v_cvt_pk_bf16_f32 v110, 0, v110
  v_cvt_pk_bf16_f32 v111, 0, v111
  v_pk_mul_f32 v[108:109], v[108:109], v[192:193]
  v_pk_mul_f32 v[110:111], v[110:111], v[194:195]
  v_cvt_pk_bf16_f32 v216, v108, v109
  v_cvt_pk_bf16_f32 v217, v110, v111
  s_waitcnt vmcnt(20)
  buffer_load_dwordx4 v[32:35], v93, s[16:19], s61 offen offset:1024 nt
  v_cvt_f32_i32 v108, v60
  v_cvt_f32_i32 v109, v61
  v_cvt_f32_i32 v110, v62
  v_cvt_f32_i32 v111, v63
  v_pk_add_f32 v[108:109], v[108:109], v[208:209] neg_lo:[0,1] neg_hi:[0,1]
  v_pk_add_f32 v[110:111], v[110:111], v[210:211] neg_lo:[0,1] neg_hi:[0,1]
  v_mov_b32_dpp v144, v224 quad_perm:[0,0,0,0] row_mask:0xf bank_mask:0xf
  v_mov_b32_dpp v145, v226 quad_perm:[2,2,2,2] row_mask:0xf bank_mask:0xf
  v_cvt_pk_bf16_f32 v108, 0, v108
  v_cvt_pk_bf16_f32 v109, 0, v109
  v_add_f32_dpp v144, v225, v144 quad_perm:[1,1,1,1] row_mask:0xf bank_mask:0xf
  v_add_f32_dpp v145, v227, v145 quad_perm:[3,3,3,3] row_mask:0xf bank_mask:0xf
  v_cvt_pk_bf16_f32 v110, 0, v110
  v_cvt_pk_bf16_f32 v111, 0, v111
  v_add_f32 v229, v144, v145
  v_pk_mul_f32 v[108:109], v[108:109], v[196:197]
  v_pk_mul_f32 v[110:111], v[110:111], v[198:199]
  v_cvt_pk_bf16_f32 v218, v108, v109
  v_cvt_pk_bf16_f32 v219, v110, v111
  s_waitcnt vmcnt(20)
  buffer_load_dwordx4 v[36:39], v93, s[16:19], s61 offen offset:1280 nt
  v_mfma_f32_16x16x32_bf16 v[224:227], v[216:219], v[168:171], 0
  v_cvt_f32_i32 v108, v64
  v_cvt_f32_i32 v109, v65
  v_cvt_f32_i32 v110, v66
  v_cvt_f32_i32 v111, v67
  v_pk_add_f32 v[108:109], v[108:109], v[212:213] neg_lo:[0,1] neg_hi:[0,1]
  v_pk_add_f32 v[110:111], v[110:111], v[214:215] neg_lo:[0,1] neg_hi:[0,1]
  v_cvt_pk_bf16_f32 v108, 0, v108
  v_cvt_pk_bf16_f32 v228, 0, v228
  v_cvt_pk_bf16_f32 v109, 0, v109
  v_cvt_pk_bf16_f32 v229, 0, v229
  v_cvt_pk_bf16_f32 v110, 0, v110
  v_pk_mul_f32 v[228:229], v[228:229], s[68:69]
  v_cvt_pk_bf16_f32 v111, 0, v111
  v_cvt_pk_bf16_f32 v123, v228, v229
  v_pk_mul_f32 v[108:109], v[108:109], v[200:201]
  v_pk_mul_f32 v[110:111], v[110:111], v[202:203]
  v_cvt_pk_bf16_f32 v220, v108, v109
  v_cvt_pk_bf16_f32 v221, v110, v111
  s_waitcnt vmcnt(20)
  s_cbranch_vccnz L_kw1_27
  s_waitcnt vmcnt(15)
L_kw1_27:
  buffer_load_dwordx4 v[40:43], v93, s[16:19], s61 offen offset:1536 nt
  v_mfma_f32_16x16x16_bf16 v[224:227], v[220:221], v[172:173], v[224:227]
  v_cvt_f32_i32 v108, v68
  v_cvt_f32_i32 v109, v69
  v_cvt_f32_i32 v110, v70
  v_cvt_f32_i32 v111, v71
  v_pk_add_f32 v[108:109], v[108:109], v[204:205] neg_lo:[0,1] neg_hi:[0,1]
  v_pk_add_f32 v[110:111], v[110:111], v[206:207] neg_lo:[0,1] neg_hi:[0,1]
  v_cvt_pk_bf16_f32 v108, 0, v108
  v_cvt_pk_bf16_f32 v109, 0, v109
  v_cvt_pk_bf16_f32 v110, 0, v110
  v_cvt_pk_bf16_f32 v111, 0, v111
  v_pk_mul_f32 v[108:109], v[108:109], v[192:193]
  v_pk_mul_f32 v[110:111], v[110:111], v[194:195]
  v_cvt_pk_bf16_f32 v216, v108, v109
  v_cvt_pk_bf16_f32 v217, v110, v111
  s_waitcnt vmcnt(20)
  buffer_load_dwordx4 v[44:47], v93, s[16:19], s61 offen offset:1792 nt
  v_cvt_f32_i32 v108, v72
  v_cvt_f32_i32 v109, v73
  v_cvt_f32_i32 v110, v74
  v_cvt_f32_i32 v111, v75
  v_pk_add_f32 v[108:109], v[108:109], v[208:209] neg_lo:[0,1] neg_hi:[0,1]
  v_pk_add_f32 v[110:111], v[110:111], v[210:211] neg_lo:[0,1] neg_hi:[0,1]
  v_mov_b32_dpp v144, v224 quad_perm:[0,0,0,0] row_mask:0xf bank_mask:0xf
  v_mov_b32_dpp v145, v226 quad_perm:[2,2,2,2] row_mask:0xf bank_mask:0xf
  v_cvt_pk_bf16_f32 v108, 0, v108
  v_cvt_pk_bf16_f32 v109, 0, v109
  v_add_f32_dpp v144, v225, v144 quad_perm:[1,1,1,1] row_mask:0xf bank_mask:0xf
  v_add_f32_dpp v145, v227, v145 quad_perm:[3,3,3,3] row_mask:0xf bank_mask:0xf
  v_cvt_pk_bf16_f32 v110, 0, v110
  v_cvt_pk_bf16_f32 v111, 0, v111
  v_add_f32 v228, v144, v145
  v_pk_mul_f32 v[108:109], v[108:109], v[196:197]
  v_pk_mul_f32 v[110:111], v[110:111], v[198:199]
  v_cvt_pk_bf16_f32 v218, v108, v109
  v_cvt_pk_bf16_f32 v219, v110, v111
  s_waitcnt vmcnt(20)
  buffer_load_dwordx4 v[48:51], v93, s[16:19], s61 offen offset:2048 nt
  v_mfma_f32_16x16x32_bf16 v[224:227], v[216:219], v[168:171], 0
  v_cvt_f32_i32 v108, v76
  v_cvt_f32_i32 v109, v77
  v_cvt_f32_i32 v110, v78
  v_cvt_f32_i32 v111, v79
  v_pk_add_f32 v[108:109], v[108:109], v[212:213] neg_lo:[0,1] neg_hi:[0,1]
  v_pk_add_f32 v[110:111], v[110:111], v[214:215] neg_lo:[0,1] neg_hi:[0,1]
  v_cvt_pk_bf16_f32 v108, 0, v108
  v_cvt_pk_bf16_f32 v109, 0, v109
  v_cvt_pk_bf16_f32 v110, 0, v110
  v_cvt_pk_bf16_f32 v111, 0, v111
  v_pk_mul_f32 v[108:109], v[108:109], v[200:201]
  v_pk_mul_f32 v[110:111], v[110:111], v[202:203]
  v_cvt_pk_bf16_f32 v220, v108, v109
  v_cvt_pk_bf16_f32 v221, v110, v111
  s_waitcnt vmcnt(20)
  s_cbranch_vccnz L_kw1_30
  s_waitcnt vmcnt(9)
L_kw1_30:
  buffer_load_dwordx4 v[52:55], v93, s[16:19], s61 offen offset:2304 nt
  v_mfma_f32_16x16x16_bf16 v[224:227], v[220:221], v[172:173], v[224:227]
  v_cvt_f32_i32 v108, v80
  v_cvt_f32_i32 v109, v81
  v_cvt_f32_i32 v110, v82
  v_cvt_f32_i32 v111, v83
  v_pk_add_f32 v[108:109], v[108:109], v[204:205] neg_lo:[0,1] neg_hi:[0,1]
  v_pk_add_f32 v[110:111], v[110:111], v[206:207] neg_lo:[0,1] neg_hi:[0,1]
  v_cvt_pk_bf16_f32 v108, 0, v108
  v_cvt_pk_bf16_f32 v109, 0, v109
  v_cvt_pk_bf16_f32 v110, 0, v110
  v_cvt_pk_bf16_f32 v111, 0, v111
  v_pk_mul_f32 v[108:109], v[108:109], v[192:193]
  v_pk_mul_f32 v[110:111], v[110:111], v[194:195]
  v_cvt_pk_bf16_f32 v216, v108, v109
  v_cvt_pk_bf16_f32 v217, v110, v111
  s_waitcnt vmcnt(20)
  buffer_load_dwordx4 v[56:59], v93, s[16:19], s61 offen offset:2560 nt
  v_cvt_f32_i32 v108, v84
  v_cvt_f32_i32 v109, v85
  v_cvt_f32_i32 v110, v86
  v_cvt_f32_i32 v111, v87
  v_pk_add_f32 v[108:109], v[108:109], v[208:209] neg_lo:[0,1] neg_hi:[0,1]
  v_pk_add_f32 v[110:111], v[110:111], v[210:211] neg_lo:[0,1] neg_hi:[0,1]
  v_mov_b32_dpp v144, v224 quad_perm:[0,0,0,0] row_mask:0xf bank_mask:0xf
  v_mov_b32_dpp v145, v226 quad_perm:[2,2,2,2] row_mask:0xf bank_mask:0xf
  v_cvt_pk_bf16_f32 v108, 0, v108
  v_cvt_pk_bf16_f32 v109, 0, v109
  v_add_f32_dpp v144, v225, v144 quad_perm:[1,1,1,1] row_mask:0xf bank_mask:0xf
  v_add_f32_dpp v145, v227, v145 quad_perm:[3,3,3,3] row_mask:0xf bank_mask:0xf
  v_cvt_pk_bf16_f32 v110, 0, v110
  v_cvt_pk_bf16_f32 v111, 0, v111
  v_add_f32 v229, v144, v145
  v_pk_mul_f32 v[108:109], v[108:109], v[196:197]
  v_pk_mul_f32 v[110:111], v[110:111], v[198:199]
  v_cvt_pk_bf16_f32 v218, v108, v109
  v_cvt_pk_bf16_f32 v219, v110, v111
  s_waitcnt vmcnt(20)
  buffer_load_dwordx4 v[60:63], v93, s[16:19], s61 offen offset:2816 nt
  v_mfma_f32_16x16x32_bf16 v[224:227], v[216:219], v[168:171], 0
  v_cvt_f32_i32 v108, v88
  v_cvt_f32_i32 v109, v89
  v_cvt_f32_i32 v110, v90
  v_cvt_f32_i32 v111, v91
  v_pk_add_f32 v[108:109], v[108:109], v[212:213] neg_lo:[0,1] neg_hi:[0,1]
  v_pk_add_f32 v[110:111], v[110:111], v[214:215] neg_lo:[0,1] neg_hi:[0,1]
  v_cvt_pk_bf16_f32 v108, 0, v108
  v_cvt_pk_bf16_f32 v228, 0, v228
  v_cvt_pk_bf16_f32 v109, 0, v109
  v_cvt_pk_bf16_f32 v229, 0, v229
  v_cvt_pk_bf16_f32 v110, 0, v110
  v_pk_mul_f32 v[228:229], v[228:229], s[68:69]
  v_cvt_pk_bf16_f32 v111, 0, v111
  v_cvt_pk_bf16_f32 v124, v228, v229
  v_pk_mul_f32 v[108:109], v[108:109], v[200:201]
  v_pk_mul_f32 v[110:111], v[110:111], v[202:203]
  v_cvt_pk_bf16_f32 v220, v108, v109
  v_cvt_pk_bf16_f32 v221, v110, v111
  s_mov_b32 s60, s61
  v_mov_b32 v146, s64
  v_mfma_f32_16x16x16_bf16 v[224:227], v[220:221], v[172:173], v[224:227]
  ds_write_b128 v99, v[120:123]
  v_add_u32 v99, 768, v99
  s_nop 5
  v_mov_b32_dpp v144, v224 quad_perm:[0,0,0,0] row_mask:0xf bank_mask:0xf
  v_mov_b32_dpp v145, v226 quad_perm:[2,2,2,2] row_mask:0xf bank_mask:0xf
  s_nop 0
  v_add_f32_dpp v144, v225, v144 quad_perm:[1,1,1,1] row_mask:0xf bank_mask:0xf
  v_add_f32_dpp v145, v227, v145 quad_perm:[3,3,3,3] row_mask:0xf bank_mask:0xf
  v_add_f32 v228, v144, v145
  v_cndmask_b32 v228, v228, v236, s[50:51]
  v_cvt_pk_bf16_f32 v228, 0, v228
  v_cvt_pk_bf16_f32 v229, 0, v229
  v_pk_mul_f32 v[228:229], v[228:229], s[68:69]
  v_cvt_pk_bf16_f32 v125, v228, v229
  ds_write_b64 v100, v[124:125] offset:256
  ds_write_b32 v104, v146
  v_add_u32 v100, 768, v100
  s_cmp_lt_u32 s64, 96
  s_cbranch_scc1 L_k
  v_subrev_u32 v99, 24576, v99
  v_subrev_u32 v100, 24576, v100
  s_mov_b32 s64, s3
  s_mov_b32 s88, s89
  s_mov_b32 s99, 0
  s_mov_b32 s36, s46
  s_and_b32 s37, s47, 0xffff
  s_cmp_lt_u32 s64, s99
  s_cbranch_scc1 L_v0_ok
L_v0_spin:
  v_mov_b32 v144, 61700
  ds_read_b32 v144, v144
  s_waitcnt lgkmcnt(0)
  v_readfirstlane_b32 s99, v144
  s_nop 1
  s_cmp_lt_u32 s64, s99
  s_cbranch_scc0 L_v0_spin
L_v0_ok:
  ds_read_b128 v[120:123], v99
  ds_read_b64 v[124:125], v100 offset:256
  v_mov_b32 v128, 0
  v_mov_b32 v129, 0
  v_mov_b32 v130, 0
  v_mov_b32 v131, 0
  v_mov_b32 v132, 0
  v_mov_b32 v133, 0
  v_mov_b32 v134, 0
  v_mov_b32 v135, 0
  v_mov_b32 v136, 0
  v_mov_b32 v137, 0
  v_mov_b32 v138, 0
  v_mov_b32 v139, 0
  v_mov_b32 v140, 0xff800000
  v_mov_b32 v142, 0x7f800000
  v_mov_b32 v143, 0
L_v0:
  s_add_u32 s97, s64, 96
  v_mov_b32 v146, s97
  s_mov_b32 s86, s84
  ds_write_b32 v104, v146
  s_add_u32 s64, s64, 2
  s_cmp_lt_u32 s64, s99
  s_cbranch_scc1 L_v10_ok
L_v10_spin:
  v_mov_b32 v144, 61700
  ds_read_b32 v144, v144
  s_waitcnt lgkmcnt(0)
  v_readfirstlane_b32 s99, v144
  s_nop 1
  s_cmp_lt_u32 s64, s99
  s_cbranch_scc0 L_v10_spin
L_v10_ok:
  s_lshr_b32 s71, s64, 5
  s_lshr_b32 s85, s96, s71
  s_bfe_u32 s85, s85, 0x10003
  s_and_b32 s70, s64, 31
  s_lshl_b32 s71, s71, 12
  s_add_u32 s70, s70, s5
  s_add_u32 s70, s70, s71
  s_mul_hi_u32 s84, s70, s90
  s_lshr_b32 s84, s84, 1
  s_mul_i32 s71, s84, 3
  s_sub_u32 s70, s70, s71
  s_lshl3_add_u32 s85, s70, s85
  s_mul_i32 s61, s84, 196608
  s_lshr_b32 s89, s84, 4
  s_lshl_b32 s70, s85, 5
  v_add_u32 v97, s70, v1
  v_mul_u32_u24 v97, 21846, v97
  v_lshrrev_b32 v97, 16, v97
  v_add_u32 v144, s85, v2
  v_lshrrev_b32 v145, v144, s91
  v_and_b32 v145, 1, v145
  v_cmp_eq_u32 s[54:55], 1, v145
  s_nop 1
  s_and_b64 s[52:53], s[54:55], s[58:59]
  s_andn2_b64 s[54:55], s[54:55], s[58:59]
  s_cmp_lt_u32 s64, 96
  s_cselect_b32 s61, s61, 805306368
  ds_read_b32 v106, v104 offset:8
  s_waitcnt vmcnt(14)
  s_cbranch_vccnz L_vw0_0
  s_waitcnt vmcnt(9)
L_vw0_0:
  buffer_load_dwordx4 v[64:67], v93, s[12:15], s60 offen offset:3072 nt
  v_mov_b32 v114, v112
  v_mov_b32 v115, v113
  v_cvt_f32_i32 v192, v4
  v_cvt_f32_i32 v193, v5
  v_mov_b32_dpp v116, v114 row_newbcast:0 row_mask:0xf bank_mask:0xf
  v_mov_b32_dpp v117, v115 row_newbcast:0 row_mask:0xf bank_mask:0xf
  v_cvt_f32_i32 v194, v6
  v_cvt_f32_i32 v195, v7
  v_pk_add_f32 v[192:193], v[192:193], v[116:117] op_sel_hi:[1,0] neg_lo:[0,1] neg_hi:[0,1]
  v_pk_add_f32 v[194:195], v[194:195], v[116:117] op_sel_hi:[1,0] neg_lo:[0,1] neg_hi:[0,1]
  v_cvt_pk_bf16_f32 v192, 0, v192
  v_cvt_pk_bf16_f32 v193, 0, v193
  v_cvt_pk_bf16_f32 v194, 0, v194
  v_cvt_pk_bf16_f32 v195, 0, v195
  v_pk_mul_f32 v[192:193], v[192:193], v[116:117] op_sel:[0,1]
  v_pk_mul_f32 v[194:195], v[194:195], v[116:117] op_sel:[0,1]
  s_waitcnt lgkmcnt(0)
  v_cmp_lt_u32 vcc, s97, v106
  s_waitcnt vmcnt(14)
  buffer_load_dwordx4 v[68:71], v93, s[12:15], s60 offen offset:3328 nt
  v_cvt_f32_i32 v196, v8
  v_cvt_f32_i32 v197, v9
  v_cvt_f32_i32 v198, v10
  v_cvt_f32_i32 v199, v11
  v_pk_add_f32 v[196:197], v[196:197], v[116:117] op_sel_hi:[1,0] neg_lo:[0,1] neg_hi:[0,1]
  v_pk_add_f32 v[198:199], v[198:199], v[116:117] op_sel_hi:[1,0] neg_lo:[0,1] neg_hi:[0,1]
  v_cvt_pk_bf16_f32 v196, 0, v196
  v_lshlrev_b32 v148, 16, v120
  v_cvt_pk_bf16_f32 v197, 0, v197
  v_and_b32 v149, s65, v120
  v_cvt_pk_bf16_f32 v198, 0, v198
  v_lshlrev_b32 v150, 16, v121
  v_cvt_pk_bf16_f32 v199, 0, v199
  v_and_b32 v151, s65, v121
  v_pk_mul_f32 v[196:197], v[196:197], v[116:117] op_sel:[0,1]
  v_lshlrev_b32 v152, 16, v122
  v_pk_mul_f32 v[198:199], v[198:199], v[116:117] op_sel:[0,1]
  s_waitcnt vmcnt(14)
  buffer_load_dwordx4 v[72:75], v93, s[12:15], s60 offen offset:3584 nt
  v_cvt_f32_i32 v200, v12
  v_cvt_f32_i32 v201, v13
  v_cvt_f32_i32 v202, v14
  v_cvt_f32_i32 v203, v15
  v_pk_add_f32 v[200:201], v[200:201], v[116:117] op_sel_hi:[1,0] neg_lo:[0,1] neg_hi:[0,1]
  v_pk_add_f32 v[202:203], v[202:203], v[116:117] op_sel_hi:[1,0] neg_lo:[0,1] neg_hi:[0,1]
  v_cvt_pk_bf16_f32 v200, 0, v200
  v_and_b32 v153, s65, v122
  v_cvt_pk_bf16_f32 v201, 0, v201
  v_lshlrev_b32 v154, 16, v123
  v_cvt_pk_bf16_f32 v202, 0, v202
  v_and_b32 v155, s65, v123
  v_cvt_pk_bf16_f32 v203, 0, v203
  v_lshlrev_b32 v156, 16, v124
  v_pk_mul_f32 v[200:201], v[200:201], v[116:117] op_sel:[0,1]
  v_and_b32 v157, s65, v124
  v_pk_mul_f32 v[202:203], v[202:203], v[116:117] op_sel:[0,1]
  s_waitcnt vmcnt(14)
  s_cbranch_vccnz L_vw0_3
  s_waitcnt vmcnt(9)
L_vw0_3:
  buffer_load_dwordx4 v[76:79], v94, s[12:15], s60 offen offset:0 nt
  v_cvt_f32_i32 v108, v16
  v_cvt_f32_i32 v109, v17
  v_mov_b32_dpp v116, v114 row_newbcast:1 row_mask:0xf bank_mask:0xf
  v_mov_b32_dpp v117, v115 row_newbcast:1 row_mask:0xf bank_mask:0xf
  v_cvt_f32_i32 v110, v18
  v_cvt_f32_i32 v111, v19
  v_pk_add_f32 v[108:109], v[108:109], v[116:117] op_sel_hi:[1,0] neg_lo:[0,1] neg_hi:[0,1]
  v_pk_add_f32 v[110:111], v[110:111], v[116:117] op_sel_hi:[1,0] neg_lo:[0,1] neg_hi:[0,1]
  s_lshl_b32 s62, s84, 9
  v_lshl_add_u32 v98, v97, 1, v96
  buffer_load_short_d16_hi v112, v98, s[32:35], s62 offen
  buffer_load_short_d16_hi v113, v98, s[28:31], s62 offen
  v_cvt_pk_bf16_f32 v108, 0, v108
  v_lshlrev_b32 v158, 16, v125
  v_cvt_pk_bf16_f32 v109, 0, v109
  v_add_u32 v99, 768, v99
  v_cvt_pk_bf16_f32 v110, 0, v110
  v_add_u32 v100, 768, v100
  v_cvt_pk_bf16_f32 v111, 0, v111
  v_max3_f32 v144, v148, v149, v150
  v_pk_mul_f32 v[108:109], v[108:109], v[116:117] op_sel:[0,1]
  ds_read_b128 v[120:123], v99
  v_pk_mul_f32 v[110:111], v[110:111], v[116:117] op_sel:[0,1]
  v_cvt_pk_bf16_f32 v204, v192, v108
  v_cvt_pk_bf16_f32 v208, v193, v109
  v_cvt_pk_bf16_f32 v212, v194, v110
  v_cvt_pk_bf16_f32 v216, v195, v111
  s_waitcnt vmcnt(16)
  buffer_load_dwordx4 v[80:83], v94, s[12:15], s60 offen offset:256 nt
  v_cvt_f32_i32 v108, v20
  v_cvt_f32_i32 v109, v21
  v_cvt_f32_i32 v110, v22
  v_cvt_f32_i32 v111, v23
  v_pk_add_f32 v[108:109], v[108:109], v[116:117] op_sel_hi:[1,0] neg_lo:[0,1] neg_hi:[0,1]
  v_pk_add_f32 v[110:111], v[110:111], v[116:117] op_sel_hi:[1,0] neg_lo:[0,1] neg_hi:[0,1]
  v_cvt_pk_bf16_f32 v108, 0, v108
  ds_read_b64 v[124:125], v100 offset:256
  v_cvt_pk_bf16_f32 v109, 0, v109
  v_max3_f32 v145, v151, v152, v153
  v_cvt_pk_bf16_f32 v110, 0, v110
  v_max3_f32 v144, v144, v154, v155
  v_cvt_pk_bf16_f32 v111, 0, v111
  v_max3_f32 v145, v145, v156, v157
  v_pk_mul_f32 v[108:109], v[108:109], v[116:117] op_sel:[0,1]
  v_max3_f32 v144, v144, v158, v140
  v_pk_mul_f32 v[110:111], v[110:111], v[116:117] op_sel:[0,1]
  v_cvt_pk_bf16_f32 v220, v196, v108
  v_cvt_pk_bf16_f32 v224, v197, v109
  v_cvt_pk_bf16_f32 v228, v198, v110
  v_cvt_pk_bf16_f32 v232, v199, v111
  s_waitcnt vmcnt(16)
  buffer_load_dwordx4 v[84:87], v94, s[12:15], s60 offen offset:512 nt
  v_cvt_f32_i32 v108, v24
  v_cvt_f32_i32 v109, v25
  v_cvt_f32_i32 v110, v26
  v_cvt_f32_i32 v111, v27
  v_pk_add_f32 v[108:109], v[108:109], v[116:117] op_sel_hi:[1,0] neg_lo:[0,1] neg_hi:[0,1]
  v_pk_add_f32 v[110:111], v[110:111], v[116:117] op_sel_hi:[1,0] neg_lo:[0,1] neg_hi:[0,1]
  v_cvt_pk_bf16_f32 v108, 0, v108
  v_max_f32 v144, v144, v145
  v_cvt_pk_bf16_f32 v109, 0, v109
  v_mov_b32 v145, v144
  v_cvt_pk_bf16_f32 v110, 0, v110
  s_nop 0
  v_permlane32_swap_b32 v144, v145
  v_cvt_pk_bf16_f32 v111, 0, v111
  v_max_f32 v144, v144, v145
  v_pk_mul_f32 v[108:109], v[108:109], v[116:117] op_sel:[0,1]
  v_mov_b32 v145, v144
  v_pk_mul_f32 v[110:111], v[110:111], v[116:117] op_sel:[0,1]
  v_cvt_pk_bf16_f32 v236, v200, v108
  v_cvt_pk_bf16_f32 v240, v201, v109
  v_cvt_pk_bf16_f32 v244, v202, v110
  v_cvt_pk_bf16_f32 v248, v203, v111
  s_waitcnt vmcnt(16)
  s_cbranch_vccnz L_vw0_6
  s_waitcnt vmcnt(11)
L_vw0_6:
  buffer_load_dwordx4 v[88:91], v94, s[12:15], s60 offen offset:768 nt
  v_cvt_f32_i32 v192, v28
  v_cvt_f32_i32 v193, v29
  v_mov_b32_dpp v116, v114 row_newbcast:2 row_mask:0xf bank_mask:0xf
  v_mov_b32_dpp v117, v115 row_newbcast:2 row_mask:0xf bank_mask:0xf
  v_cvt_f32_i32 v194, v30
  v_cvt_f32_i32 v195, v31
  v_pk_add_f32 v[192:193], v[192:193], v[116:117] op_sel_hi:[1,0] neg_lo:[0,1] neg_hi:[0,1]
  v_pk_add_f32 v[194:195], v[194:195], v[116:117] op_sel_hi:[1,0] neg_lo:[0,1] neg_hi:[0,1]
  v_cvt_pk_bf16_f32 v192, 0, v192
  v_permlane16_swap_b32 v144, v145
  v_cvt_pk_bf16_f32 v193, 0, v193
  v_max_f32 v140, v144, v145
  v_cvt_pk_bf16_f32 v194, 0, v194
  v_mul_f32 v144, s66, v140
  v_cvt_pk_bf16_f32 v195, 0, v195
  v_add_f32 v146, v144, v142
  v_pk_mul_f32 v[192:193], v[192:193], v[116:117] op_sel:[0,1]
  v_sub_f32 v142, 0, v144
  v_pk_mul_f32 v[194:195], v[194:195], v[116:117] op_sel:[0,1]
  s_waitcnt vmcnt(16)
  buffer_load_dwordx4 v[4:7], v94, s[12:15], s60 offen offset:1024 nt
  v_cvt_f32_i32 v196, v32
  v_cvt_f32_i32 v197, v33
  v_cvt_f32_i32 v198, v34
  v_cvt_f32_i32 v199, v35
  v_pk_add_f32 v[196:197], v[196:197], v[116:117] op_sel_hi:[1,0] neg_lo:[0,1] neg_hi:[0,1]
  v_pk_add_f32 v[198:199], v[198:199], v[116:117] op_sel_hi:[1,0] neg_lo:[0,1] neg_hi:[0,1]
  v_cvt_pk_bf16_f32 v196, 0, v196
  v_exp_f32 v146, -v146
  v_cvt_pk_bf16_f32 v197, 0, v197
  ds_bpermute_b32 v147, v101, v146
  v_cvt_pk_bf16_f32 v198, 0, v198
  v_fma_f32 v148, v148, s66, v142
  v_cvt_pk_bf16_f32 v199, 0, v199
  v_exp_f32 v148, v148
  v_pk_mul_f32 v[196:197], v[196:197], v[116:117] op_sel:[0,1]
  v_fma_f32 v149, v149, s66, v142
  v_pk_mul_f32 v[198:199], v[198:199], v[116:117] op_sel:[0,1]
  s_waitcnt vmcnt(16)
  buffer_load_dwordx4 v[8:11], v94, s[12:15], s60 offen offset:1280 nt
  v_cvt_f32_i32 v200, v36
  v_cvt_f32_i32 v201, v37
  v_cvt_f32_i32 v202, v38
  v_cvt_f32_i32 v203, v39
  v_pk_add_f32 v[200:201], v[200:201], v[116:117] op_sel_hi:[1,0] neg_lo:[0,1] neg_hi:[0,1]
  v_pk_add_f32 v[202:203], v[202:203], v[116:117] op_sel_hi:[1,0] neg_lo:[0,1] neg_hi:[0,1]
  v_cvt_pk_bf16_f32 v200, 0, v200
  v_exp_f32 v149, v149
  v_cvt_pk_bf16_f32 v201, 0, v201
  v_fma_f32 v150, v150, s66, v142
  v_cvt_pk_bf16_f32 v202, 0, v202
  v_exp_f32 v150, v150
  v_cvt_pk_bf16_f32 v203, 0, v203
  v_fma_f32 v151, v151, s66, v142
  v_pk_mul_f32 v[200:201], v[200:201], v[116:117] op_sel:[0,1]
  v_exp_f32 v151, v151
  v_pk_mul_f32 v[202:203], v[202:203], v[116:117] op_sel:[0,1]
  s_waitcnt vmcnt(16)
  s_cbranch_vccnz L_vw0_9
  s_waitcnt vmcnt(11)
L_vw0_9:
  buffer_load_dwordx4 v[12:15], v94, s[12:15], s60 offen offset:1536 nt
  v_cvt_f32_i32 v108, v40
  v_cvt_f32_i32 v109, v41
  v_mov_b32_dpp v116, v114 row_newbcast:3 row_mask:0xf bank_mask:0xf
  v_mov_b32_dpp v117, v115 row_newbcast:3 row_mask:0xf bank_mask:0xf
  v_cvt_f32_i32 v110, v42
  v_cvt_f32_i32 v111, v43
  v_pk_add_f32 v[108:109], v[108:109], v[116:117] op_sel_hi:[1,0] neg_lo:[0,1] neg_hi:[0,1]
  v_pk_add_f32 v[110:111], v[110:111], v[116:117] op_sel_hi:[1,0] neg_lo:[0,1] neg_hi:[0,1]
  v_cvt_pk_bf16_f32 v108, 0, v108
  v_fma_f32 v152, v152, s66, v142
  v_cvt_pk_bf16_f32 v109, 0, v109
  v_exp_f32 v152, v152
  v_cvt_pk_bf16_f32 v110, 0, v110
  v_fma_f32 v153, v153, s66, v142
  v_cvt_pk_bf16_f32 v111, 0, v111
  v_exp_f32 v153, v153
  v_pk_mul_f32 v[108:109], v[108:109], v[116:117] op_sel:[0,1]
  v_fma_f32 v154, v154, s66, v142
  v_pk_mul_f32 v[110:111], v[110:111], v[116:117] op_sel:[0,1]
  v_cvt_pk_bf16_f32 v205, v192, v108
  v_cvt_pk_bf16_f32 v209, v193, v109
  v_cvt_pk_bf16_f32 v213, v194, v110
  v_cvt_pk_bf16_f32 v217, v195, v111
  s_waitcnt vmcnt(16)
  buffer_load_dwordx4 v[16:19], v94, s[12:15], s60 offen offset:1792 nt
  v_cvt_f32_i32 v108, v44
  v_cvt_f32_i32 v109, v45
  v_cvt_f32_i32 v110, v46
  v_cvt_f32_i32 v111, v47
  v_pk_add_f32 v[108:109], v[108:109], v[116:117] op_sel_hi:[1,0] neg_lo:[0,1] neg_hi:[0,1]
  v_pk_add_f32 v[110:111], v[110:111], v[116:117] op_sel_hi:[1,0] neg_lo:[0,1] neg_hi:[0,1]
  v_cvt_pk_bf16_f32 v108, 0, v108
  v_exp_f32 v154, v154
  v_cvt_pk_bf16_f32 v109, 0, v109
  v_fma_f32 v155, v155, s66, v142
  v_cvt_pk_bf16_f32 v110, 0, v110
  v_exp_f32 v155, v155
  v_cvt_pk_bf16_f32 v111, 0, v111
  v_fma_f32 v156, v156, s66, v142
  v_pk_mul_f32 v[108:109], v[108:109], v[116:117] op_sel:[0,1]
  v_exp_f32 v156, v156
  v_pk_mul_f32 v[110:111], v[110:111], v[116:117] op_sel:[0,1]
  v_cvt_pk_bf16_f32 v221, v196, v108
  v_cvt_pk_bf16_f32 v225, v197, v109
  v_cvt_pk_bf16_f32 v229, v198, v110
  v_cvt_pk_bf16_f32 v233, v199, v111
  s_waitcnt vmcnt(16)
  buffer_load_dwordx4 v[20:23], v94, s[12:15], s60 offen offset:2048 nt
  v_cvt_f32_i32 v108, v48
  v_cvt_f32_i32 v109, v49
  v_cvt_f32_i32 v110, v50
  v_cvt_f32_i32 v111, v51
  v_pk_add_f32 v[108:109], v[108:109], v[116:117] op_sel_hi:[1,0] neg_lo:[0,1] neg_hi:[0,1]
  v_pk_add_f32 v[110:111], v[110:111], v[116:117] op_sel_hi:[1,0] neg_lo:[0,1] neg_hi:[0,1]
  v_cvt_pk_bf16_f32 v108, 0, v108
  v_fma_f32 v157, v157, s66, v142
  v_cvt_pk_bf16_f32 v109, 0, v109
  v_exp_f32 v157, v157
  v_cvt_pk_bf16_f32 v110, 0, v110
  v_fma_f32 v158, v158, s66, v142
  v_cvt_pk_bf16_f32 v111, 0, v111
  v_exp_f32 v158, v158
  v_pk_mul_f32 v[108:109], v[108:109], v[116:117] op_sel:[0,1]
  v_add_f32 v144, v148, v149
  v_pk_mul_f32 v[110:111], v[110:111], v[116:117] op_sel:[0,1]
  v_cvt_pk_bf16_f32 v237, v200, v108
  v_cvt_pk_bf16_f32 v241, v201, v109
  v_cvt_pk_bf16_f32 v245, v202, v110
  v_cvt_pk_bf16_f32 v249, v203, v111
  s_waitcnt vmcnt(16)
  s_cbranch_vccnz L_vw0_12
  s_waitcnt vmcnt(11)
L_vw0_12:
  buffer_load_dwordx4 v[24:27], v94, s[12:15], s60 offen offset:2304 nt
  v_cvt_f32_i32 v192, v52
  v_cvt_f32_i32 v193, v53
  v_mov_b32_dpp v116, v114 row_newbcast:4 row_mask:0xf bank_mask:0xf
  v_mov_b32_dpp v117, v115 row_newbcast:4 row_mask:0xf bank_mask:0xf
  v_cvt_f32_i32 v194, v54
  v_cvt_f32_i32 v195, v55
  v_pk_add_f32 v[192:193], v[192:193], v[116:117] op_sel_hi:[1,0] neg_lo:[0,1] neg_hi:[0,1]
  v_pk_add_f32 v[194:195], v[194:195], v[116:117] op_sel_hi:[1,0] neg_lo:[0,1] neg_hi:[0,1]
  v_cvt_pk_bf16_f32 v192, 0, v192
  v_add_f32 v145, v150, v151
  v_cvt_pk_bf16_f32 v193, 0, v193
  v_add_f32 v144, v144, v152
  v_cvt_pk_bf16_f32 v194, 0, v194
  v_add_f32 v145, v145, v153
  v_cvt_pk_bf16_f32 v195, 0, v195
  v_add_f32 v144, v144, v154
  v_pk_mul_f32 v[192:193], v[192:193], v[116:117] op_sel:[0,1]
  v_add_f32 v145, v145, v155
  v_pk_mul_f32 v[194:195], v[194:195], v[116:117] op_sel:[0,1]
  s_waitcnt vmcnt(16)
  buffer_load_dwordx4 v[28:31], v94, s[12:15], s60 offen offset:2560 nt
  v_cvt_f32_i32 v196, v56
  v_cvt_f32_i32 v197, v57
  v_cvt_f32_i32 v198, v58
  v_cvt_f32_i32 v199, v59
  v_pk_add_f32 v[196:197], v[196:197], v[116:117] op_sel_hi:[1,0] neg_lo:[0,1] neg_hi:[0,1]
  v_pk_add_f32 v[198:199], v[198:199], v[116:117] op_sel_hi:[1,0] neg_lo:[0,1] neg_hi:[0,1]
  v_cvt_pk_bf16_f32 v196, 0, v196
  v_add_f32 v144, v144, v156
  v_cvt_pk_bf16_f32 v197, 0, v197
  v_add_f32 v145, v145, v157
  v_cvt_pk_bf16_f32 v198, 0, v198
  v_add_f32 v144, v144, v158
  v_cvt_pk_bf16_f32 v199, 0, v199
  v_add_f32 v144, v144, v145
  v_pk_mul_f32 v[196:197], v[196:197], v[116:117] op_sel:[0,1]
  v_fma_f32 v143, v143, v146, v144
  v_pk_mul_f32 v[198:199], v[198:199], v[116:117] op_sel:[0,1]
  s_waitcnt vmcnt(16)
  buffer_load_dwordx4 v[32:35], v94, s[12:15], s60 offen offset:2816 nt
  v_cvt_f32_i32 v200, v60
  v_cvt_f32_i32 v201, v61
  v_cvt_f32_i32 v202, v62
  v_cvt_f32_i32 v203, v63
  v_pk_add_f32 v[200:201], v[200:201], v[116:117] op_sel_hi:[1,0] neg_lo:[0,1] neg_hi:[0,1]
  v_pk_add_f32 v[202:203], v[202:203], v[116:117] op_sel_hi:[1,0] neg_lo:[0,1] neg_hi:[0,1]
  v_cvt_pk_bf16_f32 v200, 0, v200
  v_cvt_pk_bf16_f32 v159, v148, v149
  v_cvt_pk_bf16_f32 v201, 0, v201
  v_cvt_pk_bf16_f32 v160, v150, v151
  v_cvt_pk_bf16_f32 v202, 0, v202
  v_cvt_pk_bf16_f32 v161, v152, v153
  v_cvt_pk_bf16_f32 v203, 0, v203
  v_cvt_pk_bf16_f32 v162, v154, v155
  v_pk_mul_f32 v[200:201], v[200:201], v[116:117] op_sel:[0,1]
  v_cvt_pk_bf16_f32 v163, v156, v157
  v_pk_mul_f32 v[202:203], v[202:203], v[116:117] op_sel:[0,1]
  s_waitcnt vmcnt(16)
  s_cbranch_vccnz L_vw0_15
  s_waitcnt vmcnt(9)
L_vw0_15:
  buffer_load_dwordx4 v[36:39], v95, s[12:15], s60 offen offset:0 nt
  v_cvt_f32_i32 v108, v64
  v_cvt_f32_i32 v109, v65
  v_mov_b32_dpp v116, v114 row_newbcast:5 row_mask:0xf bank_mask:0xf
  v_mov_b32_dpp v117, v115 row_newbcast:5 row_mask:0xf bank_mask:0xf
  v_cvt_f32_i32 v110, v66
  v_cvt_f32_i32 v111, v67
  v_pk_add_f32 v[108:109], v[108:109], v[116:117] op_sel_hi:[1,0] neg_lo:[0,1] neg_hi:[0,1]
  v_pk_add_f32 v[110:111], v[110:111], v[116:117] op_sel_hi:[1,0] neg_lo:[0,1] neg_hi:[0,1]
  v_cvt_pk_bf16_f32 v108, 0, v108
  v_cvt_pk_bf16_f32 v164, v158, 0
  v_cvt_pk_bf16_f32 v109, 0, v109
  v_cndmask_b32 v168, 0, v159, s[72:73]
  v_cvt_pk_bf16_f32 v110, 0, v110
  v_cndmask_b32 v169, 0, v160, s[72:73]
  v_cvt_pk_bf16_f32 v111, 0, v111
  v_cndmask_b32 v170, 0, v161, s[72:73]
  v_pk_mul_f32 v[108:109], v[108:109], v[116:117] op_sel:[0,1]
  v_cndmask_b32 v171, 0, v162, s[72:73]
  v_pk_mul_f32 v[110:111], v[110:111], v[116:117] op_sel:[0,1]
  v_cvt_pk_bf16_f32 v206, v192, v108
  v_cvt_pk_bf16_f32 v210, v193, v109
  v_cvt_pk_bf16_f32 v214, v194, v110
  v_cvt_pk_bf16_f32 v218, v195, v111
  s_waitcnt vmcnt(16)
  buffer_load_dwordx4 v[40:43], v95, s[12:15], s60 offen offset:256 nt
  v_cvt_f32_i32 v108, v68
  v_cvt_f32_i32 v109, v69
  v_cvt_f32_i32 v110, v70
  v_cvt_f32_i32 v111, v71
  v_pk_add_f32 v[108:109], v[108:109], v[116:117] op_sel_hi:[1,0] neg_lo:[0,1] neg_hi:[0,1]
  v_pk_add_f32 v[110:111], v[110:111], v[116:117] op_sel_hi:[1,0] neg_lo:[0,1] neg_hi:[0,1]
  v_cvt_pk_bf16_f32 v108, 0, v108
  v_cndmask_b32 v172, 0, v159, s[74:75]
  v_cvt_pk_bf16_f32 v109, 0, v109
  v_cndmask_b32 v173, 0, v160, s[74:75]
  v_cvt_pk_bf16_f32 v110, 0, v110
  v_cndmask_b32 v174, 0, v161, s[74:75]
  v_cvt_pk_bf16_f32 v111, 0, v111
  v_cndmask_b32 v175, 0, v162, s[74:75]
  v_pk_mul_f32 v[108:109], v[108:109], v[116:117] op_sel:[0,1]
  v_cndmask_b32 v176, 0, v159, s[76:77]
  v_pk_mul_f32 v[110:111], v[110:111], v[116:117] op_sel:[0,1]
  v_cvt_pk_bf16_f32 v222, v196, v108
  v_cvt_pk_bf16_f32 v226, v197, v109
  v_cvt_pk_bf16_f32 v230, v198, v110
  v_cvt_pk_bf16_f32 v234, v199, v111
  s_waitcnt vmcnt(16)
  buffer_load_dwordx4 v[44:47], v95, s[12:15], s60 offen offset:512 nt
  v_cvt_f32_i32 v108, v72
  v_cvt_f32_i32 v109, v73
  v_cvt_f32_i32 v110, v74
  v_cvt_f32_i32 v111, v75
  v_pk_add_f32 v[108:109], v[108:109], v[116:117] op_sel_hi:[1,0] neg_lo:[0,1] neg_hi:[0,1]
  v_pk_add_f32 v[110:111], v[110:111], v[116:117] op_sel_hi:[1,0] neg_lo:[0,1] neg_hi:[0,1]
  v_cvt_pk_bf16_f32 v108, 0, v108
  v_cndmask_b32 v177, 0, v160, s[76:77]
  v_cvt_pk_bf16_f32 v109, 0, v109
  v_cndmask_b32 v178, 0, v161, s[76:77]
  v_cvt_pk_bf16_f32 v110, 0, v110
  v_cndmask_b32 v179, 0, v162, s[76:77]
  v_cvt_pk_bf16_f32 v111, 0, v111
  v_cndmask_b32 v180, 0, v159, s[78:79]
  v_pk_mul_f32 v[108:109], v[108:109], v[116:117] op_sel:[0,1]
  v_cndmask_b32 v181, 0, v160, s[78:79]
  v_pk_mul_f32 v[110:111], v[110:111], v[116:117] op_sel:[0,1]
  v_cvt_pk_bf16_f32 v238, v200, v108
  v_cvt_pk_bf16_f32 v242, v201, v109
  v_cvt_pk_bf16_f32 v246, v202, v110
  v_cvt_pk_bf16_f32 v250, v203, v111
  v_mad_u32_u24 v92, v97, s63, v3
  v_add_u32 v93, 768, v92
  v_add_u32 v94, 4608, v92
  v_add_u32 v95, 7680, v92
  v_cndmask_b32 v92, v92, v105, s[52:53]
  v_cndmask_b32 v95, v95, v105, s[54:55]
  s_waitcnt vmcnt(16)
  s_cbranch_vccnz L_vw0_18
  s_waitcnt vmcnt(9)
L_vw0_18:
  buffer_load_dwordx4 v[48:51], v92, s[12:15], s61 offen offset:0 nt
  v_cvt_f32_i32 v192, v76
  v_cvt_f32_i32 v193, v77
  v_mov_b32_dpp v116, v114 row_newbcast:6 row_mask:0xf bank_mask:0xf
  v_mov_b32_dpp v117, v115 row_newbcast:6 row_mask:0xf bank_mask:0xf
  v_cvt_f32_i32 v194, v78
  v_cvt_f32_i32 v195, v79
  v_pk_add_f32 v[192:193], v[192:193], v[116:117] op_sel_hi:[1,0] neg_lo:[0,1] neg_hi:[0,1]
  v_pk_add_f32 v[194:195], v[194:195], v[116:117] op_sel_hi:[1,0] neg_lo:[0,1] neg_hi:[0,1]
  v_cvt_pk_bf16_f32 v192, 0, v192
  v_cndmask_b32 v182, 0, v161, s[78:79]
  v_cvt_pk_bf16_f32 v193, 0, v193
  v_cndmask_b32 v183, 0, v162, s[78:79]
  v_cvt_pk_bf16_f32 v194, 0, v194
  s_waitcnt lgkmcnt(0)
  v_cvt_pk_bf16_f32 v195, 0, v195
  v_mul_f32 v128, v147, v128
  v_pk_mul_f32 v[192:193], v[192:193], v[116:117] op_sel:[0,1]
  v_mul_f32 v129, v147, v129
  v_pk_mul_f32 v[194:195], v[194:195], v[116:117] op_sel:[0,1]
  s_waitcnt vmcnt(14)
  buffer_load_dwordx4 v[52:55], v92, s[12:15], s61 offen offset:256 nt
  v_cvt_f32_i32 v196, v80
  v_cvt_f32_i32 v197, v81
  v_cvt_f32_i32 v198, v82
  v_cvt_f32_i32 v199, v83
  v_pk_add_f32 v[196:197], v[196:197], v[116:117] op_sel_hi:[1,0] neg_lo:[0,1] neg_hi:[0,1]
  v_pk_add_f32 v[198:199], v[198:199], v[116:117] op_sel_hi:[1,0] neg_lo:[0,1] neg_hi:[0,1]
  v_cvt_pk_bf16_f32 v196, 0, v196
  v_mul_f32 v130, v147, v130
  v_cvt_pk_bf16_f32 v197, 0, v197
  v_mul_f32 v131, v147, v131
  v_cvt_pk_bf16_f32 v198, 0, v198
  v_mul_f32 v132, v147, v132
  v_cvt_pk_bf16_f32 v199, 0, v199
  v_mul_f32 v133, v147, v133
  v_pk_mul_f32 v[196:197], v[196:197], v[116:117] op_sel:[0,1]
  v_mul_f32 v134, v147, v134
  v_pk_mul_f32 v[198:199], v[198:199], v[116:117] op_sel:[0,1]
  s_waitcnt vmcnt(14)
  buffer_load_dwordx4 v[56:59], v92, s[12:15], s61 offen offset:512 nt
  v_cvt_f32_i32 v200, v84
  v_cvt_f32_i32 v201, v85
  v_cvt_f32_i32 v202, v86
  v_cvt_f32_i32 v203, v87
  v_pk_add_f32 v[200:201], v[200:201], v[116:117] op_sel_hi:[1,0] neg_lo:[0,1] neg_hi:[0,1]
  v_pk_add_f32 v[202:203], v[202:203], v[116:117] op_sel_hi:[1,0] neg_lo:[0,1] neg_hi:[0,1]
  v_cvt_pk_bf16_f32 v200, 0, v200
  v_mul_f32 v135, v147, v135
  v_cvt_pk_bf16_f32 v201, 0, v201
  v_mul_f32 v136, v147, v136
  v_cvt_pk_bf16_f32 v202, 0, v202
  v_mul_f32 v137, v147, v137
  v_cvt_pk_bf16_f32 v203, 0, v203
  v_mul_f32 v138, v147, v138
  v_pk_mul_f32 v[200:201], v[200:201], v[116:117] op_sel:[0,1]
  v_mul_f32 v139, v147, v139
  v_pk_mul_f32 v[202:203], v[202:203], v[116:117] op_sel:[0,1]
  s_waitcnt vmcnt(14)
  s_cbranch_vccnz L_vw0_21
  s_waitcnt vmcnt(9)
L_vw0_21:
  buffer_load_dwordx4 v[60:63], v93, s[12:15], s61 offen offset:0 nt
  v_cvt_f32_i32 v108, v88
  v_cvt_f32_i32 v109, v89
  v_mov_b32_dpp v116, v114 row_newbcast:7 row_mask:0xf bank_mask:0xf
  v_mov_b32_dpp v117, v115 row_newbcast:7 row_mask:0xf bank_mask:0xf
  v_cvt_f32_i32 v110, v90
  v_cvt_f32_i32 v111, v91
  v_pk_add_f32 v[108:109], v[108:109], v[116:117] op_sel_hi:[1,0] neg_lo:[0,1] neg_hi:[0,1]
  v_pk_add_f32 v[110:111], v[110:111], v[116:117] op_sel_hi:[1,0] neg_lo:[0,1] neg_hi:[0,1]
  v_cvt_pk_bf16_f32 v108, 0, v108
  v_cvt_pk_bf16_f32 v109, 0, v109
  v_cvt_pk_bf16_f32 v110, 0, v110
  v_cvt_pk_bf16_f32 v111, 0, v111
  v_pk_mul_f32 v[108:109], v[108:109], v[116:117] op_sel:[0,1]
  v_pk_mul_f32 v[110:111], v[110:111], v[116:117] op_sel:[0,1]
  v_cvt_pk_bf16_f32 v207, v192, v108
  v_cvt_pk_bf16_f32 v211, v193, v109
  v_cvt_pk_bf16_f32 v215, v194, v110
  v_cvt_pk_bf16_f32 v219, v195, v111
  v_mfma_f32_16x16x32_bf16 v[128:131], v[168:171], v[204:207], v[128:131]
  v_mfma_f32_16x16x32_bf16 v[128:131], v[172:175], v[208:211], v[128:131]
  v_mfma_f32_16x16x32_bf16 v[128:131], v[176:179], v[212:215], v[128:131]
  v_mfma_f32_16x16x32_bf16 v[128:131], v[180:183], v[216:219], v[128:131]
  s_waitcnt vmcnt(14)
  buffer_load_dwordx4 v[64:67], v93, s[12:15], s61 offen offset:256 nt
  v_cvt_f32_i32 v108, v4
  v_cvt_f32_i32 v109, v5
  v_cvt_f32_i32 v110, v6
  v_cvt_f32_i32 v111, v7
  v_pk_add_f32 v[108:109], v[108:109], v[116:117] op_sel_hi:[1,0] neg_lo:[0,1] neg_hi:[0,1]
  v_pk_add_f32 v[110:111], v[110:111], v[116:117] op_sel_hi:[1,0] neg_lo:[0,1] neg_hi:[0,1]
  v_cvt_pk_bf16_f32 v108, 0, v108
  v_cvt_pk_bf16_f32 v109, 0, v109
  v_cvt_pk_bf16_f32 v110, 0, v110
  v_cvt_pk_bf16_f32 v111, 0, v111
  v_pk_mul_f32 v[108:109], v[108:109], v[116:117] op_sel:[0,1]
  v_pk_mul_f32 v[110:111], v[110:111], v[116:117] op_sel:[0,1]
  v_cvt_pk_bf16_f32 v223, v196, v108
  v_cvt_pk_bf16_f32 v227, v197, v109
  v_cvt_pk_bf16_f32 v231, v198, v110
  v_cvt_pk_bf16_f32 v235, v199, v111
  v_mfma_f32_16x16x32_bf16 v[132:135], v[168:171], v[220:223], v[132:135]
  v_mfma_f32_16x16x32_bf16 v[132:135], v[172:175], v[224:227], v[132:135]
  v_mfma_f32_16x16x32_bf16 v[132:135], v[176:179], v[228:231], v[132:135]
  v_mfma_f32_16x16x32_bf16 v[132:135], v[180:183], v[232:235], v[132:135]
  s_waitcnt vmcnt(14)
  buffer_load_dwordx4 v[68:71], v93, s[12:15], s61 offen offset:512 nt
  v_cvt_f32_i32 v108, v8
  v_cvt_f32_i32 v109, v9
  v_cvt_f32_i32 v110, v10
  v_cvt_f32_i32 v111, v11
  v_pk_add_f32 v[108:109], v[108:109], v[116:117] op_sel_hi:[1,0] neg_lo:[0,1] neg_hi:[0,1]
  v_pk_add_f32 v[110:111], v[110:111], v[116:117] op_sel_hi:[1,0] neg_lo:[0,1] neg_hi:[0,1]
  v_cvt_pk_bf16_f32 v108, 0, v108
  v_cvt_pk_bf16_f32 v109, 0, v109
  v_cvt_pk_bf16_f32 v110, 0, v110
  v_cvt_pk_bf16_f32 v111, 0, v111
  v_pk_mul_f32 v[108:109], v[108:109], v[116:117] op_sel:[0,1]
  v_pk_mul_f32 v[110:111], v[110:111], v[116:117] op_sel:[0,1]
  v_cvt_pk_bf16_f32 v239, v200, v108
  v_cvt_pk_bf16_f32 v243, v201, v109
  v_cvt_pk_bf16_f32 v247, v202, v110
  v_cvt_pk_bf16_f32 v251, v203, v111
  v_mfma_f32_16x16x32_bf16 v[136:139], v[168:171], v[236:239], v[136:139]
  v_mfma_f32_16x16x32_bf16 v[136:139], v[172:175], v[240:243], v[136:139]
  v_mfma_f32_16x16x32_bf16 v[136:139], v[176:179], v[244:247], v[136:139]
  v_mfma_f32_16x16x32_bf16 v[136:139], v[180:183], v[248:251], v[136:139]
  s_waitcnt vmcnt(14)
  s_cbranch_vccnz L_vw0_24
  s_waitcnt vmcnt(9)
L_vw0_24:
  buffer_load_dwordx4 v[72:75], v93, s[12:15], s61 offen offset:768 nt
  v_cvt_f32_i32 v192, v12
  v_cvt_f32_i32 v193, v13
  v_mov_b32_dpp v116, v114 row_newbcast:8 row_mask:0xf bank_mask:0xf
  v_mov_b32_dpp v117, v115 row_newbcast:8 row_mask:0xf bank_mask:0xf
  v_cvt_f32_i32 v194, v14
  v_cvt_f32_i32 v195, v15
  v_pk_add_f32 v[192:193], v[192:193], v[116:117] op_sel_hi:[1,0] neg_lo:[0,1] neg_hi:[0,1]
  v_pk_add_f32 v[194:195], v[194:195], v[116:117] op_sel_hi:[1,0] neg_lo:[0,1] neg_hi:[0,1]
  v_cvt_pk_bf16_f32 v192, 0, v192
  v_cndmask_b32 v184, 0, v163, s[72:73]
  v_cvt_pk_bf16_f32 v193, 0, v193
  v_cndmask_b32 v185, 0, v164, s[72:73]
  v_cvt_pk_bf16_f32 v194, 0, v194
  v_cndmask_b32 v186, 0, v163, s[74:75]
  v_cvt_pk_bf16_f32 v195, 0, v195
  v_cndmask_b32 v187, 0, v164, s[74:75]
  v_pk_mul_f32 v[192:193], v[192:193], v[116:117] op_sel:[0,1]
  v_cndmask_b32 v188, 0, v163, s[76:77]
  v_pk_mul_f32 v[194:195], v[194:195], v[116:117] op_sel:[0,1]
  s_waitcnt vmcnt(14)
  buffer_load_dwordx4 v[76:79], v93, s[12:15], s61 offen offset:1024 nt
  v_cvt_f32_i32 v196, v16
  v_cvt_f32_i32 v197, v17
  v_cvt_f32_i32 v198, v18
  v_cvt_f32_i32 v199, v19
  v_pk_add_f32 v[196:197], v[196:197], v[116:117] op_sel_hi:[1,0] neg_lo:[0,1] neg_hi:[0,1]
  v_pk_add_f32 v[198:199], v[198:199], v[116:117] op_sel_hi:[1,0] neg_lo:[0,1] neg_hi:[0,1]
  v_cvt_pk_bf16_f32 v196, 0, v196
  v_cndmask_b32 v189, 0, v164, s[76:77]
  v_cvt_pk_bf16_f32 v197, 0, v197
  v_cndmask_b32 v190, 0, v163, s[78:79]
  v_cvt_pk_bf16_f32 v198, 0, v198
  v_cndmask_b32 v191, 0, v164, s[78:79]
  v_cvt_pk_bf16_f32 v199, 0, v199
  v_pk_mul_f32 v[196:197], v[196:197], v[116:117] op_sel:[0,1]
  v_pk_mul_f32 v[198:199], v[198:199], v[116:117] op_sel:[0,1]
  s_waitcnt vmcnt(14)
  buffer_load_dwordx4 v[80:83], v93, s[12:15], s61 offen offset:1280 nt
  v_cvt_f32_i32 v200, v20
  v_cvt_f32_i32 v201, v21
  v_cvt_f32_i32 v202, v22
  v_cvt_f32_i32 v203, v23
  v_pk_add_f32 v[200:201], v[200:201], v[116:117] op_sel_hi:[1,0] neg_lo:[0,1] neg_hi:[0,1]
  v_pk_add_f32 v[202:203], v[202:203], v[116:117] op_sel_hi:[1,0] neg_lo:[0,1] neg_hi:[0,1]
  v_cvt_pk_bf16_f32 v200, 0, v200
  v_cvt_pk_bf16_f32 v201, 0, v201
  v_cvt_pk_bf16_f32 v202, 0, v202
  v_cvt_pk_bf16_f32 v203, 0, v203
  v_pk_mul_f32 v[200:201], v[200:201], v[116:117] op_sel:[0,1]
  v_pk_mul_f32 v[202:203], v[202:203], v[116:117] op_sel:[0,1]
  s_waitcnt vmcnt(14)
  s_cbranch_vccnz L_vw0_27
  s_waitcnt vmcnt(9)
L_vw0_27:
  buffer_load_dwordx4 v[84:87], v93, s[12:15], s61 offen offset:1536 nt
  v_cvt_f32_i32 v108, v24
  v_cvt_f32_i32 v109, v25
  v_mov_b32_dpp v116, v114 row_newbcast:9 row_mask:0xf bank_mask:0xf
  v_mov_b32_dpp v117, v115 row_newbcast:9 row_mask:0xf bank_mask:0xf
  v_cvt_f32_i32 v110, v26
  v_cvt_f32_i32 v111, v27
  v_pk_add_f32 v[108:109], v[108:109], v[116:117] op_sel_hi:[1,0] neg_lo:[0,1] neg_hi:[0,1]
  v_pk_add_f32 v[110:111], v[110:111], v[116:117] op_sel_hi:[1,0] neg_lo:[0,1] neg_hi:[0,1]
  v_cvt_pk_bf16_f32 v108, 0, v108
  v_cvt_pk_bf16_f32 v109, 0, v109
  v_cvt_pk_bf16_f32 v110, 0, v110
  v_cvt_pk_bf16_f32 v111, 0, v111
  v_pk_mul_f32 v[108:109], v[108:109], v[116:117] op_sel:[0,1]
  v_pk_mul_f32 v[110:111], v[110:111], v[116:117] op_sel:[0,1]
  v_cvt_pk_bf16_f32 v204, v192, v108
  v_cvt_pk_bf16_f32 v208, v193, v109
  v_cvt_pk_bf16_f32 v212, v194, v110
  v_cvt_pk_bf16_f32 v216, v195, v111
  s_waitcnt vmcnt(14)
  buffer_load_dwordx4 v[88:91], v93, s[12:15], s61 offen offset:1792 nt
  v_cvt_f32_i32 v108, v28
  v_cvt_f32_i32 v109, v29
  v_cvt_f32_i32 v110, v30
  v_cvt_f32_i32 v111, v31
  v_pk_add_f32 v[108:109], v[108:109], v[116:117] op_sel_hi:[1,0] neg_lo:[0,1] neg_hi:[0,1]
  v_pk_add_f32 v[110:111], v[110:111], v[116:117] op_sel_hi:[1,0] neg_lo:[0,1] neg_hi:[0,1]
  v_cvt_pk_bf16_f32 v108, 0, v108
  v_cvt_pk_bf16_f32 v109, 0, v109
  v_cvt_pk_bf16_f32 v110, 0, v110
  v_cvt_pk_bf16_f32 v111, 0, v111
  v_pk_mul_f32 v[108:109], v[108:109], v[116:117] op_sel:[0,1]
  v_pk_mul_f32 v[110:111], v[110:111], v[116:117] op_sel:[0,1]
  v_cvt_pk_bf16_f32 v220, v196, v108
  v_cvt_pk_bf16_f32 v224, v197, v109
  v_cvt_pk_bf16_f32 v228, v198, v110
  v_cvt_pk_bf16_f32 v232, v199, v111
  s_waitcnt vmcnt(14)
  buffer_load_dwordx4 v[4:7], v93, s[12:15], s61 offen offset:2048 nt
  v_cvt_f32_i32 v108, v32
  v_cvt_f32_i32 v109, v33
  v_cvt_f32_i32 v110, v34
  v_cvt_f32_i32 v111, v35
  v_pk_add_f32 v[108:109], v[108:109], v[116:117] op_sel_hi:[1,0] neg_lo:[0,1] neg_hi:[0,1]
  v_pk_add_f32 v[110:111], v[110:111], v[116:117] op_sel_hi:[1,0] neg_lo:[0,1] neg_hi:[0,1]
  v_cvt_pk_bf16_f32 v108, 0, v108
  v_cvt_pk_bf16_f32 v109, 0, v109
  v_cvt_pk_bf16_f32 v110, 0, v110
  v_cvt_pk_bf16_f32 v111, 0, v111
  v_pk_mul_f32 v[108:109], v[108:109], v[116:117] op_sel:[0,1]
  v_pk_mul_f32 v[110:111], v[110:111], v[116:117] op_sel:[0,1]
  v_cvt_pk_bf16_f32 v236, v200, v108
  v_cvt_pk_bf16_f32 v240, v201, v109
  v_cvt_pk_bf16_f32 v244, v202, v110
  v_cvt_pk_bf16_f32 v248, v203, v111
  s_waitcnt vmcnt(14)
  s_cbranch_vccnz L_vw0_30
  s_waitcnt vmcnt(9)
L_vw0_30:
  buffer_load_dwordx4 v[8:11], v93, s[12:15], s61 offen offset:2304 nt
  v_cvt_f32_i32 v192, v36
  v_cvt_f32_i32 v193, v37
  v_mov_b32_dpp v116, v114 row_newbcast:10 row_mask:0xf bank_mask:0xf
  v_mov_b32_dpp v117, v115 row_newbcast:10 row_mask:0xf bank_mask:0xf
  v_cvt_f32_i32 v194, v38
  v_cvt_f32_i32 v195, v39
  v_pk_add_f32 v[192:193], v[192:193], v[116:117] op_sel_hi:[1,0] neg_lo:[0,1] neg_hi:[0,1]
  v_pk_add_f32 v[194:195], v[194:195], v[116:117] op_sel_hi:[1,0] neg_lo:[0,1] neg_hi:[0,1]
  v_cvt_pk_bf16_f32 v192, 0, v192
  v_cvt_pk_bf16_f32 v193, 0, v193
  v_cvt_pk_bf16_f32 v194, 0, v194
  v_cvt_pk_bf16_f32 v195, 0, v195
  v_pk_mul_f32 v[192:193], v[192:193], v[116:117] op_sel:[0,1]
  v_pk_mul_f32 v[194:195], v[194:195], v[116:117] op_sel:[0,1]
  v_cvt_pk_bf16_f32 v205, v192, 0
  v_cvt_pk_bf16_f32 v209, v193, 0
  v_cvt_pk_bf16_f32 v213, v194, 0
  v_cvt_pk_bf16_f32 v217, v195, 0
  v_mfma_f32_16x16x16_bf16 v[128:131], v[184:185], v[204:205], v[128:131]
  v_mfma_f32_16x16x16_bf16 v[128:131], v[186:187], v[208:209], v[128:131]
  v_mfma_f32_16x16x16_bf16 v[128:131], v[188:189], v[212:213], v[128:131]
  v_mfma_f32_16x16x16_bf16 v[128:131], v[190:191], v[216:217], v[128:131]
  s_waitcnt vmcnt(14)
  buffer_load_dwordx4 v[12:15], v93, s[12:15], s61 offen offset:2560 nt
  v_cvt_f32_i32 v196, v40
  v_cvt_f32_i32 v197, v41
  v_cvt_f32_i32 v198, v42
  v_cvt_f32_i32 v199, v43
  v_pk_add_f32 v[196:197], v[196:197], v[116:117] op_sel_hi:[1,0] neg_lo:[0,1] neg_hi:[0,1]
  v_pk_add_f32 v[198:199], v[198:199], v[116:117] op_sel_hi:[1,0] neg_lo:[0,1] neg_hi:[0,1]
  v_cvt_pk_bf16_f32 v196, 0, v196
  v_cvt_pk_bf16_f32 v197, 0, v197
  v_cvt_pk_bf16_f32 v198, 0, v198
  v_cvt_pk_bf16_f32 v199, 0, v199
  v_pk_mul_f32 v[196:197], v[196:197], v[116:117] op_sel:[0,1]
  v_pk_mul_f32 v[198:199], v[198:199], v[116:117] op_sel:[0,1]
  v_cvt_pk_bf16_f32 v221, v196, 0
  v_cvt_pk_bf16_f32 v225, v197, 0
  v_cvt_pk_bf16_f32 v229, v198, 0
  v_cvt_pk_bf16_f32 v233, v199, 0
  v_mfma_f32_16x16x16_bf16 v[132:135], v[184:185], v[220:221], v[132:135]
  v_mfma_f32_16x16x16_bf16 v[132:135], v[186:187], v[224:225], v[132:135]
  v_mfma_f32_16x16x16_bf16 v[132:135], v[188:189], v[228:229], v[132:135]
  v_mfma_f32_16x16x16_bf16 v[132:135], v[190:191], v[232:233], v[132:135]
  s_waitcnt vmcnt(14)
  buffer_load_dwordx4 v[16:19], v93, s[12:15], s61 offen offset:2816 nt
  v_cvt_f32_i32 v200, v44
  v_cvt_f32_i32 v201, v45
  v_cvt_f32_i32 v202, v46
  v_cvt_f32_i32 v203, v47
  v_pk_add_f32 v[200:201], v[200:201], v[116:117] op_sel_hi:[1,0] neg_lo:[0,1] neg_hi:[0,1]
  v_pk_add_f32 v[202:203], v[202:203], v[116:117] op_sel_hi:[1,0] neg_lo:[0,1] neg_hi:[0,1]
  v_cvt_pk_bf16_f32 v200, 0, v200
  v_cvt_pk_bf16_f32 v201, 0, v201
  v_cvt_pk_bf16_f32 v202, 0, v202
  v_cvt_pk_bf16_f32 v203, 0, v203
  v_pk_mul_f32 v[200:201], v[200:201], v[116:117] op_sel:[0,1]
  v_pk_mul_f32 v[202:203], v[202:203], v[116:117] op_sel:[0,1]
  v_cvt_pk_bf16_f32 v237, v200, 0
  v_cvt_pk_bf16_f32 v241, v201, 0
  v_cvt_pk_bf16_f32 v245, v202, 0
  v_cvt_pk_bf16_f32 v249, v203, 0
  v_mfma_f32_16x16x16_bf16 v[136:139], v[184:185], v[236:237], v[136:139]
  v_mfma_f32_16x16x16_bf16 v[136:139], v[186:187], v[240:241], v[136:139]
  v_mfma_f32_16x16x16_bf16 v[136:139], v[188:189], v[244:245], v[136:139]
  v_mfma_f32_16x16x16_bf16 v[136:139], v[190:191], v[248:249], v[136:139]
  s_mov_b32 s60, s61
L_v1:
  s_add_u32 s97, s64, 96
  v_mov_b32 v146, s97
  s_mov_b32 s86, s84
  ds_write_b32 v104, v146
  s_add_u32 s64, s64, 2
  s_cmp_lt_u32 s64, s99
  s_cbranch_scc1 L_v11_ok
L_v11_spin:
  v_mov_b32 v144, 61700
  ds_read_b32 v144, v144
  s_waitcnt lgkmcnt(0)
  v_readfirstlane_b32 s99, v144
  s_nop 1
  s_cmp_lt_u32 s64, s99
  s_cbranch_scc0 L_v11_spin
L_v11_ok:
  s_lshr_b32 s71, s64, 5
  s_lshr_b32 s85, s96, s71
  s_bfe_u32 s85, s85, 0x10003
  s_and_b32 s70, s64, 31
  s_lshl_b32 s71, s71, 12
  s_add_u32 s70, s70, s5
  s_add_u32 s70, s70, s71
  s_mul_hi_u32 s84, s70, s90
  s_lshr_b32 s84, s84, 1
  s_mul_i32 s71, s84, 3
  s_sub_u32 s70, s70, s71
  s_lshl3_add_u32 s85, s70, s85
  s_mul_i32 s61, s84, 196608
  s_lshr_b32 s89, s84, 4
  s_lshl_b32 s70, s85, 5
  v_add_u32 v97, s70, v1
  v_mul_u32_u24 v97, 21846, v97
  v_lshrrev_b32 v97, 16, v97
  v_add_u32 v144, s85, v2
  v_lshrrev_b32 v145, v144, s91
  v_and_b32 v145, 1, v145
  v_cmp_eq_u32 s[54:55], 1, v145
  s_nop 1
  s_and_b64 s[52:53], s[54:55], s[58:59]
  s_andn2_b64 s[54:55], s[54:55], s[58:59]
  s_cmp_lt_u32 s64, 96
  s_cselect_b32 s61, s61, 805306368
  s_lshr_b32 s70, s64, 1
  s_cmp_eq_u32 s70, 32
  s_cselect_b32 s48, -36096, s63
  ds_read_b32 v106, v104 offset:8
  s_waitcnt vmcnt(14)
  s_cbranch_vccnz L_vw1_0
  s_waitcnt vmcnt(9)
L_vw1_0:
  buffer_load_dwordx4 v[20:23], v93, s[12:15], s60 offen offset:3072 nt
  v_mov_b32 v114, v112
  v_mov_b32 v115, v113
  v_cvt_f32_i32 v192, v48
  v_cvt_f32_i32 v193, v49
  v_mov_b32_dpp v116, v114 row_newbcast:0 row_mask:0xf bank_mask:0xf
  v_mov_b32_dpp v117, v115 row_newbcast:0 row_mask:0xf bank_mask:0xf
  v_cvt_f32_i32 v194, v50
  v_cvt_f32_i32 v195, v51
  v_pk_add_f32 v[192:193], v[192:193], v[116:117] op_sel_hi:[1,0] neg_lo:[0,1] neg_hi:[0,1]
  v_pk_add_f32 v[194:195], v[194:195], v[116:117] op_sel_hi:[1,0] neg_lo:[0,1] neg_hi:[0,1]
  v_cvt_pk_bf16_f32 v192, 0, v192
  v_cvt_pk_bf16_f32 v193, 0, v193
  v_cvt_pk_bf16_f32 v194, 0, v194
  v_cvt_pk_bf16_f32 v195, 0, v195
  v_pk_mul_f32 v[192:193], v[192:193], v[116:117] op_sel:[0,1]
  v_pk_mul_f32 v[194:195], v[194:195], v[116:117] op_sel:[0,1]
  s_waitcnt lgkmcnt(0)
  v_cmp_lt_u32 vcc, s97, v106
  s_waitcnt vmcnt(14)
  buffer_load_dwordx4 v[24:27], v93, s[12:15], s60 offen offset:3328 nt
  v_cvt_f32_i32 v196, v52
  v_cvt_f32_i32 v197, v53
  v_cvt_f32_i32 v198, v54
  v_cvt_f32_i32 v199, v55
  v_pk_add_f32 v[196:197], v[196:197], v[116:117] op_sel_hi:[1,0] neg_lo:[0,1] neg_hi:[0,1]
  v_pk_add_f32 v[198:199], v[198:199], v[116:117] op_sel_hi:[1,0] neg_lo:[0,1] neg_hi:[0,1]
  v_cvt_pk_bf16_f32 v196, 0, v196
  v_lshlrev_b32 v148, 16, v120
  v_cvt_pk_bf16_f32 v197, 0, v197
  v_and_b32 v149, s65, v120
  v_cvt_pk_bf16_f32 v198, 0, v198
  v_lshlrev_b32 v150, 16, v121
  v_cvt_pk_bf16_f32 v199, 0, v199
  v_and_b32 v151, s65, v121
  v_pk_mul_f32 v[196:197], v[196:197], v[116:117] op_sel:[0,1]
  v_lshlrev_b32 v152, 16, v122
  v_pk_mul_f32 v[198:199], v[198:199], v[116:117] op_sel:[0,1]
  s_waitcnt vmcnt(14)
  buffer_load_dwordx4 v[28:31], v93, s[12:15], s60 offen offset:3584 nt
  v_cvt_f32_i32 v200, v56
  v_cvt_f32_i32 v201, v57
  v_cvt_f32_i32 v202, v58
  v_cvt_f32_i32 v203, v59
  v_pk_add_f32 v[200:201], v[200:201], v[116:117] op_sel_hi:[1,0] neg_lo:[0,1] neg_hi:[0,1]
  v_pk_add_f32 v[202:203], v[202:203], v[116:117] op_sel_hi:[1,0] neg_lo:[0,1] neg_hi:[0,1]
  v_cvt_pk_bf16_f32 v200, 0, v200
  v_and_b32 v153, s65, v122
  v_cvt_pk_bf16_f32 v201, 0, v201
  v_lshlrev_b32 v154, 16, v123
  v_cvt_pk_bf16_f32 v202, 0, v202
  v_and_b32 v155, s65, v123
  v_cvt_pk_bf16_f32 v203, 0, v203
  v_lshlrev_b32 v156, 16, v124
  v_pk_mul_f32 v[200:201], v[200:201], v[116:117] op_sel:[0,1]
  v_and_b32 v157, s65, v124
  v_pk_mul_f32 v[202:203], v[202:203], v[116:117] op_sel:[0,1]
  s_waitcnt vmcnt(14)
  s_cbranch_vccnz L_vw1_3
  s_waitcnt vmcnt(9)
L_vw1_3:
  buffer_load_dwordx4 v[32:35], v94, s[12:15], s60 offen offset:0 nt
  v_cvt_f32_i32 v108, v60
  v_cvt_f32_i32 v109, v61
  v_mov_b32_dpp v116, v114 row_newbcast:1 row_mask:0xf bank_mask:0xf
  v_mov_b32_dpp v117, v115 row_newbcast:1 row_mask:0xf bank_mask:0xf
  v_cvt_f32_i32 v110, v62
  v_cvt_f32_i32 v111, v63
  v_pk_add_f32 v[108:109], v[108:109], v[116:117] op_sel_hi:[1,0] neg_lo:[0,1] neg_hi:[0,1]
  v_pk_add_f32 v[110:111], v[110:111], v[116:117] op_sel_hi:[1,0] neg_lo:[0,1] neg_hi:[0,1]
  s_lshl_b32 s62, s84, 9
  v_lshl_add_u32 v98, v97, 1, v96
  buffer_load_short_d16_hi v112, v98, s[32:35], s62 offen
  buffer_load_short_d16_hi v113, v98, s[28:31], s62 offen
  v_cvt_pk_bf16_f32 v108, 0, v108
  v_lshlrev_b32 v158, 16, v125
  v_cvt_pk_bf16_f32 v109, 0, v109
  v_add_u32 v99, s48, v99
  v_cvt_pk_bf16_f32 v110, 0, v110
  v_add_u32 v100, s48, v100
  v_cvt_pk_bf16_f32 v111, 0, v111
  v_max3_f32 v144, v148, v149, v150
  v_pk_mul_f32 v[108:109], v[108:109], v[116:117] op_sel:[0,1]
  ds_read_b128 v[120:123], v99
  v_pk_mul_f32 v[110:111], v[110:111], v[116:117] op_sel:[0,1]
  v_cvt_pk_bf16_f32 v204, v192, v108
  v_cvt_pk_bf16_f32 v208, v193, v109
  v_cvt_pk_bf16_f32 v212, v194, v110
  v_cvt_pk_bf16_f32 v216, v195, v111
  s_waitcnt vmcnt(16)
  buffer_load_dwordx4 v[36:39], v94, s[12:15], s60 offen offset:256 nt
  v_cvt_f32_i32 v108, v64
  v_cvt_f32_i32 v109, v65
  v_cvt_f32_i32 v110, v66
  v_cvt_f32_i32 v111, v67
  v_pk_add_f32 v[108:109], v[108:109], v[116:117] op_sel_hi:[1,0] neg_lo:[0,1] neg_hi:[0,1]
  v_pk_add_f32 v[110:111], v[110:111], v[116:117] op_sel_hi:[1,0] neg_lo:[0,1] neg_hi:[0,1]
  v_cvt_pk_bf16_f32 v108, 0, v108
  ds_read_b64 v[124:125], v100 offset:256
  v_cvt_pk_bf16_f32 v109, 0, v109
  v_max3_f32 v145, v151, v152, v153
  v_cvt_pk_bf16_f32 v110, 0, v110
  v_max3_f32 v144, v144, v154, v155
  v_cvt_pk_bf16_f32 v111, 0, v111
  v_max3_f32 v145, v145, v156, v157
  v_pk_mul_f32 v[108:109], v[108:109], v[116:117] op_sel:[0,1]
  v_max3_f32 v144, v144, v158, v140
  v_pk_mul_f32 v[110:111], v[110:111], v[116:117] op_sel:[0,1]
  v_cvt_pk_bf16_f32 v220, v196, v108
  v_cvt_pk_bf16_f32 v224, v197, v109
  v_cvt_pk_bf16_f32 v228, v198, v110
  v_cvt_pk_bf16_f32 v232, v199, v111
  s_waitcnt vmcnt(16)
  buffer_load_dwordx4 v[40:43], v94, s[12:15], s60 offen offset:512 nt
  v_cvt_f32_i32 v108, v68
  v_cvt_f32_i32 v109, v69
  v_cvt_f32_i32 v110, v70
  v_cvt_f32_i32 v111, v71
  v_pk_add_f32 v[108:109], v[108:109], v[116:117] op_sel_hi:[1,0] neg_lo:[0,1] neg_hi:[0,1]
  v_pk_add_f32 v[110:111], v[110:111], v[116:117] op_sel_hi:[1,0] neg_lo:[0,1] neg_hi:[0,1]
  v_cvt_pk_bf16_f32 v108, 0, v108
  v_max_f32 v144, v144, v145
  v_cvt_pk_bf16_f32 v109, 0, v109
  v_mov_b32 v145, v144
  v_cvt_pk_bf16_f32 v110, 0, v110
  s_nop 0
  v_permlane32_swap_b32 v144, v145
  v_cvt_pk_bf16_f32 v111, 0, v111
  v_max_f32 v144, v144, v145
  v_pk_mul_f32 v[108:109], v[108:109], v[116:117] op_sel:[0,1]
  v_mov_b32 v145, v144
  v_pk_mul_f32 v[110:111], v[110:111], v[116:117] op_sel:[0,1]
  v_cvt_pk_bf16_f32 v236, v200, v108
  v_cvt_pk_bf16_f32 v240, v201, v109
  v_cvt_pk_bf16_f32 v244, v202, v110
  v_cvt_pk_bf16_f32 v248, v203, v111
  s_waitcnt vmcnt(16)
  s_cbranch_vccnz L_vw1_6
  s_waitcnt vmcnt(11)
L_vw1_6:
  buffer_load_dwordx4 v[44:47], v94, s[12:15], s60 offen offset:768 nt
  v_cvt_f32_i32 v192, v72
  v_cvt_f32_i32 v193, v73
  v_mov_b32_dpp v116, v114 row_newbcast:2 row_mask:0xf bank_mask:0xf
  v_mov_b32_dpp v117, v115 row_newbcast:2 row_mask:0xf bank_mask:0xf
  v_cvt_f32_i32 v194, v74
  v_cvt_f32_i32 v195, v75
  v_pk_add_f32 v[192:193], v[192:193], v[116:117] op_sel_hi:[1,0] neg_lo:[0,1] neg_hi:[0,1]
  v_pk_add_f32 v[194:195], v[194:195], v[116:117] op_sel_hi:[1,0] neg_lo:[0,1] neg_hi:[0,1]
  v_cvt_pk_bf16_f32 v192, 0, v192
  v_permlane16_swap_b32 v144, v145
  v_cvt_pk_bf16_f32 v193, 0, v193
  v_max_f32 v140, v144, v145
  v_cvt_pk_bf16_f32 v194, 0, v194
  v_mul_f32 v144, s66, v140
  v_cvt_pk_bf16_f32 v195, 0, v195
  v_add_f32 v146, v144, v142
  v_pk_mul_f32 v[192:193], v[192:193], v[116:117] op_sel:[0,1]
  v_sub_f32 v142, 0, v144
  v_pk_mul_f32 v[194:195], v[194:195], v[116:117] op_sel:[0,1]
  s_waitcnt vmcnt(16)
  buffer_load_dwordx4 v[48:51], v94, s[12:15], s60 offen offset:1024 nt
  v_cvt_f32_i32 v196, v76
  v_cvt_f32_i32 v197, v77
  v_cvt_f32_i32 v198, v78
  v_cvt_f32_i32 v199, v79
  v_pk_add_f32 v[196:197], v[196:197], v[116:117] op_sel_hi:[1,0] neg_lo:[0,1] neg_hi:[0,1]
  v_pk_add_f32 v[198:199], v[198:199], v[116:117] op_sel_hi:[1,0] neg_lo:[0,1] neg_hi:[0,1]
  v_cvt_pk_bf16_f32 v196, 0, v196
  v_exp_f32 v146, -v146
  v_cvt_pk_bf16_f32 v197, 0, v197
  ds_bpermute_b32 v147, v101, v146
  v_cvt_pk_bf16_f32 v198, 0, v198
  v_fma_f32 v148, v148, s66, v142
  v_cvt_pk_bf16_f32 v199, 0, v199
  v_exp_f32 v148, v148
  v_pk_mul_f32 v[196:197], v[196:197], v[116:117] op_sel:[0,1]
  v_fma_f32 v149, v149, s66, v142
  v_pk_mul_f32 v[198:199], v[198:199], v[116:117] op_sel:[0,1]
  s_waitcnt vmcnt(16)
  buffer_load_dwordx4 v[52:55], v94, s[12:15], s60 offen offset:1280 nt
  v_cvt_f32_i32 v200, v80
  v_cvt_f32_i32 v201, v81
  v_cvt_f32_i32 v202, v82
  v_cvt_f32_i32 v203, v83
  v_pk_add_f32 v[200:201], v[200:201], v[116:117] op_sel_hi:[1,0] neg_lo:[0,1] neg_hi:[0,1]
  v_pk_add_f32 v[202:203], v[202:203], v[116:117] op_sel_hi:[1,0] neg_lo:[0,1] neg_hi:[0,1]
  v_cvt_pk_bf16_f32 v200, 0, v200
  v_exp_f32 v149, v149
  v_cvt_pk_bf16_f32 v201, 0, v201
  v_fma_f32 v150, v150, s66, v142
  v_cvt_pk_bf16_f32 v202, 0, v202
  v_exp_f32 v150, v150
  v_cvt_pk_bf16_f32 v203, 0, v203
  v_fma_f32 v151, v151, s66, v142
  v_pk_mul_f32 v[200:201], v[200:201], v[116:117] op_sel:[0,1]
  v_exp_f32 v151, v151
  v_pk_mul_f32 v[202:203], v[202:203], v[116:117] op_sel:[0,1]
  s_waitcnt vmcnt(16)
  s_cbranch_vccnz L_vw1_9
  s_waitcnt vmcnt(11)
L_vw1_9:
  buffer_load_dwordx4 v[56:59], v94, s[12:15], s60 offen offset:1536 nt
  v_cvt_f32_i32 v108, v84
  v_cvt_f32_i32 v109, v85
  v_mov_b32_dpp v116, v114 row_newbcast:3 row_mask:0xf bank_mask:0xf
  v_mov_b32_dpp v117, v115 row_newbcast:3 row_mask:0xf bank_mask:0xf
  v_cvt_f32_i32 v110, v86
  v_cvt_f32_i32 v111, v87
  v_pk_add_f32 v[108:109], v[108:109], v[116:117] op_sel_hi:[1,0] neg_lo:[0,1] neg_hi:[0,1]
  v_pk_add_f32 v[110:111], v[110:111], v[116:117] op_sel_hi:[1,0] neg_lo:[0,1] neg_hi:[0,1]
  v_cvt_pk_bf16_f32 v108, 0, v108
  v_fma_f32 v152, v152, s66, v142
  v_cvt_pk_bf16_f32 v109, 0, v109
  v_exp_f32 v152, v152
  v_cvt_pk_bf16_f32 v110, 0, v110
  v_fma_f32 v153, v153, s66, v142
  v_cvt_pk_bf16_f32 v111, 0, v111
  v_exp_f32 v153, v153
  v_pk_mul_f32 v[108:109], v[108:109], v[116:117] op_sel:[0,1]
  v_fma_f32 v154, v154, s66, v142
  v_pk_mul_f32 v[110:111], v[110:111], v[116:117] op_sel:[0,1]
  v_cvt_pk_bf16_f32 v205, v192, v108
  v_cvt_pk_bf16_f32 v209, v193, v109
  v_cvt_pk_bf16_f32 v213, v194, v110
  v_cvt_pk_bf16_f32 v217, v195, v111
  s_waitcnt vmcnt(16)
  buffer_load_dwordx4 v[60:63], v94, s[12:15], s60 offen offset:1792 nt
  v_cvt_f32_i32 v108, v88
  v_cvt_f32_i32 v109, v89
  v_cvt_f32_i32 v110, v90
  v_cvt_f32_i32 v111, v91
  v_pk_add_f32 v[108:109], v[108:109], v[116:117] op_sel_hi:[1,0] neg_lo:[0,1] neg_hi:[0,1]
  v_pk_add_f32 v[110:111], v[110:111], v[116:117] op_sel_hi:[1,0] neg_lo:[0,1] neg_hi:[0,1]
  v_cvt_pk_bf16_f32 v108, 0, v108
  v_exp_f32 v154, v154
  v_cvt_pk_bf16_f32 v109, 0, v109
  v_fma_f32 v155, v155, s66, v142
  v_cvt_pk_bf16_f32 v110, 0, v110
  v_exp_f32 v155, v155
  v_cvt_pk_bf16_f32 v111, 0, v111
  v_fma_f32 v156, v156, s66, v142
  v_pk_mul_f32 v[108:109], v[108:109], v[116:117] op_sel:[0,1]
  v_exp_f32 v156, v156
  v_pk_mul_f32 v[110:111], v[110:111], v[116:117] op_sel:[0,1]
  v_cvt_pk_bf16_f32 v221, v196, v108
  v_cvt_pk_bf16_f32 v225, v197, v109
  v_cvt_pk_bf16_f32 v229, v198, v110
  v_cvt_pk_bf16_f32 v233, v199, v111
  s_waitcnt vmcnt(16)
  buffer_load_dwordx4 v[64:67], v94, s[12:15], s60 offen offset:2048 nt
  v_cvt_f32_i32 v108, v4
  v_cvt_f32_i32 v109, v5
  v_cvt_f32_i32 v110, v6
  v_cvt_f32_i32 v111, v7
  v_pk_add_f32 v[108:109], v[108:109], v[116:117] op_sel_hi:[1,0] neg_lo:[0,1] neg_hi:[0,1]
  v_pk_add_f32 v[110:111], v[110:111], v[116:117] op_sel_hi:[1,0] neg_lo:[0,1] neg_hi:[0,1]
  v_cvt_pk_bf16_f32 v108, 0, v108
  v_fma_f32 v157, v157, s66, v142
  v_cvt_pk_bf16_f32 v109, 0, v109
  v_exp_f32 v157, v157
  v_cvt_pk_bf16_f32 v110, 0, v110
  v_fma_f32 v158, v158, s66, v142
  v_cvt_pk_bf16_f32 v111, 0, v111
  v_exp_f32 v158, v158
  v_pk_mul_f32 v[108:109], v[108:109], v[116:117] op_sel:[0,1]
  v_add_f32 v144, v148, v149
  v_pk_mul_f32 v[110:111], v[110:111], v[116:117] op_sel:[0,1]
  v_cvt_pk_bf16_f32 v237, v200, v108
  v_cvt_pk_bf16_f32 v241, v201, v109
  v_cvt_pk_bf16_f32 v245, v202, v110
  v_cvt_pk_bf16_f32 v249, v203, v111
  s_waitcnt vmcnt(16)
  s_cbranch_vccnz L_vw1_12
  s_waitcnt vmcnt(11)
L_vw1_12:
  buffer_load_dwordx4 v[68:71], v94, s[12:15], s60 offen offset:2304 nt
  v_cvt_f32_i32 v192, v8
  v_cvt_f32_i32 v193, v9
  v_mov_b32_dpp v116, v114 row_newbcast:4 row_mask:0xf bank_mask:0xf
  v_mov_b32_dpp v117, v115 row_newbcast:4 row_mask:0xf bank_mask:0xf
  v_cvt_f32_i32 v194, v10
  v_cvt_f32_i32 v195, v11
  v_pk_add_f32 v[192:193], v[192:193], v[116:117] op_sel_hi:[1,0] neg_lo:[0,1] neg_hi:[0,1]
  v_pk_add_f32 v[194:195], v[194:195], v[116:117] op_sel_hi:[1,0] neg_lo:[0,1] neg_hi:[0,1]
  v_cvt_pk_bf16_f32 v192, 0, v192
  v_add_f32 v145, v150, v151
  v_cvt_pk_bf16_f32 v193, 0, v193
  v_add_f32 v144, v144, v152
  v_cvt_pk_bf16_f32 v194, 0, v194
  v_add_f32 v145, v145, v153
  v_cvt_pk_bf16_f32 v195, 0, v195
  v_add_f32 v144, v144, v154
  v_pk_mul_f32 v[192:193], v[192:193], v[116:117] op_sel:[0,1]
  v_add_f32 v145, v145, v155
  v_pk_mul_f32 v[194:195], v[194:195], v[116:117] op_sel:[0,1]
  s_waitcnt vmcnt(16)
  buffer_load_dwordx4 v[72:75], v94, s[12:15], s60 offen offset:2560 nt
  v_cvt_f32_i32 v196, v12
  v_cvt_f32_i32 v197, v13
  v_cvt_f32_i32 v198, v14
  v_cvt_f32_i32 v199, v15
  v_pk_add_f32 v[196:197], v[196:197], v[116:117] op_sel_hi:[1,0] neg_lo:[0,1] neg_hi:[0,1]
  v_pk_add_f32 v[198:199], v[198:199], v[116:117] op_sel_hi:[1,0] neg_lo:[0,1] neg_hi:[0,1]
  v_cvt_pk_bf16_f32 v196, 0, v196
  v_add_f32 v144, v144, v156
  v_cvt_pk_bf16_f32 v197, 0, v197
  v_add_f32 v145, v145, v157
  v_cvt_pk_bf16_f32 v198, 0, v198
  v_add_f32 v144, v144, v158
  v_cvt_pk_bf16_f32 v199, 0, v199
  v_add_f32 v144, v144, v145
  v_pk_mul_f32 v[196:197], v[196:197], v[116:117] op_sel:[0,1]
  v_fma_f32 v143, v143, v146, v144
  v_pk_mul_f32 v[198:199], v[198:199], v[116:117] op_sel:[0,1]
  s_waitcnt vmcnt(16)
  buffer_load_dwordx4 v[76:79], v94, s[12:15], s60 offen offset:2816 nt
  v_cvt_f32_i32 v200, v16
  v_cvt_f32_i32 v201, v17
  v_cvt_f32_i32 v202, v18
  v_cvt_f32_i32 v203, v19
  v_pk_add_f32 v[200:201], v[200:201], v[116:117] op_sel_hi:[1,0] neg_lo:[0,1] neg_hi:[0,1]
  v_pk_add_f32 v[202:203], v[202:203], v[116:117] op_sel_hi:[1,0] neg_lo:[0,1] neg_hi:[0,1]
  v_cvt_pk_bf16_f32 v200, 0, v200
  v_cvt_pk_bf16_f32 v159, v148, v149
  v_cvt_pk_bf16_f32 v201, 0, v201
  v_cvt_pk_bf16_f32 v160, v150, v151
  v_cvt_pk_bf16_f32 v202, 0, v202
  v_cvt_pk_bf16_f32 v161, v152, v153
  v_cvt_pk_bf16_f32 v203, 0, v203
  v_cvt_pk_bf16_f32 v162, v154, v155
  v_pk_mul_f32 v[200:201], v[200:201], v[116:117] op_sel:[0,1]
  v_cvt_pk_bf16_f32 v163, v156, v157
  v_pk_mul_f32 v[202:203], v[202:203], v[116:117] op_sel:[0,1]
  s_waitcnt vmcnt(16)
  s_cbranch_vccnz L_vw1_15
  s_waitcnt vmcnt(9)
L_vw1_15:
  buffer_load_dwordx4 v[80:83], v95, s[12:15], s60 offen offset:0 nt
  v_cvt_f32_i32 v108, v20
  v_cvt_f32_i32 v109, v21
  v_mov_b32_dpp v116, v114 row_newbcast:5 row_mask:0xf bank_mask:0xf
  v_mov_b32_dpp v117, v115 row_newbcast:5 row_mask:0xf bank_mask:0xf
  v_cvt_f32_i32 v110, v22
  v_cvt_f32_i32 v111, v23
  v_pk_add_f32 v[108:109], v[108:109], v[116:117] op_sel_hi:[1,0] neg_lo:[0,1] neg_hi:[0,1]
  v_pk_add_f32 v[110:111], v[110:111], v[116:117] op_sel_hi:[1,0] neg_lo:[0,1] neg_hi:[0,1]
  v_cvt_pk_bf16_f32 v108, 0, v108
  v_cvt_pk_bf16_f32 v164, v158, 0
  v_cvt_pk_bf16_f32 v109, 0, v109
  v_cndmask_b32 v168, 0, v159, s[72:73]
  v_cvt_pk_bf16_f32 v110, 0, v110
  v_cndmask_b32 v169, 0, v160, s[72:73]
  v_cvt_pk_bf16_f32 v111, 0, v111
  v_cndmask_b32 v170, 0, v161, s[72:73]
  v_pk_mul_f32 v[108:109], v[108:109], v[116:117] op_sel:[0,1]
  v_cndmask_b32 v171, 0, v162, s[72:73]
  v_pk_mul_f32 v[110:111], v[110:111], v[116:117] op_sel:[0,1]
  v_cvt_pk_bf16_f32 v206, v192, v108
  v_cvt_pk_bf16_f32 v210, v193, v109
  v_cvt_pk_bf16_f32 v214, v194, v110
  v_cvt_pk_bf16_f32 v218, v195, v111
  s_waitcnt vmcnt(16)
  buffer_load_dwordx4 v[84:87], v95, s[12:15], s60 offen offset:256 nt
  v_cvt_f32_i32 v108, v24
  v_cvt_f32_i32 v109, v25
  v_cvt_f32_i32 v110, v26
  v_cvt_f32_i32 v111, v27
  v_pk_add_f32 v[108:109], v[108:109], v[116:117] op_sel_hi:[1,0] neg_lo:[0,1] neg_hi:[0,1]
  v_pk_add_f32 v[110:111], v[110:111], v[116:117] op_sel_hi:[1,0] neg_lo:[0,1] neg_hi:[0,1]
  v_cvt_pk_bf16_f32 v108, 0, v108
  v_cndmask_b32 v172, 0, v159, s[74:75]
  v_cvt_pk_bf16_f32 v109, 0, v109
  v_cndmask_b32 v173, 0, v160, s[74:75]
  v_cvt_pk_bf16_f32 v110, 0, v110
  v_cndmask_b32 v174, 0, v161, s[74:75]
  v_cvt_pk_bf16_f32 v111, 0, v111
  v_cndmask_b32 v175, 0, v162, s[74:75]
  v_pk_mul_f32 v[108:109], v[108:109], v[116:117] op_sel:[0,1]
  v_cndmask_b32 v176, 0, v159, s[76:77]
  v_pk_mul_f32 v[110:111], v[110:111], v[116:117] op_sel:[0,1]
  v_cvt_pk_bf16_f32 v222, v196, v108
  v_cvt_pk_bf16_f32 v226, v197, v109
  v_cvt_pk_bf16_f32 v230, v198, v110
  v_cvt_pk_bf16_f32 v234, v199, v111
  s_waitcnt vmcnt(16)
  buffer_load_dwordx4 v[88:91], v95, s[12:15], s60 offen offset:512 nt
  v_cvt_f32_i32 v108, v28
  v_cvt_f32_i32 v109, v29
  v_cvt_f32_i32 v110, v30
  v_cvt_f32_i32 v111, v31
  v_pk_add_f32 v[108:109], v[108:109], v[116:117] op_sel_hi:[1,0] neg_lo:[0,1] neg_hi:[0,1]
  v_pk_add_f32 v[110:111], v[110:111], v[116:117] op_sel_hi:[1,0] neg_lo:[0,1] neg_hi:[0,1]
  v_cvt_pk_bf16_f32 v108, 0, v108
  v_cndmask_b32 v177, 0, v160, s[76:77]
  v_cvt_pk_bf16_f32 v109, 0, v109
  v_cndmask_b32 v178, 0, v161, s[76:77]
  v_cvt_pk_bf16_f32 v110, 0, v110
  v_cndmask_b32 v179, 0, v162, s[76:77]
  v_cvt_pk_bf16_f32 v111, 0, v111
  v_cndmask_b32 v180, 0, v159, s[78:79]
  v_pk_mul_f32 v[108:109], v[108:109], v[116:117] op_sel:[0,1]
  v_cndmask_b32 v181, 0, v160, s[78:79]
  v_pk_mul_f32 v[110:111], v[110:111], v[116:117] op_sel:[0,1]
  v_cvt_pk_bf16_f32 v238, v200, v108
  v_cvt_pk_bf16_f32 v242, v201, v109
  v_cvt_pk_bf16_f32 v246, v202, v110
  v_cvt_pk_bf16_f32 v250, v203, v111
  v_mad_u32_u24 v92, v97, s63, v3
  v_add_u32 v93, 768, v92
  v_add_u32 v94, 4608, v92
  v_add_u32 v95, 7680, v92
  v_cndmask_b32 v92, v92, v105, s[52:53]
  v_cndmask_b32 v95, v95, v105, s[54:55]
  s_waitcnt vmcnt(16)
  s_cbranch_vccnz L_vw1_18
  s_waitcnt vmcnt(9)
L_vw1_18:
  buffer_load_dwordx4 v[4:7], v92, s[12:15], s61 offen offset:0 nt
  v_cvt_f32_i32 v192, v32
  v_cvt_f32_i32 v193, v33
  v_mov_b32_dpp v116, v114 row_newbcast:6 row_mask:0xf bank_mask:0xf
  v_mov_b32_dpp v117, v115 row_newbcast:6 row_mask:0xf bank_mask:0xf
  v_cvt_f32_i32 v194, v34
  v_cvt_f32_i32 v195, v35
  v_pk_add_f32 v[192:193], v[192:193], v[116:117] op_sel_hi:[1,0] neg_lo:[0,1] neg_hi:[0,1]
  v_pk_add_f32 v[194:195], v[194:195], v[116:117] op_sel_hi:[1,0] neg_lo:[0,1] neg_hi:[0,1]
  v_cvt_pk_bf16_f32 v192, 0, v192
  v_cndmask_b32 v182, 0, v161, s[78:79]
  v_cvt_pk_bf16_f32 v193, 0, v193
  v_cndmask_b32 v183, 0, v162, s[78:79]
  v_cvt_pk_bf16_f32 v194, 0, v194
  s_waitcnt lgkmcnt(0)
  v_cvt_pk_bf16_f32 v195, 0, v195
  v_mul_f32 v128, v147, v128
  v_pk_mul_f32 v[192:193], v[192:193], v[116:117] op_sel:[0,1]
  v_mul_f32 v129, v147, v129
  v_pk_mul_f32 v[194:195], v[194:195], v[116:117] op_sel:[0,1]
  s_waitcnt vmcnt(14)
  buffer_load_dwordx4 v[8:11], v92, s[12:15], s61 offen offset:256 nt
  v_cvt_f32_i32 v196, v36
  v_cvt_f32_i32 v197, v37
  v_cvt_f32_i32 v198, v38
  v_cvt_f32_i32 v199, v39
  v_pk_add_f32 v[196:197], v[196:197], v[116:117] op_sel_hi:[1,0] neg_lo:[0,1] neg_hi:[0,1]
  v_pk_add_f32 v[198:199], v[198:199], v[116:117] op_sel_hi:[1,0] neg_lo:[0,1] neg_hi:[0,1]
  v_cvt_pk_bf16_f32 v196, 0, v196
  v_mul_f32 v130, v147, v130
  v_cvt_pk_bf16_f32 v197, 0, v197
  v_mul_f32 v131, v147, v131
  v_cvt_pk_bf16_f32 v198, 0, v198
  v_mul_f32 v132, v147, v132
  v_cvt_pk_bf16_f32 v199, 0, v199
  v_mul_f32 v133, v147, v133
  v_pk_mul_f32 v[196:197], v[196:197], v[116:117] op_sel:[0,1]
  v_mul_f32 v134, v147, v134
  v_pk_mul_f32 v[198:199], v[198:199], v[116:117] op_sel:[0,1]
  s_waitcnt vmcnt(14)
  buffer_load_dwordx4 v[12:15], v92, s[12:15], s61 offen offset:512 nt
  v_cvt_f32_i32 v200, v40
  v_cvt_f32_i32 v201, v41
  v_cvt_f32_i32 v202, v42
  v_cvt_f32_i32 v203, v43
  v_pk_add_f32 v[200:201], v[200:201], v[116:117] op_sel_hi:[1,0] neg_lo:[0,1] neg_hi:[0,1]
  v_pk_add_f32 v[202:203], v[202:203], v[116:117] op_sel_hi:[1,0] neg_lo:[0,1] neg_hi:[0,1]
  v_cvt_pk_bf16_f32 v200, 0, v200
  v_mul_f32 v135, v147, v135
  v_cvt_pk_bf16_f32 v201, 0, v201
  v_mul_f32 v136, v147, v136
  v_cvt_pk_bf16_f32 v202, 0, v202
  v_mul_f32 v137, v147, v137
  v_cvt_pk_bf16_f32 v203, 0, v203
  v_mul_f32 v138, v147, v138
  v_pk_mul_f32 v[200:201], v[200:201], v[116:117] op_sel:[0,1]
  v_mul_f32 v139, v147, v139
  v_pk_mul_f32 v[202:203], v[202:203], v[116:117] op_sel:[0,1]
  s_waitcnt vmcnt(14)
  s_cbranch_vccnz L_vw1_21
  s_waitcnt vmcnt(9)
L_vw1_21:
  buffer_load_dwordx4 v[16:19], v93, s[12:15], s61 offen offset:0 nt
  v_cvt_f32_i32 v108, v44
  v_cvt_f32_i32 v109, v45
  v_mov_b32_dpp v116, v114 row_newbcast:7 row_mask:0xf bank_mask:0xf
  v_mov_b32_dpp v117, v115 row_newbcast:7 row_mask:0xf bank_mask:0xf
  v_cvt_f32_i32 v110, v46
  v_cvt_f32_i32 v111, v47
  v_pk_add_f32 v[108:109], v[108:109], v[116:117] op_sel_hi:[1,0] neg_lo:[0,1] neg_hi:[0,1]
  v_pk_add_f32 v[110:111], v[110:111], v[116:117] op_sel_hi:[1,0] neg_lo:[0,1] neg_hi:[0,1]
  v_cvt_pk_bf16_f32 v108, 0, v108
  v_cvt_pk_bf16_f32 v109, 0, v109
  v_cvt_pk_bf16_f32 v110, 0, v110
  v_cvt_pk_bf16_f32 v111, 0, v111
  v_pk_mul_f32 v[108:109], v[108:109], v[116:117] op_sel:[0,1]
  v_pk_mul_f32 v[110:111], v[110:111], v[116:117] op_sel:[0,1]
  v_cvt_pk_bf16_f32 v207, v192, v108
  v_cvt_pk_bf16_f32 v211, v193, v109
  v_cvt_pk_bf16_f32 v215, v194, v110
  v_cvt_pk_bf16_f32 v219, v195, v111
  v_mfma_f32_16x16x32_bf16 v[128:131], v[168:171], v[204:207], v[128:131]
  v_mfma_f32_16x16x32_bf16 v[128:131], v[172:175], v[208:211], v[128:131]
  v_mfma_f32_16x16x32_bf16 v[128:131], v[176:179], v[212:215], v[128:131]
  v_mfma_f32_16x16x32_bf16 v[128:131], v[180:183], v[216:219], v[128:131]
  s_waitcnt vmcnt(14)
  buffer_load_dwordx4 v[20:23], v93, s[12:15], s61 offen offset:256 nt
  v_cvt_f32_i32 v108, v48
  v_cvt_f32_i32 v109, v49
  v_cvt_f32_i32 v110, v50
  v_cvt_f32_i32 v111, v51
  v_pk_add_f32 v[108:109], v[108:109], v[116:117] op_sel_hi:[1,0] neg_lo:[0,1] neg_hi:[0,1]
  v_pk_add_f32 v[110:111], v[110:111], v[116:117] op_sel_hi:[1,0] neg_lo:[0,1] neg_hi:[0,1]
  v_cvt_pk_bf16_f32 v108, 0, v108
  v_cvt_pk_bf16_f32 v109, 0, v109
  v_cvt_pk_bf16_f32 v110, 0, v110
  v_cvt_pk_bf16_f32 v111, 0, v111
  v_pk_mul_f32 v[108:109], v[108:109], v[116:117] op_sel:[0,1]
  v_pk_mul_f32 v[110:111], v[110:111], v[116:117] op_sel:[0,1]
  v_cvt_pk_bf16_f32 v223, v196, v108
  v_cvt_pk_bf16_f32 v227, v197, v109
  v_cvt_pk_bf16_f32 v231, v198, v110
  v_cvt_pk_bf16_f32 v235, v199, v111
  v_mfma_f32_16x16x32_bf16 v[132:135], v[168:171], v[220:223], v[132:135]
  v_mfma_f32_16x16x32_bf16 v[132:135], v[172:175], v[224:227], v[132:135]
  v_mfma_f32_16x16x32_bf16 v[132:135], v[176:179], v[228:231], v[132:135]
  v_mfma_f32_16x16x32_bf16 v[132:135], v[180:183], v[232:235], v[132:135]
  s_waitcnt vmcnt(14)
  buffer_load_dwordx4 v[24:27], v93, s[12:15], s61 offen offset:512 nt
  v_cvt_f32_i32 v108, v52
  v_cvt_f32_i32 v109, v53
  v_cvt_f32_i32 v110, v54
  v_cvt_f32_i32 v111, v55
  v_pk_add_f32 v[108:109], v[108:109], v[116:117] op_sel_hi:[1,0] neg_lo:[0,1] neg_hi:[0,1]
  v_pk_add_f32 v[110:111], v[110:111], v[116:117] op_sel_hi:[1,0] neg_lo:[0,1] neg_hi:[0,1]
  v_cvt_pk_bf16_f32 v108, 0, v108
  v_cvt_pk_bf16_f32 v109, 0, v109
  v_cvt_pk_bf16_f32 v110, 0, v110
  v_cvt_pk_bf16_f32 v111, 0, v111
  v_pk_mul_f32 v[108:109], v[108:109], v[116:117] op_sel:[0,1]
  v_pk_mul_f32 v[110:111], v[110:111], v[116:117] op_sel:[0,1]
  v_cvt_pk_bf16_f32 v239, v200, v108
  v_cvt_pk_bf16_f32 v243, v201, v109
  v_cvt_pk_bf16_f32 v247, v202, v110
  v_cvt_pk_bf16_f32 v251, v203, v111
  v_mfma_f32_16x16x32_bf16 v[136:139], v[168:171], v[236:239], v[136:139]
  v_mfma_f32_16x16x32_bf16 v[136:139], v[172:175], v[240:243], v[136:139]
  v_mfma_f32_16x16x32_bf16 v[136:139], v[176:179], v[244:247], v[136:139]
  v_mfma_f32_16x16x32_bf16 v[136:139], v[180:183], v[248:251], v[136:139]
  s_waitcnt vmcnt(14)
  s_cbranch_vccnz L_vw1_24
  s_waitcnt vmcnt(9)
L_vw1_24:
  buffer_load_dwordx4 v[28:31], v93, s[12:15], s61 offen offset:768 nt
  v_cvt_f32_i32 v192, v56
  v_cvt_f32_i32 v193, v57
  v_mov_b32_dpp v116, v114 row_newbcast:8 row_mask:0xf bank_mask:0xf
  v_mov_b32_dpp v117, v115 row_newbcast:8 row_mask:0xf bank_mask:0xf
  v_cvt_f32_i32 v194, v58
  v_cvt_f32_i32 v195, v59
  v_pk_add_f32 v[192:193], v[192:193], v[116:117] op_sel_hi:[1,0] neg_lo:[0,1] neg_hi:[0,1]
  v_pk_add_f32 v[194:195], v[194:195], v[116:117] op_sel_hi:[1,0] neg_lo:[0,1] neg_hi:[0,1]
  v_cvt_pk_bf16_f32 v192, 0, v192
  v_cndmask_b32 v184, 0, v163, s[72:73]
  v_cvt_pk_bf16_f32 v193, 0, v193
  v_cndmask_b32 v185, 0, v164, s[72:73]
  v_cvt_pk_bf16_f32 v194, 0, v194
  v_cndmask_b32 v186, 0, v163, s[74:75]
  v_cvt_pk_bf16_f32 v195, 0, v195
  v_cndmask_b32 v187, 0, v164, s[74:75]
  v_pk_mul_f32 v[192:193], v[192:193], v[116:117] op_sel:[0,1]
  v_cndmask_b32 v188, 0, v163, s[76:77]
  v_pk_mul_f32 v[194:195], v[194:195], v[116:117] op_sel:[0,1]
  s_waitcnt vmcnt(14)
  buffer_load_dwordx4 v[32:35], v93, s[12:15], s61 offen offset:1024 nt
  v_cvt_f32_i32 v196, v60
  v_cvt_f32_i32 v197, v61
  v_cvt_f32_i32 v198, v62
  v_cvt_f32_i32 v199, v63
  v_pk_add_f32 v[196:197], v[196:197], v[116:117] op_sel_hi:[1,0] neg_lo:[0,1] neg_hi:[0,1]
  v_pk_add_f32 v[198:199], v[198:199], v[116:117] op_sel_hi:[1,0] neg_lo:[0,1] neg_hi:[0,1]
  v_cvt_pk_bf16_f32 v196, 0, v196
  v_cndmask_b32 v189, 0, v164, s[76:77]
  v_cvt_pk_bf16_f32 v197, 0, v197
  v_cndmask_b32 v190, 0, v163, s[78:79]
  v_cvt_pk_bf16_f32 v198, 0, v198
  v_cndmask_b32 v191, 0, v164, s[78:79]
  v_cvt_pk_bf16_f32 v199, 0, v199
  v_pk_mul_f32 v[196:197], v[196:197], v[116:117] op_sel:[0,1]
  v_pk_mul_f32 v[198:199], v[198:199], v[116:117] op_sel:[0,1]
  s_waitcnt vmcnt(14)
  buffer_load_dwordx4 v[36:39], v93, s[12:15], s61 offen offset:1280 nt
  v_cvt_f32_i32 v200, v64
  v_cvt_f32_i32 v201, v65
  v_cvt_f32_i32 v202, v66
  v_cvt_f32_i32 v203, v67
  v_pk_add_f32 v[200:201], v[200:201], v[116:117] op_sel_hi:[1,0] neg_lo:[0,1] neg_hi:[0,1]
  v_pk_add_f32 v[202:203], v[202:203], v[116:117] op_sel_hi:[1,0] neg_lo:[0,1] neg_hi:[0,1]
  v_cvt_pk_bf16_f32 v200, 0, v200
  v_cvt_pk_bf16_f32 v201, 0, v201
  v_cvt_pk_bf16_f32 v202, 0, v202
  v_cvt_pk_bf16_f32 v203, 0, v203
  v_pk_mul_f32 v[200:201], v[200:201], v[116:117] op_sel:[0,1]
  v_pk_mul_f32 v[202:203], v[202:203], v[116:117] op_sel:[0,1]
  s_waitcnt vmcnt(14)
  s_cbranch_vccnz L_vw1_27
  s_waitcnt vmcnt(9)
L_vw1_27:
  buffer_load_dwordx4 v[40:43], v93, s[12:15], s61 offen offset:1536 nt
  v_cvt_f32_i32 v108, v68
  v_cvt_f32_i32 v109, v69
  v_mov_b32_dpp v116, v114 row_newbcast:9 row_mask:0xf bank_mask:0xf
  v_mov_b32_dpp v117, v115 row_newbcast:9 row_mask:0xf bank_mask:0xf
  v_cvt_f32_i32 v110, v70
  v_cvt_f32_i32 v111, v71
  v_pk_add_f32 v[108:109], v[108:109], v[116:117] op_sel_hi:[1,0] neg_lo:[0,1] neg_hi:[0,1]
  v_pk_add_f32 v[110:111], v[110:111], v[116:117] op_sel_hi:[1,0] neg_lo:[0,1] neg_hi:[0,1]
  v_cvt_pk_bf16_f32 v108, 0, v108
  v_cvt_pk_bf16_f32 v109, 0, v109
  v_cvt_pk_bf16_f32 v110, 0, v110
  v_cvt_pk_bf16_f32 v111, 0, v111
  v_pk_mul_f32 v[108:109], v[108:109], v[116:117] op_sel:[0,1]
  v_pk_mul_f32 v[110:111], v[110:111], v[116:117] op_sel:[0,1]
  v_cvt_pk_bf16_f32 v204, v192, v108
  v_cvt_pk_bf16_f32 v208, v193, v109
  v_cvt_pk_bf16_f32 v212, v194, v110
  v_cvt_pk_bf16_f32 v216, v195, v111
  s_waitcnt vmcnt(14)
  buffer_load_dwordx4 v[44:47], v93, s[12:15], s61 offen offset:1792 nt
  v_cvt_f32_i32 v108, v72
  v_cvt_f32_i32 v109, v73
  v_cvt_f32_i32 v110, v74
  v_cvt_f32_i32 v111, v75
  v_pk_add_f32 v[108:109], v[108:109], v[116:117] op_sel_hi:[1,0] neg_lo:[0,1] neg_hi:[0,1]
  v_pk_add_f32 v[110:111], v[110:111], v[116:117] op_sel_hi:[1,0] neg_lo:[0,1] neg_hi:[0,1]
  v_cvt_pk_bf16_f32 v108, 0, v108
  v_cvt_pk_bf16_f32 v109, 0, v109
  v_cvt_pk_bf16_f32 v110, 0, v110
  v_cvt_pk_bf16_f32 v111, 0, v111
  v_pk_mul_f32 v[108:109], v[108:109], v[116:117] op_sel:[0,1]
  v_pk_mul_f32 v[110:111], v[110:111], v[116:117] op_sel:[0,1]
  v_cvt_pk_bf16_f32 v220, v196, v108
  v_cvt_pk_bf16_f32 v224, v197, v109
  v_cvt_pk_bf16_f32 v228, v198, v110
  v_cvt_pk_bf16_f32 v232, v199, v111
  s_waitcnt vmcnt(14)
  buffer_load_dwordx4 v[48:51], v93, s[12:15], s61 offen offset:2048 nt
  v_cvt_f32_i32 v108, v76
  v_cvt_f32_i32 v109, v77
  v_cvt_f32_i32 v110, v78
  v_cvt_f32_i32 v111, v79
  v_pk_add_f32 v[108:109], v[108:109], v[116:117] op_sel_hi:[1,0] neg_lo:[0,1] neg_hi:[0,1]
  v_pk_add_f32 v[110:111], v[110:111], v[116:117] op_sel_hi:[1,0] neg_lo:[0,1] neg_hi:[0,1]
  v_cvt_pk_bf16_f32 v108, 0, v108
  v_cvt_pk_bf16_f32 v109, 0, v109
  v_cvt_pk_bf16_f32 v110, 0, v110
  v_cvt_pk_bf16_f32 v111, 0, v111
  v_pk_mul_f32 v[108:109], v[108:109], v[116:117] op_sel:[0,1]
  v_pk_mul_f32 v[110:111], v[110:111], v[116:117] op_sel:[0,1]
  v_cvt_pk_bf16_f32 v236, v200, v108
  v_cvt_pk_bf16_f32 v240, v201, v109
  v_cvt_pk_bf16_f32 v244, v202, v110
  v_cvt_pk_bf16_f32 v248, v203, v111
  s_waitcnt vmcnt(14)
  s_cbranch_vccnz L_vw1_30
  s_waitcnt vmcnt(9)
L_vw1_30:
  buffer_load_dwordx4 v[52:55], v93, s[12:15], s61 offen offset:2304 nt
  v_cvt_f32_i32 v192, v80
  v_cvt_f32_i32 v193, v81
  v_mov_b32_dpp v116, v114 row_newbcast:10 row_mask:0xf bank_mask:0xf
  v_mov_b32_dpp v117, v115 row_newbcast:10 row_mask:0xf bank_mask:0xf
  v_cvt_f32_i32 v194, v82
  v_cvt_f32_i32 v195, v83
  v_pk_add_f32 v[192:193], v[192:193], v[116:117] op_sel_hi:[1,0] neg_lo:[0,1] neg_hi:[0,1]
  v_pk_add_f32 v[194:195], v[194:195], v[116:117] op_sel_hi:[1,0] neg_lo:[0,1] neg_hi:[0,1]
  v_cvt_pk_bf16_f32 v192, 0, v192
  v_cvt_pk_bf16_f32 v193, 0, v193
  v_cvt_pk_bf16_f32 v194, 0, v194
  v_cvt_pk_bf16_f32 v195, 0, v195
  v_pk_mul_f32 v[192:193], v[192:193], v[116:117] op_sel:[0,1]
  v_pk_mul_f32 v[194:195], v[194:195], v[116:117] op_sel:[0,1]
  v_cvt_pk_bf16_f32 v205, v192, 0
  v_cvt_pk_bf16_f32 v209, v193, 0
  v_cvt_pk_bf16_f32 v213, v194, 0
  v_cvt_pk_bf16_f32 v217, v195, 0
  v_mfma_f32_16x16x16_bf16 v[128:131], v[184:185], v[204:205], v[128:131]
  v_mfma_f32_16x16x16_bf16 v[128:131], v[186:187], v[208:209], v[128:131]
  v_mfma_f32_16x16x16_bf16 v[128:131], v[188:189], v[212:213], v[128:131]
  v_mfma_f32_16x16x16_bf16 v[128:131], v[190:191], v[216:217], v[128:131]
  s_waitcnt vmcnt(14)
  buffer_load_dwordx4 v[56:59], v93, s[12:15], s61 offen offset:2560 nt
  v_cvt_f32_i32 v196, v84
  v_cvt_f32_i32 v197, v85
  v_cvt_f32_i32 v198, v86
  v_cvt_f32_i32 v199, v87
  v_pk_add_f32 v[196:197], v[196:197], v[116:117] op_sel_hi:[1,0] neg_lo:[0,1] neg_hi:[0,1]
  v_pk_add_f32 v[198:199], v[198:199], v[116:117] op_sel_hi:[1,0] neg_lo:[0,1] neg_hi:[0,1]
  v_cvt_pk_bf16_f32 v196, 0, v196
  v_cvt_pk_bf16_f32 v197, 0, v197
  v_cvt_pk_bf16_f32 v198, 0, v198
  v_cvt_pk_bf16_f32 v199, 0, v199
  v_pk_mul_f32 v[196:197], v[196:197], v[116:117] op_sel:[0,1]
  v_pk_mul_f32 v[198:199], v[198:199], v[116:117] op_sel:[0,1]
  v_cvt_pk_bf16_f32 v221, v196, 0
  v_cvt_pk_bf16_f32 v225, v197, 0
  v_cvt_pk_bf16_f32 v229, v198, 0
  v_cvt_pk_bf16_f32 v233, v199, 0
  v_mfma_f32_16x16x16_bf16 v[132:135], v[184:185], v[220:221], v[132:135]
  v_mfma_f32_16x16x16_bf16 v[132:135], v[186:187], v[224:225], v[132:135]
  v_mfma_f32_16x16x16_bf16 v[132:135], v[188:189], v[228:229], v[132:135]
  v_mfma_f32_16x16x16_bf16 v[132:135], v[190:191], v[232:233], v[132:135]
  s_waitcnt vmcnt(14)
  buffer_load_dwordx4 v[60:63], v93, s[12:15], s61 offen offset:2816 nt
  v_cvt_f32_i32 v200, v88
  v_cvt_f32_i32 v201, v89
  v_cvt_f32_i32 v202, v90
  v_cvt_f32_i32 v203, v91
  v_pk_add_f32 v[200:201], v[200:201], v[116:117] op_sel_hi:[1,0] neg_lo:[0,1] neg_hi:[0,1]
  v_pk_add_f32 v[202:203], v[202:203], v[116:117] op_sel_hi:[1,0] neg_lo:[0,1] neg_hi:[0,1]
  v_cvt_pk_bf16_f32 v200, 0, v200
  v_cvt_pk_bf16_f32 v201, 0, v201
  v_cvt_pk_bf16_f32 v202, 0, v202
  v_cvt_pk_bf16_f32 v203, 0, v203
  v_pk_mul_f32 v[200:201], v[200:201], v[116:117] op_sel:[0,1]
  v_pk_mul_f32 v[202:203], v[202:203], v[116:117] op_sel:[0,1]
  v_cvt_pk_bf16_f32 v237, v200, 0
  v_cvt_pk_bf16_f32 v241, v201, 0
  v_cvt_pk_bf16_f32 v245, v202, 0
  v_cvt_pk_bf16_f32 v249, v203, 0
  v_mfma_f32_16x16x16_bf16 v[136:139], v[184:185], v[236:237], v[136:139]
  v_mfma_f32_16x16x16_bf16 v[136:139], v[186:187], v[240:241], v[136:139]
  v_mfma_f32_16x16x16_bf16 v[136:139], v[188:189], v[244:245], v[136:139]
  v_mfma_f32_16x16x16_bf16 v[136:139], v[190:191], v[248:249], v[136:139]
  s_mov_b32 s60, s61
  s_cmp_ge_u32 s64, 96
  s_cbranch_scc1 L_v_done
  s_cmp_eq_u32 s89, s88
  s_cbranch_scc1 L_v0
  s_mov_b32 s88, s89
  s_and_b32 s70, s86, 15
  s_cmp_ge_u32 s70, 12
  s_cselect_b32 s70, 6208, 0
  s_bitcmp1_b32 s86, 4
  s_cselect_b32 s71, 12416, 0
  s_add_u32 s70, s70, s71
  v_mov_b32 v145, v143
  v_add_u32 v144, s70, v102
  v_add_u32 v147, s70, v103
  v_permlane32_swap_b32 v143, v145
  v_add_f32 v143, v143, v145
  v_mov_b32 v145, v143
  ds_write_b128 v144, v[128:131] offset:0
  ds_write_b128 v144, v[132:135] offset:1024
  ds_write_b128 v144, v[136:139] offset:2048
  v_permlane16_swap_b32 v143, v145
  v_add_f32 v143, v143, v145
  ds_write_b64 v147, v[142:143]
  s_waitcnt lgkmcnt(0)
  v_mov_b32 v128, 0
  v_mov_b32 v129, 0
  v_mov_b32 v130, 0
  v_mov_b32 v131, 0
  v_mov_b32 v132, 0
  v_mov_b32 v133, 0
  v_mov_b32 v134, 0
  v_mov_b32 v135, 0
  v_mov_b32 v136, 0
  v_mov_b32 v137, 0
  v_mov_b32 v138, 0
  v_mov_b32 v139, 0
  v_mov_b32 v140, 0xff800000
  v_mov_b32 v142, 0x7f800000
  v_mov_b32 v143, 0
  s_branch L_v0
L_v_done:
  s_and_b32 s70, s86, 15
  s_cmp_ge_u32 s70, 12
  s_cselect_b32 s70, 6208, 0
  s_bitcmp1_b32 s86, 4
  s_cselect_b32 s71, 12416, 0
  s_add_u32 s70, s70, s71
  v_mov_b32 v145, v143
  v_add_u32 v144, s70, v102
  v_add_u32 v147, s70, v103
  v_permlane32_swap_b32 v143, v145
  v_add_f32 v143, v143, v145
  v_mov_b32 v145, v143
  ds_write_b128 v144, v[128:131] offset:0
  ds_write_b128 v144, v[132:135] offset:1024
  ds_write_b128 v144, v[136:139] offset:2048
  v_permlane16_swap_b32 v143, v145
  v_add_f32 v143, v143, v145
  ds_write_b64 v147, v[142:143]
L_finish:
  v_mov_b32 v144, 61728
  ds_read_b128 v[168:171], v144
  ds_read_b128 v[172:175], v144 offset:16
  s_mul_i32 s70, s4, 6208
  s_lshl_b32 s71, s3, 10
  v_lshl_add_u32 v152, v0, 4, s71
  v_lshrrev_b32 v145, 4, v0
  v_lshlrev_b32 v154, 3, v145
  v_add_u32 v154, 43008, v154
  s_sub_u32 s97, 6208, s70
  v_add_u32 v153, s97, v152
  v_add_u32 v140, s70, v152
  s_sub_u32 s97, 12416, s70
  v_add_u32 v112, s97, v154
  s_add_u32 s97, s70, 6208
  v_add_u32 v113, s97, v154
  v_add_u32 v155, 18624, v154
  s_mul_i32 s70, s3, 1152
  v_lshl_add_u32 v156, v0, 4, s70
  v_lshl_add_u32 v157, v145, 5, s70
  v_and_b32 v146, 1, v0
  v_lshl_add_u32 v157, v146, 4, v157
  v_mul_u32_u24 v146, 384, v145
  v_and_b32 v145, 15, v0
  v_lshl_add_u32 v146, v145, 3, v146
  s_movk_i32 s65, 0xff00
  s_mov_b32 s48, 0x30003
  s_mov_b32 s49, 0x30003
  s_mov_b32 s50, 0x0c0c0400
  s_mov_b32 s51, 0x05040100
  s_mov_b32 s64, 0
  s_waitcnt vmcnt(0) lgkmcnt(0)
  s_barrier
  ds_read2_b64 v[176:179], v154 offset1:4
  ds_read_b128 v[192:195], v152 offset:36864
  ds_read_b128 v[196:199], v152 offset:39936
  ds_read2_b64 v[180:183], v155 offset1:4
  ds_read_b128 v[200:203], v152 offset:55488
  ds_read_b128 v[204:207], v152 offset:58560
  ds_read2_b64 v[184:187], v112 offset1:4
  ds_read_b128 v[208:211], v153 offset:43072
  ds_read_b128 v[212:215], v153 offset:46144
  ds_read2_b64 v[188:191], v113 offset1:4
  ds_read_b128 v[216:219], v140 offset:43072
  ds_read_b128 v[220:223], v140 offset:46144
  v_readfirstlane_b32 s72, v168
  v_readfirstlane_b32 s73, v169
  v_readfirstlane_b32 s74, v170
  v_readfirstlane_b32 s75, v171
  v_readfirstlane_b32 s76, v172
  v_readfirstlane_b32 s77, v173
  v_readfirstlane_b32 s78, v174
  v_bfe_u32 v148, v175, 0, 8
  v_bfe_u32 v149, v175, 8, 8
  v_bfe_u32 v150, v175, 16, 8
  v_bfe_u32 v151, v175, 24, 8
  s_waitcnt lgkmcnt(9)
  v_min_f32 v144, v176, v178
  v_sub_f32 v176, v144, v176
  v_sub_f32 v178, v144, v178
  v_exp_f32 v176, v176
  v_exp_f32 v178, v178
  v_mul_f32 v145, v176, v177
  v_pk_mul_f32 v[192:193], v[192:193], v[176:177] op_sel_hi:[1,0]
  v_pk_mul_f32 v[194:195], v[194:195], v[176:177] op_sel_hi:[1,0]
  v_pk_fma_f32 v[192:193], v[196:197], v[178:179], v[192:193] op_sel_hi:[1,0,1]
  v_pk_fma_f32 v[194:195], v[198:199], v[178:179], v[194:195] op_sel_hi:[1,0,1]
  v_fma_f32 v197, v178, v179, v145
  v_mov_b32 v196, v144
  v_and_or_b32 v192, v192, s65, v148
  v_and_or_b32 v193, v193, s65, v149
  v_and_or_b32 v194, v194, s65, v150
  v_and_or_b32 v195, v195, s65, v151
  v_mov_b32 v199, v175
  buffer_store_dwordx4 v[192:195], v156, s[40:43], s72 offen sc1
  s_mov_b64 exec, s[48:49]
  buffer_store_dwordx4 v[196:199], v157, s[40:43], s72 offen offset:1024 sc1
  s_mov_b64 exec, -1
  s_waitcnt lgkmcnt(6)
  v_min_f32 v144, v180, v182
  v_sub_f32 v180, v144, v180
  v_sub_f32 v182, v144, v182
  v_exp_f32 v180, v180
  v_exp_f32 v182, v182
  v_mul_f32 v145, v180, v181
  v_pk_mul_f32 v[200:201], v[200:201], v[180:181] op_sel_hi:[1,0]
  v_pk_mul_f32 v[202:203], v[202:203], v[180:181] op_sel_hi:[1,0]
  v_pk_fma_f32 v[200:201], v[204:205], v[182:183], v[200:201] op_sel_hi:[1,0,1]
  v_pk_fma_f32 v[202:203], v[206:207], v[182:183], v[202:203] op_sel_hi:[1,0,1]
  v_fma_f32 v205, v182, v183, v145
  v_mov_b32 v204, v144
  v_and_or_b32 v200, v200, s65, v148
  v_and_or_b32 v201, v201, s65, v149
  v_and_or_b32 v202, v202, s65, v150
  v_and_or_b32 v203, v203, s65, v151
  v_mov_b32 v207, v175
  buffer_store_dwordx4 v[200:203], v156, s[40:43], s73 offen sc1
  s_mov_b64 exec, s[48:49]
  buffer_store_dwordx4 v[204:207], v157, s[40:43], s73 offen offset:1024 sc1
  s_mov_b64 exec, -1
  s_waitcnt lgkmcnt(3)
  v_min_f32 v144, v184, v186
  v_sub_f32 v184, v144, v184
  v_sub_f32 v186, v144, v186
  v_exp_f32 v184, v184
  v_exp_f32 v186, v186
  v_mul_f32 v145, v184, v185
  v_pk_mul_f32 v[208:209], v[208:209], v[184:185] op_sel_hi:[1,0]
  v_pk_mul_f32 v[210:211], v[210:211], v[184:185] op_sel_hi:[1,0]
  v_pk_fma_f32 v[208:209], v[212:213], v[186:187], v[208:209] op_sel_hi:[1,0,1]
  v_pk_fma_f32 v[210:211], v[214:215], v[186:187], v[210:211] op_sel_hi:[1,0,1]
  v_fma_f32 v213, v186, v187, v145
  v_mov_b32 v212, v144
  v_and_or_b32 v208, v208, s65, v148
  v_and_or_b32 v209, v209, s65, v149
  v_and_or_b32 v210, v210, s65, v150
  v_and_or_b32 v211, v211, s65, v151
  v_mov_b32 v215, v175
  buffer_store_dwordx4 v[208:211], v156, s[40:43], s74 offen sc1
  s_mov_b64 exec, s[48:49]
  buffer_store_dwordx4 v[212:215], v157, s[40:43], s74 offen offset:1024 sc1
  s_mov_b64 exec, -1
  buffer_load_dwordx4 v[224:227], v156, s[40:43], s75 offen sc1
  buffer_load_dwordx4 v[228:231], v157, s[40:43], s75 offen offset:1024 sc1
  buffer_load_dwordx4 v[232:235], v156, s[40:43], s76 offen sc1
  buffer_load_dwordx4 v[236:239], v157, s[40:43], s76 offen offset:1024 sc1
  buffer_load_dwordx4 v[240:243], v156, s[40:43], s77 offen sc1
  buffer_load_dwordx4 v[244:247], v157, s[40:43], s77 offen offset:1024 sc1
  s_waitcnt lgkmcnt(0)
  v_min_f32 v144, v188, v190
  v_sub_f32 v188, v144, v188
  v_sub_f32 v190, v144, v190
  v_exp_f32 v188, v188
  v_exp_f32 v190, v190
  v_mul_f32 v145, v188, v189
  v_pk_mul_f32 v[216:217], v[216:217], v[188:189] op_sel_hi:[1,0]
  v_pk_mul_f32 v[218:219], v[218:219], v[188:189] op_sel_hi:[1,0]
  v_pk_fma_f32 v[216:217], v[220:221], v[190:191], v[216:217] op_sel_hi:[1,0,1]
  v_pk_fma_f32 v[218:219], v[222:223], v[190:191], v[218:219] op_sel_hi:[1,0,1]
  v_fma_f32 v221, v190, v191, v145
  v_mov_b32 v220, v144
  s_branch L_check
L_gather:
  s_add_u32 s64, s64, 1
  s_cmp_gt_u32 s64, 200000
  s_cbranch_scc1 L_end
  s_bitcmp0_b32 s87, 0
  s_cbranch_scc1 L_have0
  buffer_load_dwordx4 v[224:227], v156, s[40:43], s75 offen sc1
  buffer_load_dwordx4 v[228:231], v157, s[40:43], s75 offen offset:1024 sc1
L_have0:
  s_bitcmp0_b32 s87, 1
  s_cbranch_scc1 L_have1
  buffer_load_dwordx4 v[232:235], v156, s[40:43], s76 offen sc1
  buffer_load_dwordx4 v[236:239], v157, s[40:43], s76 offen offset:1024 sc1
L_have1:
  s_bitcmp0_b32 s87, 2
  s_cbranch_scc1 L_have2
  buffer_load_dwordx4 v[240:243], v156, s[40:43], s77 offen sc1
  buffer_load_dwordx4 v[244:247], v157, s[40:43], s77 offen offset:1024 sc1
L_have2:
L_check:
  s_mov_b32 s87, 0
  s_waitcnt vmcnt(0)
  v_perm_b32 v144, v225, v224, s50
  v_perm_b32 v145, v227, v226, s50
  v_cmp_ne_u32 vcc, v175, v231
  v_perm_b32 v144, v145, v144, s51
  v_cmp_ne_u32 s[70:71], v175, v144
  s_nop 1
  s_or_b64 s[70:71], s[70:71], vcc
  s_cselect_b32 s70, 1, 0
  s_or_b32 s87, s87, s70
  v_perm_b32 v144, v233, v232, s50
  v_perm_b32 v145, v235, v234, s50
  v_cmp_ne_u32 vcc, v175, v239
  v_perm_b32 v144, v145, v144, s51
  v_cmp_ne_u32 s[70:71], v175, v144
  s_nop 1
  s_or_b64 s[70:71], s[70:71], vcc
  s_cselect_b32 s70, 2, 0
  s_or_b32 s87, s87, s70
  v_perm_b32 v144, v241, v240, s50
  v_perm_b32 v145, v243, v242, s50
  v_cmp_ne_u32 vcc, v175, v247
  v_perm_b32 v144, v145, v144, s51
  v_cmp_ne_u32 s[70:71], v175, v144
  s_nop 1
  s_or_b64 s[70:71], s[70:71], vcc
  s_cselect_b32 s70, 4, 0
  s_or_b32 s87, s87, s70
  s_cbranch_scc1 L_gather
  v_min_f32 v144, v220, v228
  v_min3_f32 v144, v144, v236, v244
  v_sub_f32 v220, v144, v220
  v_sub_f32 v228, v144, v228
  v_sub_f32 v236, v144, v236
  v_sub_f32 v244, v144, v244
  v_exp_f32 v220, v220
  v_exp_f32 v228, v228
  v_exp_f32 v236, v236
  v_exp_f32 v244, v244
  v_and_b32 v216, s65, v216
  v_and_b32 v217, s65, v217
  v_and_b32 v218, s65, v218
  v_and_b32 v219, s65, v219
  v_and_b32 v224, s65, v224
  v_and_b32 v225, s65, v225
  v_and_b32 v226, s65, v226
  v_and_b32 v227, s65, v227
  v_and_b32 v232, s65, v232
  v_and_b32 v233, s65, v233
  v_and_b32 v234, s65, v234
  v_and_b32 v235, s65, v235
  v_and_b32 v240, s65, v240
  v_and_b32 v241, s65, v241
  v_and_b32 v242, s65, v242
  v_and_b32 v243, s65, v243
  v_mul_f32 v221, v220, v221
  v_mul_f32 v229, v228, v229
  v_mul_f32 v237, v236, v237
  v_mul_f32 v245, v244, v245
  v_add_f32 v221, v221, v229
  v_add_f32 v237, v237, v245
  v_add_f32 v144, v221, v237
  v_rcp_f32 v144, v144
  s_lshl_b32 s70, s3, 7
  s_add_u32 s70, s70, s78
  v_pk_mul_f32 v[216:217], v[216:217], v[220:221] op_sel_hi:[1,0]
  v_pk_mul_f32 v[224:225], v[224:225], v[228:229] op_sel_hi:[1,0]
  v_pk_mul_f32 v[232:233], v[232:233], v[236:237] op_sel_hi:[1,0]
  v_pk_mul_f32 v[240:241], v[240:241], v[244:245] op_sel_hi:[1,0]
  v_pk_add_f32 v[216:217], v[216:217], v[224:225]
  v_pk_add_f32 v[232:233], v[232:233], v[240:241]
  v_pk_add_f32 v[216:217], v[216:217], v[232:233]
  v_pk_mul_f32 v[216:217], v[216:217], v[144:145] op_sel_hi:[1,0]
  v_cvt_pk_bf16_f32 v128, v216, v217
  v_pk_mul_f32 v[218:219], v[218:219], v[220:221] op_sel_hi:[1,0]
  v_pk_mul_f32 v[226:227], v[226:227], v[228:229] op_sel_hi:[1,0]
  v_pk_mul_f32 v[234:235], v[234:235], v[236:237] op_sel_hi:[1,0]
  v_pk_mul_f32 v[242:243], v[242:243], v[244:245] op_sel_hi:[1,0]
  v_pk_add_f32 v[218:219], v[218:219], v[226:227]
  v_pk_add_f32 v[234:235], v[234:235], v[242:243]
  v_pk_add_f32 v[218:219], v[218:219], v[234:235]
  v_pk_mul_f32 v[218:219], v[218:219], v[144:145] op_sel_hi:[1,0]
  v_cvt_pk_bf16_f32 v129, v218, v219
  buffer_store_dwordx2 v[128:129], v146, s[36:39], s70 offen
L_fin:
L_end:
  s_endpgm
L_helper:
  v_lshlrev_b32 v1, 2, v0
  v_add_u32 v1, 61696, v1
  v_mov_b32 v2, 0
  s_mov_b64 exec, 0xff
  ds_write_b32 v1, v2
  s_mov_b64 exec, -1
  s_waitcnt lgkmcnt(0)
  s_mov_b32 s8, s46
  s_and_b32 s9, s47, 0xffff
  s_mov_b32 s36, s44
  s_and_b32 s37, s45, 0xffff
  s_mov_b32 s16, s46
  s_and_b32 s17, s47, 0xffff
  s_mov_b32 s12, s48
  s_and_b32 s13, s49, 0xffff
  s_mov_b32 s40, s82
  s_and_b32 s41, s83, 0xffff
  s_mov_b32 s36, s58
  s_and_b32 s37, s59, 0xffff
  s_barrier
  s_memrealtime s[72:73]
  s_getpc_b64 s[54:55]
L_h_pc:
  s_add_u32 s86, s54, L_h_cp - L_h_pc
  s_addc_u32 s87, s55, 0
  s_sub_u32 s54, s54, L_h_pc - L_k
  s_subb_u32 s55, s55, 0
  s_and_b32 s54, s54, -16
  s_lshr_b32 s70, s2, 3
  s_lshl_b32 s70, s70, 10
  v_lshl_add_u32 v106, v0, 4, s70
  v_mov_b32 v107, s55
  v_add_co_u32 v106, vcc, s54, v106
  s_nop 1
  v_addc_co_u32 v107, vcc, 0, v107, vcc
  s_lshr_b32 s70, s2, 3
  s_cmp_lt_u32 s70, (L_code_end - L_k) / 1024
  s_cbranch_scc0 L_h_cta
  global_load_dwordx4 v[108:111], v[106:107], off
L_h_cta:
  s_lshl_b32 s70, s2, 6
  v_lshl_add_u32 v104, v0, 3, s70
  v_bfe_u32 v105, v0, 1, 3
  v_lshlrev_b32 v105, 6, v105
  v_and_b32 v112, 1, v0
  v_lshl_add_u32 v105, v112, 3, v105
  v_lshlrev_b32 v112, 2, v112
  v_add_u32 v112, 61712, v112
  v_mov_b32 v113, 0
  v_lshlrev_b32 v3, 4, v0
  s_mov_b32 s76, 10
  s_mov_b32 s77, 7340032
  s_getreg_b32 s50, hwreg(HW_REG_XCC_ID)
  s_bfe_u32 s50, s50, 0x10002
  s_bfe_u32 s52, s2, 0x30003
  s_cmp_eq_u32 s52, 7
  s_cbranch_scc1 L_h_voted
  s_lshr_b32 s70, s2, 6
  s_xor_b32 s70, s70, s2
  s_and_b32 s70, s70, 3
  s_cbranch_scc1 L_h_voted
  s_cmp_eq_u32 s52, 6
  s_cbranch_scc0 L_h_probe
  s_xor_b32 s48, s50, s4
  s_and_b32 s52, s2, 3
  s_lshl2_add_u32 s52, s52, 36
  s_branch L_h_vote
L_h_probe:
  s_cmp_ge_u32 s52, 3
  s_cselect_b32 s16, s12, s8
  s_cselect_b32 s17, s13, s9
  s_cselect_b32 s70, 3, 0
  s_sub_u32 s70, s52, s70
  s_lshl_b32 s70, s70, 28
  s_add_u32 s44, s5, s4
  s_lshl_b32 s44, s44, 16
  s_add_u32 s44, s44, s70
  s_add_u32 s44, s44, 0x1c0000
  s_mul_i32 s70, s2, 0x2a95
  s_and_b32 s70, s70, 0x7f80
  s_add_u32 s44, s44, s70
  s_add_u32 s70, s44, 0x8000
  s_buffer_load_dword s58, s[16:19], s70
  s_mov_b32 s45, -1
  s_mov_b32 s46, -1
  s_mul_i32 s52, s52, 6
L_h_progp:
  s_sleep 2
  ds_read_b32 v8, v112
  s_waitcnt lgkmcnt(0)
  v_cmp_gt_u32 vcc, 1, v8
  s_nop 1
  s_cmp_lg_u32 vcc_lo, 0
  s_cbranch_scc1 L_h_progp
  s_xor_b32 s70, s44, 0
  s_memtime s[54:55]
  s_waitcnt lgkmcnt(0)
  s_buffer_load_dword s58, s[16:19], s70
  s_waitcnt lgkmcnt(0)
  s_memtime s[56:57]
  s_waitcnt lgkmcnt(0)
  s_sub_u32 s56, s56, s54
  s_min_u32 s45, s45, s56
  s_xor_b32 s70, s44, 8192
  s_memtime s[54:55]
  s_waitcnt lgkmcnt(0)
  s_buffer_load_dword s58, s[16:19], s70
  s_waitcnt lgkmcnt(0)
  s_memtime s[56:57]
  s_waitcnt lgkmcnt(0)
  s_sub_u32 s56, s56, s54
  s_min_u32 s46, s46, s56
  s_xor_b32 s70, s44, 25472
  s_memtime s[54:55]
  s_waitcnt lgkmcnt(0)
  s_buffer_load_dword s58, s[16:19], s70
  s_waitcnt lgkmcnt(0)
  s_memtime s[56:57]
  s_waitcnt lgkmcnt(0)
  s_sub_u32 s56, s56, s54
  s_min_u32 s46, s46, s56
  s_xor_b32 s70, s44, 17280
  s_memtime s[54:55]
  s_waitcnt lgkmcnt(0)
  s_buffer_load_dword s58, s[16:19], s70
  s_waitcnt lgkmcnt(0)
  s_memtime s[56:57]
  s_waitcnt lgkmcnt(0)
  s_sub_u32 s56, s56, s54
  s_min_u32 s45, s45, s56
  s_xor_b32 s70, s44, 5888
  s_memtime s[54:55]
  s_waitcnt lgkmcnt(0)
  s_buffer_load_dword s58, s[16:19], s70
  s_waitcnt lgkmcnt(0)
  s_memtime s[56:57]
  s_waitcnt lgkmcnt(0)
  s_sub_u32 s56, s56, s54
  s_min_u32 s45, s45, s56
  s_xor_b32 s70, s44, 14080
  s_memtime s[54:55]
  s_waitcnt lgkmcnt(0)
  s_buffer_load_dword s58, s[16:19], s70
  s_waitcnt lgkmcnt(0)
  s_memtime s[56:57]
  s_waitcnt lgkmcnt(0)
  s_sub_u32 s56, s56, s54
  s_min_u32 s46, s46, s56
  s_cmp_lt_u32 s46, s45
  s_cselect_b32 s48, 1, 0
  s_lshr_b32 s70, s44, 13
  s_xor_b32 s70, s70, s2
  s_xor_b32 s70, s70, s50
  s_and_b32 s70, s70, 1
  s_xor_b32 s48, s48, s70
L_h_vote:
  s_mov_b32 s49, 0
  s_lshl_b64 s[48:49], s[48:49], s52
  s_or_b32 s49, s49, 0x100000
  s_atomic_add_x2 s[48:49], s[80:81], 0
L_h_voted:
  s_waitcnt lgkmcnt(0)
  s_cmp_lg_u32 s2, 56
  s_cbranch_scc1 L_h_nonce
  s_lshl_b64 s[54:55], s[72:73], 2
  s_atomic_add_x2 s[54:55], s[80:81], 8
  s_waitcnt lgkmcnt(0)
L_h_nonce:
L_h_progv:
  s_sleep 8
  ds_read_b32 v8, v112
  s_waitcnt lgkmcnt(0)
  v_cmp_gt_u32 vcc, 6, v8
  s_nop 1
  s_cmp_lg_u32 vcc_lo, 0
  s_cbranch_scc1 L_h_progv
  s_load_dwordx2 s[48:49], s[80:81], 0
  s_mov_b32 s59, 0
L_h_votes:
  s_waitcnt lgkmcnt(0)
  s_lshr_b32 s70, s49, 20
  s_cmp_ge_u32 s70, 56
  s_cbranch_scc1 L_h_votes_done
  s_add_u32 s59, s59, 1
  s_cmp_gt_u32 s59, 8000
  s_cbranch_scc1 L_h_votes_done
  s_sleep 64
  s_mov_b64 s[48:49], 0
  s_atomic_or_x2 s[48:49], s[80:81], 0 glc
  s_branch L_h_votes
L_h_votes_done:
  s_mov_b32 s96, 0x80
  s_bfe_u64 s[54:55], s[48:49], 0x60000
  s_cmp_gt_u32 s54, 4
  s_cselect_b32 s56, 1, 0
  s_or_b32 s96, s96, s56
  s_bfe_u64 s[54:55], s[48:49], 0x60006
  s_cmp_gt_u32 s54, 4
  s_cselect_b32 s56, 2, 0
  s_or_b32 s96, s96, s56
  s_bfe_u64 s[54:55], s[48:49], 0x6000c
  s_cmp_gt_u32 s54, 4
  s_cselect_b32 s56, 4, 0
  s_or_b32 s96, s96, s56
  s_bfe_u64 s[54:55], s[48:49], 0x60012
  s_cmp_gt_u32 s54, 4
  s_cselect_b32 s56, 8, 0
  s_or_b32 s96, s96, s56
  s_bfe_u64 s[54:55], s[48:49], 0x60018
  s_cmp_gt_u32 s54, 4
  s_cselect_b32 s56, 16, 0
  s_or_b32 s96, s96, s56
  s_bfe_u64 s[54:55], s[48:49], 0x6001e
  s_cmp_gt_u32 s54, 4
  s_cselect_b32 s56, 32, 0
  s_or_b32 s96, s96, s56
  s_and_b32 s70, s2, 3
  s_lshl2_add_u32 s70, s70, 5
  s_lshr_b32 s54, s49, s70
  s_xor_b32 s54, s54, s2
  s_xor_b32 s54, s54, s4
  s_and_b32 s54, s54, 1
  s_mul_i32 s54, s54, 63
  s_xor_b32 s96, s96, s54
  v_mov_b32 v1, 61696
  v_mov_b32 v5, s96
  ds_write_b32 v1, v5
  s_load_dwordx2 s[74:75], s[80:81], 8
  s_mov_b32 s59, 0
L_h_getnonce:
  s_waitcnt lgkmcnt(0)
  s_cmp_lg_u64 s[74:75], 0
  s_cbranch_scc1 L_h_gotnonce
  s_add_u32 s59, s59, 1
  s_cmp_gt_u32 s59, 8000
  s_cbranch_scc1 L_h_gotnonce
  s_sleep 64
  s_atomic_or_x2 s[74:75], s[80:81], 8 glc
  s_branch L_h_getnonce
L_h_gotnonce:
  s_lshr_b64 s[54:55], s[74:75], 2
  v_writelane_b32 v8, s54, 7
  s_lshr_b32 s64, s5, 5
  s_mov_b32 s50, 0xaaaaaaab
  s_add_u32 s54, s64, 0
  s_mul_hi_u32 s56, s54, s50
  s_lshr_b32 s56, s56, 1
  s_mul_i32 s56, s56, 3
  s_sub_u32 s54, s54, s56
  s_lshr_b32 s56, s96, s54
  s_bfe_u32 s56, s56, 0x10003
  s_lshl_b32 s54, s54, 7
  s_add_u32 s54, s54, s64
  s_mul_hi_u32 s54, s54, s50
  s_lshr_b32 s54, s54, 1
  s_lshl3_add_u32 s54, s54, s56
  s_mul_i32 s70, s54, 3456
  s_add_u32 s70, s70, 1048576
  v_writelane_b32 v8, s70, 0
  s_add_u32 s54, s64, 4
  s_mul_hi_u32 s56, s54, s50
  s_lshr_b32 s56, s56, 1
  s_mul_i32 s56, s56, 3
  s_sub_u32 s54, s54, s56
  s_lshr_b32 s56, s96, s54
  s_bfe_u32 s56, s56, 0x10003
  s_lshl_b32 s54, s54, 7
  s_add_u32 s54, s54, s64
  s_mul_hi_u32 s54, s54, s50
  s_lshr_b32 s54, s54, 1
  s_lshl3_add_u32 s54, s54, s56
  s_add_u32 s54, s54, 6
  s_mul_i32 s70, s54, 3456
  s_add_u32 s70, s70, 1048576
  v_writelane_b32 v8, s70, 1
  s_add_u32 s54, s64, 2
  s_mul_hi_u32 s56, s54, s50
  s_lshr_b32 s56, s56, 1
  s_mul_i32 s56, s56, 3
  s_sub_u32 s54, s54, s56
  s_lshr_b32 s56, s96, s54
  s_bfe_u32 s56, s56, 0x10003
  s_lshl_b32 s54, s54, 7
  s_add_u32 s54, s54, s64
  s_mul_hi_u32 s54, s54, s50
  s_lshr_b32 s54, s54, 1
  s_lshl3_add_u32 s54, s54, s56
  s_lshl_b32 s56, s4, 1
  s_sub_u32 s57, s54, s56
  s_add_u32 s57, s57, 4
  s_mul_i32 s70, s57, 3456
  s_add_u32 s70, s70, 1048576
  v_writelane_b32 v8, s70, 2
  s_add_u32 s54, s54, s56
  s_add_u32 s54, s54, 2
  s_xor_b32 s56, s54, 1
  s_mul_i32 s70, s56, 3456
  s_add_u32 s70, s70, 1048576
  v_writelane_b32 v8, s70, 3
  s_andn2_b32 s56, s54, 1
  s_xor_b32 s56, s56, 2
  s_mul_i32 s70, s56, 3456
  s_add_u32 s70, s70, 1048576
  v_writelane_b32 v8, s70, 4
  s_add_u32 s56, s56, 1
  s_mul_i32 s70, s56, 3456
  s_add_u32 s70, s70, 1048576
  v_writelane_b32 v8, s70, 5
  s_lshr_b32 s54, s54, 2
  s_mul_i32 s54, s54, 1536
  v_writelane_b32 v8, s54, 6
  v_lshlrev_b32 v1, 2, v0
  s_mov_b64 exec, 0xff
  ds_write_b32 v1, v8 offset:61728
  s_mov_b64 exec, -1
  s_lshl_b32 s62, s2, 8
  s_add_u32 s62, s62, 6291456
  s_xor_b32 s63, s62, 1024
  s_lshr_b32 s58, s96, 3
  s_xor_b32 s58, s58, s96
  s_mov_b32 s44, 16777216
  s_bitcmp1_b32 s5, 5
  s_cselect_b32 s70, 2048, 0
  s_xor_b32 s44, s44, s70
  s_bitcmp1_b32 s5, 6
  s_cselect_b32 s70, 4096, 0
  s_xor_b32 s44, s44, s70
  s_bitcmp1_b32 s5, 7
  s_cselect_b32 s70, 8192, 0
  s_xor_b32 s44, s44, s70
  s_bitcmp1_b32 s5, 8
  s_cselect_b32 s70, 16384, 0
  s_xor_b32 s44, s44, s70
  s_bitcmp1_b32 s5, 9
  s_cselect_b32 s70, 2097152, 0
  s_xor_b32 s44, s44, s70
  s_bitcmp1_b32 s5, 10
  s_cselect_b32 s70, 4194304, 0
  s_xor_b32 s44, s44, s70
  s_bitcmp1_b32 s5, 11
  s_cselect_b32 s70, 8388608, 0
  s_xor_b32 s44, s44, s70
  s_mul_i32 s70, s4, 1024
  s_xor_b32 s60, s44, s70
  s_xor_b32 s61, s60, 1024
  s_mov_b32 s78, 62
  s_swappc_b64 s[84:85], s[86:87]
L_h_proga:
  s_sleep 4
  ds_read_b32 v8, v112
  s_waitcnt lgkmcnt(0)
  v_cmp_gt_u32 vcc, 64, v8
  s_nop 1
  s_cmp_lg_u32 vcc_lo, 0
  s_cbranch_scc1 L_h_proga
  ds_read_b128 v[8:11], v3 offset:0
  ds_read_b128 v[12:15], v3 offset:1024
  ds_read_b128 v[16:19], v3 offset:2048
  s_waitcnt lgkmcnt(0)
  s_xor_b32 s70, s60, 0
  buffer_store_dwordx4 v[8:11], v3, s[40:43], s70 offen sc1
  s_xor_b32 s70, s60, 32768
  buffer_store_dwordx4 v[12:15], v3, s[40:43], s70 offen sc1
  s_xor_b32 s70, s60, 67584
  buffer_store_dwordx4 v[16:19], v3, s[40:43], s70 offen sc1
  s_bitcmp0_b32 s58, 2
  s_cbranch_scc1 L_h_e0
  ds_read_b128 v[20:23], v3 offset:3072
  ds_read_b128 v[24:27], v3 offset:4096
  ds_read_b128 v[28:31], v3 offset:5120
  ds_read_b128 v[32:35], v3 offset:6144
  ds_read_b128 v[36:39], v3 offset:7168
  ds_read_b128 v[40:43], v3 offset:8192
  ds_read_b128 v[44:47], v3 offset:9216
  ds_read_b128 v[48:51], v3 offset:10240
  ds_read_b128 v[52:55], v3 offset:11264
  s_waitcnt lgkmcnt(0)
  s_xor_b32 s70, s60, 100352
  buffer_store_dwordx4 v[20:23], v3, s[40:43], s70 offen sc1
  s_xor_b32 s70, s60, 136192
  buffer_store_dwordx4 v[24:27], v3, s[40:43], s70 offen sc1
  s_xor_b32 s70, s60, 168960
  buffer_store_dwordx4 v[28:31], v3, s[40:43], s70 offen sc1
  s_xor_b32 s70, s60, 203776
  buffer_store_dwordx4 v[32:35], v3, s[40:43], s70 offen sc1
  s_xor_b32 s70, s60, 236544
  buffer_store_dwordx4 v[36:39], v3, s[40:43], s70 offen sc1
  s_xor_b32 s70, s60, 272384
  buffer_store_dwordx4 v[40:43], v3, s[40:43], s70 offen sc1
  s_xor_b32 s70, s60, 305152
  buffer_store_dwordx4 v[44:47], v3, s[40:43], s70 offen sc1
  s_xor_b32 s70, s60, 335872
  buffer_store_dwordx4 v[48:51], v3, s[40:43], s70 offen sc1
  s_xor_b32 s70, s60, 368640
  buffer_store_dwordx4 v[52:55], v3, s[40:43], s70 offen sc1
L_h_e0:
  s_bitcmp0_b32 s58, 0
  s_cbranch_scc1 L_h_e1
  ds_read_b128 v[56:59], v3 offset:12288
  ds_read_b128 v[60:63], v3 offset:13312
  ds_read_b128 v[64:67], v3 offset:14336
  ds_read_b128 v[68:71], v3 offset:15360
  ds_read_b128 v[72:75], v3 offset:16384
  ds_read_b128 v[76:79], v3 offset:17408
  ds_read_b128 v[80:83], v3 offset:18432
  ds_read_b128 v[84:87], v3 offset:19456
  ds_read_b128 v[88:91], v3 offset:20480
  ds_read_b128 v[92:95], v3 offset:21504
  ds_read_b128 v[96:99], v3 offset:22528
  ds_read_b128 v[100:103], v3 offset:23552
  s_waitcnt lgkmcnt(0)
  s_xor_b32 s70, s60, 408576
  buffer_store_dwordx4 v[56:59], v3, s[40:43], s70 offen sc1
  s_xor_b32 s70, s60, 441344
  buffer_store_dwordx4 v[60:63], v3, s[40:43], s70 offen sc1
  s_xor_b32 s70, s60, 472064
  buffer_store_dwordx4 v[64:67], v3, s[40:43], s70 offen sc1
  s_xor_b32 s70, s60, 504832
  buffer_store_dwordx4 v[68:71], v3, s[40:43], s70 offen sc1
  s_xor_b32 s70, s60, 525312
  buffer_store_dwordx4 v[72:75], v3, s[40:43], s70 offen sc1
  s_xor_b32 s70, s60, 558080
  buffer_store_dwordx4 v[76:79], v3, s[40:43], s70 offen sc1
  s_xor_b32 s70, s60, 592896
  buffer_store_dwordx4 v[80:83], v3, s[40:43], s70 offen sc1
  s_xor_b32 s70, s60, 625664
  buffer_store_dwordx4 v[84:87], v3, s[40:43], s70 offen sc1
  s_xor_b32 s70, s60, 659456
  buffer_store_dwordx4 v[88:91], v3, s[40:43], s70 offen sc1
  s_xor_b32 s70, s60, 692224
  buffer_store_dwordx4 v[92:95], v3, s[40:43], s70 offen sc1
  s_xor_b32 s70, s60, 727040
  buffer_store_dwordx4 v[96:99], v3, s[40:43], s70 offen sc1
  s_xor_b32 s70, s60, 759808
  buffer_store_dwordx4 v[100:103], v3, s[40:43], s70 offen sc1
L_h_e1:
  s_add_u32 s54, s74, 1
  v_lshlrev_b32 v5, 3, v0
  s_waitcnt vmcnt(0)
  v_mov_b32 v8, s54
  v_mov_b32 v9, s75
  s_mov_b64 exec, 0xffff
  buffer_store_dwordx2 v[8:9], v5, s[40:43], s62 offen sc1
  s_mov_b64 exec, 1
  s_mov_b32 s59, 0
L_h_flaga:
  buffer_load_dwordx2 v[10:11], v5, s[40:43], s63 offen sc1
  s_waitcnt vmcnt(0)
  v_readfirstlane_b32 s56, v10
  v_readfirstlane_b32 s57, v11
  s_nop 0
  s_sub_u32 s56, s56, s54
  s_xor_b32 s57, s57, s75
  s_lshr_b32 s56, s56, 1
  s_or_b32 s56, s56, s57
  s_cbranch_scc0 L_h_flaga_done
  s_add_u32 s59, s59, 1
  s_cmp_gt_u32 s59, 100000
  s_cbranch_scc1 L_h_flaga_done
  s_sleep 8
  s_branch L_h_flaga
L_h_flaga_done:
  s_mov_b64 exec, -1
  s_bfe_u32 s54, s96, 0x10005
  s_mul_i32 s54, s54, 384
  v_lshrrev_b32 v4, 3, v0
  v_add_u32 v5, 0, v4
  v_mul_u32_u24 v5, 21846, v5
  v_bfe_u32 v5, v5, 16, 1
  v_mul_u32_u24 v6, 384, v5
  v_sub_u32 v6, v3, v6
  v_add_u32 v6, s54, v6
  v_add_u32 v6, 0, v6
  v_mul_u32_u24 v5, 1024, v5
  v_xor_b32 v5, s44, v5
  v_bfe_u32 v2, v6, 10, 1
  v_mul_u32_u24 v2, 32768, v2
  v_xor_b32 v5, v5, v2
  v_bfe_u32 v2, v6, 11, 1
  v_mul_u32_u24 v2, 67584, v2
  v_xor_b32 v5, v5, v2
  v_and_b32 v6, 1023, v6
  v_add_u32 v5, v5, v6
  buffer_load_dwordx4 v[8:11], v5, s[40:43], 0 offen sc1
  v_add_u32 v5, 8, v4
  v_mul_u32_u24 v5, 21846, v5
  v_bfe_u32 v5, v5, 16, 1
  v_mul_u32_u24 v6, 384, v5
  v_sub_u32 v6, v3, v6
  v_add_u32 v6, s54, v6
  v_add_u32 v6, 1024, v6
  v_mul_u32_u24 v5, 1024, v5
  v_xor_b32 v5, s44, v5
  v_bfe_u32 v2, v6, 10, 1
  v_mul_u32_u24 v2, 32768, v2
  v_xor_b32 v5, v5, v2
  v_bfe_u32 v2, v6, 11, 1
  v_mul_u32_u24 v2, 67584, v2
  v_xor_b32 v5, v5, v2
  v_and_b32 v6, 1023, v6
  v_add_u32 v5, v5, v6
  buffer_load_dwordx4 v[12:15], v5, s[40:43], 0 offen sc1
  v_add_u32 v5, 16, v4
  v_mul_u32_u24 v5, 21846, v5
  v_bfe_u32 v5, v5, 16, 1
  v_mul_u32_u24 v6, 384, v5
  v_sub_u32 v6, v3, v6
  v_add_u32 v6, s54, v6
  v_add_u32 v6, 2048, v6
  v_mul_u32_u24 v5, 1024, v5
  v_xor_b32 v5, s44, v5
  v_bfe_u32 v2, v6, 10, 1
  v_mul_u32_u24 v2, 32768, v2
  v_xor_b32 v5, v5, v2
  v_bfe_u32 v2, v6, 11, 1
  v_mul_u32_u24 v2, 67584, v2
  v_xor_b32 v5, v5, v2
  v_and_b32 v6, 1023, v6
  v_add_u32 v5, v5, v6
  buffer_load_dwordx4 v[16:19], v5, s[40:43], 0 offen sc1
  s_bitcmp0_b32 s58, 2
  s_cbranch_scc1 L_h_i0
  s_xor_b32 s70, s61, 100352
  buffer_load_dwordx4 v[20:23], v3, s[40:43], s70 offen sc1
  s_xor_b32 s70, s61, 136192
  buffer_load_dwordx4 v[24:27], v3, s[40:43], s70 offen sc1
  s_xor_b32 s70, s61, 168960
  buffer_load_dwordx4 v[28:31], v3, s[40:43], s70 offen sc1
  s_xor_b32 s70, s61, 203776
  buffer_load_dwordx4 v[32:35], v3, s[40:43], s70 offen sc1
  s_xor_b32 s70, s61, 236544
  buffer_load_dwordx4 v[36:39], v3, s[40:43], s70 offen sc1
  s_xor_b32 s70, s61, 272384
  buffer_load_dwordx4 v[40:43], v3, s[40:43], s70 offen sc1
  s_xor_b32 s70, s61, 305152
  buffer_load_dwordx4 v[44:47], v3, s[40:43], s70 offen sc1
  s_xor_b32 s70, s61, 335872
  buffer_load_dwordx4 v[48:51], v3, s[40:43], s70 offen sc1
  s_xor_b32 s70, s61, 368640
  buffer_load_dwordx4 v[52:55], v3, s[40:43], s70 offen sc1
  s_waitcnt vmcnt(0)
  ds_write_b128 v3, v[20:23] offset:3072
  ds_write_b128 v3, v[24:27] offset:4096
  ds_write_b128 v3, v[28:31] offset:5120
  ds_write_b128 v3, v[32:35] offset:6144
  ds_write_b128 v3, v[36:39] offset:7168
  ds_write_b128 v3, v[40:43] offset:8192
  ds_write_b128 v3, v[44:47] offset:9216
  ds_write_b128 v3, v[48:51] offset:10240
  ds_write_b128 v3, v[52:55] offset:11264
L_h_i0:
  s_bitcmp0_b32 s58, 0
  s_cbranch_scc1 L_h_i1
  s_xor_b32 s70, s61, 408576
  buffer_load_dwordx4 v[56:59], v3, s[40:43], s70 offen sc1
  s_xor_b32 s70, s61, 441344
  buffer_load_dwordx4 v[60:63], v3, s[40:43], s70 offen sc1
  s_xor_b32 s70, s61, 472064
  buffer_load_dwordx4 v[64:67], v3, s[40:43], s70 offen sc1
  s_xor_b32 s70, s61, 504832
  buffer_load_dwordx4 v[68:71], v3, s[40:43], s70 offen sc1
  s_xor_b32 s70, s61, 525312
  buffer_load_dwordx4 v[72:75], v3, s[40:43], s70 offen sc1
  s_xor_b32 s70, s61, 558080
  buffer_load_dwordx4 v[76:79], v3, s[40:43], s70 offen sc1
  s_xor_b32 s70, s61, 592896
  buffer_load_dwordx4 v[80:83], v3, s[40:43], s70 offen sc1
  s_xor_b32 s70, s61, 625664
  buffer_load_dwordx4 v[84:87], v3, s[40:43], s70 offen sc1
  s_xor_b32 s70, s61, 659456
  buffer_load_dwordx4 v[88:91], v3, s[40:43], s70 offen sc1
  s_xor_b32 s70, s61, 692224
  buffer_load_dwordx4 v[92:95], v3, s[40:43], s70 offen sc1
  s_xor_b32 s70, s61, 727040
  buffer_load_dwordx4 v[96:99], v3, s[40:43], s70 offen sc1
  s_xor_b32 s70, s61, 759808
  buffer_load_dwordx4 v[100:103], v3, s[40:43], s70 offen sc1
  s_waitcnt vmcnt(0)
  ds_write_b128 v3, v[56:59] offset:12288
  ds_write_b128 v3, v[60:63] offset:13312
  ds_write_b128 v3, v[64:67] offset:14336
  ds_write_b128 v3, v[68:71] offset:15360
  ds_write_b128 v3, v[72:75] offset:16384
  ds_write_b128 v3, v[76:79] offset:17408
  ds_write_b128 v3, v[80:83] offset:18432
  ds_write_b128 v3, v[84:87] offset:19456
  ds_write_b128 v3, v[88:91] offset:20480
  ds_write_b128 v3, v[92:95] offset:21504
  ds_write_b128 v3, v[96:99] offset:22528
  ds_write_b128 v3, v[100:103] offset:23552
L_h_i1:
  s_waitcnt vmcnt(0)
  ds_write_b128 v3, v[8:11] offset:0
  ds_write_b128 v3, v[12:15] offset:1024
  ds_write_b128 v3, v[16:19] offset:2048
  s_bitcmp0_b32 s58, 1
  s_cselect_b32 s70, 255, 32
  v_mov_b32 v1, 61700
  v_mov_b32 v5, s70
  ds_write_b32 v1, v5
  s_mov_b32 s78, 94
  s_swappc_b64 s[84:85], s[86:87]
  s_bitcmp0_b32 s58, 1
  s_cbranch_scc1 L_h_all
L_h_progb:
  s_sleep 4
  ds_read_b32 v8, v112
  s_waitcnt lgkmcnt(0)
  v_cmp_gt_u32 vcc, 96, v8
  s_nop 1
  s_cmp_lg_u32 vcc_lo, 0
  s_cbranch_scc1 L_h_progb
  ds_read_b128 v[8:11], v3 offset:24576
  ds_read_b128 v[12:15], v3 offset:25600
  ds_read_b128 v[16:19], v3 offset:26624
  ds_read_b128 v[20:23], v3 offset:27648
  ds_read_b128 v[24:27], v3 offset:28672
  ds_read_b128 v[28:31], v3 offset:29696
  ds_read_b128 v[32:35], v3 offset:30720
  ds_read_b128 v[36:39], v3 offset:31744
  ds_read_b128 v[40:43], v3 offset:32768
  ds_read_b128 v[44:47], v3 offset:33792
  ds_read_b128 v[48:51], v3 offset:34816
  ds_read_b128 v[52:55], v3 offset:35840
  s_waitcnt lgkmcnt(0)
  s_xor_b32 s70, s60, 797696
  buffer_store_dwordx4 v[8:11], v3, s[40:43], s70 offen sc1
  s_xor_b32 s70, s60, 830464
  buffer_store_dwordx4 v[12:15], v3, s[40:43], s70 offen sc1
  s_xor_b32 s70, s60, 861184
  buffer_store_dwordx4 v[16:19], v3, s[40:43], s70 offen sc1
  s_xor_b32 s70, s60, 893952
  buffer_store_dwordx4 v[20:23], v3, s[40:43], s70 offen sc1
  s_xor_b32 s70, s60, 931840
  buffer_store_dwordx4 v[24:27], v3, s[40:43], s70 offen sc1
  s_xor_b32 s70, s60, 964608
  buffer_store_dwordx4 v[28:31], v3, s[40:43], s70 offen sc1
  s_xor_b32 s70, s60, 995328
  buffer_store_dwordx4 v[32:35], v3, s[40:43], s70 offen sc1
  s_xor_b32 s70, s60, 1028096
  buffer_store_dwordx4 v[36:39], v3, s[40:43], s70 offen sc1
  s_xor_b32 s70, s60, 1052672
  buffer_store_dwordx4 v[40:43], v3, s[40:43], s70 offen sc1
  s_xor_b32 s70, s60, 1085440
  buffer_store_dwordx4 v[44:47], v3, s[40:43], s70 offen sc1
  s_xor_b32 s70, s60, 1120256
  buffer_store_dwordx4 v[48:51], v3, s[40:43], s70 offen sc1
  s_xor_b32 s70, s60, 1153024
  buffer_store_dwordx4 v[52:55], v3, s[40:43], s70 offen sc1
  s_add_u32 s54, s74, 2
  v_lshlrev_b32 v5, 3, v0
  s_waitcnt vmcnt(0)
  v_mov_b32 v8, s54
  v_mov_b32 v9, s75
  s_mov_b64 exec, 0xffff
  buffer_store_dwordx2 v[8:9], v5, s[40:43], s62 offen sc1
  s_mov_b64 exec, 1
  s_mov_b32 s59, 0
L_h_flagb:
  buffer_load_dwordx2 v[10:11], v5, s[40:43], s63 offen sc1
  s_waitcnt vmcnt(0)
  v_readfirstlane_b32 s56, v10
  v_readfirstlane_b32 s57, v11
  s_nop 0
  s_sub_u32 s56, s56, s54
  s_xor_b32 s57, s57, s75
  s_lshr_b32 s56, s56, 1
  s_or_b32 s56, s56, s57
  s_cbranch_scc0 L_h_flagb_done
  s_add_u32 s59, s59, 1
  s_cmp_gt_u32 s59, 100000
  s_cbranch_scc1 L_h_flagb_done
  s_sleep 8
  s_branch L_h_flagb
L_h_flagb_done:
  s_mov_b64 exec, -1
  s_xor_b32 s70, s61, 797696
  buffer_load_dwordx4 v[8:11], v3, s[40:43], s70 offen sc1
  s_xor_b32 s70, s61, 830464
  buffer_load_dwordx4 v[12:15], v3, s[40:43], s70 offen sc1
  s_xor_b32 s70, s61, 861184
  buffer_load_dwordx4 v[16:19], v3, s[40:43], s70 offen sc1
  s_xor_b32 s70, s61, 893952
  buffer_load_dwordx4 v[20:23], v3, s[40:43], s70 offen sc1
  s_xor_b32 s70, s61, 931840
  buffer_load_dwordx4 v[24:27], v3, s[40:43], s70 offen sc1
  s_xor_b32 s70, s61, 964608
  buffer_load_dwordx4 v[28:31], v3, s[40:43], s70 offen sc1
  s_xor_b32 s70, s61, 995328
  buffer_load_dwordx4 v[32:35], v3, s[40:43], s70 offen sc1
  s_xor_b32 s70, s61, 1028096
  buffer_load_dwordx4 v[36:39], v3, s[40:43], s70 offen sc1
  s_xor_b32 s70, s61, 1052672
  buffer_load_dwordx4 v[40:43], v3, s[40:43], s70 offen sc1
  s_xor_b32 s70, s61, 1085440
  buffer_load_dwordx4 v[44:47], v3, s[40:43], s70 offen sc1
  s_xor_b32 s70, s61, 1120256
  buffer_load_dwordx4 v[48:51], v3, s[40:43], s70 offen sc1
  s_xor_b32 s70, s61, 1153024
  buffer_load_dwordx4 v[52:55], v3, s[40:43], s70 offen sc1
  s_waitcnt vmcnt(0)
  ds_write_b128 v3, v[8:11] offset:24576
  ds_write_b128 v3, v[12:15] offset:25600
  ds_write_b128 v3, v[16:19] offset:26624
  ds_write_b128 v3, v[20:23] offset:27648
  ds_write_b128 v3, v[24:27] offset:28672
  ds_write_b128 v3, v[28:31] offset:29696
  ds_write_b128 v3, v[32:35] offset:30720
  ds_write_b128 v3, v[36:39] offset:31744
  ds_write_b128 v3, v[40:43] offset:32768
  ds_write_b128 v3, v[44:47] offset:33792
  ds_write_b128 v3, v[48:51] offset:34816
  ds_write_b128 v3, v[52:55] offset:35840
  v_mov_b32 v1, 61700
  v_mov_b32 v5, 255
  ds_write_b32 v1, v5
L_h_all:
  s_mov_b32 s78, 186
  s_swappc_b64 s[84:85], s[86:87]
L_h_progt:
  s_sleep 4
  ds_read_b32 v8, v112
  s_waitcnt lgkmcnt(0)
  v_cmp_gt_u32 vcc, 188, v8
  s_nop 1
  s_cmp_lg_u32 vcc_lo, 0
  s_cbranch_scc1 L_h_progt
  v_mov_b32 v8, 255
  ds_write_b32 v112, v8 offset:8
  s_branch L_finish
L_h_cp:
  s_cmp_gt_u32 s76, s78
  s_cbranch_scc0 L_h_cpgo
  s_setpc_b64 s[84:85]
L_h_cpgo:
  ds_read_b32 v8, v112
  s_waitcnt lgkmcnt(0)
  v_cmp_gt_u32 vcc, s76, v8
  s_nop 1
  s_cmp_eq_u32 vcc_lo, 0
  s_cbranch_scc1 L_h_cpnext
L_h_first:
  s_sleep 2
  ds_read_b32 v8, v112
  s_waitcnt lgkmcnt(0)
  v_cmp_gt_u32 s[48:49], s76, v8
  s_nop 1
  s_cmp_eq_u32 s48, -1
  s_cbranch_scc1 L_h_first
  s_memrealtime s[54:55]
L_h_progm:
  s_sleep 2
  ds_read_b32 v8, v112
  s_waitcnt lgkmcnt(0)
  v_cmp_gt_u32 vcc, s76, v8
  s_nop 1
  s_cmp_lg_u32 vcc_lo, 0
  s_cbranch_scc1 L_h_progm
  s_memrealtime s[56:57]
  v_mov_b32 v114, s54
  v_mov_b32 v115, s55
  s_mov_b64 exec, s[48:49]
  s_waitcnt lgkmcnt(0)
  v_mov_b32 v114, s56
  v_mov_b32 v115, s57
  s_mov_b64 exec, -1
  s_cmp_ge_u32 s2, 8
  s_cbranch_scc1 L_h_np
  s_mov_b64 exec, 0xff
  buffer_store_dwordx2 v[114:115], v104, s[40:43], s77 offen sc1
  s_mov_b64 exec, -1
L_h_np:
  s_add_u32 s50, s76, 2
L_h_progc:
  s_sleep 4
  ds_read_b32 v8, v112
  s_waitcnt lgkmcnt(0)
  v_cmp_gt_u32 vcc, s50, v8
  s_nop 1
  s_cmp_lg_u32 vcc_lo, 0
  s_cbranch_scc1 L_h_progc
  buffer_load_dwordx2 v[8:9], v105, s[40:43], s77 offen
  v_mov_b32 v10, s73
  s_waitcnt vmcnt(0)
  ds_read_b32 v12, v112
  v_subrev_co_u32 v8, vcc, s72, v8
  s_nop 1
  v_subb_co_u32 v9, vcc, v9, v10, vcc
  v_lshrrev_b32 v10, 24, v8
  v_or_b32 v9, v9, v10
  v_cmp_eq_u32 vcc, 0, v9
  s_nop 1
  v_cndmask_b32 v8, 0, v8, vcc
  s_and_b32 s56, vcc_lo, 0xffff
  s_bcnt1_i32_b32 s56, s56
  v_add_u32_dpp v8, v8, v8 row_ror:8 row_mask:0xf bank_mask:0xf
  s_nop 1
  v_add_u32_dpp v8, v8, v8 row_ror:4 row_mask:0xf bank_mask:0xf
  s_nop 1
  v_add_u32_dpp v8, v8, v8 row_ror:2 row_mask:0xf bank_mask:0xf
  s_nop 1
  v_add_u32_dpp v8, v8, v8 row_ror:1 row_mask:0xf bank_mask:0xf
  v_subrev_u32 v9, s72, v114
  v_mul_lo_u32 v9, v9, s56
  s_max_u32 s56, s56, 1
  v_sub_u32 v8, v9, v8
  v_cvt_f32_u32 v9, s56
  v_cvt_f32_i32 v8, v8
  v_rcp_f32 v9, v9
  s_nop 0
  v_mul_f32 v8, v8, v9
  v_cvt_i32_f32 v8, v8
  s_waitcnt lgkmcnt(0)
  v_add_u32 v12, 2, v12
  v_min_u32 v9, v113, v12
  v_subrev_u32 v9, s76, v9
  v_max_i32 v9, 0, v9
  v_lshrrev_b32 v9, 1, v9
  v_mul_u32_u24 v9, 32, v9
  v_sub_u32 v8, v8, v9
  v_add_u32 v9, 46, v8
  v_max_i32 v9, 0, v9
  v_min_i32 v9, 2000, v9
  v_mul_u32_u24 v9, 2048, v9
  v_lshrrev_b32 v9, 16, v9
  v_cmp_ne_u32 vcc, 0, v9
  v_lshl_add_u32 v9, v9, 1, v12
  s_nop 0
  v_cndmask_b32 v113, 0, v9, vcc
  ds_write_b32 v112, v113 offset:8
L_h_cpnext:
  s_add_u32 s76, s76, 4
  s_add_u32 s77, s77, 512
  s_branch L_h_cp
L_code_end:
.section .rodata,"a"
.p2align 6
.amdhsa_kernel standalone__kv_cache_quant_int4_int2_kv_with_per_channel_or_per_token_scales__sampling_kernel
  .amdhsa_next_free_vgpr 256
  .amdhsa_next_free_sgpr 102
  .amdhsa_accum_offset 256
  .amdhsa_group_segment_fixed_size 0
  .amdhsa_kernarg_size 80
  .amdhsa_user_sgpr_count 2
  .amdhsa_user_sgpr_kernarg_segment_ptr 1
  .amdhsa_system_sgpr_workgroup_id_x 1
  .amdhsa_float_denorm_mode_32 3
.end_amdhsa_kernel
```

```asm
; @launch grid=(256,1,1) block=(192,1,1) lds=62464
.amdgcn_target "amdgcn-amd-amdhsa--gfx950"
.text
.globl standalone__kv_cache_quant_int4_int2_kv_with_per_channel_or_per_token_scales__sampling_kernel
.p2align 8
.type standalone__kv_cache_quant_int4_int2_kv_with_per_channel_or_per_token_scales__sampling_kernel,@function
standalone__kv_cache_quant_int4_int2_kv_with_per_channel_or_per_token_scales__sampling_kernel:
  s_cmp_ge_u32 s2, 256
  s_cbranch_scc1 L_end
  s_load_dwordx16 s[44:59], s[0:1], 0
  s_load_dwordx4 s[80:83], s[0:1], 64
  v_lshrrev_b32 v1, 6, v0
  v_and_b32 v0, 63, v0
  v_readfirstlane_b32 s3, v1
  s_bfe_u32 s4, s2, 0x10002
  s_lshr_b32 s5, s2, 3
  s_lshl_b32 s5, s5, 2
  s_and_b32 s70, s2, 3
  s_add_u32 s5, s5, s70
  s_lshl_b32 s5, s5, 5
  s_mov_b32 s22, 6291456
  s_mov_b32 s23, 0x20000
  s_mov_b32 s26, 6291456
  s_mov_b32 s27, 0x20000
  s_mov_b32 s30, 2097152
  s_mov_b32 s31, 0x20000
  s_mov_b32 s34, 2097152
  s_mov_b32 s35, 0x20000
  s_mov_b32 s10, 805306368
  s_mov_b32 s11, 0x20000
  s_mov_b32 s38, 393216
  s_mov_b32 s39, 0x20000
  s_mov_b32 s18, 805306368
  s_mov_b32 s19, 0x20000
  s_mov_b32 s14, 805306368
  s_mov_b32 s15, 0x20000
  s_mov_b32 s42, 33554432
  s_mov_b32 s43, 0x20000
  s_cmp_eq_u32 s3, 2
  s_cbranch_scc1 L_helper
  v_and_b32 v108, 3, v0
  v_bfe_u32 v109, v0, 2, 2
  v_lshrrev_b32 v110, 4, v0
  v_and_b32 v111, 15, v0
  v_lshlrev_b32 v144, 4, v108
  v_lshl_add_u32 v144, v110, 6, v144
  v_lshrrev_b32 v233, 1, v144
  v_and_b32 v231, 2, v109
  v_lshlrev_b32 v230, 5, v231
  v_add_u32 v230, 129, v230
  v_and_b32 v145, 1, v109
  v_lshl_add_u32 v231, v145, 2, v231
  v_mul_u32_u24 v145, 33024, v145
  v_add_u32 v232, v144, v145
  v_subrev_u32 v232, 33024, v232
  v_mul_u32_u24 v145, 384, v109
  v_add_u32 v235, v145, v233
  v_mov_b32 v105, 2147483632
  s_mov_b32 s90, 0xaaaaaaab
  s_mov_b32 s91, 0x492492
  s_movk_i32 s63, 768
  s_mov_b32 s64, s3
  s_mov_b32 s99, 8
  s_mov_b32 s96, 0
  v_lshlrev_b32 v114, 4, v0
  s_lshl_b32 s86, s5, 9
  s_mul_i32 s70, s3, 3072
  s_add_u32 s71, s86, 0
  s_mul_hi_u32 s71, s71, s90
  s_lshr_b32 s71, s71, 8
  s_lshl_b32 s71, s71, 7
  s_add_u32 s88, s71, s70
  s_add_u32 s71, s86, 2097152
  s_mul_hi_u32 s71, s71, s90
  s_lshr_b32 s71, s71, 8
  s_lshl_b32 s71, s71, 7
  s_add_u32 s68, s71, s70
  s_add_u32 s71, s86, 4194304
  s_mul_hi_u32 s71, s71, s90
  s_lshr_b32 s71, s71, 8
  s_lshl_b32 s71, s71, 7
  s_add_u32 s69, s71, s70
  s_lshl_b32 s70, s3, 13
  s_add_u32 s86, s86, s70
  s_mov_b32 s74, 6291456
  s_mov_b32 s75, 0x20000
  s_mov_b32 s78, 2097152
  s_mov_b32 s79, 0x20000
  s_waitcnt lgkmcnt(0)
  s_cmp_eq_u32 s4, 0
  s_cselect_b64 s[72:73], s[50:51], s[52:53]
  s_cselect_b64 s[76:77], s[54:55], s[56:57]
  s_and_b32 s73, s73, 0xffff
  s_and_b32 s77, s77, 0xffff
  buffer_load_dwordx4 v[128:131], v114, s[72:75], s86 offen offset:0
  buffer_load_dwordx4 v[128:131], v114, s[76:79], s88 offen offset:0
  buffer_load_dwordx4 v[128:131], v114, s[72:75], s86 offen offset:1024
  buffer_load_dwordx4 v[128:131], v114, s[76:79], s88 offen offset:1024
  buffer_load_dwordx4 v[128:131], v114, s[72:75], s86 offen offset:2048
  buffer_load_dwordx4 v[128:131], v114, s[76:79], s88 offen offset:2048
  buffer_load_dwordx4 v[128:131], v114, s[72:75], s86 offen offset:3072
  buffer_load_dwordx4 v[128:131], v114, s[76:79], s68 offen offset:0
  s_mov_b32 s20, s50
  s_and_b32 s21, s51, 0xffff
  s_mov_b32 s24, s52
  s_and_b32 s25, s53, 0xffff
  s_mov_b32 s28, s54
  s_and_b32 s29, s55, 0xffff
  s_mov_b32 s32, s56
  s_and_b32 s33, s57, 0xffff
  s_mov_b32 s8, s46
  s_and_b32 s9, s47, 0xffff
  s_mov_b32 s36, s44
  s_and_b32 s37, s45, 0xffff
  s_mov_b32 s16, s46
  s_and_b32 s17, s47, 0xffff
  s_mov_b32 s12, s48
  s_and_b32 s13, s49, 0xffff
  s_mov_b32 s40, s82
  s_and_b32 s41, s83, 0xffff
  s_mov_b64 s[46:47], s[58:59]
  s_mov_b32 s56, 0x0f0f0f0f
  s_mov_b32 s57, 0x0f0f0f0f
  s_mov_b32 s58, 0xffff
  s_mov_b32 s59, 0xffff
  s_lshr_b32 s71, s64, 4
  s_andn2_b32 s71, s71, 1
  s_lshr_b32 s71, 0x12, s71
  s_and_b32 s71, s71, 3
  s_lshr_b32 s85, s96, s71
  s_andn2_b32 s70, s64, 1
  s_or_b32 s70, s70, s4
  s_cmp_lt_u32 s64, 8
  s_cselect_b32 s70, s70, s64
  s_cselect_b32 s85, s64, s85
  s_and_b32 s85, s85, 1
  s_and_b32 s70, s70, 31
  s_lshl_b32 s71, s71, 12
  s_add_u32 s70, s70, s5
  s_add_u32 s70, s70, s71
  s_mul_hi_u32 s84, s70, s90
  s_lshr_b32 s84, s84, 1
  s_mul_i32 s71, s84, 3
  s_sub_u32 s70, s70, s71
  s_lshl3_add_u32 s85, s70, s85
  s_mul_i32 s61, s84, 196608
  s_lshr_b32 s89, s84, 4
  s_lshl_b32 s70, s85, 5
  v_add_u32 v97, s70, v230
  v_mul_u32_u24 v97, 21846, v97
  v_lshrrev_b32 v97, 16, v97
  v_add_u32 v144, s85, v231
  v_lshrrev_b32 v145, v144, s91
  v_and_b32 v145, 1, v145
  v_cmp_eq_u32 s[54:55], 1, v145
  s_nop 1
  s_and_b64 s[52:53], s[54:55], s[56:57]
  s_andn2_b64 s[54:55], s[54:55], s[56:57]
  v_mul_u32_u24 v144, 43, v144
  v_lshrrev_b32 v144, 8, v144
  v_mul_u32_u24 v144, 384, v144
  v_add_u32 v234, v144, v233
  v_mad_u32_u24 v92, v97, s63, v232
  v_add_u32 v93, 768, v92
  v_add_u32 v94, 4608, v92
  v_add_u32 v95, 7680, v92
  v_cndmask_b32 v92, v92, v105, s[52:53]
  v_cndmask_b32 v95, v95, v105, s[54:55]
  s_mov_b32 s60, s61
  s_mul_i32 s70, s89, 1536
  buffer_load_dwordx2 v[174:175], v235, s[36:39], s70 offen offset:0
  buffer_load_dwordx2 v[176:177], v235, s[36:39], s70 offen offset:128
  buffer_load_dwordx2 v[178:179], v235, s[36:39], s70 offen offset:256
  buffer_load_dwordx4 v[4:7], v92, s[8:11], s60 offen offset:0 nt
  s_add_u32 s86, s86, 4096
  buffer_load_dwordx4 v[128:131], v114, s[72:75], s86 offen offset:0
  buffer_load_dwordx4 v[128:131], v114, s[76:79], s68 offen offset:1024
  buffer_load_dwordx4 v[128:131], v114, s[72:75], s86 offen offset:1024
  buffer_load_dwordx4 v[128:131], v114, s[76:79], s68 offen offset:2048
  buffer_load_dwordx4 v[128:131], v114, s[72:75], s86 offen offset:2048
  buffer_load_dwordx4 v[128:131], v114, s[76:79], s69 offen offset:0
  buffer_load_dwordx4 v[128:131], v114, s[72:75], s86 offen offset:3072
  buffer_load_dwordx4 v[128:131], v114, s[76:79], s69 offen offset:1024
  s_add_u32 s86, s86, 2093056
  buffer_load_dwordx4 v[128:131], v114, s[72:75], s86 offen offset:0
  buffer_load_dwordx4 v[128:131], v114, s[76:79], s69 offen offset:2048
  buffer_load_dwordx4 v[128:131], v114, s[72:75], s86 offen offset:1024
  buffer_load_dwordx4 v[128:131], v114, s[72:75], s86 offen offset:2048
  buffer_load_dwordx4 v[128:131], v114, s[72:75], s86 offen offset:3072
  s_add_u32 s86, s86, 4096
  buffer_load_dwordx4 v[128:131], v114, s[72:75], s86 offen offset:0
  buffer_load_dwordx4 v[128:131], v114, s[72:75], s86 offen offset:1024
  buffer_load_dwordx4 v[128:131], v114, s[72:75], s86 offen offset:2048
  s_barrier
  s_mov_b64 vcc, 0
  v_lshlrev_b32 v144, 4, v111
  v_and_b32 v2, 2, v110
  v_lshlrev_b32 v1, 5, v2
  v_add_u32 v1, 129, v1
  v_and_b32 v145, 1, v110
  v_lshl_add_u32 v2, v145, 2, v2
  v_mul_u32_u24 v145, 33024, v145
  v_add_u32 v3, v144, v145
  v_subrev_u32 v3, 33024, v3
  v_and_b32 v145, 1, v110
  v_mul_u32_u24 v145, 86, v145
  v_lshl_add_u32 v96, v111, 1, v145
  v_subrev_u32 v96, 86, v96
  v_lshlrev_b32 v101, 4, v110
  v_lshrrev_b32 v144, 2, v0
  s_mul_i32 s70, s3, 384
  v_lshl_add_u32 v99, v144, 4, s70
  v_lshl_add_u32 v100, v144, 3, s70
  s_mul_i32 s70, s3, 3072
  s_add_u32 s70, s70, 36864
  v_lshl_add_u32 v102, v0, 4, s70
  s_lshl_b32 s70, s3, 5
  s_add_u32 s70, s70, 43008
  v_lshl_add_u32 v103, v109, 3, s70
  s_lshl2_add_u32 s70, s3, 61712
  v_mov_b32 v104, s70
  v_mov_b32 v112, 0
  v_mov_b32 v113, 0
  v_mov_b32 v236, 0xff800000
  v_mov_b32 v146, 1
  s_mov_b32 s65, 0xffff0000
  s_mov_b32 s66, 0x3fb8aa3b
  s_waitcnt vmcnt(23)
  buffer_load_dwordx4 v[128:131], v114, s[72:75], s86 offen offset:3072
  s_add_u32 s86, s86, 2093056
  s_waitcnt vmcnt(23)
  buffer_load_dwordx4 v[128:131], v114, s[72:75], s86 offen offset:0
  s_waitcnt vmcnt(23)
  buffer_load_dwordx4 v[128:131], v114, s[72:75], s86 offen offset:1024
  s_waitcnt vmcnt(23)
  buffer_load_dwordx4 v[128:131], v114, s[72:75], s86 offen offset:2048
  s_waitcnt vmcnt(23)
  buffer_load_dwordx4 v[128:131], v114, s[72:75], s86 offen offset:3072
  s_add_u32 s86, s86, 4096
  s_waitcnt vmcnt(23)
  buffer_load_dwordx4 v[128:131], v114, s[72:75], s86 offen offset:0
  s_waitcnt vmcnt(23)
  buffer_load_dwordx4 v[128:131], v114, s[72:75], s86 offen offset:1024
  s_waitcnt vmcnt(23)
  buffer_load_dwordx4 v[128:131], v114, s[72:75], s86 offen offset:2048
  s_waitcnt vmcnt(23)
  buffer_load_dwordx4 v[128:131], v114, s[72:75], s86 offen offset:3072
  s_mov_b32 s68, 0x3d93cd3a
  s_mov_b32 s69, 0x3d93cd3a
  s_mov_b32 s72, 0x11111111
  s_mov_b32 s73, 0x11111111
  s_mov_b32 s74, 0x22222222
  s_mov_b32 s75, 0x22222222
  s_mov_b32 s76, 0x44444444
  s_mov_b32 s77, 0x44444444
  s_mov_b32 s78, 0x88888888
  s_mov_b32 s79, 0x88888888
  ds_write_b32 v104, v146
  s_mov_b32 s88, s89
  s_mul_i32 s62, s84, 1536
  buffer_load_dwordx2 v[180:181], v234, s[20:23], s62 offen offset:0
  buffer_load_dwordx2 v[186:187], v234, s[24:27], s62 offen offset:0
  buffer_load_dwordx2 v[182:183], v234, s[20:23], s62 offen offset:128
  buffer_load_dwordx2 v[188:189], v234, s[24:27], s62 offen offset:128
  buffer_load_dwordx2 v[184:185], v234, s[20:23], s62 offen offset:256
  buffer_load_dwordx2 v[190:191], v234, s[24:27], s62 offen offset:256
  s_waitcnt vmcnt(15)
  buffer_load_dwordx4 v[8:11], v92, s[8:11], s60 offen offset:256 nt
  s_waitcnt vmcnt(15)
  buffer_load_dwordx4 v[12:15], v92, s[8:11], s60 offen offset:512 nt
  s_waitcnt vmcnt(15)
  buffer_load_dwordx4 v[16:19], v93, s[8:11], s60 offen offset:0 nt
  s_waitcnt vmcnt(15)
  buffer_load_dwordx4 v[20:23], v93, s[8:11], s60 offen offset:256 nt
  s_waitcnt vmcnt(15)
  buffer_load_dwordx4 v[24:27], v93, s[8:11], s60 offen offset:512 nt
  s_waitcnt vmcnt(15)
  buffer_load_dwordx4 v[28:31], v93, s[8:11], s60 offen offset:768 nt
  s_waitcnt vmcnt(15)
  buffer_load_dwordx4 v[32:35], v93, s[8:11], s60 offen offset:1024 nt
  s_waitcnt vmcnt(15)
  buffer_load_dwordx4 v[36:39], v93, s[8:11], s60 offen offset:1280 nt
  s_waitcnt vmcnt(15)
  buffer_load_dwordx4 v[40:43], v93, s[8:11], s60 offen offset:1536 nt
  s_waitcnt vmcnt(15)
  buffer_load_dwordx4 v[44:47], v93, s[8:11], s60 offen offset:1792 nt
  s_waitcnt vmcnt(16)
  buffer_load_dwordx4 v[48:51], v93, s[8:11], s60 offen offset:2048 nt
  s_waitcnt vmcnt(17)
  buffer_load_dwordx4 v[52:55], v93, s[8:11], s60 offen offset:2304 nt
  s_waitcnt vmcnt(18)
  buffer_load_dwordx4 v[56:59], v93, s[8:11], s60 offen offset:2560 nt
  s_waitcnt vmcnt(19)
  buffer_load_dwordx4 v[60:63], v93, s[8:11], s60 offen offset:2816 nt
  s_waitcnt vmcnt(14)
L_k:
  v_add_u32 v144, s85, v2
  v_lshrrev_b32 v145, v144, s91
  v_and_b32 v145, 1, v145
  v_cmp_eq_u32 s[50:51], 1, v145
  s_nop 1
  s_and_b64 s[48:49], s[50:51], s[58:59]
  s_andn2_b64 s[50:51], s[50:51], s[58:59]
  s_mov_b32 s97, s64
  s_add_u32 s64, s64, 2
  ds_read_b32 v106, v104 offset:8
  s_waitcnt vmcnt(14)
  s_cbranch_vccnz L_kw0_0
  s_waitcnt vmcnt(9)
L_kw0_0:
  buffer_load_dwordx4 v[64:67], v93, s[8:11], s60 offen offset:3072 nt
  v_lshlrev_b32 v204, 16, v186
  v_and_b32 v205, s65, v186
  v_lshlrev_b32 v206, 16, v187
  v_and_b32 v207, s65, v187
  v_lshlrev_b32 v192, 16, v180
  v_and_b32 v193, s65, v180
  v_lshlrev_b32 v194, 16, v181
  v_and_b32 v195, s65, v181
  v_mov_b32 v168, v174
  v_mov_b32 v169, v175
  v_cvt_f32_i32 v108, v4
  v_cvt_f32_i32 v109, v5
  v_cvt_f32_i32 v110, v6
  v_cvt_f32_i32 v111, v7
  v_pk_add_f32 v[108:109], v[108:109], v[204:205] neg_lo:[0,1] neg_hi:[0,1]
  v_pk_add_f32 v[110:111], v[110:111], v[206:207] neg_lo:[0,1] neg_hi:[0,1]
  v_cvt_pk_bf16_f32 v108, 0, v108
  v_cvt_pk_bf16_f32 v109, 0, v109
  v_cvt_pk_bf16_f32 v110, 0, v110
  v_cvt_pk_bf16_f32 v111, 0, v111
  v_pk_mul_f32 v[108:109], v[108:109], v[192:193]
  v_pk_mul_f32 v[110:111], v[110:111], v[194:195]
  v_cvt_pk_bf16_f32 v216, v108, v109
  v_cvt_pk_bf16_f32 v217, v110, v111
  s_waitcnt lgkmcnt(0)
  v_cmp_lt_u32 vcc, s97, v106
  s_waitcnt vmcnt(14)
  buffer_load_dwordx4 v[68:71], v93, s[8:11], s60 offen offset:3328 nt
  v_lshlrev_b32 v208, 16, v188
  v_and_b32 v209, s65, v188
  v_lshlrev_b32 v210, 16, v189
  v_and_b32 v211, s65, v189
  v_lshlrev_b32 v196, 16, v182
  v_and_b32 v197, s65, v182
  v_lshlrev_b32 v198, 16, v183
  v_and_b32 v199, s65, v183
  v_mov_b32 v170, v176
  v_mov_b32 v171, v177
  v_cvt_f32_i32 v108, v8
  v_cvt_f32_i32 v109, v9
  v_cvt_f32_i32 v110, v10
  v_cvt_f32_i32 v111, v11
  v_pk_add_f32 v[108:109], v[108:109], v[208:209] neg_lo:[0,1] neg_hi:[0,1]
  v_pk_add_f32 v[110:111], v[110:111], v[210:211] neg_lo:[0,1] neg_hi:[0,1]
  v_cvt_pk_bf16_f32 v108, 0, v108
  v_cvt_pk_bf16_f32 v109, 0, v109
  v_cvt_pk_bf16_f32 v110, 0, v110
  v_cvt_pk_bf16_f32 v111, 0, v111
  v_pk_mul_f32 v[108:109], v[108:109], v[196:197]
  v_pk_mul_f32 v[110:111], v[110:111], v[198:199]
  v_cvt_pk_bf16_f32 v218, v108, v109
  v_cvt_pk_bf16_f32 v219, v110, v111
  s_waitcnt vmcnt(14)
  buffer_load_dwordx4 v[72:75], v93, s[8:11], s60 offen offset:3584 nt
  v_mfma_f32_16x16x32_bf16 v[224:227], v[216:219], v[168:171], 0
  v_lshlrev_b32 v212, 16, v190
  v_and_b32 v213, s65, v190
  v_lshlrev_b32 v214, 16, v191
  v_and_b32 v215, s65, v191
  v_lshlrev_b32 v200, 16, v184
  v_and_b32 v201, s65, v184
  v_lshlrev_b32 v202, 16, v185
  v_and_b32 v203, s65, v185
  v_mov_b32 v172, v178
  v_mov_b32 v173, v179
  v_cvt_f32_i32 v108, v12
  v_cvt_f32_i32 v109, v13
  v_cvt_f32_i32 v110, v14
  v_cvt_f32_i32 v111, v15
  v_pk_add_f32 v[108:109], v[108:109], v[212:213] neg_lo:[0,1] neg_hi:[0,1]
  v_pk_add_f32 v[110:111], v[110:111], v[214:215] neg_lo:[0,1] neg_hi:[0,1]
  v_cvt_pk_bf16_f32 v108, 0, v108
  v_cvt_pk_bf16_f32 v109, 0, v109
  v_cvt_pk_bf16_f32 v110, 0, v110
  v_cvt_pk_bf16_f32 v111, 0, v111
  v_pk_mul_f32 v[108:109], v[108:109], v[200:201]
  v_pk_mul_f32 v[110:111], v[110:111], v[202:203]
  v_cvt_pk_bf16_f32 v220, v108, v109
  v_cvt_pk_bf16_f32 v221, v110, v111
  s_waitcnt vmcnt(14)
  s_cbranch_vccnz L_kw0_3
  s_waitcnt vmcnt(9)
L_kw0_3:
  buffer_load_dwordx4 v[76:79], v94, s[8:11], s60 offen offset:0 nt
  v_mfma_f32_16x16x16_bf16 v[224:227], v[220:221], v[172:173], v[224:227]
  v_cvt_f32_i32 v108, v16
  v_cvt_f32_i32 v109, v17
  v_cvt_f32_i32 v110, v18
  v_cvt_f32_i32 v111, v19
  v_pk_add_f32 v[108:109], v[108:109], v[204:205] neg_lo:[0,1] neg_hi:[0,1]
  v_pk_add_f32 v[110:111], v[110:111], v[206:207] neg_lo:[0,1] neg_hi:[0,1]
  v_cvt_pk_bf16_f32 v108, 0, v108
  v_cvt_pk_bf16_f32 v109, 0, v109
  v_cvt_pk_bf16_f32 v110, 0, v110
  v_cvt_pk_bf16_f32 v111, 0, v111
  v_pk_mul_f32 v[108:109], v[108:109], v[192:193]
  v_pk_mul_f32 v[110:111], v[110:111], v[194:195]
  v_cvt_pk_bf16_f32 v216, v108, v109
  v_cvt_pk_bf16_f32 v217, v110, v111
  s_waitcnt vmcnt(14)
  buffer_load_dwordx4 v[80:83], v94, s[8:11], s60 offen offset:256 nt
  v_cvt_f32_i32 v108, v20
  v_cvt_f32_i32 v109, v21
  v_cvt_f32_i32 v110, v22
  v_cvt_f32_i32 v111, v23
  v_pk_add_f32 v[108:109], v[108:109], v[208:209] neg_lo:[0,1] neg_hi:[0,1]
  v_pk_add_f32 v[110:111], v[110:111], v[210:211] neg_lo:[0,1] neg_hi:[0,1]
  v_mov_b32_dpp v144, v224 quad_perm:[0,0,0,0] row_mask:0xf bank_mask:0xf
  v_mov_b32_dpp v145, v226 quad_perm:[2,2,2,2] row_mask:0xf bank_mask:0xf
  v_cvt_pk_bf16_f32 v108, 0, v108
  v_cvt_pk_bf16_f32 v109, 0, v109
  v_add_f32_dpp v144, v225, v144 quad_perm:[1,1,1,1] row_mask:0xf bank_mask:0xf
  v_add_f32_dpp v145, v227, v145 quad_perm:[3,3,3,3] row_mask:0xf bank_mask:0xf
  v_cvt_pk_bf16_f32 v110, 0, v110
  v_cvt_pk_bf16_f32 v111, 0, v111
  v_add_f32 v228, v144, v145
  v_pk_mul_f32 v[108:109], v[108:109], v[196:197]
  v_pk_mul_f32 v[110:111], v[110:111], v[198:199]
  v_cvt_pk_bf16_f32 v218, v108, v109
  v_cvt_pk_bf16_f32 v219, v110, v111
  s_waitcnt vmcnt(14)
  buffer_load_dwordx4 v[84:87], v94, s[8:11], s60 offen offset:512 nt
  v_mfma_f32_16x16x32_bf16 v[224:227], v[216:219], v[168:171], 0
  v_cvt_f32_i32 v108, v24
  v_cvt_f32_i32 v109, v25
  v_cvt_f32_i32 v110, v26
  v_cvt_f32_i32 v111, v27
  v_pk_add_f32 v[108:109], v[108:109], v[212:213] neg_lo:[0,1] neg_hi:[0,1]
  v_pk_add_f32 v[110:111], v[110:111], v[214:215] neg_lo:[0,1] neg_hi:[0,1]
  v_cvt_pk_bf16_f32 v108, 0, v108
  v_cndmask_b32 v228, v228, v236, s[48:49]
  v_cvt_pk_bf16_f32 v109, 0, v109
  v_cvt_pk_bf16_f32 v110, 0, v110
  v_cvt_pk_bf16_f32 v111, 0, v111
  v_pk_mul_f32 v[108:109], v[108:109], v[200:201]
  v_pk_mul_f32 v[110:111], v[110:111], v[202:203]
  v_cvt_pk_bf16_f32 v220, v108, v109
  v_cvt_pk_bf16_f32 v221, v110, v111
  s_waitcnt vmcnt(14)
  s_cbranch_vccnz L_kw0_6
  s_waitcnt vmcnt(9)
L_kw0_6:
  buffer_load_dwordx4 v[88:91], v94, s[8:11], s60 offen offset:768 nt
  v_mfma_f32_16x16x16_bf16 v[224:227], v[220:221], v[172:173], v[224:227]
  v_cvt_f32_i32 v108, v28
  v_cvt_f32_i32 v109, v29
  v_cvt_f32_i32 v110, v30
  v_cvt_f32_i32 v111, v31
  v_pk_add_f32 v[108:109], v[108:109], v[204:205] neg_lo:[0,1] neg_hi:[0,1]
  v_pk_add_f32 v[110:111], v[110:111], v[206:207] neg_lo:[0,1] neg_hi:[0,1]
  v_cvt_pk_bf16_f32 v108, 0, v108
  v_cvt_pk_bf16_f32 v109, 0, v109
  v_cvt_pk_bf16_f32 v110, 0, v110
  v_cvt_pk_bf16_f32 v111, 0, v111
  v_pk_mul_f32 v[108:109], v[108:109], v[192:193]
  v_pk_mul_f32 v[110:111], v[110:111], v[194:195]
  v_cvt_pk_bf16_f32 v216, v108, v109
  v_cvt_pk_bf16_f32 v217, v110, v111
  s_waitcnt vmcnt(14)
  buffer_load_dwordx4 v[4:7], v94, s[8:11], s60 offen offset:1024 nt
  v_cvt_f32_i32 v108, v32
  v_cvt_f32_i32 v109, v33
  v_cvt_f32_i32 v110, v34
  v_cvt_f32_i32 v111, v35
  v_pk_add_f32 v[108:109], v[108:109], v[208:209] neg_lo:[0,1] neg_hi:[0,1]
  v_pk_add_f32 v[110:111], v[110:111], v[210:211] neg_lo:[0,1] neg_hi:[0,1]
  v_mov_b32_dpp v144, v224 quad_perm:[0,0,0,0] row_mask:0xf bank_mask:0xf
  v_mov_b32_dpp v145, v226 quad_perm:[2,2,2,2] row_mask:0xf bank_mask:0xf
  v_cvt_pk_bf16_f32 v108, 0, v108
  v_cvt_pk_bf16_f32 v109, 0, v109
  v_add_f32_dpp v144, v225, v144 quad_perm:[1,1,1,1] row_mask:0xf bank_mask:0xf
  v_add_f32_dpp v145, v227, v145 quad_perm:[3,3,3,3] row_mask:0xf bank_mask:0xf
  v_cvt_pk_bf16_f32 v110, 0, v110
  v_cvt_pk_bf16_f32 v111, 0, v111
  v_add_f32 v229, v144, v145
  v_pk_mul_f32 v[108:109], v[108:109], v[196:197]
  v_pk_mul_f32 v[110:111], v[110:111], v[198:199]
  v_cvt_pk_bf16_f32 v218, v108, v109
  v_cvt_pk_bf16_f32 v219, v110, v111
  s_waitcnt vmcnt(14)
  buffer_load_dwordx4 v[8:11], v94, s[8:11], s60 offen offset:1280 nt
  v_mfma_f32_16x16x32_bf16 v[224:227], v[216:219], v[168:171], 0
  v_cvt_f32_i32 v108, v36
  v_cvt_f32_i32 v109, v37
  v_cvt_f32_i32 v110, v38
  v_cvt_f32_i32 v111, v39
  v_pk_add_f32 v[108:109], v[108:109], v[212:213] neg_lo:[0,1] neg_hi:[0,1]
  v_pk_add_f32 v[110:111], v[110:111], v[214:215] neg_lo:[0,1] neg_hi:[0,1]
  v_cvt_pk_bf16_f32 v108, 0, v108
  v_cvt_pk_bf16_f32 v228, 0, v228
  v_cvt_pk_bf16_f32 v109, 0, v109
  v_cvt_pk_bf16_f32 v229, 0, v229
  v_cvt_pk_bf16_f32 v110, 0, v110
  v_pk_mul_f32 v[228:229], v[228:229], s[68:69]
  v_cvt_pk_bf16_f32 v111, 0, v111
  v_cvt_pk_bf16_f32 v120, v228, v229
  v_pk_mul_f32 v[108:109], v[108:109], v[200:201]
  v_pk_mul_f32 v[110:111], v[110:111], v[202:203]
  v_cvt_pk_bf16_f32 v220, v108, v109
  v_cvt_pk_bf16_f32 v221, v110, v111
  s_waitcnt vmcnt(14)
  s_cbranch_vccnz L_kw0_9
  s_waitcnt vmcnt(9)
L_kw0_9:
  buffer_load_dwordx4 v[12:15], v94, s[8:11], s60 offen offset:1536 nt
  v_mfma_f32_16x16x16_bf16 v[224:227], v[220:221], v[172:173], v[224:227]
  v_cvt_f32_i32 v108, v40
  v_cvt_f32_i32 v109, v41
  v_cvt_f32_i32 v110, v42
  v_cvt_f32_i32 v111, v43
  v_pk_add_f32 v[108:109], v[108:109], v[204:205] neg_lo:[0,1] neg_hi:[0,1]
  v_pk_add_f32 v[110:111], v[110:111], v[206:207] neg_lo:[0,1] neg_hi:[0,1]
  v_cvt_pk_bf16_f32 v108, 0, v108
  v_cvt_pk_bf16_f32 v109, 0, v109
  v_cvt_pk_bf16_f32 v110, 0, v110
  v_cvt_pk_bf16_f32 v111, 0, v111
  v_pk_mul_f32 v[108:109], v[108:109], v[192:193]
  v_pk_mul_f32 v[110:111], v[110:111], v[194:195]
  v_cvt_pk_bf16_f32 v216, v108, v109
  v_cvt_pk_bf16_f32 v217, v110, v111
  s_waitcnt vmcnt(14)
  buffer_load_dwordx4 v[16:19], v94, s[8:11], s60 offen offset:1792 nt
  v_cvt_f32_i32 v108, v44
  v_cvt_f32_i32 v109, v45
  v_cvt_f32_i32 v110, v46
  v_cvt_f32_i32 v111, v47
  v_pk_add_f32 v[108:109], v[108:109], v[208:209] neg_lo:[0,1] neg_hi:[0,1]
  v_pk_add_f32 v[110:111], v[110:111], v[210:211] neg_lo:[0,1] neg_hi:[0,1]
  v_mov_b32_dpp v144, v224 quad_perm:[0,0,0,0] row_mask:0xf bank_mask:0xf
  v_mov_b32_dpp v145, v226 quad_perm:[2,2,2,2] row_mask:0xf bank_mask:0xf
  v_cvt_pk_bf16_f32 v108, 0, v108
  v_cvt_pk_bf16_f32 v109, 0, v109
  v_add_f32_dpp v144, v225, v144 quad_perm:[1,1,1,1] row_mask:0xf bank_mask:0xf
  v_add_f32_dpp v145, v227, v145 quad_perm:[3,3,3,3] row_mask:0xf bank_mask:0xf
  v_cvt_pk_bf16_f32 v110, 0, v110
  v_cvt_pk_bf16_f32 v111, 0, v111
  v_add_f32 v228, v144, v145
  v_pk_mul_f32 v[108:109], v[108:109], v[196:197]
  v_pk_mul_f32 v[110:111], v[110:111], v[198:199]
  v_cvt_pk_bf16_f32 v218, v108, v109
  v_cvt_pk_bf16_f32 v219, v110, v111
  s_waitcnt vmcnt(14)
  buffer_load_dwordx4 v[20:23], v94, s[8:11], s60 offen offset:2048 nt
  v_mfma_f32_16x16x32_bf16 v[224:227], v[216:219], v[168:171], 0
  v_cvt_f32_i32 v108, v48
  v_cvt_f32_i32 v109, v49
  v_cvt_f32_i32 v110, v50
  v_cvt_f32_i32 v111, v51
  v_pk_add_f32 v[108:109], v[108:109], v[212:213] neg_lo:[0,1] neg_hi:[0,1]
  v_pk_add_f32 v[110:111], v[110:111], v[214:215] neg_lo:[0,1] neg_hi:[0,1]
  v_cvt_pk_bf16_f32 v108, 0, v108
  v_cvt_pk_bf16_f32 v109, 0, v109
  v_cvt_pk_bf16_f32 v110, 0, v110
  v_cvt_pk_bf16_f32 v111, 0, v111
  v_pk_mul_f32 v[108:109], v[108:109], v[200:201]
  v_pk_mul_f32 v[110:111], v[110:111], v[202:203]
  v_cvt_pk_bf16_f32 v220, v108, v109
  v_cvt_pk_bf16_f32 v221, v110, v111
  s_waitcnt vmcnt(14)
  s_cbranch_vccnz L_kw0_12
  s_waitcnt vmcnt(9)
L_kw0_12:
  buffer_load_dwordx4 v[24:27], v94, s[8:11], s60 offen offset:2304 nt
  v_mfma_f32_16x16x16_bf16 v[224:227], v[220:221], v[172:173], v[224:227]
  v_cvt_f32_i32 v108, v52
  v_cvt_f32_i32 v109, v53
  v_cvt_f32_i32 v110, v54
  v_cvt_f32_i32 v111, v55
  v_pk_add_f32 v[108:109], v[108:109], v[204:205] neg_lo:[0,1] neg_hi:[0,1]
  v_pk_add_f32 v[110:111], v[110:111], v[206:207] neg_lo:[0,1] neg_hi:[0,1]
  v_cvt_pk_bf16_f32 v108, 0, v108
  v_cvt_pk_bf16_f32 v109, 0, v109
  v_cvt_pk_bf16_f32 v110, 0, v110
  v_cvt_pk_bf16_f32 v111, 0, v111
  v_pk_mul_f32 v[108:109], v[108:109], v[192:193]
  v_pk_mul_f32 v[110:111], v[110:111], v[194:195]
  v_cvt_pk_bf16_f32 v216, v108, v109
  v_cvt_pk_bf16_f32 v217, v110, v111
  s_waitcnt vmcnt(14)
  buffer_load_dwordx4 v[28:31], v94, s[8:11], s60 offen offset:2560 nt
  v_cvt_f32_i32 v108, v56
  v_cvt_f32_i32 v109, v57
  v_cvt_f32_i32 v110, v58
  v_cvt_f32_i32 v111, v59
  v_pk_add_f32 v[108:109], v[108:109], v[208:209] neg_lo:[0,1] neg_hi:[0,1]
  v_pk_add_f32 v[110:111], v[110:111], v[210:211] neg_lo:[0,1] neg_hi:[0,1]
  v_mov_b32_dpp v144, v224 quad_perm:[0,0,0,0] row_mask:0xf bank_mask:0xf
  v_mov_b32_dpp v145, v226 quad_perm:[2,2,2,2] row_mask:0xf bank_mask:0xf
  v_cvt_pk_bf16_f32 v108, 0, v108
  v_cvt_pk_bf16_f32 v109, 0, v109
  v_add_f32_dpp v144, v225, v144 quad_perm:[1,1,1,1] row_mask:0xf bank_mask:0xf
  v_add_f32_dpp v145, v227, v145 quad_perm:[3,3,3,3] row_mask:0xf bank_mask:0xf
  v_cvt_pk_bf16_f32 v110, 0, v110
  v_cvt_pk_bf16_f32 v111, 0, v111
  v_add_f32 v229, v144, v145
  v_pk_mul_f32 v[108:109], v[108:109], v[196:197]
  v_pk_mul_f32 v[110:111], v[110:111], v[198:199]
  v_cvt_pk_bf16_f32 v218, v108, v109
  v_cvt_pk_bf16_f32 v219, v110, v111
  s_waitcnt vmcnt(14)
  buffer_load_dwordx4 v[32:35], v94, s[8:11], s60 offen offset:2816 nt
  v_mfma_f32_16x16x32_bf16 v[224:227], v[216:219], v[168:171], 0
  v_cvt_f32_i32 v108, v60
  v_cvt_f32_i32 v109, v61
  v_cvt_f32_i32 v110, v62
  v_cvt_f32_i32 v111, v63
  v_pk_add_f32 v[108:109], v[108:109], v[212:213] neg_lo:[0,1] neg_hi:[0,1]
  v_pk_add_f32 v[110:111], v[110:111], v[214:215] neg_lo:[0,1] neg_hi:[0,1]
  v_cvt_pk_bf16_f32 v108, 0, v108
  v_cvt_pk_bf16_f32 v228, 0, v228
  v_cvt_pk_bf16_f32 v109, 0, v109
  v_cvt_pk_bf16_f32 v229, 0, v229
  v_cvt_pk_bf16_f32 v110, 0, v110
  v_pk_mul_f32 v[228:229], v[228:229], s[68:69]
  v_cvt_pk_bf16_f32 v111, 0, v111
  v_cvt_pk_bf16_f32 v121, v228, v229
  v_pk_mul_f32 v[108:109], v[108:109], v[200:201]
  v_pk_mul_f32 v[110:111], v[110:111], v[202:203]
  v_cvt_pk_bf16_f32 v220, v108, v109
  v_cvt_pk_bf16_f32 v221, v110, v111
  s_waitcnt vmcnt(14)
  s_cbranch_vccnz L_kw0_15
  s_waitcnt vmcnt(9)
L_kw0_15:
  buffer_load_dwordx4 v[36:39], v95, s[8:11], s60 offen offset:0 nt
  v_mfma_f32_16x16x16_bf16 v[224:227], v[220:221], v[172:173], v[224:227]
  v_cvt_f32_i32 v108, v64
  v_cvt_f32_i32 v109, v65
  v_cvt_f32_i32 v110, v66
  v_cvt_f32_i32 v111, v67
  v_pk_add_f32 v[108:109], v[108:109], v[204:205] neg_lo:[0,1] neg_hi:[0,1]
  v_pk_add_f32 v[110:111], v[110:111], v[206:207] neg_lo:[0,1] neg_hi:[0,1]
  v_cvt_pk_bf16_f32 v108, 0, v108
  v_cvt_pk_bf16_f32 v109, 0, v109
  v_cvt_pk_bf16_f32 v110, 0, v110
  v_cvt_pk_bf16_f32 v111, 0, v111
  v_pk_mul_f32 v[108:109], v[108:109], v[192:193]
  v_pk_mul_f32 v[110:111], v[110:111], v[194:195]
  v_cvt_pk_bf16_f32 v216, v108, v109
  v_cvt_pk_bf16_f32 v217, v110, v111
  s_waitcnt vmcnt(14)
  buffer_load_dwordx4 v[40:43], v95, s[8:11], s60 offen offset:256 nt
  v_cvt_f32_i32 v108, v68
  v_cvt_f32_i32 v109, v69
  v_cvt_f32_i32 v110, v70
  v_cvt_f32_i32 v111, v71
  v_pk_add_f32 v[108:109], v[108:109], v[208:209] neg_lo:[0,1] neg_hi:[0,1]
  v_pk_add_f32 v[110:111], v[110:111], v[210:211] neg_lo:[0,1] neg_hi:[0,1]
  v_mov_b32_dpp v144, v224 quad_perm:[0,0,0,0] row_mask:0xf bank_mask:0xf
  v_mov_b32_dpp v145, v226 quad_perm:[2,2,2,2] row_mask:0xf bank_mask:0xf
  v_cvt_pk_bf16_f32 v108, 0, v108
  v_cvt_pk_bf16_f32 v109, 0, v109
  v_add_f32_dpp v144, v225, v144 quad_perm:[1,1,1,1] row_mask:0xf bank_mask:0xf
  v_add_f32_dpp v145, v227, v145 quad_perm:[3,3,3,3] row_mask:0xf bank_mask:0xf
  v_cvt_pk_bf16_f32 v110, 0, v110
  v_cvt_pk_bf16_f32 v111, 0, v111
  v_add_f32 v228, v144, v145
  v_pk_mul_f32 v[108:109], v[108:109], v[196:197]
  v_pk_mul_f32 v[110:111], v[110:111], v[198:199]
  v_cvt_pk_bf16_f32 v218, v108, v109
  v_cvt_pk_bf16_f32 v219, v110, v111
  s_waitcnt vmcnt(14)
  buffer_load_dwordx4 v[44:47], v95, s[8:11], s60 offen offset:512 nt
  v_mfma_f32_16x16x32_bf16 v[224:227], v[216:219], v[168:171], 0
  v_cvt_f32_i32 v108, v72
  v_cvt_f32_i32 v109, v73
  v_cvt_f32_i32 v110, v74
  v_cvt_f32_i32 v111, v75
  v_pk_add_f32 v[108:109], v[108:109], v[212:213] neg_lo:[0,1] neg_hi:[0,1]
  v_pk_add_f32 v[110:111], v[110:111], v[214:215] neg_lo:[0,1] neg_hi:[0,1]
  s_cmp_lt_u32 s64, s99
  s_cbranch_scc1 L_k_known0
L_k_spin0:
  v_mov_b32 v144, 61696
  ds_read_b32 v144, v144
  s_waitcnt lgkmcnt(0)
  v_readfirstlane_b32 s96, v144
  s_nop 1
  s_cmp_eq_u32 s96, 0
  s_cbranch_scc1 L_k_spin0
  s_mov_b32 s99, -1
L_k_known0:
  s_lshr_b32 s71, s64, 4
  s_andn2_b32 s71, s71, 1
  s_lshr_b32 s71, 0x12, s71
  s_and_b32 s71, s71, 3
  s_lshr_b32 s85, s96, s71
  s_andn2_b32 s70, s64, 1
  s_or_b32 s70, s70, s4
  s_cmp_lt_u32 s64, 8
  s_cselect_b32 s70, s70, s64
  s_cselect_b32 s85, s64, s85
  s_and_b32 s85, s85, 1
  s_and_b32 s70, s70, 31
  s_lshl_b32 s71, s71, 12
  s_add_u32 s70, s70, s5
  s_add_u32 s70, s70, s71
  s_mul_hi_u32 s84, s70, s90
  s_lshr_b32 s84, s84, 1
  s_mul_i32 s71, s84, 3
  s_sub_u32 s70, s70, s71
  s_lshl3_add_u32 s85, s70, s85
  s_mul_i32 s61, s84, 196608
  s_lshr_b32 s89, s84, 4
  s_lshl_b32 s70, s85, 5
  v_add_u32 v97, s70, v230
  v_mul_u32_u24 v97, 21846, v97
  v_lshrrev_b32 v97, 16, v97
  v_add_u32 v144, s85, v231
  v_lshrrev_b32 v145, v144, s91
  v_and_b32 v145, 1, v145
  v_cmp_eq_u32 s[54:55], 1, v145
  s_nop 1
  s_and_b64 s[52:53], s[54:55], s[56:57]
  s_andn2_b64 s[54:55], s[54:55], s[56:57]
  v_mul_u32_u24 v144, 43, v144
  v_lshrrev_b32 v144, 8, v144
  v_mul_u32_u24 v144, 384, v144
  v_add_u32 v234, v144, v233
  s_cmp_eq_u32 s89, s88
  s_cbranch_scc1 L_k_sameq0
  s_mul_i32 s70, s89, 1536
  buffer_load_dwordx2 v[174:175], v235, s[36:39], s70 offen offset:0
  buffer_load_dwordx2 v[176:177], v235, s[36:39], s70 offen offset:128
  buffer_load_dwordx2 v[178:179], v235, s[36:39], s70 offen offset:256
  s_mov_b32 s88, s89
L_k_sameq0:
  s_mul_i32 s62, s84, 1536
  buffer_load_dwordx2 v[180:181], v234, s[20:23], s62 offen offset:0
  buffer_load_dwordx2 v[186:187], v234, s[24:27], s62 offen offset:0
  buffer_load_dwordx2 v[182:183], v234, s[20:23], s62 offen offset:128
  buffer_load_dwordx2 v[188:189], v234, s[24:27], s62 offen offset:128
  buffer_load_dwordx2 v[184:185], v234, s[20:23], s62 offen offset:256
  buffer_load_dwordx2 v[190:191], v234, s[24:27], s62 offen offset:256
  v_cvt_pk_bf16_f32 v108, 0, v108
  v_cvt_pk_bf16_f32 v109, 0, v109
  v_cvt_pk_bf16_f32 v110, 0, v110
  v_cvt_pk_bf16_f32 v111, 0, v111
  v_pk_mul_f32 v[108:109], v[108:109], v[200:201]
  v_pk_mul_f32 v[110:111], v[110:111], v[202:203]
  v_cvt_pk_bf16_f32 v220, v108, v109
  v_cvt_pk_bf16_f32 v221, v110, v111
  v_mad_u32_u24 v92, v97, s63, v232
  v_add_u32 v93, 768, v92
  v_add_u32 v94, 4608, v92
  v_add_u32 v95, 7680, v92
  v_cndmask_b32 v92, v92, v105, s[52:53]
  v_cndmask_b32 v95, v95, v105, s[54:55]
  s_waitcnt vmcnt(20)
  s_cbranch_vccnz L_kw0_18
  s_waitcnt vmcnt(15)
L_kw0_18:
  buffer_load_dwordx4 v[48:51], v92, s[16:19], s61 offen offset:0 nt
  v_mfma_f32_16x16x16_bf16 v[224:227], v[220:221], v[172:173], v[224:227]
  v_cvt_f32_i32 v108, v76
  v_cvt_f32_i32 v109, v77
  v_cvt_f32_i32 v110, v78
  v_cvt_f32_i32 v111, v79
  v_pk_add_f32 v[108:109], v[108:109], v[204:205] neg_lo:[0,1] neg_hi:[0,1]
  v_pk_add_f32 v[110:111], v[110:111], v[206:207] neg_lo:[0,1] neg_hi:[0,1]
  v_cvt_pk_bf16_f32 v108, 0, v108
  v_cvt_pk_bf16_f32 v109, 0, v109
  v_cvt_pk_bf16_f32 v110, 0, v110
  v_cvt_pk_bf16_f32 v111, 0, v111
  v_pk_mul_f32 v[108:109], v[108:109], v[192:193]
  v_pk_mul_f32 v[110:111], v[110:111], v[194:195]
  v_cvt_pk_bf16_f32 v216, v108, v109
  v_cvt_pk_bf16_f32 v217, v110, v111
  s_waitcnt vmcnt(20)
  buffer_load_dwordx4 v[52:55], v92, s[16:19], s61 offen offset:256 nt
  v_cvt_f32_i32 v108, v80
  v_cvt_f32_i32 v109, v81
  v_cvt_f32_i32 v110, v82
  v_cvt_f32_i32 v111, v83
  v_pk_add_f32 v[108:109], v[108:109], v[208:209] neg_lo:[0,1] neg_hi:[0,1]
  v_pk_add_f32 v[110:111], v[110:111], v[210:211] neg_lo:[0,1] neg_hi:[0,1]
  v_mov_b32_dpp v144, v224 quad_perm:[0,0,0,0] row_mask:0xf bank_mask:0xf
  v_mov_b32_dpp v145, v226 quad_perm:[2,2,2,2] row_mask:0xf bank_mask:0xf
  v_cvt_pk_bf16_f32 v108, 0, v108
  v_cvt_pk_bf16_f32 v109, 0, v109
  v_add_f32_dpp v144, v225, v144 quad_perm:[1,1,1,1] row_mask:0xf bank_mask:0xf
  v_add_f32_dpp v145, v227, v145 quad_perm:[3,3,3,3] row_mask:0xf bank_mask:0xf
  v_cvt_pk_bf16_f32 v110, 0, v110
  v_cvt_pk_bf16_f32 v111, 0, v111
  v_add_f32 v229, v144, v145
  v_pk_mul_f32 v[108:109], v[108:109], v[196:197]
  v_pk_mul_f32 v[110:111], v[110:111], v[198:199]
  v_cvt_pk_bf16_f32 v218, v108, v109
  v_cvt_pk_bf16_f32 v219, v110, v111
  s_waitcnt vmcnt(20)
  buffer_load_dwordx4 v[56:59], v92, s[16:19], s61 offen offset:512 nt
  v_mfma_f32_16x16x32_bf16 v[224:227], v[216:219], v[168:171], 0
  v_cvt_f32_i32 v108, v84
  v_cvt_f32_i32 v109, v85
  v_cvt_f32_i32 v110, v86
  v_cvt_f32_i32 v111, v87
  v_pk_add_f32 v[108:109], v[108:109], v[212:213] neg_lo:[0,1] neg_hi:[0,1]
  v_pk_add_f32 v[110:111], v[110:111], v[214:215] neg_lo:[0,1] neg_hi:[0,1]
  v_cvt_pk_bf16_f32 v108, 0, v108
  v_cvt_pk_bf16_f32 v228, 0, v228
  v_cvt_pk_bf16_f32 v109, 0, v109
  v_cvt_pk_bf16_f32 v229, 0, v229
  v_cvt_pk_bf16_f32 v110, 0, v110
  v_pk_mul_f32 v[228:229], v[228:229], s[68:69]
  v_cvt_pk_bf16_f32 v111, 0, v111
  v_cvt_pk_bf16_f32 v122, v228, v229
  v_pk_mul_f32 v[108:109], v[108:109], v[200:201]
  v_pk_mul_f32 v[110:111], v[110:111], v[202:203]
  v_cvt_pk_bf16_f32 v220, v108, v109
  v_cvt_pk_bf16_f32 v221, v110, v111
  s_waitcnt vmcnt(20)
  s_cbranch_vccnz L_kw0_21
  s_waitcnt vmcnt(15)
L_kw0_21:
  buffer_load_dwordx4 v[60:63], v93, s[16:19], s61 offen offset:0 nt
  v_mfma_f32_16x16x16_bf16 v[224:227], v[220:221], v[172:173], v[224:227]
  v_cvt_f32_i32 v108, v88
  v_cvt_f32_i32 v109, v89
  v_cvt_f32_i32 v110, v90
  v_cvt_f32_i32 v111, v91
  v_pk_add_f32 v[108:109], v[108:109], v[204:205] neg_lo:[0,1] neg_hi:[0,1]
  v_pk_add_f32 v[110:111], v[110:111], v[206:207] neg_lo:[0,1] neg_hi:[0,1]
  v_cvt_pk_bf16_f32 v108, 0, v108
  v_cvt_pk_bf16_f32 v109, 0, v109
  v_cvt_pk_bf16_f32 v110, 0, v110
  v_cvt_pk_bf16_f32 v111, 0, v111
  v_pk_mul_f32 v[108:109], v[108:109], v[192:193]
  v_pk_mul_f32 v[110:111], v[110:111], v[194:195]
  v_cvt_pk_bf16_f32 v216, v108, v109
  v_cvt_pk_bf16_f32 v217, v110, v111
  s_waitcnt vmcnt(20)
  buffer_load_dwordx4 v[64:67], v93, s[16:19], s61 offen offset:256 nt
  v_cvt_f32_i32 v108, v4
  v_cvt_f32_i32 v109, v5
  v_cvt_f32_i32 v110, v6
  v_cvt_f32_i32 v111, v7
  v_pk_add_f32 v[108:109], v[108:109], v[208:209] neg_lo:[0,1] neg_hi:[0,1]
  v_pk_add_f32 v[110:111], v[110:111], v[210:211] neg_lo:[0,1] neg_hi:[0,1]
  v_mov_b32_dpp v144, v224 quad_perm:[0,0,0,0] row_mask:0xf bank_mask:0xf
  v_mov_b32_dpp v145, v226 quad_perm:[2,2,2,2] row_mask:0xf bank_mask:0xf
  v_cvt_pk_bf16_f32 v108, 0, v108
  v_cvt_pk_bf16_f32 v109, 0, v109
  v_add_f32_dpp v144, v225, v144 quad_perm:[1,1,1,1] row_mask:0xf bank_mask:0xf
  v_add_f32_dpp v145, v227, v145 quad_perm:[3,3,3,3] row_mask:0xf bank_mask:0xf
  v_cvt_pk_bf16_f32 v110, 0, v110
  v_cvt_pk_bf16_f32 v111, 0, v111
  v_add_f32 v228, v144, v145
  v_pk_mul_f32 v[108:109], v[108:109], v[196:197]
  v_pk_mul_f32 v[110:111], v[110:111], v[198:199]
  v_cvt_pk_bf16_f32 v218, v108, v109
  v_cvt_pk_bf16_f32 v219, v110, v111
  s_waitcnt vmcnt(20)
  buffer_load_dwordx4 v[68:71], v93, s[16:19], s61 offen offset:512 nt
  v_mfma_f32_16x16x32_bf16 v[224:227], v[216:219], v[168:171], 0
  v_cvt_f32_i32 v108, v8
  v_cvt_f32_i32 v109, v9
  v_cvt_f32_i32 v110, v10
  v_cvt_f32_i32 v111, v11
  v_pk_add_f32 v[108:109], v[108:109], v[212:213] neg_lo:[0,1] neg_hi:[0,1]
  v_pk_add_f32 v[110:111], v[110:111], v[214:215] neg_lo:[0,1] neg_hi:[0,1]
  v_cvt_pk_bf16_f32 v108, 0, v108
  v_cvt_pk_bf16_f32 v109, 0, v109
  v_cvt_pk_bf16_f32 v110, 0, v110
  v_cvt_pk_bf16_f32 v111, 0, v111
  v_pk_mul_f32 v[108:109], v[108:109], v[200:201]
  v_pk_mul_f32 v[110:111], v[110:111], v[202:203]
  v_cvt_pk_bf16_f32 v220, v108, v109
  v_cvt_pk_bf16_f32 v221, v110, v111
  s_waitcnt vmcnt(20)
  s_cbranch_vccnz L_kw0_24
  s_waitcnt vmcnt(15)
L_kw0_24:
  buffer_load_dwordx4 v[72:75], v93, s[16:19], s61 offen offset:768 nt
  v_mfma_f32_16x16x16_bf16 v[224:227], v[220:221], v[172:173], v[224:227]
  v_cvt_f32_i32 v108, v12
  v_cvt_f32_i32 v109, v13
  v_cvt_f32_i32 v110, v14
  v_cvt_f32_i32 v111, v15
  v_pk_add_f32 v[108:109], v[108:109], v[204:205] neg_lo:[0,1] neg_hi:[0,1]
  v_pk_add_f32 v[110:111], v[110:111], v[206:207] neg_lo:[0,1] neg_hi:[0,1]
  v_cvt_pk_bf16_f32 v108, 0, v108
  v_cvt_pk_bf16_f32 v109, 0, v109
  v_cvt_pk_bf16_f32 v110, 0, v110
  v_cvt_pk_bf16_f32 v111, 0, v111
  v_pk_mul_f32 v[108:109], v[108:109], v[192:193]
  v_pk_mul_f32 v[110:111], v[110:111], v[194:195]
  v_cvt_pk_bf16_f32 v216, v108, v109
  v_cvt_pk_bf16_f32 v217, v110, v111
  s_waitcnt vmcnt(20)
  buffer_load_dwordx4 v[76:79], v93, s[16:19], s61 offen offset:1024 nt
  v_cvt_f32_i32 v108, v16
  v_cvt_f32_i32 v109, v17
  v_cvt_f32_i32 v110, v18
  v_cvt_f32_i32 v111, v19
  v_pk_add_f32 v[108:109], v[108:109], v[208:209] neg_lo:[0,1] neg_hi:[0,1]
  v_pk_add_f32 v[110:111], v[110:111], v[210:211] neg_lo:[0,1] neg_hi:[0,1]
  v_mov_b32_dpp v144, v224 quad_perm:[0,0,0,0] row_mask:0xf bank_mask:0xf
  v_mov_b32_dpp v145, v226 quad_perm:[2,2,2,2] row_mask:0xf bank_mask:0xf
  v_cvt_pk_bf16_f32 v108, 0, v108
  v_cvt_pk_bf16_f32 v109, 0, v109
  v_add_f32_dpp v144, v225, v144 quad_perm:[1,1,1,1] row_mask:0xf bank_mask:0xf
  v_add_f32_dpp v145, v227, v145 quad_perm:[3,3,3,3] row_mask:0xf bank_mask:0xf
  v_cvt_pk_bf16_f32 v110, 0, v110
  v_cvt_pk_bf16_f32 v111, 0, v111
  v_add_f32 v229, v144, v145
  v_pk_mul_f32 v[108:109], v[108:109], v[196:197]
  v_pk_mul_f32 v[110:111], v[110:111], v[198:199]
  v_cvt_pk_bf16_f32 v218, v108, v109
  v_cvt_pk_bf16_f32 v219, v110, v111
  s_waitcnt vmcnt(20)
  buffer_load_dwordx4 v[80:83], v93, s[16:19], s61 offen offset:1280 nt
  v_mfma_f32_16x16x32_bf16 v[224:227], v[216:219], v[168:171], 0
  v_cvt_f32_i32 v108, v20
  v_cvt_f32_i32 v109, v21
  v_cvt_f32_i32 v110, v22
  v_cvt_f32_i32 v111, v23
  v_pk_add_f32 v[108:109], v[108:109], v[212:213] neg_lo:[0,1] neg_hi:[0,1]
  v_pk_add_f32 v[110:111], v[110:111], v[214:215] neg_lo:[0,1] neg_hi:[0,1]
  v_cvt_pk_bf16_f32 v108, 0, v108
  v_cvt_pk_bf16_f32 v228, 0, v228
  v_cvt_pk_bf16_f32 v109, 0, v109
  v_cvt_pk_bf16_f32 v229, 0, v229
  v_cvt_pk_bf16_f32 v110, 0, v110
  v_pk_mul_f32 v[228:229], v[228:229], s[68:69]
  v_cvt_pk_bf16_f32 v111, 0, v111
  v_cvt_pk_bf16_f32 v123, v228, v229
  v_pk_mul_f32 v[108:109], v[108:109], v[200:201]
  v_pk_mul_f32 v[110:111], v[110:111], v[202:203]
  v_cvt_pk_bf16_f32 v220, v108, v109
  v_cvt_pk_bf16_f32 v221, v110, v111
  s_waitcnt vmcnt(20)
  s_cbranch_vccnz L_kw0_27
  s_waitcnt vmcnt(15)
L_kw0_27:
  buffer_load_dwordx4 v[84:87], v93, s[16:19], s61 offen offset:1536 nt
  v_mfma_f32_16x16x16_bf16 v[224:227], v[220:221], v[172:173], v[224:227]
  v_cvt_f32_i32 v108, v24
  v_cvt_f32_i32 v109, v25
  v_cvt_f32_i32 v110, v26
  v_cvt_f32_i32 v111, v27
  v_pk_add_f32 v[108:109], v[108:109], v[204:205] neg_lo:[0,1] neg_hi:[0,1]
  v_pk_add_f32 v[110:111], v[110:111], v[206:207] neg_lo:[0,1] neg_hi:[0,1]
  v_cvt_pk_bf16_f32 v108, 0, v108
  v_cvt_pk_bf16_f32 v109, 0, v109
  v_cvt_pk_bf16_f32 v110, 0, v110
  v_cvt_pk_bf16_f32 v111, 0, v111
  v_pk_mul_f32 v[108:109], v[108:109], v[192:193]
  v_pk_mul_f32 v[110:111], v[110:111], v[194:195]
  v_cvt_pk_bf16_f32 v216, v108, v109
  v_cvt_pk_bf16_f32 v217, v110, v111
  s_waitcnt vmcnt(20)
  buffer_load_dwordx4 v[88:91], v93, s[16:19], s61 offen offset:1792 nt
  v_cvt_f32_i32 v108, v28
  v_cvt_f32_i32 v109, v29
  v_cvt_f32_i32 v110, v30
  v_cvt_f32_i32 v111, v31
  v_pk_add_f32 v[108:109], v[108:109], v[208:209] neg_lo:[0,1] neg_hi:[0,1]
  v_pk_add_f32 v[110:111], v[110:111], v[210:211] neg_lo:[0,1] neg_hi:[0,1]
  v_mov_b32_dpp v144, v224 quad_perm:[0,0,0,0] row_mask:0xf bank_mask:0xf
  v_mov_b32_dpp v145, v226 quad_perm:[2,2,2,2] row_mask:0xf bank_mask:0xf
  v_cvt_pk_bf16_f32 v108, 0, v108
  v_cvt_pk_bf16_f32 v109, 0, v109
  v_add_f32_dpp v144, v225, v144 quad_perm:[1,1,1,1] row_mask:0xf bank_mask:0xf
  v_add_f32_dpp v145, v227, v145 quad_perm:[3,3,3,3] row_mask:0xf bank_mask:0xf
  v_cvt_pk_bf16_f32 v110, 0, v110
  v_cvt_pk_bf16_f32 v111, 0, v111
  v_add_f32 v228, v144, v145
  v_pk_mul_f32 v[108:109], v[108:109], v[196:197]
  v_pk_mul_f32 v[110:111], v[110:111], v[198:199]
  v_cvt_pk_bf16_f32 v218, v108, v109
  v_cvt_pk_bf16_f32 v219, v110, v111
  s_waitcnt vmcnt(20)
  buffer_load_dwordx4 v[4:7], v93, s[16:19], s61 offen offset:2048 nt
  v_mfma_f32_16x16x32_bf16 v[224:227], v[216:219], v[168:171], 0
  v_cvt_f32_i32 v108, v32
  v_cvt_f32_i32 v109, v33
  v_cvt_f32_i32 v110, v34
  v_cvt_f32_i32 v111, v35
  v_pk_add_f32 v[108:109], v[108:109], v[212:213] neg_lo:[0,1] neg_hi:[0,1]
  v_pk_add_f32 v[110:111], v[110:111], v[214:215] neg_lo:[0,1] neg_hi:[0,1]
  v_cvt_pk_bf16_f32 v108, 0, v108
  v_cvt_pk_bf16_f32 v109, 0, v109
  v_cvt_pk_bf16_f32 v110, 0, v110
  v_cvt_pk_bf16_f32 v111, 0, v111
  v_pk_mul_f32 v[108:109], v[108:109], v[200:201]
  v_pk_mul_f32 v[110:111], v[110:111], v[202:203]
  v_cvt_pk_bf16_f32 v220, v108, v109
  v_cvt_pk_bf16_f32 v221, v110, v111
  s_waitcnt vmcnt(20)
  s_cbranch_vccnz L_kw0_30
  s_waitcnt vmcnt(9)
L_kw0_30:
  buffer_load_dwordx4 v[8:11], v93, s[16:19], s61 offen offset:2304 nt
  v_mfma_f32_16x16x16_bf16 v[224:227], v[220:221], v[172:173], v[224:227]
  v_cvt_f32_i32 v108, v36
  v_cvt_f32_i32 v109, v37
  v_cvt_f32_i32 v110, v38
  v_cvt_f32_i32 v111, v39
  v_pk_add_f32 v[108:109], v[108:109], v[204:205] neg_lo:[0,1] neg_hi:[0,1]
  v_pk_add_f32 v[110:111], v[110:111], v[206:207] neg_lo:[0,1] neg_hi:[0,1]
  v_cvt_pk_bf16_f32 v108, 0, v108
  v_cvt_pk_bf16_f32 v109, 0, v109
  v_cvt_pk_bf16_f32 v110, 0, v110
  v_cvt_pk_bf16_f32 v111, 0, v111
  v_pk_mul_f32 v[108:109], v[108:109], v[192:193]
  v_pk_mul_f32 v[110:111], v[110:111], v[194:195]
  v_cvt_pk_bf16_f32 v216, v108, v109
  v_cvt_pk_bf16_f32 v217, v110, v111
  s_waitcnt vmcnt(20)
  buffer_load_dwordx4 v[12:15], v93, s[16:19], s61 offen offset:2560 nt
  v_cvt_f32_i32 v108, v40
  v_cvt_f32_i32 v109, v41
  v_cvt_f32_i32 v110, v42
  v_cvt_f32_i32 v111, v43
  v_pk_add_f32 v[108:109], v[108:109], v[208:209] neg_lo:[0,1] neg_hi:[0,1]
  v_pk_add_f32 v[110:111], v[110:111], v[210:211] neg_lo:[0,1] neg_hi:[0,1]
  v_mov_b32_dpp v144, v224 quad_perm:[0,0,0,0] row_mask:0xf bank_mask:0xf
  v_mov_b32_dpp v145, v226 quad_perm:[2,2,2,2] row_mask:0xf bank_mask:0xf
  v_cvt_pk_bf16_f32 v108, 0, v108
  v_cvt_pk_bf16_f32 v109, 0, v109
  v_add_f32_dpp v144, v225, v144 quad_perm:[1,1,1,1] row_mask:0xf bank_mask:0xf
  v_add_f32_dpp v145, v227, v145 quad_perm:[3,3,3,3] row_mask:0xf bank_mask:0xf
  v_cvt_pk_bf16_f32 v110, 0, v110
  v_cvt_pk_bf16_f32 v111, 0, v111
  v_add_f32 v229, v144, v145
  v_pk_mul_f32 v[108:109], v[108:109], v[196:197]
  v_pk_mul_f32 v[110:111], v[110:111], v[198:199]
  v_cvt_pk_bf16_f32 v218, v108, v109
  v_cvt_pk_bf16_f32 v219, v110, v111
  s_waitcnt vmcnt(20)
  buffer_load_dwordx4 v[16:19], v93, s[16:19], s61 offen offset:2816 nt
  v_mfma_f32_16x16x32_bf16 v[224:227], v[216:219], v[168:171], 0
  v_cvt_f32_i32 v108, v44
  v_cvt_f32_i32 v109, v45
  v_cvt_f32_i32 v110, v46
  v_cvt_f32_i32 v111, v47
  v_pk_add_f32 v[108:109], v[108:109], v[212:213] neg_lo:[0,1] neg_hi:[0,1]
  v_pk_add_f32 v[110:111], v[110:111], v[214:215] neg_lo:[0,1] neg_hi:[0,1]
  v_cvt_pk_bf16_f32 v108, 0, v108
  v_cvt_pk_bf16_f32 v228, 0, v228
  v_cvt_pk_bf16_f32 v109, 0, v109
  v_cvt_pk_bf16_f32 v229, 0, v229
  v_cvt_pk_bf16_f32 v110, 0, v110
  v_pk_mul_f32 v[228:229], v[228:229], s[68:69]
  v_cvt_pk_bf16_f32 v111, 0, v111
  v_cvt_pk_bf16_f32 v124, v228, v229
  v_pk_mul_f32 v[108:109], v[108:109], v[200:201]
  v_pk_mul_f32 v[110:111], v[110:111], v[202:203]
  v_cvt_pk_bf16_f32 v220, v108, v109
  v_cvt_pk_bf16_f32 v221, v110, v111
  s_mov_b32 s60, s61
  v_mov_b32 v146, s64
  v_mfma_f32_16x16x16_bf16 v[224:227], v[220:221], v[172:173], v[224:227]
  ds_write_b128 v99, v[120:123]
  v_add_u32 v99, 768, v99
  s_nop 5
  v_mov_b32_dpp v144, v224 quad_perm:[0,0,0,0] row_mask:0xf bank_mask:0xf
  v_mov_b32_dpp v145, v226 quad_perm:[2,2,2,2] row_mask:0xf bank_mask:0xf
  s_nop 0
  v_add_f32_dpp v144, v225, v144 quad_perm:[1,1,1,1] row_mask:0xf bank_mask:0xf
  v_add_f32_dpp v145, v227, v145 quad_perm:[3,3,3,3] row_mask:0xf bank_mask:0xf
  v_add_f32 v228, v144, v145
  v_cndmask_b32 v228, v228, v236, s[50:51]
  v_cvt_pk_bf16_f32 v228, 0, v228
  v_cvt_pk_bf16_f32 v229, 0, v229
  v_pk_mul_f32 v[228:229], v[228:229], s[68:69]
  v_cvt_pk_bf16_f32 v125, v228, v229
  ds_write_b64 v100, v[124:125] offset:256
  ds_write_b32 v104, v146
  v_add_u32 v100, 768, v100
  v_add_u32 v144, s85, v2
  v_lshrrev_b32 v145, v144, s91
  v_and_b32 v145, 1, v145
  v_cmp_eq_u32 s[50:51], 1, v145
  s_nop 1
  s_and_b64 s[48:49], s[50:51], s[58:59]
  s_andn2_b64 s[50:51], s[50:51], s[58:59]
  s_mov_b32 s97, s64
  s_add_u32 s64, s64, 2
  ds_read_b32 v106, v104 offset:8
  s_waitcnt vmcnt(14)
  s_cbranch_vccnz L_kw1_0
  s_waitcnt vmcnt(9)
L_kw1_0:
  buffer_load_dwordx4 v[20:23], v93, s[8:11], s60 offen offset:3072 nt
  v_lshlrev_b32 v204, 16, v186
  v_and_b32 v205, s65, v186
  v_lshlrev_b32 v206, 16, v187
  v_and_b32 v207, s65, v187
  v_lshlrev_b32 v192, 16, v180
  v_and_b32 v193, s65, v180
  v_lshlrev_b32 v194, 16, v181
  v_and_b32 v195, s65, v181
  v_mov_b32 v168, v174
  v_mov_b32 v169, v175
  v_cvt_f32_i32 v108, v48
  v_cvt_f32_i32 v109, v49
  v_cvt_f32_i32 v110, v50
  v_cvt_f32_i32 v111, v51
  v_pk_add_f32 v[108:109], v[108:109], v[204:205] neg_lo:[0,1] neg_hi:[0,1]
  v_pk_add_f32 v[110:111], v[110:111], v[206:207] neg_lo:[0,1] neg_hi:[0,1]
  v_cvt_pk_bf16_f32 v108, 0, v108
  v_cvt_pk_bf16_f32 v109, 0, v109
  v_cvt_pk_bf16_f32 v110, 0, v110
  v_cvt_pk_bf16_f32 v111, 0, v111
  v_pk_mul_f32 v[108:109], v[108:109], v[192:193]
  v_pk_mul_f32 v[110:111], v[110:111], v[194:195]
  v_cvt_pk_bf16_f32 v216, v108, v109
  v_cvt_pk_bf16_f32 v217, v110, v111
  s_waitcnt lgkmcnt(0)
  v_cmp_lt_u32 vcc, s97, v106
  s_waitcnt vmcnt(14)
  buffer_load_dwordx4 v[24:27], v93, s[8:11], s60 offen offset:3328 nt
  v_lshlrev_b32 v208, 16, v188
  v_and_b32 v209, s65, v188
  v_lshlrev_b32 v210, 16, v189
  v_and_b32 v211, s65, v189
  v_lshlrev_b32 v196, 16, v182
  v_and_b32 v197, s65, v182
  v_lshlrev_b32 v198, 16, v183
  v_and_b32 v199, s65, v183
  v_mov_b32 v170, v176
  v_mov_b32 v171, v177
  v_cvt_f32_i32 v108, v52
  v_cvt_f32_i32 v109, v53
  v_cvt_f32_i32 v110, v54
  v_cvt_f32_i32 v111, v55
  v_pk_add_f32 v[108:109], v[108:109], v[208:209] neg_lo:[0,1] neg_hi:[0,1]
  v_pk_add_f32 v[110:111], v[110:111], v[210:211] neg_lo:[0,1] neg_hi:[0,1]
  v_cvt_pk_bf16_f32 v108, 0, v108
  v_cvt_pk_bf16_f32 v109, 0, v109
  v_cvt_pk_bf16_f32 v110, 0, v110
  v_cvt_pk_bf16_f32 v111, 0, v111
  v_pk_mul_f32 v[108:109], v[108:109], v[196:197]
  v_pk_mul_f32 v[110:111], v[110:111], v[198:199]
  v_cvt_pk_bf16_f32 v218, v108, v109
  v_cvt_pk_bf16_f32 v219, v110, v111
  s_waitcnt vmcnt(14)
  buffer_load_dwordx4 v[28:31], v93, s[8:11], s60 offen offset:3584 nt
  v_mfma_f32_16x16x32_bf16 v[224:227], v[216:219], v[168:171], 0
  v_lshlrev_b32 v212, 16, v190
  v_and_b32 v213, s65, v190
  v_lshlrev_b32 v214, 16, v191
  v_and_b32 v215, s65, v191
  v_lshlrev_b32 v200, 16, v184
  v_and_b32 v201, s65, v184
  v_lshlrev_b32 v202, 16, v185
  v_and_b32 v203, s65, v185
  v_mov_b32 v172, v178
  v_mov_b32 v173, v179
  v_cvt_f32_i32 v108, v56
  v_cvt_f32_i32 v109, v57
  v_cvt_f32_i32 v110, v58
  v_cvt_f32_i32 v111, v59
  v_pk_add_f32 v[108:109], v[108:109], v[212:213] neg_lo:[0,1] neg_hi:[0,1]
  v_pk_add_f32 v[110:111], v[110:111], v[214:215] neg_lo:[0,1] neg_hi:[0,1]
  v_cvt_pk_bf16_f32 v108, 0, v108
  v_cvt_pk_bf16_f32 v109, 0, v109
  v_cvt_pk_bf16_f32 v110, 0, v110
  v_cvt_pk_bf16_f32 v111, 0, v111
  v_pk_mul_f32 v[108:109], v[108:109], v[200:201]
  v_pk_mul_f32 v[110:111], v[110:111], v[202:203]
  v_cvt_pk_bf16_f32 v220, v108, v109
  v_cvt_pk_bf16_f32 v221, v110, v111
  s_waitcnt vmcnt(14)
  s_cbranch_vccnz L_kw1_3
  s_waitcnt vmcnt(9)
L_kw1_3:
  buffer_load_dwordx4 v[32:35], v94, s[8:11], s60 offen offset:0 nt
  v_mfma_f32_16x16x16_bf16 v[224:227], v[220:221], v[172:173], v[224:227]
  v_cvt_f32_i32 v108, v60
  v_cvt_f32_i32 v109, v61
  v_cvt_f32_i32 v110, v62
  v_cvt_f32_i32 v111, v63
  v_pk_add_f32 v[108:109], v[108:109], v[204:205] neg_lo:[0,1] neg_hi:[0,1]
  v_pk_add_f32 v[110:111], v[110:111], v[206:207] neg_lo:[0,1] neg_hi:[0,1]
  v_cvt_pk_bf16_f32 v108, 0, v108
  v_cvt_pk_bf16_f32 v109, 0, v109
  v_cvt_pk_bf16_f32 v110, 0, v110
  v_cvt_pk_bf16_f32 v111, 0, v111
  v_pk_mul_f32 v[108:109], v[108:109], v[192:193]
  v_pk_mul_f32 v[110:111], v[110:111], v[194:195]
  v_cvt_pk_bf16_f32 v216, v108, v109
  v_cvt_pk_bf16_f32 v217, v110, v111
  s_waitcnt vmcnt(14)
  buffer_load_dwordx4 v[36:39], v94, s[8:11], s60 offen offset:256 nt
  v_cvt_f32_i32 v108, v64
  v_cvt_f32_i32 v109, v65
  v_cvt_f32_i32 v110, v66
  v_cvt_f32_i32 v111, v67
  v_pk_add_f32 v[108:109], v[108:109], v[208:209] neg_lo:[0,1] neg_hi:[0,1]
  v_pk_add_f32 v[110:111], v[110:111], v[210:211] neg_lo:[0,1] neg_hi:[0,1]
  v_mov_b32_dpp v144, v224 quad_perm:[0,0,0,0] row_mask:0xf bank_mask:0xf
  v_mov_b32_dpp v145, v226 quad_perm:[2,2,2,2] row_mask:0xf bank_mask:0xf
  v_cvt_pk_bf16_f32 v108, 0, v108
  v_cvt_pk_bf16_f32 v109, 0, v109
  v_add_f32_dpp v144, v225, v144 quad_perm:[1,1,1,1] row_mask:0xf bank_mask:0xf
  v_add_f32_dpp v145, v227, v145 quad_perm:[3,3,3,3] row_mask:0xf bank_mask:0xf
  v_cvt_pk_bf16_f32 v110, 0, v110
  v_cvt_pk_bf16_f32 v111, 0, v111
  v_add_f32 v228, v144, v145
  v_pk_mul_f32 v[108:109], v[108:109], v[196:197]
  v_pk_mul_f32 v[110:111], v[110:111], v[198:199]
  v_cvt_pk_bf16_f32 v218, v108, v109
  v_cvt_pk_bf16_f32 v219, v110, v111
  s_waitcnt vmcnt(14)
  buffer_load_dwordx4 v[40:43], v94, s[8:11], s60 offen offset:512 nt
  v_mfma_f32_16x16x32_bf16 v[224:227], v[216:219], v[168:171], 0
  v_cvt_f32_i32 v108, v68
  v_cvt_f32_i32 v109, v69
  v_cvt_f32_i32 v110, v70
  v_cvt_f32_i32 v111, v71
  v_pk_add_f32 v[108:109], v[108:109], v[212:213] neg_lo:[0,1] neg_hi:[0,1]
  v_pk_add_f32 v[110:111], v[110:111], v[214:215] neg_lo:[0,1] neg_hi:[0,1]
  v_cvt_pk_bf16_f32 v108, 0, v108
  v_cndmask_b32 v228, v228, v236, s[48:49]
  v_cvt_pk_bf16_f32 v109, 0, v109
  v_cvt_pk_bf16_f32 v110, 0, v110
  v_cvt_pk_bf16_f32 v111, 0, v111
  v_pk_mul_f32 v[108:109], v[108:109], v[200:201]
  v_pk_mul_f32 v[110:111], v[110:111], v[202:203]
  v_cvt_pk_bf16_f32 v220, v108, v109
  v_cvt_pk_bf16_f32 v221, v110, v111
  s_waitcnt vmcnt(14)
  s_cbranch_vccnz L_kw1_6
  s_waitcnt vmcnt(9)
L_kw1_6:
  buffer_load_dwordx4 v[44:47], v94, s[8:11], s60 offen offset:768 nt
  v_mfma_f32_16x16x16_bf16 v[224:227], v[220:221], v[172:173], v[224:227]
  v_cvt_f32_i32 v108, v72
  v_cvt_f32_i32 v109, v73
  v_cvt_f32_i32 v110, v74
  v_cvt_f32_i32 v111, v75
  v_pk_add_f32 v[108:109], v[108:109], v[204:205] neg_lo:[0,1] neg_hi:[0,1]
  v_pk_add_f32 v[110:111], v[110:111], v[206:207] neg_lo:[0,1] neg_hi:[0,1]
  v_cvt_pk_bf16_f32 v108, 0, v108
  v_cvt_pk_bf16_f32 v109, 0, v109
  v_cvt_pk_bf16_f32 v110, 0, v110
  v_cvt_pk_bf16_f32 v111, 0, v111
  v_pk_mul_f32 v[108:109], v[108:109], v[192:193]
  v_pk_mul_f32 v[110:111], v[110:111], v[194:195]
  v_cvt_pk_bf16_f32 v216, v108, v109
  v_cvt_pk_bf16_f32 v217, v110, v111
  s_waitcnt vmcnt(14)
  buffer_load_dwordx4 v[48:51], v94, s[8:11], s60 offen offset:1024 nt
  v_cvt_f32_i32 v108, v76
  v_cvt_f32_i32 v109, v77
  v_cvt_f32_i32 v110, v78
  v_cvt_f32_i32 v111, v79
  v_pk_add_f32 v[108:109], v[108:109], v[208:209] neg_lo:[0,1] neg_hi:[0,1]
  v_pk_add_f32 v[110:111], v[110:111], v[210:211] neg_lo:[0,1] neg_hi:[0,1]
  v_mov_b32_dpp v144, v224 quad_perm:[0,0,0,0] row_mask:0xf bank_mask:0xf
  v_mov_b32_dpp v145, v226 quad_perm:[2,2,2,2] row_mask:0xf bank_mask:0xf
  v_cvt_pk_bf16_f32 v108, 0, v108
  v_cvt_pk_bf16_f32 v109, 0, v109
  v_add_f32_dpp v144, v225, v144 quad_perm:[1,1,1,1] row_mask:0xf bank_mask:0xf
  v_add_f32_dpp v145, v227, v145 quad_perm:[3,3,3,3] row_mask:0xf bank_mask:0xf
  v_cvt_pk_bf16_f32 v110, 0, v110
  v_cvt_pk_bf16_f32 v111, 0, v111
  v_add_f32 v229, v144, v145
  v_pk_mul_f32 v[108:109], v[108:109], v[196:197]
  v_pk_mul_f32 v[110:111], v[110:111], v[198:199]
  v_cvt_pk_bf16_f32 v218, v108, v109
  v_cvt_pk_bf16_f32 v219, v110, v111
  s_waitcnt vmcnt(14)
  buffer_load_dwordx4 v[52:55], v94, s[8:11], s60 offen offset:1280 nt
  v_mfma_f32_16x16x32_bf16 v[224:227], v[216:219], v[168:171], 0
  v_cvt_f32_i32 v108, v80
  v_cvt_f32_i32 v109, v81
  v_cvt_f32_i32 v110, v82
  v_cvt_f32_i32 v111, v83
  v_pk_add_f32 v[108:109], v[108:109], v[212:213] neg_lo:[0,1] neg_hi:[0,1]
  v_pk_add_f32 v[110:111], v[110:111], v[214:215] neg_lo:[0,1] neg_hi:[0,1]
  v_cvt_pk_bf16_f32 v108, 0, v108
  v_cvt_pk_bf16_f32 v228, 0, v228
  v_cvt_pk_bf16_f32 v109, 0, v109
  v_cvt_pk_bf16_f32 v229, 0, v229
  v_cvt_pk_bf16_f32 v110, 0, v110
  v_pk_mul_f32 v[228:229], v[228:229], s[68:69]
  v_cvt_pk_bf16_f32 v111, 0, v111
  v_cvt_pk_bf16_f32 v120, v228, v229
  v_pk_mul_f32 v[108:109], v[108:109], v[200:201]
  v_pk_mul_f32 v[110:111], v[110:111], v[202:203]
  v_cvt_pk_bf16_f32 v220, v108, v109
  v_cvt_pk_bf16_f32 v221, v110, v111
  s_waitcnt vmcnt(14)
  s_cbranch_vccnz L_kw1_9
  s_waitcnt vmcnt(9)
L_kw1_9:
  buffer_load_dwordx4 v[56:59], v94, s[8:11], s60 offen offset:1536 nt
  v_mfma_f32_16x16x16_bf16 v[224:227], v[220:221], v[172:173], v[224:227]
  v_cvt_f32_i32 v108, v84
  v_cvt_f32_i32 v109, v85
  v_cvt_f32_i32 v110, v86
  v_cvt_f32_i32 v111, v87
  v_pk_add_f32 v[108:109], v[108:109], v[204:205] neg_lo:[0,1] neg_hi:[0,1]
  v_pk_add_f32 v[110:111], v[110:111], v[206:207] neg_lo:[0,1] neg_hi:[0,1]
  v_cvt_pk_bf16_f32 v108, 0, v108
  v_cvt_pk_bf16_f32 v109, 0, v109
  v_cvt_pk_bf16_f32 v110, 0, v110
  v_cvt_pk_bf16_f32 v111, 0, v111
  v_pk_mul_f32 v[108:109], v[108:109], v[192:193]
  v_pk_mul_f32 v[110:111], v[110:111], v[194:195]
  v_cvt_pk_bf16_f32 v216, v108, v109
  v_cvt_pk_bf16_f32 v217, v110, v111
  s_waitcnt vmcnt(14)
  buffer_load_dwordx4 v[60:63], v94, s[8:11], s60 offen offset:1792 nt
  v_cvt_f32_i32 v108, v88
  v_cvt_f32_i32 v109, v89
  v_cvt_f32_i32 v110, v90
  v_cvt_f32_i32 v111, v91
  v_pk_add_f32 v[108:109], v[108:109], v[208:209] neg_lo:[0,1] neg_hi:[0,1]
  v_pk_add_f32 v[110:111], v[110:111], v[210:211] neg_lo:[0,1] neg_hi:[0,1]
  v_mov_b32_dpp v144, v224 quad_perm:[0,0,0,0] row_mask:0xf bank_mask:0xf
  v_mov_b32_dpp v145, v226 quad_perm:[2,2,2,2] row_mask:0xf bank_mask:0xf
  v_cvt_pk_bf16_f32 v108, 0, v108
  v_cvt_pk_bf16_f32 v109, 0, v109
  v_add_f32_dpp v144, v225, v144 quad_perm:[1,1,1,1] row_mask:0xf bank_mask:0xf
  v_add_f32_dpp v145, v227, v145 quad_perm:[3,3,3,3] row_mask:0xf bank_mask:0xf
  v_cvt_pk_bf16_f32 v110, 0, v110
  v_cvt_pk_bf16_f32 v111, 0, v111
  v_add_f32 v228, v144, v145
  v_pk_mul_f32 v[108:109], v[108:109], v[196:197]
  v_pk_mul_f32 v[110:111], v[110:111], v[198:199]
  v_cvt_pk_bf16_f32 v218, v108, v109
  v_cvt_pk_bf16_f32 v219, v110, v111
  s_waitcnt vmcnt(14)
  buffer_load_dwordx4 v[64:67], v94, s[8:11], s60 offen offset:2048 nt
  v_mfma_f32_16x16x32_bf16 v[224:227], v[216:219], v[168:171], 0
  v_cvt_f32_i32 v108, v4
  v_cvt_f32_i32 v109, v5
  v_cvt_f32_i32 v110, v6
  v_cvt_f32_i32 v111, v7
  v_pk_add_f32 v[108:109], v[108:109], v[212:213] neg_lo:[0,1] neg_hi:[0,1]
  v_pk_add_f32 v[110:111], v[110:111], v[214:215] neg_lo:[0,1] neg_hi:[0,1]
  v_cvt_pk_bf16_f32 v108, 0, v108
  v_cvt_pk_bf16_f32 v109, 0, v109
  v_cvt_pk_bf16_f32 v110, 0, v110
  v_cvt_pk_bf16_f32 v111, 0, v111
  v_pk_mul_f32 v[108:109], v[108:109], v[200:201]
  v_pk_mul_f32 v[110:111], v[110:111], v[202:203]
  v_cvt_pk_bf16_f32 v220, v108, v109
  v_cvt_pk_bf16_f32 v221, v110, v111
  s_waitcnt vmcnt(14)
  s_cbranch_vccnz L_kw1_12
  s_waitcnt vmcnt(9)
L_kw1_12:
  buffer_load_dwordx4 v[68:71], v94, s[8:11], s60 offen offset:2304 nt
  v_mfma_f32_16x16x16_bf16 v[224:227], v[220:221], v[172:173], v[224:227]
  v_cvt_f32_i32 v108, v8
  v_cvt_f32_i32 v109, v9
  v_cvt_f32_i32 v110, v10
  v_cvt_f32_i32 v111, v11
  v_pk_add_f32 v[108:109], v[108:109], v[204:205] neg_lo:[0,1] neg_hi:[0,1]
  v_pk_add_f32 v[110:111], v[110:111], v[206:207] neg_lo:[0,1] neg_hi:[0,1]
  v_cvt_pk_bf16_f32 v108, 0, v108
  v_cvt_pk_bf16_f32 v109, 0, v109
  v_cvt_pk_bf16_f32 v110, 0, v110
  v_cvt_pk_bf16_f32 v111, 0, v111
  v_pk_mul_f32 v[108:109], v[108:109], v[192:193]
  v_pk_mul_f32 v[110:111], v[110:111], v[194:195]
  v_cvt_pk_bf16_f32 v216, v108, v109
  v_cvt_pk_bf16_f32 v217, v110, v111
  s_waitcnt vmcnt(14)
  buffer_load_dwordx4 v[72:75], v94, s[8:11], s60 offen offset:2560 nt
  v_cvt_f32_i32 v108, v12
  v_cvt_f32_i32 v109, v13
  v_cvt_f32_i32 v110, v14
  v_cvt_f32_i32 v111, v15
  v_pk_add_f32 v[108:109], v[108:109], v[208:209] neg_lo:[0,1] neg_hi:[0,1]
  v_pk_add_f32 v[110:111], v[110:111], v[210:211] neg_lo:[0,1] neg_hi:[0,1]
  v_mov_b32_dpp v144, v224 quad_perm:[0,0,0,0] row_mask:0xf bank_mask:0xf
  v_mov_b32_dpp v145, v226 quad_perm:[2,2,2,2] row_mask:0xf bank_mask:0xf
  v_cvt_pk_bf16_f32 v108, 0, v108
  v_cvt_pk_bf16_f32 v109, 0, v109
  v_add_f32_dpp v144, v225, v144 quad_perm:[1,1,1,1] row_mask:0xf bank_mask:0xf
  v_add_f32_dpp v145, v227, v145 quad_perm:[3,3,3,3] row_mask:0xf bank_mask:0xf
  v_cvt_pk_bf16_f32 v110, 0, v110
  v_cvt_pk_bf16_f32 v111, 0, v111
  v_add_f32 v229, v144, v145
  v_pk_mul_f32 v[108:109], v[108:109], v[196:197]
  v_pk_mul_f32 v[110:111], v[110:111], v[198:199]
  v_cvt_pk_bf16_f32 v218, v108, v109
  v_cvt_pk_bf16_f32 v219, v110, v111
  s_waitcnt vmcnt(14)
  buffer_load_dwordx4 v[76:79], v94, s[8:11], s60 offen offset:2816 nt
  v_mfma_f32_16x16x32_bf16 v[224:227], v[216:219], v[168:171], 0
  v_cvt_f32_i32 v108, v16
  v_cvt_f32_i32 v109, v17
  v_cvt_f32_i32 v110, v18
  v_cvt_f32_i32 v111, v19
  v_pk_add_f32 v[108:109], v[108:109], v[212:213] neg_lo:[0,1] neg_hi:[0,1]
  v_pk_add_f32 v[110:111], v[110:111], v[214:215] neg_lo:[0,1] neg_hi:[0,1]
  v_cvt_pk_bf16_f32 v108, 0, v108
  v_cvt_pk_bf16_f32 v228, 0, v228
  v_cvt_pk_bf16_f32 v109, 0, v109
  v_cvt_pk_bf16_f32 v229, 0, v229
  v_cvt_pk_bf16_f32 v110, 0, v110
  v_pk_mul_f32 v[228:229], v[228:229], s[68:69]
  v_cvt_pk_bf16_f32 v111, 0, v111
  v_cvt_pk_bf16_f32 v121, v228, v229
  v_pk_mul_f32 v[108:109], v[108:109], v[200:201]
  v_pk_mul_f32 v[110:111], v[110:111], v[202:203]
  v_cvt_pk_bf16_f32 v220, v108, v109
  v_cvt_pk_bf16_f32 v221, v110, v111
  s_waitcnt vmcnt(14)
  s_cbranch_vccnz L_kw1_15
  s_waitcnt vmcnt(9)
L_kw1_15:
  buffer_load_dwordx4 v[80:83], v95, s[8:11], s60 offen offset:0 nt
  v_mfma_f32_16x16x16_bf16 v[224:227], v[220:221], v[172:173], v[224:227]
  v_cvt_f32_i32 v108, v20
  v_cvt_f32_i32 v109, v21
  v_cvt_f32_i32 v110, v22
  v_cvt_f32_i32 v111, v23
  v_pk_add_f32 v[108:109], v[108:109], v[204:205] neg_lo:[0,1] neg_hi:[0,1]
  v_pk_add_f32 v[110:111], v[110:111], v[206:207] neg_lo:[0,1] neg_hi:[0,1]
  v_cvt_pk_bf16_f32 v108, 0, v108
  v_cvt_pk_bf16_f32 v109, 0, v109
  v_cvt_pk_bf16_f32 v110, 0, v110
  v_cvt_pk_bf16_f32 v111, 0, v111
  v_pk_mul_f32 v[108:109], v[108:109], v[192:193]
  v_pk_mul_f32 v[110:111], v[110:111], v[194:195]
  v_cvt_pk_bf16_f32 v216, v108, v109
  v_cvt_pk_bf16_f32 v217, v110, v111
  s_waitcnt vmcnt(14)
  buffer_load_dwordx4 v[84:87], v95, s[8:11], s60 offen offset:256 nt
  v_cvt_f32_i32 v108, v24
  v_cvt_f32_i32 v109, v25
  v_cvt_f32_i32 v110, v26
  v_cvt_f32_i32 v111, v27
  v_pk_add_f32 v[108:109], v[108:109], v[208:209] neg_lo:[0,1] neg_hi:[0,1]
  v_pk_add_f32 v[110:111], v[110:111], v[210:211] neg_lo:[0,1] neg_hi:[0,1]
  v_mov_b32_dpp v144, v224 quad_perm:[0,0,0,0] row_mask:0xf bank_mask:0xf
  v_mov_b32_dpp v145, v226 quad_perm:[2,2,2,2] row_mask:0xf bank_mask:0xf
  v_cvt_pk_bf16_f32 v108, 0, v108
  v_cvt_pk_bf16_f32 v109, 0, v109
  v_add_f32_dpp v144, v225, v144 quad_perm:[1,1,1,1] row_mask:0xf bank_mask:0xf
  v_add_f32_dpp v145, v227, v145 quad_perm:[3,3,3,3] row_mask:0xf bank_mask:0xf
  v_cvt_pk_bf16_f32 v110, 0, v110
  v_cvt_pk_bf16_f32 v111, 0, v111
  v_add_f32 v228, v144, v145
  v_pk_mul_f32 v[108:109], v[108:109], v[196:197]
  v_pk_mul_f32 v[110:111], v[110:111], v[198:199]
  v_cvt_pk_bf16_f32 v218, v108, v109
  v_cvt_pk_bf16_f32 v219, v110, v111
  s_waitcnt vmcnt(14)
  buffer_load_dwordx4 v[88:91], v95, s[8:11], s60 offen offset:512 nt
  v_mfma_f32_16x16x32_bf16 v[224:227], v[216:219], v[168:171], 0
  v_cvt_f32_i32 v108, v28
  v_cvt_f32_i32 v109, v29
  v_cvt_f32_i32 v110, v30
  v_cvt_f32_i32 v111, v31
  v_pk_add_f32 v[108:109], v[108:109], v[212:213] neg_lo:[0,1] neg_hi:[0,1]
  v_pk_add_f32 v[110:111], v[110:111], v[214:215] neg_lo:[0,1] neg_hi:[0,1]
  s_cmp_lt_u32 s64, s99
  s_cbranch_scc1 L_k_known1
L_k_spin1:
  v_mov_b32 v144, 61696
  ds_read_b32 v144, v144
  s_waitcnt lgkmcnt(0)
  v_readfirstlane_b32 s96, v144
  s_nop 1
  s_cmp_eq_u32 s96, 0
  s_cbranch_scc1 L_k_spin1
  s_mov_b32 s99, -1
L_k_known1:
  s_lshr_b32 s71, s64, 4
  s_andn2_b32 s71, s71, 1
  s_lshr_b32 s71, 0x12, s71
  s_and_b32 s71, s71, 3
  s_lshr_b32 s85, s96, s71
  s_andn2_b32 s70, s64, 1
  s_or_b32 s70, s70, s4
  s_cmp_lt_u32 s64, 8
  s_cselect_b32 s70, s70, s64
  s_cselect_b32 s85, s64, s85
  s_and_b32 s85, s85, 1
  s_and_b32 s70, s70, 31
  s_lshl_b32 s71, s71, 12
  s_add_u32 s70, s70, s5
  s_add_u32 s70, s70, s71
  s_mul_hi_u32 s84, s70, s90
  s_lshr_b32 s84, s84, 1
  s_mul_i32 s71, s84, 3
  s_sub_u32 s70, s70, s71
  s_lshl3_add_u32 s85, s70, s85
  s_mul_i32 s61, s84, 196608
  s_lshr_b32 s89, s84, 4
  s_lshl_b32 s70, s85, 5
  v_add_u32 v97, s70, v230
  v_mul_u32_u24 v97, 21846, v97
  v_lshrrev_b32 v97, 16, v97
  v_add_u32 v144, s85, v231
  v_lshrrev_b32 v145, v144, s91
  v_and_b32 v145, 1, v145
  v_cmp_eq_u32 s[54:55], 1, v145
  s_nop 1
  s_and_b64 s[52:53], s[54:55], s[56:57]
  s_andn2_b64 s[54:55], s[54:55], s[56:57]
  v_mul_u32_u24 v144, 43, v144
  v_lshrrev_b32 v144, 8, v144
  v_mul_u32_u24 v144, 384, v144
  v_add_u32 v234, v144, v233
  s_cmp_eq_u32 s89, s88
  s_cbranch_scc1 L_k_sameq1
  s_mul_i32 s70, s89, 1536
  buffer_load_dwordx2 v[174:175], v235, s[36:39], s70 offen offset:0
  buffer_load_dwordx2 v[176:177], v235, s[36:39], s70 offen offset:128
  buffer_load_dwordx2 v[178:179], v235, s[36:39], s70 offen offset:256
  s_mov_b32 s88, s89
L_k_sameq1:
  s_mul_i32 s62, s84, 1536
  buffer_load_dwordx2 v[180:181], v234, s[20:23], s62 offen offset:0
  buffer_load_dwordx2 v[186:187], v234, s[24:27], s62 offen offset:0
  buffer_load_dwordx2 v[182:183], v234, s[20:23], s62 offen offset:128
  buffer_load_dwordx2 v[188:189], v234, s[24:27], s62 offen offset:128
  buffer_load_dwordx2 v[184:185], v234, s[20:23], s62 offen offset:256
  buffer_load_dwordx2 v[190:191], v234, s[24:27], s62 offen offset:256
  v_cvt_pk_bf16_f32 v108, 0, v108
  v_cvt_pk_bf16_f32 v109, 0, v109
  v_cvt_pk_bf16_f32 v110, 0, v110
  v_cvt_pk_bf16_f32 v111, 0, v111
  v_pk_mul_f32 v[108:109], v[108:109], v[200:201]
  v_pk_mul_f32 v[110:111], v[110:111], v[202:203]
  v_cvt_pk_bf16_f32 v220, v108, v109
  v_cvt_pk_bf16_f32 v221, v110, v111
  s_cmp_lt_u32 s64, 96
  s_cbranch_scc1 L_k_keep
  s_lshr_b32 s71, s3, 5
  s_lshr_b32 s85, s96, s71
  s_bfe_u32 s85, s85, 0x10003
  s_and_b32 s70, s3, 31
  s_lshl_b32 s71, s71, 12
  s_add_u32 s70, s70, s5
  s_add_u32 s70, s70, s71
  s_mul_hi_u32 s84, s70, s90
  s_lshr_b32 s84, s84, 1
  s_mul_i32 s71, s84, 3
  s_sub_u32 s70, s70, s71
  s_lshl3_add_u32 s85, s70, s85
  s_mul_i32 s61, s84, 196608
  s_lshr_b32 s89, s84, 4
  s_lshl_b32 s70, s85, 5
  v_add_u32 v97, s70, v1
  v_mul_u32_u24 v97, 21846, v97
  v_lshrrev_b32 v97, 16, v97
  v_add_u32 v144, s85, v2
  v_lshrrev_b32 v145, v144, s91
  v_and_b32 v145, 1, v145
  v_cmp_eq_u32 s[54:55], 1, v145
  s_nop 1
  s_and_b64 s[52:53], s[54:55], s[58:59]
  s_andn2_b64 s[54:55], s[54:55], s[58:59]
  s_mov_b32 s16, s12
  s_mov_b32 s17, s13
  s_lshl_b32 s62, s84, 9
  v_lshl_add_u32 v98, v97, 1, v96
  buffer_load_short_d16_hi v112, v98, s[32:35], s62 offen
  buffer_load_short_d16_hi v113, v98, s[28:31], s62 offen
  v_mov_b32 v232, v3
L_k_keep:
  v_mad_u32_u24 v92, v97, s63, v232
  v_add_u32 v93, 768, v92
  v_add_u32 v94, 4608, v92
  v_add_u32 v95, 7680, v92
  v_cndmask_b32 v92, v92, v105, s[52:53]
  v_cndmask_b32 v95, v95, v105, s[54:55]
  s_waitcnt vmcnt(20)
  s_cbranch_vccnz L_kw1_18
  s_waitcnt vmcnt(15)
L_kw1_18:
  buffer_load_dwordx4 v[4:7], v92, s[16:19], s61 offen offset:0 nt
  v_mfma_f32_16x16x16_bf16 v[224:227], v[220:221], v[172:173], v[224:227]
  v_cvt_f32_i32 v108, v32
  v_cvt_f32_i32 v109, v33
  v_cvt_f32_i32 v110, v34
  v_cvt_f32_i32 v111, v35
  v_pk_add_f32 v[108:109], v[108:109], v[204:205] neg_lo:[0,1] neg_hi:[0,1]
  v_pk_add_f32 v[110:111], v[110:111], v[206:207] neg_lo:[0,1] neg_hi:[0,1]
  v_cvt_pk_bf16_f32 v108, 0, v108
  v_cvt_pk_bf16_f32 v109, 0, v109
  v_cvt_pk_bf16_f32 v110, 0, v110
  v_cvt_pk_bf16_f32 v111, 0, v111
  v_pk_mul_f32 v[108:109], v[108:109], v[192:193]
  v_pk_mul_f32 v[110:111], v[110:111], v[194:195]
  v_cvt_pk_bf16_f32 v216, v108, v109
  v_cvt_pk_bf16_f32 v217, v110, v111
  s_waitcnt vmcnt(20)
  buffer_load_dwordx4 v[8:11], v92, s[16:19], s61 offen offset:256 nt
  v_cvt_f32_i32 v108, v36
  v_cvt_f32_i32 v109, v37
  v_cvt_f32_i32 v110, v38
  v_cvt_f32_i32 v111, v39
  v_pk_add_f32 v[108:109], v[108:109], v[208:209] neg_lo:[0,1] neg_hi:[0,1]
  v_pk_add_f32 v[110:111], v[110:111], v[210:211] neg_lo:[0,1] neg_hi:[0,1]
  v_mov_b32_dpp v144, v224 quad_perm:[0,0,0,0] row_mask:0xf bank_mask:0xf
  v_mov_b32_dpp v145, v226 quad_perm:[2,2,2,2] row_mask:0xf bank_mask:0xf
  v_cvt_pk_bf16_f32 v108, 0, v108
  v_cvt_pk_bf16_f32 v109, 0, v109
  v_add_f32_dpp v144, v225, v144 quad_perm:[1,1,1,1] row_mask:0xf bank_mask:0xf
  v_add_f32_dpp v145, v227, v145 quad_perm:[3,3,3,3] row_mask:0xf bank_mask:0xf
  v_cvt_pk_bf16_f32 v110, 0, v110
  v_cvt_pk_bf16_f32 v111, 0, v111
  v_add_f32 v229, v144, v145
  v_pk_mul_f32 v[108:109], v[108:109], v[196:197]
  v_pk_mul_f32 v[110:111], v[110:111], v[198:199]
  v_cvt_pk_bf16_f32 v218, v108, v109
  v_cvt_pk_bf16_f32 v219, v110, v111
  s_waitcnt vmcnt(20)
  buffer_load_dwordx4 v[12:15], v92, s[16:19], s61 offen offset:512 nt
  v_mfma_f32_16x16x32_bf16 v[224:227], v[216:219], v[168:171], 0
  v_cvt_f32_i32 v108, v40
  v_cvt_f32_i32 v109, v41
  v_cvt_f32_i32 v110, v42
  v_cvt_f32_i32 v111, v43
  v_pk_add_f32 v[108:109], v[108:109], v[212:213] neg_lo:[0,1] neg_hi:[0,1]
  v_pk_add_f32 v[110:111], v[110:111], v[214:215] neg_lo:[0,1] neg_hi:[0,1]
  v_cvt_pk_bf16_f32 v108, 0, v108
  v_cvt_pk_bf16_f32 v228, 0, v228
  v_cvt_pk_bf16_f32 v109, 0, v109
  v_cvt_pk_bf16_f32 v229, 0, v229
  v_cvt_pk_bf16_f32 v110, 0, v110
  v_pk_mul_f32 v[228:229], v[228:229], s[68:69]
  v_cvt_pk_bf16_f32 v111, 0, v111
  v_cvt_pk_bf16_f32 v122, v228, v229
  v_pk_mul_f32 v[108:109], v[108:109], v[200:201]
  v_pk_mul_f32 v[110:111], v[110:111], v[202:203]
  v_cvt_pk_bf16_f32 v220, v108, v109
  v_cvt_pk_bf16_f32 v221, v110, v111
  s_waitcnt vmcnt(20)
  s_cbranch_vccnz L_kw1_21
  s_waitcnt vmcnt(15)
L_kw1_21:
  buffer_load_dwordx4 v[16:19], v93, s[16:19], s61 offen offset:0 nt
  v_mfma_f32_16x16x16_bf16 v[224:227], v[220:221], v[172:173], v[224:227]
  v_cvt_f32_i32 v108, v44
  v_cvt_f32_i32 v109, v45
  v_cvt_f32_i32 v110, v46
  v_cvt_f32_i32 v111, v47
  v_pk_add_f32 v[108:109], v[108:109], v[204:205] neg_lo:[0,1] neg_hi:[0,1]
  v_pk_add_f32 v[110:111], v[110:111], v[206:207] neg_lo:[0,1] neg_hi:[0,1]
  v_cvt_pk_bf16_f32 v108, 0, v108
  v_cvt_pk_bf16_f32 v109, 0, v109
  v_cvt_pk_bf16_f32 v110, 0, v110
  v_cvt_pk_bf16_f32 v111, 0, v111
  v_pk_mul_f32 v[108:109], v[108:109], v[192:193]
  v_pk_mul_f32 v[110:111], v[110:111], v[194:195]
  v_cvt_pk_bf16_f32 v216, v108, v109
  v_cvt_pk_bf16_f32 v217, v110, v111
  s_waitcnt vmcnt(20)
  buffer_load_dwordx4 v[20:23], v93, s[16:19], s61 offen offset:256 nt
  v_cvt_f32_i32 v108, v48
  v_cvt_f32_i32 v109, v49
  v_cvt_f32_i32 v110, v50
  v_cvt_f32_i32 v111, v51
  v_pk_add_f32 v[108:109], v[108:109], v[208:209] neg_lo:[0,1] neg_hi:[0,1]
  v_pk_add_f32 v[110:111], v[110:111], v[210:211] neg_lo:[0,1] neg_hi:[0,1]
  v_mov_b32_dpp v144, v224 quad_perm:[0,0,0,0] row_mask:0xf bank_mask:0xf
  v_mov_b32_dpp v145, v226 quad_perm:[2,2,2,2] row_mask:0xf bank_mask:0xf
  v_cvt_pk_bf16_f32 v108, 0, v108
  v_cvt_pk_bf16_f32 v109, 0, v109
  v_add_f32_dpp v144, v225, v144 quad_perm:[1,1,1,1] row_mask:0xf bank_mask:0xf
  v_add_f32_dpp v145, v227, v145 quad_perm:[3,3,3,3] row_mask:0xf bank_mask:0xf
  v_cvt_pk_bf16_f32 v110, 0, v110
  v_cvt_pk_bf16_f32 v111, 0, v111
  v_add_f32 v228, v144, v145
  v_pk_mul_f32 v[108:109], v[108:109], v[196:197]
  v_pk_mul_f32 v[110:111], v[110:111], v[198:199]
  v_cvt_pk_bf16_f32 v218, v108, v109
  v_cvt_pk_bf16_f32 v219, v110, v111
  s_waitcnt vmcnt(20)
  buffer_load_dwordx4 v[24:27], v93, s[16:19], s61 offen offset:512 nt
  v_mfma_f32_16x16x32_bf16 v[224:227], v[216:219], v[168:171], 0
  v_cvt_f32_i32 v108, v52
  v_cvt_f32_i32 v109, v53
  v_cvt_f32_i32 v110, v54
  v_cvt_f32_i32 v111, v55
  v_pk_add_f32 v[108:109], v[108:109], v[212:213] neg_lo:[0,1] neg_hi:[0,1]
  v_pk_add_f32 v[110:111], v[110:111], v[214:215] neg_lo:[0,1] neg_hi:[0,1]
  v_cvt_pk_bf16_f32 v108, 0, v108
  v_cvt_pk_bf16_f32 v109, 0, v109
  v_cvt_pk_bf16_f32 v110, 0, v110
  v_cvt_pk_bf16_f32 v111, 0, v111
  v_pk_mul_f32 v[108:109], v[108:109], v[200:201]
  v_pk_mul_f32 v[110:111], v[110:111], v[202:203]
  v_cvt_pk_bf16_f32 v220, v108, v109
  v_cvt_pk_bf16_f32 v221, v110, v111
  s_waitcnt vmcnt(20)
  s_cbranch_vccnz L_kw1_24
  s_waitcnt vmcnt(15)
L_kw1_24:
  buffer_load_dwordx4 v[28:31], v93, s[16:19], s61 offen offset:768 nt
  v_mfma_f32_16x16x16_bf16 v[224:227], v[220:221], v[172:173], v[224:227]
  v_cvt_f32_i32 v108, v56
  v_cvt_f32_i32 v109, v57
  v_cvt_f32_i32 v110, v58
  v_cvt_f32_i32 v111, v59
  v_pk_add_f32 v[108:109], v[108:109], v[204:205] neg_lo:[0,1] neg_hi:[0,1]
  v_pk_add_f32 v[110:111], v[110:111], v[206:207] neg_lo:[0,1] neg_hi:[0,1]
  v_cvt_pk_bf16_f32 v108, 0, v108
  v_cvt_pk_bf16_f32 v109, 0, v109
  v_cvt_pk_bf16_f32 v110, 0, v110
  v_cvt_pk_bf16_f32 v111, 0, v111
  v_pk_mul_f32 v[108:109], v[108:109], v[192:193]
  v_pk_mul_f32 v[110:111], v[110:111], v[194:195]
  v_cvt_pk_bf16_f32 v216, v108, v109
  v_cvt_pk_bf16_f32 v217, v110, v111
  s_waitcnt vmcnt(20)
  buffer_load_dwordx4 v[32:35], v93, s[16:19], s61 offen offset:1024 nt
  v_cvt_f32_i32 v108, v60
  v_cvt_f32_i32 v109, v61
  v_cvt_f32_i32 v110, v62
  v_cvt_f32_i32 v111, v63
  v_pk_add_f32 v[108:109], v[108:109], v[208:209] neg_lo:[0,1] neg_hi:[0,1]
  v_pk_add_f32 v[110:111], v[110:111], v[210:211] neg_lo:[0,1] neg_hi:[0,1]
  v_mov_b32_dpp v144, v224 quad_perm:[0,0,0,0] row_mask:0xf bank_mask:0xf
  v_mov_b32_dpp v145, v226 quad_perm:[2,2,2,2] row_mask:0xf bank_mask:0xf
  v_cvt_pk_bf16_f32 v108, 0, v108
  v_cvt_pk_bf16_f32 v109, 0, v109
  v_add_f32_dpp v144, v225, v144 quad_perm:[1,1,1,1] row_mask:0xf bank_mask:0xf
  v_add_f32_dpp v145, v227, v145 quad_perm:[3,3,3,3] row_mask:0xf bank_mask:0xf
  v_cvt_pk_bf16_f32 v110, 0, v110
  v_cvt_pk_bf16_f32 v111, 0, v111
  v_add_f32 v229, v144, v145
  v_pk_mul_f32 v[108:109], v[108:109], v[196:197]
  v_pk_mul_f32 v[110:111], v[110:111], v[198:199]
  v_cvt_pk_bf16_f32 v218, v108, v109
  v_cvt_pk_bf16_f32 v219, v110, v111
  s_waitcnt vmcnt(20)
  buffer_load_dwordx4 v[36:39], v93, s[16:19], s61 offen offset:1280 nt
  v_mfma_f32_16x16x32_bf16 v[224:227], v[216:219], v[168:171], 0
  v_cvt_f32_i32 v108, v64
  v_cvt_f32_i32 v109, v65
  v_cvt_f32_i32 v110, v66
  v_cvt_f32_i32 v111, v67
  v_pk_add_f32 v[108:109], v[108:109], v[212:213] neg_lo:[0,1] neg_hi:[0,1]
  v_pk_add_f32 v[110:111], v[110:111], v[214:215] neg_lo:[0,1] neg_hi:[0,1]
  v_cvt_pk_bf16_f32 v108, 0, v108
  v_cvt_pk_bf16_f32 v228, 0, v228
  v_cvt_pk_bf16_f32 v109, 0, v109
  v_cvt_pk_bf16_f32 v229, 0, v229
  v_cvt_pk_bf16_f32 v110, 0, v110
  v_pk_mul_f32 v[228:229], v[228:229], s[68:69]
  v_cvt_pk_bf16_f32 v111, 0, v111
  v_cvt_pk_bf16_f32 v123, v228, v229
  v_pk_mul_f32 v[108:109], v[108:109], v[200:201]
  v_pk_mul_f32 v[110:111], v[110:111], v[202:203]
  v_cvt_pk_bf16_f32 v220, v108, v109
  v_cvt_pk_bf16_f32 v221, v110, v111
  s_waitcnt vmcnt(20)
  s_cbranch_vccnz L_kw1_27
  s_waitcnt vmcnt(15)
L_kw1_27:
  buffer_load_dwordx4 v[40:43], v93, s[16:19], s61 offen offset:1536 nt
  v_mfma_f32_16x16x16_bf16 v[224:227], v[220:221], v[172:173], v[224:227]
  v_cvt_f32_i32 v108, v68
  v_cvt_f32_i32 v109, v69
  v_cvt_f32_i32 v110, v70
  v_cvt_f32_i32 v111, v71
  v_pk_add_f32 v[108:109], v[108:109], v[204:205] neg_lo:[0,1] neg_hi:[0,1]
  v_pk_add_f32 v[110:111], v[110:111], v[206:207] neg_lo:[0,1] neg_hi:[0,1]
  v_cvt_pk_bf16_f32 v108, 0, v108
  v_cvt_pk_bf16_f32 v109, 0, v109
  v_cvt_pk_bf16_f32 v110, 0, v110
  v_cvt_pk_bf16_f32 v111, 0, v111
  v_pk_mul_f32 v[108:109], v[108:109], v[192:193]
  v_pk_mul_f32 v[110:111], v[110:111], v[194:195]
  v_cvt_pk_bf16_f32 v216, v108, v109
  v_cvt_pk_bf16_f32 v217, v110, v111
  s_waitcnt vmcnt(20)
  buffer_load_dwordx4 v[44:47], v93, s[16:19], s61 offen offset:1792 nt
  v_cvt_f32_i32 v108, v72
  v_cvt_f32_i32 v109, v73
  v_cvt_f32_i32 v110, v74
  v_cvt_f32_i32 v111, v75
  v_pk_add_f32 v[108:109], v[108:109], v[208:209] neg_lo:[0,1] neg_hi:[0,1]
  v_pk_add_f32 v[110:111], v[110:111], v[210:211] neg_lo:[0,1] neg_hi:[0,1]
  v_mov_b32_dpp v144, v224 quad_perm:[0,0,0,0] row_mask:0xf bank_mask:0xf
  v_mov_b32_dpp v145, v226 quad_perm:[2,2,2,2] row_mask:0xf bank_mask:0xf
  v_cvt_pk_bf16_f32 v108, 0, v108
  v_cvt_pk_bf16_f32 v109, 0, v109
  v_add_f32_dpp v144, v225, v144 quad_perm:[1,1,1,1] row_mask:0xf bank_mask:0xf
  v_add_f32_dpp v145, v227, v145 quad_perm:[3,3,3,3] row_mask:0xf bank_mask:0xf
  v_cvt_pk_bf16_f32 v110, 0, v110
  v_cvt_pk_bf16_f32 v111, 0, v111
  v_add_f32 v228, v144, v145
  v_pk_mul_f32 v[108:109], v[108:109], v[196:197]
  v_pk_mul_f32 v[110:111], v[110:111], v[198:199]
  v_cvt_pk_bf16_f32 v218, v108, v109
  v_cvt_pk_bf16_f32 v219, v110, v111
  s_waitcnt vmcnt(20)
  buffer_load_dwordx4 v[48:51], v93, s[16:19], s61 offen offset:2048 nt
  v_mfma_f32_16x16x32_bf16 v[224:227], v[216:219], v[168:171], 0
  v_cvt_f32_i32 v108, v76
  v_cvt_f32_i32 v109, v77
  v_cvt_f32_i32 v110, v78
  v_cvt_f32_i32 v111, v79
  v_pk_add_f32 v[108:109], v[108:109], v[212:213] neg_lo:[0,1] neg_hi:[0,1]
  v_pk_add_f32 v[110:111], v[110:111], v[214:215] neg_lo:[0,1] neg_hi:[0,1]
  v_cvt_pk_bf16_f32 v108, 0, v108
  v_cvt_pk_bf16_f32 v109, 0, v109
  v_cvt_pk_bf16_f32 v110, 0, v110
  v_cvt_pk_bf16_f32 v111, 0, v111
  v_pk_mul_f32 v[108:109], v[108:109], v[200:201]
  v_pk_mul_f32 v[110:111], v[110:111], v[202:203]
  v_cvt_pk_bf16_f32 v220, v108, v109
  v_cvt_pk_bf16_f32 v221, v110, v111
  s_waitcnt vmcnt(20)
  s_cbranch_vccnz L_kw1_30
  s_waitcnt vmcnt(9)
L_kw1_30:
  buffer_load_dwordx4 v[52:55], v93, s[16:19], s61 offen offset:2304 nt
  v_mfma_f32_16x16x16_bf16 v[224:227], v[220:221], v[172:173], v[224:227]
  v_cvt_f32_i32 v108, v80
  v_cvt_f32_i32 v109, v81
  v_cvt_f32_i32 v110, v82
  v_cvt_f32_i32 v111, v83
  v_pk_add_f32 v[108:109], v[108:109], v[204:205] neg_lo:[0,1] neg_hi:[0,1]
  v_pk_add_f32 v[110:111], v[110:111], v[206:207] neg_lo:[0,1] neg_hi:[0,1]
  v_cvt_pk_bf16_f32 v108, 0, v108
  v_cvt_pk_bf16_f32 v109, 0, v109
  v_cvt_pk_bf16_f32 v110, 0, v110
  v_cvt_pk_bf16_f32 v111, 0, v111
  v_pk_mul_f32 v[108:109], v[108:109], v[192:193]
  v_pk_mul_f32 v[110:111], v[110:111], v[194:195]
  v_cvt_pk_bf16_f32 v216, v108, v109
  v_cvt_pk_bf16_f32 v217, v110, v111
  s_waitcnt vmcnt(20)
  buffer_load_dwordx4 v[56:59], v93, s[16:19], s61 offen offset:2560 nt
  v_cvt_f32_i32 v108, v84
  v_cvt_f32_i32 v109, v85
  v_cvt_f32_i32 v110, v86
  v_cvt_f32_i32 v111, v87
  v_pk_add_f32 v[108:109], v[108:109], v[208:209] neg_lo:[0,1] neg_hi:[0,1]
  v_pk_add_f32 v[110:111], v[110:111], v[210:211] neg_lo:[0,1] neg_hi:[0,1]
  v_mov_b32_dpp v144, v224 quad_perm:[0,0,0,0] row_mask:0xf bank_mask:0xf
  v_mov_b32_dpp v145, v226 quad_perm:[2,2,2,2] row_mask:0xf bank_mask:0xf
  v_cvt_pk_bf16_f32 v108, 0, v108
  v_cvt_pk_bf16_f32 v109, 0, v109
  v_add_f32_dpp v144, v225, v144 quad_perm:[1,1,1,1] row_mask:0xf bank_mask:0xf
  v_add_f32_dpp v145, v227, v145 quad_perm:[3,3,3,3] row_mask:0xf bank_mask:0xf
  v_cvt_pk_bf16_f32 v110, 0, v110
  v_cvt_pk_bf16_f32 v111, 0, v111
  v_add_f32 v229, v144, v145
  v_pk_mul_f32 v[108:109], v[108:109], v[196:197]
  v_pk_mul_f32 v[110:111], v[110:111], v[198:199]
  v_cvt_pk_bf16_f32 v218, v108, v109
  v_cvt_pk_bf16_f32 v219, v110, v111
  s_waitcnt vmcnt(20)
  buffer_load_dwordx4 v[60:63], v93, s[16:19], s61 offen offset:2816 nt
  v_mfma_f32_16x16x32_bf16 v[224:227], v[216:219], v[168:171], 0
  v_cvt_f32_i32 v108, v88
  v_cvt_f32_i32 v109, v89
  v_cvt_f32_i32 v110, v90
  v_cvt_f32_i32 v111, v91
  v_pk_add_f32 v[108:109], v[108:109], v[212:213] neg_lo:[0,1] neg_hi:[0,1]
  v_pk_add_f32 v[110:111], v[110:111], v[214:215] neg_lo:[0,1] neg_hi:[0,1]
  v_cvt_pk_bf16_f32 v108, 0, v108
  v_cvt_pk_bf16_f32 v228, 0, v228
  v_cvt_pk_bf16_f32 v109, 0, v109
  v_cvt_pk_bf16_f32 v229, 0, v229
  v_cvt_pk_bf16_f32 v110, 0, v110
  v_pk_mul_f32 v[228:229], v[228:229], s[68:69]
  v_cvt_pk_bf16_f32 v111, 0, v111
  v_cvt_pk_bf16_f32 v124, v228, v229
  v_pk_mul_f32 v[108:109], v[108:109], v[200:201]
  v_pk_mul_f32 v[110:111], v[110:111], v[202:203]
  v_cvt_pk_bf16_f32 v220, v108, v109
  v_cvt_pk_bf16_f32 v221, v110, v111
  s_mov_b32 s60, s61
  v_mov_b32 v146, s64
  v_mfma_f32_16x16x16_bf16 v[224:227], v[220:221], v[172:173], v[224:227]
  ds_write_b128 v99, v[120:123]
  v_add_u32 v99, 768, v99
  s_nop 5
  v_mov_b32_dpp v144, v224 quad_perm:[0,0,0,0] row_mask:0xf bank_mask:0xf
  v_mov_b32_dpp v145, v226 quad_perm:[2,2,2,2] row_mask:0xf bank_mask:0xf
  s_nop 0
  v_add_f32_dpp v144, v225, v144 quad_perm:[1,1,1,1] row_mask:0xf bank_mask:0xf
  v_add_f32_dpp v145, v227, v145 quad_perm:[3,3,3,3] row_mask:0xf bank_mask:0xf
  v_add_f32 v228, v144, v145
  v_cndmask_b32 v228, v228, v236, s[50:51]
  v_cvt_pk_bf16_f32 v228, 0, v228
  v_cvt_pk_bf16_f32 v229, 0, v229
  v_pk_mul_f32 v[228:229], v[228:229], s[68:69]
  v_cvt_pk_bf16_f32 v125, v228, v229
  ds_write_b64 v100, v[124:125] offset:256
  ds_write_b32 v104, v146
  v_add_u32 v100, 768, v100
  s_cmp_lt_u32 s64, 96
  s_cbranch_scc1 L_k
  v_subrev_u32 v99, 24576, v99
  v_subrev_u32 v100, 24576, v100
  s_mov_b32 s64, s3
  s_mov_b32 s88, s89
  s_mov_b32 s99, 0
  s_mov_b32 s36, s46
  s_and_b32 s37, s47, 0xffff
  s_cmp_lt_u32 s64, s99
  s_cbranch_scc1 L_v0_ok
L_v0_spin:
  v_mov_b32 v144, 61700
  ds_read_b32 v144, v144
  s_waitcnt lgkmcnt(0)
  v_readfirstlane_b32 s99, v144
  s_nop 1
  s_cmp_lt_u32 s64, s99
  s_cbranch_scc0 L_v0_spin
L_v0_ok:
  ds_read_b128 v[120:123], v99
  ds_read_b64 v[124:125], v100 offset:256
  v_mov_b32 v128, 0
  v_mov_b32 v129, 0
  v_mov_b32 v130, 0
  v_mov_b32 v131, 0
  v_mov_b32 v132, 0
  v_mov_b32 v133, 0
  v_mov_b32 v134, 0
  v_mov_b32 v135, 0
  v_mov_b32 v136, 0
  v_mov_b32 v137, 0
  v_mov_b32 v138, 0
  v_mov_b32 v139, 0
  v_mov_b32 v140, 0xff800000
  v_mov_b32 v142, 0x7f800000
  v_mov_b32 v143, 0
L_v0:
  s_add_u32 s97, s64, 96
  v_mov_b32 v146, s97
  s_mov_b32 s86, s84
  ds_write_b32 v104, v146
  s_add_u32 s64, s64, 2
  s_cmp_lt_u32 s64, s99
  s_cbranch_scc1 L_v10_ok
L_v10_spin:
  v_mov_b32 v144, 61700
  ds_read_b32 v144, v144
  s_waitcnt lgkmcnt(0)
  v_readfirstlane_b32 s99, v144
  s_nop 1
  s_cmp_lt_u32 s64, s99
  s_cbranch_scc0 L_v10_spin
L_v10_ok:
  s_lshr_b32 s71, s64, 5
  s_lshr_b32 s85, s96, s71
  s_bfe_u32 s85, s85, 0x10003
  s_and_b32 s70, s64, 31
  s_lshl_b32 s71, s71, 12
  s_add_u32 s70, s70, s5
  s_add_u32 s70, s70, s71
  s_mul_hi_u32 s84, s70, s90
  s_lshr_b32 s84, s84, 1
  s_mul_i32 s71, s84, 3
  s_sub_u32 s70, s70, s71
  s_lshl3_add_u32 s85, s70, s85
  s_mul_i32 s61, s84, 196608
  s_lshr_b32 s89, s84, 4
  s_lshl_b32 s70, s85, 5
  v_add_u32 v97, s70, v1
  v_mul_u32_u24 v97, 21846, v97
  v_lshrrev_b32 v97, 16, v97
  v_add_u32 v144, s85, v2
  v_lshrrev_b32 v145, v144, s91
  v_and_b32 v145, 1, v145
  v_cmp_eq_u32 s[54:55], 1, v145
  s_nop 1
  s_and_b64 s[52:53], s[54:55], s[58:59]
  s_andn2_b64 s[54:55], s[54:55], s[58:59]
  s_cmp_lt_u32 s64, 96
  s_cselect_b32 s61, s61, 805306368
  ds_read_b32 v106, v104 offset:8
  s_waitcnt vmcnt(14)
  s_cbranch_vccnz L_vw0_0
  s_waitcnt vmcnt(9)
L_vw0_0:
  buffer_load_dwordx4 v[64:67], v93, s[12:15], s60 offen offset:3072 nt
  v_mov_b32 v114, v112
  v_mov_b32 v115, v113
  v_cvt_f32_i32 v192, v4
  v_cvt_f32_i32 v193, v5
  v_mov_b32_dpp v116, v114 row_newbcast:0 row_mask:0xf bank_mask:0xf
  v_mov_b32_dpp v117, v115 row_newbcast:0 row_mask:0xf bank_mask:0xf
  v_cvt_f32_i32 v194, v6
  v_cvt_f32_i32 v195, v7
  v_pk_add_f32 v[192:193], v[192:193], v[116:117] op_sel_hi:[1,0] neg_lo:[0,1] neg_hi:[0,1]
  v_pk_add_f32 v[194:195], v[194:195], v[116:117] op_sel_hi:[1,0] neg_lo:[0,1] neg_hi:[0,1]
  v_cvt_pk_bf16_f32 v192, 0, v192
  v_cvt_pk_bf16_f32 v193, 0, v193
  v_cvt_pk_bf16_f32 v194, 0, v194
  v_cvt_pk_bf16_f32 v195, 0, v195
  v_pk_mul_f32 v[192:193], v[192:193], v[116:117] op_sel:[0,1]
  v_pk_mul_f32 v[194:195], v[194:195], v[116:117] op_sel:[0,1]
  s_waitcnt lgkmcnt(0)
  v_cmp_lt_u32 vcc, s97, v106
  s_waitcnt vmcnt(14)
  buffer_load_dwordx4 v[68:71], v93, s[12:15], s60 offen offset:3328 nt
  v_cvt_f32_i32 v196, v8
  v_cvt_f32_i32 v197, v9
  v_cvt_f32_i32 v198, v10
  v_cvt_f32_i32 v199, v11
  v_pk_add_f32 v[196:197], v[196:197], v[116:117] op_sel_hi:[1,0] neg_lo:[0,1] neg_hi:[0,1]
  v_pk_add_f32 v[198:199], v[198:199], v[116:117] op_sel_hi:[1,0] neg_lo:[0,1] neg_hi:[0,1]
  v_cvt_pk_bf16_f32 v196, 0, v196
  v_lshlrev_b32 v148, 16, v120
  v_cvt_pk_bf16_f32 v197, 0, v197
  v_and_b32 v149, s65, v120
  v_cvt_pk_bf16_f32 v198, 0, v198
  v_lshlrev_b32 v150, 16, v121
  v_cvt_pk_bf16_f32 v199, 0, v199
  v_and_b32 v151, s65, v121
  v_pk_mul_f32 v[196:197], v[196:197], v[116:117] op_sel:[0,1]
  v_lshlrev_b32 v152, 16, v122
  v_pk_mul_f32 v[198:199], v[198:199], v[116:117] op_sel:[0,1]
  s_waitcnt vmcnt(14)
  buffer_load_dwordx4 v[72:75], v93, s[12:15], s60 offen offset:3584 nt
  v_cvt_f32_i32 v200, v12
  v_cvt_f32_i32 v201, v13
  v_cvt_f32_i32 v202, v14
  v_cvt_f32_i32 v203, v15
  v_pk_add_f32 v[200:201], v[200:201], v[116:117] op_sel_hi:[1,0] neg_lo:[0,1] neg_hi:[0,1]
  v_pk_add_f32 v[202:203], v[202:203], v[116:117] op_sel_hi:[1,0] neg_lo:[0,1] neg_hi:[0,1]
  v_cvt_pk_bf16_f32 v200, 0, v200
  v_and_b32 v153, s65, v122
  v_cvt_pk_bf16_f32 v201, 0, v201
  v_lshlrev_b32 v154, 16, v123
  v_cvt_pk_bf16_f32 v202, 0, v202
  v_and_b32 v155, s65, v123
  v_cvt_pk_bf16_f32 v203, 0, v203
  v_lshlrev_b32 v156, 16, v124
  v_pk_mul_f32 v[200:201], v[200:201], v[116:117] op_sel:[0,1]
  v_and_b32 v157, s65, v124
  v_pk_mul_f32 v[202:203], v[202:203], v[116:117] op_sel:[0,1]
  s_waitcnt vmcnt(14)
  s_cbranch_vccnz L_vw0_3
  s_waitcnt vmcnt(9)
L_vw0_3:
  buffer_load_dwordx4 v[76:79], v94, s[12:15], s60 offen offset:0 nt
  v_cvt_f32_i32 v108, v16
  v_cvt_f32_i32 v109, v17
  v_mov_b32_dpp v116, v114 row_newbcast:1 row_mask:0xf bank_mask:0xf
  v_mov_b32_dpp v117, v115 row_newbcast:1 row_mask:0xf bank_mask:0xf
  v_cvt_f32_i32 v110, v18
  v_cvt_f32_i32 v111, v19
  v_pk_add_f32 v[108:109], v[108:109], v[116:117] op_sel_hi:[1,0] neg_lo:[0,1] neg_hi:[0,1]
  v_pk_add_f32 v[110:111], v[110:111], v[116:117] op_sel_hi:[1,0] neg_lo:[0,1] neg_hi:[0,1]
  s_lshl_b32 s62, s84, 9
  v_lshl_add_u32 v98, v97, 1, v96
  buffer_load_short_d16_hi v112, v98, s[32:35], s62 offen
  buffer_load_short_d16_hi v113, v98, s[28:31], s62 offen
  v_cvt_pk_bf16_f32 v108, 0, v108
  v_lshlrev_b32 v158, 16, v125
  v_cvt_pk_bf16_f32 v109, 0, v109
  v_add_u32 v99, 768, v99
  v_cvt_pk_bf16_f32 v110, 0, v110
  v_add_u32 v100, 768, v100
  v_cvt_pk_bf16_f32 v111, 0, v111
  v_max3_f32 v144, v148, v149, v150
  v_pk_mul_f32 v[108:109], v[108:109], v[116:117] op_sel:[0,1]
  ds_read_b128 v[120:123], v99
  v_pk_mul_f32 v[110:111], v[110:111], v[116:117] op_sel:[0,1]
  v_cvt_pk_bf16_f32 v204, v192, v108
  v_cvt_pk_bf16_f32 v208, v193, v109
  v_cvt_pk_bf16_f32 v212, v194, v110
  v_cvt_pk_bf16_f32 v216, v195, v111
  s_waitcnt vmcnt(16)
  buffer_load_dwordx4 v[80:83], v94, s[12:15], s60 offen offset:256 nt
  v_cvt_f32_i32 v108, v20
  v_cvt_f32_i32 v109, v21
  v_cvt_f32_i32 v110, v22
  v_cvt_f32_i32 v111, v23
  v_pk_add_f32 v[108:109], v[108:109], v[116:117] op_sel_hi:[1,0] neg_lo:[0,1] neg_hi:[0,1]
  v_pk_add_f32 v[110:111], v[110:111], v[116:117] op_sel_hi:[1,0] neg_lo:[0,1] neg_hi:[0,1]
  v_cvt_pk_bf16_f32 v108, 0, v108
  ds_read_b64 v[124:125], v100 offset:256
  v_cvt_pk_bf16_f32 v109, 0, v109
  v_max3_f32 v145, v151, v152, v153
  v_cvt_pk_bf16_f32 v110, 0, v110
  v_max3_f32 v144, v144, v154, v155
  v_cvt_pk_bf16_f32 v111, 0, v111
  v_max3_f32 v145, v145, v156, v157
  v_pk_mul_f32 v[108:109], v[108:109], v[116:117] op_sel:[0,1]
  v_max3_f32 v144, v144, v158, v140
  v_pk_mul_f32 v[110:111], v[110:111], v[116:117] op_sel:[0,1]
  v_cvt_pk_bf16_f32 v220, v196, v108
  v_cvt_pk_bf16_f32 v224, v197, v109
  v_cvt_pk_bf16_f32 v228, v198, v110
  v_cvt_pk_bf16_f32 v232, v199, v111
  s_waitcnt vmcnt(16)
  buffer_load_dwordx4 v[84:87], v94, s[12:15], s60 offen offset:512 nt
  v_cvt_f32_i32 v108, v24
  v_cvt_f32_i32 v109, v25
  v_cvt_f32_i32 v110, v26
  v_cvt_f32_i32 v111, v27
  v_pk_add_f32 v[108:109], v[108:109], v[116:117] op_sel_hi:[1,0] neg_lo:[0,1] neg_hi:[0,1]
  v_pk_add_f32 v[110:111], v[110:111], v[116:117] op_sel_hi:[1,0] neg_lo:[0,1] neg_hi:[0,1]
  v_cvt_pk_bf16_f32 v108, 0, v108
  v_max_f32 v144, v144, v145
  v_cvt_pk_bf16_f32 v109, 0, v109
  v_mov_b32 v145, v144
  v_cvt_pk_bf16_f32 v110, 0, v110
  s_nop 0
  v_permlane32_swap_b32 v144, v145
  v_cvt_pk_bf16_f32 v111, 0, v111
  v_max_f32 v144, v144, v145
  v_pk_mul_f32 v[108:109], v[108:109], v[116:117] op_sel:[0,1]
  v_mov_b32 v145, v144
  v_pk_mul_f32 v[110:111], v[110:111], v[116:117] op_sel:[0,1]
  v_cvt_pk_bf16_f32 v236, v200, v108
  v_cvt_pk_bf16_f32 v240, v201, v109
  v_cvt_pk_bf16_f32 v244, v202, v110
  v_cvt_pk_bf16_f32 v248, v203, v111
  s_waitcnt vmcnt(16)
  s_cbranch_vccnz L_vw0_6
  s_waitcnt vmcnt(11)
L_vw0_6:
  buffer_load_dwordx4 v[88:91], v94, s[12:15], s60 offen offset:768 nt
  v_cvt_f32_i32 v192, v28
  v_cvt_f32_i32 v193, v29
  v_mov_b32_dpp v116, v114 row_newbcast:2 row_mask:0xf bank_mask:0xf
  v_mov_b32_dpp v117, v115 row_newbcast:2 row_mask:0xf bank_mask:0xf
  v_cvt_f32_i32 v194, v30
  v_cvt_f32_i32 v195, v31
  v_pk_add_f32 v[192:193], v[192:193], v[116:117] op_sel_hi:[1,0] neg_lo:[0,1] neg_hi:[0,1]
  v_pk_add_f32 v[194:195], v[194:195], v[116:117] op_sel_hi:[1,0] neg_lo:[0,1] neg_hi:[0,1]
  v_cvt_pk_bf16_f32 v192, 0, v192
  v_permlane16_swap_b32 v144, v145
  v_cvt_pk_bf16_f32 v193, 0, v193
  v_max_f32 v140, v144, v145
  v_cvt_pk_bf16_f32 v194, 0, v194
  v_mul_f32 v144, s66, v140
  v_cvt_pk_bf16_f32 v195, 0, v195
  v_add_f32 v146, v144, v142
  v_pk_mul_f32 v[192:193], v[192:193], v[116:117] op_sel:[0,1]
  v_sub_f32 v142, 0, v144
  v_pk_mul_f32 v[194:195], v[194:195], v[116:117] op_sel:[0,1]
  s_waitcnt vmcnt(16)
  buffer_load_dwordx4 v[4:7], v94, s[12:15], s60 offen offset:1024 nt
  v_cvt_f32_i32 v196, v32
  v_cvt_f32_i32 v197, v33
  v_cvt_f32_i32 v198, v34
  v_cvt_f32_i32 v199, v35
  v_pk_add_f32 v[196:197], v[196:197], v[116:117] op_sel_hi:[1,0] neg_lo:[0,1] neg_hi:[0,1]
  v_pk_add_f32 v[198:199], v[198:199], v[116:117] op_sel_hi:[1,0] neg_lo:[0,1] neg_hi:[0,1]
  v_cvt_pk_bf16_f32 v196, 0, v196
  v_exp_f32 v146, -v146
  v_cvt_pk_bf16_f32 v197, 0, v197
  ds_bpermute_b32 v147, v101, v146
  v_cvt_pk_bf16_f32 v198, 0, v198
  v_fma_f32 v148, v148, s66, v142
  v_cvt_pk_bf16_f32 v199, 0, v199
  v_exp_f32 v148, v148
  v_pk_mul_f32 v[196:197], v[196:197], v[116:117] op_sel:[0,1]
  v_fma_f32 v149, v149, s66, v142
  v_pk_mul_f32 v[198:199], v[198:199], v[116:117] op_sel:[0,1]
  s_waitcnt vmcnt(16)
  buffer_load_dwordx4 v[8:11], v94, s[12:15], s60 offen offset:1280 nt
  v_cvt_f32_i32 v200, v36
  v_cvt_f32_i32 v201, v37
  v_cvt_f32_i32 v202, v38
  v_cvt_f32_i32 v203, v39
  v_pk_add_f32 v[200:201], v[200:201], v[116:117] op_sel_hi:[1,0] neg_lo:[0,1] neg_hi:[0,1]
  v_pk_add_f32 v[202:203], v[202:203], v[116:117] op_sel_hi:[1,0] neg_lo:[0,1] neg_hi:[0,1]
  v_cvt_pk_bf16_f32 v200, 0, v200
  v_exp_f32 v149, v149
  v_cvt_pk_bf16_f32 v201, 0, v201
  v_fma_f32 v150, v150, s66, v142
  v_cvt_pk_bf16_f32 v202, 0, v202
  v_exp_f32 v150, v150
  v_cvt_pk_bf16_f32 v203, 0, v203
  v_fma_f32 v151, v151, s66, v142
  v_pk_mul_f32 v[200:201], v[200:201], v[116:117] op_sel:[0,1]
  v_exp_f32 v151, v151
  v_pk_mul_f32 v[202:203], v[202:203], v[116:117] op_sel:[0,1]
  s_waitcnt vmcnt(16)
  s_cbranch_vccnz L_vw0_9
  s_waitcnt vmcnt(11)
L_vw0_9:
  buffer_load_dwordx4 v[12:15], v94, s[12:15], s60 offen offset:1536 nt
  v_cvt_f32_i32 v108, v40
  v_cvt_f32_i32 v109, v41
  v_mov_b32_dpp v116, v114 row_newbcast:3 row_mask:0xf bank_mask:0xf
  v_mov_b32_dpp v117, v115 row_newbcast:3 row_mask:0xf bank_mask:0xf
  v_cvt_f32_i32 v110, v42
  v_cvt_f32_i32 v111, v43
  v_pk_add_f32 v[108:109], v[108:109], v[116:117] op_sel_hi:[1,0] neg_lo:[0,1] neg_hi:[0,1]
  v_pk_add_f32 v[110:111], v[110:111], v[116:117] op_sel_hi:[1,0] neg_lo:[0,1] neg_hi:[0,1]
  v_cvt_pk_bf16_f32 v108, 0, v108
  v_fma_f32 v152, v152, s66, v142
  v_cvt_pk_bf16_f32 v109, 0, v109
  v_exp_f32 v152, v152
  v_cvt_pk_bf16_f32 v110, 0, v110
  v_fma_f32 v153, v153, s66, v142
  v_cvt_pk_bf16_f32 v111, 0, v111
  v_exp_f32 v153, v153
  v_pk_mul_f32 v[108:109], v[108:109], v[116:117] op_sel:[0,1]
  v_fma_f32 v154, v154, s66, v142
  v_pk_mul_f32 v[110:111], v[110:111], v[116:117] op_sel:[0,1]
  v_cvt_pk_bf16_f32 v205, v192, v108
  v_cvt_pk_bf16_f32 v209, v193, v109
  v_cvt_pk_bf16_f32 v213, v194, v110
  v_cvt_pk_bf16_f32 v217, v195, v111
  s_waitcnt vmcnt(16)
  buffer_load_dwordx4 v[16:19], v94, s[12:15], s60 offen offset:1792 nt
  v_cvt_f32_i32 v108, v44
  v_cvt_f32_i32 v109, v45
  v_cvt_f32_i32 v110, v46
  v_cvt_f32_i32 v111, v47
  v_pk_add_f32 v[108:109], v[108:109], v[116:117] op_sel_hi:[1,0] neg_lo:[0,1] neg_hi:[0,1]
  v_pk_add_f32 v[110:111], v[110:111], v[116:117] op_sel_hi:[1,0] neg_lo:[0,1] neg_hi:[0,1]
  v_cvt_pk_bf16_f32 v108, 0, v108
  v_exp_f32 v154, v154
  v_cvt_pk_bf16_f32 v109, 0, v109
  v_fma_f32 v155, v155, s66, v142
  v_cvt_pk_bf16_f32 v110, 0, v110
  v_exp_f32 v155, v155
  v_cvt_pk_bf16_f32 v111, 0, v111
  v_fma_f32 v156, v156, s66, v142
  v_pk_mul_f32 v[108:109], v[108:109], v[116:117] op_sel:[0,1]
  v_exp_f32 v156, v156
  v_pk_mul_f32 v[110:111], v[110:111], v[116:117] op_sel:[0,1]
  v_cvt_pk_bf16_f32 v221, v196, v108
  v_cvt_pk_bf16_f32 v225, v197, v109
  v_cvt_pk_bf16_f32 v229, v198, v110
  v_cvt_pk_bf16_f32 v233, v199, v111
  s_waitcnt vmcnt(16)
  buffer_load_dwordx4 v[20:23], v94, s[12:15], s60 offen offset:2048 nt
  v_cvt_f32_i32 v108, v48
  v_cvt_f32_i32 v109, v49
  v_cvt_f32_i32 v110, v50
  v_cvt_f32_i32 v111, v51
  v_pk_add_f32 v[108:109], v[108:109], v[116:117] op_sel_hi:[1,0] neg_lo:[0,1] neg_hi:[0,1]
  v_pk_add_f32 v[110:111], v[110:111], v[116:117] op_sel_hi:[1,0] neg_lo:[0,1] neg_hi:[0,1]
  v_cvt_pk_bf16_f32 v108, 0, v108
  v_fma_f32 v157, v157, s66, v142
  v_cvt_pk_bf16_f32 v109, 0, v109
  v_exp_f32 v157, v157
  v_cvt_pk_bf16_f32 v110, 0, v110
  v_fma_f32 v158, v158, s66, v142
  v_cvt_pk_bf16_f32 v111, 0, v111
  v_exp_f32 v158, v158
  v_pk_mul_f32 v[108:109], v[108:109], v[116:117] op_sel:[0,1]
  v_add_f32 v144, v148, v149
  v_pk_mul_f32 v[110:111], v[110:111], v[116:117] op_sel:[0,1]
  v_cvt_pk_bf16_f32 v237, v200, v108
  v_cvt_pk_bf16_f32 v241, v201, v109
  v_cvt_pk_bf16_f32 v245, v202, v110
  v_cvt_pk_bf16_f32 v249, v203, v111
  s_waitcnt vmcnt(16)
  s_cbranch_vccnz L_vw0_12
  s_waitcnt vmcnt(11)
L_vw0_12:
  buffer_load_dwordx4 v[24:27], v94, s[12:15], s60 offen offset:2304 nt
  v_cvt_f32_i32 v192, v52
  v_cvt_f32_i32 v193, v53
  v_mov_b32_dpp v116, v114 row_newbcast:4 row_mask:0xf bank_mask:0xf
  v_mov_b32_dpp v117, v115 row_newbcast:4 row_mask:0xf bank_mask:0xf
  v_cvt_f32_i32 v194, v54
  v_cvt_f32_i32 v195, v55
  v_pk_add_f32 v[192:193], v[192:193], v[116:117] op_sel_hi:[1,0] neg_lo:[0,1] neg_hi:[0,1]
  v_pk_add_f32 v[194:195], v[194:195], v[116:117] op_sel_hi:[1,0] neg_lo:[0,1] neg_hi:[0,1]
  v_cvt_pk_bf16_f32 v192, 0, v192
  v_add_f32 v145, v150, v151
  v_cvt_pk_bf16_f32 v193, 0, v193
  v_add_f32 v144, v144, v152
  v_cvt_pk_bf16_f32 v194, 0, v194
  v_add_f32 v145, v145, v153
  v_cvt_pk_bf16_f32 v195, 0, v195
  v_add_f32 v144, v144, v154
  v_pk_mul_f32 v[192:193], v[192:193], v[116:117] op_sel:[0,1]
  v_add_f32 v145, v145, v155
  v_pk_mul_f32 v[194:195], v[194:195], v[116:117] op_sel:[0,1]
  s_waitcnt vmcnt(16)
  buffer_load_dwordx4 v[28:31], v94, s[12:15], s60 offen offset:2560 nt
  v_cvt_f32_i32 v196, v56
  v_cvt_f32_i32 v197, v57
  v_cvt_f32_i32 v198, v58
  v_cvt_f32_i32 v199, v59
  v_pk_add_f32 v[196:197], v[196:197], v[116:117] op_sel_hi:[1,0] neg_lo:[0,1] neg_hi:[0,1]
  v_pk_add_f32 v[198:199], v[198:199], v[116:117] op_sel_hi:[1,0] neg_lo:[0,1] neg_hi:[0,1]
  v_cvt_pk_bf16_f32 v196, 0, v196
  v_add_f32 v144, v144, v156
  v_cvt_pk_bf16_f32 v197, 0, v197
  v_add_f32 v145, v145, v157
  v_cvt_pk_bf16_f32 v198, 0, v198
  v_add_f32 v144, v144, v158
  v_cvt_pk_bf16_f32 v199, 0, v199
  v_add_f32 v144, v144, v145
  v_pk_mul_f32 v[196:197], v[196:197], v[116:117] op_sel:[0,1]
  v_fma_f32 v143, v143, v146, v144
  v_pk_mul_f32 v[198:199], v[198:199], v[116:117] op_sel:[0,1]
  s_waitcnt vmcnt(16)
  buffer_load_dwordx4 v[32:35], v94, s[12:15], s60 offen offset:2816 nt
  v_cvt_f32_i32 v200, v60
  v_cvt_f32_i32 v201, v61
  v_cvt_f32_i32 v202, v62
  v_cvt_f32_i32 v203, v63
  v_pk_add_f32 v[200:201], v[200:201], v[116:117] op_sel_hi:[1,0] neg_lo:[0,1] neg_hi:[0,1]
  v_pk_add_f32 v[202:203], v[202:203], v[116:117] op_sel_hi:[1,0] neg_lo:[0,1] neg_hi:[0,1]
  v_cvt_pk_bf16_f32 v200, 0, v200
  v_cvt_pk_bf16_f32 v159, v148, v149
  v_cvt_pk_bf16_f32 v201, 0, v201
  v_cvt_pk_bf16_f32 v160, v150, v151
  v_cvt_pk_bf16_f32 v202, 0, v202
  v_cvt_pk_bf16_f32 v161, v152, v153
  v_cvt_pk_bf16_f32 v203, 0, v203
  v_cvt_pk_bf16_f32 v162, v154, v155
  v_pk_mul_f32 v[200:201], v[200:201], v[116:117] op_sel:[0,1]
  v_cvt_pk_bf16_f32 v163, v156, v157
  v_pk_mul_f32 v[202:203], v[202:203], v[116:117] op_sel:[0,1]
  s_waitcnt vmcnt(16)
  s_cbranch_vccnz L_vw0_15
  s_waitcnt vmcnt(9)
L_vw0_15:
  buffer_load_dwordx4 v[36:39], v95, s[12:15], s60 offen offset:0 nt
  v_cvt_f32_i32 v108, v64
  v_cvt_f32_i32 v109, v65
  v_mov_b32_dpp v116, v114 row_newbcast:5 row_mask:0xf bank_mask:0xf
  v_mov_b32_dpp v117, v115 row_newbcast:5 row_mask:0xf bank_mask:0xf
  v_cvt_f32_i32 v110, v66
  v_cvt_f32_i32 v111, v67
  v_pk_add_f32 v[108:109], v[108:109], v[116:117] op_sel_hi:[1,0] neg_lo:[0,1] neg_hi:[0,1]
  v_pk_add_f32 v[110:111], v[110:111], v[116:117] op_sel_hi:[1,0] neg_lo:[0,1] neg_hi:[0,1]
  v_cvt_pk_bf16_f32 v108, 0, v108
  v_cvt_pk_bf16_f32 v164, v158, 0
  v_cvt_pk_bf16_f32 v109, 0, v109
  v_cndmask_b32 v168, 0, v159, s[72:73]
  v_cvt_pk_bf16_f32 v110, 0, v110
  v_cndmask_b32 v169, 0, v160, s[72:73]
  v_cvt_pk_bf16_f32 v111, 0, v111
  v_cndmask_b32 v170, 0, v161, s[72:73]
  v_pk_mul_f32 v[108:109], v[108:109], v[116:117] op_sel:[0,1]
  v_cndmask_b32 v171, 0, v162, s[72:73]
  v_pk_mul_f32 v[110:111], v[110:111], v[116:117] op_sel:[0,1]
  v_cvt_pk_bf16_f32 v206, v192, v108
  v_cvt_pk_bf16_f32 v210, v193, v109
  v_cvt_pk_bf16_f32 v214, v194, v110
  v_cvt_pk_bf16_f32 v218, v195, v111
  s_waitcnt vmcnt(16)
  buffer_load_dwordx4 v[40:43], v95, s[12:15], s60 offen offset:256 nt
  v_cvt_f32_i32 v108, v68
  v_cvt_f32_i32 v109, v69
  v_cvt_f32_i32 v110, v70
  v_cvt_f32_i32 v111, v71
  v_pk_add_f32 v[108:109], v[108:109], v[116:117] op_sel_hi:[1,0] neg_lo:[0,1] neg_hi:[0,1]
  v_pk_add_f32 v[110:111], v[110:111], v[116:117] op_sel_hi:[1,0] neg_lo:[0,1] neg_hi:[0,1]
  v_cvt_pk_bf16_f32 v108, 0, v108
  v_cndmask_b32 v172, 0, v159, s[74:75]
  v_cvt_pk_bf16_f32 v109, 0, v109
  v_cndmask_b32 v173, 0, v160, s[74:75]
  v_cvt_pk_bf16_f32 v110, 0, v110
  v_cndmask_b32 v174, 0, v161, s[74:75]
  v_cvt_pk_bf16_f32 v111, 0, v111
  v_cndmask_b32 v175, 0, v162, s[74:75]
  v_pk_mul_f32 v[108:109], v[108:109], v[116:117] op_sel:[0,1]
  v_cndmask_b32 v176, 0, v159, s[76:77]
  v_pk_mul_f32 v[110:111], v[110:111], v[116:117] op_sel:[0,1]
  v_cvt_pk_bf16_f32 v222, v196, v108
  v_cvt_pk_bf16_f32 v226, v197, v109
  v_cvt_pk_bf16_f32 v230, v198, v110
  v_cvt_pk_bf16_f32 v234, v199, v111
  s_waitcnt vmcnt(16)
  buffer_load_dwordx4 v[44:47], v95, s[12:15], s60 offen offset:512 nt
  v_cvt_f32_i32 v108, v72
  v_cvt_f32_i32 v109, v73
  v_cvt_f32_i32 v110, v74
  v_cvt_f32_i32 v111, v75
  v_pk_add_f32 v[108:109], v[108:109], v[116:117] op_sel_hi:[1,0] neg_lo:[0,1] neg_hi:[0,1]
  v_pk_add_f32 v[110:111], v[110:111], v[116:117] op_sel_hi:[1,0] neg_lo:[0,1] neg_hi:[0,1]
  v_cvt_pk_bf16_f32 v108, 0, v108
  v_cndmask_b32 v177, 0, v160, s[76:77]
  v_cvt_pk_bf16_f32 v109, 0, v109
  v_cndmask_b32 v178, 0, v161, s[76:77]
  v_cvt_pk_bf16_f32 v110, 0, v110
  v_cndmask_b32 v179, 0, v162, s[76:77]
  v_cvt_pk_bf16_f32 v111, 0, v111
  v_cndmask_b32 v180, 0, v159, s[78:79]
  v_pk_mul_f32 v[108:109], v[108:109], v[116:117] op_sel:[0,1]
  v_cndmask_b32 v181, 0, v160, s[78:79]
  v_pk_mul_f32 v[110:111], v[110:111], v[116:117] op_sel:[0,1]
  v_cvt_pk_bf16_f32 v238, v200, v108
  v_cvt_pk_bf16_f32 v242, v201, v109
  v_cvt_pk_bf16_f32 v246, v202, v110
  v_cvt_pk_bf16_f32 v250, v203, v111
  v_mad_u32_u24 v92, v97, s63, v3
  v_add_u32 v93, 768, v92
  v_add_u32 v94, 4608, v92
  v_add_u32 v95, 7680, v92
  v_cndmask_b32 v92, v92, v105, s[52:53]
  v_cndmask_b32 v95, v95, v105, s[54:55]
  s_waitcnt vmcnt(16)
  s_cbranch_vccnz L_vw0_18
  s_waitcnt vmcnt(9)
L_vw0_18:
  buffer_load_dwordx4 v[48:51], v92, s[12:15], s61 offen offset:0 nt
  v_cvt_f32_i32 v192, v76
  v_cvt_f32_i32 v193, v77
  v_mov_b32_dpp v116, v114 row_newbcast:6 row_mask:0xf bank_mask:0xf
  v_mov_b32_dpp v117, v115 row_newbcast:6 row_mask:0xf bank_mask:0xf
  v_cvt_f32_i32 v194, v78
  v_cvt_f32_i32 v195, v79
  v_pk_add_f32 v[192:193], v[192:193], v[116:117] op_sel_hi:[1,0] neg_lo:[0,1] neg_hi:[0,1]
  v_pk_add_f32 v[194:195], v[194:195], v[116:117] op_sel_hi:[1,0] neg_lo:[0,1] neg_hi:[0,1]
  v_cvt_pk_bf16_f32 v192, 0, v192
  v_cndmask_b32 v182, 0, v161, s[78:79]
  v_cvt_pk_bf16_f32 v193, 0, v193
  v_cndmask_b32 v183, 0, v162, s[78:79]
  v_cvt_pk_bf16_f32 v194, 0, v194
  s_waitcnt lgkmcnt(0)
  v_cvt_pk_bf16_f32 v195, 0, v195
  v_mul_f32 v128, v147, v128
  v_pk_mul_f32 v[192:193], v[192:193], v[116:117] op_sel:[0,1]
  v_mul_f32 v129, v147, v129
  v_pk_mul_f32 v[194:195], v[194:195], v[116:117] op_sel:[0,1]
  s_waitcnt vmcnt(14)
  buffer_load_dwordx4 v[52:55], v92, s[12:15], s61 offen offset:256 nt
  v_cvt_f32_i32 v196, v80
  v_cvt_f32_i32 v197, v81
  v_cvt_f32_i32 v198, v82
  v_cvt_f32_i32 v199, v83
  v_pk_add_f32 v[196:197], v[196:197], v[116:117] op_sel_hi:[1,0] neg_lo:[0,1] neg_hi:[0,1]
  v_pk_add_f32 v[198:199], v[198:199], v[116:117] op_sel_hi:[1,0] neg_lo:[0,1] neg_hi:[0,1]
  v_cvt_pk_bf16_f32 v196, 0, v196
  v_mul_f32 v130, v147, v130
  v_cvt_pk_bf16_f32 v197, 0, v197
  v_mul_f32 v131, v147, v131
  v_cvt_pk_bf16_f32 v198, 0, v198
  v_mul_f32 v132, v147, v132
  v_cvt_pk_bf16_f32 v199, 0, v199
  v_mul_f32 v133, v147, v133
  v_pk_mul_f32 v[196:197], v[196:197], v[116:117] op_sel:[0,1]
  v_mul_f32 v134, v147, v134
  v_pk_mul_f32 v[198:199], v[198:199], v[116:117] op_sel:[0,1]
  s_waitcnt vmcnt(14)
  buffer_load_dwordx4 v[56:59], v92, s[12:15], s61 offen offset:512 nt
  v_cvt_f32_i32 v200, v84
  v_cvt_f32_i32 v201, v85
  v_cvt_f32_i32 v202, v86
  v_cvt_f32_i32 v203, v87
  v_pk_add_f32 v[200:201], v[200:201], v[116:117] op_sel_hi:[1,0] neg_lo:[0,1] neg_hi:[0,1]
  v_pk_add_f32 v[202:203], v[202:203], v[116:117] op_sel_hi:[1,0] neg_lo:[0,1] neg_hi:[0,1]
  v_cvt_pk_bf16_f32 v200, 0, v200
  v_mul_f32 v135, v147, v135
  v_cvt_pk_bf16_f32 v201, 0, v201
  v_mul_f32 v136, v147, v136
  v_cvt_pk_bf16_f32 v202, 0, v202
  v_mul_f32 v137, v147, v137
  v_cvt_pk_bf16_f32 v203, 0, v203
  v_mul_f32 v138, v147, v138
  v_pk_mul_f32 v[200:201], v[200:201], v[116:117] op_sel:[0,1]
  v_mul_f32 v139, v147, v139
  v_pk_mul_f32 v[202:203], v[202:203], v[116:117] op_sel:[0,1]
  s_waitcnt vmcnt(14)
  s_cbranch_vccnz L_vw0_21
  s_waitcnt vmcnt(9)
L_vw0_21:
  buffer_load_dwordx4 v[60:63], v93, s[12:15], s61 offen offset:0 nt
  v_cvt_f32_i32 v108, v88
  v_cvt_f32_i32 v109, v89
  v_mov_b32_dpp v116, v114 row_newbcast:7 row_mask:0xf bank_mask:0xf
  v_mov_b32_dpp v117, v115 row_newbcast:7 row_mask:0xf bank_mask:0xf
  v_cvt_f32_i32 v110, v90
  v_cvt_f32_i32 v111, v91
  v_pk_add_f32 v[108:109], v[108:109], v[116:117] op_sel_hi:[1,0] neg_lo:[0,1] neg_hi:[0,1]
  v_pk_add_f32 v[110:111], v[110:111], v[116:117] op_sel_hi:[1,0] neg_lo:[0,1] neg_hi:[0,1]
  v_cvt_pk_bf16_f32 v108, 0, v108
  v_cvt_pk_bf16_f32 v109, 0, v109
  v_cvt_pk_bf16_f32 v110, 0, v110
  v_cvt_pk_bf16_f32 v111, 0, v111
  v_pk_mul_f32 v[108:109], v[108:109], v[116:117] op_sel:[0,1]
  v_pk_mul_f32 v[110:111], v[110:111], v[116:117] op_sel:[0,1]
  v_cvt_pk_bf16_f32 v207, v192, v108
  v_cvt_pk_bf16_f32 v211, v193, v109
  v_cvt_pk_bf16_f32 v215, v194, v110
  v_cvt_pk_bf16_f32 v219, v195, v111
  v_mfma_f32_16x16x32_bf16 v[128:131], v[168:171], v[204:207], v[128:131]
  v_mfma_f32_16x16x32_bf16 v[128:131], v[172:175], v[208:211], v[128:131]
  v_mfma_f32_16x16x32_bf16 v[128:131], v[176:179], v[212:215], v[128:131]
  v_mfma_f32_16x16x32_bf16 v[128:131], v[180:183], v[216:219], v[128:131]
  s_waitcnt vmcnt(14)
  buffer_load_dwordx4 v[64:67], v93, s[12:15], s61 offen offset:256 nt
  v_cvt_f32_i32 v108, v4
  v_cvt_f32_i32 v109, v5
  v_cvt_f32_i32 v110, v6
  v_cvt_f32_i32 v111, v7
  v_pk_add_f32 v[108:109], v[108:109], v[116:117] op_sel_hi:[1,0] neg_lo:[0,1] neg_hi:[0,1]
  v_pk_add_f32 v[110:111], v[110:111], v[116:117] op_sel_hi:[1,0] neg_lo:[0,1] neg_hi:[0,1]
  v_cvt_pk_bf16_f32 v108, 0, v108
  v_cvt_pk_bf16_f32 v109, 0, v109
  v_cvt_pk_bf16_f32 v110, 0, v110
  v_cvt_pk_bf16_f32 v111, 0, v111
  v_pk_mul_f32 v[108:109], v[108:109], v[116:117] op_sel:[0,1]
  v_pk_mul_f32 v[110:111], v[110:111], v[116:117] op_sel:[0,1]
  v_cvt_pk_bf16_f32 v223, v196, v108
  v_cvt_pk_bf16_f32 v227, v197, v109
  v_cvt_pk_bf16_f32 v231, v198, v110
  v_cvt_pk_bf16_f32 v235, v199, v111
  v_mfma_f32_16x16x32_bf16 v[132:135], v[168:171], v[220:223], v[132:135]
  v_mfma_f32_16x16x32_bf16 v[132:135], v[172:175], v[224:227], v[132:135]
  v_mfma_f32_16x16x32_bf16 v[132:135], v[176:179], v[228:231], v[132:135]
  v_mfma_f32_16x16x32_bf16 v[132:135], v[180:183], v[232:235], v[132:135]
  s_waitcnt vmcnt(14)
  buffer_load_dwordx4 v[68:71], v93, s[12:15], s61 offen offset:512 nt
  v_cvt_f32_i32 v108, v8
  v_cvt_f32_i32 v109, v9
  v_cvt_f32_i32 v110, v10
  v_cvt_f32_i32 v111, v11
  v_pk_add_f32 v[108:109], v[108:109], v[116:117] op_sel_hi:[1,0] neg_lo:[0,1] neg_hi:[0,1]
  v_pk_add_f32 v[110:111], v[110:111], v[116:117] op_sel_hi:[1,0] neg_lo:[0,1] neg_hi:[0,1]
  v_cvt_pk_bf16_f32 v108, 0, v108
  v_cvt_pk_bf16_f32 v109, 0, v109
  v_cvt_pk_bf16_f32 v110, 0, v110
  v_cvt_pk_bf16_f32 v111, 0, v111
  v_pk_mul_f32 v[108:109], v[108:109], v[116:117] op_sel:[0,1]
  v_pk_mul_f32 v[110:111], v[110:111], v[116:117] op_sel:[0,1]
  v_cvt_pk_bf16_f32 v239, v200, v108
  v_cvt_pk_bf16_f32 v243, v201, v109
  v_cvt_pk_bf16_f32 v247, v202, v110
  v_cvt_pk_bf16_f32 v251, v203, v111
  v_mfma_f32_16x16x32_bf16 v[136:139], v[168:171], v[236:239], v[136:139]
  v_mfma_f32_16x16x32_bf16 v[136:139], v[172:175], v[240:243], v[136:139]
  v_mfma_f32_16x16x32_bf16 v[136:139], v[176:179], v[244:247], v[136:139]
  v_mfma_f32_16x16x32_bf16 v[136:139], v[180:183], v[248:251], v[136:139]
  s_waitcnt vmcnt(14)
  s_cbranch_vccnz L_vw0_24
  s_waitcnt vmcnt(9)
L_vw0_24:
  buffer_load_dwordx4 v[72:75], v93, s[12:15], s61 offen offset:768 nt
  v_cvt_f32_i32 v192, v12
  v_cvt_f32_i32 v193, v13
  v_mov_b32_dpp v116, v114 row_newbcast:8 row_mask:0xf bank_mask:0xf
  v_mov_b32_dpp v117, v115 row_newbcast:8 row_mask:0xf bank_mask:0xf
  v_cvt_f32_i32 v194, v14
  v_cvt_f32_i32 v195, v15
  v_pk_add_f32 v[192:193], v[192:193], v[116:117] op_sel_hi:[1,0] neg_lo:[0,1] neg_hi:[0,1]
  v_pk_add_f32 v[194:195], v[194:195], v[116:117] op_sel_hi:[1,0] neg_lo:[0,1] neg_hi:[0,1]
  v_cvt_pk_bf16_f32 v192, 0, v192
  v_cndmask_b32 v184, 0, v163, s[72:73]
  v_cvt_pk_bf16_f32 v193, 0, v193
  v_cndmask_b32 v185, 0, v164, s[72:73]
  v_cvt_pk_bf16_f32 v194, 0, v194
  v_cndmask_b32 v186, 0, v163, s[74:75]
  v_cvt_pk_bf16_f32 v195, 0, v195
  v_cndmask_b32 v187, 0, v164, s[74:75]
  v_pk_mul_f32 v[192:193], v[192:193], v[116:117] op_sel:[0,1]
  v_cndmask_b32 v188, 0, v163, s[76:77]
  v_pk_mul_f32 v[194:195], v[194:195], v[116:117] op_sel:[0,1]
  s_waitcnt vmcnt(14)
  buffer_load_dwordx4 v[76:79], v93, s[12:15], s61 offen offset:1024 nt
  v_cvt_f32_i32 v196, v16
  v_cvt_f32_i32 v197, v17
  v_cvt_f32_i32 v198, v18
  v_cvt_f32_i32 v199, v19
  v_pk_add_f32 v[196:197], v[196:197], v[116:117] op_sel_hi:[1,0] neg_lo:[0,1] neg_hi:[0,1]
  v_pk_add_f32 v[198:199], v[198:199], v[116:117] op_sel_hi:[1,0] neg_lo:[0,1] neg_hi:[0,1]
  v_cvt_pk_bf16_f32 v196, 0, v196
  v_cndmask_b32 v189, 0, v164, s[76:77]
  v_cvt_pk_bf16_f32 v197, 0, v197
  v_cndmask_b32 v190, 0, v163, s[78:79]
  v_cvt_pk_bf16_f32 v198, 0, v198
  v_cndmask_b32 v191, 0, v164, s[78:79]
  v_cvt_pk_bf16_f32 v199, 0, v199
  v_pk_mul_f32 v[196:197], v[196:197], v[116:117] op_sel:[0,1]
  v_pk_mul_f32 v[198:199], v[198:199], v[116:117] op_sel:[0,1]
  s_waitcnt vmcnt(14)
  buffer_load_dwordx4 v[80:83], v93, s[12:15], s61 offen offset:1280 nt
  v_cvt_f32_i32 v200, v20
  v_cvt_f32_i32 v201, v21
  v_cvt_f32_i32 v202, v22
  v_cvt_f32_i32 v203, v23
  v_pk_add_f32 v[200:201], v[200:201], v[116:117] op_sel_hi:[1,0] neg_lo:[0,1] neg_hi:[0,1]
  v_pk_add_f32 v[202:203], v[202:203], v[116:117] op_sel_hi:[1,0] neg_lo:[0,1] neg_hi:[0,1]
  v_cvt_pk_bf16_f32 v200, 0, v200
  v_cvt_pk_bf16_f32 v201, 0, v201
  v_cvt_pk_bf16_f32 v202, 0, v202
  v_cvt_pk_bf16_f32 v203, 0, v203
  v_pk_mul_f32 v[200:201], v[200:201], v[116:117] op_sel:[0,1]
  v_pk_mul_f32 v[202:203], v[202:203], v[116:117] op_sel:[0,1]
  s_waitcnt vmcnt(14)
  s_cbranch_vccnz L_vw0_27
  s_waitcnt vmcnt(9)
L_vw0_27:
  buffer_load_dwordx4 v[84:87], v93, s[12:15], s61 offen offset:1536 nt
  v_cvt_f32_i32 v108, v24
  v_cvt_f32_i32 v109, v25
  v_mov_b32_dpp v116, v114 row_newbcast:9 row_mask:0xf bank_mask:0xf
  v_mov_b32_dpp v117, v115 row_newbcast:9 row_mask:0xf bank_mask:0xf
  v_cvt_f32_i32 v110, v26
  v_cvt_f32_i32 v111, v27
  v_pk_add_f32 v[108:109], v[108:109], v[116:117] op_sel_hi:[1,0] neg_lo:[0,1] neg_hi:[0,1]
  v_pk_add_f32 v[110:111], v[110:111], v[116:117] op_sel_hi:[1,0] neg_lo:[0,1] neg_hi:[0,1]
  v_cvt_pk_bf16_f32 v108, 0, v108
  v_cvt_pk_bf16_f32 v109, 0, v109
  v_cvt_pk_bf16_f32 v110, 0, v110
  v_cvt_pk_bf16_f32 v111, 0, v111
  v_pk_mul_f32 v[108:109], v[108:109], v[116:117] op_sel:[0,1]
  v_pk_mul_f32 v[110:111], v[110:111], v[116:117] op_sel:[0,1]
  v_cvt_pk_bf16_f32 v204, v192, v108
  v_cvt_pk_bf16_f32 v208, v193, v109
  v_cvt_pk_bf16_f32 v212, v194, v110
  v_cvt_pk_bf16_f32 v216, v195, v111
  s_waitcnt vmcnt(14)
  buffer_load_dwordx4 v[88:91], v93, s[12:15], s61 offen offset:1792 nt
  v_cvt_f32_i32 v108, v28
  v_cvt_f32_i32 v109, v29
  v_cvt_f32_i32 v110, v30
  v_cvt_f32_i32 v111, v31
  v_pk_add_f32 v[108:109], v[108:109], v[116:117] op_sel_hi:[1,0] neg_lo:[0,1] neg_hi:[0,1]
  v_pk_add_f32 v[110:111], v[110:111], v[116:117] op_sel_hi:[1,0] neg_lo:[0,1] neg_hi:[0,1]
  v_cvt_pk_bf16_f32 v108, 0, v108
  v_cvt_pk_bf16_f32 v109, 0, v109
  v_cvt_pk_bf16_f32 v110, 0, v110
  v_cvt_pk_bf16_f32 v111, 0, v111
  v_pk_mul_f32 v[108:109], v[108:109], v[116:117] op_sel:[0,1]
  v_pk_mul_f32 v[110:111], v[110:111], v[116:117] op_sel:[0,1]
  v_cvt_pk_bf16_f32 v220, v196, v108
  v_cvt_pk_bf16_f32 v224, v197, v109
  v_cvt_pk_bf16_f32 v228, v198, v110
  v_cvt_pk_bf16_f32 v232, v199, v111
  s_waitcnt vmcnt(14)
  buffer_load_dwordx4 v[4:7], v93, s[12:15], s61 offen offset:2048 nt
  v_cvt_f32_i32 v108, v32
  v_cvt_f32_i32 v109, v33
  v_cvt_f32_i32 v110, v34
  v_cvt_f32_i32 v111, v35
  v_pk_add_f32 v[108:109], v[108:109], v[116:117] op_sel_hi:[1,0] neg_lo:[0,1] neg_hi:[0,1]
  v_pk_add_f32 v[110:111], v[110:111], v[116:117] op_sel_hi:[1,0] neg_lo:[0,1] neg_hi:[0,1]
  v_cvt_pk_bf16_f32 v108, 0, v108
  v_cvt_pk_bf16_f32 v109, 0, v109
  v_cvt_pk_bf16_f32 v110, 0, v110
  v_cvt_pk_bf16_f32 v111, 0, v111
  v_pk_mul_f32 v[108:109], v[108:109], v[116:117] op_sel:[0,1]
  v_pk_mul_f32 v[110:111], v[110:111], v[116:117] op_sel:[0,1]
  v_cvt_pk_bf16_f32 v236, v200, v108
  v_cvt_pk_bf16_f32 v240, v201, v109
  v_cvt_pk_bf16_f32 v244, v202, v110
  v_cvt_pk_bf16_f32 v248, v203, v111
  s_waitcnt vmcnt(14)
  s_cbranch_vccnz L_vw0_30
  s_waitcnt vmcnt(9)
L_vw0_30:
  buffer_load_dwordx4 v[8:11], v93, s[12:15], s61 offen offset:2304 nt
  v_cvt_f32_i32 v192, v36
  v_cvt_f32_i32 v193, v37
  v_mov_b32_dpp v116, v114 row_newbcast:10 row_mask:0xf bank_mask:0xf
  v_mov_b32_dpp v117, v115 row_newbcast:10 row_mask:0xf bank_mask:0xf
  v_cvt_f32_i32 v194, v38
  v_cvt_f32_i32 v195, v39
  v_pk_add_f32 v[192:193], v[192:193], v[116:117] op_sel_hi:[1,0] neg_lo:[0,1] neg_hi:[0,1]
  v_pk_add_f32 v[194:195], v[194:195], v[116:117] op_sel_hi:[1,0] neg_lo:[0,1] neg_hi:[0,1]
  v_cvt_pk_bf16_f32 v192, 0, v192
  v_cvt_pk_bf16_f32 v193, 0, v193
  v_cvt_pk_bf16_f32 v194, 0, v194
  v_cvt_pk_bf16_f32 v195, 0, v195
  v_pk_mul_f32 v[192:193], v[192:193], v[116:117] op_sel:[0,1]
  v_pk_mul_f32 v[194:195], v[194:195], v[116:117] op_sel:[0,1]
  v_cvt_pk_bf16_f32 v205, v192, 0
  v_cvt_pk_bf16_f32 v209, v193, 0
  v_cvt_pk_bf16_f32 v213, v194, 0
  v_cvt_pk_bf16_f32 v217, v195, 0
  v_mfma_f32_16x16x16_bf16 v[128:131], v[184:185], v[204:205], v[128:131]
  v_mfma_f32_16x16x16_bf16 v[128:131], v[186:187], v[208:209], v[128:131]
  v_mfma_f32_16x16x16_bf16 v[128:131], v[188:189], v[212:213], v[128:131]
  v_mfma_f32_16x16x16_bf16 v[128:131], v[190:191], v[216:217], v[128:131]
  s_waitcnt vmcnt(14)
  buffer_load_dwordx4 v[12:15], v93, s[12:15], s61 offen offset:2560 nt
  v_cvt_f32_i32 v196, v40
  v_cvt_f32_i32 v197, v41
  v_cvt_f32_i32 v198, v42
  v_cvt_f32_i32 v199, v43
  v_pk_add_f32 v[196:197], v[196:197], v[116:117] op_sel_hi:[1,0] neg_lo:[0,1] neg_hi:[0,1]
  v_pk_add_f32 v[198:199], v[198:199], v[116:117] op_sel_hi:[1,0] neg_lo:[0,1] neg_hi:[0,1]
  v_cvt_pk_bf16_f32 v196, 0, v196
  v_cvt_pk_bf16_f32 v197, 0, v197
  v_cvt_pk_bf16_f32 v198, 0, v198
  v_cvt_pk_bf16_f32 v199, 0, v199
  v_pk_mul_f32 v[196:197], v[196:197], v[116:117] op_sel:[0,1]
  v_pk_mul_f32 v[198:199], v[198:199], v[116:117] op_sel:[0,1]
  v_cvt_pk_bf16_f32 v221, v196, 0
  v_cvt_pk_bf16_f32 v225, v197, 0
  v_cvt_pk_bf16_f32 v229, v198, 0
  v_cvt_pk_bf16_f32 v233, v199, 0
  v_mfma_f32_16x16x16_bf16 v[132:135], v[184:185], v[220:221], v[132:135]
  v_mfma_f32_16x16x16_bf16 v[132:135], v[186:187], v[224:225], v[132:135]
  v_mfma_f32_16x16x16_bf16 v[132:135], v[188:189], v[228:229], v[132:135]
  v_mfma_f32_16x16x16_bf16 v[132:135], v[190:191], v[232:233], v[132:135]
  s_waitcnt vmcnt(14)
  buffer_load_dwordx4 v[16:19], v93, s[12:15], s61 offen offset:2816 nt
  v_cvt_f32_i32 v200, v44
  v_cvt_f32_i32 v201, v45
  v_cvt_f32_i32 v202, v46
  v_cvt_f32_i32 v203, v47
  v_pk_add_f32 v[200:201], v[200:201], v[116:117] op_sel_hi:[1,0] neg_lo:[0,1] neg_hi:[0,1]
  v_pk_add_f32 v[202:203], v[202:203], v[116:117] op_sel_hi:[1,0] neg_lo:[0,1] neg_hi:[0,1]
  v_cvt_pk_bf16_f32 v200, 0, v200
  v_cvt_pk_bf16_f32 v201, 0, v201
  v_cvt_pk_bf16_f32 v202, 0, v202
  v_cvt_pk_bf16_f32 v203, 0, v203
  v_pk_mul_f32 v[200:201], v[200:201], v[116:117] op_sel:[0,1]
  v_pk_mul_f32 v[202:203], v[202:203], v[116:117] op_sel:[0,1]
  v_cvt_pk_bf16_f32 v237, v200, 0
  v_cvt_pk_bf16_f32 v241, v201, 0
  v_cvt_pk_bf16_f32 v245, v202, 0
  v_cvt_pk_bf16_f32 v249, v203, 0
  v_mfma_f32_16x16x16_bf16 v[136:139], v[184:185], v[236:237], v[136:139]
  v_mfma_f32_16x16x16_bf16 v[136:139], v[186:187], v[240:241], v[136:139]
  v_mfma_f32_16x16x16_bf16 v[136:139], v[188:189], v[244:245], v[136:139]
  v_mfma_f32_16x16x16_bf16 v[136:139], v[190:191], v[248:249], v[136:139]
  s_mov_b32 s60, s61
L_v1:
  s_add_u32 s97, s64, 96
  v_mov_b32 v146, s97
  s_mov_b32 s86, s84
  ds_write_b32 v104, v146
  s_add_u32 s64, s64, 2
  s_cmp_lt_u32 s64, s99
  s_cbranch_scc1 L_v11_ok
L_v11_spin:
  v_mov_b32 v144, 61700
  ds_read_b32 v144, v144
  s_waitcnt lgkmcnt(0)
  v_readfirstlane_b32 s99, v144
  s_nop 1
  s_cmp_lt_u32 s64, s99
  s_cbranch_scc0 L_v11_spin
L_v11_ok:
  s_lshr_b32 s71, s64, 5
  s_lshr_b32 s85, s96, s71
  s_bfe_u32 s85, s85, 0x10003
  s_and_b32 s70, s64, 31
  s_lshl_b32 s71, s71, 12
  s_add_u32 s70, s70, s5
  s_add_u32 s70, s70, s71
  s_mul_hi_u32 s84, s70, s90
  s_lshr_b32 s84, s84, 1
  s_mul_i32 s71, s84, 3
  s_sub_u32 s70, s70, s71
  s_lshl3_add_u32 s85, s70, s85
  s_mul_i32 s61, s84, 196608
  s_lshr_b32 s89, s84, 4
  s_lshl_b32 s70, s85, 5
  v_add_u32 v97, s70, v1
  v_mul_u32_u24 v97, 21846, v97
  v_lshrrev_b32 v97, 16, v97
  v_add_u32 v144, s85, v2
  v_lshrrev_b32 v145, v144, s91
  v_and_b32 v145, 1, v145
  v_cmp_eq_u32 s[54:55], 1, v145
  s_nop 1
  s_and_b64 s[52:53], s[54:55], s[58:59]
  s_andn2_b64 s[54:55], s[54:55], s[58:59]
  s_cmp_lt_u32 s64, 96
  s_cselect_b32 s61, s61, 805306368
  s_lshr_b32 s70, s64, 1
  s_cmp_eq_u32 s70, 32
  s_cselect_b32 s48, -36096, s63
  ds_read_b32 v106, v104 offset:8
  s_waitcnt vmcnt(14)
  s_cbranch_vccnz L_vw1_0
  s_waitcnt vmcnt(9)
L_vw1_0:
  buffer_load_dwordx4 v[20:23], v93, s[12:15], s60 offen offset:3072 nt
  v_mov_b32 v114, v112
  v_mov_b32 v115, v113
  v_cvt_f32_i32 v192, v48
  v_cvt_f32_i32 v193, v49
  v_mov_b32_dpp v116, v114 row_newbcast:0 row_mask:0xf bank_mask:0xf
  v_mov_b32_dpp v117, v115 row_newbcast:0 row_mask:0xf bank_mask:0xf
  v_cvt_f32_i32 v194, v50
  v_cvt_f32_i32 v195, v51
  v_pk_add_f32 v[192:193], v[192:193], v[116:117] op_sel_hi:[1,0] neg_lo:[0,1] neg_hi:[0,1]
  v_pk_add_f32 v[194:195], v[194:195], v[116:117] op_sel_hi:[1,0] neg_lo:[0,1] neg_hi:[0,1]
  v_cvt_pk_bf16_f32 v192, 0, v192
  v_cvt_pk_bf16_f32 v193, 0, v193
  v_cvt_pk_bf16_f32 v194, 0, v194
  v_cvt_pk_bf16_f32 v195, 0, v195
  v_pk_mul_f32 v[192:193], v[192:193], v[116:117] op_sel:[0,1]
  v_pk_mul_f32 v[194:195], v[194:195], v[116:117] op_sel:[0,1]
  s_waitcnt lgkmcnt(0)
  v_cmp_lt_u32 vcc, s97, v106
  s_waitcnt vmcnt(14)
  buffer_load_dwordx4 v[24:27], v93, s[12:15], s60 offen offset:3328 nt
  v_cvt_f32_i32 v196, v52
  v_cvt_f32_i32 v197, v53
  v_cvt_f32_i32 v198, v54
  v_cvt_f32_i32 v199, v55
  v_pk_add_f32 v[196:197], v[196:197], v[116:117] op_sel_hi:[1,0] neg_lo:[0,1] neg_hi:[0,1]
  v_pk_add_f32 v[198:199], v[198:199], v[116:117] op_sel_hi:[1,0] neg_lo:[0,1] neg_hi:[0,1]
  v_cvt_pk_bf16_f32 v196, 0, v196
  v_lshlrev_b32 v148, 16, v120
  v_cvt_pk_bf16_f32 v197, 0, v197
  v_and_b32 v149, s65, v120
  v_cvt_pk_bf16_f32 v198, 0, v198
  v_lshlrev_b32 v150, 16, v121
  v_cvt_pk_bf16_f32 v199, 0, v199
  v_and_b32 v151, s65, v121
  v_pk_mul_f32 v[196:197], v[196:197], v[116:117] op_sel:[0,1]
  v_lshlrev_b32 v152, 16, v122
  v_pk_mul_f32 v[198:199], v[198:199], v[116:117] op_sel:[0,1]
  s_waitcnt vmcnt(14)
  buffer_load_dwordx4 v[28:31], v93, s[12:15], s60 offen offset:3584 nt
  v_cvt_f32_i32 v200, v56
  v_cvt_f32_i32 v201, v57
  v_cvt_f32_i32 v202, v58
  v_cvt_f32_i32 v203, v59
  v_pk_add_f32 v[200:201], v[200:201], v[116:117] op_sel_hi:[1,0] neg_lo:[0,1] neg_hi:[0,1]
  v_pk_add_f32 v[202:203], v[202:203], v[116:117] op_sel_hi:[1,0] neg_lo:[0,1] neg_hi:[0,1]
  v_cvt_pk_bf16_f32 v200, 0, v200
  v_and_b32 v153, s65, v122
  v_cvt_pk_bf16_f32 v201, 0, v201
  v_lshlrev_b32 v154, 16, v123
  v_cvt_pk_bf16_f32 v202, 0, v202
  v_and_b32 v155, s65, v123
  v_cvt_pk_bf16_f32 v203, 0, v203
  v_lshlrev_b32 v156, 16, v124
  v_pk_mul_f32 v[200:201], v[200:201], v[116:117] op_sel:[0,1]
  v_and_b32 v157, s65, v124
  v_pk_mul_f32 v[202:203], v[202:203], v[116:117] op_sel:[0,1]
  s_waitcnt vmcnt(14)
  s_cbranch_vccnz L_vw1_3
  s_waitcnt vmcnt(9)
L_vw1_3:
  buffer_load_dwordx4 v[32:35], v94, s[12:15], s60 offen offset:0 nt
  v_cvt_f32_i32 v108, v60
  v_cvt_f32_i32 v109, v61
  v_mov_b32_dpp v116, v114 row_newbcast:1 row_mask:0xf bank_mask:0xf
  v_mov_b32_dpp v117, v115 row_newbcast:1 row_mask:0xf bank_mask:0xf
  v_cvt_f32_i32 v110, v62
  v_cvt_f32_i32 v111, v63
  v_pk_add_f32 v[108:109], v[108:109], v[116:117] op_sel_hi:[1,0] neg_lo:[0,1] neg_hi:[0,1]
  v_pk_add_f32 v[110:111], v[110:111], v[116:117] op_sel_hi:[1,0] neg_lo:[0,1] neg_hi:[0,1]
  s_lshl_b32 s62, s84, 9
  v_lshl_add_u32 v98, v97, 1, v96
  buffer_load_short_d16_hi v112, v98, s[32:35], s62 offen
  buffer_load_short_d16_hi v113, v98, s[28:31], s62 offen
  v_cvt_pk_bf16_f32 v108, 0, v108
  v_lshlrev_b32 v158, 16, v125
  v_cvt_pk_bf16_f32 v109, 0, v109
  v_add_u32 v99, s48, v99
  v_cvt_pk_bf16_f32 v110, 0, v110
  v_add_u32 v100, s48, v100
  v_cvt_pk_bf16_f32 v111, 0, v111
  v_max3_f32 v144, v148, v149, v150
  v_pk_mul_f32 v[108:109], v[108:109], v[116:117] op_sel:[0,1]
  ds_read_b128 v[120:123], v99
  v_pk_mul_f32 v[110:111], v[110:111], v[116:117] op_sel:[0,1]
  v_cvt_pk_bf16_f32 v204, v192, v108
  v_cvt_pk_bf16_f32 v208, v193, v109
  v_cvt_pk_bf16_f32 v212, v194, v110
  v_cvt_pk_bf16_f32 v216, v195, v111
  s_waitcnt vmcnt(16)
  buffer_load_dwordx4 v[36:39], v94, s[12:15], s60 offen offset:256 nt
  v_cvt_f32_i32 v108, v64
  v_cvt_f32_i32 v109, v65
  v_cvt_f32_i32 v110, v66
  v_cvt_f32_i32 v111, v67
  v_pk_add_f32 v[108:109], v[108:109], v[116:117] op_sel_hi:[1,0] neg_lo:[0,1] neg_hi:[0,1]
  v_pk_add_f32 v[110:111], v[110:111], v[116:117] op_sel_hi:[1,0] neg_lo:[0,1] neg_hi:[0,1]
  v_cvt_pk_bf16_f32 v108, 0, v108
  ds_read_b64 v[124:125], v100 offset:256
  v_cvt_pk_bf16_f32 v109, 0, v109
  v_max3_f32 v145, v151, v152, v153
  v_cvt_pk_bf16_f32 v110, 0, v110
  v_max3_f32 v144, v144, v154, v155
  v_cvt_pk_bf16_f32 v111, 0, v111
  v_max3_f32 v145, v145, v156, v157
  v_pk_mul_f32 v[108:109], v[108:109], v[116:117] op_sel:[0,1]
  v_max3_f32 v144, v144, v158, v140
  v_pk_mul_f32 v[110:111], v[110:111], v[116:117] op_sel:[0,1]
  v_cvt_pk_bf16_f32 v220, v196, v108
  v_cvt_pk_bf16_f32 v224, v197, v109
  v_cvt_pk_bf16_f32 v228, v198, v110
  v_cvt_pk_bf16_f32 v232, v199, v111
  s_waitcnt vmcnt(16)
  buffer_load_dwordx4 v[40:43], v94, s[12:15], s60 offen offset:512 nt
  v_cvt_f32_i32 v108, v68
  v_cvt_f32_i32 v109, v69
  v_cvt_f32_i32 v110, v70
  v_cvt_f32_i32 v111, v71
  v_pk_add_f32 v[108:109], v[108:109], v[116:117] op_sel_hi:[1,0] neg_lo:[0,1] neg_hi:[0,1]
  v_pk_add_f32 v[110:111], v[110:111], v[116:117] op_sel_hi:[1,0] neg_lo:[0,1] neg_hi:[0,1]
  v_cvt_pk_bf16_f32 v108, 0, v108
  v_max_f32 v144, v144, v145
  v_cvt_pk_bf16_f32 v109, 0, v109
  v_mov_b32 v145, v144
  v_cvt_pk_bf16_f32 v110, 0, v110
  s_nop 0
  v_permlane32_swap_b32 v144, v145
  v_cvt_pk_bf16_f32 v111, 0, v111
  v_max_f32 v144, v144, v145
  v_pk_mul_f32 v[108:109], v[108:109], v[116:117] op_sel:[0,1]
  v_mov_b32 v145, v144
  v_pk_mul_f32 v[110:111], v[110:111], v[116:117] op_sel:[0,1]
  v_cvt_pk_bf16_f32 v236, v200, v108
  v_cvt_pk_bf16_f32 v240, v201, v109
  v_cvt_pk_bf16_f32 v244, v202, v110
  v_cvt_pk_bf16_f32 v248, v203, v111
  s_waitcnt vmcnt(16)
  s_cbranch_vccnz L_vw1_6
  s_waitcnt vmcnt(11)
L_vw1_6:
  buffer_load_dwordx4 v[44:47], v94, s[12:15], s60 offen offset:768 nt
  v_cvt_f32_i32 v192, v72
  v_cvt_f32_i32 v193, v73
  v_mov_b32_dpp v116, v114 row_newbcast:2 row_mask:0xf bank_mask:0xf
  v_mov_b32_dpp v117, v115 row_newbcast:2 row_mask:0xf bank_mask:0xf
  v_cvt_f32_i32 v194, v74
  v_cvt_f32_i32 v195, v75
  v_pk_add_f32 v[192:193], v[192:193], v[116:117] op_sel_hi:[1,0] neg_lo:[0,1] neg_hi:[0,1]
  v_pk_add_f32 v[194:195], v[194:195], v[116:117] op_sel_hi:[1,0] neg_lo:[0,1] neg_hi:[0,1]
  v_cvt_pk_bf16_f32 v192, 0, v192
  v_permlane16_swap_b32 v144, v145
  v_cvt_pk_bf16_f32 v193, 0, v193
  v_max_f32 v140, v144, v145
  v_cvt_pk_bf16_f32 v194, 0, v194
  v_mul_f32 v144, s66, v140
  v_cvt_pk_bf16_f32 v195, 0, v195
  v_add_f32 v146, v144, v142
  v_pk_mul_f32 v[192:193], v[192:193], v[116:117] op_sel:[0,1]
  v_sub_f32 v142, 0, v144
  v_pk_mul_f32 v[194:195], v[194:195], v[116:117] op_sel:[0,1]
  s_waitcnt vmcnt(16)
  buffer_load_dwordx4 v[48:51], v94, s[12:15], s60 offen offset:1024 nt
  v_cvt_f32_i32 v196, v76
  v_cvt_f32_i32 v197, v77
  v_cvt_f32_i32 v198, v78
  v_cvt_f32_i32 v199, v79
  v_pk_add_f32 v[196:197], v[196:197], v[116:117] op_sel_hi:[1,0] neg_lo:[0,1] neg_hi:[0,1]
  v_pk_add_f32 v[198:199], v[198:199], v[116:117] op_sel_hi:[1,0] neg_lo:[0,1] neg_hi:[0,1]
  v_cvt_pk_bf16_f32 v196, 0, v196
  v_exp_f32 v146, -v146
  v_cvt_pk_bf16_f32 v197, 0, v197
  ds_bpermute_b32 v147, v101, v146
  v_cvt_pk_bf16_f32 v198, 0, v198
  v_fma_f32 v148, v148, s66, v142
  v_cvt_pk_bf16_f32 v199, 0, v199
  v_exp_f32 v148, v148
  v_pk_mul_f32 v[196:197], v[196:197], v[116:117] op_sel:[0,1]
  v_fma_f32 v149, v149, s66, v142
  v_pk_mul_f32 v[198:199], v[198:199], v[116:117] op_sel:[0,1]
  s_waitcnt vmcnt(16)
  buffer_load_dwordx4 v[52:55], v94, s[12:15], s60 offen offset:1280 nt
  v_cvt_f32_i32 v200, v80
  v_cvt_f32_i32 v201, v81
  v_cvt_f32_i32 v202, v82
  v_cvt_f32_i32 v203, v83
  v_pk_add_f32 v[200:201], v[200:201], v[116:117] op_sel_hi:[1,0] neg_lo:[0,1] neg_hi:[0,1]
  v_pk_add_f32 v[202:203], v[202:203], v[116:117] op_sel_hi:[1,0] neg_lo:[0,1] neg_hi:[0,1]
  v_cvt_pk_bf16_f32 v200, 0, v200
  v_exp_f32 v149, v149
  v_cvt_pk_bf16_f32 v201, 0, v201
  v_fma_f32 v150, v150, s66, v142
  v_cvt_pk_bf16_f32 v202, 0, v202
  v_exp_f32 v150, v150
  v_cvt_pk_bf16_f32 v203, 0, v203
  v_fma_f32 v151, v151, s66, v142
  v_pk_mul_f32 v[200:201], v[200:201], v[116:117] op_sel:[0,1]
  v_exp_f32 v151, v151
  v_pk_mul_f32 v[202:203], v[202:203], v[116:117] op_sel:[0,1]
  s_waitcnt vmcnt(16)
  s_cbranch_vccnz L_vw1_9
  s_waitcnt vmcnt(11)
L_vw1_9:
  buffer_load_dwordx4 v[56:59], v94, s[12:15], s60 offen offset:1536 nt
  v_cvt_f32_i32 v108, v84
  v_cvt_f32_i32 v109, v85
  v_mov_b32_dpp v116, v114 row_newbcast:3 row_mask:0xf bank_mask:0xf
  v_mov_b32_dpp v117, v115 row_newbcast:3 row_mask:0xf bank_mask:0xf
  v_cvt_f32_i32 v110, v86
  v_cvt_f32_i32 v111, v87
  v_pk_add_f32 v[108:109], v[108:109], v[116:117] op_sel_hi:[1,0] neg_lo:[0,1] neg_hi:[0,1]
  v_pk_add_f32 v[110:111], v[110:111], v[116:117] op_sel_hi:[1,0] neg_lo:[0,1] neg_hi:[0,1]
  v_cvt_pk_bf16_f32 v108, 0, v108
  v_fma_f32 v152, v152, s66, v142
  v_cvt_pk_bf16_f32 v109, 0, v109
  v_exp_f32 v152, v152
  v_cvt_pk_bf16_f32 v110, 0, v110
  v_fma_f32 v153, v153, s66, v142
  v_cvt_pk_bf16_f32 v111, 0, v111
  v_exp_f32 v153, v153
  v_pk_mul_f32 v[108:109], v[108:109], v[116:117] op_sel:[0,1]
  v_fma_f32 v154, v154, s66, v142
  v_pk_mul_f32 v[110:111], v[110:111], v[116:117] op_sel:[0,1]
  v_cvt_pk_bf16_f32 v205, v192, v108
  v_cvt_pk_bf16_f32 v209, v193, v109
  v_cvt_pk_bf16_f32 v213, v194, v110
  v_cvt_pk_bf16_f32 v217, v195, v111
  s_waitcnt vmcnt(16)
  buffer_load_dwordx4 v[60:63], v94, s[12:15], s60 offen offset:1792 nt
  v_cvt_f32_i32 v108, v88
  v_cvt_f32_i32 v109, v89
  v_cvt_f32_i32 v110, v90
  v_cvt_f32_i32 v111, v91
  v_pk_add_f32 v[108:109], v[108:109], v[116:117] op_sel_hi:[1,0] neg_lo:[0,1] neg_hi:[0,1]
  v_pk_add_f32 v[110:111], v[110:111], v[116:117] op_sel_hi:[1,0] neg_lo:[0,1] neg_hi:[0,1]
  v_cvt_pk_bf16_f32 v108, 0, v108
  v_exp_f32 v154, v154
  v_cvt_pk_bf16_f32 v109, 0, v109
  v_fma_f32 v155, v155, s66, v142
  v_cvt_pk_bf16_f32 v110, 0, v110
  v_exp_f32 v155, v155
  v_cvt_pk_bf16_f32 v111, 0, v111
  v_fma_f32 v156, v156, s66, v142
  v_pk_mul_f32 v[108:109], v[108:109], v[116:117] op_sel:[0,1]
  v_exp_f32 v156, v156
  v_pk_mul_f32 v[110:111], v[110:111], v[116:117] op_sel:[0,1]
  v_cvt_pk_bf16_f32 v221, v196, v108
  v_cvt_pk_bf16_f32 v225, v197, v109
  v_cvt_pk_bf16_f32 v229, v198, v110
  v_cvt_pk_bf16_f32 v233, v199, v111
  s_waitcnt vmcnt(16)
  buffer_load_dwordx4 v[64:67], v94, s[12:15], s60 offen offset:2048 nt
  v_cvt_f32_i32 v108, v4
  v_cvt_f32_i32 v109, v5
  v_cvt_f32_i32 v110, v6
  v_cvt_f32_i32 v111, v7
  v_pk_add_f32 v[108:109], v[108:109], v[116:117] op_sel_hi:[1,0] neg_lo:[0,1] neg_hi:[0,1]
  v_pk_add_f32 v[110:111], v[110:111], v[116:117] op_sel_hi:[1,0] neg_lo:[0,1] neg_hi:[0,1]
  v_cvt_pk_bf16_f32 v108, 0, v108
  v_fma_f32 v157, v157, s66, v142
  v_cvt_pk_bf16_f32 v109, 0, v109
  v_exp_f32 v157, v157
  v_cvt_pk_bf16_f32 v110, 0, v110
  v_fma_f32 v158, v158, s66, v142
  v_cvt_pk_bf16_f32 v111, 0, v111
  v_exp_f32 v158, v158
  v_pk_mul_f32 v[108:109], v[108:109], v[116:117] op_sel:[0,1]
  v_add_f32 v144, v148, v149
  v_pk_mul_f32 v[110:111], v[110:111], v[116:117] op_sel:[0,1]
  v_cvt_pk_bf16_f32 v237, v200, v108
  v_cvt_pk_bf16_f32 v241, v201, v109
  v_cvt_pk_bf16_f32 v245, v202, v110
  v_cvt_pk_bf16_f32 v249, v203, v111
  s_waitcnt vmcnt(16)
  s_cbranch_vccnz L_vw1_12
  s_waitcnt vmcnt(11)
L_vw1_12:
  buffer_load_dwordx4 v[68:71], v94, s[12:15], s60 offen offset:2304 nt
  v_cvt_f32_i32 v192, v8
  v_cvt_f32_i32 v193, v9
  v_mov_b32_dpp v116, v114 row_newbcast:4 row_mask:0xf bank_mask:0xf
  v_mov_b32_dpp v117, v115 row_newbcast:4 row_mask:0xf bank_mask:0xf
  v_cvt_f32_i32 v194, v10
  v_cvt_f32_i32 v195, v11
  v_pk_add_f32 v[192:193], v[192:193], v[116:117] op_sel_hi:[1,0] neg_lo:[0,1] neg_hi:[0,1]
  v_pk_add_f32 v[194:195], v[194:195], v[116:117] op_sel_hi:[1,0] neg_lo:[0,1] neg_hi:[0,1]
  v_cvt_pk_bf16_f32 v192, 0, v192
  v_add_f32 v145, v150, v151
  v_cvt_pk_bf16_f32 v193, 0, v193
  v_add_f32 v144, v144, v152
  v_cvt_pk_bf16_f32 v194, 0, v194
  v_add_f32 v145, v145, v153
  v_cvt_pk_bf16_f32 v195, 0, v195
  v_add_f32 v144, v144, v154
  v_pk_mul_f32 v[192:193], v[192:193], v[116:117] op_sel:[0,1]
  v_add_f32 v145, v145, v155
  v_pk_mul_f32 v[194:195], v[194:195], v[116:117] op_sel:[0,1]
  s_waitcnt vmcnt(16)
  buffer_load_dwordx4 v[72:75], v94, s[12:15], s60 offen offset:2560 nt
  v_cvt_f32_i32 v196, v12
  v_cvt_f32_i32 v197, v13
  v_cvt_f32_i32 v198, v14
  v_cvt_f32_i32 v199, v15
  v_pk_add_f32 v[196:197], v[196:197], v[116:117] op_sel_hi:[1,0] neg_lo:[0,1] neg_hi:[0,1]
  v_pk_add_f32 v[198:199], v[198:199], v[116:117] op_sel_hi:[1,0] neg_lo:[0,1] neg_hi:[0,1]
  v_cvt_pk_bf16_f32 v196, 0, v196
  v_add_f32 v144, v144, v156
  v_cvt_pk_bf16_f32 v197, 0, v197
  v_add_f32 v145, v145, v157
  v_cvt_pk_bf16_f32 v198, 0, v198
  v_add_f32 v144, v144, v158
  v_cvt_pk_bf16_f32 v199, 0, v199
  v_add_f32 v144, v144, v145
  v_pk_mul_f32 v[196:197], v[196:197], v[116:117] op_sel:[0,1]
  v_fma_f32 v143, v143, v146, v144
  v_pk_mul_f32 v[198:199], v[198:199], v[116:117] op_sel:[0,1]
  s_waitcnt vmcnt(16)
  buffer_load_dwordx4 v[76:79], v94, s[12:15], s60 offen offset:2816 nt
  v_cvt_f32_i32 v200, v16
  v_cvt_f32_i32 v201, v17
  v_cvt_f32_i32 v202, v18
  v_cvt_f32_i32 v203, v19
  v_pk_add_f32 v[200:201], v[200:201], v[116:117] op_sel_hi:[1,0] neg_lo:[0,1] neg_hi:[0,1]
  v_pk_add_f32 v[202:203], v[202:203], v[116:117] op_sel_hi:[1,0] neg_lo:[0,1] neg_hi:[0,1]
  v_cvt_pk_bf16_f32 v200, 0, v200
  v_cvt_pk_bf16_f32 v159, v148, v149
  v_cvt_pk_bf16_f32 v201, 0, v201
  v_cvt_pk_bf16_f32 v160, v150, v151
  v_cvt_pk_bf16_f32 v202, 0, v202
  v_cvt_pk_bf16_f32 v161, v152, v153
  v_cvt_pk_bf16_f32 v203, 0, v203
  v_cvt_pk_bf16_f32 v162, v154, v155
  v_pk_mul_f32 v[200:201], v[200:201], v[116:117] op_sel:[0,1]
  v_cvt_pk_bf16_f32 v163, v156, v157
  v_pk_mul_f32 v[202:203], v[202:203], v[116:117] op_sel:[0,1]
  s_waitcnt vmcnt(16)
  s_cbranch_vccnz L_vw1_15
  s_waitcnt vmcnt(9)
L_vw1_15:
  buffer_load_dwordx4 v[80:83], v95, s[12:15], s60 offen offset:0 nt
  v_cvt_f32_i32 v108, v20
  v_cvt_f32_i32 v109, v21
  v_mov_b32_dpp v116, v114 row_newbcast:5 row_mask:0xf bank_mask:0xf
  v_mov_b32_dpp v117, v115 row_newbcast:5 row_mask:0xf bank_mask:0xf
  v_cvt_f32_i32 v110, v22
  v_cvt_f32_i32 v111, v23
  v_pk_add_f32 v[108:109], v[108:109], v[116:117] op_sel_hi:[1,0] neg_lo:[0,1] neg_hi:[0,1]
  v_pk_add_f32 v[110:111], v[110:111], v[116:117] op_sel_hi:[1,0] neg_lo:[0,1] neg_hi:[0,1]
  v_cvt_pk_bf16_f32 v108, 0, v108
  v_cvt_pk_bf16_f32 v164, v158, 0
  v_cvt_pk_bf16_f32 v109, 0, v109
  v_cndmask_b32 v168, 0, v159, s[72:73]
  v_cvt_pk_bf16_f32 v110, 0, v110
  v_cndmask_b32 v169, 0, v160, s[72:73]
  v_cvt_pk_bf16_f32 v111, 0, v111
  v_cndmask_b32 v170, 0, v161, s[72:73]
  v_pk_mul_f32 v[108:109], v[108:109], v[116:117] op_sel:[0,1]
  v_cndmask_b32 v171, 0, v162, s[72:73]
  v_pk_mul_f32 v[110:111], v[110:111], v[116:117] op_sel:[0,1]
  v_cvt_pk_bf16_f32 v206, v192, v108
  v_cvt_pk_bf16_f32 v210, v193, v109
  v_cvt_pk_bf16_f32 v214, v194, v110
  v_cvt_pk_bf16_f32 v218, v195, v111
  s_waitcnt vmcnt(16)
  buffer_load_dwordx4 v[84:87], v95, s[12:15], s60 offen offset:256 nt
  v_cvt_f32_i32 v108, v24
  v_cvt_f32_i32 v109, v25
  v_cvt_f32_i32 v110, v26
  v_cvt_f32_i32 v111, v27
  v_pk_add_f32 v[108:109], v[108:109], v[116:117] op_sel_hi:[1,0] neg_lo:[0,1] neg_hi:[0,1]
  v_pk_add_f32 v[110:111], v[110:111], v[116:117] op_sel_hi:[1,0] neg_lo:[0,1] neg_hi:[0,1]
  v_cvt_pk_bf16_f32 v108, 0, v108
  v_cndmask_b32 v172, 0, v159, s[74:75]
  v_cvt_pk_bf16_f32 v109, 0, v109
  v_cndmask_b32 v173, 0, v160, s[74:75]
  v_cvt_pk_bf16_f32 v110, 0, v110
  v_cndmask_b32 v174, 0, v161, s[74:75]
  v_cvt_pk_bf16_f32 v111, 0, v111
  v_cndmask_b32 v175, 0, v162, s[74:75]
  v_pk_mul_f32 v[108:109], v[108:109], v[116:117] op_sel:[0,1]
  v_cndmask_b32 v176, 0, v159, s[76:77]
  v_pk_mul_f32 v[110:111], v[110:111], v[116:117] op_sel:[0,1]
  v_cvt_pk_bf16_f32 v222, v196, v108
  v_cvt_pk_bf16_f32 v226, v197, v109
  v_cvt_pk_bf16_f32 v230, v198, v110
  v_cvt_pk_bf16_f32 v234, v199, v111
  s_waitcnt vmcnt(16)
  buffer_load_dwordx4 v[88:91], v95, s[12:15], s60 offen offset:512 nt
  v_cvt_f32_i32 v108, v28
  v_cvt_f32_i32 v109, v29
  v_cvt_f32_i32 v110, v30
  v_cvt_f32_i32 v111, v31
  v_pk_add_f32 v[108:109], v[108:109], v[116:117] op_sel_hi:[1,0] neg_lo:[0,1] neg_hi:[0,1]
  v_pk_add_f32 v[110:111], v[110:111], v[116:117] op_sel_hi:[1,0] neg_lo:[0,1] neg_hi:[0,1]
  v_cvt_pk_bf16_f32 v108, 0, v108
  v_cndmask_b32 v177, 0, v160, s[76:77]
  v_cvt_pk_bf16_f32 v109, 0, v109
  v_cndmask_b32 v178, 0, v161, s[76:77]
  v_cvt_pk_bf16_f32 v110, 0, v110
  v_cndmask_b32 v179, 0, v162, s[76:77]
  v_cvt_pk_bf16_f32 v111, 0, v111
  v_cndmask_b32 v180, 0, v159, s[78:79]
  v_pk_mul_f32 v[108:109], v[108:109], v[116:117] op_sel:[0,1]
  v_cndmask_b32 v181, 0, v160, s[78:79]
  v_pk_mul_f32 v[110:111], v[110:111], v[116:117] op_sel:[0,1]
  v_cvt_pk_bf16_f32 v238, v200, v108
  v_cvt_pk_bf16_f32 v242, v201, v109
  v_cvt_pk_bf16_f32 v246, v202, v110
  v_cvt_pk_bf16_f32 v250, v203, v111
  v_mad_u32_u24 v92, v97, s63, v3
  v_add_u32 v93, 768, v92
  v_add_u32 v94, 4608, v92
  v_add_u32 v95, 7680, v92
  v_cndmask_b32 v92, v92, v105, s[52:53]
  v_cndmask_b32 v95, v95, v105, s[54:55]
  s_waitcnt vmcnt(16)
  s_cbranch_vccnz L_vw1_18
  s_waitcnt vmcnt(9)
L_vw1_18:
  buffer_load_dwordx4 v[4:7], v92, s[12:15], s61 offen offset:0 nt
  v_cvt_f32_i32 v192, v32
  v_cvt_f32_i32 v193, v33
  v_mov_b32_dpp v116, v114 row_newbcast:6 row_mask:0xf bank_mask:0xf
  v_mov_b32_dpp v117, v115 row_newbcast:6 row_mask:0xf bank_mask:0xf
  v_cvt_f32_i32 v194, v34
  v_cvt_f32_i32 v195, v35
  v_pk_add_f32 v[192:193], v[192:193], v[116:117] op_sel_hi:[1,0] neg_lo:[0,1] neg_hi:[0,1]
  v_pk_add_f32 v[194:195], v[194:195], v[116:117] op_sel_hi:[1,0] neg_lo:[0,1] neg_hi:[0,1]
  v_cvt_pk_bf16_f32 v192, 0, v192
  v_cndmask_b32 v182, 0, v161, s[78:79]
  v_cvt_pk_bf16_f32 v193, 0, v193
  v_cndmask_b32 v183, 0, v162, s[78:79]
  v_cvt_pk_bf16_f32 v194, 0, v194
  s_waitcnt lgkmcnt(0)
  v_cvt_pk_bf16_f32 v195, 0, v195
  v_mul_f32 v128, v147, v128
  v_pk_mul_f32 v[192:193], v[192:193], v[116:117] op_sel:[0,1]
  v_mul_f32 v129, v147, v129
  v_pk_mul_f32 v[194:195], v[194:195], v[116:117] op_sel:[0,1]
  s_waitcnt vmcnt(14)
  buffer_load_dwordx4 v[8:11], v92, s[12:15], s61 offen offset:256 nt
  v_cvt_f32_i32 v196, v36
  v_cvt_f32_i32 v197, v37
  v_cvt_f32_i32 v198, v38
  v_cvt_f32_i32 v199, v39
  v_pk_add_f32 v[196:197], v[196:197], v[116:117] op_sel_hi:[1,0] neg_lo:[0,1] neg_hi:[0,1]
  v_pk_add_f32 v[198:199], v[198:199], v[116:117] op_sel_hi:[1,0] neg_lo:[0,1] neg_hi:[0,1]
  v_cvt_pk_bf16_f32 v196, 0, v196
  v_mul_f32 v130, v147, v130
  v_cvt_pk_bf16_f32 v197, 0, v197
  v_mul_f32 v131, v147, v131
  v_cvt_pk_bf16_f32 v198, 0, v198
  v_mul_f32 v132, v147, v132
  v_cvt_pk_bf16_f32 v199, 0, v199
  v_mul_f32 v133, v147, v133
  v_pk_mul_f32 v[196:197], v[196:197], v[116:117] op_sel:[0,1]
  v_mul_f32 v134, v147, v134
  v_pk_mul_f32 v[198:199], v[198:199], v[116:117] op_sel:[0,1]
  s_waitcnt vmcnt(14)
  buffer_load_dwordx4 v[12:15], v92, s[12:15], s61 offen offset:512 nt
  v_cvt_f32_i32 v200, v40
  v_cvt_f32_i32 v201, v41
  v_cvt_f32_i32 v202, v42
  v_cvt_f32_i32 v203, v43
  v_pk_add_f32 v[200:201], v[200:201], v[116:117] op_sel_hi:[1,0] neg_lo:[0,1] neg_hi:[0,1]
  v_pk_add_f32 v[202:203], v[202:203], v[116:117] op_sel_hi:[1,0] neg_lo:[0,1] neg_hi:[0,1]
  v_cvt_pk_bf16_f32 v200, 0, v200
  v_mul_f32 v135, v147, v135
  v_cvt_pk_bf16_f32 v201, 0, v201
  v_mul_f32 v136, v147, v136
  v_cvt_pk_bf16_f32 v202, 0, v202
  v_mul_f32 v137, v147, v137
  v_cvt_pk_bf16_f32 v203, 0, v203
  v_mul_f32 v138, v147, v138
  v_pk_mul_f32 v[200:201], v[200:201], v[116:117] op_sel:[0,1]
  v_mul_f32 v139, v147, v139
  v_pk_mul_f32 v[202:203], v[202:203], v[116:117] op_sel:[0,1]
  s_waitcnt vmcnt(14)
  s_cbranch_vccnz L_vw1_21
  s_waitcnt vmcnt(9)
L_vw1_21:
  buffer_load_dwordx4 v[16:19], v93, s[12:15], s61 offen offset:0 nt
  v_cvt_f32_i32 v108, v44
  v_cvt_f32_i32 v109, v45
  v_mov_b32_dpp v116, v114 row_newbcast:7 row_mask:0xf bank_mask:0xf
  v_mov_b32_dpp v117, v115 row_newbcast:7 row_mask:0xf bank_mask:0xf
  v_cvt_f32_i32 v110, v46
  v_cvt_f32_i32 v111, v47
  v_pk_add_f32 v[108:109], v[108:109], v[116:117] op_sel_hi:[1,0] neg_lo:[0,1] neg_hi:[0,1]
  v_pk_add_f32 v[110:111], v[110:111], v[116:117] op_sel_hi:[1,0] neg_lo:[0,1] neg_hi:[0,1]
  v_cvt_pk_bf16_f32 v108, 0, v108
  v_cvt_pk_bf16_f32 v109, 0, v109
  v_cvt_pk_bf16_f32 v110, 0, v110
  v_cvt_pk_bf16_f32 v111, 0, v111
  v_pk_mul_f32 v[108:109], v[108:109], v[116:117] op_sel:[0,1]
  v_pk_mul_f32 v[110:111], v[110:111], v[116:117] op_sel:[0,1]
  v_cvt_pk_bf16_f32 v207, v192, v108
  v_cvt_pk_bf16_f32 v211, v193, v109
  v_cvt_pk_bf16_f32 v215, v194, v110
  v_cvt_pk_bf16_f32 v219, v195, v111
  v_mfma_f32_16x16x32_bf16 v[128:131], v[168:171], v[204:207], v[128:131]
  v_mfma_f32_16x16x32_bf16 v[128:131], v[172:175], v[208:211], v[128:131]
  v_mfma_f32_16x16x32_bf16 v[128:131], v[176:179], v[212:215], v[128:131]
  v_mfma_f32_16x16x32_bf16 v[128:131], v[180:183], v[216:219], v[128:131]
  s_waitcnt vmcnt(14)
  buffer_load_dwordx4 v[20:23], v93, s[12:15], s61 offen offset:256 nt
  v_cvt_f32_i32 v108, v48
  v_cvt_f32_i32 v109, v49
  v_cvt_f32_i32 v110, v50
  v_cvt_f32_i32 v111, v51
  v_pk_add_f32 v[108:109], v[108:109], v[116:117] op_sel_hi:[1,0] neg_lo:[0,1] neg_hi:[0,1]
  v_pk_add_f32 v[110:111], v[110:111], v[116:117] op_sel_hi:[1,0] neg_lo:[0,1] neg_hi:[0,1]
  v_cvt_pk_bf16_f32 v108, 0, v108
  v_cvt_pk_bf16_f32 v109, 0, v109
  v_cvt_pk_bf16_f32 v110, 0, v110
  v_cvt_pk_bf16_f32 v111, 0, v111
  v_pk_mul_f32 v[108:109], v[108:109], v[116:117] op_sel:[0,1]
  v_pk_mul_f32 v[110:111], v[110:111], v[116:117] op_sel:[0,1]
  v_cvt_pk_bf16_f32 v223, v196, v108
  v_cvt_pk_bf16_f32 v227, v197, v109
  v_cvt_pk_bf16_f32 v231, v198, v110
  v_cvt_pk_bf16_f32 v235, v199, v111
  v_mfma_f32_16x16x32_bf16 v[132:135], v[168:171], v[220:223], v[132:135]
  v_mfma_f32_16x16x32_bf16 v[132:135], v[172:175], v[224:227], v[132:135]
  v_mfma_f32_16x16x32_bf16 v[132:135], v[176:179], v[228:231], v[132:135]
  v_mfma_f32_16x16x32_bf16 v[132:135], v[180:183], v[232:235], v[132:135]
  s_waitcnt vmcnt(14)
  buffer_load_dwordx4 v[24:27], v93, s[12:15], s61 offen offset:512 nt
  v_cvt_f32_i32 v108, v52
  v_cvt_f32_i32 v109, v53
  v_cvt_f32_i32 v110, v54
  v_cvt_f32_i32 v111, v55
  v_pk_add_f32 v[108:109], v[108:109], v[116:117] op_sel_hi:[1,0] neg_lo:[0,1] neg_hi:[0,1]
  v_pk_add_f32 v[110:111], v[110:111], v[116:117] op_sel_hi:[1,0] neg_lo:[0,1] neg_hi:[0,1]
  v_cvt_pk_bf16_f32 v108, 0, v108
  v_cvt_pk_bf16_f32 v109, 0, v109
  v_cvt_pk_bf16_f32 v110, 0, v110
  v_cvt_pk_bf16_f32 v111, 0, v111
  v_pk_mul_f32 v[108:109], v[108:109], v[116:117] op_sel:[0,1]
  v_pk_mul_f32 v[110:111], v[110:111], v[116:117] op_sel:[0,1]
  v_cvt_pk_bf16_f32 v239, v200, v108
  v_cvt_pk_bf16_f32 v243, v201, v109
  v_cvt_pk_bf16_f32 v247, v202, v110
  v_cvt_pk_bf16_f32 v251, v203, v111
  v_mfma_f32_16x16x32_bf16 v[136:139], v[168:171], v[236:239], v[136:139]
  v_mfma_f32_16x16x32_bf16 v[136:139], v[172:175], v[240:243], v[136:139]
  v_mfma_f32_16x16x32_bf16 v[136:139], v[176:179], v[244:247], v[136:139]
  v_mfma_f32_16x16x32_bf16 v[136:139], v[180:183], v[248:251], v[136:139]
  s_waitcnt vmcnt(14)
  s_cbranch_vccnz L_vw1_24
  s_waitcnt vmcnt(9)
L_vw1_24:
  buffer_load_dwordx4 v[28:31], v93, s[12:15], s61 offen offset:768 nt
  v_cvt_f32_i32 v192, v56
  v_cvt_f32_i32 v193, v57
  v_mov_b32_dpp v116, v114 row_newbcast:8 row_mask:0xf bank_mask:0xf
  v_mov_b32_dpp v117, v115 row_newbcast:8 row_mask:0xf bank_mask:0xf
  v_cvt_f32_i32 v194, v58
  v_cvt_f32_i32 v195, v59
  v_pk_add_f32 v[192:193], v[192:193], v[116:117] op_sel_hi:[1,0] neg_lo:[0,1] neg_hi:[0,1]
  v_pk_add_f32 v[194:195], v[194:195], v[116:117] op_sel_hi:[1,0] neg_lo:[0,1] neg_hi:[0,1]
  v_cvt_pk_bf16_f32 v192, 0, v192
  v_cndmask_b32 v184, 0, v163, s[72:73]
  v_cvt_pk_bf16_f32 v193, 0, v193
  v_cndmask_b32 v185, 0, v164, s[72:73]
  v_cvt_pk_bf16_f32 v194, 0, v194
  v_cndmask_b32 v186, 0, v163, s[74:75]
  v_cvt_pk_bf16_f32 v195, 0, v195
  v_cndmask_b32 v187, 0, v164, s[74:75]
  v_pk_mul_f32 v[192:193], v[192:193], v[116:117] op_sel:[0,1]
  v_cndmask_b32 v188, 0, v163, s[76:77]
  v_pk_mul_f32 v[194:195], v[194:195], v[116:117] op_sel:[0,1]
  s_waitcnt vmcnt(14)
  buffer_load_dwordx4 v[32:35], v93, s[12:15], s61 offen offset:1024 nt
  v_cvt_f32_i32 v196, v60
  v_cvt_f32_i32 v197, v61
  v_cvt_f32_i32 v198, v62
  v_cvt_f32_i32 v199, v63
  v_pk_add_f32 v[196:197], v[196:197], v[116:117] op_sel_hi:[1,0] neg_lo:[0,1] neg_hi:[0,1]
  v_pk_add_f32 v[198:199], v[198:199], v[116:117] op_sel_hi:[1,0] neg_lo:[0,1] neg_hi:[0,1]
  v_cvt_pk_bf16_f32 v196, 0, v196
  v_cndmask_b32 v189, 0, v164, s[76:77]
  v_cvt_pk_bf16_f32 v197, 0, v197
  v_cndmask_b32 v190, 0, v163, s[78:79]
  v_cvt_pk_bf16_f32 v198, 0, v198
  v_cndmask_b32 v191, 0, v164, s[78:79]
  v_cvt_pk_bf16_f32 v199, 0, v199
  v_pk_mul_f32 v[196:197], v[196:197], v[116:117] op_sel:[0,1]
  v_pk_mul_f32 v[198:199], v[198:199], v[116:117] op_sel:[0,1]
  s_waitcnt vmcnt(14)
  buffer_load_dwordx4 v[36:39], v93, s[12:15], s61 offen offset:1280 nt
  v_cvt_f32_i32 v200, v64
  v_cvt_f32_i32 v201, v65
  v_cvt_f32_i32 v202, v66
  v_cvt_f32_i32 v203, v67
  v_pk_add_f32 v[200:201], v[200:201], v[116:117] op_sel_hi:[1,0] neg_lo:[0,1] neg_hi:[0,1]
  v_pk_add_f32 v[202:203], v[202:203], v[116:117] op_sel_hi:[1,0] neg_lo:[0,1] neg_hi:[0,1]
  v_cvt_pk_bf16_f32 v200, 0, v200
  v_cvt_pk_bf16_f32 v201, 0, v201
  v_cvt_pk_bf16_f32 v202, 0, v202
  v_cvt_pk_bf16_f32 v203, 0, v203
  v_pk_mul_f32 v[200:201], v[200:201], v[116:117] op_sel:[0,1]
  v_pk_mul_f32 v[202:203], v[202:203], v[116:117] op_sel:[0,1]
  s_waitcnt vmcnt(14)
  s_cbranch_vccnz L_vw1_27
  s_waitcnt vmcnt(9)
L_vw1_27:
  buffer_load_dwordx4 v[40:43], v93, s[12:15], s61 offen offset:1536 nt
  v_cvt_f32_i32 v108, v68
  v_cvt_f32_i32 v109, v69
  v_mov_b32_dpp v116, v114 row_newbcast:9 row_mask:0xf bank_mask:0xf
  v_mov_b32_dpp v117, v115 row_newbcast:9 row_mask:0xf bank_mask:0xf
  v_cvt_f32_i32 v110, v70
  v_cvt_f32_i32 v111, v71
  v_pk_add_f32 v[108:109], v[108:109], v[116:117] op_sel_hi:[1,0] neg_lo:[0,1] neg_hi:[0,1]
  v_pk_add_f32 v[110:111], v[110:111], v[116:117] op_sel_hi:[1,0] neg_lo:[0,1] neg_hi:[0,1]
  v_cvt_pk_bf16_f32 v108, 0, v108
  v_cvt_pk_bf16_f32 v109, 0, v109
  v_cvt_pk_bf16_f32 v110, 0, v110
  v_cvt_pk_bf16_f32 v111, 0, v111
  v_pk_mul_f32 v[108:109], v[108:109], v[116:117] op_sel:[0,1]
  v_pk_mul_f32 v[110:111], v[110:111], v[116:117] op_sel:[0,1]
  v_cvt_pk_bf16_f32 v204, v192, v108
  v_cvt_pk_bf16_f32 v208, v193, v109
  v_cvt_pk_bf16_f32 v212, v194, v110
  v_cvt_pk_bf16_f32 v216, v195, v111
  s_waitcnt vmcnt(14)
  buffer_load_dwordx4 v[44:47], v93, s[12:15], s61 offen offset:1792 nt
  v_cvt_f32_i32 v108, v72
  v_cvt_f32_i32 v109, v73
  v_cvt_f32_i32 v110, v74
  v_cvt_f32_i32 v111, v75
  v_pk_add_f32 v[108:109], v[108:109], v[116:117] op_sel_hi:[1,0] neg_lo:[0,1] neg_hi:[0,1]
  v_pk_add_f32 v[110:111], v[110:111], v[116:117] op_sel_hi:[1,0] neg_lo:[0,1] neg_hi:[0,1]
  v_cvt_pk_bf16_f32 v108, 0, v108
  v_cvt_pk_bf16_f32 v109, 0, v109
  v_cvt_pk_bf16_f32 v110, 0, v110
  v_cvt_pk_bf16_f32 v111, 0, v111
  v_pk_mul_f32 v[108:109], v[108:109], v[116:117] op_sel:[0,1]
  v_pk_mul_f32 v[110:111], v[110:111], v[116:117] op_sel:[0,1]
  v_cvt_pk_bf16_f32 v220, v196, v108
  v_cvt_pk_bf16_f32 v224, v197, v109
  v_cvt_pk_bf16_f32 v228, v198, v110
  v_cvt_pk_bf16_f32 v232, v199, v111
  s_waitcnt vmcnt(14)
  buffer_load_dwordx4 v[48:51], v93, s[12:15], s61 offen offset:2048 nt
  v_cvt_f32_i32 v108, v76
  v_cvt_f32_i32 v109, v77
  v_cvt_f32_i32 v110, v78
  v_cvt_f32_i32 v111, v79
  v_pk_add_f32 v[108:109], v[108:109], v[116:117] op_sel_hi:[1,0] neg_lo:[0,1] neg_hi:[0,1]
  v_pk_add_f32 v[110:111], v[110:111], v[116:117] op_sel_hi:[1,0] neg_lo:[0,1] neg_hi:[0,1]
  v_cvt_pk_bf16_f32 v108, 0, v108
  v_cvt_pk_bf16_f32 v109, 0, v109
  v_cvt_pk_bf16_f32 v110, 0, v110
  v_cvt_pk_bf16_f32 v111, 0, v111
  v_pk_mul_f32 v[108:109], v[108:109], v[116:117] op_sel:[0,1]
  v_pk_mul_f32 v[110:111], v[110:111], v[116:117] op_sel:[0,1]
  v_cvt_pk_bf16_f32 v236, v200, v108
  v_cvt_pk_bf16_f32 v240, v201, v109
  v_cvt_pk_bf16_f32 v244, v202, v110
  v_cvt_pk_bf16_f32 v248, v203, v111
  s_waitcnt vmcnt(14)
  s_cbranch_vccnz L_vw1_30
  s_waitcnt vmcnt(9)
L_vw1_30:
  buffer_load_dwordx4 v[52:55], v93, s[12:15], s61 offen offset:2304 nt
  v_cvt_f32_i32 v192, v80
  v_cvt_f32_i32 v193, v81
  v_mov_b32_dpp v116, v114 row_newbcast:10 row_mask:0xf bank_mask:0xf
  v_mov_b32_dpp v117, v115 row_newbcast:10 row_mask:0xf bank_mask:0xf
  v_cvt_f32_i32 v194, v82
  v_cvt_f32_i32 v195, v83
  v_pk_add_f32 v[192:193], v[192:193], v[116:117] op_sel_hi:[1,0] neg_lo:[0,1] neg_hi:[0,1]
  v_pk_add_f32 v[194:195], v[194:195], v[116:117] op_sel_hi:[1,0] neg_lo:[0,1] neg_hi:[0,1]
  v_cvt_pk_bf16_f32 v192, 0, v192
  v_cvt_pk_bf16_f32 v193, 0, v193
  v_cvt_pk_bf16_f32 v194, 0, v194
  v_cvt_pk_bf16_f32 v195, 0, v195
  v_pk_mul_f32 v[192:193], v[192:193], v[116:117] op_sel:[0,1]
  v_pk_mul_f32 v[194:195], v[194:195], v[116:117] op_sel:[0,1]
  v_cvt_pk_bf16_f32 v205, v192, 0
  v_cvt_pk_bf16_f32 v209, v193, 0
  v_cvt_pk_bf16_f32 v213, v194, 0
  v_cvt_pk_bf16_f32 v217, v195, 0
  v_mfma_f32_16x16x16_bf16 v[128:131], v[184:185], v[204:205], v[128:131]
  v_mfma_f32_16x16x16_bf16 v[128:131], v[186:187], v[208:209], v[128:131]
  v_mfma_f32_16x16x16_bf16 v[128:131], v[188:189], v[212:213], v[128:131]
  v_mfma_f32_16x16x16_bf16 v[128:131], v[190:191], v[216:217], v[128:131]
  s_waitcnt vmcnt(14)
  buffer_load_dwordx4 v[56:59], v93, s[12:15], s61 offen offset:2560 nt
  v_cvt_f32_i32 v196, v84
  v_cvt_f32_i32 v197, v85
  v_cvt_f32_i32 v198, v86
  v_cvt_f32_i32 v199, v87
  v_pk_add_f32 v[196:197], v[196:197], v[116:117] op_sel_hi:[1,0] neg_lo:[0,1] neg_hi:[0,1]
  v_pk_add_f32 v[198:199], v[198:199], v[116:117] op_sel_hi:[1,0] neg_lo:[0,1] neg_hi:[0,1]
  v_cvt_pk_bf16_f32 v196, 0, v196
  v_cvt_pk_bf16_f32 v197, 0, v197
  v_cvt_pk_bf16_f32 v198, 0, v198
  v_cvt_pk_bf16_f32 v199, 0, v199
  v_pk_mul_f32 v[196:197], v[196:197], v[116:117] op_sel:[0,1]
  v_pk_mul_f32 v[198:199], v[198:199], v[116:117] op_sel:[0,1]
  v_cvt_pk_bf16_f32 v221, v196, 0
  v_cvt_pk_bf16_f32 v225, v197, 0
  v_cvt_pk_bf16_f32 v229, v198, 0
  v_cvt_pk_bf16_f32 v233, v199, 0
  v_mfma_f32_16x16x16_bf16 v[132:135], v[184:185], v[220:221], v[132:135]
  v_mfma_f32_16x16x16_bf16 v[132:135], v[186:187], v[224:225], v[132:135]
  v_mfma_f32_16x16x16_bf16 v[132:135], v[188:189], v[228:229], v[132:135]
  v_mfma_f32_16x16x16_bf16 v[132:135], v[190:191], v[232:233], v[132:135]
  s_waitcnt vmcnt(14)
  buffer_load_dwordx4 v[60:63], v93, s[12:15], s61 offen offset:2816 nt
  v_cvt_f32_i32 v200, v88
  v_cvt_f32_i32 v201, v89
  v_cvt_f32_i32 v202, v90
  v_cvt_f32_i32 v203, v91
  v_pk_add_f32 v[200:201], v[200:201], v[116:117] op_sel_hi:[1,0] neg_lo:[0,1] neg_hi:[0,1]
  v_pk_add_f32 v[202:203], v[202:203], v[116:117] op_sel_hi:[1,0] neg_lo:[0,1] neg_hi:[0,1]
  v_cvt_pk_bf16_f32 v200, 0, v200
  v_cvt_pk_bf16_f32 v201, 0, v201
  v_cvt_pk_bf16_f32 v202, 0, v202
  v_cvt_pk_bf16_f32 v203, 0, v203
  v_pk_mul_f32 v[200:201], v[200:201], v[116:117] op_sel:[0,1]
  v_pk_mul_f32 v[202:203], v[202:203], v[116:117] op_sel:[0,1]
  v_cvt_pk_bf16_f32 v237, v200, 0
  v_cvt_pk_bf16_f32 v241, v201, 0
  v_cvt_pk_bf16_f32 v245, v202, 0
  v_cvt_pk_bf16_f32 v249, v203, 0
  v_mfma_f32_16x16x16_bf16 v[136:139], v[184:185], v[236:237], v[136:139]
  v_mfma_f32_16x16x16_bf16 v[136:139], v[186:187], v[240:241], v[136:139]
  v_mfma_f32_16x16x16_bf16 v[136:139], v[188:189], v[244:245], v[136:139]
  v_mfma_f32_16x16x16_bf16 v[136:139], v[190:191], v[248:249], v[136:139]
  s_mov_b32 s60, s61
  s_cmp_ge_u32 s64, 96
  s_cbranch_scc1 L_v_done
  s_cmp_eq_u32 s89, s88
  s_cbranch_scc1 L_v0
  s_mov_b32 s88, s89
  s_and_b32 s70, s86, 15
  s_cmp_ge_u32 s70, 12
  s_cselect_b32 s70, 6208, 0
  s_bitcmp1_b32 s86, 4
  s_cselect_b32 s71, 12416, 0
  s_add_u32 s70, s70, s71
  v_mov_b32 v145, v143
  v_add_u32 v144, s70, v102
  v_add_u32 v147, s70, v103
  v_permlane32_swap_b32 v143, v145
  v_add_f32 v143, v143, v145
  v_mov_b32 v145, v143
  ds_write_b128 v144, v[128:131] offset:0
  ds_write_b128 v144, v[132:135] offset:1024
  ds_write_b128 v144, v[136:139] offset:2048
  v_permlane16_swap_b32 v143, v145
  v_add_f32 v143, v143, v145
  ds_write_b64 v147, v[142:143]
  s_waitcnt lgkmcnt(0)
  v_mov_b32 v128, 0
  v_mov_b32 v129, 0
  v_mov_b32 v130, 0
  v_mov_b32 v131, 0
  v_mov_b32 v132, 0
  v_mov_b32 v133, 0
  v_mov_b32 v134, 0
  v_mov_b32 v135, 0
  v_mov_b32 v136, 0
  v_mov_b32 v137, 0
  v_mov_b32 v138, 0
  v_mov_b32 v139, 0
  v_mov_b32 v140, 0xff800000
  v_mov_b32 v142, 0x7f800000
  v_mov_b32 v143, 0
  s_branch L_v0
L_v_done:
  s_and_b32 s70, s86, 15
  s_cmp_ge_u32 s70, 12
  s_cselect_b32 s70, 6208, 0
  s_bitcmp1_b32 s86, 4
  s_cselect_b32 s71, 12416, 0
  s_add_u32 s70, s70, s71
  v_mov_b32 v145, v143
  v_add_u32 v144, s70, v102
  v_add_u32 v147, s70, v103
  v_permlane32_swap_b32 v143, v145
  v_add_f32 v143, v143, v145
  v_mov_b32 v145, v143
  ds_write_b128 v144, v[128:131] offset:0
  ds_write_b128 v144, v[132:135] offset:1024
  ds_write_b128 v144, v[136:139] offset:2048
  v_permlane16_swap_b32 v143, v145
  v_add_f32 v143, v143, v145
  ds_write_b64 v147, v[142:143]
L_finish:
  v_mov_b32 v144, 61728
  ds_read_b128 v[168:171], v144
  ds_read_b128 v[172:175], v144 offset:16
  s_mul_i32 s70, s4, 6208
  s_lshl_b32 s71, s3, 10
  v_lshl_add_u32 v152, v0, 4, s71
  v_lshrrev_b32 v145, 4, v0
  v_lshlrev_b32 v154, 3, v145
  v_add_u32 v154, 43008, v154
  s_sub_u32 s97, 6208, s70
  v_add_u32 v153, s97, v152
  v_add_u32 v140, s70, v152
  s_sub_u32 s97, 12416, s70
  v_add_u32 v112, s97, v154
  s_add_u32 s97, s70, 6208
  v_add_u32 v113, s97, v154
  v_add_u32 v155, 18624, v154
  s_mul_i32 s70, s3, 1152
  v_lshl_add_u32 v156, v0, 4, s70
  v_lshl_add_u32 v157, v145, 5, s70
  v_and_b32 v146, 1, v0
  v_lshl_add_u32 v157, v146, 4, v157
  v_mul_u32_u24 v146, 384, v145
  v_and_b32 v145, 15, v0
  v_lshl_add_u32 v146, v145, 3, v146
  s_movk_i32 s65, 0xff00
  s_mov_b32 s48, 0x30003
  s_mov_b32 s49, 0x30003
  s_mov_b32 s50, 0x0c0c0400
  s_mov_b32 s51, 0x05040100
  s_mov_b32 s64, 0
  s_waitcnt vmcnt(0) lgkmcnt(0)
  s_barrier
  ds_read2_b64 v[176:179], v154 offset1:4
  ds_read_b128 v[192:195], v152 offset:36864
  ds_read_b128 v[196:199], v152 offset:39936
  ds_read2_b64 v[180:183], v155 offset1:4
  ds_read_b128 v[200:203], v152 offset:55488
  ds_read_b128 v[204:207], v152 offset:58560
  ds_read2_b64 v[184:187], v112 offset1:4
  ds_read_b128 v[208:211], v153 offset:43072
  ds_read_b128 v[212:215], v153 offset:46144
  ds_read2_b64 v[188:191], v113 offset1:4
  ds_read_b128 v[216:219], v140 offset:43072
  ds_read_b128 v[220:223], v140 offset:46144
  v_readfirstlane_b32 s72, v168
  v_readfirstlane_b32 s73, v169
  v_readfirstlane_b32 s74, v170
  v_readfirstlane_b32 s75, v171
  v_readfirstlane_b32 s76, v172
  v_readfirstlane_b32 s77, v173
  v_readfirstlane_b32 s78, v174
  v_bfe_u32 v148, v175, 0, 8
  v_bfe_u32 v149, v175, 8, 8
  v_bfe_u32 v150, v175, 16, 8
  v_bfe_u32 v151, v175, 24, 8
  s_waitcnt lgkmcnt(9)
  v_min_f32 v144, v176, v178
  v_sub_f32 v176, v144, v176
  v_sub_f32 v178, v144, v178
  v_exp_f32 v176, v176
  v_exp_f32 v178, v178
  v_mul_f32 v145, v176, v177
  v_pk_mul_f32 v[192:193], v[192:193], v[176:177] op_sel_hi:[1,0]
  v_pk_mul_f32 v[194:195], v[194:195], v[176:177] op_sel_hi:[1,0]
  v_pk_fma_f32 v[192:193], v[196:197], v[178:179], v[192:193] op_sel_hi:[1,0,1]
  v_pk_fma_f32 v[194:195], v[198:199], v[178:179], v[194:195] op_sel_hi:[1,0,1]
  v_fma_f32 v197, v178, v179, v145
  v_mov_b32 v196, v144
  v_and_or_b32 v192, v192, s65, v148
  v_and_or_b32 v193, v193, s65, v149
  v_and_or_b32 v194, v194, s65, v150
  v_and_or_b32 v195, v195, s65, v151
  v_mov_b32 v199, v175
  buffer_store_dwordx4 v[192:195], v156, s[40:43], s72 offen sc1
  s_mov_b64 exec, s[48:49]
  buffer_store_dwordx4 v[196:199], v157, s[40:43], s72 offen offset:1024 sc1
  s_mov_b64 exec, -1
  s_waitcnt lgkmcnt(6)
  v_min_f32 v144, v180, v182
  v_sub_f32 v180, v144, v180
  v_sub_f32 v182, v144, v182
  v_exp_f32 v180, v180
  v_exp_f32 v182, v182
  v_mul_f32 v145, v180, v181
  v_pk_mul_f32 v[200:201], v[200:201], v[180:181] op_sel_hi:[1,0]
  v_pk_mul_f32 v[202:203], v[202:203], v[180:181] op_sel_hi:[1,0]
  v_pk_fma_f32 v[200:201], v[204:205], v[182:183], v[200:201] op_sel_hi:[1,0,1]
  v_pk_fma_f32 v[202:203], v[206:207], v[182:183], v[202:203] op_sel_hi:[1,0,1]
  v_fma_f32 v205, v182, v183, v145
  v_mov_b32 v204, v144
  v_and_or_b32 v200, v200, s65, v148
  v_and_or_b32 v201, v201, s65, v149
  v_and_or_b32 v202, v202, s65, v150
  v_and_or_b32 v203, v203, s65, v151
  v_mov_b32 v207, v175
  buffer_store_dwordx4 v[200:203], v156, s[40:43], s73 offen sc1
  s_mov_b64 exec, s[48:49]
  buffer_store_dwordx4 v[204:207], v157, s[40:43], s73 offen offset:1024 sc1
  s_mov_b64 exec, -1
  s_waitcnt lgkmcnt(3)
  v_min_f32 v144, v184, v186
  v_sub_f32 v184, v144, v184
  v_sub_f32 v186, v144, v186
  v_exp_f32 v184, v184
  v_exp_f32 v186, v186
  v_mul_f32 v145, v184, v185
  v_pk_mul_f32 v[208:209], v[208:209], v[184:185] op_sel_hi:[1,0]
  v_pk_mul_f32 v[210:211], v[210:211], v[184:185] op_sel_hi:[1,0]
  v_pk_fma_f32 v[208:209], v[212:213], v[186:187], v[208:209] op_sel_hi:[1,0,1]
  v_pk_fma_f32 v[210:211], v[214:215], v[186:187], v[210:211] op_sel_hi:[1,0,1]
  v_fma_f32 v213, v186, v187, v145
  v_mov_b32 v212, v144
  v_and_or_b32 v208, v208, s65, v148
  v_and_or_b32 v209, v209, s65, v149
  v_and_or_b32 v210, v210, s65, v150
  v_and_or_b32 v211, v211, s65, v151
  v_mov_b32 v215, v175
  buffer_store_dwordx4 v[208:211], v156, s[40:43], s74 offen sc1
  s_mov_b64 exec, s[48:49]
  buffer_store_dwordx4 v[212:215], v157, s[40:43], s74 offen offset:1024 sc1
  s_mov_b64 exec, -1
  buffer_load_dwordx4 v[224:227], v156, s[40:43], s75 offen sc1
  buffer_load_dwordx4 v[228:231], v157, s[40:43], s75 offen offset:1024 sc1
  buffer_load_dwordx4 v[232:235], v156, s[40:43], s76 offen sc1
  buffer_load_dwordx4 v[236:239], v157, s[40:43], s76 offen offset:1024 sc1
  buffer_load_dwordx4 v[240:243], v156, s[40:43], s77 offen sc1
  buffer_load_dwordx4 v[244:247], v157, s[40:43], s77 offen offset:1024 sc1
  s_waitcnt lgkmcnt(0)
  v_min_f32 v144, v188, v190
  v_sub_f32 v188, v144, v188
  v_sub_f32 v190, v144, v190
  v_exp_f32 v188, v188
  v_exp_f32 v190, v190
  v_mul_f32 v145, v188, v189
  v_pk_mul_f32 v[216:217], v[216:217], v[188:189] op_sel_hi:[1,0]
  v_pk_mul_f32 v[218:219], v[218:219], v[188:189] op_sel_hi:[1,0]
  v_pk_fma_f32 v[216:217], v[220:221], v[190:191], v[216:217] op_sel_hi:[1,0,1]
  v_pk_fma_f32 v[218:219], v[222:223], v[190:191], v[218:219] op_sel_hi:[1,0,1]
  v_fma_f32 v221, v190, v191, v145
  v_mov_b32 v220, v144
  s_branch L_check
L_gather:
  s_add_u32 s64, s64, 1
  s_cmp_gt_u32 s64, 200000
  s_cbranch_scc1 L_end
  s_bitcmp0_b32 s87, 0
  s_cbranch_scc1 L_have0
  buffer_load_dwordx4 v[224:227], v156, s[40:43], s75 offen sc1
  buffer_load_dwordx4 v[228:231], v157, s[40:43], s75 offen offset:1024 sc1
L_have0:
  s_bitcmp0_b32 s87, 1
  s_cbranch_scc1 L_have1
  buffer_load_dwordx4 v[232:235], v156, s[40:43], s76 offen sc1
  buffer_load_dwordx4 v[236:239], v157, s[40:43], s76 offen offset:1024 sc1
L_have1:
  s_bitcmp0_b32 s87, 2
  s_cbranch_scc1 L_have2
  buffer_load_dwordx4 v[240:243], v156, s[40:43], s77 offen sc1
  buffer_load_dwordx4 v[244:247], v157, s[40:43], s77 offen offset:1024 sc1
L_have2:
L_check:
  s_mov_b32 s87, 0
  s_waitcnt vmcnt(0)
  v_perm_b32 v144, v225, v224, s50
  v_perm_b32 v145, v227, v226, s50
  v_cmp_ne_u32 vcc, v175, v231
  v_perm_b32 v144, v145, v144, s51
  v_cmp_ne_u32 s[70:71], v175, v144
  s_nop 1
  s_or_b64 s[70:71], s[70:71], vcc
  s_cselect_b32 s70, 1, 0
  s_or_b32 s87, s87, s70
  v_perm_b32 v144, v233, v232, s50
  v_perm_b32 v145, v235, v234, s50
  v_cmp_ne_u32 vcc, v175, v239
  v_perm_b32 v144, v145, v144, s51
  v_cmp_ne_u32 s[70:71], v175, v144
  s_nop 1
  s_or_b64 s[70:71], s[70:71], vcc
  s_cselect_b32 s70, 2, 0
  s_or_b32 s87, s87, s70
  v_perm_b32 v144, v241, v240, s50
  v_perm_b32 v145, v243, v242, s50
  v_cmp_ne_u32 vcc, v175, v247
  v_perm_b32 v144, v145, v144, s51
  v_cmp_ne_u32 s[70:71], v175, v144
  s_nop 1
  s_or_b64 s[70:71], s[70:71], vcc
  s_cselect_b32 s70, 4, 0
  s_or_b32 s87, s87, s70
  s_cbranch_scc1 L_gather
  v_min_f32 v144, v220, v228
  v_min3_f32 v144, v144, v236, v244
  v_sub_f32 v220, v144, v220
  v_sub_f32 v228, v144, v228
  v_sub_f32 v236, v144, v236
  v_sub_f32 v244, v144, v244
  v_exp_f32 v220, v220
  v_exp_f32 v228, v228
  v_exp_f32 v236, v236
  v_exp_f32 v244, v244
  v_and_b32 v216, s65, v216
  v_and_b32 v217, s65, v217
  v_and_b32 v218, s65, v218
  v_and_b32 v219, s65, v219
  v_and_b32 v224, s65, v224
  v_and_b32 v225, s65, v225
  v_and_b32 v226, s65, v226
  v_and_b32 v227, s65, v227
  v_and_b32 v232, s65, v232
  v_and_b32 v233, s65, v233
  v_and_b32 v234, s65, v234
  v_and_b32 v235, s65, v235
  v_and_b32 v240, s65, v240
  v_and_b32 v241, s65, v241
  v_and_b32 v242, s65, v242
  v_and_b32 v243, s65, v243
  v_mul_f32 v221, v220, v221
  v_mul_f32 v229, v228, v229
  v_mul_f32 v237, v236, v237
  v_mul_f32 v245, v244, v245
  v_add_f32 v221, v221, v229
  v_add_f32 v237, v237, v245
  v_add_f32 v144, v221, v237
  v_rcp_f32 v144, v144
  s_lshl_b32 s70, s3, 7
  s_add_u32 s70, s70, s78
  v_pk_mul_f32 v[216:217], v[216:217], v[220:221] op_sel_hi:[1,0]
  v_pk_mul_f32 v[224:225], v[224:225], v[228:229] op_sel_hi:[1,0]
  v_pk_mul_f32 v[232:233], v[232:233], v[236:237] op_sel_hi:[1,0]
  v_pk_mul_f32 v[240:241], v[240:241], v[244:245] op_sel_hi:[1,0]
  v_pk_add_f32 v[216:217], v[216:217], v[224:225]
  v_pk_add_f32 v[232:233], v[232:233], v[240:241]
  v_pk_add_f32 v[216:217], v[216:217], v[232:233]
  v_pk_mul_f32 v[216:217], v[216:217], v[144:145] op_sel_hi:[1,0]
  v_cvt_pk_bf16_f32 v128, v216, v217
  v_pk_mul_f32 v[218:219], v[218:219], v[220:221] op_sel_hi:[1,0]
  v_pk_mul_f32 v[226:227], v[226:227], v[228:229] op_sel_hi:[1,0]
  v_pk_mul_f32 v[234:235], v[234:235], v[236:237] op_sel_hi:[1,0]
  v_pk_mul_f32 v[242:243], v[242:243], v[244:245] op_sel_hi:[1,0]
  v_pk_add_f32 v[218:219], v[218:219], v[226:227]
  v_pk_add_f32 v[234:235], v[234:235], v[242:243]
  v_pk_add_f32 v[218:219], v[218:219], v[234:235]
  v_pk_mul_f32 v[218:219], v[218:219], v[144:145] op_sel_hi:[1,0]
  v_cvt_pk_bf16_f32 v129, v218, v219
  buffer_store_dwordx2 v[128:129], v146, s[36:39], s70 offen
L_fin:
L_end:
  s_endpgm
L_helper:
  v_lshlrev_b32 v1, 2, v0
  v_add_u32 v1, 61696, v1
  v_mov_b32 v2, 0
  s_mov_b64 exec, 0xff
  ds_write_b32 v1, v2
  s_mov_b64 exec, -1
  s_waitcnt lgkmcnt(0)
  s_mov_b32 s8, s46
  s_and_b32 s9, s47, 0xffff
  s_mov_b32 s36, s44
  s_and_b32 s37, s45, 0xffff
  s_mov_b32 s16, s46
  s_and_b32 s17, s47, 0xffff
  s_mov_b32 s12, s48
  s_and_b32 s13, s49, 0xffff
  s_mov_b32 s40, s82
  s_and_b32 s41, s83, 0xffff
  s_mov_b32 s36, s58
  s_and_b32 s37, s59, 0xffff
  s_barrier
  s_memrealtime s[72:73]
  s_load_dword s59, s[80:81], 192
  s_getpc_b64 s[54:55]
L_h_pc:
  s_add_u32 s86, s54, L_h_cp - L_h_pc
  s_addc_u32 s87, s55, 0
  s_sub_u32 s54, s54, L_h_pc - L_k
  s_subb_u32 s55, s55, 0
  s_and_b32 s54, s54, -16
  s_lshr_b32 s70, s2, 3
  s_lshl_b32 s70, s70, 10
  v_lshl_add_u32 v106, v0, 4, s70
  v_mov_b32 v107, s55
  v_add_co_u32 v106, vcc, s54, v106
  s_nop 1
  v_addc_co_u32 v107, vcc, 0, v107, vcc
  s_lshr_b32 s70, s2, 3
  s_cmp_lt_u32 s70, (L_code_end - L_k) / 1024
  s_cbranch_scc0 L_h_cta
  global_load_dwordx4 v[108:111], v[106:107], off
L_h_cta:
  s_lshl_b32 s70, s2, 6
  v_lshl_add_u32 v104, v0, 3, s70
  v_bfe_u32 v105, v0, 1, 3
  v_lshlrev_b32 v105, 6, v105
  v_and_b32 v112, 1, v0
  v_lshl_add_u32 v105, v112, 3, v105
  v_lshlrev_b32 v112, 2, v112
  v_add_u32 v112, 61712, v112
  v_mov_b32 v113, 0
  v_lshlrev_b32 v3, 4, v0
  s_mov_b32 s76, 10
  s_mov_b32 s77, 7340032
  s_getreg_b32 s50, hwreg(HW_REG_XCC_ID)
  s_bfe_u32 s50, s50, 0x10002
  s_bfe_u32 s52, s2, 0x30003
  s_cmp_eq_u32 s52, 7
  s_cbranch_scc1 L_h_voted
  s_lshr_b32 s70, s2, 6
  s_xor_b32 s70, s70, s2
  s_and_b32 s70, s70, 3
  s_cbranch_scc1 L_h_voted
  s_cmp_eq_u32 s52, 6
  s_cbranch_scc0 L_h_probe
  s_xor_b32 s48, s50, s4
  s_and_b32 s52, s2, 3
  s_lshl2_add_u32 s52, s52, 36
  s_branch L_h_vote
L_h_probe:
  s_cmp_ge_u32 s52, 3
  s_cselect_b32 s16, s12, s8
  s_cselect_b32 s17, s13, s9
  s_cselect_b32 s70, 3, 0
  s_sub_u32 s70, s52, s70
  s_lshl_b32 s70, s70, 28
  s_add_u32 s44, s5, s4
  s_lshl_b32 s44, s44, 16
  s_add_u32 s44, s44, s70
  s_add_u32 s44, s44, 0x1c0000
  s_mul_i32 s70, s2, 0x2a95
  s_and_b32 s70, s70, 0x7f80
  s_add_u32 s44, s44, s70
  s_add_u32 s70, s44, 0x8000
  s_buffer_load_dword s58, s[16:19], s70
  s_mov_b32 s45, -1
  s_mov_b32 s46, -1
  s_mul_i32 s52, s52, 6
L_h_progp:
  s_sleep 2
  ds_read_b32 v8, v112
  s_waitcnt lgkmcnt(0)
  v_cmp_gt_u32 vcc, 1, v8
  s_nop 1
  s_cmp_lg_u32 vcc_lo, 0
  s_cbranch_scc1 L_h_progp
  s_xor_b32 s70, s44, 0
  s_memtime s[54:55]
  s_waitcnt lgkmcnt(0)
  s_buffer_load_dword s58, s[16:19], s70
  s_waitcnt lgkmcnt(0)
  s_memtime s[56:57]
  s_waitcnt lgkmcnt(0)
  s_sub_u32 s56, s56, s54
  s_min_u32 s45, s45, s56
  s_xor_b32 s70, s44, 8192
  s_memtime s[54:55]
  s_waitcnt lgkmcnt(0)
  s_buffer_load_dword s58, s[16:19], s70
  s_waitcnt lgkmcnt(0)
  s_memtime s[56:57]
  s_waitcnt lgkmcnt(0)
  s_sub_u32 s56, s56, s54
  s_min_u32 s46, s46, s56
  s_xor_b32 s70, s44, 25472
  s_memtime s[54:55]
  s_waitcnt lgkmcnt(0)
  s_buffer_load_dword s58, s[16:19], s70
  s_waitcnt lgkmcnt(0)
  s_memtime s[56:57]
  s_waitcnt lgkmcnt(0)
  s_sub_u32 s56, s56, s54
  s_min_u32 s46, s46, s56
  s_xor_b32 s70, s44, 17280
  s_memtime s[54:55]
  s_waitcnt lgkmcnt(0)
  s_buffer_load_dword s58, s[16:19], s70
  s_waitcnt lgkmcnt(0)
  s_memtime s[56:57]
  s_waitcnt lgkmcnt(0)
  s_sub_u32 s56, s56, s54
  s_min_u32 s45, s45, s56
  s_xor_b32 s70, s44, 5888
  s_memtime s[54:55]
  s_waitcnt lgkmcnt(0)
  s_buffer_load_dword s58, s[16:19], s70
  s_waitcnt lgkmcnt(0)
  s_memtime s[56:57]
  s_waitcnt lgkmcnt(0)
  s_sub_u32 s56, s56, s54
  s_min_u32 s45, s45, s56
  s_xor_b32 s70, s44, 14080
  s_memtime s[54:55]
  s_waitcnt lgkmcnt(0)
  s_buffer_load_dword s58, s[16:19], s70
  s_waitcnt lgkmcnt(0)
  s_memtime s[56:57]
  s_waitcnt lgkmcnt(0)
  s_sub_u32 s56, s56, s54
  s_min_u32 s46, s46, s56
  s_cmp_lt_u32 s46, s45
  s_cselect_b32 s48, 1, 0
  s_lshr_b32 s70, s44, 13
  s_xor_b32 s70, s70, s2
  s_xor_b32 s70, s70, s50
  s_and_b32 s70, s70, 1
  s_xor_b32 s48, s48, s70
L_h_vote:
  s_mov_b32 s49, 0
  s_lshl_b64 s[48:49], s[48:49], s52
  s_or_b32 s49, s49, 0x100000
  s_atomic_add_x2 s[48:49], s[80:81], 0
L_h_voted:
  s_waitcnt lgkmcnt(0)
  s_cmp_lg_u32 s2, 56
  s_cbranch_scc1 L_h_nonce
  s_lshl_b64 s[54:55], s[72:73], 2
  s_atomic_add_x2 s[54:55], s[80:81], 8
  s_waitcnt lgkmcnt(0)
L_h_nonce:
L_h_progv:
  s_sleep 4
  ds_read_b32 v8, v112
  s_waitcnt lgkmcnt(0)
  v_cmp_gt_u32 vcc, 6, v8
  s_nop 1
  s_cmp_lg_u32 vcc_lo, 0
  s_cbranch_scc1 L_h_progv
  s_load_dwordx2 s[48:49], s[80:81], 0
  s_mov_b32 s59, 0
L_h_votes:
  s_waitcnt lgkmcnt(0)
  s_lshr_b32 s70, s49, 20
  s_cmp_ge_u32 s70, 56
  s_cbranch_scc1 L_h_votes_done
  s_add_u32 s59, s59, 1
  s_cmp_gt_u32 s59, 8000
  s_cbranch_scc1 L_h_votes_done
  s_sleep 64
  s_mov_b64 s[48:49], 0
  s_atomic_or_x2 s[48:49], s[80:81], 0 glc
  s_branch L_h_votes
L_h_votes_done:
  s_mov_b32 s96, 0x80
  s_bfe_u64 s[54:55], s[48:49], 0x60000
  s_cmp_gt_u32 s54, 4
  s_cselect_b32 s56, 1, 0
  s_or_b32 s96, s96, s56
  s_bfe_u64 s[54:55], s[48:49], 0x60006
  s_cmp_gt_u32 s54, 4
  s_cselect_b32 s56, 2, 0
  s_or_b32 s96, s96, s56
  s_bfe_u64 s[54:55], s[48:49], 0x6000c
  s_cmp_gt_u32 s54, 4
  s_cselect_b32 s56, 4, 0
  s_or_b32 s96, s96, s56
  s_bfe_u64 s[54:55], s[48:49], 0x60012
  s_cmp_gt_u32 s54, 4
  s_cselect_b32 s56, 8, 0
  s_or_b32 s96, s96, s56
  s_bfe_u64 s[54:55], s[48:49], 0x60018
  s_cmp_gt_u32 s54, 4
  s_cselect_b32 s56, 16, 0
  s_or_b32 s96, s96, s56
  s_bfe_u64 s[54:55], s[48:49], 0x6001e
  s_cmp_gt_u32 s54, 4
  s_cselect_b32 s56, 32, 0
  s_or_b32 s96, s96, s56
  s_and_b32 s70, s2, 3
  s_lshl2_add_u32 s70, s70, 5
  s_lshr_b32 s54, s49, s70
  s_xor_b32 s54, s54, s2
  s_xor_b32 s54, s54, s4
  s_and_b32 s54, s54, 1
  s_mul_i32 s54, s54, 63
  s_xor_b32 s96, s96, s54
  v_mov_b32 v1, 61696
  v_mov_b32 v5, s96
  ds_write_b32 v1, v5
  s_load_dwordx2 s[74:75], s[80:81], 8
  s_mov_b32 s59, 0
L_h_getnonce:
  s_waitcnt lgkmcnt(0)
  s_cmp_lg_u64 s[74:75], 0
  s_cbranch_scc1 L_h_gotnonce
  s_add_u32 s59, s59, 1
  s_cmp_gt_u32 s59, 8000
  s_cbranch_scc1 L_h_gotnonce
  s_sleep 64
  s_atomic_or_x2 s[74:75], s[80:81], 8 glc
  s_branch L_h_getnonce
L_h_gotnonce:
  s_lshr_b64 s[54:55], s[74:75], 4
  s_mul_i32 s54, s54, 0x9e3779b1
  v_writelane_b32 v8, s54, 7
  s_lshr_b32 s64, s5, 5
  s_mov_b32 s50, 0xaaaaaaab
  s_add_u32 s54, s64, 0
  s_mul_hi_u32 s56, s54, s50
  s_lshr_b32 s56, s56, 1
  s_mul_i32 s56, s56, 3
  s_sub_u32 s54, s54, s56
  s_lshr_b32 s56, s96, s54
  s_bfe_u32 s56, s56, 0x10003
  s_lshl_b32 s54, s54, 7
  s_add_u32 s54, s54, s64
  s_mul_hi_u32 s54, s54, s50
  s_lshr_b32 s54, s54, 1
  s_lshl3_add_u32 s54, s54, s56
  s_mul_i32 s70, s54, 3456
  s_add_u32 s70, s70, 1048576
  v_writelane_b32 v8, s70, 0
  s_add_u32 s54, s64, 4
  s_mul_hi_u32 s56, s54, s50
  s_lshr_b32 s56, s56, 1
  s_mul_i32 s56, s56, 3
  s_sub_u32 s54, s54, s56
  s_lshr_b32 s56, s96, s54
  s_bfe_u32 s56, s56, 0x10003
  s_lshl_b32 s54, s54, 7
  s_add_u32 s54, s54, s64
  s_mul_hi_u32 s54, s54, s50
  s_lshr_b32 s54, s54, 1
  s_lshl3_add_u32 s54, s54, s56
  s_add_u32 s54, s54, 6
  s_mul_i32 s70, s54, 3456
  s_add_u32 s70, s70, 1048576
  v_writelane_b32 v8, s70, 1
  s_add_u32 s54, s64, 2
  s_mul_hi_u32 s56, s54, s50
  s_lshr_b32 s56, s56, 1
  s_mul_i32 s56, s56, 3
  s_sub_u32 s54, s54, s56
  s_lshr_b32 s56, s96, s54
  s_bfe_u32 s56, s56, 0x10003
  s_lshl_b32 s54, s54, 7
  s_add_u32 s54, s54, s64
  s_mul_hi_u32 s54, s54, s50
  s_lshr_b32 s54, s54, 1
  s_lshl3_add_u32 s54, s54, s56
  s_lshl_b32 s56, s4, 1
  s_sub_u32 s57, s54, s56
  s_add_u32 s57, s57, 4
  s_mul_i32 s70, s57, 3456
  s_add_u32 s70, s70, 1048576
  v_writelane_b32 v8, s70, 2
  s_add_u32 s54, s54, s56
  s_add_u32 s54, s54, 2
  s_xor_b32 s56, s54, 1
  s_mul_i32 s70, s56, 3456
  s_add_u32 s70, s70, 1048576
  v_writelane_b32 v8, s70, 3
  s_andn2_b32 s56, s54, 1
  s_xor_b32 s56, s56, 2
  s_mul_i32 s70, s56, 3456
  s_add_u32 s70, s70, 1048576
  v_writelane_b32 v8, s70, 4
  s_add_u32 s56, s56, 1
  s_mul_i32 s70, s56, 3456
  s_add_u32 s70, s70, 1048576
  v_writelane_b32 v8, s70, 5
  s_lshr_b32 s54, s54, 2
  s_mul_i32 s54, s54, 1536
  v_writelane_b32 v8, s54, 6
  v_lshlrev_b32 v1, 2, v0
  s_mov_b64 exec, 0xff
  ds_write_b32 v1, v8 offset:61728
  s_mov_b64 exec, -1
  s_lshl_b32 s62, s2, 8
  s_add_u32 s62, s62, 6291456
  s_xor_b32 s63, s62, 1024
  s_lshr_b32 s58, s96, 3
  s_xor_b32 s58, s58, s96
  s_mov_b32 s44, 16777216
  s_bitcmp1_b32 s5, 5
  s_cselect_b32 s70, 2048, 0
  s_xor_b32 s44, s44, s70
  s_bitcmp1_b32 s5, 6
  s_cselect_b32 s70, 4096, 0
  s_xor_b32 s44, s44, s70
  s_bitcmp1_b32 s5, 7
  s_cselect_b32 s70, 8192, 0
  s_xor_b32 s44, s44, s70
  s_bitcmp1_b32 s5, 8
  s_cselect_b32 s70, 16384, 0
  s_xor_b32 s44, s44, s70
  s_bitcmp1_b32 s5, 9
  s_cselect_b32 s70, 2097152, 0
  s_xor_b32 s44, s44, s70
  s_bitcmp1_b32 s5, 10
  s_cselect_b32 s70, 4194304, 0
  s_xor_b32 s44, s44, s70
  s_bitcmp1_b32 s5, 11
  s_cselect_b32 s70, 8388608, 0
  s_xor_b32 s44, s44, s70
  s_mul_i32 s70, s4, 1024
  s_xor_b32 s60, s44, s70
  s_xor_b32 s61, s60, 1024
  s_mov_b32 s78, 62
  s_swappc_b64 s[84:85], s[86:87]
L_h_proga:
  s_sleep 4
  ds_read_b32 v8, v112
  s_waitcnt lgkmcnt(0)
  v_cmp_gt_u32 vcc, 64, v8
  s_nop 1
  s_cmp_lg_u32 vcc_lo, 0
  s_cbranch_scc1 L_h_proga
  ds_read_b128 v[8:11], v3 offset:0
  ds_read_b128 v[12:15], v3 offset:1024
  ds_read_b128 v[16:19], v3 offset:2048
  s_waitcnt lgkmcnt(0)
  s_xor_b32 s70, s60, 0
  buffer_store_dwordx4 v[8:11], v3, s[40:43], s70 offen sc1
  s_xor_b32 s70, s60, 32768
  buffer_store_dwordx4 v[12:15], v3, s[40:43], s70 offen sc1
  s_xor_b32 s70, s60, 67584
  buffer_store_dwordx4 v[16:19], v3, s[40:43], s70 offen sc1
  s_bitcmp0_b32 s58, 2
  s_cbranch_scc1 L_h_e0
  ds_read_b128 v[20:23], v3 offset:3072
  ds_read_b128 v[24:27], v3 offset:4096
  ds_read_b128 v[28:31], v3 offset:5120
  ds_read_b128 v[32:35], v3 offset:6144
  ds_read_b128 v[36:39], v3 offset:7168
  ds_read_b128 v[40:43], v3 offset:8192
  ds_read_b128 v[44:47], v3 offset:9216
  ds_read_b128 v[48:51], v3 offset:10240
  ds_read_b128 v[52:55], v3 offset:11264
  s_waitcnt lgkmcnt(0)
  s_xor_b32 s70, s60, 100352
  buffer_store_dwordx4 v[20:23], v3, s[40:43], s70 offen sc1
  s_xor_b32 s70, s60, 136192
  buffer_store_dwordx4 v[24:27], v3, s[40:43], s70 offen sc1
  s_xor_b32 s70, s60, 168960
  buffer_store_dwordx4 v[28:31], v3, s[40:43], s70 offen sc1
  s_xor_b32 s70, s60, 203776
  buffer_store_dwordx4 v[32:35], v3, s[40:43], s70 offen sc1
  s_xor_b32 s70, s60, 236544
  buffer_store_dwordx4 v[36:39], v3, s[40:43], s70 offen sc1
  s_xor_b32 s70, s60, 272384
  buffer_store_dwordx4 v[40:43], v3, s[40:43], s70 offen sc1
  s_xor_b32 s70, s60, 305152
  buffer_store_dwordx4 v[44:47], v3, s[40:43], s70 offen sc1
  s_xor_b32 s70, s60, 335872
  buffer_store_dwordx4 v[48:51], v3, s[40:43], s70 offen sc1
  s_xor_b32 s70, s60, 368640
  buffer_store_dwordx4 v[52:55], v3, s[40:43], s70 offen sc1
L_h_e0:
  s_bitcmp0_b32 s58, 0
  s_cbranch_scc1 L_h_e1
  ds_read_b128 v[56:59], v3 offset:12288
  ds_read_b128 v[60:63], v3 offset:13312
  ds_read_b128 v[64:67], v3 offset:14336
  ds_read_b128 v[68:71], v3 offset:15360
  ds_read_b128 v[72:75], v3 offset:16384
  ds_read_b128 v[76:79], v3 offset:17408
  ds_read_b128 v[80:83], v3 offset:18432
  ds_read_b128 v[84:87], v3 offset:19456
  ds_read_b128 v[88:91], v3 offset:20480
  ds_read_b128 v[92:95], v3 offset:21504
  ds_read_b128 v[96:99], v3 offset:22528
  ds_read_b128 v[100:103], v3 offset:23552
  s_waitcnt lgkmcnt(0)
  s_xor_b32 s70, s60, 408576
  buffer_store_dwordx4 v[56:59], v3, s[40:43], s70 offen sc1
  s_xor_b32 s70, s60, 441344
  buffer_store_dwordx4 v[60:63], v3, s[40:43], s70 offen sc1
  s_xor_b32 s70, s60, 472064
  buffer_store_dwordx4 v[64:67], v3, s[40:43], s70 offen sc1
  s_xor_b32 s70, s60, 504832
  buffer_store_dwordx4 v[68:71], v3, s[40:43], s70 offen sc1
  s_xor_b32 s70, s60, 525312
  buffer_store_dwordx4 v[72:75], v3, s[40:43], s70 offen sc1
  s_xor_b32 s70, s60, 558080
  buffer_store_dwordx4 v[76:79], v3, s[40:43], s70 offen sc1
  s_xor_b32 s70, s60, 592896
  buffer_store_dwordx4 v[80:83], v3, s[40:43], s70 offen sc1
  s_xor_b32 s70, s60, 625664
  buffer_store_dwordx4 v[84:87], v3, s[40:43], s70 offen sc1
  s_xor_b32 s70, s60, 659456
  buffer_store_dwordx4 v[88:91], v3, s[40:43], s70 offen sc1
  s_xor_b32 s70, s60, 692224
  buffer_store_dwordx4 v[92:95], v3, s[40:43], s70 offen sc1
  s_xor_b32 s70, s60, 727040
  buffer_store_dwordx4 v[96:99], v3, s[40:43], s70 offen sc1
  s_xor_b32 s70, s60, 759808
  buffer_store_dwordx4 v[100:103], v3, s[40:43], s70 offen sc1
L_h_e1:
  s_add_u32 s54, s74, 1
  v_lshlrev_b32 v5, 3, v0
  s_waitcnt vmcnt(0)
  v_mov_b32 v8, s54
  v_mov_b32 v9, s75
  s_mov_b64 exec, 0xffff
  buffer_store_dwordx2 v[8:9], v5, s[40:43], s62 offen sc1
  s_mov_b64 exec, 1
  s_mov_b32 s59, 0
L_h_flaga:
  buffer_load_dwordx2 v[10:11], v5, s[40:43], s63 offen sc1
  s_waitcnt vmcnt(0)
  v_readfirstlane_b32 s56, v10
  v_readfirstlane_b32 s57, v11
  s_nop 0
  s_sub_u32 s56, s56, s54
  s_xor_b32 s57, s57, s75
  s_lshr_b32 s56, s56, 1
  s_or_b32 s56, s56, s57
  s_cbranch_scc0 L_h_flaga_done
  s_add_u32 s59, s59, 1
  s_cmp_gt_u32 s59, 100000
  s_cbranch_scc1 L_h_flaga_done
  s_sleep 8
  s_branch L_h_flaga
L_h_flaga_done:
  s_mov_b64 exec, -1
  s_bfe_u32 s54, s96, 0x10005
  s_mul_i32 s54, s54, 384
  v_lshrrev_b32 v4, 3, v0
  v_add_u32 v5, 0, v4
  v_mul_u32_u24 v5, 21846, v5
  v_bfe_u32 v5, v5, 16, 1
  v_mul_u32_u24 v6, 384, v5
  v_sub_u32 v6, v3, v6
  v_add_u32 v6, s54, v6
  v_add_u32 v6, 0, v6
  v_mul_u32_u24 v5, 1024, v5
  v_xor_b32 v5, s44, v5
  v_bfe_u32 v2, v6, 10, 1
  v_mul_u32_u24 v2, 32768, v2
  v_xor_b32 v5, v5, v2
  v_bfe_u32 v2, v6, 11, 1
  v_mul_u32_u24 v2, 67584, v2
  v_xor_b32 v5, v5, v2
  v_and_b32 v6, 1023, v6
  v_add_u32 v5, v5, v6
  buffer_load_dwordx4 v[8:11], v5, s[40:43], 0 offen sc1
  v_add_u32 v5, 8, v4
  v_mul_u32_u24 v5, 21846, v5
  v_bfe_u32 v5, v5, 16, 1
  v_mul_u32_u24 v6, 384, v5
  v_sub_u32 v6, v3, v6
  v_add_u32 v6, s54, v6
  v_add_u32 v6, 1024, v6
  v_mul_u32_u24 v5, 1024, v5
  v_xor_b32 v5, s44, v5
  v_bfe_u32 v2, v6, 10, 1
  v_mul_u32_u24 v2, 32768, v2
  v_xor_b32 v5, v5, v2
  v_bfe_u32 v2, v6, 11, 1
  v_mul_u32_u24 v2, 67584, v2
  v_xor_b32 v5, v5, v2
  v_and_b32 v6, 1023, v6
  v_add_u32 v5, v5, v6
  buffer_load_dwordx4 v[12:15], v5, s[40:43], 0 offen sc1
  v_add_u32 v5, 16, v4
  v_mul_u32_u24 v5, 21846, v5
  v_bfe_u32 v5, v5, 16, 1
  v_mul_u32_u24 v6, 384, v5
  v_sub_u32 v6, v3, v6
  v_add_u32 v6, s54, v6
  v_add_u32 v6, 2048, v6
  v_mul_u32_u24 v5, 1024, v5
  v_xor_b32 v5, s44, v5
  v_bfe_u32 v2, v6, 10, 1
  v_mul_u32_u24 v2, 32768, v2
  v_xor_b32 v5, v5, v2
  v_bfe_u32 v2, v6, 11, 1
  v_mul_u32_u24 v2, 67584, v2
  v_xor_b32 v5, v5, v2
  v_and_b32 v6, 1023, v6
  v_add_u32 v5, v5, v6
  buffer_load_dwordx4 v[16:19], v5, s[40:43], 0 offen sc1
  s_bitcmp0_b32 s58, 2
  s_cbranch_scc1 L_h_i0
  s_xor_b32 s70, s61, 100352
  buffer_load_dwordx4 v[20:23], v3, s[40:43], s70 offen sc1
  s_xor_b32 s70, s61, 136192
  buffer_load_dwordx4 v[24:27], v3, s[40:43], s70 offen sc1
  s_xor_b32 s70, s61, 168960
  buffer_load_dwordx4 v[28:31], v3, s[40:43], s70 offen sc1
  s_xor_b32 s70, s61, 203776
  buffer_load_dwordx4 v[32:35], v3, s[40:43], s70 offen sc1
  s_xor_b32 s70, s61, 236544
  buffer_load_dwordx4 v[36:39], v3, s[40:43], s70 offen sc1
  s_xor_b32 s70, s61, 272384
  buffer_load_dwordx4 v[40:43], v3, s[40:43], s70 offen sc1
  s_xor_b32 s70, s61, 305152
  buffer_load_dwordx4 v[44:47], v3, s[40:43], s70 offen sc1
  s_xor_b32 s70, s61, 335872
  buffer_load_dwordx4 v[48:51], v3, s[40:43], s70 offen sc1
  s_xor_b32 s70, s61, 368640
  buffer_load_dwordx4 v[52:55], v3, s[40:43], s70 offen sc1
  s_waitcnt vmcnt(0)
  ds_write_b128 v3, v[20:23] offset:3072
  ds_write_b128 v3, v[24:27] offset:4096
  ds_write_b128 v3, v[28:31] offset:5120
  ds_write_b128 v3, v[32:35] offset:6144
  ds_write_b128 v3, v[36:39] offset:7168
  ds_write_b128 v3, v[40:43] offset:8192
  ds_write_b128 v3, v[44:47] offset:9216
  ds_write_b128 v3, v[48:51] offset:10240
  ds_write_b128 v3, v[52:55] offset:11264
L_h_i0:
  s_bitcmp0_b32 s58, 0
  s_cbranch_scc1 L_h_i1
  s_xor_b32 s70, s61, 408576
  buffer_load_dwordx4 v[56:59], v3, s[40:43], s70 offen sc1
  s_xor_b32 s70, s61, 441344
  buffer_load_dwordx4 v[60:63], v3, s[40:43], s70 offen sc1
  s_xor_b32 s70, s61, 472064
  buffer_load_dwordx4 v[64:67], v3, s[40:43], s70 offen sc1
  s_xor_b32 s70, s61, 504832
  buffer_load_dwordx4 v[68:71], v3, s[40:43], s70 offen sc1
  s_xor_b32 s70, s61, 525312
  buffer_load_dwordx4 v[72:75], v3, s[40:43], s70 offen sc1
  s_xor_b32 s70, s61, 558080
  buffer_load_dwordx4 v[76:79], v3, s[40:43], s70 offen sc1
  s_xor_b32 s70, s61, 592896
  buffer_load_dwordx4 v[80:83], v3, s[40:43], s70 offen sc1
  s_xor_b32 s70, s61, 625664
  buffer_load_dwordx4 v[84:87], v3, s[40:43], s70 offen sc1
  s_xor_b32 s70, s61, 659456
  buffer_load_dwordx4 v[88:91], v3, s[40:43], s70 offen sc1
  s_xor_b32 s70, s61, 692224
  buffer_load_dwordx4 v[92:95], v3, s[40:43], s70 offen sc1
  s_xor_b32 s70, s61, 727040
  buffer_load_dwordx4 v[96:99], v3, s[40:43], s70 offen sc1
  s_xor_b32 s70, s61, 759808
  buffer_load_dwordx4 v[100:103], v3, s[40:43], s70 offen sc1
  s_waitcnt vmcnt(0)
  ds_write_b128 v3, v[56:59] offset:12288
  ds_write_b128 v3, v[60:63] offset:13312
  ds_write_b128 v3, v[64:67] offset:14336
  ds_write_b128 v3, v[68:71] offset:15360
  ds_write_b128 v3, v[72:75] offset:16384
  ds_write_b128 v3, v[76:79] offset:17408
  ds_write_b128 v3, v[80:83] offset:18432
  ds_write_b128 v3, v[84:87] offset:19456
  ds_write_b128 v3, v[88:91] offset:20480
  ds_write_b128 v3, v[92:95] offset:21504
  ds_write_b128 v3, v[96:99] offset:22528
  ds_write_b128 v3, v[100:103] offset:23552
L_h_i1:
  s_waitcnt vmcnt(0)
  ds_write_b128 v3, v[8:11] offset:0
  ds_write_b128 v3, v[12:15] offset:1024
  ds_write_b128 v3, v[16:19] offset:2048
  s_bitcmp0_b32 s58, 1
  s_cselect_b32 s70, 255, 32
  v_mov_b32 v1, 61700
  v_mov_b32 v5, s70
  ds_write_b32 v1, v5
  s_mov_b32 s78, 94
  s_swappc_b64 s[84:85], s[86:87]
  s_bitcmp0_b32 s58, 1
  s_cbranch_scc1 L_h_all
L_h_progb:
  s_sleep 4
  ds_read_b32 v8, v112
  s_waitcnt lgkmcnt(0)
  v_cmp_gt_u32 vcc, 96, v8
  s_nop 1
  s_cmp_lg_u32 vcc_lo, 0
  s_cbranch_scc1 L_h_progb
  ds_read_b128 v[8:11], v3 offset:24576
  ds_read_b128 v[12:15], v3 offset:25600
  ds_read_b128 v[16:19], v3 offset:26624
  ds_read_b128 v[20:23], v3 offset:27648
  ds_read_b128 v[24:27], v3 offset:28672
  ds_read_b128 v[28:31], v3 offset:29696
  ds_read_b128 v[32:35], v3 offset:30720
  ds_read_b128 v[36:39], v3 offset:31744
  ds_read_b128 v[40:43], v3 offset:32768
  ds_read_b128 v[44:47], v3 offset:33792
  ds_read_b128 v[48:51], v3 offset:34816
  ds_read_b128 v[52:55], v3 offset:35840
  s_waitcnt lgkmcnt(0)
  s_xor_b32 s70, s60, 797696
  buffer_store_dwordx4 v[8:11], v3, s[40:43], s70 offen sc1
  s_xor_b32 s70, s60, 830464
  buffer_store_dwordx4 v[12:15], v3, s[40:43], s70 offen sc1
  s_xor_b32 s70, s60, 861184
  buffer_store_dwordx4 v[16:19], v3, s[40:43], s70 offen sc1
  s_xor_b32 s70, s60, 893952
  buffer_store_dwordx4 v[20:23], v3, s[40:43], s70 offen sc1
  s_xor_b32 s70, s60, 931840
  buffer_store_dwordx4 v[24:27], v3, s[40:43], s70 offen sc1
  s_xor_b32 s70, s60, 964608
  buffer_store_dwordx4 v[28:31], v3, s[40:43], s70 offen sc1
  s_xor_b32 s70, s60, 995328
  buffer_store_dwordx4 v[32:35], v3, s[40:43], s70 offen sc1
  s_xor_b32 s70, s60, 1028096
  buffer_store_dwordx4 v[36:39], v3, s[40:43], s70 offen sc1
  s_xor_b32 s70, s60, 1052672
  buffer_store_dwordx4 v[40:43], v3, s[40:43], s70 offen sc1
  s_xor_b32 s70, s60, 1085440
  buffer_store_dwordx4 v[44:47], v3, s[40:43], s70 offen sc1
  s_xor_b32 s70, s60, 1120256
  buffer_store_dwordx4 v[48:51], v3, s[40:43], s70 offen sc1
  s_xor_b32 s70, s60, 1153024
  buffer_store_dwordx4 v[52:55], v3, s[40:43], s70 offen sc1
  s_add_u32 s54, s74, 2
  v_lshlrev_b32 v5, 3, v0
  s_waitcnt vmcnt(0)
  v_mov_b32 v8, s54
  v_mov_b32 v9, s75
  s_mov_b64 exec, 0xffff
  buffer_store_dwordx2 v[8:9], v5, s[40:43], s62 offen sc1
  s_mov_b64 exec, 1
  s_mov_b32 s59, 0
L_h_flagb:
  buffer_load_dwordx2 v[10:11], v5, s[40:43], s63 offen sc1
  s_waitcnt vmcnt(0)
  v_readfirstlane_b32 s56, v10
  v_readfirstlane_b32 s57, v11
  s_nop 0
  s_sub_u32 s56, s56, s54
  s_xor_b32 s57, s57, s75
  s_lshr_b32 s56, s56, 1
  s_or_b32 s56, s56, s57
  s_cbranch_scc0 L_h_flagb_done
  s_add_u32 s59, s59, 1
  s_cmp_gt_u32 s59, 100000
  s_cbranch_scc1 L_h_flagb_done
  s_sleep 8
  s_branch L_h_flagb
L_h_flagb_done:
  s_mov_b64 exec, -1
  s_xor_b32 s70, s61, 797696
  buffer_load_dwordx4 v[8:11], v3, s[40:43], s70 offen sc1
  s_xor_b32 s70, s61, 830464
  buffer_load_dwordx4 v[12:15], v3, s[40:43], s70 offen sc1
  s_xor_b32 s70, s61, 861184
  buffer_load_dwordx4 v[16:19], v3, s[40:43], s70 offen sc1
  s_xor_b32 s70, s61, 893952
  buffer_load_dwordx4 v[20:23], v3, s[40:43], s70 offen sc1
  s_xor_b32 s70, s61, 931840
  buffer_load_dwordx4 v[24:27], v3, s[40:43], s70 offen sc1
  s_xor_b32 s70, s61, 964608
  buffer_load_dwordx4 v[28:31], v3, s[40:43], s70 offen sc1
  s_xor_b32 s70, s61, 995328
  buffer_load_dwordx4 v[32:35], v3, s[40:43], s70 offen sc1
  s_xor_b32 s70, s61, 1028096
  buffer_load_dwordx4 v[36:39], v3, s[40:43], s70 offen sc1
  s_xor_b32 s70, s61, 1052672
  buffer_load_dwordx4 v[40:43], v3, s[40:43], s70 offen sc1
  s_xor_b32 s70, s61, 1085440
  buffer_load_dwordx4 v[44:47], v3, s[40:43], s70 offen sc1
  s_xor_b32 s70, s61, 1120256
  buffer_load_dwordx4 v[48:51], v3, s[40:43], s70 offen sc1
  s_xor_b32 s70, s61, 1153024
  buffer_load_dwordx4 v[52:55], v3, s[40:43], s70 offen sc1
  s_waitcnt vmcnt(0)
  ds_write_b128 v3, v[8:11] offset:24576
  ds_write_b128 v3, v[12:15] offset:25600
  ds_write_b128 v3, v[16:19] offset:26624
  ds_write_b128 v3, v[20:23] offset:27648
  ds_write_b128 v3, v[24:27] offset:28672
  ds_write_b128 v3, v[28:31] offset:29696
  ds_write_b128 v3, v[32:35] offset:30720
  ds_write_b128 v3, v[36:39] offset:31744
  ds_write_b128 v3, v[40:43] offset:32768
  ds_write_b128 v3, v[44:47] offset:33792
  ds_write_b128 v3, v[48:51] offset:34816
  ds_write_b128 v3, v[52:55] offset:35840
  v_mov_b32 v1, 61700
  v_mov_b32 v5, 255
  ds_write_b32 v1, v5
L_h_all:
  s_mov_b32 s78, 186
  s_swappc_b64 s[84:85], s[86:87]
L_h_progt:
  s_sleep 4
  ds_read_b32 v8, v112
  s_waitcnt lgkmcnt(0)
  v_cmp_gt_u32 vcc, 188, v8
  s_nop 1
  s_cmp_lg_u32 vcc_lo, 0
  s_cbranch_scc1 L_h_progt
  v_mov_b32 v8, 255
  ds_write_b32 v112, v8 offset:8
  s_branch L_finish
L_h_cp:
  s_cmp_gt_u32 s76, s78
  s_cbranch_scc0 L_h_cpgo
  s_setpc_b64 s[84:85]
L_h_cpgo:
  ds_read_b32 v8, v112
  s_waitcnt lgkmcnt(0)
  v_cmp_gt_u32 vcc, s76, v8
  s_nop 1
  s_cmp_eq_u32 vcc_lo, 0
  s_cbranch_scc1 L_h_cpnext
L_h_first:
  s_sleep 2
  ds_read_b32 v8, v112
  s_waitcnt lgkmcnt(0)
  v_cmp_gt_u32 s[48:49], s76, v8
  s_nop 1
  s_cmp_eq_u32 s48, -1
  s_cbranch_scc1 L_h_first
  s_memrealtime s[54:55]
L_h_progm:
  s_sleep 2
  ds_read_b32 v8, v112
  s_waitcnt lgkmcnt(0)
  v_cmp_gt_u32 vcc, s76, v8
  s_nop 1
  s_cmp_lg_u32 vcc_lo, 0
  s_cbranch_scc1 L_h_progm
  s_memrealtime s[56:57]
  v_mov_b32 v114, s54
  v_mov_b32 v115, s55
  s_mov_b64 exec, s[48:49]
  s_waitcnt lgkmcnt(0)
  v_mov_b32 v114, s56
  v_mov_b32 v115, s57
  s_mov_b64 exec, -1
  s_cmp_ge_u32 s2, 8
  s_cbranch_scc1 L_h_np
  s_mov_b64 exec, 0xff
  buffer_store_dwordx2 v[114:115], v104, s[40:43], s77 offen sc1
  s_mov_b64 exec, -1
L_h_np:
  s_add_u32 s50, s76, 2
L_h_progc:
  s_sleep 4
  ds_read_b32 v8, v112
  s_waitcnt lgkmcnt(0)
  v_cmp_gt_u32 vcc, s50, v8
  s_nop 1
  s_cmp_lg_u32 vcc_lo, 0
  s_cbranch_scc1 L_h_progc
  buffer_load_dwordx2 v[8:9], v105, s[40:43], s77 offen
  v_mov_b32 v10, s73
  s_waitcnt vmcnt(0)
  ds_read_b32 v12, v112
  v_subrev_co_u32 v8, vcc, s72, v8
  s_nop 1
  v_subb_co_u32 v9, vcc, v9, v10, vcc
  v_lshrrev_b32 v10, 24, v8
  v_or_b32 v9, v9, v10
  v_cmp_eq_u32 vcc, 0, v9
  s_nop 1
  v_cndmask_b32 v8, 0, v8, vcc
  s_and_b32 s56, vcc_lo, 0xffff
  s_bcnt1_i32_b32 s56, s56
  v_add_u32_dpp v8, v8, v8 row_ror:8 row_mask:0xf bank_mask:0xf
  s_nop 1
  v_add_u32_dpp v8, v8, v8 row_ror:4 row_mask:0xf bank_mask:0xf
  s_nop 1
  v_add_u32_dpp v8, v8, v8 row_ror:2 row_mask:0xf bank_mask:0xf
  s_nop 1
  v_add_u32_dpp v8, v8, v8 row_ror:1 row_mask:0xf bank_mask:0xf
  v_subrev_u32 v9, s72, v114
  v_mul_lo_u32 v9, v9, s56
  s_max_u32 s56, s56, 1
  v_sub_u32 v8, v9, v8
  v_cvt_f32_u32 v9, s56
  v_cvt_f32_i32 v8, v8
  v_rcp_f32 v9, v9
  s_nop 0
  v_mul_f32 v8, v8, v9
  v_cvt_i32_f32 v8, v8
  s_waitcnt lgkmcnt(0)
  v_add_u32 v12, 2, v12
  v_min_u32 v9, v113, v12
  v_subrev_u32 v9, s76, v9
  v_max_i32 v9, 0, v9
  v_lshrrev_b32 v9, 1, v9
  v_mul_u32_u24 v9, 32, v9
  v_sub_u32 v8, v8, v9
  v_add_u32 v9, 46, v8
  v_max_i32 v9, 0, v9
  v_min_i32 v9, 2000, v9
  v_mul_u32_u24 v9, 2048, v9
  v_lshrrev_b32 v9, 16, v9
  v_cmp_ne_u32 vcc, 0, v9
  v_lshl_add_u32 v9, v9, 1, v12
  s_nop 0
  v_cndmask_b32 v113, 0, v9, vcc
  ds_write_b32 v112, v113 offset:8
L_h_cpnext:
  s_add_u32 s76, s76, 4
  s_add_u32 s77, s77, 512
  s_branch L_h_cp
L_code_end:
.section .rodata,"a"
.p2align 6
.amdhsa_kernel standalone__kv_cache_quant_int4_int2_kv_with_per_channel_or_per_token_scales__sampling_kernel
  .amdhsa_next_free_vgpr 256
  .amdhsa_next_free_sgpr 102
  .amdhsa_accum_offset 256
  .amdhsa_group_segment_fixed_size 0
  .amdhsa_kernarg_size 80
  .amdhsa_user_sgpr_count 2
  .amdhsa_user_sgpr_kernarg_segment_ptr 1
  .amdhsa_system_sgpr_workgroup_id_x 1
  .amdhsa_float_denorm_mode_32 3
.end_amdhsa_kernel
```

```asm
; @launch grid=(256,1,1) block=(192,1,1) lds=62464
.amdgcn_target "amdgcn-amd-amdhsa--gfx950"
.text
.globl standalone__kv_cache_quant_int4_int2_kv_with_per_channel_or_per_token_scales__sampling_kernel
.p2align 8
.type standalone__kv_cache_quant_int4_int2_kv_with_per_channel_or_per_token_scales__sampling_kernel,@function
standalone__kv_cache_quant_int4_int2_kv_with_per_channel_or_per_token_scales__sampling_kernel:
  s_cmp_ge_u32 s2, 256
  s_cbranch_scc1 L_end
  s_load_dwordx16 s[44:59], s[0:1], 0
  s_load_dwordx4 s[80:83], s[0:1], 64
  v_lshrrev_b32 v1, 6, v0
  v_and_b32 v0, 63, v0
  v_readfirstlane_b32 s3, v1
  s_bfe_u32 s4, s2, 0x10002
  s_lshr_b32 s5, s2, 3
  s_lshl_b32 s5, s5, 2
  s_and_b32 s70, s2, 3
  s_add_u32 s5, s5, s70
  s_lshl_b32 s5, s5, 5
  s_mov_b32 s22, 6291456
  s_mov_b32 s23, 0x20000
  s_mov_b32 s26, 6291456
  s_mov_b32 s27, 0x20000
  s_mov_b32 s30, 2097152
  s_mov_b32 s31, 0x20000
  s_mov_b32 s34, 2097152
  s_mov_b32 s35, 0x20000
  s_mov_b32 s10, 805306368
  s_mov_b32 s11, 0x20000
  s_mov_b32 s38, 393216
  s_mov_b32 s39, 0x20000
  s_mov_b32 s18, 805306368
  s_mov_b32 s19, 0x20000
  s_mov_b32 s14, 805306368
  s_mov_b32 s15, 0x20000
  s_mov_b32 s42, 33554432
  s_mov_b32 s43, 0x20000
  s_cmp_eq_u32 s3, 2
  s_cbranch_scc1 L_helper
  v_and_b32 v108, 3, v0
  v_bfe_u32 v109, v0, 2, 2
  v_lshrrev_b32 v110, 4, v0
  v_and_b32 v111, 15, v0
  v_lshlrev_b32 v144, 4, v108
  v_lshl_add_u32 v144, v110, 6, v144
  v_lshrrev_b32 v233, 1, v144
  v_and_b32 v231, 2, v109
  v_lshlrev_b32 v230, 5, v231
  v_add_u32 v230, 129, v230
  v_and_b32 v145, 1, v109
  v_lshl_add_u32 v231, v145, 2, v231
  v_mul_u32_u24 v145, 33024, v145
  v_add_u32 v232, v144, v145
  v_subrev_u32 v232, 33024, v232
  v_mul_u32_u24 v145, 384, v109
  v_add_u32 v235, v145, v233
  v_mov_b32 v105, 2147483632
  s_mov_b32 s90, 0xaaaaaaab
  s_mov_b32 s91, 0x492492
  s_movk_i32 s63, 768
  s_mov_b32 s64, s3
  s_mov_b32 s99, 8
  s_mov_b32 s96, 0
  v_lshlrev_b32 v114, 4, v0
  s_lshl_b32 s86, s5, 9
  s_mul_i32 s70, s3, 3072
  s_add_u32 s71, s86, 0
  s_mul_hi_u32 s71, s71, s90
  s_lshr_b32 s71, s71, 8
  s_lshl_b32 s71, s71, 7
  s_add_u32 s88, s71, s70
  s_add_u32 s71, s86, 2097152
  s_mul_hi_u32 s71, s71, s90
  s_lshr_b32 s71, s71, 8
  s_lshl_b32 s71, s71, 7
  s_add_u32 s68, s71, s70
  s_add_u32 s71, s86, 4194304
  s_mul_hi_u32 s71, s71, s90
  s_lshr_b32 s71, s71, 8
  s_lshl_b32 s71, s71, 7
  s_add_u32 s69, s71, s70
  s_lshl_b32 s70, s3, 13
  s_add_u32 s86, s86, s70
  s_mov_b32 s74, 6291456
  s_mov_b32 s75, 0x20000
  s_mov_b32 s78, 2097152
  s_mov_b32 s79, 0x20000
  s_waitcnt lgkmcnt(0)
  s_cmp_eq_u32 s4, 0
  s_cselect_b64 s[72:73], s[50:51], s[52:53]
  s_cselect_b64 s[76:77], s[54:55], s[56:57]
  s_and_b32 s73, s73, 0xffff
  s_and_b32 s77, s77, 0xffff
  buffer_load_dwordx4 v[128:131], v114, s[72:75], s86 offen offset:0
  buffer_load_dwordx4 v[128:131], v114, s[76:79], s88 offen offset:0
  buffer_load_dwordx4 v[128:131], v114, s[72:75], s86 offen offset:1024
  buffer_load_dwordx4 v[128:131], v114, s[76:79], s88 offen offset:1024
  buffer_load_dwordx4 v[128:131], v114, s[72:75], s86 offen offset:2048
  buffer_load_dwordx4 v[128:131], v114, s[76:79], s88 offen offset:2048
  buffer_load_dwordx4 v[128:131], v114, s[72:75], s86 offen offset:3072
  buffer_load_dwordx4 v[128:131], v114, s[76:79], s68 offen offset:0
  s_mov_b32 s20, s50
  s_and_b32 s21, s51, 0xffff
  s_mov_b32 s24, s52
  s_and_b32 s25, s53, 0xffff
  s_mov_b32 s28, s54
  s_and_b32 s29, s55, 0xffff
  s_mov_b32 s32, s56
  s_and_b32 s33, s57, 0xffff
  s_mov_b32 s8, s46
  s_and_b32 s9, s47, 0xffff
  s_mov_b32 s36, s44
  s_and_b32 s37, s45, 0xffff
  s_mov_b32 s16, s46
  s_and_b32 s17, s47, 0xffff
  s_mov_b32 s12, s48
  s_and_b32 s13, s49, 0xffff
  s_mov_b32 s40, s82
  s_and_b32 s41, s83, 0xffff
  s_mov_b64 s[46:47], s[58:59]
  s_mov_b32 s56, 0x0f0f0f0f
  s_mov_b32 s57, 0x0f0f0f0f
  s_mov_b32 s58, 0xffff
  s_mov_b32 s59, 0xffff
  s_lshr_b32 s71, s64, 4
  s_andn2_b32 s71, s71, 1
  s_lshr_b32 s71, 0x12, s71
  s_and_b32 s71, s71, 3
  s_lshr_b32 s85, s96, s71
  s_andn2_b32 s70, s64, 1
  s_or_b32 s70, s70, s4
  s_cmp_lt_u32 s64, 8
  s_cselect_b32 s70, s70, s64
  s_cselect_b32 s85, s64, s85
  s_and_b32 s85, s85, 1
  s_and_b32 s70, s70, 31
  s_lshl_b32 s71, s71, 12
  s_add_u32 s70, s70, s5
  s_add_u32 s70, s70, s71
  s_mul_hi_u32 s84, s70, s90
  s_lshr_b32 s84, s84, 1
  s_mul_i32 s71, s84, 3
  s_sub_u32 s70, s70, s71
  s_lshl3_add_u32 s85, s70, s85
  s_mul_i32 s61, s84, 196608
  s_lshr_b32 s89, s84, 4
  s_lshl_b32 s70, s85, 5
  v_add_u32 v97, s70, v230
  v_mul_u32_u24 v97, 21846, v97
  v_lshrrev_b32 v97, 16, v97
  v_add_u32 v144, s85, v231
  v_lshrrev_b32 v145, v144, s91
  v_and_b32 v145, 1, v145
  v_cmp_eq_u32 s[54:55], 1, v145
  s_nop 1
  s_and_b64 s[52:53], s[54:55], s[56:57]
  s_andn2_b64 s[54:55], s[54:55], s[56:57]
  v_mul_u32_u24 v144, 43, v144
  v_lshrrev_b32 v144, 8, v144
  v_mul_u32_u24 v144, 384, v144
  v_add_u32 v234, v144, v233
  v_mad_u32_u24 v92, v97, s63, v232
  v_add_u32 v93, 768, v92
  v_add_u32 v94, 4608, v92
  v_add_u32 v95, 7680, v92
  v_cndmask_b32 v92, v92, v105, s[52:53]
  v_cndmask_b32 v95, v95, v105, s[54:55]
  s_mov_b32 s60, s61
  s_mul_i32 s70, s89, 1536
  buffer_load_dwordx2 v[174:175], v235, s[36:39], s70 offen offset:0
  buffer_load_dwordx2 v[176:177], v235, s[36:39], s70 offen offset:128
  buffer_load_dwordx2 v[178:179], v235, s[36:39], s70 offen offset:256
  buffer_load_dwordx4 v[4:7], v92, s[8:11], s60 offen offset:0 nt
  s_add_u32 s86, s86, 4096
  buffer_load_dwordx4 v[128:131], v114, s[72:75], s86 offen offset:0
  buffer_load_dwordx4 v[128:131], v114, s[76:79], s68 offen offset:1024
  buffer_load_dwordx4 v[128:131], v114, s[72:75], s86 offen offset:1024
  buffer_load_dwordx4 v[128:131], v114, s[76:79], s68 offen offset:2048
  buffer_load_dwordx4 v[128:131], v114, s[72:75], s86 offen offset:2048
  buffer_load_dwordx4 v[128:131], v114, s[76:79], s69 offen offset:0
  buffer_load_dwordx4 v[128:131], v114, s[72:75], s86 offen offset:3072
  buffer_load_dwordx4 v[128:131], v114, s[76:79], s69 offen offset:1024
  s_add_u32 s86, s86, 2093056
  buffer_load_dwordx4 v[128:131], v114, s[72:75], s86 offen offset:0
  buffer_load_dwordx4 v[128:131], v114, s[76:79], s69 offen offset:2048
  buffer_load_dwordx4 v[128:131], v114, s[72:75], s86 offen offset:1024
  buffer_load_dwordx4 v[128:131], v114, s[72:75], s86 offen offset:2048
  buffer_load_dwordx4 v[128:131], v114, s[72:75], s86 offen offset:3072
  s_add_u32 s86, s86, 4096
  buffer_load_dwordx4 v[128:131], v114, s[72:75], s86 offen offset:0
  buffer_load_dwordx4 v[128:131], v114, s[72:75], s86 offen offset:1024
  buffer_load_dwordx4 v[128:131], v114, s[72:75], s86 offen offset:2048
  s_barrier
  s_mov_b64 vcc, 0
  v_lshlrev_b32 v144, 4, v111
  v_and_b32 v2, 2, v110
  v_lshlrev_b32 v1, 5, v2
  v_add_u32 v1, 129, v1
  v_and_b32 v145, 1, v110
  v_lshl_add_u32 v2, v145, 2, v2
  v_mul_u32_u24 v145, 33024, v145
  v_add_u32 v3, v144, v145
  v_subrev_u32 v3, 33024, v3
  v_and_b32 v145, 1, v110
  v_mul_u32_u24 v145, 86, v145
  v_lshl_add_u32 v96, v111, 1, v145
  v_subrev_u32 v96, 86, v96
  v_lshlrev_b32 v101, 4, v110
  v_lshrrev_b32 v144, 2, v0
  s_mul_i32 s70, s3, 384
  v_lshl_add_u32 v99, v144, 4, s70
  v_lshl_add_u32 v100, v144, 3, s70
  s_mul_i32 s70, s3, 3072
  s_add_u32 s70, s70, 36864
  v_lshl_add_u32 v102, v0, 4, s70
  s_lshl_b32 s70, s3, 5
  s_add_u32 s70, s70, 43008
  v_lshl_add_u32 v103, v109, 3, s70
  s_lshl2_add_u32 s70, s3, 61712
  v_mov_b32 v104, s70
  v_mov_b32 v112, 0
  v_mov_b32 v113, 0
  v_mov_b32 v236, 0xff800000
  v_mov_b32 v146, 1
  s_mov_b32 s65, 0xffff0000
  s_mov_b32 s66, 0x3fb8aa3b
  s_waitcnt vmcnt(23)
  buffer_load_dwordx4 v[128:131], v114, s[72:75], s86 offen offset:3072
  s_add_u32 s86, s86, 2093056
  s_waitcnt vmcnt(23)
  buffer_load_dwordx4 v[128:131], v114, s[72:75], s86 offen offset:0
  s_waitcnt vmcnt(23)
  buffer_load_dwordx4 v[128:131], v114, s[72:75], s86 offen offset:1024
  s_waitcnt vmcnt(23)
  buffer_load_dwordx4 v[128:131], v114, s[72:75], s86 offen offset:2048
  s_waitcnt vmcnt(23)
  buffer_load_dwordx4 v[128:131], v114, s[72:75], s86 offen offset:3072
  s_add_u32 s86, s86, 4096
  s_waitcnt vmcnt(23)
  buffer_load_dwordx4 v[128:131], v114, s[72:75], s86 offen offset:0
  s_waitcnt vmcnt(23)
  buffer_load_dwordx4 v[128:131], v114, s[72:75], s86 offen offset:1024
  s_waitcnt vmcnt(23)
  buffer_load_dwordx4 v[128:131], v114, s[72:75], s86 offen offset:2048
  s_waitcnt vmcnt(23)
  buffer_load_dwordx4 v[128:131], v114, s[72:75], s86 offen offset:3072
  s_mov_b32 s68, 0x3d93cd3a
  s_mov_b32 s69, 0x3d93cd3a
  s_mov_b32 s72, 0x11111111
  s_mov_b32 s73, 0x11111111
  s_mov_b32 s74, 0x22222222
  s_mov_b32 s75, 0x22222222
  s_mov_b32 s76, 0x44444444
  s_mov_b32 s77, 0x44444444
  s_mov_b32 s78, 0x88888888
  s_mov_b32 s79, 0x88888888
  ds_write_b32 v104, v146
  s_mov_b32 s88, s89
  s_mul_i32 s62, s84, 1536
  buffer_load_dwordx2 v[180:181], v234, s[20:23], s62 offen offset:0
  buffer_load_dwordx2 v[186:187], v234, s[24:27], s62 offen offset:0
  buffer_load_dwordx2 v[182:183], v234, s[20:23], s62 offen offset:128
  buffer_load_dwordx2 v[188:189], v234, s[24:27], s62 offen offset:128
  buffer_load_dwordx2 v[184:185], v234, s[20:23], s62 offen offset:256
  buffer_load_dwordx2 v[190:191], v234, s[24:27], s62 offen offset:256
  s_waitcnt vmcnt(15)
  buffer_load_dwordx4 v[8:11], v92, s[8:11], s60 offen offset:256 nt
  s_waitcnt vmcnt(15)
  buffer_load_dwordx4 v[12:15], v92, s[8:11], s60 offen offset:512 nt
  s_waitcnt vmcnt(15)
  buffer_load_dwordx4 v[16:19], v93, s[8:11], s60 offen offset:0 nt
  s_waitcnt vmcnt(15)
  buffer_load_dwordx4 v[20:23], v93, s[8:11], s60 offen offset:256 nt
  s_waitcnt vmcnt(15)
  buffer_load_dwordx4 v[24:27], v93, s[8:11], s60 offen offset:512 nt
  s_waitcnt vmcnt(15)
  buffer_load_dwordx4 v[28:31], v93, s[8:11], s60 offen offset:768 nt
  s_waitcnt vmcnt(15)
  buffer_load_dwordx4 v[32:35], v93, s[8:11], s60 offen offset:1024 nt
  s_waitcnt vmcnt(15)
  buffer_load_dwordx4 v[36:39], v93, s[8:11], s60 offen offset:1280 nt
  s_waitcnt vmcnt(15)
  buffer_load_dwordx4 v[40:43], v93, s[8:11], s60 offen offset:1536 nt
  s_waitcnt vmcnt(15)
  buffer_load_dwordx4 v[44:47], v93, s[8:11], s60 offen offset:1792 nt
  s_waitcnt vmcnt(16)
  buffer_load_dwordx4 v[48:51], v93, s[8:11], s60 offen offset:2048 nt
  s_waitcnt vmcnt(17)
  buffer_load_dwordx4 v[52:55], v93, s[8:11], s60 offen offset:2304 nt
  s_waitcnt vmcnt(18)
  buffer_load_dwordx4 v[56:59], v93, s[8:11], s60 offen offset:2560 nt
  s_waitcnt vmcnt(19)
  buffer_load_dwordx4 v[60:63], v93, s[8:11], s60 offen offset:2816 nt
  s_waitcnt vmcnt(14)
L_k:
  v_add_u32 v144, s85, v2
  v_lshrrev_b32 v145, v144, s91
  v_and_b32 v145, 1, v145
  v_cmp_eq_u32 s[50:51], 1, v145
  s_nop 1
  s_and_b64 s[48:49], s[50:51], s[58:59]
  s_andn2_b64 s[50:51], s[50:51], s[58:59]
  s_mov_b32 s97, s64
  s_add_u32 s64, s64, 2
  ds_read_b32 v106, v104 offset:8
  s_waitcnt vmcnt(14)
  s_cbranch_vccnz L_kw0_0
  s_waitcnt vmcnt(9)
L_kw0_0:
  buffer_load_dwordx4 v[64:67], v93, s[8:11], s60 offen offset:3072 nt
  v_lshlrev_b32 v204, 16, v186
  v_and_b32 v205, s65, v186
  v_lshlrev_b32 v206, 16, v187
  v_and_b32 v207, s65, v187
  v_lshlrev_b32 v192, 16, v180
  v_and_b32 v193, s65, v180
  v_lshlrev_b32 v194, 16, v181
  v_and_b32 v195, s65, v181
  v_mov_b32 v168, v174
  v_mov_b32 v169, v175
  v_cvt_f32_i32 v108, v4
  v_cvt_f32_i32 v109, v5
  v_cvt_f32_i32 v110, v6
  v_cvt_f32_i32 v111, v7
  v_pk_add_f32 v[108:109], v[108:109], v[204:205] neg_lo:[0,1] neg_hi:[0,1]
  v_pk_add_f32 v[110:111], v[110:111], v[206:207] neg_lo:[0,1] neg_hi:[0,1]
  v_cvt_pk_bf16_f32 v108, 0, v108
  v_cvt_pk_bf16_f32 v109, 0, v109
  v_cvt_pk_bf16_f32 v110, 0, v110
  v_cvt_pk_bf16_f32 v111, 0, v111
  v_pk_mul_f32 v[108:109], v[108:109], v[192:193]
  v_pk_mul_f32 v[110:111], v[110:111], v[194:195]
  v_cvt_pk_bf16_f32 v216, v108, v109
  v_cvt_pk_bf16_f32 v217, v110, v111
  s_waitcnt lgkmcnt(0)
  v_cmp_lt_u32 vcc, s97, v106
  s_waitcnt vmcnt(14)
  buffer_load_dwordx4 v[68:71], v93, s[8:11], s60 offen offset:3328 nt
  v_lshlrev_b32 v208, 16, v188
  v_and_b32 v209, s65, v188
  v_lshlrev_b32 v210, 16, v189
  v_and_b32 v211, s65, v189
  v_lshlrev_b32 v196, 16, v182
  v_and_b32 v197, s65, v182
  v_lshlrev_b32 v198, 16, v183
  v_and_b32 v199, s65, v183
  v_mov_b32 v170, v176
  v_mov_b32 v171, v177
  v_cvt_f32_i32 v108, v8
  v_cvt_f32_i32 v109, v9
  v_cvt_f32_i32 v110, v10
  v_cvt_f32_i32 v111, v11
  v_pk_add_f32 v[108:109], v[108:109], v[208:209] neg_lo:[0,1] neg_hi:[0,1]
  v_pk_add_f32 v[110:111], v[110:111], v[210:211] neg_lo:[0,1] neg_hi:[0,1]
  v_cvt_pk_bf16_f32 v108, 0, v108
  v_cvt_pk_bf16_f32 v109, 0, v109
  v_cvt_pk_bf16_f32 v110, 0, v110
  v_cvt_pk_bf16_f32 v111, 0, v111
  v_pk_mul_f32 v[108:109], v[108:109], v[196:197]
  v_pk_mul_f32 v[110:111], v[110:111], v[198:199]
  v_cvt_pk_bf16_f32 v218, v108, v109
  v_cvt_pk_bf16_f32 v219, v110, v111
  s_waitcnt vmcnt(14)
  buffer_load_dwordx4 v[72:75], v93, s[8:11], s60 offen offset:3584 nt
  v_mfma_f32_16x16x32_bf16 v[224:227], v[216:219], v[168:171], 0
  v_lshlrev_b32 v212, 16, v190
  v_and_b32 v213, s65, v190
  v_lshlrev_b32 v214, 16, v191
  v_and_b32 v215, s65, v191
  v_lshlrev_b32 v200, 16, v184
  v_and_b32 v201, s65, v184
  v_lshlrev_b32 v202, 16, v185
  v_and_b32 v203, s65, v185
  v_mov_b32 v172, v178
  v_mov_b32 v173, v179
  v_cvt_f32_i32 v108, v12
  v_cvt_f32_i32 v109, v13
  v_cvt_f32_i32 v110, v14
  v_cvt_f32_i32 v111, v15
  v_pk_add_f32 v[108:109], v[108:109], v[212:213] neg_lo:[0,1] neg_hi:[0,1]
  v_pk_add_f32 v[110:111], v[110:111], v[214:215] neg_lo:[0,1] neg_hi:[0,1]
  v_cvt_pk_bf16_f32 v108, 0, v108
  v_cvt_pk_bf16_f32 v109, 0, v109
  v_cvt_pk_bf16_f32 v110, 0, v110
  v_cvt_pk_bf16_f32 v111, 0, v111
  v_pk_mul_f32 v[108:109], v[108:109], v[200:201]
  v_pk_mul_f32 v[110:111], v[110:111], v[202:203]
  v_cvt_pk_bf16_f32 v220, v108, v109
  v_cvt_pk_bf16_f32 v221, v110, v111
  s_waitcnt vmcnt(14)
  s_cbranch_vccnz L_kw0_3
  s_waitcnt vmcnt(9)
L_kw0_3:
  buffer_load_dwordx4 v[76:79], v94, s[8:11], s60 offen offset:0 nt
  v_mfma_f32_16x16x16_bf16 v[224:227], v[220:221], v[172:173], v[224:227]
  v_cvt_f32_i32 v108, v16
  v_cvt_f32_i32 v109, v17
  v_cvt_f32_i32 v110, v18
  v_cvt_f32_i32 v111, v19
  v_pk_add_f32 v[108:109], v[108:109], v[204:205] neg_lo:[0,1] neg_hi:[0,1]
  v_pk_add_f32 v[110:111], v[110:111], v[206:207] neg_lo:[0,1] neg_hi:[0,1]
  v_cvt_pk_bf16_f32 v108, 0, v108
  v_cvt_pk_bf16_f32 v109, 0, v109
  v_cvt_pk_bf16_f32 v110, 0, v110
  v_cvt_pk_bf16_f32 v111, 0, v111
  v_pk_mul_f32 v[108:109], v[108:109], v[192:193]
  v_pk_mul_f32 v[110:111], v[110:111], v[194:195]
  v_cvt_pk_bf16_f32 v216, v108, v109
  v_cvt_pk_bf16_f32 v217, v110, v111
  s_waitcnt vmcnt(14)
  buffer_load_dwordx4 v[80:83], v94, s[8:11], s60 offen offset:256 nt
  v_cvt_f32_i32 v108, v20
  v_cvt_f32_i32 v109, v21
  v_cvt_f32_i32 v110, v22
  v_cvt_f32_i32 v111, v23
  v_pk_add_f32 v[108:109], v[108:109], v[208:209] neg_lo:[0,1] neg_hi:[0,1]
  v_pk_add_f32 v[110:111], v[110:111], v[210:211] neg_lo:[0,1] neg_hi:[0,1]
  v_mov_b32_dpp v144, v224 quad_perm:[0,0,0,0] row_mask:0xf bank_mask:0xf
  v_mov_b32_dpp v145, v226 quad_perm:[2,2,2,2] row_mask:0xf bank_mask:0xf
  v_cvt_pk_bf16_f32 v108, 0, v108
  v_cvt_pk_bf16_f32 v109, 0, v109
  v_add_f32_dpp v144, v225, v144 quad_perm:[1,1,1,1] row_mask:0xf bank_mask:0xf
  v_add_f32_dpp v145, v227, v145 quad_perm:[3,3,3,3] row_mask:0xf bank_mask:0xf
  v_cvt_pk_bf16_f32 v110, 0, v110
  v_cvt_pk_bf16_f32 v111, 0, v111
  v_add_f32 v228, v144, v145
  v_pk_mul_f32 v[108:109], v[108:109], v[196:197]
  v_pk_mul_f32 v[110:111], v[110:111], v[198:199]
  v_cvt_pk_bf16_f32 v218, v108, v109
  v_cvt_pk_bf16_f32 v219, v110, v111
  s_waitcnt vmcnt(14)
  buffer_load_dwordx4 v[84:87], v94, s[8:11], s60 offen offset:512 nt
  v_mfma_f32_16x16x32_bf16 v[224:227], v[216:219], v[168:171], 0
  v_cvt_f32_i32 v108, v24
  v_cvt_f32_i32 v109, v25
  v_cvt_f32_i32 v110, v26
  v_cvt_f32_i32 v111, v27
  v_pk_add_f32 v[108:109], v[108:109], v[212:213] neg_lo:[0,1] neg_hi:[0,1]
  v_pk_add_f32 v[110:111], v[110:111], v[214:215] neg_lo:[0,1] neg_hi:[0,1]
  v_cvt_pk_bf16_f32 v108, 0, v108
  v_cndmask_b32 v228, v228, v236, s[48:49]
  v_cvt_pk_bf16_f32 v109, 0, v109
  v_cvt_pk_bf16_f32 v110, 0, v110
  v_cvt_pk_bf16_f32 v111, 0, v111
  v_pk_mul_f32 v[108:109], v[108:109], v[200:201]
  v_pk_mul_f32 v[110:111], v[110:111], v[202:203]
  v_cvt_pk_bf16_f32 v220, v108, v109
  v_cvt_pk_bf16_f32 v221, v110, v111
  s_waitcnt vmcnt(14)
  s_cbranch_vccnz L_kw0_6
  s_waitcnt vmcnt(9)
L_kw0_6:
  buffer_load_dwordx4 v[88:91], v94, s[8:11], s60 offen offset:768 nt
  v_mfma_f32_16x16x16_bf16 v[224:227], v[220:221], v[172:173], v[224:227]
  v_cvt_f32_i32 v108, v28
  v_cvt_f32_i32 v109, v29
  v_cvt_f32_i32 v110, v30
  v_cvt_f32_i32 v111, v31
  v_pk_add_f32 v[108:109], v[108:109], v[204:205] neg_lo:[0,1] neg_hi:[0,1]
  v_pk_add_f32 v[110:111], v[110:111], v[206:207] neg_lo:[0,1] neg_hi:[0,1]
  v_cvt_pk_bf16_f32 v108, 0, v108
  v_cvt_pk_bf16_f32 v109, 0, v109
  v_cvt_pk_bf16_f32 v110, 0, v110
  v_cvt_pk_bf16_f32 v111, 0, v111
  v_pk_mul_f32 v[108:109], v[108:109], v[192:193]
  v_pk_mul_f32 v[110:111], v[110:111], v[194:195]
  v_cvt_pk_bf16_f32 v216, v108, v109
  v_cvt_pk_bf16_f32 v217, v110, v111
  s_waitcnt vmcnt(14)
  buffer_load_dwordx4 v[4:7], v94, s[8:11], s60 offen offset:1024 nt
  v_cvt_f32_i32 v108, v32
  v_cvt_f32_i32 v109, v33
  v_cvt_f32_i32 v110, v34
  v_cvt_f32_i32 v111, v35
  v_pk_add_f32 v[108:109], v[108:109], v[208:209] neg_lo:[0,1] neg_hi:[0,1]
  v_pk_add_f32 v[110:111], v[110:111], v[210:211] neg_lo:[0,1] neg_hi:[0,1]
  v_mov_b32_dpp v144, v224 quad_perm:[0,0,0,0] row_mask:0xf bank_mask:0xf
  v_mov_b32_dpp v145, v226 quad_perm:[2,2,2,2] row_mask:0xf bank_mask:0xf
  v_cvt_pk_bf16_f32 v108, 0, v108
  v_cvt_pk_bf16_f32 v109, 0, v109
  v_add_f32_dpp v144, v225, v144 quad_perm:[1,1,1,1] row_mask:0xf bank_mask:0xf
  v_add_f32_dpp v145, v227, v145 quad_perm:[3,3,3,3] row_mask:0xf bank_mask:0xf
  v_cvt_pk_bf16_f32 v110, 0, v110
  v_cvt_pk_bf16_f32 v111, 0, v111
  v_add_f32 v229, v144, v145
  v_pk_mul_f32 v[108:109], v[108:109], v[196:197]
  v_pk_mul_f32 v[110:111], v[110:111], v[198:199]
  v_cvt_pk_bf16_f32 v218, v108, v109
  v_cvt_pk_bf16_f32 v219, v110, v111
  s_waitcnt vmcnt(14)
  buffer_load_dwordx4 v[8:11], v94, s[8:11], s60 offen offset:1280 nt
  v_mfma_f32_16x16x32_bf16 v[224:227], v[216:219], v[168:171], 0
  v_cvt_f32_i32 v108, v36
  v_cvt_f32_i32 v109, v37
  v_cvt_f32_i32 v110, v38
  v_cvt_f32_i32 v111, v39
  v_pk_add_f32 v[108:109], v[108:109], v[212:213] neg_lo:[0,1] neg_hi:[0,1]
  v_pk_add_f32 v[110:111], v[110:111], v[214:215] neg_lo:[0,1] neg_hi:[0,1]
  v_cvt_pk_bf16_f32 v108, 0, v108
  v_cvt_pk_bf16_f32 v228, 0, v228
  v_cvt_pk_bf16_f32 v109, 0, v109
  v_cvt_pk_bf16_f32 v229, 0, v229
  v_cvt_pk_bf16_f32 v110, 0, v110
  v_pk_mul_f32 v[228:229], v[228:229], s[68:69]
  v_cvt_pk_bf16_f32 v111, 0, v111
  v_cvt_pk_bf16_f32 v120, v228, v229
  v_pk_mul_f32 v[108:109], v[108:109], v[200:201]
  v_pk_mul_f32 v[110:111], v[110:111], v[202:203]
  v_cvt_pk_bf16_f32 v220, v108, v109
  v_cvt_pk_bf16_f32 v221, v110, v111
  s_waitcnt vmcnt(14)
  s_cbranch_vccnz L_kw0_9
  s_waitcnt vmcnt(9)
L_kw0_9:
  buffer_load_dwordx4 v[12:15], v94, s[8:11], s60 offen offset:1536 nt
  v_mfma_f32_16x16x16_bf16 v[224:227], v[220:221], v[172:173], v[224:227]
  v_cvt_f32_i32 v108, v40
  v_cvt_f32_i32 v109, v41
  v_cvt_f32_i32 v110, v42
  v_cvt_f32_i32 v111, v43
  v_pk_add_f32 v[108:109], v[108:109], v[204:205] neg_lo:[0,1] neg_hi:[0,1]
  v_pk_add_f32 v[110:111], v[110:111], v[206:207] neg_lo:[0,1] neg_hi:[0,1]
  v_cvt_pk_bf16_f32 v108, 0, v108
  v_cvt_pk_bf16_f32 v109, 0, v109
  v_cvt_pk_bf16_f32 v110, 0, v110
  v_cvt_pk_bf16_f32 v111, 0, v111
  v_pk_mul_f32 v[108:109], v[108:109], v[192:193]
  v_pk_mul_f32 v[110:111], v[110:111], v[194:195]
  v_cvt_pk_bf16_f32 v216, v108, v109
  v_cvt_pk_bf16_f32 v217, v110, v111
  s_waitcnt vmcnt(14)
  buffer_load_dwordx4 v[16:19], v94, s[8:11], s60 offen offset:1792 nt
  v_cvt_f32_i32 v108, v44
  v_cvt_f32_i32 v109, v45
  v_cvt_f32_i32 v110, v46
  v_cvt_f32_i32 v111, v47
  v_pk_add_f32 v[108:109], v[108:109], v[208:209] neg_lo:[0,1] neg_hi:[0,1]
  v_pk_add_f32 v[110:111], v[110:111], v[210:211] neg_lo:[0,1] neg_hi:[0,1]
  v_mov_b32_dpp v144, v224 quad_perm:[0,0,0,0] row_mask:0xf bank_mask:0xf
  v_mov_b32_dpp v145, v226 quad_perm:[2,2,2,2] row_mask:0xf bank_mask:0xf
  v_cvt_pk_bf16_f32 v108, 0, v108
  v_cvt_pk_bf16_f32 v109, 0, v109
  v_add_f32_dpp v144, v225, v144 quad_perm:[1,1,1,1] row_mask:0xf bank_mask:0xf
  v_add_f32_dpp v145, v227, v145 quad_perm:[3,3,3,3] row_mask:0xf bank_mask:0xf
  v_cvt_pk_bf16_f32 v110, 0, v110
  v_cvt_pk_bf16_f32 v111, 0, v111
  v_add_f32 v228, v144, v145
  v_pk_mul_f32 v[108:109], v[108:109], v[196:197]
  v_pk_mul_f32 v[110:111], v[110:111], v[198:199]
  v_cvt_pk_bf16_f32 v218, v108, v109
  v_cvt_pk_bf16_f32 v219, v110, v111
  s_waitcnt vmcnt(14)
  buffer_load_dwordx4 v[20:23], v94, s[8:11], s60 offen offset:2048 nt
  v_mfma_f32_16x16x32_bf16 v[224:227], v[216:219], v[168:171], 0
  v_cvt_f32_i32 v108, v48
  v_cvt_f32_i32 v109, v49
  v_cvt_f32_i32 v110, v50
  v_cvt_f32_i32 v111, v51
  v_pk_add_f32 v[108:109], v[108:109], v[212:213] neg_lo:[0,1] neg_hi:[0,1]
  v_pk_add_f32 v[110:111], v[110:111], v[214:215] neg_lo:[0,1] neg_hi:[0,1]
  v_cvt_pk_bf16_f32 v108, 0, v108
  v_cvt_pk_bf16_f32 v109, 0, v109
  v_cvt_pk_bf16_f32 v110, 0, v110
  v_cvt_pk_bf16_f32 v111, 0, v111
  v_pk_mul_f32 v[108:109], v[108:109], v[200:201]
  v_pk_mul_f32 v[110:111], v[110:111], v[202:203]
  v_cvt_pk_bf16_f32 v220, v108, v109
  v_cvt_pk_bf16_f32 v221, v110, v111
  s_waitcnt vmcnt(14)
  s_cbranch_vccnz L_kw0_12
  s_waitcnt vmcnt(9)
L_kw0_12:
  buffer_load_dwordx4 v[24:27], v94, s[8:11], s60 offen offset:2304 nt
  v_mfma_f32_16x16x16_bf16 v[224:227], v[220:221], v[172:173], v[224:227]
  v_cvt_f32_i32 v108, v52
  v_cvt_f32_i32 v109, v53
  v_cvt_f32_i32 v110, v54
  v_cvt_f32_i32 v111, v55
  v_pk_add_f32 v[108:109], v[108:109], v[204:205] neg_lo:[0,1] neg_hi:[0,1]
  v_pk_add_f32 v[110:111], v[110:111], v[206:207] neg_lo:[0,1] neg_hi:[0,1]
  v_cvt_pk_bf16_f32 v108, 0, v108
  v_cvt_pk_bf16_f32 v109, 0, v109
  v_cvt_pk_bf16_f32 v110, 0, v110
  v_cvt_pk_bf16_f32 v111, 0, v111
  v_pk_mul_f32 v[108:109], v[108:109], v[192:193]
  v_pk_mul_f32 v[110:111], v[110:111], v[194:195]
  v_cvt_pk_bf16_f32 v216, v108, v109
  v_cvt_pk_bf16_f32 v217, v110, v111
  s_waitcnt vmcnt(14)
  buffer_load_dwordx4 v[28:31], v94, s[8:11], s60 offen offset:2560 nt
  v_cvt_f32_i32 v108, v56
  v_cvt_f32_i32 v109, v57
  v_cvt_f32_i32 v110, v58
  v_cvt_f32_i32 v111, v59
  v_pk_add_f32 v[108:109], v[108:109], v[208:209] neg_lo:[0,1] neg_hi:[0,1]
  v_pk_add_f32 v[110:111], v[110:111], v[210:211] neg_lo:[0,1] neg_hi:[0,1]
  v_mov_b32_dpp v144, v224 quad_perm:[0,0,0,0] row_mask:0xf bank_mask:0xf
  v_mov_b32_dpp v145, v226 quad_perm:[2,2,2,2] row_mask:0xf bank_mask:0xf
  v_cvt_pk_bf16_f32 v108, 0, v108
  v_cvt_pk_bf16_f32 v109, 0, v109
  v_add_f32_dpp v144, v225, v144 quad_perm:[1,1,1,1] row_mask:0xf bank_mask:0xf
  v_add_f32_dpp v145, v227, v145 quad_perm:[3,3,3,3] row_mask:0xf bank_mask:0xf
  v_cvt_pk_bf16_f32 v110, 0, v110
  v_cvt_pk_bf16_f32 v111, 0, v111
  v_add_f32 v229, v144, v145
  v_pk_mul_f32 v[108:109], v[108:109], v[196:197]
  v_pk_mul_f32 v[110:111], v[110:111], v[198:199]
  v_cvt_pk_bf16_f32 v218, v108, v109
  v_cvt_pk_bf16_f32 v219, v110, v111
  s_waitcnt vmcnt(14)
  buffer_load_dwordx4 v[32:35], v94, s[8:11], s60 offen offset:2816 nt
  v_mfma_f32_16x16x32_bf16 v[224:227], v[216:219], v[168:171], 0
  v_cvt_f32_i32 v108, v60
  v_cvt_f32_i32 v109, v61
  v_cvt_f32_i32 v110, v62
  v_cvt_f32_i32 v111, v63
  v_pk_add_f32 v[108:109], v[108:109], v[212:213] neg_lo:[0,1] neg_hi:[0,1]
  v_pk_add_f32 v[110:111], v[110:111], v[214:215] neg_lo:[0,1] neg_hi:[0,1]
  v_cvt_pk_bf16_f32 v108, 0, v108
  v_cvt_pk_bf16_f32 v228, 0, v228
  v_cvt_pk_bf16_f32 v109, 0, v109
  v_cvt_pk_bf16_f32 v229, 0, v229
  v_cvt_pk_bf16_f32 v110, 0, v110
  v_pk_mul_f32 v[228:229], v[228:229], s[68:69]
  v_cvt_pk_bf16_f32 v111, 0, v111
  v_cvt_pk_bf16_f32 v121, v228, v229
  v_pk_mul_f32 v[108:109], v[108:109], v[200:201]
  v_pk_mul_f32 v[110:111], v[110:111], v[202:203]
  v_cvt_pk_bf16_f32 v220, v108, v109
  v_cvt_pk_bf16_f32 v221, v110, v111
  s_waitcnt vmcnt(14)
  s_cbranch_vccnz L_kw0_15
  s_waitcnt vmcnt(9)
L_kw0_15:
  buffer_load_dwordx4 v[36:39], v95, s[8:11], s60 offen offset:0 nt
  v_mfma_f32_16x16x16_bf16 v[224:227], v[220:221], v[172:173], v[224:227]
  v_cvt_f32_i32 v108, v64
  v_cvt_f32_i32 v109, v65
  v_cvt_f32_i32 v110, v66
  v_cvt_f32_i32 v111, v67
  v_pk_add_f32 v[108:109], v[108:109], v[204:205] neg_lo:[0,1] neg_hi:[0,1]
  v_pk_add_f32 v[110:111], v[110:111], v[206:207] neg_lo:[0,1] neg_hi:[0,1]
  v_cvt_pk_bf16_f32 v108, 0, v108
  v_cvt_pk_bf16_f32 v109, 0, v109
  v_cvt_pk_bf16_f32 v110, 0, v110
  v_cvt_pk_bf16_f32 v111, 0, v111
  v_pk_mul_f32 v[108:109], v[108:109], v[192:193]
  v_pk_mul_f32 v[110:111], v[110:111], v[194:195]
  v_cvt_pk_bf16_f32 v216, v108, v109
  v_cvt_pk_bf16_f32 v217, v110, v111
  s_waitcnt vmcnt(14)
  buffer_load_dwordx4 v[40:43], v95, s[8:11], s60 offen offset:256 nt
  v_cvt_f32_i32 v108, v68
  v_cvt_f32_i32 v109, v69
  v_cvt_f32_i32 v110, v70
  v_cvt_f32_i32 v111, v71
  v_pk_add_f32 v[108:109], v[108:109], v[208:209] neg_lo:[0,1] neg_hi:[0,1]
  v_pk_add_f32 v[110:111], v[110:111], v[210:211] neg_lo:[0,1] neg_hi:[0,1]
  v_mov_b32_dpp v144, v224 quad_perm:[0,0,0,0] row_mask:0xf bank_mask:0xf
  v_mov_b32_dpp v145, v226 quad_perm:[2,2,2,2] row_mask:0xf bank_mask:0xf
  v_cvt_pk_bf16_f32 v108, 0, v108
  v_cvt_pk_bf16_f32 v109, 0, v109
  v_add_f32_dpp v144, v225, v144 quad_perm:[1,1,1,1] row_mask:0xf bank_mask:0xf
  v_add_f32_dpp v145, v227, v145 quad_perm:[3,3,3,3] row_mask:0xf bank_mask:0xf
  v_cvt_pk_bf16_f32 v110, 0, v110
  v_cvt_pk_bf16_f32 v111, 0, v111
  v_add_f32 v228, v144, v145
  v_pk_mul_f32 v[108:109], v[108:109], v[196:197]
  v_pk_mul_f32 v[110:111], v[110:111], v[198:199]
  v_cvt_pk_bf16_f32 v218, v108, v109
  v_cvt_pk_bf16_f32 v219, v110, v111
  s_waitcnt vmcnt(14)
  buffer_load_dwordx4 v[44:47], v95, s[8:11], s60 offen offset:512 nt
  v_mfma_f32_16x16x32_bf16 v[224:227], v[216:219], v[168:171], 0
  v_cvt_f32_i32 v108, v72
  v_cvt_f32_i32 v109, v73
  v_cvt_f32_i32 v110, v74
  v_cvt_f32_i32 v111, v75
  v_pk_add_f32 v[108:109], v[108:109], v[212:213] neg_lo:[0,1] neg_hi:[0,1]
  v_pk_add_f32 v[110:111], v[110:111], v[214:215] neg_lo:[0,1] neg_hi:[0,1]
  s_cmp_lt_u32 s64, s99
  s_cbranch_scc1 L_k_known0
L_k_spin0:
  v_mov_b32 v144, 61696
  ds_read_b32 v144, v144
  s_waitcnt lgkmcnt(0)
  v_readfirstlane_b32 s96, v144
  s_nop 1
  s_cmp_eq_u32 s96, 0
  s_cbranch_scc1 L_k_spin0
  s_mov_b32 s99, -1
L_k_known0:
  s_lshr_b32 s71, s64, 4
  s_andn2_b32 s71, s71, 1
  s_lshr_b32 s71, 0x12, s71
  s_and_b32 s71, s71, 3
  s_lshr_b32 s85, s96, s71
  s_andn2_b32 s70, s64, 1
  s_or_b32 s70, s70, s4
  s_cmp_lt_u32 s64, 8
  s_cselect_b32 s70, s70, s64
  s_cselect_b32 s85, s64, s85
  s_and_b32 s85, s85, 1
  s_and_b32 s70, s70, 31
  s_lshl_b32 s71, s71, 12
  s_add_u32 s70, s70, s5
  s_add_u32 s70, s70, s71
  s_mul_hi_u32 s84, s70, s90
  s_lshr_b32 s84, s84, 1
  s_mul_i32 s71, s84, 3
  s_sub_u32 s70, s70, s71
  s_lshl3_add_u32 s85, s70, s85
  s_mul_i32 s61, s84, 196608
  s_lshr_b32 s89, s84, 4
  s_lshl_b32 s70, s85, 5
  v_add_u32 v97, s70, v230
  v_mul_u32_u24 v97, 21846, v97
  v_lshrrev_b32 v97, 16, v97
  v_add_u32 v144, s85, v231
  v_lshrrev_b32 v145, v144, s91
  v_and_b32 v145, 1, v145
  v_cmp_eq_u32 s[54:55], 1, v145
  s_nop 1
  s_and_b64 s[52:53], s[54:55], s[56:57]
  s_andn2_b64 s[54:55], s[54:55], s[56:57]
  v_mul_u32_u24 v144, 43, v144
  v_lshrrev_b32 v144, 8, v144
  v_mul_u32_u24 v144, 384, v144
  v_add_u32 v234, v144, v233
  s_cmp_eq_u32 s89, s88
  s_cbranch_scc1 L_k_sameq0
  s_mul_i32 s70, s89, 1536
  buffer_load_dwordx2 v[174:175], v235, s[36:39], s70 offen offset:0
  buffer_load_dwordx2 v[176:177], v235, s[36:39], s70 offen offset:128
  buffer_load_dwordx2 v[178:179], v235, s[36:39], s70 offen offset:256
  s_mov_b32 s88, s89
L_k_sameq0:
  s_mul_i32 s62, s84, 1536
  buffer_load_dwordx2 v[180:181], v234, s[20:23], s62 offen offset:0
  buffer_load_dwordx2 v[186:187], v234, s[24:27], s62 offen offset:0
  buffer_load_dwordx2 v[182:183], v234, s[20:23], s62 offen offset:128
  buffer_load_dwordx2 v[188:189], v234, s[24:27], s62 offen offset:128
  buffer_load_dwordx2 v[184:185], v234, s[20:23], s62 offen offset:256
  buffer_load_dwordx2 v[190:191], v234, s[24:27], s62 offen offset:256
  v_cvt_pk_bf16_f32 v108, 0, v108
  v_cvt_pk_bf16_f32 v109, 0, v109
  v_cvt_pk_bf16_f32 v110, 0, v110
  v_cvt_pk_bf16_f32 v111, 0, v111
  v_pk_mul_f32 v[108:109], v[108:109], v[200:201]
  v_pk_mul_f32 v[110:111], v[110:111], v[202:203]
  v_cvt_pk_bf16_f32 v220, v108, v109
  v_cvt_pk_bf16_f32 v221, v110, v111
  v_mad_u32_u24 v92, v97, s63, v232
  v_add_u32 v93, 768, v92
  v_add_u32 v94, 4608, v92
  v_add_u32 v95, 7680, v92
  v_cndmask_b32 v92, v92, v105, s[52:53]
  v_cndmask_b32 v95, v95, v105, s[54:55]
  s_waitcnt vmcnt(20)
  s_cbranch_vccnz L_kw0_18
  s_waitcnt vmcnt(15)
L_kw0_18:
  buffer_load_dwordx4 v[48:51], v92, s[16:19], s61 offen offset:0 nt
  v_mfma_f32_16x16x16_bf16 v[224:227], v[220:221], v[172:173], v[224:227]
  v_cvt_f32_i32 v108, v76
  v_cvt_f32_i32 v109, v77
  v_cvt_f32_i32 v110, v78
  v_cvt_f32_i32 v111, v79
  v_pk_add_f32 v[108:109], v[108:109], v[204:205] neg_lo:[0,1] neg_hi:[0,1]
  v_pk_add_f32 v[110:111], v[110:111], v[206:207] neg_lo:[0,1] neg_hi:[0,1]
  v_cvt_pk_bf16_f32 v108, 0, v108
  v_cvt_pk_bf16_f32 v109, 0, v109
  v_cvt_pk_bf16_f32 v110, 0, v110
  v_cvt_pk_bf16_f32 v111, 0, v111
  v_pk_mul_f32 v[108:109], v[108:109], v[192:193]
  v_pk_mul_f32 v[110:111], v[110:111], v[194:195]
  v_cvt_pk_bf16_f32 v216, v108, v109
  v_cvt_pk_bf16_f32 v217, v110, v111
  s_waitcnt vmcnt(20)
  buffer_load_dwordx4 v[52:55], v92, s[16:19], s61 offen offset:256 nt
  v_cvt_f32_i32 v108, v80
  v_cvt_f32_i32 v109, v81
  v_cvt_f32_i32 v110, v82
  v_cvt_f32_i32 v111, v83
  v_pk_add_f32 v[108:109], v[108:109], v[208:209] neg_lo:[0,1] neg_hi:[0,1]
  v_pk_add_f32 v[110:111], v[110:111], v[210:211] neg_lo:[0,1] neg_hi:[0,1]
  v_mov_b32_dpp v144, v224 quad_perm:[0,0,0,0] row_mask:0xf bank_mask:0xf
  v_mov_b32_dpp v145, v226 quad_perm:[2,2,2,2] row_mask:0xf bank_mask:0xf
  v_cvt_pk_bf16_f32 v108, 0, v108
  v_cvt_pk_bf16_f32 v109, 0, v109
  v_add_f32_dpp v144, v225, v144 quad_perm:[1,1,1,1] row_mask:0xf bank_mask:0xf
  v_add_f32_dpp v145, v227, v145 quad_perm:[3,3,3,3] row_mask:0xf bank_mask:0xf
  v_cvt_pk_bf16_f32 v110, 0, v110
  v_cvt_pk_bf16_f32 v111, 0, v111
  v_add_f32 v229, v144, v145
  v_pk_mul_f32 v[108:109], v[108:109], v[196:197]
  v_pk_mul_f32 v[110:111], v[110:111], v[198:199]
  v_cvt_pk_bf16_f32 v218, v108, v109
  v_cvt_pk_bf16_f32 v219, v110, v111
  s_waitcnt vmcnt(20)
  buffer_load_dwordx4 v[56:59], v92, s[16:19], s61 offen offset:512 nt
  v_mfma_f32_16x16x32_bf16 v[224:227], v[216:219], v[168:171], 0
  v_cvt_f32_i32 v108, v84
  v_cvt_f32_i32 v109, v85
  v_cvt_f32_i32 v110, v86
  v_cvt_f32_i32 v111, v87
  v_pk_add_f32 v[108:109], v[108:109], v[212:213] neg_lo:[0,1] neg_hi:[0,1]
  v_pk_add_f32 v[110:111], v[110:111], v[214:215] neg_lo:[0,1] neg_hi:[0,1]
  v_cvt_pk_bf16_f32 v108, 0, v108
  v_cvt_pk_bf16_f32 v228, 0, v228
  v_cvt_pk_bf16_f32 v109, 0, v109
  v_cvt_pk_bf16_f32 v229, 0, v229
  v_cvt_pk_bf16_f32 v110, 0, v110
  v_pk_mul_f32 v[228:229], v[228:229], s[68:69]
  v_cvt_pk_bf16_f32 v111, 0, v111
  v_cvt_pk_bf16_f32 v122, v228, v229
  v_pk_mul_f32 v[108:109], v[108:109], v[200:201]
  v_pk_mul_f32 v[110:111], v[110:111], v[202:203]
  v_cvt_pk_bf16_f32 v220, v108, v109
  v_cvt_pk_bf16_f32 v221, v110, v111
  s_waitcnt vmcnt(20)
  s_cbranch_vccnz L_kw0_21
  s_waitcnt vmcnt(15)
L_kw0_21:
  buffer_load_dwordx4 v[60:63], v93, s[16:19], s61 offen offset:0 nt
  v_mfma_f32_16x16x16_bf16 v[224:227], v[220:221], v[172:173], v[224:227]
  v_cvt_f32_i32 v108, v88
  v_cvt_f32_i32 v109, v89
  v_cvt_f32_i32 v110, v90
  v_cvt_f32_i32 v111, v91
  v_pk_add_f32 v[108:109], v[108:109], v[204:205] neg_lo:[0,1] neg_hi:[0,1]
  v_pk_add_f32 v[110:111], v[110:111], v[206:207] neg_lo:[0,1] neg_hi:[0,1]
  v_cvt_pk_bf16_f32 v108, 0, v108
  v_cvt_pk_bf16_f32 v109, 0, v109
  v_cvt_pk_bf16_f32 v110, 0, v110
  v_cvt_pk_bf16_f32 v111, 0, v111
  v_pk_mul_f32 v[108:109], v[108:109], v[192:193]
  v_pk_mul_f32 v[110:111], v[110:111], v[194:195]
  v_cvt_pk_bf16_f32 v216, v108, v109
  v_cvt_pk_bf16_f32 v217, v110, v111
  s_waitcnt vmcnt(20)
  buffer_load_dwordx4 v[64:67], v93, s[16:19], s61 offen offset:256 nt
  v_cvt_f32_i32 v108, v4
  v_cvt_f32_i32 v109, v5
  v_cvt_f32_i32 v110, v6
  v_cvt_f32_i32 v111, v7
  v_pk_add_f32 v[108:109], v[108:109], v[208:209] neg_lo:[0,1] neg_hi:[0,1]
  v_pk_add_f32 v[110:111], v[110:111], v[210:211] neg_lo:[0,1] neg_hi:[0,1]
  v_mov_b32_dpp v144, v224 quad_perm:[0,0,0,0] row_mask:0xf bank_mask:0xf
  v_mov_b32_dpp v145, v226 quad_perm:[2,2,2,2] row_mask:0xf bank_mask:0xf
  v_cvt_pk_bf16_f32 v108, 0, v108
  v_cvt_pk_bf16_f32 v109, 0, v109
  v_add_f32_dpp v144, v225, v144 quad_perm:[1,1,1,1] row_mask:0xf bank_mask:0xf
  v_add_f32_dpp v145, v227, v145 quad_perm:[3,3,3,3] row_mask:0xf bank_mask:0xf
  v_cvt_pk_bf16_f32 v110, 0, v110
  v_cvt_pk_bf16_f32 v111, 0, v111
  v_add_f32 v228, v144, v145
  v_pk_mul_f32 v[108:109], v[108:109], v[196:197]
  v_pk_mul_f32 v[110:111], v[110:111], v[198:199]
  v_cvt_pk_bf16_f32 v218, v108, v109
  v_cvt_pk_bf16_f32 v219, v110, v111
  s_waitcnt vmcnt(20)
  buffer_load_dwordx4 v[68:71], v93, s[16:19], s61 offen offset:512 nt
  v_mfma_f32_16x16x32_bf16 v[224:227], v[216:219], v[168:171], 0
  v_cvt_f32_i32 v108, v8
  v_cvt_f32_i32 v109, v9
  v_cvt_f32_i32 v110, v10
  v_cvt_f32_i32 v111, v11
  v_pk_add_f32 v[108:109], v[108:109], v[212:213] neg_lo:[0,1] neg_hi:[0,1]
  v_pk_add_f32 v[110:111], v[110:111], v[214:215] neg_lo:[0,1] neg_hi:[0,1]
  v_cvt_pk_bf16_f32 v108, 0, v108
  v_cvt_pk_bf16_f32 v109, 0, v109
  v_cvt_pk_bf16_f32 v110, 0, v110
  v_cvt_pk_bf16_f32 v111, 0, v111
  v_pk_mul_f32 v[108:109], v[108:109], v[200:201]
  v_pk_mul_f32 v[110:111], v[110:111], v[202:203]
  v_cvt_pk_bf16_f32 v220, v108, v109
  v_cvt_pk_bf16_f32 v221, v110, v111
  s_waitcnt vmcnt(20)
  s_cbranch_vccnz L_kw0_24
  s_waitcnt vmcnt(15)
L_kw0_24:
  buffer_load_dwordx4 v[72:75], v93, s[16:19], s61 offen offset:768 nt
  v_mfma_f32_16x16x16_bf16 v[224:227], v[220:221], v[172:173], v[224:227]
  v_cvt_f32_i32 v108, v12
  v_cvt_f32_i32 v109, v13
  v_cvt_f32_i32 v110, v14
  v_cvt_f32_i32 v111, v15
  v_pk_add_f32 v[108:109], v[108:109], v[204:205] neg_lo:[0,1] neg_hi:[0,1]
  v_pk_add_f32 v[110:111], v[110:111], v[206:207] neg_lo:[0,1] neg_hi:[0,1]
  v_cvt_pk_bf16_f32 v108, 0, v108
  v_cvt_pk_bf16_f32 v109, 0, v109
  v_cvt_pk_bf16_f32 v110, 0, v110
  v_cvt_pk_bf16_f32 v111, 0, v111
  v_pk_mul_f32 v[108:109], v[108:109], v[192:193]
  v_pk_mul_f32 v[110:111], v[110:111], v[194:195]
  v_cvt_pk_bf16_f32 v216, v108, v109
  v_cvt_pk_bf16_f32 v217, v110, v111
  s_waitcnt vmcnt(20)
  buffer_load_dwordx4 v[76:79], v93, s[16:19], s61 offen offset:1024 nt
  v_cvt_f32_i32 v108, v16
  v_cvt_f32_i32 v109, v17
  v_cvt_f32_i32 v110, v18
  v_cvt_f32_i32 v111, v19
  v_pk_add_f32 v[108:109], v[108:109], v[208:209] neg_lo:[0,1] neg_hi:[0,1]
  v_pk_add_f32 v[110:111], v[110:111], v[210:211] neg_lo:[0,1] neg_hi:[0,1]
  v_mov_b32_dpp v144, v224 quad_perm:[0,0,0,0] row_mask:0xf bank_mask:0xf
  v_mov_b32_dpp v145, v226 quad_perm:[2,2,2,2] row_mask:0xf bank_mask:0xf
  v_cvt_pk_bf16_f32 v108, 0, v108
  v_cvt_pk_bf16_f32 v109, 0, v109
  v_add_f32_dpp v144, v225, v144 quad_perm:[1,1,1,1] row_mask:0xf bank_mask:0xf
  v_add_f32_dpp v145, v227, v145 quad_perm:[3,3,3,3] row_mask:0xf bank_mask:0xf
  v_cvt_pk_bf16_f32 v110, 0, v110
  v_cvt_pk_bf16_f32 v111, 0, v111
  v_add_f32 v229, v144, v145
  v_pk_mul_f32 v[108:109], v[108:109], v[196:197]
  v_pk_mul_f32 v[110:111], v[110:111], v[198:199]
  v_cvt_pk_bf16_f32 v218, v108, v109
  v_cvt_pk_bf16_f32 v219, v110, v111
  s_waitcnt vmcnt(20)
  buffer_load_dwordx4 v[80:83], v93, s[16:19], s61 offen offset:1280 nt
  v_mfma_f32_16x16x32_bf16 v[224:227], v[216:219], v[168:171], 0
  v_cvt_f32_i32 v108, v20
  v_cvt_f32_i32 v109, v21
  v_cvt_f32_i32 v110, v22
  v_cvt_f32_i32 v111, v23
  v_pk_add_f32 v[108:109], v[108:109], v[212:213] neg_lo:[0,1] neg_hi:[0,1]
  v_pk_add_f32 v[110:111], v[110:111], v[214:215] neg_lo:[0,1] neg_hi:[0,1]
  v_cvt_pk_bf16_f32 v108, 0, v108
  v_cvt_pk_bf16_f32 v228, 0, v228
  v_cvt_pk_bf16_f32 v109, 0, v109
  v_cvt_pk_bf16_f32 v229, 0, v229
  v_cvt_pk_bf16_f32 v110, 0, v110
  v_pk_mul_f32 v[228:229], v[228:229], s[68:69]
  v_cvt_pk_bf16_f32 v111, 0, v111
  v_cvt_pk_bf16_f32 v123, v228, v229
  v_pk_mul_f32 v[108:109], v[108:109], v[200:201]
  v_pk_mul_f32 v[110:111], v[110:111], v[202:203]
  v_cvt_pk_bf16_f32 v220, v108, v109
  v_cvt_pk_bf16_f32 v221, v110, v111
  s_waitcnt vmcnt(20)
  s_cbranch_vccnz L_kw0_27
  s_waitcnt vmcnt(15)
L_kw0_27:
  buffer_load_dwordx4 v[84:87], v93, s[16:19], s61 offen offset:1536 nt
  v_mfma_f32_16x16x16_bf16 v[224:227], v[220:221], v[172:173], v[224:227]
  v_cvt_f32_i32 v108, v24
  v_cvt_f32_i32 v109, v25
  v_cvt_f32_i32 v110, v26
  v_cvt_f32_i32 v111, v27
  v_pk_add_f32 v[108:109], v[108:109], v[204:205] neg_lo:[0,1] neg_hi:[0,1]
  v_pk_add_f32 v[110:111], v[110:111], v[206:207] neg_lo:[0,1] neg_hi:[0,1]
  v_cvt_pk_bf16_f32 v108, 0, v108
  v_cvt_pk_bf16_f32 v109, 0, v109
  v_cvt_pk_bf16_f32 v110, 0, v110
  v_cvt_pk_bf16_f32 v111, 0, v111
  v_pk_mul_f32 v[108:109], v[108:109], v[192:193]
  v_pk_mul_f32 v[110:111], v[110:111], v[194:195]
  v_cvt_pk_bf16_f32 v216, v108, v109
  v_cvt_pk_bf16_f32 v217, v110, v111
  s_waitcnt vmcnt(20)
  buffer_load_dwordx4 v[88:91], v93, s[16:19], s61 offen offset:1792 nt
  v_cvt_f32_i32 v108, v28
  v_cvt_f32_i32 v109, v29
  v_cvt_f32_i32 v110, v30
  v_cvt_f32_i32 v111, v31
  v_pk_add_f32 v[108:109], v[108:109], v[208:209] neg_lo:[0,1] neg_hi:[0,1]
  v_pk_add_f32 v[110:111], v[110:111], v[210:211] neg_lo:[0,1] neg_hi:[0,1]
  v_mov_b32_dpp v144, v224 quad_perm:[0,0,0,0] row_mask:0xf bank_mask:0xf
  v_mov_b32_dpp v145, v226 quad_perm:[2,2,2,2] row_mask:0xf bank_mask:0xf
  v_cvt_pk_bf16_f32 v108, 0, v108
  v_cvt_pk_bf16_f32 v109, 0, v109
  v_add_f32_dpp v144, v225, v144 quad_perm:[1,1,1,1] row_mask:0xf bank_mask:0xf
  v_add_f32_dpp v145, v227, v145 quad_perm:[3,3,3,3] row_mask:0xf bank_mask:0xf
  v_cvt_pk_bf16_f32 v110, 0, v110
  v_cvt_pk_bf16_f32 v111, 0, v111
  v_add_f32 v228, v144, v145
  v_pk_mul_f32 v[108:109], v[108:109], v[196:197]
  v_pk_mul_f32 v[110:111], v[110:111], v[198:199]
  v_cvt_pk_bf16_f32 v218, v108, v109
  v_cvt_pk_bf16_f32 v219, v110, v111
  s_waitcnt vmcnt(20)
  buffer_load_dwordx4 v[4:7], v93, s[16:19], s61 offen offset:2048 nt
  v_mfma_f32_16x16x32_bf16 v[224:227], v[216:219], v[168:171], 0
  v_cvt_f32_i32 v108, v32
  v_cvt_f32_i32 v109, v33
  v_cvt_f32_i32 v110, v34
  v_cvt_f32_i32 v111, v35
  v_pk_add_f32 v[108:109], v[108:109], v[212:213] neg_lo:[0,1] neg_hi:[0,1]
  v_pk_add_f32 v[110:111], v[110:111], v[214:215] neg_lo:[0,1] neg_hi:[0,1]
  v_cvt_pk_bf16_f32 v108, 0, v108
  v_cvt_pk_bf16_f32 v109, 0, v109
  v_cvt_pk_bf16_f32 v110, 0, v110
  v_cvt_pk_bf16_f32 v111, 0, v111
  v_pk_mul_f32 v[108:109], v[108:109], v[200:201]
  v_pk_mul_f32 v[110:111], v[110:111], v[202:203]
  v_cvt_pk_bf16_f32 v220, v108, v109
  v_cvt_pk_bf16_f32 v221, v110, v111
  s_waitcnt vmcnt(20)
  s_cbranch_vccnz L_kw0_30
  s_waitcnt vmcnt(9)
L_kw0_30:
  buffer_load_dwordx4 v[8:11], v93, s[16:19], s61 offen offset:2304 nt
  v_mfma_f32_16x16x16_bf16 v[224:227], v[220:221], v[172:173], v[224:227]
  v_cvt_f32_i32 v108, v36
  v_cvt_f32_i32 v109, v37
  v_cvt_f32_i32 v110, v38
  v_cvt_f32_i32 v111, v39
  v_pk_add_f32 v[108:109], v[108:109], v[204:205] neg_lo:[0,1] neg_hi:[0,1]
  v_pk_add_f32 v[110:111], v[110:111], v[206:207] neg_lo:[0,1] neg_hi:[0,1]
  v_cvt_pk_bf16_f32 v108, 0, v108
  v_cvt_pk_bf16_f32 v109, 0, v109
  v_cvt_pk_bf16_f32 v110, 0, v110
  v_cvt_pk_bf16_f32 v111, 0, v111
  v_pk_mul_f32 v[108:109], v[108:109], v[192:193]
  v_pk_mul_f32 v[110:111], v[110:111], v[194:195]
  v_cvt_pk_bf16_f32 v216, v108, v109
  v_cvt_pk_bf16_f32 v217, v110, v111
  s_waitcnt vmcnt(20)
  buffer_load_dwordx4 v[12:15], v93, s[16:19], s61 offen offset:2560 nt
  v_cvt_f32_i32 v108, v40
  v_cvt_f32_i32 v109, v41
  v_cvt_f32_i32 v110, v42
  v_cvt_f32_i32 v111, v43
  v_pk_add_f32 v[108:109], v[108:109], v[208:209] neg_lo:[0,1] neg_hi:[0,1]
  v_pk_add_f32 v[110:111], v[110:111], v[210:211] neg_lo:[0,1] neg_hi:[0,1]
  v_mov_b32_dpp v144, v224 quad_perm:[0,0,0,0] row_mask:0xf bank_mask:0xf
  v_mov_b32_dpp v145, v226 quad_perm:[2,2,2,2] row_mask:0xf bank_mask:0xf
  v_cvt_pk_bf16_f32 v108, 0, v108
  v_cvt_pk_bf16_f32 v109, 0, v109
  v_add_f32_dpp v144, v225, v144 quad_perm:[1,1,1,1] row_mask:0xf bank_mask:0xf
  v_add_f32_dpp v145, v227, v145 quad_perm:[3,3,3,3] row_mask:0xf bank_mask:0xf
  v_cvt_pk_bf16_f32 v110, 0, v110
  v_cvt_pk_bf16_f32 v111, 0, v111
  v_add_f32 v229, v144, v145
  v_pk_mul_f32 v[108:109], v[108:109], v[196:197]
  v_pk_mul_f32 v[110:111], v[110:111], v[198:199]
  v_cvt_pk_bf16_f32 v218, v108, v109
  v_cvt_pk_bf16_f32 v219, v110, v111
  s_waitcnt vmcnt(20)
  buffer_load_dwordx4 v[16:19], v93, s[16:19], s61 offen offset:2816 nt
  v_mfma_f32_16x16x32_bf16 v[224:227], v[216:219], v[168:171], 0
  v_cvt_f32_i32 v108, v44
  v_cvt_f32_i32 v109, v45
  v_cvt_f32_i32 v110, v46
  v_cvt_f32_i32 v111, v47
  v_pk_add_f32 v[108:109], v[108:109], v[212:213] neg_lo:[0,1] neg_hi:[0,1]
  v_pk_add_f32 v[110:111], v[110:111], v[214:215] neg_lo:[0,1] neg_hi:[0,1]
  v_cvt_pk_bf16_f32 v108, 0, v108
  v_cvt_pk_bf16_f32 v228, 0, v228
  v_cvt_pk_bf16_f32 v109, 0, v109
  v_cvt_pk_bf16_f32 v229, 0, v229
  v_cvt_pk_bf16_f32 v110, 0, v110
  v_pk_mul_f32 v[228:229], v[228:229], s[68:69]
  v_cvt_pk_bf16_f32 v111, 0, v111
  v_cvt_pk_bf16_f32 v124, v228, v229
  v_pk_mul_f32 v[108:109], v[108:109], v[200:201]
  v_pk_mul_f32 v[110:111], v[110:111], v[202:203]
  v_cvt_pk_bf16_f32 v220, v108, v109
  v_cvt_pk_bf16_f32 v221, v110, v111
  s_mov_b32 s60, s61
  v_mov_b32 v146, s64
  v_mfma_f32_16x16x16_bf16 v[224:227], v[220:221], v[172:173], v[224:227]
  ds_write_b128 v99, v[120:123]
  v_add_u32 v99, 768, v99
  s_nop 5
  v_mov_b32_dpp v144, v224 quad_perm:[0,0,0,0] row_mask:0xf bank_mask:0xf
  v_mov_b32_dpp v145, v226 quad_perm:[2,2,2,2] row_mask:0xf bank_mask:0xf
  s_nop 0
  v_add_f32_dpp v144, v225, v144 quad_perm:[1,1,1,1] row_mask:0xf bank_mask:0xf
  v_add_f32_dpp v145, v227, v145 quad_perm:[3,3,3,3] row_mask:0xf bank_mask:0xf
  v_add_f32 v228, v144, v145
  v_cndmask_b32 v228, v228, v236, s[50:51]
  v_cvt_pk_bf16_f32 v228, 0, v228
  v_cvt_pk_bf16_f32 v229, 0, v229
  v_pk_mul_f32 v[228:229], v[228:229], s[68:69]
  v_cvt_pk_bf16_f32 v125, v228, v229
  ds_write_b64 v100, v[124:125] offset:256
  ds_write_b32 v104, v146
  v_add_u32 v100, 768, v100
  v_add_u32 v144, s85, v2
  v_lshrrev_b32 v145, v144, s91
  v_and_b32 v145, 1, v145
  v_cmp_eq_u32 s[50:51], 1, v145
  s_nop 1
  s_and_b64 s[48:49], s[50:51], s[58:59]
  s_andn2_b64 s[50:51], s[50:51], s[58:59]
  s_mov_b32 s97, s64
  s_add_u32 s64, s64, 2
  ds_read_b32 v106, v104 offset:8
  s_waitcnt vmcnt(14)
  s_cbranch_vccnz L_kw1_0
  s_waitcnt vmcnt(9)
L_kw1_0:
  buffer_load_dwordx4 v[20:23], v93, s[8:11], s60 offen offset:3072 nt
  v_lshlrev_b32 v204, 16, v186
  v_and_b32 v205, s65, v186
  v_lshlrev_b32 v206, 16, v187
  v_and_b32 v207, s65, v187
  v_lshlrev_b32 v192, 16, v180
  v_and_b32 v193, s65, v180
  v_lshlrev_b32 v194, 16, v181
  v_and_b32 v195, s65, v181
  v_mov_b32 v168, v174
  v_mov_b32 v169, v175
  v_cvt_f32_i32 v108, v48
  v_cvt_f32_i32 v109, v49
  v_cvt_f32_i32 v110, v50
  v_cvt_f32_i32 v111, v51
  v_pk_add_f32 v[108:109], v[108:109], v[204:205] neg_lo:[0,1] neg_hi:[0,1]
  v_pk_add_f32 v[110:111], v[110:111], v[206:207] neg_lo:[0,1] neg_hi:[0,1]
  v_cvt_pk_bf16_f32 v108, 0, v108
  v_cvt_pk_bf16_f32 v109, 0, v109
  v_cvt_pk_bf16_f32 v110, 0, v110
  v_cvt_pk_bf16_f32 v111, 0, v111
  v_pk_mul_f32 v[108:109], v[108:109], v[192:193]
  v_pk_mul_f32 v[110:111], v[110:111], v[194:195]
  v_cvt_pk_bf16_f32 v216, v108, v109
  v_cvt_pk_bf16_f32 v217, v110, v111
  s_waitcnt lgkmcnt(0)
  v_cmp_lt_u32 vcc, s97, v106
  s_waitcnt vmcnt(14)
  buffer_load_dwordx4 v[24:27], v93, s[8:11], s60 offen offset:3328 nt
  v_lshlrev_b32 v208, 16, v188
  v_and_b32 v209, s65, v188
  v_lshlrev_b32 v210, 16, v189
  v_and_b32 v211, s65, v189
  v_lshlrev_b32 v196, 16, v182
  v_and_b32 v197, s65, v182
  v_lshlrev_b32 v198, 16, v183
  v_and_b32 v199, s65, v183
  v_mov_b32 v170, v176
  v_mov_b32 v171, v177
  v_cvt_f32_i32 v108, v52
  v_cvt_f32_i32 v109, v53
  v_cvt_f32_i32 v110, v54
  v_cvt_f32_i32 v111, v55
  v_pk_add_f32 v[108:109], v[108:109], v[208:209] neg_lo:[0,1] neg_hi:[0,1]
  v_pk_add_f32 v[110:111], v[110:111], v[210:211] neg_lo:[0,1] neg_hi:[0,1]
  v_cvt_pk_bf16_f32 v108, 0, v108
  v_cvt_pk_bf16_f32 v109, 0, v109
  v_cvt_pk_bf16_f32 v110, 0, v110
  v_cvt_pk_bf16_f32 v111, 0, v111
  v_pk_mul_f32 v[108:109], v[108:109], v[196:197]
  v_pk_mul_f32 v[110:111], v[110:111], v[198:199]
  v_cvt_pk_bf16_f32 v218, v108, v109
  v_cvt_pk_bf16_f32 v219, v110, v111
  s_waitcnt vmcnt(14)
  buffer_load_dwordx4 v[28:31], v93, s[8:11], s60 offen offset:3584 nt
  v_mfma_f32_16x16x32_bf16 v[224:227], v[216:219], v[168:171], 0
  v_lshlrev_b32 v212, 16, v190
  v_and_b32 v213, s65, v190
  v_lshlrev_b32 v214, 16, v191
  v_and_b32 v215, s65, v191
  v_lshlrev_b32 v200, 16, v184
  v_and_b32 v201, s65, v184
  v_lshlrev_b32 v202, 16, v185
  v_and_b32 v203, s65, v185
  v_mov_b32 v172, v178
  v_mov_b32 v173, v179
  v_cvt_f32_i32 v108, v56
  v_cvt_f32_i32 v109, v57
  v_cvt_f32_i32 v110, v58
  v_cvt_f32_i32 v111, v59
  v_pk_add_f32 v[108:109], v[108:109], v[212:213] neg_lo:[0,1] neg_hi:[0,1]
  v_pk_add_f32 v[110:111], v[110:111], v[214:215] neg_lo:[0,1] neg_hi:[0,1]
  v_cvt_pk_bf16_f32 v108, 0, v108
  v_cvt_pk_bf16_f32 v109, 0, v109
  v_cvt_pk_bf16_f32 v110, 0, v110
  v_cvt_pk_bf16_f32 v111, 0, v111
  v_pk_mul_f32 v[108:109], v[108:109], v[200:201]
  v_pk_mul_f32 v[110:111], v[110:111], v[202:203]
  v_cvt_pk_bf16_f32 v220, v108, v109
  v_cvt_pk_bf16_f32 v221, v110, v111
  s_waitcnt vmcnt(14)
  s_cbranch_vccnz L_kw1_3
  s_waitcnt vmcnt(9)
L_kw1_3:
  buffer_load_dwordx4 v[32:35], v94, s[8:11], s60 offen offset:0 nt
  v_mfma_f32_16x16x16_bf16 v[224:227], v[220:221], v[172:173], v[224:227]
  v_cvt_f32_i32 v108, v60
  v_cvt_f32_i32 v109, v61
  v_cvt_f32_i32 v110, v62
  v_cvt_f32_i32 v111, v63
  v_pk_add_f32 v[108:109], v[108:109], v[204:205] neg_lo:[0,1] neg_hi:[0,1]
  v_pk_add_f32 v[110:111], v[110:111], v[206:207] neg_lo:[0,1] neg_hi:[0,1]
  v_cvt_pk_bf16_f32 v108, 0, v108
  v_cvt_pk_bf16_f32 v109, 0, v109
  v_cvt_pk_bf16_f32 v110, 0, v110
  v_cvt_pk_bf16_f32 v111, 0, v111
  v_pk_mul_f32 v[108:109], v[108:109], v[192:193]
  v_pk_mul_f32 v[110:111], v[110:111], v[194:195]
  v_cvt_pk_bf16_f32 v216, v108, v109
  v_cvt_pk_bf16_f32 v217, v110, v111
  s_waitcnt vmcnt(14)
  buffer_load_dwordx4 v[36:39], v94, s[8:11], s60 offen offset:256 nt
  v_cvt_f32_i32 v108, v64
  v_cvt_f32_i32 v109, v65
  v_cvt_f32_i32 v110, v66
  v_cvt_f32_i32 v111, v67
  v_pk_add_f32 v[108:109], v[108:109], v[208:209] neg_lo:[0,1] neg_hi:[0,1]
  v_pk_add_f32 v[110:111], v[110:111], v[210:211] neg_lo:[0,1] neg_hi:[0,1]
  v_mov_b32_dpp v144, v224 quad_perm:[0,0,0,0] row_mask:0xf bank_mask:0xf
  v_mov_b32_dpp v145, v226 quad_perm:[2,2,2,2] row_mask:0xf bank_mask:0xf
  v_cvt_pk_bf16_f32 v108, 0, v108
  v_cvt_pk_bf16_f32 v109, 0, v109
  v_add_f32_dpp v144, v225, v144 quad_perm:[1,1,1,1] row_mask:0xf bank_mask:0xf
  v_add_f32_dpp v145, v227, v145 quad_perm:[3,3,3,3] row_mask:0xf bank_mask:0xf
  v_cvt_pk_bf16_f32 v110, 0, v110
  v_cvt_pk_bf16_f32 v111, 0, v111
  v_add_f32 v228, v144, v145
  v_pk_mul_f32 v[108:109], v[108:109], v[196:197]
  v_pk_mul_f32 v[110:111], v[110:111], v[198:199]
  v_cvt_pk_bf16_f32 v218, v108, v109
  v_cvt_pk_bf16_f32 v219, v110, v111
  s_waitcnt vmcnt(14)
  buffer_load_dwordx4 v[40:43], v94, s[8:11], s60 offen offset:512 nt
  v_mfma_f32_16x16x32_bf16 v[224:227], v[216:219], v[168:171], 0
  v_cvt_f32_i32 v108, v68
  v_cvt_f32_i32 v109, v69
  v_cvt_f32_i32 v110, v70
  v_cvt_f32_i32 v111, v71
  v_pk_add_f32 v[108:109], v[108:109], v[212:213] neg_lo:[0,1] neg_hi:[0,1]
  v_pk_add_f32 v[110:111], v[110:111], v[214:215] neg_lo:[0,1] neg_hi:[0,1]
  v_cvt_pk_bf16_f32 v108, 0, v108
  v_cndmask_b32 v228, v228, v236, s[48:49]
  v_cvt_pk_bf16_f32 v109, 0, v109
  v_cvt_pk_bf16_f32 v110, 0, v110
  v_cvt_pk_bf16_f32 v111, 0, v111
  v_pk_mul_f32 v[108:109], v[108:109], v[200:201]
  v_pk_mul_f32 v[110:111], v[110:111], v[202:203]
  v_cvt_pk_bf16_f32 v220, v108, v109
  v_cvt_pk_bf16_f32 v221, v110, v111
  s_waitcnt vmcnt(14)
  s_cbranch_vccnz L_kw1_6
  s_waitcnt vmcnt(9)
L_kw1_6:
  buffer_load_dwordx4 v[44:47], v94, s[8:11], s60 offen offset:768 nt
  v_mfma_f32_16x16x16_bf16 v[224:227], v[220:221], v[172:173], v[224:227]
  v_cvt_f32_i32 v108, v72
  v_cvt_f32_i32 v109, v73
  v_cvt_f32_i32 v110, v74
  v_cvt_f32_i32 v111, v75
  v_pk_add_f32 v[108:109], v[108:109], v[204:205] neg_lo:[0,1] neg_hi:[0,1]
  v_pk_add_f32 v[110:111], v[110:111], v[206:207] neg_lo:[0,1] neg_hi:[0,1]
  v_cvt_pk_bf16_f32 v108, 0, v108
  v_cvt_pk_bf16_f32 v109, 0, v109
  v_cvt_pk_bf16_f32 v110, 0, v110
  v_cvt_pk_bf16_f32 v111, 0, v111
  v_pk_mul_f32 v[108:109], v[108:109], v[192:193]
  v_pk_mul_f32 v[110:111], v[110:111], v[194:195]
  v_cvt_pk_bf16_f32 v216, v108, v109
  v_cvt_pk_bf16_f32 v217, v110, v111
  s_waitcnt vmcnt(14)
  buffer_load_dwordx4 v[48:51], v94, s[8:11], s60 offen offset:1024 nt
  v_cvt_f32_i32 v108, v76
  v_cvt_f32_i32 v109, v77
  v_cvt_f32_i32 v110, v78
  v_cvt_f32_i32 v111, v79
  v_pk_add_f32 v[108:109], v[108:109], v[208:209] neg_lo:[0,1] neg_hi:[0,1]
  v_pk_add_f32 v[110:111], v[110:111], v[210:211] neg_lo:[0,1] neg_hi:[0,1]
  v_mov_b32_dpp v144, v224 quad_perm:[0,0,0,0] row_mask:0xf bank_mask:0xf
  v_mov_b32_dpp v145, v226 quad_perm:[2,2,2,2] row_mask:0xf bank_mask:0xf
  v_cvt_pk_bf16_f32 v108, 0, v108
  v_cvt_pk_bf16_f32 v109, 0, v109
  v_add_f32_dpp v144, v225, v144 quad_perm:[1,1,1,1] row_mask:0xf bank_mask:0xf
  v_add_f32_dpp v145, v227, v145 quad_perm:[3,3,3,3] row_mask:0xf bank_mask:0xf
  v_cvt_pk_bf16_f32 v110, 0, v110
  v_cvt_pk_bf16_f32 v111, 0, v111
  v_add_f32 v229, v144, v145
  v_pk_mul_f32 v[108:109], v[108:109], v[196:197]
  v_pk_mul_f32 v[110:111], v[110:111], v[198:199]
  v_cvt_pk_bf16_f32 v218, v108, v109
  v_cvt_pk_bf16_f32 v219, v110, v111
  s_waitcnt vmcnt(14)
  buffer_load_dwordx4 v[52:55], v94, s[8:11], s60 offen offset:1280 nt
  v_mfma_f32_16x16x32_bf16 v[224:227], v[216:219], v[168:171], 0
  v_cvt_f32_i32 v108, v80
  v_cvt_f32_i32 v109, v81
  v_cvt_f32_i32 v110, v82
  v_cvt_f32_i32 v111, v83
  v_pk_add_f32 v[108:109], v[108:109], v[212:213] neg_lo:[0,1] neg_hi:[0,1]
  v_pk_add_f32 v[110:111], v[110:111], v[214:215] neg_lo:[0,1] neg_hi:[0,1]
  v_cvt_pk_bf16_f32 v108, 0, v108
  v_cvt_pk_bf16_f32 v228, 0, v228
  v_cvt_pk_bf16_f32 v109, 0, v109
  v_cvt_pk_bf16_f32 v229, 0, v229
  v_cvt_pk_bf16_f32 v110, 0, v110
  v_pk_mul_f32 v[228:229], v[228:229], s[68:69]
  v_cvt_pk_bf16_f32 v111, 0, v111
  v_cvt_pk_bf16_f32 v120, v228, v229
  v_pk_mul_f32 v[108:109], v[108:109], v[200:201]
  v_pk_mul_f32 v[110:111], v[110:111], v[202:203]
  v_cvt_pk_bf16_f32 v220, v108, v109
  v_cvt_pk_bf16_f32 v221, v110, v111
  s_waitcnt vmcnt(14)
  s_cbranch_vccnz L_kw1_9
  s_waitcnt vmcnt(9)
L_kw1_9:
  buffer_load_dwordx4 v[56:59], v94, s[8:11], s60 offen offset:1536 nt
  v_mfma_f32_16x16x16_bf16 v[224:227], v[220:221], v[172:173], v[224:227]
  v_cvt_f32_i32 v108, v84
  v_cvt_f32_i32 v109, v85
  v_cvt_f32_i32 v110, v86
  v_cvt_f32_i32 v111, v87
  v_pk_add_f32 v[108:109], v[108:109], v[204:205] neg_lo:[0,1] neg_hi:[0,1]
  v_pk_add_f32 v[110:111], v[110:111], v[206:207] neg_lo:[0,1] neg_hi:[0,1]
  v_cvt_pk_bf16_f32 v108, 0, v108
  v_cvt_pk_bf16_f32 v109, 0, v109
  v_cvt_pk_bf16_f32 v110, 0, v110
  v_cvt_pk_bf16_f32 v111, 0, v111
  v_pk_mul_f32 v[108:109], v[108:109], v[192:193]
  v_pk_mul_f32 v[110:111], v[110:111], v[194:195]
  v_cvt_pk_bf16_f32 v216, v108, v109
  v_cvt_pk_bf16_f32 v217, v110, v111
  s_waitcnt vmcnt(14)
  buffer_load_dwordx4 v[60:63], v94, s[8:11], s60 offen offset:1792 nt
  v_cvt_f32_i32 v108, v88
  v_cvt_f32_i32 v109, v89
  v_cvt_f32_i32 v110, v90
  v_cvt_f32_i32 v111, v91
  v_pk_add_f32 v[108:109], v[108:109], v[208:209] neg_lo:[0,1] neg_hi:[0,1]
  v_pk_add_f32 v[110:111], v[110:111], v[210:211] neg_lo:[0,1] neg_hi:[0,1]
  v_mov_b32_dpp v144, v224 quad_perm:[0,0,0,0] row_mask:0xf bank_mask:0xf
  v_mov_b32_dpp v145, v226 quad_perm:[2,2,2,2] row_mask:0xf bank_mask:0xf
  v_cvt_pk_bf16_f32 v108, 0, v108
  v_cvt_pk_bf16_f32 v109, 0, v109
  v_add_f32_dpp v144, v225, v144 quad_perm:[1,1,1,1] row_mask:0xf bank_mask:0xf
  v_add_f32_dpp v145, v227, v145 quad_perm:[3,3,3,3] row_mask:0xf bank_mask:0xf
  v_cvt_pk_bf16_f32 v110, 0, v110
  v_cvt_pk_bf16_f32 v111, 0, v111
  v_add_f32 v228, v144, v145
  v_pk_mul_f32 v[108:109], v[108:109], v[196:197]
  v_pk_mul_f32 v[110:111], v[110:111], v[198:199]
  v_cvt_pk_bf16_f32 v218, v108, v109
  v_cvt_pk_bf16_f32 v219, v110, v111
  s_waitcnt vmcnt(14)
  buffer_load_dwordx4 v[64:67], v94, s[8:11], s60 offen offset:2048 nt
  v_mfma_f32_16x16x32_bf16 v[224:227], v[216:219], v[168:171], 0
  v_cvt_f32_i32 v108, v4
  v_cvt_f32_i32 v109, v5
  v_cvt_f32_i32 v110, v6
  v_cvt_f32_i32 v111, v7
  v_pk_add_f32 v[108:109], v[108:109], v[212:213] neg_lo:[0,1] neg_hi:[0,1]
  v_pk_add_f32 v[110:111], v[110:111], v[214:215] neg_lo:[0,1] neg_hi:[0,1]
  v_cvt_pk_bf16_f32 v108, 0, v108
  v_cvt_pk_bf16_f32 v109, 0, v109
  v_cvt_pk_bf16_f32 v110, 0, v110
  v_cvt_pk_bf16_f32 v111, 0, v111
  v_pk_mul_f32 v[108:109], v[108:109], v[200:201]
  v_pk_mul_f32 v[110:111], v[110:111], v[202:203]
  v_cvt_pk_bf16_f32 v220, v108, v109
  v_cvt_pk_bf16_f32 v221, v110, v111
  s_waitcnt vmcnt(14)
  s_cbranch_vccnz L_kw1_12
  s_waitcnt vmcnt(9)
L_kw1_12:
  buffer_load_dwordx4 v[68:71], v94, s[8:11], s60 offen offset:2304 nt
  v_mfma_f32_16x16x16_bf16 v[224:227], v[220:221], v[172:173], v[224:227]
  v_cvt_f32_i32 v108, v8
  v_cvt_f32_i32 v109, v9
  v_cvt_f32_i32 v110, v10
  v_cvt_f32_i32 v111, v11
  v_pk_add_f32 v[108:109], v[108:109], v[204:205] neg_lo:[0,1] neg_hi:[0,1]
  v_pk_add_f32 v[110:111], v[110:111], v[206:207] neg_lo:[0,1] neg_hi:[0,1]
  v_cvt_pk_bf16_f32 v108, 0, v108
  v_cvt_pk_bf16_f32 v109, 0, v109
  v_cvt_pk_bf16_f32 v110, 0, v110
  v_cvt_pk_bf16_f32 v111, 0, v111
  v_pk_mul_f32 v[108:109], v[108:109], v[192:193]
  v_pk_mul_f32 v[110:111], v[110:111], v[194:195]
  v_cvt_pk_bf16_f32 v216, v108, v109
  v_cvt_pk_bf16_f32 v217, v110, v111
  s_waitcnt vmcnt(14)
  buffer_load_dwordx4 v[72:75], v94, s[8:11], s60 offen offset:2560 nt
  v_cvt_f32_i32 v108, v12
  v_cvt_f32_i32 v109, v13
  v_cvt_f32_i32 v110, v14
  v_cvt_f32_i32 v111, v15
  v_pk_add_f32 v[108:109], v[108:109], v[208:209] neg_lo:[0,1] neg_hi:[0,1]
  v_pk_add_f32 v[110:111], v[110:111], v[210:211] neg_lo:[0,1] neg_hi:[0,1]
  v_mov_b32_dpp v144, v224 quad_perm:[0,0,0,0] row_mask:0xf bank_mask:0xf
  v_mov_b32_dpp v145, v226 quad_perm:[2,2,2,2] row_mask:0xf bank_mask:0xf
  v_cvt_pk_bf16_f32 v108, 0, v108
  v_cvt_pk_bf16_f32 v109, 0, v109
  v_add_f32_dpp v144, v225, v144 quad_perm:[1,1,1,1] row_mask:0xf bank_mask:0xf
  v_add_f32_dpp v145, v227, v145 quad_perm:[3,3,3,3] row_mask:0xf bank_mask:0xf
  v_cvt_pk_bf16_f32 v110, 0, v110
  v_cvt_pk_bf16_f32 v111, 0, v111
  v_add_f32 v229, v144, v145
  v_pk_mul_f32 v[108:109], v[108:109], v[196:197]
  v_pk_mul_f32 v[110:111], v[110:111], v[198:199]
  v_cvt_pk_bf16_f32 v218, v108, v109
  v_cvt_pk_bf16_f32 v219, v110, v111
  s_waitcnt vmcnt(14)
  buffer_load_dwordx4 v[76:79], v94, s[8:11], s60 offen offset:2816 nt
  v_mfma_f32_16x16x32_bf16 v[224:227], v[216:219], v[168:171], 0
  v_cvt_f32_i32 v108, v16
  v_cvt_f32_i32 v109, v17
  v_cvt_f32_i32 v110, v18
  v_cvt_f32_i32 v111, v19
  v_pk_add_f32 v[108:109], v[108:109], v[212:213] neg_lo:[0,1] neg_hi:[0,1]
  v_pk_add_f32 v[110:111], v[110:111], v[214:215] neg_lo:[0,1] neg_hi:[0,1]
  v_cvt_pk_bf16_f32 v108, 0, v108
  v_cvt_pk_bf16_f32 v228, 0, v228
  v_cvt_pk_bf16_f32 v109, 0, v109
  v_cvt_pk_bf16_f32 v229, 0, v229
  v_cvt_pk_bf16_f32 v110, 0, v110
  v_pk_mul_f32 v[228:229], v[228:229], s[68:69]
  v_cvt_pk_bf16_f32 v111, 0, v111
  v_cvt_pk_bf16_f32 v121, v228, v229
  v_pk_mul_f32 v[108:109], v[108:109], v[200:201]
  v_pk_mul_f32 v[110:111], v[110:111], v[202:203]
  v_cvt_pk_bf16_f32 v220, v108, v109
  v_cvt_pk_bf16_f32 v221, v110, v111
  s_waitcnt vmcnt(14)
  s_cbranch_vccnz L_kw1_15
  s_waitcnt vmcnt(9)
L_kw1_15:
  buffer_load_dwordx4 v[80:83], v95, s[8:11], s60 offen offset:0 nt
  v_mfma_f32_16x16x16_bf16 v[224:227], v[220:221], v[172:173], v[224:227]
  v_cvt_f32_i32 v108, v20
  v_cvt_f32_i32 v109, v21
  v_cvt_f32_i32 v110, v22
  v_cvt_f32_i32 v111, v23
  v_pk_add_f32 v[108:109], v[108:109], v[204:205] neg_lo:[0,1] neg_hi:[0,1]
  v_pk_add_f32 v[110:111], v[110:111], v[206:207] neg_lo:[0,1] neg_hi:[0,1]
  v_cvt_pk_bf16_f32 v108, 0, v108
  v_cvt_pk_bf16_f32 v109, 0, v109
  v_cvt_pk_bf16_f32 v110, 0, v110
  v_cvt_pk_bf16_f32 v111, 0, v111
  v_pk_mul_f32 v[108:109], v[108:109], v[192:193]
  v_pk_mul_f32 v[110:111], v[110:111], v[194:195]
  v_cvt_pk_bf16_f32 v216, v108, v109
  v_cvt_pk_bf16_f32 v217, v110, v111
  s_waitcnt vmcnt(14)
  buffer_load_dwordx4 v[84:87], v95, s[8:11], s60 offen offset:256 nt
  v_cvt_f32_i32 v108, v24
  v_cvt_f32_i32 v109, v25
  v_cvt_f32_i32 v110, v26
  v_cvt_f32_i32 v111, v27
  v_pk_add_f32 v[108:109], v[108:109], v[208:209] neg_lo:[0,1] neg_hi:[0,1]
  v_pk_add_f32 v[110:111], v[110:111], v[210:211] neg_lo:[0,1] neg_hi:[0,1]
  v_mov_b32_dpp v144, v224 quad_perm:[0,0,0,0] row_mask:0xf bank_mask:0xf
  v_mov_b32_dpp v145, v226 quad_perm:[2,2,2,2] row_mask:0xf bank_mask:0xf
  v_cvt_pk_bf16_f32 v108, 0, v108
  v_cvt_pk_bf16_f32 v109, 0, v109
  v_add_f32_dpp v144, v225, v144 quad_perm:[1,1,1,1] row_mask:0xf bank_mask:0xf
  v_add_f32_dpp v145, v227, v145 quad_perm:[3,3,3,3] row_mask:0xf bank_mask:0xf
  v_cvt_pk_bf16_f32 v110, 0, v110
  v_cvt_pk_bf16_f32 v111, 0, v111
  v_add_f32 v228, v144, v145
  v_pk_mul_f32 v[108:109], v[108:109], v[196:197]
  v_pk_mul_f32 v[110:111], v[110:111], v[198:199]
  v_cvt_pk_bf16_f32 v218, v108, v109
  v_cvt_pk_bf16_f32 v219, v110, v111
  s_waitcnt vmcnt(14)
  buffer_load_dwordx4 v[88:91], v95, s[8:11], s60 offen offset:512 nt
  v_mfma_f32_16x16x32_bf16 v[224:227], v[216:219], v[168:171], 0
  v_cvt_f32_i32 v108, v28
  v_cvt_f32_i32 v109, v29
  v_cvt_f32_i32 v110, v30
  v_cvt_f32_i32 v111, v31
  v_pk_add_f32 v[108:109], v[108:109], v[212:213] neg_lo:[0,1] neg_hi:[0,1]
  v_pk_add_f32 v[110:111], v[110:111], v[214:215] neg_lo:[0,1] neg_hi:[0,1]
  s_cmp_lt_u32 s64, s99
  s_cbranch_scc1 L_k_known1
L_k_spin1:
  v_mov_b32 v144, 61696
  ds_read_b32 v144, v144
  s_waitcnt lgkmcnt(0)
  v_readfirstlane_b32 s96, v144
  s_nop 1
  s_cmp_eq_u32 s96, 0
  s_cbranch_scc1 L_k_spin1
  s_mov_b32 s99, -1
L_k_known1:
  s_lshr_b32 s71, s64, 4
  s_andn2_b32 s71, s71, 1
  s_lshr_b32 s71, 0x12, s71
  s_and_b32 s71, s71, 3
  s_lshr_b32 s85, s96, s71
  s_andn2_b32 s70, s64, 1
  s_or_b32 s70, s70, s4
  s_cmp_lt_u32 s64, 8
  s_cselect_b32 s70, s70, s64
  s_cselect_b32 s85, s64, s85
  s_and_b32 s85, s85, 1
  s_and_b32 s70, s70, 31
  s_lshl_b32 s71, s71, 12
  s_add_u32 s70, s70, s5
  s_add_u32 s70, s70, s71
  s_mul_hi_u32 s84, s70, s90
  s_lshr_b32 s84, s84, 1
  s_mul_i32 s71, s84, 3
  s_sub_u32 s70, s70, s71
  s_lshl3_add_u32 s85, s70, s85
  s_mul_i32 s61, s84, 196608
  s_lshr_b32 s89, s84, 4
  s_lshl_b32 s70, s85, 5
  v_add_u32 v97, s70, v230
  v_mul_u32_u24 v97, 21846, v97
  v_lshrrev_b32 v97, 16, v97
  v_add_u32 v144, s85, v231
  v_lshrrev_b32 v145, v144, s91
  v_and_b32 v145, 1, v145
  v_cmp_eq_u32 s[54:55], 1, v145
  s_nop 1
  s_and_b64 s[52:53], s[54:55], s[56:57]
  s_andn2_b64 s[54:55], s[54:55], s[56:57]
  v_mul_u32_u24 v144, 43, v144
  v_lshrrev_b32 v144, 8, v144
  v_mul_u32_u24 v144, 384, v144
  v_add_u32 v234, v144, v233
  s_cmp_eq_u32 s89, s88
  s_cbranch_scc1 L_k_sameq1
  s_mul_i32 s70, s89, 1536
  buffer_load_dwordx2 v[174:175], v235, s[36:39], s70 offen offset:0
  buffer_load_dwordx2 v[176:177], v235, s[36:39], s70 offen offset:128
  buffer_load_dwordx2 v[178:179], v235, s[36:39], s70 offen offset:256
  s_mov_b32 s88, s89
L_k_sameq1:
  s_mul_i32 s62, s84, 1536
  buffer_load_dwordx2 v[180:181], v234, s[20:23], s62 offen offset:0
  buffer_load_dwordx2 v[186:187], v234, s[24:27], s62 offen offset:0
  buffer_load_dwordx2 v[182:183], v234, s[20:23], s62 offen offset:128
  buffer_load_dwordx2 v[188:189], v234, s[24:27], s62 offen offset:128
  buffer_load_dwordx2 v[184:185], v234, s[20:23], s62 offen offset:256
  buffer_load_dwordx2 v[190:191], v234, s[24:27], s62 offen offset:256
  v_cvt_pk_bf16_f32 v108, 0, v108
  v_cvt_pk_bf16_f32 v109, 0, v109
  v_cvt_pk_bf16_f32 v110, 0, v110
  v_cvt_pk_bf16_f32 v111, 0, v111
  v_pk_mul_f32 v[108:109], v[108:109], v[200:201]
  v_pk_mul_f32 v[110:111], v[110:111], v[202:203]
  v_cvt_pk_bf16_f32 v220, v108, v109
  v_cvt_pk_bf16_f32 v221, v110, v111
  s_cmp_lt_u32 s64, 96
  s_cbranch_scc1 L_k_keep
  s_lshr_b32 s71, s3, 5
  s_lshr_b32 s85, s96, s71
  s_bfe_u32 s85, s85, 0x10003
  s_and_b32 s70, s3, 31
  s_lshl_b32 s71, s71, 12
  s_add_u32 s70, s70, s5
  s_add_u32 s70, s70, s71
  s_mul_hi_u32 s84, s70, s90
  s_lshr_b32 s84, s84, 1
  s_mul_i32 s71, s84, 3
  s_sub_u32 s70, s70, s71
  s_lshl3_add_u32 s85, s70, s85
  s_mul_i32 s61, s84, 196608
  s_lshr_b32 s89, s84, 4
  s_lshl_b32 s70, s85, 5
  v_add_u32 v97, s70, v1
  v_mul_u32_u24 v97, 21846, v97
  v_lshrrev_b32 v97, 16, v97
  v_add_u32 v144, s85, v2
  v_lshrrev_b32 v145, v144, s91
  v_and_b32 v145, 1, v145
  v_cmp_eq_u32 s[54:55], 1, v145
  s_nop 1
  s_and_b64 s[52:53], s[54:55], s[58:59]
  s_andn2_b64 s[54:55], s[54:55], s[58:59]
  s_mov_b32 s16, s12
  s_mov_b32 s17, s13
  s_lshl_b32 s62, s84, 9
  v_lshl_add_u32 v98, v97, 1, v96
  buffer_load_short_d16_hi v112, v98, s[32:35], s62 offen
  buffer_load_short_d16_hi v113, v98, s[28:31], s62 offen
  v_mov_b32 v232, v3
L_k_keep:
  v_mad_u32_u24 v92, v97, s63, v232
  v_add_u32 v93, 768, v92
  v_add_u32 v94, 4608, v92
  v_add_u32 v95, 7680, v92
  v_cndmask_b32 v92, v92, v105, s[52:53]
  v_cndmask_b32 v95, v95, v105, s[54:55]
  s_waitcnt vmcnt(20)
  s_cbranch_vccnz L_kw1_18
  s_waitcnt vmcnt(15)
L_kw1_18:
  buffer_load_dwordx4 v[4:7], v92, s[16:19], s61 offen offset:0 nt
  v_mfma_f32_16x16x16_bf16 v[224:227], v[220:221], v[172:173], v[224:227]
  v_cvt_f32_i32 v108, v32
  v_cvt_f32_i32 v109, v33
  v_cvt_f32_i32 v110, v34
  v_cvt_f32_i32 v111, v35
  v_pk_add_f32 v[108:109], v[108:109], v[204:205] neg_lo:[0,1] neg_hi:[0,1]
  v_pk_add_f32 v[110:111], v[110:111], v[206:207] neg_lo:[0,1] neg_hi:[0,1]
  v_cvt_pk_bf16_f32 v108, 0, v108
  v_cvt_pk_bf16_f32 v109, 0, v109
  v_cvt_pk_bf16_f32 v110, 0, v110
  v_cvt_pk_bf16_f32 v111, 0, v111
  v_pk_mul_f32 v[108:109], v[108:109], v[192:193]
  v_pk_mul_f32 v[110:111], v[110:111], v[194:195]
  v_cvt_pk_bf16_f32 v216, v108, v109
  v_cvt_pk_bf16_f32 v217, v110, v111
  s_waitcnt vmcnt(20)
  buffer_load_dwordx4 v[8:11], v92, s[16:19], s61 offen offset:256 nt
  v_cvt_f32_i32 v108, v36
  v_cvt_f32_i32 v109, v37
  v_cvt_f32_i32 v110, v38
  v_cvt_f32_i32 v111, v39
  v_pk_add_f32 v[108:109], v[108:109], v[208:209] neg_lo:[0,1] neg_hi:[0,1]
  v_pk_add_f32 v[110:111], v[110:111], v[210:211] neg_lo:[0,1] neg_hi:[0,1]
  v_mov_b32_dpp v144, v224 quad_perm:[0,0,0,0] row_mask:0xf bank_mask:0xf
  v_mov_b32_dpp v145, v226 quad_perm:[2,2,2,2] row_mask:0xf bank_mask:0xf
  v_cvt_pk_bf16_f32 v108, 0, v108
  v_cvt_pk_bf16_f32 v109, 0, v109
  v_add_f32_dpp v144, v225, v144 quad_perm:[1,1,1,1] row_mask:0xf bank_mask:0xf
  v_add_f32_dpp v145, v227, v145 quad_perm:[3,3,3,3] row_mask:0xf bank_mask:0xf
  v_cvt_pk_bf16_f32 v110, 0, v110
  v_cvt_pk_bf16_f32 v111, 0, v111
  v_add_f32 v229, v144, v145
  v_pk_mul_f32 v[108:109], v[108:109], v[196:197]
  v_pk_mul_f32 v[110:111], v[110:111], v[198:199]
  v_cvt_pk_bf16_f32 v218, v108, v109
  v_cvt_pk_bf16_f32 v219, v110, v111
  s_waitcnt vmcnt(20)
  buffer_load_dwordx4 v[12:15], v92, s[16:19], s61 offen offset:512 nt
  v_mfma_f32_16x16x32_bf16 v[224:227], v[216:219], v[168:171], 0
  v_cvt_f32_i32 v108, v40
  v_cvt_f32_i32 v109, v41
  v_cvt_f32_i32 v110, v42
  v_cvt_f32_i32 v111, v43
  v_pk_add_f32 v[108:109], v[108:109], v[212:213] neg_lo:[0,1] neg_hi:[0,1]
  v_pk_add_f32 v[110:111], v[110:111], v[214:215] neg_lo:[0,1] neg_hi:[0,1]
  v_cvt_pk_bf16_f32 v108, 0, v108
  v_cvt_pk_bf16_f32 v228, 0, v228
  v_cvt_pk_bf16_f32 v109, 0, v109
  v_cvt_pk_bf16_f32 v229, 0, v229
  v_cvt_pk_bf16_f32 v110, 0, v110
  v_pk_mul_f32 v[228:229], v[228:229], s[68:69]
  v_cvt_pk_bf16_f32 v111, 0, v111
  v_cvt_pk_bf16_f32 v122, v228, v229
  v_pk_mul_f32 v[108:109], v[108:109], v[200:201]
  v_pk_mul_f32 v[110:111], v[110:111], v[202:203]
  v_cvt_pk_bf16_f32 v220, v108, v109
  v_cvt_pk_bf16_f32 v221, v110, v111
  s_waitcnt vmcnt(20)
  s_cbranch_vccnz L_kw1_21
  s_waitcnt vmcnt(15)
L_kw1_21:
  buffer_load_dwordx4 v[16:19], v93, s[16:19], s61 offen offset:0 nt
  v_mfma_f32_16x16x16_bf16 v[224:227], v[220:221], v[172:173], v[224:227]
  v_cvt_f32_i32 v108, v44
  v_cvt_f32_i32 v109, v45
  v_cvt_f32_i32 v110, v46
  v_cvt_f32_i32 v111, v47
  v_pk_add_f32 v[108:109], v[108:109], v[204:205] neg_lo:[0,1] neg_hi:[0,1]
  v_pk_add_f32 v[110:111], v[110:111], v[206:207] neg_lo:[0,1] neg_hi:[0,1]
  v_cvt_pk_bf16_f32 v108, 0, v108
  v_cvt_pk_bf16_f32 v109, 0, v109
  v_cvt_pk_bf16_f32 v110, 0, v110
  v_cvt_pk_bf16_f32 v111, 0, v111
  v_pk_mul_f32 v[108:109], v[108:109], v[192:193]
  v_pk_mul_f32 v[110:111], v[110:111], v[194:195]
  v_cvt_pk_bf16_f32 v216, v108, v109
  v_cvt_pk_bf16_f32 v217, v110, v111
  s_waitcnt vmcnt(20)
  buffer_load_dwordx4 v[20:23], v93, s[16:19], s61 offen offset:256 nt
  v_cvt_f32_i32 v108, v48
  v_cvt_f32_i32 v109, v49
  v_cvt_f32_i32 v110, v50
  v_cvt_f32_i32 v111, v51
  v_pk_add_f32 v[108:109], v[108:109], v[208:209] neg_lo:[0,1] neg_hi:[0,1]
  v_pk_add_f32 v[110:111], v[110:111], v[210:211] neg_lo:[0,1] neg_hi:[0,1]
  v_mov_b32_dpp v144, v224 quad_perm:[0,0,0,0] row_mask:0xf bank_mask:0xf
  v_mov_b32_dpp v145, v226 quad_perm:[2,2,2,2] row_mask:0xf bank_mask:0xf
  v_cvt_pk_bf16_f32 v108, 0, v108
  v_cvt_pk_bf16_f32 v109, 0, v109
  v_add_f32_dpp v144, v225, v144 quad_perm:[1,1,1,1] row_mask:0xf bank_mask:0xf
  v_add_f32_dpp v145, v227, v145 quad_perm:[3,3,3,3] row_mask:0xf bank_mask:0xf
  v_cvt_pk_bf16_f32 v110, 0, v110
  v_cvt_pk_bf16_f32 v111, 0, v111
  v_add_f32 v228, v144, v145
  v_pk_mul_f32 v[108:109], v[108:109], v[196:197]
  v_pk_mul_f32 v[110:111], v[110:111], v[198:199]
  v_cvt_pk_bf16_f32 v218, v108, v109
  v_cvt_pk_bf16_f32 v219, v110, v111
  s_waitcnt vmcnt(20)
  buffer_load_dwordx4 v[24:27], v93, s[16:19], s61 offen offset:512 nt
  v_mfma_f32_16x16x32_bf16 v[224:227], v[216:219], v[168:171], 0
  v_cvt_f32_i32 v108, v52
  v_cvt_f32_i32 v109, v53
  v_cvt_f32_i32 v110, v54
  v_cvt_f32_i32 v111, v55
  v_pk_add_f32 v[108:109], v[108:109], v[212:213] neg_lo:[0,1] neg_hi:[0,1]
  v_pk_add_f32 v[110:111], v[110:111], v[214:215] neg_lo:[0,1] neg_hi:[0,1]
  v_cvt_pk_bf16_f32 v108, 0, v108
  v_cvt_pk_bf16_f32 v109, 0, v109
  v_cvt_pk_bf16_f32 v110, 0, v110
  v_cvt_pk_bf16_f32 v111, 0, v111
  v_pk_mul_f32 v[108:109], v[108:109], v[200:201]
  v_pk_mul_f32 v[110:111], v[110:111], v[202:203]
  v_cvt_pk_bf16_f32 v220, v108, v109
  v_cvt_pk_bf16_f32 v221, v110, v111
  s_waitcnt vmcnt(20)
  s_cbranch_vccnz L_kw1_24
  s_waitcnt vmcnt(15)
L_kw1_24:
  buffer_load_dwordx4 v[28:31], v93, s[16:19], s61 offen offset:768 nt
  v_mfma_f32_16x16x16_bf16 v[224:227], v[220:221], v[172:173], v[224:227]
  v_cvt_f32_i32 v108, v56
  v_cvt_f32_i32 v109, v57
  v_cvt_f32_i32 v110, v58
  v_cvt_f32_i32 v111, v59
  v_pk_add_f32 v[108:109], v[108:109], v[204:205] neg_lo:[0,1] neg_hi:[0,1]
  v_pk_add_f32 v[110:111], v[110:111], v[206:207] neg_lo:[0,1] neg_hi:[0,1]
  v_cvt_pk_bf16_f32 v108, 0, v108
  v_cvt_pk_bf16_f32 v109, 0, v109
  v_cvt_pk_bf16_f32 v110, 0, v110
  v_cvt_pk_bf16_f32 v111, 0, v111
  v_pk_mul_f32 v[108:109], v[108:109], v[192:193]
  v_pk_mul_f32 v[110:111], v[110:111], v[194:195]
  v_cvt_pk_bf16_f32 v216, v108, v109
  v_cvt_pk_bf16_f32 v217, v110, v111
  s_waitcnt vmcnt(20)
  buffer_load_dwordx4 v[32:35], v93, s[16:19], s61 offen offset:1024 nt
  v_cvt_f32_i32 v108, v60
  v_cvt_f32_i32 v109, v61
  v_cvt_f32_i32 v110, v62
  v_cvt_f32_i32 v111, v63
  v_pk_add_f32 v[108:109], v[108:109], v[208:209] neg_lo:[0,1] neg_hi:[0,1]
  v_pk_add_f32 v[110:111], v[110:111], v[210:211] neg_lo:[0,1] neg_hi:[0,1]
  v_mov_b32_dpp v144, v224 quad_perm:[0,0,0,0] row_mask:0xf bank_mask:0xf
  v_mov_b32_dpp v145, v226 quad_perm:[2,2,2,2] row_mask:0xf bank_mask:0xf
  v_cvt_pk_bf16_f32 v108, 0, v108
  v_cvt_pk_bf16_f32 v109, 0, v109
  v_add_f32_dpp v144, v225, v144 quad_perm:[1,1,1,1] row_mask:0xf bank_mask:0xf
  v_add_f32_dpp v145, v227, v145 quad_perm:[3,3,3,3] row_mask:0xf bank_mask:0xf
  v_cvt_pk_bf16_f32 v110, 0, v110
  v_cvt_pk_bf16_f32 v111, 0, v111
  v_add_f32 v229, v144, v145
  v_pk_mul_f32 v[108:109], v[108:109], v[196:197]
  v_pk_mul_f32 v[110:111], v[110:111], v[198:199]
  v_cvt_pk_bf16_f32 v218, v108, v109
  v_cvt_pk_bf16_f32 v219, v110, v111
  s_waitcnt vmcnt(20)
  buffer_load_dwordx4 v[36:39], v93, s[16:19], s61 offen offset:1280 nt
  v_mfma_f32_16x16x32_bf16 v[224:227], v[216:219], v[168:171], 0
  v_cvt_f32_i32 v108, v64
  v_cvt_f32_i32 v109, v65
  v_cvt_f32_i32 v110, v66
  v_cvt_f32_i32 v111, v67
  v_pk_add_f32 v[108:109], v[108:109], v[212:213] neg_lo:[0,1] neg_hi:[0,1]
  v_pk_add_f32 v[110:111], v[110:111], v[214:215] neg_lo:[0,1] neg_hi:[0,1]
  v_cvt_pk_bf16_f32 v108, 0, v108
  v_cvt_pk_bf16_f32 v228, 0, v228
  v_cvt_pk_bf16_f32 v109, 0, v109
  v_cvt_pk_bf16_f32 v229, 0, v229
  v_cvt_pk_bf16_f32 v110, 0, v110
  v_pk_mul_f32 v[228:229], v[228:229], s[68:69]
  v_cvt_pk_bf16_f32 v111, 0, v111
  v_cvt_pk_bf16_f32 v123, v228, v229
  v_pk_mul_f32 v[108:109], v[108:109], v[200:201]
  v_pk_mul_f32 v[110:111], v[110:111], v[202:203]
  v_cvt_pk_bf16_f32 v220, v108, v109
  v_cvt_pk_bf16_f32 v221, v110, v111
  s_waitcnt vmcnt(20)
  s_cbranch_vccnz L_kw1_27
  s_waitcnt vmcnt(15)
L_kw1_27:
  buffer_load_dwordx4 v[40:43], v93, s[16:19], s61 offen offset:1536 nt
  v_mfma_f32_16x16x16_bf16 v[224:227], v[220:221], v[172:173], v[224:227]
  v_cvt_f32_i32 v108, v68
  v_cvt_f32_i32 v109, v69
  v_cvt_f32_i32 v110, v70
  v_cvt_f32_i32 v111, v71
  v_pk_add_f32 v[108:109], v[108:109], v[204:205] neg_lo:[0,1] neg_hi:[0,1]
  v_pk_add_f32 v[110:111], v[110:111], v[206:207] neg_lo:[0,1] neg_hi:[0,1]
  v_cvt_pk_bf16_f32 v108, 0, v108
  v_cvt_pk_bf16_f32 v109, 0, v109
  v_cvt_pk_bf16_f32 v110, 0, v110
  v_cvt_pk_bf16_f32 v111, 0, v111
  v_pk_mul_f32 v[108:109], v[108:109], v[192:193]
  v_pk_mul_f32 v[110:111], v[110:111], v[194:195]
  v_cvt_pk_bf16_f32 v216, v108, v109
  v_cvt_pk_bf16_f32 v217, v110, v111
  s_waitcnt vmcnt(20)
  buffer_load_dwordx4 v[44:47], v93, s[16:19], s61 offen offset:1792 nt
  v_cvt_f32_i32 v108, v72
  v_cvt_f32_i32 v109, v73
  v_cvt_f32_i32 v110, v74
  v_cvt_f32_i32 v111, v75
  v_pk_add_f32 v[108:109], v[108:109], v[208:209] neg_lo:[0,1] neg_hi:[0,1]
  v_pk_add_f32 v[110:111], v[110:111], v[210:211] neg_lo:[0,1] neg_hi:[0,1]
  v_mov_b32_dpp v144, v224 quad_perm:[0,0,0,0] row_mask:0xf bank_mask:0xf
  v_mov_b32_dpp v145, v226 quad_perm:[2,2,2,2] row_mask:0xf bank_mask:0xf
  v_cvt_pk_bf16_f32 v108, 0, v108
  v_cvt_pk_bf16_f32 v109, 0, v109
  v_add_f32_dpp v144, v225, v144 quad_perm:[1,1,1,1] row_mask:0xf bank_mask:0xf
  v_add_f32_dpp v145, v227, v145 quad_perm:[3,3,3,3] row_mask:0xf bank_mask:0xf
  v_cvt_pk_bf16_f32 v110, 0, v110
  v_cvt_pk_bf16_f32 v111, 0, v111
  v_add_f32 v228, v144, v145
  v_pk_mul_f32 v[108:109], v[108:109], v[196:197]
  v_pk_mul_f32 v[110:111], v[110:111], v[198:199]
  v_cvt_pk_bf16_f32 v218, v108, v109
  v_cvt_pk_bf16_f32 v219, v110, v111
  s_waitcnt vmcnt(20)
  buffer_load_dwordx4 v[48:51], v93, s[16:19], s61 offen offset:2048 nt
  v_mfma_f32_16x16x32_bf16 v[224:227], v[216:219], v[168:171], 0
  v_cvt_f32_i32 v108, v76
  v_cvt_f32_i32 v109, v77
  v_cvt_f32_i32 v110, v78
  v_cvt_f32_i32 v111, v79
  v_pk_add_f32 v[108:109], v[108:109], v[212:213] neg_lo:[0,1] neg_hi:[0,1]
  v_pk_add_f32 v[110:111], v[110:111], v[214:215] neg_lo:[0,1] neg_hi:[0,1]
  v_cvt_pk_bf16_f32 v108, 0, v108
  v_cvt_pk_bf16_f32 v109, 0, v109
  v_cvt_pk_bf16_f32 v110, 0, v110
  v_cvt_pk_bf16_f32 v111, 0, v111
  v_pk_mul_f32 v[108:109], v[108:109], v[200:201]
  v_pk_mul_f32 v[110:111], v[110:111], v[202:203]
  v_cvt_pk_bf16_f32 v220, v108, v109
  v_cvt_pk_bf16_f32 v221, v110, v111
  s_waitcnt vmcnt(20)
  s_cbranch_vccnz L_kw1_30
  s_waitcnt vmcnt(9)
L_kw1_30:
  buffer_load_dwordx4 v[52:55], v93, s[16:19], s61 offen offset:2304 nt
  v_mfma_f32_16x16x16_bf16 v[224:227], v[220:221], v[172:173], v[224:227]
  v_cvt_f32_i32 v108, v80
  v_cvt_f32_i32 v109, v81
  v_cvt_f32_i32 v110, v82
  v_cvt_f32_i32 v111, v83
  v_pk_add_f32 v[108:109], v[108:109], v[204:205] neg_lo:[0,1] neg_hi:[0,1]
  v_pk_add_f32 v[110:111], v[110:111], v[206:207] neg_lo:[0,1] neg_hi:[0,1]
  v_cvt_pk_bf16_f32 v108, 0, v108
  v_cvt_pk_bf16_f32 v109, 0, v109
  v_cvt_pk_bf16_f32 v110, 0, v110
  v_cvt_pk_bf16_f32 v111, 0, v111
  v_pk_mul_f32 v[108:109], v[108:109], v[192:193]
  v_pk_mul_f32 v[110:111], v[110:111], v[194:195]
  v_cvt_pk_bf16_f32 v216, v108, v109
  v_cvt_pk_bf16_f32 v217, v110, v111
  s_waitcnt vmcnt(20)
  buffer_load_dwordx4 v[56:59], v93, s[16:19], s61 offen offset:2560 nt
  v_cvt_f32_i32 v108, v84
  v_cvt_f32_i32 v109, v85
  v_cvt_f32_i32 v110, v86
  v_cvt_f32_i32 v111, v87
  v_pk_add_f32 v[108:109], v[108:109], v[208:209] neg_lo:[0,1] neg_hi:[0,1]
  v_pk_add_f32 v[110:111], v[110:111], v[210:211] neg_lo:[0,1] neg_hi:[0,1]
  v_mov_b32_dpp v144, v224 quad_perm:[0,0,0,0] row_mask:0xf bank_mask:0xf
  v_mov_b32_dpp v145, v226 quad_perm:[2,2,2,2] row_mask:0xf bank_mask:0xf
  v_cvt_pk_bf16_f32 v108, 0, v108
  v_cvt_pk_bf16_f32 v109, 0, v109
  v_add_f32_dpp v144, v225, v144 quad_perm:[1,1,1,1] row_mask:0xf bank_mask:0xf
  v_add_f32_dpp v145, v227, v145 quad_perm:[3,3,3,3] row_mask:0xf bank_mask:0xf
  v_cvt_pk_bf16_f32 v110, 0, v110
  v_cvt_pk_bf16_f32 v111, 0, v111
  v_add_f32 v229, v144, v145
  v_pk_mul_f32 v[108:109], v[108:109], v[196:197]
  v_pk_mul_f32 v[110:111], v[110:111], v[198:199]
  v_cvt_pk_bf16_f32 v218, v108, v109
  v_cvt_pk_bf16_f32 v219, v110, v111
  s_waitcnt vmcnt(20)
  buffer_load_dwordx4 v[60:63], v93, s[16:19], s61 offen offset:2816 nt
  v_mfma_f32_16x16x32_bf16 v[224:227], v[216:219], v[168:171], 0
  v_cvt_f32_i32 v108, v88
  v_cvt_f32_i32 v109, v89
  v_cvt_f32_i32 v110, v90
  v_cvt_f32_i32 v111, v91
  v_pk_add_f32 v[108:109], v[108:109], v[212:213] neg_lo:[0,1] neg_hi:[0,1]
  v_pk_add_f32 v[110:111], v[110:111], v[214:215] neg_lo:[0,1] neg_hi:[0,1]
  v_cvt_pk_bf16_f32 v108, 0, v108
  v_cvt_pk_bf16_f32 v228, 0, v228
  v_cvt_pk_bf16_f32 v109, 0, v109
  v_cvt_pk_bf16_f32 v229, 0, v229
  v_cvt_pk_bf16_f32 v110, 0, v110
  v_pk_mul_f32 v[228:229], v[228:229], s[68:69]
  v_cvt_pk_bf16_f32 v111, 0, v111
  v_cvt_pk_bf16_f32 v124, v228, v229
  v_pk_mul_f32 v[108:109], v[108:109], v[200:201]
  v_pk_mul_f32 v[110:111], v[110:111], v[202:203]
  v_cvt_pk_bf16_f32 v220, v108, v109
  v_cvt_pk_bf16_f32 v221, v110, v111
  s_mov_b32 s60, s61
  v_mov_b32 v146, s64
  v_mfma_f32_16x16x16_bf16 v[224:227], v[220:221], v[172:173], v[224:227]
  ds_write_b128 v99, v[120:123]
  v_add_u32 v99, 768, v99
  s_nop 5
  v_mov_b32_dpp v144, v224 quad_perm:[0,0,0,0] row_mask:0xf bank_mask:0xf
  v_mov_b32_dpp v145, v226 quad_perm:[2,2,2,2] row_mask:0xf bank_mask:0xf
  s_nop 0
  v_add_f32_dpp v144, v225, v144 quad_perm:[1,1,1,1] row_mask:0xf bank_mask:0xf
  v_add_f32_dpp v145, v227, v145 quad_perm:[3,3,3,3] row_mask:0xf bank_mask:0xf
  v_add_f32 v228, v144, v145
  v_cndmask_b32 v228, v228, v236, s[50:51]
  v_cvt_pk_bf16_f32 v228, 0, v228
  v_cvt_pk_bf16_f32 v229, 0, v229
  v_pk_mul_f32 v[228:229], v[228:229], s[68:69]
  v_cvt_pk_bf16_f32 v125, v228, v229
  ds_write_b64 v100, v[124:125] offset:256
  ds_write_b32 v104, v146
  v_add_u32 v100, 768, v100
  s_cmp_lt_u32 s64, 96
  s_cbranch_scc1 L_k
  v_subrev_u32 v99, 24576, v99
  v_subrev_u32 v100, 24576, v100
  s_mov_b32 s64, s3
  s_mov_b32 s88, s89
  s_mov_b32 s99, 0
  s_mov_b32 s36, s46
  s_and_b32 s37, s47, 0xffff
  s_cmp_lt_u32 s64, s99
  s_cbranch_scc1 L_v0_ok
L_v0_spin:
  v_mov_b32 v144, 61700
  ds_read_b32 v144, v144
  s_waitcnt lgkmcnt(0)
  v_readfirstlane_b32 s99, v144
  s_nop 1
  s_cmp_lt_u32 s64, s99
  s_cbranch_scc0 L_v0_spin
L_v0_ok:
  ds_read_b128 v[120:123], v99
  ds_read_b64 v[124:125], v100 offset:256
  v_mov_b32 v128, 0
  v_mov_b32 v129, 0
  v_mov_b32 v130, 0
  v_mov_b32 v131, 0
  v_mov_b32 v132, 0
  v_mov_b32 v133, 0
  v_mov_b32 v134, 0
  v_mov_b32 v135, 0
  v_mov_b32 v136, 0
  v_mov_b32 v137, 0
  v_mov_b32 v138, 0
  v_mov_b32 v139, 0
  v_mov_b32 v140, 0xff800000
  v_mov_b32 v142, 0x7f800000
  v_mov_b32 v143, 0
L_v0:
  s_add_u32 s97, s64, 96
  v_mov_b32 v146, s97
  s_mov_b32 s86, s84
  ds_write_b32 v104, v146
  s_add_u32 s64, s64, 2
  s_cmp_lt_u32 s64, s99
  s_cbranch_scc1 L_v10_ok
L_v10_spin:
  v_mov_b32 v144, 61700
  ds_read_b32 v144, v144
  s_waitcnt lgkmcnt(0)
  v_readfirstlane_b32 s99, v144
  s_nop 1
  s_cmp_lt_u32 s64, s99
  s_cbranch_scc0 L_v10_spin
L_v10_ok:
  s_lshr_b32 s71, s64, 5
  s_lshr_b32 s85, s96, s71
  s_bfe_u32 s85, s85, 0x10003
  s_and_b32 s70, s64, 31
  s_lshl_b32 s71, s71, 12
  s_add_u32 s70, s70, s5
  s_add_u32 s70, s70, s71
  s_mul_hi_u32 s84, s70, s90
  s_lshr_b32 s84, s84, 1
  s_mul_i32 s71, s84, 3
  s_sub_u32 s70, s70, s71
  s_lshl3_add_u32 s85, s70, s85
  s_mul_i32 s61, s84, 196608
  s_lshr_b32 s89, s84, 4
  s_lshl_b32 s70, s85, 5
  v_add_u32 v97, s70, v1
  v_mul_u32_u24 v97, 21846, v97
  v_lshrrev_b32 v97, 16, v97
  v_add_u32 v144, s85, v2
  v_lshrrev_b32 v145, v144, s91
  v_and_b32 v145, 1, v145
  v_cmp_eq_u32 s[54:55], 1, v145
  s_nop 1
  s_and_b64 s[52:53], s[54:55], s[58:59]
  s_andn2_b64 s[54:55], s[54:55], s[58:59]
  s_cmp_lt_u32 s64, 96
  s_cselect_b32 s61, s61, 805306368
  ds_read_b32 v106, v104 offset:8
  s_waitcnt vmcnt(14)
  s_cbranch_vccnz L_vw0_0
  s_waitcnt vmcnt(9)
L_vw0_0:
  buffer_load_dwordx4 v[64:67], v93, s[12:15], s60 offen offset:3072 nt
  v_mov_b32 v114, v112
  v_mov_b32 v115, v113
  v_cvt_f32_i32 v192, v4
  v_cvt_f32_i32 v193, v5
  v_mov_b32_dpp v116, v114 row_newbcast:0 row_mask:0xf bank_mask:0xf
  v_mov_b32_dpp v117, v115 row_newbcast:0 row_mask:0xf bank_mask:0xf
  v_cvt_f32_i32 v194, v6
  v_cvt_f32_i32 v195, v7
  v_pk_add_f32 v[192:193], v[192:193], v[116:117] op_sel_hi:[1,0] neg_lo:[0,1] neg_hi:[0,1]
  v_pk_add_f32 v[194:195], v[194:195], v[116:117] op_sel_hi:[1,0] neg_lo:[0,1] neg_hi:[0,1]
  v_cvt_pk_bf16_f32 v192, 0, v192
  v_cvt_pk_bf16_f32 v193, 0, v193
  v_cvt_pk_bf16_f32 v194, 0, v194
  v_cvt_pk_bf16_f32 v195, 0, v195
  v_pk_mul_f32 v[192:193], v[192:193], v[116:117] op_sel:[0,1]
  v_pk_mul_f32 v[194:195], v[194:195], v[116:117] op_sel:[0,1]
  s_waitcnt lgkmcnt(0)
  v_cmp_lt_u32 vcc, s97, v106
  s_waitcnt vmcnt(14)
  buffer_load_dwordx4 v[68:71], v93, s[12:15], s60 offen offset:3328 nt
  v_cvt_f32_i32 v196, v8
  v_cvt_f32_i32 v197, v9
  v_cvt_f32_i32 v198, v10
  v_cvt_f32_i32 v199, v11
  v_pk_add_f32 v[196:197], v[196:197], v[116:117] op_sel_hi:[1,0] neg_lo:[0,1] neg_hi:[0,1]
  v_pk_add_f32 v[198:199], v[198:199], v[116:117] op_sel_hi:[1,0] neg_lo:[0,1] neg_hi:[0,1]
  v_cvt_pk_bf16_f32 v196, 0, v196
  v_lshlrev_b32 v148, 16, v120
  v_cvt_pk_bf16_f32 v197, 0, v197
  v_and_b32 v149, s65, v120
  v_cvt_pk_bf16_f32 v198, 0, v198
  v_lshlrev_b32 v150, 16, v121
  v_cvt_pk_bf16_f32 v199, 0, v199
  v_and_b32 v151, s65, v121
  v_pk_mul_f32 v[196:197], v[196:197], v[116:117] op_sel:[0,1]
  v_lshlrev_b32 v152, 16, v122
  v_pk_mul_f32 v[198:199], v[198:199], v[116:117] op_sel:[0,1]
  s_waitcnt vmcnt(14)
  buffer_load_dwordx4 v[72:75], v93, s[12:15], s60 offen offset:3584 nt
  v_cvt_f32_i32 v200, v12
  v_cvt_f32_i32 v201, v13
  v_cvt_f32_i32 v202, v14
  v_cvt_f32_i32 v203, v15
  v_pk_add_f32 v[200:201], v[200:201], v[116:117] op_sel_hi:[1,0] neg_lo:[0,1] neg_hi:[0,1]
  v_pk_add_f32 v[202:203], v[202:203], v[116:117] op_sel_hi:[1,0] neg_lo:[0,1] neg_hi:[0,1]
  v_cvt_pk_bf16_f32 v200, 0, v200
  v_and_b32 v153, s65, v122
  v_cvt_pk_bf16_f32 v201, 0, v201
  v_lshlrev_b32 v154, 16, v123
  v_cvt_pk_bf16_f32 v202, 0, v202
  v_and_b32 v155, s65, v123
  v_cvt_pk_bf16_f32 v203, 0, v203
  v_lshlrev_b32 v156, 16, v124
  v_pk_mul_f32 v[200:201], v[200:201], v[116:117] op_sel:[0,1]
  v_and_b32 v157, s65, v124
  v_pk_mul_f32 v[202:203], v[202:203], v[116:117] op_sel:[0,1]
  s_waitcnt vmcnt(14)
  s_cbranch_vccnz L_vw0_3
  s_waitcnt vmcnt(9)
L_vw0_3:
  buffer_load_dwordx4 v[76:79], v94, s[12:15], s60 offen offset:0 nt
  v_cvt_f32_i32 v108, v16
  v_cvt_f32_i32 v109, v17
  v_mov_b32_dpp v116, v114 row_newbcast:1 row_mask:0xf bank_mask:0xf
  v_mov_b32_dpp v117, v115 row_newbcast:1 row_mask:0xf bank_mask:0xf
  v_cvt_f32_i32 v110, v18
  v_cvt_f32_i32 v111, v19
  v_pk_add_f32 v[108:109], v[108:109], v[116:117] op_sel_hi:[1,0] neg_lo:[0,1] neg_hi:[0,1]
  v_pk_add_f32 v[110:111], v[110:111], v[116:117] op_sel_hi:[1,0] neg_lo:[0,1] neg_hi:[0,1]
  s_lshl_b32 s62, s84, 9
  v_lshl_add_u32 v98, v97, 1, v96
  buffer_load_short_d16_hi v112, v98, s[32:35], s62 offen
  buffer_load_short_d16_hi v113, v98, s[28:31], s62 offen
  v_cvt_pk_bf16_f32 v108, 0, v108
  v_lshlrev_b32 v158, 16, v125
  v_cvt_pk_bf16_f32 v109, 0, v109
  v_add_u32 v99, 768, v99
  v_cvt_pk_bf16_f32 v110, 0, v110
  v_add_u32 v100, 768, v100
  v_cvt_pk_bf16_f32 v111, 0, v111
  v_max3_f32 v144, v148, v149, v150
  v_pk_mul_f32 v[108:109], v[108:109], v[116:117] op_sel:[0,1]
  ds_read_b128 v[120:123], v99
  v_pk_mul_f32 v[110:111], v[110:111], v[116:117] op_sel:[0,1]
  v_cvt_pk_bf16_f32 v204, v192, v108
  v_cvt_pk_bf16_f32 v208, v193, v109
  v_cvt_pk_bf16_f32 v212, v194, v110
  v_cvt_pk_bf16_f32 v216, v195, v111
  s_waitcnt vmcnt(16)
  buffer_load_dwordx4 v[80:83], v94, s[12:15], s60 offen offset:256 nt
  v_cvt_f32_i32 v108, v20
  v_cvt_f32_i32 v109, v21
  v_cvt_f32_i32 v110, v22
  v_cvt_f32_i32 v111, v23
  v_pk_add_f32 v[108:109], v[108:109], v[116:117] op_sel_hi:[1,0] neg_lo:[0,1] neg_hi:[0,1]
  v_pk_add_f32 v[110:111], v[110:111], v[116:117] op_sel_hi:[1,0] neg_lo:[0,1] neg_hi:[0,1]
  v_cvt_pk_bf16_f32 v108, 0, v108
  ds_read_b64 v[124:125], v100 offset:256
  v_cvt_pk_bf16_f32 v109, 0, v109
  v_max3_f32 v145, v151, v152, v153
  v_cvt_pk_bf16_f32 v110, 0, v110
  v_max3_f32 v144, v144, v154, v155
  v_cvt_pk_bf16_f32 v111, 0, v111
  v_max3_f32 v145, v145, v156, v157
  v_pk_mul_f32 v[108:109], v[108:109], v[116:117] op_sel:[0,1]
  v_max3_f32 v144, v144, v158, v140
  v_pk_mul_f32 v[110:111], v[110:111], v[116:117] op_sel:[0,1]
  v_cvt_pk_bf16_f32 v220, v196, v108
  v_cvt_pk_bf16_f32 v224, v197, v109
  v_cvt_pk_bf16_f32 v228, v198, v110
  v_cvt_pk_bf16_f32 v232, v199, v111
  s_waitcnt vmcnt(16)
  buffer_load_dwordx4 v[84:87], v94, s[12:15], s60 offen offset:512 nt
  v_cvt_f32_i32 v108, v24
  v_cvt_f32_i32 v109, v25
  v_cvt_f32_i32 v110, v26
  v_cvt_f32_i32 v111, v27
  v_pk_add_f32 v[108:109], v[108:109], v[116:117] op_sel_hi:[1,0] neg_lo:[0,1] neg_hi:[0,1]
  v_pk_add_f32 v[110:111], v[110:111], v[116:117] op_sel_hi:[1,0] neg_lo:[0,1] neg_hi:[0,1]
  v_cvt_pk_bf16_f32 v108, 0, v108
  v_max_f32 v144, v144, v145
  v_cvt_pk_bf16_f32 v109, 0, v109
  v_mov_b32 v145, v144
  v_cvt_pk_bf16_f32 v110, 0, v110
  s_nop 0
  v_permlane32_swap_b32 v144, v145
  v_cvt_pk_bf16_f32 v111, 0, v111
  v_max_f32 v144, v144, v145
  v_pk_mul_f32 v[108:109], v[108:109], v[116:117] op_sel:[0,1]
  v_mov_b32 v145, v144
  v_pk_mul_f32 v[110:111], v[110:111], v[116:117] op_sel:[0,1]
  v_cvt_pk_bf16_f32 v236, v200, v108
  v_cvt_pk_bf16_f32 v240, v201, v109
  v_cvt_pk_bf16_f32 v244, v202, v110
  v_cvt_pk_bf16_f32 v248, v203, v111
  s_waitcnt vmcnt(16)
  s_cbranch_vccnz L_vw0_6
  s_waitcnt vmcnt(11)
L_vw0_6:
  buffer_load_dwordx4 v[88:91], v94, s[12:15], s60 offen offset:768 nt
  v_cvt_f32_i32 v192, v28
  v_cvt_f32_i32 v193, v29
  v_mov_b32_dpp v116, v114 row_newbcast:2 row_mask:0xf bank_mask:0xf
  v_mov_b32_dpp v117, v115 row_newbcast:2 row_mask:0xf bank_mask:0xf
  v_cvt_f32_i32 v194, v30
  v_cvt_f32_i32 v195, v31
  v_pk_add_f32 v[192:193], v[192:193], v[116:117] op_sel_hi:[1,0] neg_lo:[0,1] neg_hi:[0,1]
  v_pk_add_f32 v[194:195], v[194:195], v[116:117] op_sel_hi:[1,0] neg_lo:[0,1] neg_hi:[0,1]
  v_cvt_pk_bf16_f32 v192, 0, v192
  v_permlane16_swap_b32 v144, v145
  v_cvt_pk_bf16_f32 v193, 0, v193
  v_max_f32 v140, v144, v145
  v_cvt_pk_bf16_f32 v194, 0, v194
  v_mul_f32 v144, s66, v140
  v_cvt_pk_bf16_f32 v195, 0, v195
  v_add_f32 v146, v144, v142
  v_pk_mul_f32 v[192:193], v[192:193], v[116:117] op_sel:[0,1]
  v_sub_f32 v142, 0, v144
  v_pk_mul_f32 v[194:195], v[194:195], v[116:117] op_sel:[0,1]
  s_waitcnt vmcnt(16)
  buffer_load_dwordx4 v[4:7], v94, s[12:15], s60 offen offset:1024 nt
  v_cvt_f32_i32 v196, v32
  v_cvt_f32_i32 v197, v33
  v_cvt_f32_i32 v198, v34
  v_cvt_f32_i32 v199, v35
  v_pk_add_f32 v[196:197], v[196:197], v[116:117] op_sel_hi:[1,0] neg_lo:[0,1] neg_hi:[0,1]
  v_pk_add_f32 v[198:199], v[198:199], v[116:117] op_sel_hi:[1,0] neg_lo:[0,1] neg_hi:[0,1]
  v_cvt_pk_bf16_f32 v196, 0, v196
  v_exp_f32 v146, -v146
  v_cvt_pk_bf16_f32 v197, 0, v197
  ds_bpermute_b32 v147, v101, v146
  v_cvt_pk_bf16_f32 v198, 0, v198
  v_fma_f32 v148, v148, s66, v142
  v_cvt_pk_bf16_f32 v199, 0, v199
  v_exp_f32 v148, v148
  v_pk_mul_f32 v[196:197], v[196:197], v[116:117] op_sel:[0,1]
  v_fma_f32 v149, v149, s66, v142
  v_pk_mul_f32 v[198:199], v[198:199], v[116:117] op_sel:[0,1]
  s_waitcnt vmcnt(16)
  buffer_load_dwordx4 v[8:11], v94, s[12:15], s60 offen offset:1280 nt
  v_cvt_f32_i32 v200, v36
  v_cvt_f32_i32 v201, v37
  v_cvt_f32_i32 v202, v38
  v_cvt_f32_i32 v203, v39
  v_pk_add_f32 v[200:201], v[200:201], v[116:117] op_sel_hi:[1,0] neg_lo:[0,1] neg_hi:[0,1]
  v_pk_add_f32 v[202:203], v[202:203], v[116:117] op_sel_hi:[1,0] neg_lo:[0,1] neg_hi:[0,1]
  v_cvt_pk_bf16_f32 v200, 0, v200
  v_exp_f32 v149, v149
  v_cvt_pk_bf16_f32 v201, 0, v201
  v_fma_f32 v150, v150, s66, v142
  v_cvt_pk_bf16_f32 v202, 0, v202
  v_exp_f32 v150, v150
  v_cvt_pk_bf16_f32 v203, 0, v203
  v_fma_f32 v151, v151, s66, v142
  v_pk_mul_f32 v[200:201], v[200:201], v[116:117] op_sel:[0,1]
  v_exp_f32 v151, v151
  v_pk_mul_f32 v[202:203], v[202:203], v[116:117] op_sel:[0,1]
  s_waitcnt vmcnt(16)
  s_cbranch_vccnz L_vw0_9
  s_waitcnt vmcnt(11)
L_vw0_9:
  buffer_load_dwordx4 v[12:15], v94, s[12:15], s60 offen offset:1536 nt
  v_cvt_f32_i32 v108, v40
  v_cvt_f32_i32 v109, v41
  v_mov_b32_dpp v116, v114 row_newbcast:3 row_mask:0xf bank_mask:0xf
  v_mov_b32_dpp v117, v115 row_newbcast:3 row_mask:0xf bank_mask:0xf
  v_cvt_f32_i32 v110, v42
  v_cvt_f32_i32 v111, v43
  v_pk_add_f32 v[108:109], v[108:109], v[116:117] op_sel_hi:[1,0] neg_lo:[0,1] neg_hi:[0,1]
  v_pk_add_f32 v[110:111], v[110:111], v[116:117] op_sel_hi:[1,0] neg_lo:[0,1] neg_hi:[0,1]
  v_cvt_pk_bf16_f32 v108, 0, v108
  v_fma_f32 v152, v152, s66, v142
  v_cvt_pk_bf16_f32 v109, 0, v109
  v_exp_f32 v152, v152
  v_cvt_pk_bf16_f32 v110, 0, v110
  v_fma_f32 v153, v153, s66, v142
  v_cvt_pk_bf16_f32 v111, 0, v111
  v_exp_f32 v153, v153
  v_pk_mul_f32 v[108:109], v[108:109], v[116:117] op_sel:[0,1]
  v_fma_f32 v154, v154, s66, v142
  v_pk_mul_f32 v[110:111], v[110:111], v[116:117] op_sel:[0,1]
  v_cvt_pk_bf16_f32 v205, v192, v108
  v_cvt_pk_bf16_f32 v209, v193, v109
  v_cvt_pk_bf16_f32 v213, v194, v110
  v_cvt_pk_bf16_f32 v217, v195, v111
  s_waitcnt vmcnt(16)
  buffer_load_dwordx4 v[16:19], v94, s[12:15], s60 offen offset:1792 nt
  v_cvt_f32_i32 v108, v44
  v_cvt_f32_i32 v109, v45
  v_cvt_f32_i32 v110, v46
  v_cvt_f32_i32 v111, v47
  v_pk_add_f32 v[108:109], v[108:109], v[116:117] op_sel_hi:[1,0] neg_lo:[0,1] neg_hi:[0,1]
  v_pk_add_f32 v[110:111], v[110:111], v[116:117] op_sel_hi:[1,0] neg_lo:[0,1] neg_hi:[0,1]
  v_cvt_pk_bf16_f32 v108, 0, v108
  v_exp_f32 v154, v154
  v_cvt_pk_bf16_f32 v109, 0, v109
  v_fma_f32 v155, v155, s66, v142
  v_cvt_pk_bf16_f32 v110, 0, v110
  v_exp_f32 v155, v155
  v_cvt_pk_bf16_f32 v111, 0, v111
  v_fma_f32 v156, v156, s66, v142
  v_pk_mul_f32 v[108:109], v[108:109], v[116:117] op_sel:[0,1]
  v_exp_f32 v156, v156
  v_pk_mul_f32 v[110:111], v[110:111], v[116:117] op_sel:[0,1]
  v_cvt_pk_bf16_f32 v221, v196, v108
  v_cvt_pk_bf16_f32 v225, v197, v109
  v_cvt_pk_bf16_f32 v229, v198, v110
  v_cvt_pk_bf16_f32 v233, v199, v111
  s_waitcnt vmcnt(16)
  buffer_load_dwordx4 v[20:23], v94, s[12:15], s60 offen offset:2048 nt
  v_cvt_f32_i32 v108, v48
  v_cvt_f32_i32 v109, v49
  v_cvt_f32_i32 v110, v50
  v_cvt_f32_i32 v111, v51
  v_pk_add_f32 v[108:109], v[108:109], v[116:117] op_sel_hi:[1,0] neg_lo:[0,1] neg_hi:[0,1]
  v_pk_add_f32 v[110:111], v[110:111], v[116:117] op_sel_hi:[1,0] neg_lo:[0,1] neg_hi:[0,1]
  v_cvt_pk_bf16_f32 v108, 0, v108
  v_fma_f32 v157, v157, s66, v142
  v_cvt_pk_bf16_f32 v109, 0, v109
  v_exp_f32 v157, v157
  v_cvt_pk_bf16_f32 v110, 0, v110
  v_fma_f32 v158, v158, s66, v142
  v_cvt_pk_bf16_f32 v111, 0, v111
  v_exp_f32 v158, v158
  v_pk_mul_f32 v[108:109], v[108:109], v[116:117] op_sel:[0,1]
  v_add_f32 v144, v148, v149
  v_pk_mul_f32 v[110:111], v[110:111], v[116:117] op_sel:[0,1]
  v_cvt_pk_bf16_f32 v237, v200, v108
  v_cvt_pk_bf16_f32 v241, v201, v109
  v_cvt_pk_bf16_f32 v245, v202, v110
  v_cvt_pk_bf16_f32 v249, v203, v111
  s_waitcnt vmcnt(16)
  s_cbranch_vccnz L_vw0_12
  s_waitcnt vmcnt(11)
L_vw0_12:
  buffer_load_dwordx4 v[24:27], v94, s[12:15], s60 offen offset:2304 nt
  v_cvt_f32_i32 v192, v52
  v_cvt_f32_i32 v193, v53
  v_mov_b32_dpp v116, v114 row_newbcast:4 row_mask:0xf bank_mask:0xf
  v_mov_b32_dpp v117, v115 row_newbcast:4 row_mask:0xf bank_mask:0xf
  v_cvt_f32_i32 v194, v54
  v_cvt_f32_i32 v195, v55
  v_pk_add_f32 v[192:193], v[192:193], v[116:117] op_sel_hi:[1,0] neg_lo:[0,1] neg_hi:[0,1]
  v_pk_add_f32 v[194:195], v[194:195], v[116:117] op_sel_hi:[1,0] neg_lo:[0,1] neg_hi:[0,1]
  v_cvt_pk_bf16_f32 v192, 0, v192
  v_add_f32 v145, v150, v151
  v_cvt_pk_bf16_f32 v193, 0, v193
  v_add_f32 v144, v144, v152
  v_cvt_pk_bf16_f32 v194, 0, v194
  v_add_f32 v145, v145, v153
  v_cvt_pk_bf16_f32 v195, 0, v195
  v_add_f32 v144, v144, v154
  v_pk_mul_f32 v[192:193], v[192:193], v[116:117] op_sel:[0,1]
  v_add_f32 v145, v145, v155
  v_pk_mul_f32 v[194:195], v[194:195], v[116:117] op_sel:[0,1]
  s_waitcnt vmcnt(16)
  buffer_load_dwordx4 v[28:31], v94, s[12:15], s60 offen offset:2560 nt
  v_cvt_f32_i32 v196, v56
  v_cvt_f32_i32 v197, v57
  v_cvt_f32_i32 v198, v58
  v_cvt_f32_i32 v199, v59
  v_pk_add_f32 v[196:197], v[196:197], v[116:117] op_sel_hi:[1,0] neg_lo:[0,1] neg_hi:[0,1]
  v_pk_add_f32 v[198:199], v[198:199], v[116:117] op_sel_hi:[1,0] neg_lo:[0,1] neg_hi:[0,1]
  v_cvt_pk_bf16_f32 v196, 0, v196
  v_add_f32 v144, v144, v156
  v_cvt_pk_bf16_f32 v197, 0, v197
  v_add_f32 v145, v145, v157
  v_cvt_pk_bf16_f32 v198, 0, v198
  v_add_f32 v144, v144, v158
  v_cvt_pk_bf16_f32 v199, 0, v199
  v_add_f32 v144, v144, v145
  v_pk_mul_f32 v[196:197], v[196:197], v[116:117] op_sel:[0,1]
  v_fma_f32 v143, v143, v146, v144
  v_pk_mul_f32 v[198:199], v[198:199], v[116:117] op_sel:[0,1]
  s_waitcnt vmcnt(16)
  buffer_load_dwordx4 v[32:35], v94, s[12:15], s60 offen offset:2816 nt
  v_cvt_f32_i32 v200, v60
  v_cvt_f32_i32 v201, v61
  v_cvt_f32_i32 v202, v62
  v_cvt_f32_i32 v203, v63
  v_pk_add_f32 v[200:201], v[200:201], v[116:117] op_sel_hi:[1,0] neg_lo:[0,1] neg_hi:[0,1]
  v_pk_add_f32 v[202:203], v[202:203], v[116:117] op_sel_hi:[1,0] neg_lo:[0,1] neg_hi:[0,1]
  v_cvt_pk_bf16_f32 v200, 0, v200
  v_cvt_pk_bf16_f32 v159, v148, v149
  v_cvt_pk_bf16_f32 v201, 0, v201
  v_cvt_pk_bf16_f32 v160, v150, v151
  v_cvt_pk_bf16_f32 v202, 0, v202
  v_cvt_pk_bf16_f32 v161, v152, v153
  v_cvt_pk_bf16_f32 v203, 0, v203
  v_cvt_pk_bf16_f32 v162, v154, v155
  v_pk_mul_f32 v[200:201], v[200:201], v[116:117] op_sel:[0,1]
  v_cvt_pk_bf16_f32 v163, v156, v157
  v_pk_mul_f32 v[202:203], v[202:203], v[116:117] op_sel:[0,1]
  s_waitcnt vmcnt(16)
  s_cbranch_vccnz L_vw0_15
  s_waitcnt vmcnt(9)
L_vw0_15:
  buffer_load_dwordx4 v[36:39], v95, s[12:15], s60 offen offset:0 nt
  v_cvt_f32_i32 v108, v64
  v_cvt_f32_i32 v109, v65
  v_mov_b32_dpp v116, v114 row_newbcast:5 row_mask:0xf bank_mask:0xf
  v_mov_b32_dpp v117, v115 row_newbcast:5 row_mask:0xf bank_mask:0xf
  v_cvt_f32_i32 v110, v66
  v_cvt_f32_i32 v111, v67
  v_pk_add_f32 v[108:109], v[108:109], v[116:117] op_sel_hi:[1,0] neg_lo:[0,1] neg_hi:[0,1]
  v_pk_add_f32 v[110:111], v[110:111], v[116:117] op_sel_hi:[1,0] neg_lo:[0,1] neg_hi:[0,1]
  v_cvt_pk_bf16_f32 v108, 0, v108
  v_cvt_pk_bf16_f32 v164, v158, 0
  v_cvt_pk_bf16_f32 v109, 0, v109
  v_cndmask_b32 v168, 0, v159, s[72:73]
  v_cvt_pk_bf16_f32 v110, 0, v110
  v_cndmask_b32 v169, 0, v160, s[72:73]
  v_cvt_pk_bf16_f32 v111, 0, v111
  v_cndmask_b32 v170, 0, v161, s[72:73]
  v_pk_mul_f32 v[108:109], v[108:109], v[116:117] op_sel:[0,1]
  v_cndmask_b32 v171, 0, v162, s[72:73]
  v_pk_mul_f32 v[110:111], v[110:111], v[116:117] op_sel:[0,1]
  v_cvt_pk_bf16_f32 v206, v192, v108
  v_cvt_pk_bf16_f32 v210, v193, v109
  v_cvt_pk_bf16_f32 v214, v194, v110
  v_cvt_pk_bf16_f32 v218, v195, v111
  s_waitcnt vmcnt(16)
  buffer_load_dwordx4 v[40:43], v95, s[12:15], s60 offen offset:256 nt
  v_cvt_f32_i32 v108, v68
  v_cvt_f32_i32 v109, v69
  v_cvt_f32_i32 v110, v70
  v_cvt_f32_i32 v111, v71
  v_pk_add_f32 v[108:109], v[108:109], v[116:117] op_sel_hi:[1,0] neg_lo:[0,1] neg_hi:[0,1]
  v_pk_add_f32 v[110:111], v[110:111], v[116:117] op_sel_hi:[1,0] neg_lo:[0,1] neg_hi:[0,1]
  v_cvt_pk_bf16_f32 v108, 0, v108
  v_cndmask_b32 v172, 0, v159, s[74:75]
  v_cvt_pk_bf16_f32 v109, 0, v109
  v_cndmask_b32 v173, 0, v160, s[74:75]
  v_cvt_pk_bf16_f32 v110, 0, v110
  v_cndmask_b32 v174, 0, v161, s[74:75]
  v_cvt_pk_bf16_f32 v111, 0, v111
  v_cndmask_b32 v175, 0, v162, s[74:75]
  v_pk_mul_f32 v[108:109], v[108:109], v[116:117] op_sel:[0,1]
  v_cndmask_b32 v176, 0, v159, s[76:77]
  v_pk_mul_f32 v[110:111], v[110:111], v[116:117] op_sel:[0,1]
  v_cvt_pk_bf16_f32 v222, v196, v108
  v_cvt_pk_bf16_f32 v226, v197, v109
  v_cvt_pk_bf16_f32 v230, v198, v110
  v_cvt_pk_bf16_f32 v234, v199, v111
  s_waitcnt vmcnt(16)
  buffer_load_dwordx4 v[44:47], v95, s[12:15], s60 offen offset:512 nt
  v_cvt_f32_i32 v108, v72
  v_cvt_f32_i32 v109, v73
  v_cvt_f32_i32 v110, v74
  v_cvt_f32_i32 v111, v75
  v_pk_add_f32 v[108:109], v[108:109], v[116:117] op_sel_hi:[1,0] neg_lo:[0,1] neg_hi:[0,1]
  v_pk_add_f32 v[110:111], v[110:111], v[116:117] op_sel_hi:[1,0] neg_lo:[0,1] neg_hi:[0,1]
  v_cvt_pk_bf16_f32 v108, 0, v108
  v_cndmask_b32 v177, 0, v160, s[76:77]
  v_cvt_pk_bf16_f32 v109, 0, v109
  v_cndmask_b32 v178, 0, v161, s[76:77]
  v_cvt_pk_bf16_f32 v110, 0, v110
  v_cndmask_b32 v179, 0, v162, s[76:77]
  v_cvt_pk_bf16_f32 v111, 0, v111
  v_cndmask_b32 v180, 0, v159, s[78:79]
  v_pk_mul_f32 v[108:109], v[108:109], v[116:117] op_sel:[0,1]
  v_cndmask_b32 v181, 0, v160, s[78:79]
  v_pk_mul_f32 v[110:111], v[110:111], v[116:117] op_sel:[0,1]
  v_cvt_pk_bf16_f32 v238, v200, v108
  v_cvt_pk_bf16_f32 v242, v201, v109
  v_cvt_pk_bf16_f32 v246, v202, v110
  v_cvt_pk_bf16_f32 v250, v203, v111
  v_mad_u32_u24 v92, v97, s63, v3
  v_add_u32 v93, 768, v92
  v_add_u32 v94, 4608, v92
  v_add_u32 v95, 7680, v92
  v_cndmask_b32 v92, v92, v105, s[52:53]
  v_cndmask_b32 v95, v95, v105, s[54:55]
  s_waitcnt vmcnt(16)
  s_cbranch_vccnz L_vw0_18
  s_waitcnt vmcnt(9)
L_vw0_18:
  buffer_load_dwordx4 v[48:51], v92, s[12:15], s61 offen offset:0 nt
  v_cvt_f32_i32 v192, v76
  v_cvt_f32_i32 v193, v77
  v_mov_b32_dpp v116, v114 row_newbcast:6 row_mask:0xf bank_mask:0xf
  v_mov_b32_dpp v117, v115 row_newbcast:6 row_mask:0xf bank_mask:0xf
  v_cvt_f32_i32 v194, v78
  v_cvt_f32_i32 v195, v79
  v_pk_add_f32 v[192:193], v[192:193], v[116:117] op_sel_hi:[1,0] neg_lo:[0,1] neg_hi:[0,1]
  v_pk_add_f32 v[194:195], v[194:195], v[116:117] op_sel_hi:[1,0] neg_lo:[0,1] neg_hi:[0,1]
  v_cvt_pk_bf16_f32 v192, 0, v192
  v_cndmask_b32 v182, 0, v161, s[78:79]
  v_cvt_pk_bf16_f32 v193, 0, v193
  v_cndmask_b32 v183, 0, v162, s[78:79]
  v_cvt_pk_bf16_f32 v194, 0, v194
  s_waitcnt lgkmcnt(0)
  v_cvt_pk_bf16_f32 v195, 0, v195
  v_mul_f32 v128, v147, v128
  v_pk_mul_f32 v[192:193], v[192:193], v[116:117] op_sel:[0,1]
  v_mul_f32 v129, v147, v129
  v_pk_mul_f32 v[194:195], v[194:195], v[116:117] op_sel:[0,1]
  s_waitcnt vmcnt(14)
  buffer_load_dwordx4 v[52:55], v92, s[12:15], s61 offen offset:256 nt
  v_cvt_f32_i32 v196, v80
  v_cvt_f32_i32 v197, v81
  v_cvt_f32_i32 v198, v82
  v_cvt_f32_i32 v199, v83
  v_pk_add_f32 v[196:197], v[196:197], v[116:117] op_sel_hi:[1,0] neg_lo:[0,1] neg_hi:[0,1]
  v_pk_add_f32 v[198:199], v[198:199], v[116:117] op_sel_hi:[1,0] neg_lo:[0,1] neg_hi:[0,1]
  v_cvt_pk_bf16_f32 v196, 0, v196
  v_mul_f32 v130, v147, v130
  v_cvt_pk_bf16_f32 v197, 0, v197
  v_mul_f32 v131, v147, v131
  v_cvt_pk_bf16_f32 v198, 0, v198
  v_mul_f32 v132, v147, v132
  v_cvt_pk_bf16_f32 v199, 0, v199
  v_mul_f32 v133, v147, v133
  v_pk_mul_f32 v[196:197], v[196:197], v[116:117] op_sel:[0,1]
  v_mul_f32 v134, v147, v134
  v_pk_mul_f32 v[198:199], v[198:199], v[116:117] op_sel:[0,1]
  s_waitcnt vmcnt(14)
  buffer_load_dwordx4 v[56:59], v92, s[12:15], s61 offen offset:512 nt
  v_cvt_f32_i32 v200, v84
  v_cvt_f32_i32 v201, v85
  v_cvt_f32_i32 v202, v86
  v_cvt_f32_i32 v203, v87
  v_pk_add_f32 v[200:201], v[200:201], v[116:117] op_sel_hi:[1,0] neg_lo:[0,1] neg_hi:[0,1]
  v_pk_add_f32 v[202:203], v[202:203], v[116:117] op_sel_hi:[1,0] neg_lo:[0,1] neg_hi:[0,1]
  v_cvt_pk_bf16_f32 v200, 0, v200
  v_mul_f32 v135, v147, v135
  v_cvt_pk_bf16_f32 v201, 0, v201
  v_mul_f32 v136, v147, v136
  v_cvt_pk_bf16_f32 v202, 0, v202
  v_mul_f32 v137, v147, v137
  v_cvt_pk_bf16_f32 v203, 0, v203
  v_mul_f32 v138, v147, v138
  v_pk_mul_f32 v[200:201], v[200:201], v[116:117] op_sel:[0,1]
  v_mul_f32 v139, v147, v139
  v_pk_mul_f32 v[202:203], v[202:203], v[116:117] op_sel:[0,1]
  s_waitcnt vmcnt(14)
  s_cbranch_vccnz L_vw0_21
  s_waitcnt vmcnt(9)
L_vw0_21:
  buffer_load_dwordx4 v[60:63], v93, s[12:15], s61 offen offset:0 nt
  v_cvt_f32_i32 v108, v88
  v_cvt_f32_i32 v109, v89
  v_mov_b32_dpp v116, v114 row_newbcast:7 row_mask:0xf bank_mask:0xf
  v_mov_b32_dpp v117, v115 row_newbcast:7 row_mask:0xf bank_mask:0xf
  v_cvt_f32_i32 v110, v90
  v_cvt_f32_i32 v111, v91
  v_pk_add_f32 v[108:109], v[108:109], v[116:117] op_sel_hi:[1,0] neg_lo:[0,1] neg_hi:[0,1]
  v_pk_add_f32 v[110:111], v[110:111], v[116:117] op_sel_hi:[1,0] neg_lo:[0,1] neg_hi:[0,1]
  v_cvt_pk_bf16_f32 v108, 0, v108
  v_cvt_pk_bf16_f32 v109, 0, v109
  v_cvt_pk_bf16_f32 v110, 0, v110
  v_cvt_pk_bf16_f32 v111, 0, v111
  v_pk_mul_f32 v[108:109], v[108:109], v[116:117] op_sel:[0,1]
  v_pk_mul_f32 v[110:111], v[110:111], v[116:117] op_sel:[0,1]
  v_cvt_pk_bf16_f32 v207, v192, v108
  v_cvt_pk_bf16_f32 v211, v193, v109
  v_cvt_pk_bf16_f32 v215, v194, v110
  v_cvt_pk_bf16_f32 v219, v195, v111
  v_mfma_f32_16x16x32_bf16 v[128:131], v[168:171], v[204:207], v[128:131]
  v_mfma_f32_16x16x32_bf16 v[128:131], v[172:175], v[208:211], v[128:131]
  v_mfma_f32_16x16x32_bf16 v[128:131], v[176:179], v[212:215], v[128:131]
  v_mfma_f32_16x16x32_bf16 v[128:131], v[180:183], v[216:219], v[128:131]
  s_waitcnt vmcnt(14)
  buffer_load_dwordx4 v[64:67], v93, s[12:15], s61 offen offset:256 nt
  v_cvt_f32_i32 v108, v4
  v_cvt_f32_i32 v109, v5
  v_cvt_f32_i32 v110, v6
  v_cvt_f32_i32 v111, v7
  v_pk_add_f32 v[108:109], v[108:109], v[116:117] op_sel_hi:[1,0] neg_lo:[0,1] neg_hi:[0,1]
  v_pk_add_f32 v[110:111], v[110:111], v[116:117] op_sel_hi:[1,0] neg_lo:[0,1] neg_hi:[0,1]
  v_cvt_pk_bf16_f32 v108, 0, v108
  v_cvt_pk_bf16_f32 v109, 0, v109
  v_cvt_pk_bf16_f32 v110, 0, v110
  v_cvt_pk_bf16_f32 v111, 0, v111
  v_pk_mul_f32 v[108:109], v[108:109], v[116:117] op_sel:[0,1]
  v_pk_mul_f32 v[110:111], v[110:111], v[116:117] op_sel:[0,1]
  v_cvt_pk_bf16_f32 v223, v196, v108
  v_cvt_pk_bf16_f32 v227, v197, v109
  v_cvt_pk_bf16_f32 v231, v198, v110
  v_cvt_pk_bf16_f32 v235, v199, v111
  v_mfma_f32_16x16x32_bf16 v[132:135], v[168:171], v[220:223], v[132:135]
  v_mfma_f32_16x16x32_bf16 v[132:135], v[172:175], v[224:227], v[132:135]
  v_mfma_f32_16x16x32_bf16 v[132:135], v[176:179], v[228:231], v[132:135]
  v_mfma_f32_16x16x32_bf16 v[132:135], v[180:183], v[232:235], v[132:135]
  s_waitcnt vmcnt(14)
  buffer_load_dwordx4 v[68:71], v93, s[12:15], s61 offen offset:512 nt
  v_cvt_f32_i32 v108, v8
  v_cvt_f32_i32 v109, v9
  v_cvt_f32_i32 v110, v10
  v_cvt_f32_i32 v111, v11
  v_pk_add_f32 v[108:109], v[108:109], v[116:117] op_sel_hi:[1,0] neg_lo:[0,1] neg_hi:[0,1]
  v_pk_add_f32 v[110:111], v[110:111], v[116:117] op_sel_hi:[1,0] neg_lo:[0,1] neg_hi:[0,1]
  v_cvt_pk_bf16_f32 v108, 0, v108
  v_cvt_pk_bf16_f32 v109, 0, v109
  v_cvt_pk_bf16_f32 v110, 0, v110
  v_cvt_pk_bf16_f32 v111, 0, v111
  v_pk_mul_f32 v[108:109], v[108:109], v[116:117] op_sel:[0,1]
  v_pk_mul_f32 v[110:111], v[110:111], v[116:117] op_sel:[0,1]
  v_cvt_pk_bf16_f32 v239, v200, v108
  v_cvt_pk_bf16_f32 v243, v201, v109
  v_cvt_pk_bf16_f32 v247, v202, v110
  v_cvt_pk_bf16_f32 v251, v203, v111
  v_mfma_f32_16x16x32_bf16 v[136:139], v[168:171], v[236:239], v[136:139]
  v_mfma_f32_16x16x32_bf16 v[136:139], v[172:175], v[240:243], v[136:139]
  v_mfma_f32_16x16x32_bf16 v[136:139], v[176:179], v[244:247], v[136:139]
  v_mfma_f32_16x16x32_bf16 v[136:139], v[180:183], v[248:251], v[136:139]
  s_waitcnt vmcnt(14)
  s_cbranch_vccnz L_vw0_24
  s_waitcnt vmcnt(9)
L_vw0_24:
  buffer_load_dwordx4 v[72:75], v93, s[12:15], s61 offen offset:768 nt
  v_cvt_f32_i32 v192, v12
  v_cvt_f32_i32 v193, v13
  v_mov_b32_dpp v116, v114 row_newbcast:8 row_mask:0xf bank_mask:0xf
  v_mov_b32_dpp v117, v115 row_newbcast:8 row_mask:0xf bank_mask:0xf
  v_cvt_f32_i32 v194, v14
  v_cvt_f32_i32 v195, v15
  v_pk_add_f32 v[192:193], v[192:193], v[116:117] op_sel_hi:[1,0] neg_lo:[0,1] neg_hi:[0,1]
  v_pk_add_f32 v[194:195], v[194:195], v[116:117] op_sel_hi:[1,0] neg_lo:[0,1] neg_hi:[0,1]
  v_cvt_pk_bf16_f32 v192, 0, v192
  v_cndmask_b32 v184, 0, v163, s[72:73]
  v_cvt_pk_bf16_f32 v193, 0, v193
  v_cndmask_b32 v185, 0, v164, s[72:73]
  v_cvt_pk_bf16_f32 v194, 0, v194
  v_cndmask_b32 v186, 0, v163, s[74:75]
  v_cvt_pk_bf16_f32 v195, 0, v195
  v_cndmask_b32 v187, 0, v164, s[74:75]
  v_pk_mul_f32 v[192:193], v[192:193], v[116:117] op_sel:[0,1]
  v_cndmask_b32 v188, 0, v163, s[76:77]
  v_pk_mul_f32 v[194:195], v[194:195], v[116:117] op_sel:[0,1]
  s_waitcnt vmcnt(14)
  buffer_load_dwordx4 v[76:79], v93, s[12:15], s61 offen offset:1024 nt
  v_cvt_f32_i32 v196, v16
  v_cvt_f32_i32 v197, v17
  v_cvt_f32_i32 v198, v18
  v_cvt_f32_i32 v199, v19
  v_pk_add_f32 v[196:197], v[196:197], v[116:117] op_sel_hi:[1,0] neg_lo:[0,1] neg_hi:[0,1]
  v_pk_add_f32 v[198:199], v[198:199], v[116:117] op_sel_hi:[1,0] neg_lo:[0,1] neg_hi:[0,1]
  v_cvt_pk_bf16_f32 v196, 0, v196
  v_cndmask_b32 v189, 0, v164, s[76:77]
  v_cvt_pk_bf16_f32 v197, 0, v197
  v_cndmask_b32 v190, 0, v163, s[78:79]
  v_cvt_pk_bf16_f32 v198, 0, v198
  v_cndmask_b32 v191, 0, v164, s[78:79]
  v_cvt_pk_bf16_f32 v199, 0, v199
  v_pk_mul_f32 v[196:197], v[196:197], v[116:117] op_sel:[0,1]
  v_pk_mul_f32 v[198:199], v[198:199], v[116:117] op_sel:[0,1]
  s_waitcnt vmcnt(14)
  buffer_load_dwordx4 v[80:83], v93, s[12:15], s61 offen offset:1280 nt
  v_cvt_f32_i32 v200, v20
  v_cvt_f32_i32 v201, v21
  v_cvt_f32_i32 v202, v22
  v_cvt_f32_i32 v203, v23
  v_pk_add_f32 v[200:201], v[200:201], v[116:117] op_sel_hi:[1,0] neg_lo:[0,1] neg_hi:[0,1]
  v_pk_add_f32 v[202:203], v[202:203], v[116:117] op_sel_hi:[1,0] neg_lo:[0,1] neg_hi:[0,1]
  v_cvt_pk_bf16_f32 v200, 0, v200
  v_cvt_pk_bf16_f32 v201, 0, v201
  v_cvt_pk_bf16_f32 v202, 0, v202
  v_cvt_pk_bf16_f32 v203, 0, v203
  v_pk_mul_f32 v[200:201], v[200:201], v[116:117] op_sel:[0,1]
  v_pk_mul_f32 v[202:203], v[202:203], v[116:117] op_sel:[0,1]
  s_waitcnt vmcnt(14)
  s_cbranch_vccnz L_vw0_27
  s_waitcnt vmcnt(9)
L_vw0_27:
  buffer_load_dwordx4 v[84:87], v93, s[12:15], s61 offen offset:1536 nt
  v_cvt_f32_i32 v108, v24
  v_cvt_f32_i32 v109, v25
  v_mov_b32_dpp v116, v114 row_newbcast:9 row_mask:0xf bank_mask:0xf
  v_mov_b32_dpp v117, v115 row_newbcast:9 row_mask:0xf bank_mask:0xf
  v_cvt_f32_i32 v110, v26
  v_cvt_f32_i32 v111, v27
  v_pk_add_f32 v[108:109], v[108:109], v[116:117] op_sel_hi:[1,0] neg_lo:[0,1] neg_hi:[0,1]
  v_pk_add_f32 v[110:111], v[110:111], v[116:117] op_sel_hi:[1,0] neg_lo:[0,1] neg_hi:[0,1]
  v_cvt_pk_bf16_f32 v108, 0, v108
  v_cvt_pk_bf16_f32 v109, 0, v109
  v_cvt_pk_bf16_f32 v110, 0, v110
  v_cvt_pk_bf16_f32 v111, 0, v111
  v_pk_mul_f32 v[108:109], v[108:109], v[116:117] op_sel:[0,1]
  v_pk_mul_f32 v[110:111], v[110:111], v[116:117] op_sel:[0,1]
  v_cvt_pk_bf16_f32 v204, v192, v108
  v_cvt_pk_bf16_f32 v208, v193, v109
  v_cvt_pk_bf16_f32 v212, v194, v110
  v_cvt_pk_bf16_f32 v216, v195, v111
  s_waitcnt vmcnt(14)
  buffer_load_dwordx4 v[88:91], v93, s[12:15], s61 offen offset:1792 nt
  v_cvt_f32_i32 v108, v28
  v_cvt_f32_i32 v109, v29
  v_cvt_f32_i32 v110, v30
  v_cvt_f32_i32 v111, v31
  v_pk_add_f32 v[108:109], v[108:109], v[116:117] op_sel_hi:[1,0] neg_lo:[0,1] neg_hi:[0,1]
  v_pk_add_f32 v[110:111], v[110:111], v[116:117] op_sel_hi:[1,0] neg_lo:[0,1] neg_hi:[0,1]
  v_cvt_pk_bf16_f32 v108, 0, v108
  v_cvt_pk_bf16_f32 v109, 0, v109
  v_cvt_pk_bf16_f32 v110, 0, v110
  v_cvt_pk_bf16_f32 v111, 0, v111
  v_pk_mul_f32 v[108:109], v[108:109], v[116:117] op_sel:[0,1]
  v_pk_mul_f32 v[110:111], v[110:111], v[116:117] op_sel:[0,1]
  v_cvt_pk_bf16_f32 v220, v196, v108
  v_cvt_pk_bf16_f32 v224, v197, v109
  v_cvt_pk_bf16_f32 v228, v198, v110
  v_cvt_pk_bf16_f32 v232, v199, v111
  s_waitcnt vmcnt(14)
  buffer_load_dwordx4 v[4:7], v93, s[12:15], s61 offen offset:2048 nt
  v_cvt_f32_i32 v108, v32
  v_cvt_f32_i32 v109, v33
  v_cvt_f32_i32 v110, v34
  v_cvt_f32_i32 v111, v35
  v_pk_add_f32 v[108:109], v[108:109], v[116:117] op_sel_hi:[1,0] neg_lo:[0,1] neg_hi:[0,1]
  v_pk_add_f32 v[110:111], v[110:111], v[116:117] op_sel_hi:[1,0] neg_lo:[0,1] neg_hi:[0,1]
  v_cvt_pk_bf16_f32 v108, 0, v108
  v_cvt_pk_bf16_f32 v109, 0, v109
  v_cvt_pk_bf16_f32 v110, 0, v110
  v_cvt_pk_bf16_f32 v111, 0, v111
  v_pk_mul_f32 v[108:109], v[108:109], v[116:117] op_sel:[0,1]
  v_pk_mul_f32 v[110:111], v[110:111], v[116:117] op_sel:[0,1]
  v_cvt_pk_bf16_f32 v236, v200, v108
  v_cvt_pk_bf16_f32 v240, v201, v109
  v_cvt_pk_bf16_f32 v244, v202, v110
  v_cvt_pk_bf16_f32 v248, v203, v111
  s_waitcnt vmcnt(14)
  s_cbranch_vccnz L_vw0_30
  s_waitcnt vmcnt(9)
L_vw0_30:
  buffer_load_dwordx4 v[8:11], v93, s[12:15], s61 offen offset:2304 nt
  v_cvt_f32_i32 v192, v36
  v_cvt_f32_i32 v193, v37
  v_mov_b32_dpp v116, v114 row_newbcast:10 row_mask:0xf bank_mask:0xf
  v_mov_b32_dpp v117, v115 row_newbcast:10 row_mask:0xf bank_mask:0xf
  v_cvt_f32_i32 v194, v38
  v_cvt_f32_i32 v195, v39
  v_pk_add_f32 v[192:193], v[192:193], v[116:117] op_sel_hi:[1,0] neg_lo:[0,1] neg_hi:[0,1]
  v_pk_add_f32 v[194:195], v[194:195], v[116:117] op_sel_hi:[1,0] neg_lo:[0,1] neg_hi:[0,1]
  v_cvt_pk_bf16_f32 v192, 0, v192
  v_cvt_pk_bf16_f32 v193, 0, v193
  v_cvt_pk_bf16_f32 v194, 0, v194
  v_cvt_pk_bf16_f32 v195, 0, v195
  v_pk_mul_f32 v[192:193], v[192:193], v[116:117] op_sel:[0,1]
  v_pk_mul_f32 v[194:195], v[194:195], v[116:117] op_sel:[0,1]
  v_cvt_pk_bf16_f32 v205, v192, 0
  v_cvt_pk_bf16_f32 v209, v193, 0
  v_cvt_pk_bf16_f32 v213, v194, 0
  v_cvt_pk_bf16_f32 v217, v195, 0
  v_mfma_f32_16x16x16_bf16 v[128:131], v[184:185], v[204:205], v[128:131]
  v_mfma_f32_16x16x16_bf16 v[128:131], v[186:187], v[208:209], v[128:131]
  v_mfma_f32_16x16x16_bf16 v[128:131], v[188:189], v[212:213], v[128:131]
  v_mfma_f32_16x16x16_bf16 v[128:131], v[190:191], v[216:217], v[128:131]
  s_waitcnt vmcnt(14)
  buffer_load_dwordx4 v[12:15], v93, s[12:15], s61 offen offset:2560 nt
  v_cvt_f32_i32 v196, v40
  v_cvt_f32_i32 v197, v41
  v_cvt_f32_i32 v198, v42
  v_cvt_f32_i32 v199, v43
  v_pk_add_f32 v[196:197], v[196:197], v[116:117] op_sel_hi:[1,0] neg_lo:[0,1] neg_hi:[0,1]
  v_pk_add_f32 v[198:199], v[198:199], v[116:117] op_sel_hi:[1,0] neg_lo:[0,1] neg_hi:[0,1]
  v_cvt_pk_bf16_f32 v196, 0, v196
  v_cvt_pk_bf16_f32 v197, 0, v197
  v_cvt_pk_bf16_f32 v198, 0, v198
  v_cvt_pk_bf16_f32 v199, 0, v199
  v_pk_mul_f32 v[196:197], v[196:197], v[116:117] op_sel:[0,1]
  v_pk_mul_f32 v[198:199], v[198:199], v[116:117] op_sel:[0,1]
  v_cvt_pk_bf16_f32 v221, v196, 0
  v_cvt_pk_bf16_f32 v225, v197, 0
  v_cvt_pk_bf16_f32 v229, v198, 0
  v_cvt_pk_bf16_f32 v233, v199, 0
  v_mfma_f32_16x16x16_bf16 v[132:135], v[184:185], v[220:221], v[132:135]
  v_mfma_f32_16x16x16_bf16 v[132:135], v[186:187], v[224:225], v[132:135]
  v_mfma_f32_16x16x16_bf16 v[132:135], v[188:189], v[228:229], v[132:135]
  v_mfma_f32_16x16x16_bf16 v[132:135], v[190:191], v[232:233], v[132:135]
  s_waitcnt vmcnt(14)
  buffer_load_dwordx4 v[16:19], v93, s[12:15], s61 offen offset:2816 nt
  v_cvt_f32_i32 v200, v44
  v_cvt_f32_i32 v201, v45
  v_cvt_f32_i32 v202, v46
  v_cvt_f32_i32 v203, v47
  v_pk_add_f32 v[200:201], v[200:201], v[116:117] op_sel_hi:[1,0] neg_lo:[0,1] neg_hi:[0,1]
  v_pk_add_f32 v[202:203], v[202:203], v[116:117] op_sel_hi:[1,0] neg_lo:[0,1] neg_hi:[0,1]
  v_cvt_pk_bf16_f32 v200, 0, v200
  v_cvt_pk_bf16_f32 v201, 0, v201
  v_cvt_pk_bf16_f32 v202, 0, v202
  v_cvt_pk_bf16_f32 v203, 0, v203
  v_pk_mul_f32 v[200:201], v[200:201], v[116:117] op_sel:[0,1]
  v_pk_mul_f32 v[202:203], v[202:203], v[116:117] op_sel:[0,1]
  v_cvt_pk_bf16_f32 v237, v200, 0
  v_cvt_pk_bf16_f32 v241, v201, 0
  v_cvt_pk_bf16_f32 v245, v202, 0
  v_cvt_pk_bf16_f32 v249, v203, 0
  v_mfma_f32_16x16x16_bf16 v[136:139], v[184:185], v[236:237], v[136:139]
  v_mfma_f32_16x16x16_bf16 v[136:139], v[186:187], v[240:241], v[136:139]
  v_mfma_f32_16x16x16_bf16 v[136:139], v[188:189], v[244:245], v[136:139]
  v_mfma_f32_16x16x16_bf16 v[136:139], v[190:191], v[248:249], v[136:139]
  s_mov_b32 s60, s61
L_v1:
  s_add_u32 s97, s64, 96
  v_mov_b32 v146, s97
  s_mov_b32 s86, s84
  ds_write_b32 v104, v146
  s_add_u32 s64, s64, 2
  s_cmp_lt_u32 s64, s99
  s_cbranch_scc1 L_v11_ok
L_v11_spin:
  v_mov_b32 v144, 61700
  ds_read_b32 v144, v144
  s_waitcnt lgkmcnt(0)
  v_readfirstlane_b32 s99, v144
  s_nop 1
  s_cmp_lt_u32 s64, s99
  s_cbranch_scc0 L_v11_spin
L_v11_ok:
  s_lshr_b32 s71, s64, 5
  s_lshr_b32 s85, s96, s71
  s_bfe_u32 s85, s85, 0x10003
  s_and_b32 s70, s64, 31
  s_lshl_b32 s71, s71, 12
  s_add_u32 s70, s70, s5
  s_add_u32 s70, s70, s71
  s_mul_hi_u32 s84, s70, s90
  s_lshr_b32 s84, s84, 1
  s_mul_i32 s71, s84, 3
  s_sub_u32 s70, s70, s71
  s_lshl3_add_u32 s85, s70, s85
  s_mul_i32 s61, s84, 196608
  s_lshr_b32 s89, s84, 4
  s_lshl_b32 s70, s85, 5
  v_add_u32 v97, s70, v1
  v_mul_u32_u24 v97, 21846, v97
  v_lshrrev_b32 v97, 16, v97
  v_add_u32 v144, s85, v2
  v_lshrrev_b32 v145, v144, s91
  v_and_b32 v145, 1, v145
  v_cmp_eq_u32 s[54:55], 1, v145
  s_nop 1
  s_and_b64 s[52:53], s[54:55], s[58:59]
  s_andn2_b64 s[54:55], s[54:55], s[58:59]
  s_cmp_lt_u32 s64, 96
  s_cselect_b32 s61, s61, 805306368
  s_lshr_b32 s70, s64, 1
  s_cmp_eq_u32 s70, 32
  s_cselect_b32 s48, -36096, s63
  ds_read_b32 v106, v104 offset:8
  s_waitcnt vmcnt(14)
  s_cbranch_vccnz L_vw1_0
  s_waitcnt vmcnt(9)
L_vw1_0:
  buffer_load_dwordx4 v[20:23], v93, s[12:15], s60 offen offset:3072 nt
  v_mov_b32 v114, v112
  v_mov_b32 v115, v113
  v_cvt_f32_i32 v192, v48
  v_cvt_f32_i32 v193, v49
  v_mov_b32_dpp v116, v114 row_newbcast:0 row_mask:0xf bank_mask:0xf
  v_mov_b32_dpp v117, v115 row_newbcast:0 row_mask:0xf bank_mask:0xf
  v_cvt_f32_i32 v194, v50
  v_cvt_f32_i32 v195, v51
  v_pk_add_f32 v[192:193], v[192:193], v[116:117] op_sel_hi:[1,0] neg_lo:[0,1] neg_hi:[0,1]
  v_pk_add_f32 v[194:195], v[194:195], v[116:117] op_sel_hi:[1,0] neg_lo:[0,1] neg_hi:[0,1]
  v_cvt_pk_bf16_f32 v192, 0, v192
  v_cvt_pk_bf16_f32 v193, 0, v193
  v_cvt_pk_bf16_f32 v194, 0, v194
  v_cvt_pk_bf16_f32 v195, 0, v195
  v_pk_mul_f32 v[192:193], v[192:193], v[116:117] op_sel:[0,1]
  v_pk_mul_f32 v[194:195], v[194:195], v[116:117] op_sel:[0,1]
  s_waitcnt lgkmcnt(0)
  v_cmp_lt_u32 vcc, s97, v106
  s_waitcnt vmcnt(14)
  buffer_load_dwordx4 v[24:27], v93, s[12:15], s60 offen offset:3328 nt
  v_cvt_f32_i32 v196, v52
  v_cvt_f32_i32 v197, v53
  v_cvt_f32_i32 v198, v54
  v_cvt_f32_i32 v199, v55
  v_pk_add_f32 v[196:197], v[196:197], v[116:117] op_sel_hi:[1,0] neg_lo:[0,1] neg_hi:[0,1]
  v_pk_add_f32 v[198:199], v[198:199], v[116:117] op_sel_hi:[1,0] neg_lo:[0,1] neg_hi:[0,1]
  v_cvt_pk_bf16_f32 v196, 0, v196
  v_lshlrev_b32 v148, 16, v120
  v_cvt_pk_bf16_f32 v197, 0, v197
  v_and_b32 v149, s65, v120
  v_cvt_pk_bf16_f32 v198, 0, v198
  v_lshlrev_b32 v150, 16, v121
  v_cvt_pk_bf16_f32 v199, 0, v199
  v_and_b32 v151, s65, v121
  v_pk_mul_f32 v[196:197], v[196:197], v[116:117] op_sel:[0,1]
  v_lshlrev_b32 v152, 16, v122
  v_pk_mul_f32 v[198:199], v[198:199], v[116:117] op_sel:[0,1]
  s_waitcnt vmcnt(14)
  buffer_load_dwordx4 v[28:31], v93, s[12:15], s60 offen offset:3584 nt
  v_cvt_f32_i32 v200, v56
  v_cvt_f32_i32 v201, v57
  v_cvt_f32_i32 v202, v58
  v_cvt_f32_i32 v203, v59
  v_pk_add_f32 v[200:201], v[200:201], v[116:117] op_sel_hi:[1,0] neg_lo:[0,1] neg_hi:[0,1]
  v_pk_add_f32 v[202:203], v[202:203], v[116:117] op_sel_hi:[1,0] neg_lo:[0,1] neg_hi:[0,1]
  v_cvt_pk_bf16_f32 v200, 0, v200
  v_and_b32 v153, s65, v122
  v_cvt_pk_bf16_f32 v201, 0, v201
  v_lshlrev_b32 v154, 16, v123
  v_cvt_pk_bf16_f32 v202, 0, v202
  v_and_b32 v155, s65, v123
  v_cvt_pk_bf16_f32 v203, 0, v203
  v_lshlrev_b32 v156, 16, v124
  v_pk_mul_f32 v[200:201], v[200:201], v[116:117] op_sel:[0,1]
  v_and_b32 v157, s65, v124
  v_pk_mul_f32 v[202:203], v[202:203], v[116:117] op_sel:[0,1]
  s_waitcnt vmcnt(14)
  s_cbranch_vccnz L_vw1_3
  s_waitcnt vmcnt(9)
L_vw1_3:
  buffer_load_dwordx4 v[32:35], v94, s[12:15], s60 offen offset:0 nt
  v_cvt_f32_i32 v108, v60
  v_cvt_f32_i32 v109, v61
  v_mov_b32_dpp v116, v114 row_newbcast:1 row_mask:0xf bank_mask:0xf
  v_mov_b32_dpp v117, v115 row_newbcast:1 row_mask:0xf bank_mask:0xf
  v_cvt_f32_i32 v110, v62
  v_cvt_f32_i32 v111, v63
  v_pk_add_f32 v[108:109], v[108:109], v[116:117] op_sel_hi:[1,0] neg_lo:[0,1] neg_hi:[0,1]
  v_pk_add_f32 v[110:111], v[110:111], v[116:117] op_sel_hi:[1,0] neg_lo:[0,1] neg_hi:[0,1]
  s_lshl_b32 s62, s84, 9
  v_lshl_add_u32 v98, v97, 1, v96
  buffer_load_short_d16_hi v112, v98, s[32:35], s62 offen
  buffer_load_short_d16_hi v113, v98, s[28:31], s62 offen
  v_cvt_pk_bf16_f32 v108, 0, v108
  v_lshlrev_b32 v158, 16, v125
  v_cvt_pk_bf16_f32 v109, 0, v109
  v_add_u32 v99, s48, v99
  v_cvt_pk_bf16_f32 v110, 0, v110
  v_add_u32 v100, s48, v100
  v_cvt_pk_bf16_f32 v111, 0, v111
  v_max3_f32 v144, v148, v149, v150
  v_pk_mul_f32 v[108:109], v[108:109], v[116:117] op_sel:[0,1]
  ds_read_b128 v[120:123], v99
  v_pk_mul_f32 v[110:111], v[110:111], v[116:117] op_sel:[0,1]
  v_cvt_pk_bf16_f32 v204, v192, v108
  v_cvt_pk_bf16_f32 v208, v193, v109
  v_cvt_pk_bf16_f32 v212, v194, v110
  v_cvt_pk_bf16_f32 v216, v195, v111
  s_waitcnt vmcnt(16)
  buffer_load_dwordx4 v[36:39], v94, s[12:15], s60 offen offset:256 nt
  v_cvt_f32_i32 v108, v64
  v_cvt_f32_i32 v109, v65
  v_cvt_f32_i32 v110, v66
  v_cvt_f32_i32 v111, v67
  v_pk_add_f32 v[108:109], v[108:109], v[116:117] op_sel_hi:[1,0] neg_lo:[0,1] neg_hi:[0,1]
  v_pk_add_f32 v[110:111], v[110:111], v[116:117] op_sel_hi:[1,0] neg_lo:[0,1] neg_hi:[0,1]
  v_cvt_pk_bf16_f32 v108, 0, v108
  ds_read_b64 v[124:125], v100 offset:256
  v_cvt_pk_bf16_f32 v109, 0, v109
  v_max3_f32 v145, v151, v152, v153
  v_cvt_pk_bf16_f32 v110, 0, v110
  v_max3_f32 v144, v144, v154, v155
  v_cvt_pk_bf16_f32 v111, 0, v111
  v_max3_f32 v145, v145, v156, v157
  v_pk_mul_f32 v[108:109], v[108:109], v[116:117] op_sel:[0,1]
  v_max3_f32 v144, v144, v158, v140
  v_pk_mul_f32 v[110:111], v[110:111], v[116:117] op_sel:[0,1]
  v_cvt_pk_bf16_f32 v220, v196, v108
  v_cvt_pk_bf16_f32 v224, v197, v109
  v_cvt_pk_bf16_f32 v228, v198, v110
  v_cvt_pk_bf16_f32 v232, v199, v111
  s_waitcnt vmcnt(16)
  buffer_load_dwordx4 v[40:43], v94, s[12:15], s60 offen offset:512 nt
  v_cvt_f32_i32 v108, v68
  v_cvt_f32_i32 v109, v69
  v_cvt_f32_i32 v110, v70
  v_cvt_f32_i32 v111, v71
  v_pk_add_f32 v[108:109], v[108:109], v[116:117] op_sel_hi:[1,0] neg_lo:[0,1] neg_hi:[0,1]
  v_pk_add_f32 v[110:111], v[110:111], v[116:117] op_sel_hi:[1,0] neg_lo:[0,1] neg_hi:[0,1]
  v_cvt_pk_bf16_f32 v108, 0, v108
  v_max_f32 v144, v144, v145
  v_cvt_pk_bf16_f32 v109, 0, v109
  v_mov_b32 v145, v144
  v_cvt_pk_bf16_f32 v110, 0, v110
  s_nop 0
  v_permlane32_swap_b32 v144, v145
  v_cvt_pk_bf16_f32 v111, 0, v111
  v_max_f32 v144, v144, v145
  v_pk_mul_f32 v[108:109], v[108:109], v[116:117] op_sel:[0,1]
  v_mov_b32 v145, v144
  v_pk_mul_f32 v[110:111], v[110:111], v[116:117] op_sel:[0,1]
  v_cvt_pk_bf16_f32 v236, v200, v108
  v_cvt_pk_bf16_f32 v240, v201, v109
  v_cvt_pk_bf16_f32 v244, v202, v110
  v_cvt_pk_bf16_f32 v248, v203, v111
  s_waitcnt vmcnt(16)
  s_cbranch_vccnz L_vw1_6
  s_waitcnt vmcnt(11)
L_vw1_6:
  buffer_load_dwordx4 v[44:47], v94, s[12:15], s60 offen offset:768 nt
  v_cvt_f32_i32 v192, v72
  v_cvt_f32_i32 v193, v73
  v_mov_b32_dpp v116, v114 row_newbcast:2 row_mask:0xf bank_mask:0xf
  v_mov_b32_dpp v117, v115 row_newbcast:2 row_mask:0xf bank_mask:0xf
  v_cvt_f32_i32 v194, v74
  v_cvt_f32_i32 v195, v75
  v_pk_add_f32 v[192:193], v[192:193], v[116:117] op_sel_hi:[1,0] neg_lo:[0,1] neg_hi:[0,1]
  v_pk_add_f32 v[194:195], v[194:195], v[116:117] op_sel_hi:[1,0] neg_lo:[0,1] neg_hi:[0,1]
  v_cvt_pk_bf16_f32 v192, 0, v192
  v_permlane16_swap_b32 v144, v145
  v_cvt_pk_bf16_f32 v193, 0, v193
  v_max_f32 v140, v144, v145
  v_cvt_pk_bf16_f32 v194, 0, v194
  v_mul_f32 v144, s66, v140
  v_cvt_pk_bf16_f32 v195, 0, v195
  v_add_f32 v146, v144, v142
  v_pk_mul_f32 v[192:193], v[192:193], v[116:117] op_sel:[0,1]
  v_sub_f32 v142, 0, v144
  v_pk_mul_f32 v[194:195], v[194:195], v[116:117] op_sel:[0,1]
  s_waitcnt vmcnt(16)
  buffer_load_dwordx4 v[48:51], v94, s[12:15], s60 offen offset:1024 nt
  v_cvt_f32_i32 v196, v76
  v_cvt_f32_i32 v197, v77
  v_cvt_f32_i32 v198, v78
  v_cvt_f32_i32 v199, v79
  v_pk_add_f32 v[196:197], v[196:197], v[116:117] op_sel_hi:[1,0] neg_lo:[0,1] neg_hi:[0,1]
  v_pk_add_f32 v[198:199], v[198:199], v[116:117] op_sel_hi:[1,0] neg_lo:[0,1] neg_hi:[0,1]
  v_cvt_pk_bf16_f32 v196, 0, v196
  v_exp_f32 v146, -v146
  v_cvt_pk_bf16_f32 v197, 0, v197
  ds_bpermute_b32 v147, v101, v146
  v_cvt_pk_bf16_f32 v198, 0, v198
  v_fma_f32 v148, v148, s66, v142
  v_cvt_pk_bf16_f32 v199, 0, v199
  v_exp_f32 v148, v148
  v_pk_mul_f32 v[196:197], v[196:197], v[116:117] op_sel:[0,1]
  v_fma_f32 v149, v149, s66, v142
  v_pk_mul_f32 v[198:199], v[198:199], v[116:117] op_sel:[0,1]
  s_waitcnt vmcnt(16)
  buffer_load_dwordx4 v[52:55], v94, s[12:15], s60 offen offset:1280 nt
  v_cvt_f32_i32 v200, v80
  v_cvt_f32_i32 v201, v81
  v_cvt_f32_i32 v202, v82
  v_cvt_f32_i32 v203, v83
  v_pk_add_f32 v[200:201], v[200:201], v[116:117] op_sel_hi:[1,0] neg_lo:[0,1] neg_hi:[0,1]
  v_pk_add_f32 v[202:203], v[202:203], v[116:117] op_sel_hi:[1,0] neg_lo:[0,1] neg_hi:[0,1]
  v_cvt_pk_bf16_f32 v200, 0, v200
  v_exp_f32 v149, v149
  v_cvt_pk_bf16_f32 v201, 0, v201
  v_fma_f32 v150, v150, s66, v142
  v_cvt_pk_bf16_f32 v202, 0, v202
  v_exp_f32 v150, v150
  v_cvt_pk_bf16_f32 v203, 0, v203
  v_fma_f32 v151, v151, s66, v142
  v_pk_mul_f32 v[200:201], v[200:201], v[116:117] op_sel:[0,1]
  v_exp_f32 v151, v151
  v_pk_mul_f32 v[202:203], v[202:203], v[116:117] op_sel:[0,1]
  s_waitcnt vmcnt(16)
  s_cbranch_vccnz L_vw1_9
  s_waitcnt vmcnt(11)
L_vw1_9:
  buffer_load_dwordx4 v[56:59], v94, s[12:15], s60 offen offset:1536 nt
  v_cvt_f32_i32 v108, v84
  v_cvt_f32_i32 v109, v85
  v_mov_b32_dpp v116, v114 row_newbcast:3 row_mask:0xf bank_mask:0xf
  v_mov_b32_dpp v117, v115 row_newbcast:3 row_mask:0xf bank_mask:0xf
  v_cvt_f32_i32 v110, v86
  v_cvt_f32_i32 v111, v87
  v_pk_add_f32 v[108:109], v[108:109], v[116:117] op_sel_hi:[1,0] neg_lo:[0,1] neg_hi:[0,1]
  v_pk_add_f32 v[110:111], v[110:111], v[116:117] op_sel_hi:[1,0] neg_lo:[0,1] neg_hi:[0,1]
  v_cvt_pk_bf16_f32 v108, 0, v108
  v_fma_f32 v152, v152, s66, v142
  v_cvt_pk_bf16_f32 v109, 0, v109
  v_exp_f32 v152, v152
  v_cvt_pk_bf16_f32 v110, 0, v110
  v_fma_f32 v153, v153, s66, v142
  v_cvt_pk_bf16_f32 v111, 0, v111
  v_exp_f32 v153, v153
  v_pk_mul_f32 v[108:109], v[108:109], v[116:117] op_sel:[0,1]
  v_fma_f32 v154, v154, s66, v142
  v_pk_mul_f32 v[110:111], v[110:111], v[116:117] op_sel:[0,1]
  v_cvt_pk_bf16_f32 v205, v192, v108
  v_cvt_pk_bf16_f32 v209, v193, v109
  v_cvt_pk_bf16_f32 v213, v194, v110
  v_cvt_pk_bf16_f32 v217, v195, v111
  s_waitcnt vmcnt(16)
  buffer_load_dwordx4 v[60:63], v94, s[12:15], s60 offen offset:1792 nt
  v_cvt_f32_i32 v108, v88
  v_cvt_f32_i32 v109, v89
  v_cvt_f32_i32 v110, v90
  v_cvt_f32_i32 v111, v91
  v_pk_add_f32 v[108:109], v[108:109], v[116:117] op_sel_hi:[1,0] neg_lo:[0,1] neg_hi:[0,1]
  v_pk_add_f32 v[110:111], v[110:111], v[116:117] op_sel_hi:[1,0] neg_lo:[0,1] neg_hi:[0,1]
  v_cvt_pk_bf16_f32 v108, 0, v108
  v_exp_f32 v154, v154
  v_cvt_pk_bf16_f32 v109, 0, v109
  v_fma_f32 v155, v155, s66, v142
  v_cvt_pk_bf16_f32 v110, 0, v110
  v_exp_f32 v155, v155
  v_cvt_pk_bf16_f32 v111, 0, v111
  v_fma_f32 v156, v156, s66, v142
  v_pk_mul_f32 v[108:109], v[108:109], v[116:117] op_sel:[0,1]
  v_exp_f32 v156, v156
  v_pk_mul_f32 v[110:111], v[110:111], v[116:117] op_sel:[0,1]
  v_cvt_pk_bf16_f32 v221, v196, v108
  v_cvt_pk_bf16_f32 v225, v197, v109
  v_cvt_pk_bf16_f32 v229, v198, v110
  v_cvt_pk_bf16_f32 v233, v199, v111
  s_waitcnt vmcnt(16)
  buffer_load_dwordx4 v[64:67], v94, s[12:15], s60 offen offset:2048 nt
  v_cvt_f32_i32 v108, v4
  v_cvt_f32_i32 v109, v5
  v_cvt_f32_i32 v110, v6
  v_cvt_f32_i32 v111, v7
  v_pk_add_f32 v[108:109], v[108:109], v[116:117] op_sel_hi:[1,0] neg_lo:[0,1] neg_hi:[0,1]
  v_pk_add_f32 v[110:111], v[110:111], v[116:117] op_sel_hi:[1,0] neg_lo:[0,1] neg_hi:[0,1]
  v_cvt_pk_bf16_f32 v108, 0, v108
  v_fma_f32 v157, v157, s66, v142
  v_cvt_pk_bf16_f32 v109, 0, v109
  v_exp_f32 v157, v157
  v_cvt_pk_bf16_f32 v110, 0, v110
  v_fma_f32 v158, v158, s66, v142
  v_cvt_pk_bf16_f32 v111, 0, v111
  v_exp_f32 v158, v158
  v_pk_mul_f32 v[108:109], v[108:109], v[116:117] op_sel:[0,1]
  v_add_f32 v144, v148, v149
  v_pk_mul_f32 v[110:111], v[110:111], v[116:117] op_sel:[0,1]
  v_cvt_pk_bf16_f32 v237, v200, v108
  v_cvt_pk_bf16_f32 v241, v201, v109
  v_cvt_pk_bf16_f32 v245, v202, v110
  v_cvt_pk_bf16_f32 v249, v203, v111
  s_waitcnt vmcnt(16)
  s_cbranch_vccnz L_vw1_12
  s_waitcnt vmcnt(11)
L_vw1_12:
  buffer_load_dwordx4 v[68:71], v94, s[12:15], s60 offen offset:2304 nt
  v_cvt_f32_i32 v192, v8
  v_cvt_f32_i32 v193, v9
  v_mov_b32_dpp v116, v114 row_newbcast:4 row_mask:0xf bank_mask:0xf
  v_mov_b32_dpp v117, v115 row_newbcast:4 row_mask:0xf bank_mask:0xf
  v_cvt_f32_i32 v194, v10
  v_cvt_f32_i32 v195, v11
  v_pk_add_f32 v[192:193], v[192:193], v[116:117] op_sel_hi:[1,0] neg_lo:[0,1] neg_hi:[0,1]
  v_pk_add_f32 v[194:195], v[194:195], v[116:117] op_sel_hi:[1,0] neg_lo:[0,1] neg_hi:[0,1]
  v_cvt_pk_bf16_f32 v192, 0, v192
  v_add_f32 v145, v150, v151
  v_cvt_pk_bf16_f32 v193, 0, v193
  v_add_f32 v144, v144, v152
  v_cvt_pk_bf16_f32 v194, 0, v194
  v_add_f32 v145, v145, v153
  v_cvt_pk_bf16_f32 v195, 0, v195
  v_add_f32 v144, v144, v154
  v_pk_mul_f32 v[192:193], v[192:193], v[116:117] op_sel:[0,1]
  v_add_f32 v145, v145, v155
  v_pk_mul_f32 v[194:195], v[194:195], v[116:117] op_sel:[0,1]
  s_waitcnt vmcnt(16)
  buffer_load_dwordx4 v[72:75], v94, s[12:15], s60 offen offset:2560 nt
  v_cvt_f32_i32 v196, v12
  v_cvt_f32_i32 v197, v13
  v_cvt_f32_i32 v198, v14
  v_cvt_f32_i32 v199, v15
  v_pk_add_f32 v[196:197], v[196:197], v[116:117] op_sel_hi:[1,0] neg_lo:[0,1] neg_hi:[0,1]
  v_pk_add_f32 v[198:199], v[198:199], v[116:117] op_sel_hi:[1,0] neg_lo:[0,1] neg_hi:[0,1]
  v_cvt_pk_bf16_f32 v196, 0, v196
  v_add_f32 v144, v144, v156
  v_cvt_pk_bf16_f32 v197, 0, v197
  v_add_f32 v145, v145, v157
  v_cvt_pk_bf16_f32 v198, 0, v198
  v_add_f32 v144, v144, v158
  v_cvt_pk_bf16_f32 v199, 0, v199
  v_add_f32 v144, v144, v145
  v_pk_mul_f32 v[196:197], v[196:197], v[116:117] op_sel:[0,1]
  v_fma_f32 v143, v143, v146, v144
  v_pk_mul_f32 v[198:199], v[198:199], v[116:117] op_sel:[0,1]
  s_waitcnt vmcnt(16)
  buffer_load_dwordx4 v[76:79], v94, s[12:15], s60 offen offset:2816 nt
  v_cvt_f32_i32 v200, v16
  v_cvt_f32_i32 v201, v17
  v_cvt_f32_i32 v202, v18
  v_cvt_f32_i32 v203, v19
  v_pk_add_f32 v[200:201], v[200:201], v[116:117] op_sel_hi:[1,0] neg_lo:[0,1] neg_hi:[0,1]
  v_pk_add_f32 v[202:203], v[202:203], v[116:117] op_sel_hi:[1,0] neg_lo:[0,1] neg_hi:[0,1]
  v_cvt_pk_bf16_f32 v200, 0, v200
  v_cvt_pk_bf16_f32 v159, v148, v149
  v_cvt_pk_bf16_f32 v201, 0, v201
  v_cvt_pk_bf16_f32 v160, v150, v151
  v_cvt_pk_bf16_f32 v202, 0, v202
  v_cvt_pk_bf16_f32 v161, v152, v153
  v_cvt_pk_bf16_f32 v203, 0, v203
  v_cvt_pk_bf16_f32 v162, v154, v155
  v_pk_mul_f32 v[200:201], v[200:201], v[116:117] op_sel:[0,1]
  v_cvt_pk_bf16_f32 v163, v156, v157
  v_pk_mul_f32 v[202:203], v[202:203], v[116:117] op_sel:[0,1]
  s_waitcnt vmcnt(16)
  s_cbranch_vccnz L_vw1_15
  s_waitcnt vmcnt(9)
L_vw1_15:
  buffer_load_dwordx4 v[80:83], v95, s[12:15], s60 offen offset:0 nt
  v_cvt_f32_i32 v108, v20
  v_cvt_f32_i32 v109, v21
  v_mov_b32_dpp v116, v114 row_newbcast:5 row_mask:0xf bank_mask:0xf
  v_mov_b32_dpp v117, v115 row_newbcast:5 row_mask:0xf bank_mask:0xf
  v_cvt_f32_i32 v110, v22
  v_cvt_f32_i32 v111, v23
  v_pk_add_f32 v[108:109], v[108:109], v[116:117] op_sel_hi:[1,0] neg_lo:[0,1] neg_hi:[0,1]
  v_pk_add_f32 v[110:111], v[110:111], v[116:117] op_sel_hi:[1,0] neg_lo:[0,1] neg_hi:[0,1]
  v_cvt_pk_bf16_f32 v108, 0, v108
  v_cvt_pk_bf16_f32 v164, v158, 0
  v_cvt_pk_bf16_f32 v109, 0, v109
  v_cndmask_b32 v168, 0, v159, s[72:73]
  v_cvt_pk_bf16_f32 v110, 0, v110
  v_cndmask_b32 v169, 0, v160, s[72:73]
  v_cvt_pk_bf16_f32 v111, 0, v111
  v_cndmask_b32 v170, 0, v161, s[72:73]
  v_pk_mul_f32 v[108:109], v[108:109], v[116:117] op_sel:[0,1]
  v_cndmask_b32 v171, 0, v162, s[72:73]
  v_pk_mul_f32 v[110:111], v[110:111], v[116:117] op_sel:[0,1]
  v_cvt_pk_bf16_f32 v206, v192, v108
  v_cvt_pk_bf16_f32 v210, v193, v109
  v_cvt_pk_bf16_f32 v214, v194, v110
  v_cvt_pk_bf16_f32 v218, v195, v111
  s_waitcnt vmcnt(16)
  buffer_load_dwordx4 v[84:87], v95, s[12:15], s60 offen offset:256 nt
  v_cvt_f32_i32 v108, v24
  v_cvt_f32_i32 v109, v25
  v_cvt_f32_i32 v110, v26
  v_cvt_f32_i32 v111, v27
  v_pk_add_f32 v[108:109], v[108:109], v[116:117] op_sel_hi:[1,0] neg_lo:[0,1] neg_hi:[0,1]
  v_pk_add_f32 v[110:111], v[110:111], v[116:117] op_sel_hi:[1,0] neg_lo:[0,1] neg_hi:[0,1]
  v_cvt_pk_bf16_f32 v108, 0, v108
  v_cndmask_b32 v172, 0, v159, s[74:75]
  v_cvt_pk_bf16_f32 v109, 0, v109
  v_cndmask_b32 v173, 0, v160, s[74:75]
  v_cvt_pk_bf16_f32 v110, 0, v110
  v_cndmask_b32 v174, 0, v161, s[74:75]
  v_cvt_pk_bf16_f32 v111, 0, v111
  v_cndmask_b32 v175, 0, v162, s[74:75]
  v_pk_mul_f32 v[108:109], v[108:109], v[116:117] op_sel:[0,1]
  v_cndmask_b32 v176, 0, v159, s[76:77]
  v_pk_mul_f32 v[110:111], v[110:111], v[116:117] op_sel:[0,1]
  v_cvt_pk_bf16_f32 v222, v196, v108
  v_cvt_pk_bf16_f32 v226, v197, v109
  v_cvt_pk_bf16_f32 v230, v198, v110
  v_cvt_pk_bf16_f32 v234, v199, v111
  s_waitcnt vmcnt(16)
  buffer_load_dwordx4 v[88:91], v95, s[12:15], s60 offen offset:512 nt
  v_cvt_f32_i32 v108, v28
  v_cvt_f32_i32 v109, v29
  v_cvt_f32_i32 v110, v30
  v_cvt_f32_i32 v111, v31
  v_pk_add_f32 v[108:109], v[108:109], v[116:117] op_sel_hi:[1,0] neg_lo:[0,1] neg_hi:[0,1]
  v_pk_add_f32 v[110:111], v[110:111], v[116:117] op_sel_hi:[1,0] neg_lo:[0,1] neg_hi:[0,1]
  v_cvt_pk_bf16_f32 v108, 0, v108
  v_cndmask_b32 v177, 0, v160, s[76:77]
  v_cvt_pk_bf16_f32 v109, 0, v109
  v_cndmask_b32 v178, 0, v161, s[76:77]
  v_cvt_pk_bf16_f32 v110, 0, v110
  v_cndmask_b32 v179, 0, v162, s[76:77]
  v_cvt_pk_bf16_f32 v111, 0, v111
  v_cndmask_b32 v180, 0, v159, s[78:79]
  v_pk_mul_f32 v[108:109], v[108:109], v[116:117] op_sel:[0,1]
  v_cndmask_b32 v181, 0, v160, s[78:79]
  v_pk_mul_f32 v[110:111], v[110:111], v[116:117] op_sel:[0,1]
  v_cvt_pk_bf16_f32 v238, v200, v108
  v_cvt_pk_bf16_f32 v242, v201, v109
  v_cvt_pk_bf16_f32 v246, v202, v110
  v_cvt_pk_bf16_f32 v250, v203, v111
  v_mad_u32_u24 v92, v97, s63, v3
  v_add_u32 v93, 768, v92
  v_add_u32 v94, 4608, v92
  v_add_u32 v95, 7680, v92
  v_cndmask_b32 v92, v92, v105, s[52:53]
  v_cndmask_b32 v95, v95, v105, s[54:55]
  s_waitcnt vmcnt(16)
  s_cbranch_vccnz L_vw1_18
  s_waitcnt vmcnt(9)
L_vw1_18:
  buffer_load_dwordx4 v[4:7], v92, s[12:15], s61 offen offset:0 nt
  v_cvt_f32_i32 v192, v32
  v_cvt_f32_i32 v193, v33
  v_mov_b32_dpp v116, v114 row_newbcast:6 row_mask:0xf bank_mask:0xf
  v_mov_b32_dpp v117, v115 row_newbcast:6 row_mask:0xf bank_mask:0xf
  v_cvt_f32_i32 v194, v34
  v_cvt_f32_i32 v195, v35
  v_pk_add_f32 v[192:193], v[192:193], v[116:117] op_sel_hi:[1,0] neg_lo:[0,1] neg_hi:[0,1]
  v_pk_add_f32 v[194:195], v[194:195], v[116:117] op_sel_hi:[1,0] neg_lo:[0,1] neg_hi:[0,1]
  v_cvt_pk_bf16_f32 v192, 0, v192
  v_cndmask_b32 v182, 0, v161, s[78:79]
  v_cvt_pk_bf16_f32 v193, 0, v193
  v_cndmask_b32 v183, 0, v162, s[78:79]
  v_cvt_pk_bf16_f32 v194, 0, v194
  s_waitcnt lgkmcnt(0)
  v_cvt_pk_bf16_f32 v195, 0, v195
  v_mul_f32 v128, v147, v128
  v_pk_mul_f32 v[192:193], v[192:193], v[116:117] op_sel:[0,1]
  v_mul_f32 v129, v147, v129
  v_pk_mul_f32 v[194:195], v[194:195], v[116:117] op_sel:[0,1]
  s_waitcnt vmcnt(14)
  buffer_load_dwordx4 v[8:11], v92, s[12:15], s61 offen offset:256 nt
  v_cvt_f32_i32 v196, v36
  v_cvt_f32_i32 v197, v37
  v_cvt_f32_i32 v198, v38
  v_cvt_f32_i32 v199, v39
  v_pk_add_f32 v[196:197], v[196:197], v[116:117] op_sel_hi:[1,0] neg_lo:[0,1] neg_hi:[0,1]
  v_pk_add_f32 v[198:199], v[198:199], v[116:117] op_sel_hi:[1,0] neg_lo:[0,1] neg_hi:[0,1]
  v_cvt_pk_bf16_f32 v196, 0, v196
  v_mul_f32 v130, v147, v130
  v_cvt_pk_bf16_f32 v197, 0, v197
  v_mul_f32 v131, v147, v131
  v_cvt_pk_bf16_f32 v198, 0, v198
  v_mul_f32 v132, v147, v132
  v_cvt_pk_bf16_f32 v199, 0, v199
  v_mul_f32 v133, v147, v133
  v_pk_mul_f32 v[196:197], v[196:197], v[116:117] op_sel:[0,1]
  v_mul_f32 v134, v147, v134
  v_pk_mul_f32 v[198:199], v[198:199], v[116:117] op_sel:[0,1]
  s_waitcnt vmcnt(14)
  buffer_load_dwordx4 v[12:15], v92, s[12:15], s61 offen offset:512 nt
  v_cvt_f32_i32 v200, v40
  v_cvt_f32_i32 v201, v41
  v_cvt_f32_i32 v202, v42
  v_cvt_f32_i32 v203, v43
  v_pk_add_f32 v[200:201], v[200:201], v[116:117] op_sel_hi:[1,0] neg_lo:[0,1] neg_hi:[0,1]
  v_pk_add_f32 v[202:203], v[202:203], v[116:117] op_sel_hi:[1,0] neg_lo:[0,1] neg_hi:[0,1]
  v_cvt_pk_bf16_f32 v200, 0, v200
  v_mul_f32 v135, v147, v135
  v_cvt_pk_bf16_f32 v201, 0, v201
  v_mul_f32 v136, v147, v136
  v_cvt_pk_bf16_f32 v202, 0, v202
  v_mul_f32 v137, v147, v137
  v_cvt_pk_bf16_f32 v203, 0, v203
  v_mul_f32 v138, v147, v138
  v_pk_mul_f32 v[200:201], v[200:201], v[116:117] op_sel:[0,1]
  v_mul_f32 v139, v147, v139
  v_pk_mul_f32 v[202:203], v[202:203], v[116:117] op_sel:[0,1]
  s_waitcnt vmcnt(14)
  s_cbranch_vccnz L_vw1_21
  s_waitcnt vmcnt(9)
L_vw1_21:
  buffer_load_dwordx4 v[16:19], v93, s[12:15], s61 offen offset:0 nt
  v_cvt_f32_i32 v108, v44
  v_cvt_f32_i32 v109, v45
  v_mov_b32_dpp v116, v114 row_newbcast:7 row_mask:0xf bank_mask:0xf
  v_mov_b32_dpp v117, v115 row_newbcast:7 row_mask:0xf bank_mask:0xf
  v_cvt_f32_i32 v110, v46
  v_cvt_f32_i32 v111, v47
  v_pk_add_f32 v[108:109], v[108:109], v[116:117] op_sel_hi:[1,0] neg_lo:[0,1] neg_hi:[0,1]
  v_pk_add_f32 v[110:111], v[110:111], v[116:117] op_sel_hi:[1,0] neg_lo:[0,1] neg_hi:[0,1]
  v_cvt_pk_bf16_f32 v108, 0, v108
  v_cvt_pk_bf16_f32 v109, 0, v109
  v_cvt_pk_bf16_f32 v110, 0, v110
  v_cvt_pk_bf16_f32 v111, 0, v111
  v_pk_mul_f32 v[108:109], v[108:109], v[116:117] op_sel:[0,1]
  v_pk_mul_f32 v[110:111], v[110:111], v[116:117] op_sel:[0,1]
  v_cvt_pk_bf16_f32 v207, v192, v108
  v_cvt_pk_bf16_f32 v211, v193, v109
  v_cvt_pk_bf16_f32 v215, v194, v110
  v_cvt_pk_bf16_f32 v219, v195, v111
  v_mfma_f32_16x16x32_bf16 v[128:131], v[168:171], v[204:207], v[128:131]
  v_mfma_f32_16x16x32_bf16 v[128:131], v[172:175], v[208:211], v[128:131]
  v_mfma_f32_16x16x32_bf16 v[128:131], v[176:179], v[212:215], v[128:131]
  v_mfma_f32_16x16x32_bf16 v[128:131], v[180:183], v[216:219], v[128:131]
  s_waitcnt vmcnt(14)
  buffer_load_dwordx4 v[20:23], v93, s[12:15], s61 offen offset:256 nt
  v_cvt_f32_i32 v108, v48
  v_cvt_f32_i32 v109, v49
  v_cvt_f32_i32 v110, v50
  v_cvt_f32_i32 v111, v51
  v_pk_add_f32 v[108:109], v[108:109], v[116:117] op_sel_hi:[1,0] neg_lo:[0,1] neg_hi:[0,1]
  v_pk_add_f32 v[110:111], v[110:111], v[116:117] op_sel_hi:[1,0] neg_lo:[0,1] neg_hi:[0,1]
  v_cvt_pk_bf16_f32 v108, 0, v108
  v_cvt_pk_bf16_f32 v109, 0, v109
  v_cvt_pk_bf16_f32 v110, 0, v110
  v_cvt_pk_bf16_f32 v111, 0, v111
  v_pk_mul_f32 v[108:109], v[108:109], v[116:117] op_sel:[0,1]
  v_pk_mul_f32 v[110:111], v[110:111], v[116:117] op_sel:[0,1]
  v_cvt_pk_bf16_f32 v223, v196, v108
  v_cvt_pk_bf16_f32 v227, v197, v109
  v_cvt_pk_bf16_f32 v231, v198, v110
  v_cvt_pk_bf16_f32 v235, v199, v111
  v_mfma_f32_16x16x32_bf16 v[132:135], v[168:171], v[220:223], v[132:135]
  v_mfma_f32_16x16x32_bf16 v[132:135], v[172:175], v[224:227], v[132:135]
  v_mfma_f32_16x16x32_bf16 v[132:135], v[176:179], v[228:231], v[132:135]
  v_mfma_f32_16x16x32_bf16 v[132:135], v[180:183], v[232:235], v[132:135]
  s_waitcnt vmcnt(14)
  buffer_load_dwordx4 v[24:27], v93, s[12:15], s61 offen offset:512 nt
  v_cvt_f32_i32 v108, v52
  v_cvt_f32_i32 v109, v53
  v_cvt_f32_i32 v110, v54
  v_cvt_f32_i32 v111, v55
  v_pk_add_f32 v[108:109], v[108:109], v[116:117] op_sel_hi:[1,0] neg_lo:[0,1] neg_hi:[0,1]
  v_pk_add_f32 v[110:111], v[110:111], v[116:117] op_sel_hi:[1,0] neg_lo:[0,1] neg_hi:[0,1]
  v_cvt_pk_bf16_f32 v108, 0, v108
  v_cvt_pk_bf16_f32 v109, 0, v109
  v_cvt_pk_bf16_f32 v110, 0, v110
  v_cvt_pk_bf16_f32 v111, 0, v111
  v_pk_mul_f32 v[108:109], v[108:109], v[116:117] op_sel:[0,1]
  v_pk_mul_f32 v[110:111], v[110:111], v[116:117] op_sel:[0,1]
  v_cvt_pk_bf16_f32 v239, v200, v108
  v_cvt_pk_bf16_f32 v243, v201, v109
  v_cvt_pk_bf16_f32 v247, v202, v110
  v_cvt_pk_bf16_f32 v251, v203, v111
  v_mfma_f32_16x16x32_bf16 v[136:139], v[168:171], v[236:239], v[136:139]
  v_mfma_f32_16x16x32_bf16 v[136:139], v[172:175], v[240:243], v[136:139]
  v_mfma_f32_16x16x32_bf16 v[136:139], v[176:179], v[244:247], v[136:139]
  v_mfma_f32_16x16x32_bf16 v[136:139], v[180:183], v[248:251], v[136:139]
  s_waitcnt vmcnt(14)
  s_cbranch_vccnz L_vw1_24
  s_waitcnt vmcnt(9)
L_vw1_24:
  buffer_load_dwordx4 v[28:31], v93, s[12:15], s61 offen offset:768 nt
  v_cvt_f32_i32 v192, v56
  v_cvt_f32_i32 v193, v57
  v_mov_b32_dpp v116, v114 row_newbcast:8 row_mask:0xf bank_mask:0xf
  v_mov_b32_dpp v117, v115 row_newbcast:8 row_mask:0xf bank_mask:0xf
  v_cvt_f32_i32 v194, v58
  v_cvt_f32_i32 v195, v59
  v_pk_add_f32 v[192:193], v[192:193], v[116:117] op_sel_hi:[1,0] neg_lo:[0,1] neg_hi:[0,1]
  v_pk_add_f32 v[194:195], v[194:195], v[116:117] op_sel_hi:[1,0] neg_lo:[0,1] neg_hi:[0,1]
  v_cvt_pk_bf16_f32 v192, 0, v192
  v_cndmask_b32 v184, 0, v163, s[72:73]
  v_cvt_pk_bf16_f32 v193, 0, v193
  v_cndmask_b32 v185, 0, v164, s[72:73]
  v_cvt_pk_bf16_f32 v194, 0, v194
  v_cndmask_b32 v186, 0, v163, s[74:75]
  v_cvt_pk_bf16_f32 v195, 0, v195
  v_cndmask_b32 v187, 0, v164, s[74:75]
  v_pk_mul_f32 v[192:193], v[192:193], v[116:117] op_sel:[0,1]
  v_cndmask_b32 v188, 0, v163, s[76:77]
  v_pk_mul_f32 v[194:195], v[194:195], v[116:117] op_sel:[0,1]
  s_waitcnt vmcnt(14)
  buffer_load_dwordx4 v[32:35], v93, s[12:15], s61 offen offset:1024 nt
  v_cvt_f32_i32 v196, v60
  v_cvt_f32_i32 v197, v61
  v_cvt_f32_i32 v198, v62
  v_cvt_f32_i32 v199, v63
  v_pk_add_f32 v[196:197], v[196:197], v[116:117] op_sel_hi:[1,0] neg_lo:[0,1] neg_hi:[0,1]
  v_pk_add_f32 v[198:199], v[198:199], v[116:117] op_sel_hi:[1,0] neg_lo:[0,1] neg_hi:[0,1]
  v_cvt_pk_bf16_f32 v196, 0, v196
  v_cndmask_b32 v189, 0, v164, s[76:77]
  v_cvt_pk_bf16_f32 v197, 0, v197
  v_cndmask_b32 v190, 0, v163, s[78:79]
  v_cvt_pk_bf16_f32 v198, 0, v198
  v_cndmask_b32 v191, 0, v164, s[78:79]
  v_cvt_pk_bf16_f32 v199, 0, v199
  v_pk_mul_f32 v[196:197], v[196:197], v[116:117] op_sel:[0,1]
  v_pk_mul_f32 v[198:199], v[198:199], v[116:117] op_sel:[0,1]
  s_waitcnt vmcnt(14)
  buffer_load_dwordx4 v[36:39], v93, s[12:15], s61 offen offset:1280 nt
  v_cvt_f32_i32 v200, v64
  v_cvt_f32_i32 v201, v65
  v_cvt_f32_i32 v202, v66
  v_cvt_f32_i32 v203, v67
  v_pk_add_f32 v[200:201], v[200:201], v[116:117] op_sel_hi:[1,0] neg_lo:[0,1] neg_hi:[0,1]
  v_pk_add_f32 v[202:203], v[202:203], v[116:117] op_sel_hi:[1,0] neg_lo:[0,1] neg_hi:[0,1]
  v_cvt_pk_bf16_f32 v200, 0, v200
  v_cvt_pk_bf16_f32 v201, 0, v201
  v_cvt_pk_bf16_f32 v202, 0, v202
  v_cvt_pk_bf16_f32 v203, 0, v203
  v_pk_mul_f32 v[200:201], v[200:201], v[116:117] op_sel:[0,1]
  v_pk_mul_f32 v[202:203], v[202:203], v[116:117] op_sel:[0,1]
  s_waitcnt vmcnt(14)
  s_cbranch_vccnz L_vw1_27
  s_waitcnt vmcnt(9)
L_vw1_27:
  buffer_load_dwordx4 v[40:43], v93, s[12:15], s61 offen offset:1536 nt
  v_cvt_f32_i32 v108, v68
  v_cvt_f32_i32 v109, v69
  v_mov_b32_dpp v116, v114 row_newbcast:9 row_mask:0xf bank_mask:0xf
  v_mov_b32_dpp v117, v115 row_newbcast:9 row_mask:0xf bank_mask:0xf
  v_cvt_f32_i32 v110, v70
  v_cvt_f32_i32 v111, v71
  v_pk_add_f32 v[108:109], v[108:109], v[116:117] op_sel_hi:[1,0] neg_lo:[0,1] neg_hi:[0,1]
  v_pk_add_f32 v[110:111], v[110:111], v[116:117] op_sel_hi:[1,0] neg_lo:[0,1] neg_hi:[0,1]
  v_cvt_pk_bf16_f32 v108, 0, v108
  v_cvt_pk_bf16_f32 v109, 0, v109
  v_cvt_pk_bf16_f32 v110, 0, v110
  v_cvt_pk_bf16_f32 v111, 0, v111
  v_pk_mul_f32 v[108:109], v[108:109], v[116:117] op_sel:[0,1]
  v_pk_mul_f32 v[110:111], v[110:111], v[116:117] op_sel:[0,1]
  v_cvt_pk_bf16_f32 v204, v192, v108
  v_cvt_pk_bf16_f32 v208, v193, v109
  v_cvt_pk_bf16_f32 v212, v194, v110
  v_cvt_pk_bf16_f32 v216, v195, v111
  s_waitcnt vmcnt(14)
  buffer_load_dwordx4 v[44:47], v93, s[12:15], s61 offen offset:1792 nt
  v_cvt_f32_i32 v108, v72
  v_cvt_f32_i32 v109, v73
  v_cvt_f32_i32 v110, v74
  v_cvt_f32_i32 v111, v75
  v_pk_add_f32 v[108:109], v[108:109], v[116:117] op_sel_hi:[1,0] neg_lo:[0,1] neg_hi:[0,1]
  v_pk_add_f32 v[110:111], v[110:111], v[116:117] op_sel_hi:[1,0] neg_lo:[0,1] neg_hi:[0,1]
  v_cvt_pk_bf16_f32 v108, 0, v108
  v_cvt_pk_bf16_f32 v109, 0, v109
  v_cvt_pk_bf16_f32 v110, 0, v110
  v_cvt_pk_bf16_f32 v111, 0, v111
  v_pk_mul_f32 v[108:109], v[108:109], v[116:117] op_sel:[0,1]
  v_pk_mul_f32 v[110:111], v[110:111], v[116:117] op_sel:[0,1]
  v_cvt_pk_bf16_f32 v220, v196, v108
  v_cvt_pk_bf16_f32 v224, v197, v109
  v_cvt_pk_bf16_f32 v228, v198, v110
  v_cvt_pk_bf16_f32 v232, v199, v111
  s_waitcnt vmcnt(14)
  buffer_load_dwordx4 v[48:51], v93, s[12:15], s61 offen offset:2048 nt
  v_cvt_f32_i32 v108, v76
  v_cvt_f32_i32 v109, v77
  v_cvt_f32_i32 v110, v78
  v_cvt_f32_i32 v111, v79
  v_pk_add_f32 v[108:109], v[108:109], v[116:117] op_sel_hi:[1,0] neg_lo:[0,1] neg_hi:[0,1]
  v_pk_add_f32 v[110:111], v[110:111], v[116:117] op_sel_hi:[1,0] neg_lo:[0,1] neg_hi:[0,1]
  v_cvt_pk_bf16_f32 v108, 0, v108
  v_cvt_pk_bf16_f32 v109, 0, v109
  v_cvt_pk_bf16_f32 v110, 0, v110
  v_cvt_pk_bf16_f32 v111, 0, v111
  v_pk_mul_f32 v[108:109], v[108:109], v[116:117] op_sel:[0,1]
  v_pk_mul_f32 v[110:111], v[110:111], v[116:117] op_sel:[0,1]
  v_cvt_pk_bf16_f32 v236, v200, v108
  v_cvt_pk_bf16_f32 v240, v201, v109
  v_cvt_pk_bf16_f32 v244, v202, v110
  v_cvt_pk_bf16_f32 v248, v203, v111
  s_waitcnt vmcnt(14)
  s_cbranch_vccnz L_vw1_30
  s_waitcnt vmcnt(9)
L_vw1_30:
  buffer_load_dwordx4 v[52:55], v93, s[12:15], s61 offen offset:2304 nt
  v_cvt_f32_i32 v192, v80
  v_cvt_f32_i32 v193, v81
  v_mov_b32_dpp v116, v114 row_newbcast:10 row_mask:0xf bank_mask:0xf
  v_mov_b32_dpp v117, v115 row_newbcast:10 row_mask:0xf bank_mask:0xf
  v_cvt_f32_i32 v194, v82
  v_cvt_f32_i32 v195, v83
  v_pk_add_f32 v[192:193], v[192:193], v[116:117] op_sel_hi:[1,0] neg_lo:[0,1] neg_hi:[0,1]
  v_pk_add_f32 v[194:195], v[194:195], v[116:117] op_sel_hi:[1,0] neg_lo:[0,1] neg_hi:[0,1]
  v_cvt_pk_bf16_f32 v192, 0, v192
  v_cvt_pk_bf16_f32 v193, 0, v193
  v_cvt_pk_bf16_f32 v194, 0, v194
  v_cvt_pk_bf16_f32 v195, 0, v195
  v_pk_mul_f32 v[192:193], v[192:193], v[116:117] op_sel:[0,1]
  v_pk_mul_f32 v[194:195], v[194:195], v[116:117] op_sel:[0,1]
  v_cvt_pk_bf16_f32 v205, v192, 0
  v_cvt_pk_bf16_f32 v209, v193, 0
  v_cvt_pk_bf16_f32 v213, v194, 0
  v_cvt_pk_bf16_f32 v217, v195, 0
  v_mfma_f32_16x16x16_bf16 v[128:131], v[184:185], v[204:205], v[128:131]
  v_mfma_f32_16x16x16_bf16 v[128:131], v[186:187], v[208:209], v[128:131]
  v_mfma_f32_16x16x16_bf16 v[128:131], v[188:189], v[212:213], v[128:131]
  v_mfma_f32_16x16x16_bf16 v[128:131], v[190:191], v[216:217], v[128:131]
  s_waitcnt vmcnt(14)
  buffer_load_dwordx4 v[56:59], v93, s[12:15], s61 offen offset:2560 nt
  v_cvt_f32_i32 v196, v84
  v_cvt_f32_i32 v197, v85
  v_cvt_f32_i32 v198, v86
  v_cvt_f32_i32 v199, v87
  v_pk_add_f32 v[196:197], v[196:197], v[116:117] op_sel_hi:[1,0] neg_lo:[0,1] neg_hi:[0,1]
  v_pk_add_f32 v[198:199], v[198:199], v[116:117] op_sel_hi:[1,0] neg_lo:[0,1] neg_hi:[0,1]
  v_cvt_pk_bf16_f32 v196, 0, v196
  v_cvt_pk_bf16_f32 v197, 0, v197
  v_cvt_pk_bf16_f32 v198, 0, v198
  v_cvt_pk_bf16_f32 v199, 0, v199
  v_pk_mul_f32 v[196:197], v[196:197], v[116:117] op_sel:[0,1]
  v_pk_mul_f32 v[198:199], v[198:199], v[116:117] op_sel:[0,1]
  v_cvt_pk_bf16_f32 v221, v196, 0
  v_cvt_pk_bf16_f32 v225, v197, 0
  v_cvt_pk_bf16_f32 v229, v198, 0
  v_cvt_pk_bf16_f32 v233, v199, 0
  v_mfma_f32_16x16x16_bf16 v[132:135], v[184:185], v[220:221], v[132:135]
  v_mfma_f32_16x16x16_bf16 v[132:135], v[186:187], v[224:225], v[132:135]
  v_mfma_f32_16x16x16_bf16 v[132:135], v[188:189], v[228:229], v[132:135]
  v_mfma_f32_16x16x16_bf16 v[132:135], v[190:191], v[232:233], v[132:135]
  s_waitcnt vmcnt(14)
  buffer_load_dwordx4 v[60:63], v93, s[12:15], s61 offen offset:2816 nt
  v_cvt_f32_i32 v200, v88
  v_cvt_f32_i32 v201, v89
  v_cvt_f32_i32 v202, v90
  v_cvt_f32_i32 v203, v91
  v_pk_add_f32 v[200:201], v[200:201], v[116:117] op_sel_hi:[1,0] neg_lo:[0,1] neg_hi:[0,1]
  v_pk_add_f32 v[202:203], v[202:203], v[116:117] op_sel_hi:[1,0] neg_lo:[0,1] neg_hi:[0,1]
  v_cvt_pk_bf16_f32 v200, 0, v200
  v_cvt_pk_bf16_f32 v201, 0, v201
  v_cvt_pk_bf16_f32 v202, 0, v202
  v_cvt_pk_bf16_f32 v203, 0, v203
  v_pk_mul_f32 v[200:201], v[200:201], v[116:117] op_sel:[0,1]
  v_pk_mul_f32 v[202:203], v[202:203], v[116:117] op_sel:[0,1]
  v_cvt_pk_bf16_f32 v237, v200, 0
  v_cvt_pk_bf16_f32 v241, v201, 0
  v_cvt_pk_bf16_f32 v245, v202, 0
  v_cvt_pk_bf16_f32 v249, v203, 0
  v_mfma_f32_16x16x16_bf16 v[136:139], v[184:185], v[236:237], v[136:139]
  v_mfma_f32_16x16x16_bf16 v[136:139], v[186:187], v[240:241], v[136:139]
  v_mfma_f32_16x16x16_bf16 v[136:139], v[188:189], v[244:245], v[136:139]
  v_mfma_f32_16x16x16_bf16 v[136:139], v[190:191], v[248:249], v[136:139]
  s_mov_b32 s60, s61
  s_cmp_ge_u32 s64, 96
  s_cbranch_scc1 L_v_done
  s_cmp_eq_u32 s89, s88
  s_cbranch_scc1 L_v0
  s_mov_b32 s88, s89
  s_and_b32 s70, s86, 15
  s_cmp_ge_u32 s70, 12
  s_cselect_b32 s70, 6208, 0
  s_bitcmp1_b32 s86, 4
  s_cselect_b32 s71, 12416, 0
  s_add_u32 s70, s70, s71
  v_mov_b32 v145, v143
  v_add_u32 v144, s70, v102
  v_add_u32 v147, s70, v103
  v_permlane32_swap_b32 v143, v145
  v_add_f32 v143, v143, v145
  v_mov_b32 v145, v143
  ds_write_b128 v144, v[128:131] offset:0
  ds_write_b128 v144, v[132:135] offset:1024
  ds_write_b128 v144, v[136:139] offset:2048
  v_permlane16_swap_b32 v143, v145
  v_add_f32 v143, v143, v145
  ds_write_b64 v147, v[142:143]
  s_waitcnt lgkmcnt(0)
  v_mov_b32 v128, 0
  v_mov_b32 v129, 0
  v_mov_b32 v130, 0
  v_mov_b32 v131, 0
  v_mov_b32 v132, 0
  v_mov_b32 v133, 0
  v_mov_b32 v134, 0
  v_mov_b32 v135, 0
  v_mov_b32 v136, 0
  v_mov_b32 v137, 0
  v_mov_b32 v138, 0
  v_mov_b32 v139, 0
  v_mov_b32 v140, 0xff800000
  v_mov_b32 v142, 0x7f800000
  v_mov_b32 v143, 0
  s_branch L_v0
L_v_done:
  s_and_b32 s70, s86, 15
  s_cmp_ge_u32 s70, 12
  s_cselect_b32 s70, 6208, 0
  s_bitcmp1_b32 s86, 4
  s_cselect_b32 s71, 12416, 0
  s_add_u32 s70, s70, s71
  v_mov_b32 v145, v143
  v_add_u32 v144, s70, v102
  v_add_u32 v147, s70, v103
  v_permlane32_swap_b32 v143, v145
  v_add_f32 v143, v143, v145
  v_mov_b32 v145, v143
  ds_write_b128 v144, v[128:131] offset:0
  ds_write_b128 v144, v[132:135] offset:1024
  ds_write_b128 v144, v[136:139] offset:2048
  v_permlane16_swap_b32 v143, v145
  v_add_f32 v143, v143, v145
  ds_write_b64 v147, v[142:143]
L_finish:
  v_mov_b32 v144, 61728
  ds_read_b128 v[168:171], v144
  ds_read_b128 v[172:175], v144 offset:16
  s_mul_i32 s70, s4, 6208
  s_lshl_b32 s71, s3, 10
  v_lshl_add_u32 v152, v0, 4, s71
  v_lshrrev_b32 v145, 4, v0
  v_lshlrev_b32 v154, 3, v145
  v_add_u32 v154, 43008, v154
  s_sub_u32 s97, 6208, s70
  v_add_u32 v153, s97, v152
  v_add_u32 v140, s70, v152
  s_sub_u32 s97, 12416, s70
  v_add_u32 v112, s97, v154
  s_add_u32 s97, s70, 6208
  v_add_u32 v113, s97, v154
  v_add_u32 v155, 18624, v154
  s_mul_i32 s70, s3, 1152
  v_lshl_add_u32 v156, v0, 4, s70
  v_lshl_add_u32 v157, v145, 5, s70
  v_and_b32 v146, 1, v0
  v_lshl_add_u32 v157, v146, 4, v157
  v_mul_u32_u24 v146, 384, v145
  v_and_b32 v145, 15, v0
  v_lshl_add_u32 v146, v145, 3, v146
  s_movk_i32 s65, 0xff00
  s_mov_b32 s48, 0x30003
  s_mov_b32 s49, 0x30003
  s_mov_b32 s50, 0x0c0c0400
  s_mov_b32 s51, 0x05040100
  s_mov_b32 s64, 0
  s_waitcnt vmcnt(0) lgkmcnt(0)
  s_barrier
  ds_read2_b64 v[176:179], v154 offset1:4
  ds_read_b128 v[192:195], v152 offset:36864
  ds_read_b128 v[196:199], v152 offset:39936
  ds_read2_b64 v[180:183], v155 offset1:4
  ds_read_b128 v[200:203], v152 offset:55488
  ds_read_b128 v[204:207], v152 offset:58560
  ds_read2_b64 v[184:187], v112 offset1:4
  ds_read_b128 v[208:211], v153 offset:43072
  ds_read_b128 v[212:215], v153 offset:46144
  ds_read2_b64 v[188:191], v113 offset1:4
  ds_read_b128 v[216:219], v140 offset:43072
  ds_read_b128 v[220:223], v140 offset:46144
  v_readfirstlane_b32 s72, v168
  v_readfirstlane_b32 s73, v169
  v_readfirstlane_b32 s74, v170
  v_readfirstlane_b32 s75, v171
  v_readfirstlane_b32 s76, v172
  v_readfirstlane_b32 s77, v173
  v_readfirstlane_b32 s78, v174
  v_bfe_u32 v148, v175, 0, 8
  v_bfe_u32 v149, v175, 8, 8
  v_bfe_u32 v150, v175, 16, 8
  v_bfe_u32 v151, v175, 24, 8
  s_waitcnt lgkmcnt(9)
  v_min_f32 v144, v176, v178
  v_sub_f32 v176, v144, v176
  v_sub_f32 v178, v144, v178
  v_exp_f32 v176, v176
  v_exp_f32 v178, v178
  v_mul_f32 v145, v176, v177
  v_pk_mul_f32 v[192:193], v[192:193], v[176:177] op_sel_hi:[1,0]
  v_pk_mul_f32 v[194:195], v[194:195], v[176:177] op_sel_hi:[1,0]
  v_pk_fma_f32 v[192:193], v[196:197], v[178:179], v[192:193] op_sel_hi:[1,0,1]
  v_pk_fma_f32 v[194:195], v[198:199], v[178:179], v[194:195] op_sel_hi:[1,0,1]
  v_fma_f32 v197, v178, v179, v145
  v_mov_b32 v196, v144
  v_and_or_b32 v192, v192, s65, v148
  v_and_or_b32 v193, v193, s65, v149
  v_and_or_b32 v194, v194, s65, v150
  v_and_or_b32 v195, v195, s65, v151
  v_mov_b32 v199, v175
  buffer_store_dwordx4 v[192:195], v156, s[40:43], s72 offen sc1
  s_mov_b64 exec, s[48:49]
  buffer_store_dwordx4 v[196:199], v157, s[40:43], s72 offen offset:1024 sc1
  s_mov_b64 exec, -1
  s_waitcnt lgkmcnt(6)
  v_min_f32 v144, v180, v182
  v_sub_f32 v180, v144, v180
  v_sub_f32 v182, v144, v182
  v_exp_f32 v180, v180
  v_exp_f32 v182, v182
  v_mul_f32 v145, v180, v181
  v_pk_mul_f32 v[200:201], v[200:201], v[180:181] op_sel_hi:[1,0]
  v_pk_mul_f32 v[202:203], v[202:203], v[180:181] op_sel_hi:[1,0]
  v_pk_fma_f32 v[200:201], v[204:205], v[182:183], v[200:201] op_sel_hi:[1,0,1]
  v_pk_fma_f32 v[202:203], v[206:207], v[182:183], v[202:203] op_sel_hi:[1,0,1]
  v_fma_f32 v205, v182, v183, v145
  v_mov_b32 v204, v144
  v_and_or_b32 v200, v200, s65, v148
  v_and_or_b32 v201, v201, s65, v149
  v_and_or_b32 v202, v202, s65, v150
  v_and_or_b32 v203, v203, s65, v151
  v_mov_b32 v207, v175
  buffer_store_dwordx4 v[200:203], v156, s[40:43], s73 offen sc1
  s_mov_b64 exec, s[48:49]
  buffer_store_dwordx4 v[204:207], v157, s[40:43], s73 offen offset:1024 sc1
  s_mov_b64 exec, -1
  s_waitcnt lgkmcnt(3)
  v_min_f32 v144, v184, v186
  v_sub_f32 v184, v144, v184
  v_sub_f32 v186, v144, v186
  v_exp_f32 v184, v184
  v_exp_f32 v186, v186
  v_mul_f32 v145, v184, v185
  v_pk_mul_f32 v[208:209], v[208:209], v[184:185] op_sel_hi:[1,0]
  v_pk_mul_f32 v[210:211], v[210:211], v[184:185] op_sel_hi:[1,0]
  v_pk_fma_f32 v[208:209], v[212:213], v[186:187], v[208:209] op_sel_hi:[1,0,1]
  v_pk_fma_f32 v[210:211], v[214:215], v[186:187], v[210:211] op_sel_hi:[1,0,1]
  v_fma_f32 v213, v186, v187, v145
  v_mov_b32 v212, v144
  v_and_or_b32 v208, v208, s65, v148
  v_and_or_b32 v209, v209, s65, v149
  v_and_or_b32 v210, v210, s65, v150
  v_and_or_b32 v211, v211, s65, v151
  v_mov_b32 v215, v175
  buffer_store_dwordx4 v[208:211], v156, s[40:43], s74 offen sc1
  s_mov_b64 exec, s[48:49]
  buffer_store_dwordx4 v[212:215], v157, s[40:43], s74 offen offset:1024 sc1
  s_mov_b64 exec, -1
  buffer_load_dwordx4 v[224:227], v156, s[40:43], s75 offen sc1
  buffer_load_dwordx4 v[228:231], v157, s[40:43], s75 offen offset:1024 sc1
  buffer_load_dwordx4 v[232:235], v156, s[40:43], s76 offen sc1
  buffer_load_dwordx4 v[236:239], v157, s[40:43], s76 offen offset:1024 sc1
  buffer_load_dwordx4 v[240:243], v156, s[40:43], s77 offen sc1
  buffer_load_dwordx4 v[244:247], v157, s[40:43], s77 offen offset:1024 sc1
  s_waitcnt lgkmcnt(0)
  v_min_f32 v144, v188, v190
  v_sub_f32 v188, v144, v188
  v_sub_f32 v190, v144, v190
  v_exp_f32 v188, v188
  v_exp_f32 v190, v190
  v_mul_f32 v145, v188, v189
  v_pk_mul_f32 v[216:217], v[216:217], v[188:189] op_sel_hi:[1,0]
  v_pk_mul_f32 v[218:219], v[218:219], v[188:189] op_sel_hi:[1,0]
  v_pk_fma_f32 v[216:217], v[220:221], v[190:191], v[216:217] op_sel_hi:[1,0,1]
  v_pk_fma_f32 v[218:219], v[222:223], v[190:191], v[218:219] op_sel_hi:[1,0,1]
  v_fma_f32 v221, v190, v191, v145
  v_mov_b32 v220, v144
  s_branch L_check
L_gather:
  s_add_u32 s64, s64, 1
  s_cmp_gt_u32 s64, 200000
  s_cbranch_scc1 L_end
  s_bitcmp0_b32 s87, 0
  s_cbranch_scc1 L_have0
  buffer_load_dwordx4 v[224:227], v156, s[40:43], s75 offen sc1
  buffer_load_dwordx4 v[228:231], v157, s[40:43], s75 offen offset:1024 sc1
L_have0:
  s_bitcmp0_b32 s87, 1
  s_cbranch_scc1 L_have1
  buffer_load_dwordx4 v[232:235], v156, s[40:43], s76 offen sc1
  buffer_load_dwordx4 v[236:239], v157, s[40:43], s76 offen offset:1024 sc1
L_have1:
  s_bitcmp0_b32 s87, 2
  s_cbranch_scc1 L_have2
  buffer_load_dwordx4 v[240:243], v156, s[40:43], s77 offen sc1
  buffer_load_dwordx4 v[244:247], v157, s[40:43], s77 offen offset:1024 sc1
L_have2:
L_check:
  s_mov_b32 s87, 0
  s_waitcnt vmcnt(0)
  v_perm_b32 v144, v225, v224, s50
  v_perm_b32 v145, v227, v226, s50
  v_cmp_ne_u32 vcc, v175, v231
  v_perm_b32 v144, v145, v144, s51
  v_cmp_ne_u32 s[70:71], v175, v144
  s_nop 1
  s_or_b64 s[70:71], s[70:71], vcc
  s_cselect_b32 s70, 1, 0
  s_or_b32 s87, s87, s70
  v_perm_b32 v144, v233, v232, s50
  v_perm_b32 v145, v235, v234, s50
  v_cmp_ne_u32 vcc, v175, v239
  v_perm_b32 v144, v145, v144, s51
  v_cmp_ne_u32 s[70:71], v175, v144
  s_nop 1
  s_or_b64 s[70:71], s[70:71], vcc
  s_cselect_b32 s70, 2, 0
  s_or_b32 s87, s87, s70
  v_perm_b32 v144, v241, v240, s50
  v_perm_b32 v145, v243, v242, s50
  v_cmp_ne_u32 vcc, v175, v247
  v_perm_b32 v144, v145, v144, s51
  v_cmp_ne_u32 s[70:71], v175, v144
  s_nop 1
  s_or_b64 s[70:71], s[70:71], vcc
  s_cselect_b32 s70, 4, 0
  s_or_b32 s87, s87, s70
  s_cbranch_scc1 L_gather
  v_min_f32 v144, v220, v228
  v_min3_f32 v144, v144, v236, v244
  v_sub_f32 v220, v144, v220
  v_sub_f32 v228, v144, v228
  v_sub_f32 v236, v144, v236
  v_sub_f32 v244, v144, v244
  v_exp_f32 v220, v220
  v_exp_f32 v228, v228
  v_exp_f32 v236, v236
  v_exp_f32 v244, v244
  v_and_b32 v216, s65, v216
  v_and_b32 v217, s65, v217
  v_and_b32 v218, s65, v218
  v_and_b32 v219, s65, v219
  v_and_b32 v224, s65, v224
  v_and_b32 v225, s65, v225
  v_and_b32 v226, s65, v226
  v_and_b32 v227, s65, v227
  v_and_b32 v232, s65, v232
  v_and_b32 v233, s65, v233
  v_and_b32 v234, s65, v234
  v_and_b32 v235, s65, v235
  v_and_b32 v240, s65, v240
  v_and_b32 v241, s65, v241
  v_and_b32 v242, s65, v242
  v_and_b32 v243, s65, v243
  v_mul_f32 v221, v220, v221
  v_mul_f32 v229, v228, v229
  v_mul_f32 v237, v236, v237
  v_mul_f32 v245, v244, v245
  v_add_f32 v221, v221, v229
  v_add_f32 v237, v237, v245
  v_add_f32 v144, v221, v237
  v_rcp_f32 v144, v144
  s_lshl_b32 s70, s3, 7
  s_add_u32 s70, s70, s78
  v_pk_mul_f32 v[216:217], v[216:217], v[220:221] op_sel_hi:[1,0]
  v_pk_mul_f32 v[224:225], v[224:225], v[228:229] op_sel_hi:[1,0]
  v_pk_mul_f32 v[232:233], v[232:233], v[236:237] op_sel_hi:[1,0]
  v_pk_mul_f32 v[240:241], v[240:241], v[244:245] op_sel_hi:[1,0]
  v_pk_add_f32 v[216:217], v[216:217], v[224:225]
  v_pk_add_f32 v[232:233], v[232:233], v[240:241]
  v_pk_add_f32 v[216:217], v[216:217], v[232:233]
  v_pk_mul_f32 v[216:217], v[216:217], v[144:145] op_sel_hi:[1,0]
  v_cvt_pk_bf16_f32 v128, v216, v217
  v_pk_mul_f32 v[218:219], v[218:219], v[220:221] op_sel_hi:[1,0]
  v_pk_mul_f32 v[226:227], v[226:227], v[228:229] op_sel_hi:[1,0]
  v_pk_mul_f32 v[234:235], v[234:235], v[236:237] op_sel_hi:[1,0]
  v_pk_mul_f32 v[242:243], v[242:243], v[244:245] op_sel_hi:[1,0]
  v_pk_add_f32 v[218:219], v[218:219], v[226:227]
  v_pk_add_f32 v[234:235], v[234:235], v[242:243]
  v_pk_add_f32 v[218:219], v[218:219], v[234:235]
  v_pk_mul_f32 v[218:219], v[218:219], v[144:145] op_sel_hi:[1,0]
  v_cvt_pk_bf16_f32 v129, v218, v219
  buffer_store_dwordx2 v[128:129], v146, s[36:39], s70 offen
L_fin:
L_end:
  s_endpgm
L_helper:
  v_lshlrev_b32 v1, 2, v0
  v_add_u32 v1, 61696, v1
  v_mov_b32 v2, 0
  s_mov_b64 exec, 0xff
  ds_write_b32 v1, v2
  s_mov_b64 exec, -1
  s_waitcnt lgkmcnt(0)
  s_mov_b32 s8, s46
  s_and_b32 s9, s47, 0xffff
  s_mov_b32 s36, s44
  s_and_b32 s37, s45, 0xffff
  s_mov_b32 s16, s46
  s_and_b32 s17, s47, 0xffff
  s_mov_b32 s12, s48
  s_and_b32 s13, s49, 0xffff
  s_mov_b32 s40, s82
  s_and_b32 s41, s83, 0xffff
  s_mov_b32 s36, s58
  s_and_b32 s37, s59, 0xffff
  s_barrier
  s_memrealtime s[72:73]
  s_load_dword s59, s[80:81], 192
  s_getpc_b64 s[54:55]
L_h_pc:
  s_add_u32 s86, s54, L_h_cp - L_h_pc
  s_addc_u32 s87, s55, 0
  s_sub_u32 s54, s54, L_h_pc - L_k
  s_subb_u32 s55, s55, 0
  s_and_b32 s54, s54, -16
  s_lshr_b32 s70, s2, 3
  s_lshl_b32 s70, s70, 10
  v_lshl_add_u32 v106, v0, 4, s70
  v_mov_b32 v107, s55
  v_add_co_u32 v106, vcc, s54, v106
  s_nop 1
  v_addc_co_u32 v107, vcc, 0, v107, vcc
  s_lshr_b32 s70, s2, 3
  s_cmp_lt_u32 s70, (L_code_end - L_k) / 1024
  s_cbranch_scc0 L_h_cta
  global_load_dwordx4 v[108:111], v[106:107], off
L_h_cta:
  s_lshl_b32 s70, s2, 6
  v_lshl_add_u32 v104, v0, 3, s70
  v_bfe_u32 v105, v0, 1, 3
  v_lshlrev_b32 v105, 6, v105
  v_and_b32 v112, 1, v0
  v_lshl_add_u32 v105, v112, 3, v105
  v_lshlrev_b32 v112, 2, v112
  v_add_u32 v112, 61712, v112
  v_mov_b32 v113, 0
  v_lshlrev_b32 v3, 4, v0
  s_mov_b32 s76, 10
  s_mov_b32 s77, 7340032
  s_getreg_b32 s50, hwreg(HW_REG_XCC_ID)
  s_bfe_u32 s50, s50, 0x10002
  s_bfe_u32 s52, s2, 0x30003
  s_cmp_eq_u32 s52, 7
  s_cbranch_scc1 L_h_voted
  s_lshr_b32 s70, s2, 6
  s_xor_b32 s70, s70, s2
  s_and_b32 s70, s70, 3
  s_cbranch_scc1 L_h_voted
  s_cmp_eq_u32 s52, 6
  s_cbranch_scc0 L_h_probe
  s_xor_b32 s48, s50, s4
  s_and_b32 s52, s2, 3
  s_lshl2_add_u32 s52, s52, 36
  s_branch L_h_vote
L_h_probe:
  s_cmp_ge_u32 s52, 3
  s_cselect_b32 s16, s12, s8
  s_cselect_b32 s17, s13, s9
  s_cselect_b32 s70, 3, 0
  s_sub_u32 s70, s52, s70
  s_lshl_b32 s70, s70, 28
  s_add_u32 s44, s5, s4
  s_lshl_b32 s44, s44, 16
  s_add_u32 s44, s44, s70
  s_add_u32 s44, s44, 0x1c0000
  s_mul_i32 s70, s2, 0x2a95
  s_and_b32 s70, s70, 0x7f80
  s_add_u32 s44, s44, s70
  s_add_u32 s70, s44, 0x8000
  s_buffer_load_dword s58, s[16:19], s70
  s_mov_b32 s45, -1
  s_mov_b32 s46, -1
  s_mul_i32 s52, s52, 6
L_h_progp:
  s_sleep 2
  ds_read_b32 v8, v112
  s_waitcnt lgkmcnt(0)
  v_cmp_gt_u32 vcc, 1, v8
  s_nop 1
  s_cmp_lg_u32 vcc_lo, 0
  s_cbranch_scc1 L_h_progp
  s_xor_b32 s70, s44, 0
  s_memtime s[54:55]
  s_waitcnt lgkmcnt(0)
  s_buffer_load_dword s58, s[16:19], s70
  s_waitcnt lgkmcnt(0)
  s_memtime s[56:57]
  s_waitcnt lgkmcnt(0)
  s_sub_u32 s56, s56, s54
  s_min_u32 s45, s45, s56
  s_xor_b32 s70, s44, 8192
  s_memtime s[54:55]
  s_waitcnt lgkmcnt(0)
  s_buffer_load_dword s58, s[16:19], s70
  s_waitcnt lgkmcnt(0)
  s_memtime s[56:57]
  s_waitcnt lgkmcnt(0)
  s_sub_u32 s56, s56, s54
  s_min_u32 s46, s46, s56
  s_xor_b32 s70, s44, 25472
  s_memtime s[54:55]
  s_waitcnt lgkmcnt(0)
  s_buffer_load_dword s58, s[16:19], s70
  s_waitcnt lgkmcnt(0)
  s_memtime s[56:57]
  s_waitcnt lgkmcnt(0)
  s_sub_u32 s56, s56, s54
  s_min_u32 s46, s46, s56
  s_xor_b32 s70, s44, 17280
  s_memtime s[54:55]
  s_waitcnt lgkmcnt(0)
  s_buffer_load_dword s58, s[16:19], s70
  s_waitcnt lgkmcnt(0)
  s_memtime s[56:57]
  s_waitcnt lgkmcnt(0)
  s_sub_u32 s56, s56, s54
  s_min_u32 s45, s45, s56
  s_xor_b32 s70, s44, 5888
  s_memtime s[54:55]
  s_waitcnt lgkmcnt(0)
  s_buffer_load_dword s58, s[16:19], s70
  s_waitcnt lgkmcnt(0)
  s_memtime s[56:57]
  s_waitcnt lgkmcnt(0)
  s_sub_u32 s56, s56, s54
  s_min_u32 s45, s45, s56
  s_xor_b32 s70, s44, 14080
  s_memtime s[54:55]
  s_waitcnt lgkmcnt(0)
  s_buffer_load_dword s58, s[16:19], s70
  s_waitcnt lgkmcnt(0)
  s_memtime s[56:57]
  s_waitcnt lgkmcnt(0)
  s_sub_u32 s56, s56, s54
  s_min_u32 s46, s46, s56
  s_cmp_lt_u32 s46, s45
  s_cselect_b32 s48, 1, 0
  s_lshr_b32 s70, s44, 13
  s_xor_b32 s70, s70, s2
  s_xor_b32 s70, s70, s50
  s_and_b32 s70, s70, 1
  s_xor_b32 s48, s48, s70
L_h_vote:
  s_mov_b32 s49, 0
  s_lshl_b64 s[48:49], s[48:49], s52
  s_or_b32 s49, s49, 0x100000
  s_atomic_add_x2 s[48:49], s[80:81], 0
L_h_voted:
  s_waitcnt lgkmcnt(0)
  s_cmp_lg_u32 s2, 56
  s_cbranch_scc1 L_h_nonce
  s_lshl_b64 s[54:55], s[72:73], 2
  s_atomic_add_x2 s[54:55], s[80:81], 8
  s_waitcnt lgkmcnt(0)
L_h_nonce:
L_h_progv:
  s_sleep 4
  ds_read_b32 v8, v112
  s_waitcnt lgkmcnt(0)
  v_cmp_gt_u32 vcc, 6, v8
  s_nop 1
  s_cmp_lg_u32 vcc_lo, 0
  s_cbranch_scc1 L_h_progv
  s_load_dwordx2 s[48:49], s[80:81], 0
  s_mov_b32 s59, 0
L_h_votes:
  s_waitcnt lgkmcnt(0)
  s_lshr_b32 s70, s49, 20
  s_cmp_ge_u32 s70, 56
  s_cbranch_scc1 L_h_votes_done
  s_add_u32 s59, s59, 1
  s_cmp_gt_u32 s59, 8000
  s_cbranch_scc1 L_h_votes_done
  s_sleep 64
  s_mov_b64 s[48:49], 0
  s_atomic_or_x2 s[48:49], s[80:81], 0 glc
  s_branch L_h_votes
L_h_votes_done:
  s_mov_b32 s96, 0x80
  s_bfe_u64 s[54:55], s[48:49], 0x60000
  s_cmp_gt_u32 s54, 4
  s_cselect_b32 s56, 1, 0
  s_or_b32 s96, s96, s56
  s_bfe_u64 s[54:55], s[48:49], 0x60006
  s_cmp_gt_u32 s54, 4
  s_cselect_b32 s56, 2, 0
  s_or_b32 s96, s96, s56
  s_bfe_u64 s[54:55], s[48:49], 0x6000c
  s_cmp_gt_u32 s54, 4
  s_cselect_b32 s56, 4, 0
  s_or_b32 s96, s96, s56
  s_bfe_u64 s[54:55], s[48:49], 0x60012
  s_cmp_gt_u32 s54, 4
  s_cselect_b32 s56, 8, 0
  s_or_b32 s96, s96, s56
  s_bfe_u64 s[54:55], s[48:49], 0x60018
  s_cmp_gt_u32 s54, 4
  s_cselect_b32 s56, 16, 0
  s_or_b32 s96, s96, s56
  s_bfe_u64 s[54:55], s[48:49], 0x6001e
  s_cmp_gt_u32 s54, 4
  s_cselect_b32 s56, 32, 0
  s_or_b32 s96, s96, s56
  s_and_b32 s70, s2, 3
  s_lshl2_add_u32 s70, s70, 5
  s_lshr_b32 s54, s49, s70
  s_xor_b32 s54, s54, s2
  s_xor_b32 s54, s54, s4
  s_and_b32 s54, s54, 1
  s_mul_i32 s54, s54, 63
  s_xor_b32 s96, s96, s54
  v_mov_b32 v1, 61696
  v_mov_b32 v5, s96
  ds_write_b32 v1, v5
  s_load_dwordx2 s[74:75], s[80:81], 8
  s_mov_b32 s59, 0
L_h_getnonce:
  s_waitcnt lgkmcnt(0)
  s_cmp_lg_u64 s[74:75], 0
  s_cbranch_scc1 L_h_gotnonce
  s_add_u32 s59, s59, 1
  s_cmp_gt_u32 s59, 8000
  s_cbranch_scc1 L_h_gotnonce
  s_sleep 64
  s_atomic_or_x2 s[74:75], s[80:81], 8 glc
  s_branch L_h_getnonce
L_h_gotnonce:
  s_lshr_b64 s[54:55], s[74:75], 4
  s_mul_i32 s54, s54, 0x9e3779b1
  v_writelane_b32 v8, s54, 7
  s_lshr_b32 s64, s5, 5
  s_mov_b32 s50, 0xaaaaaaab
  s_add_u32 s54, s64, 0
  s_mul_hi_u32 s56, s54, s50
  s_lshr_b32 s56, s56, 1
  s_mul_i32 s56, s56, 3
  s_sub_u32 s54, s54, s56
  s_lshr_b32 s56, s96, s54
  s_bfe_u32 s56, s56, 0x10003
  s_lshl_b32 s54, s54, 7
  s_add_u32 s54, s54, s64
  s_mul_hi_u32 s54, s54, s50
  s_lshr_b32 s54, s54, 1
  s_lshl3_add_u32 s54, s54, s56
  s_mul_i32 s70, s54, 3456
  s_add_u32 s70, s70, 1048576
  v_writelane_b32 v8, s70, 0
  s_add_u32 s54, s64, 4
  s_mul_hi_u32 s56, s54, s50
  s_lshr_b32 s56, s56, 1
  s_mul_i32 s56, s56, 3
  s_sub_u32 s54, s54, s56
  s_lshr_b32 s56, s96, s54
  s_bfe_u32 s56, s56, 0x10003
  s_lshl_b32 s54, s54, 7
  s_add_u32 s54, s54, s64
  s_mul_hi_u32 s54, s54, s50
  s_lshr_b32 s54, s54, 1
  s_lshl3_add_u32 s54, s54, s56
  s_add_u32 s54, s54, 6
  s_mul_i32 s70, s54, 3456
  s_add_u32 s70, s70, 1048576
  v_writelane_b32 v8, s70, 1
  s_add_u32 s54, s64, 2
  s_mul_hi_u32 s56, s54, s50
  s_lshr_b32 s56, s56, 1
  s_mul_i32 s56, s56, 3
  s_sub_u32 s54, s54, s56
  s_lshr_b32 s56, s96, s54
  s_bfe_u32 s56, s56, 0x10003
  s_lshl_b32 s54, s54, 7
  s_add_u32 s54, s54, s64
  s_mul_hi_u32 s54, s54, s50
  s_lshr_b32 s54, s54, 1
  s_lshl3_add_u32 s54, s54, s56
  s_lshl_b32 s56, s4, 1
  s_sub_u32 s57, s54, s56
  s_add_u32 s57, s57, 4
  s_mul_i32 s70, s57, 3456
  s_add_u32 s70, s70, 1048576
  v_writelane_b32 v8, s70, 2
  s_add_u32 s54, s54, s56
  s_add_u32 s54, s54, 2
  s_xor_b32 s56, s54, 1
  s_mul_i32 s70, s56, 3456
  s_add_u32 s70, s70, 1048576
  v_writelane_b32 v8, s70, 3
  s_andn2_b32 s56, s54, 1
  s_xor_b32 s56, s56, 2
  s_mul_i32 s70, s56, 3456
  s_add_u32 s70, s70, 1048576
  v_writelane_b32 v8, s70, 4
  s_add_u32 s56, s56, 1
  s_mul_i32 s70, s56, 3456
  s_add_u32 s70, s70, 1048576
  v_writelane_b32 v8, s70, 5
  s_lshr_b32 s54, s54, 2
  s_mul_i32 s54, s54, 1536
  v_writelane_b32 v8, s54, 6
  v_lshlrev_b32 v1, 2, v0
  s_mov_b64 exec, 0xff
  ds_write_b32 v1, v8 offset:61728
  s_mov_b64 exec, -1
  s_lshl_b32 s62, s2, 8
  s_add_u32 s62, s62, 6291456
  s_xor_b32 s63, s62, 1024
  s_lshr_b32 s58, s96, 3
  s_xor_b32 s58, s58, s96
  s_mov_b32 s44, 16777216
  s_bitcmp1_b32 s5, 5
  s_cselect_b32 s70, 2048, 0
  s_xor_b32 s44, s44, s70
  s_bitcmp1_b32 s5, 6
  s_cselect_b32 s70, 4096, 0
  s_xor_b32 s44, s44, s70
  s_bitcmp1_b32 s5, 7
  s_cselect_b32 s70, 8192, 0
  s_xor_b32 s44, s44, s70
  s_bitcmp1_b32 s5, 8
  s_cselect_b32 s70, 16384, 0
  s_xor_b32 s44, s44, s70
  s_bitcmp1_b32 s5, 9
  s_cselect_b32 s70, 2097152, 0
  s_xor_b32 s44, s44, s70
  s_bitcmp1_b32 s5, 10
  s_cselect_b32 s70, 4194304, 0
  s_xor_b32 s44, s44, s70
  s_bitcmp1_b32 s5, 11
  s_cselect_b32 s70, 8388608, 0
  s_xor_b32 s44, s44, s70
  s_mul_i32 s70, s4, 1024
  s_xor_b32 s60, s44, s70
  s_xor_b32 s61, s60, 1024
  s_mov_b32 s78, 62
  s_swappc_b64 s[84:85], s[86:87]
L_h_proga:
  s_sleep 4
  ds_read_b32 v8, v112
  s_waitcnt lgkmcnt(0)
  v_cmp_gt_u32 vcc, 64, v8
  s_nop 1
  s_cmp_lg_u32 vcc_lo, 0
  s_cbranch_scc1 L_h_proga
  ds_read_b128 v[8:11], v3 offset:0
  ds_read_b128 v[12:15], v3 offset:1024
  ds_read_b128 v[16:19], v3 offset:2048
  s_waitcnt lgkmcnt(0)
  s_xor_b32 s70, s60, 0
  buffer_store_dwordx4 v[8:11], v3, s[40:43], s70 offen sc1
  s_xor_b32 s70, s60, 32768
  buffer_store_dwordx4 v[12:15], v3, s[40:43], s70 offen sc1
  s_xor_b32 s70, s60, 67584
  buffer_store_dwordx4 v[16:19], v3, s[40:43], s70 offen sc1
  s_bitcmp0_b32 s58, 2
  s_cbranch_scc1 L_h_e0
  ds_read_b128 v[20:23], v3 offset:3072
  ds_read_b128 v[24:27], v3 offset:4096
  ds_read_b128 v[28:31], v3 offset:5120
  ds_read_b128 v[32:35], v3 offset:6144
  ds_read_b128 v[36:39], v3 offset:7168
  ds_read_b128 v[40:43], v3 offset:8192
  ds_read_b128 v[44:47], v3 offset:9216
  ds_read_b128 v[48:51], v3 offset:10240
  ds_read_b128 v[52:55], v3 offset:11264
  s_waitcnt lgkmcnt(0)
  s_xor_b32 s70, s60, 100352
  buffer_store_dwordx4 v[20:23], v3, s[40:43], s70 offen sc1
  s_xor_b32 s70, s60, 136192
  buffer_store_dwordx4 v[24:27], v3, s[40:43], s70 offen sc1
  s_xor_b32 s70, s60, 168960
  buffer_store_dwordx4 v[28:31], v3, s[40:43], s70 offen sc1
  s_xor_b32 s70, s60, 203776
  buffer_store_dwordx4 v[32:35], v3, s[40:43], s70 offen sc1
  s_xor_b32 s70, s60, 236544
  buffer_store_dwordx4 v[36:39], v3, s[40:43], s70 offen sc1
  s_xor_b32 s70, s60, 272384
  buffer_store_dwordx4 v[40:43], v3, s[40:43], s70 offen sc1
  s_xor_b32 s70, s60, 305152
  buffer_store_dwordx4 v[44:47], v3, s[40:43], s70 offen sc1
  s_xor_b32 s70, s60, 335872
  buffer_store_dwordx4 v[48:51], v3, s[40:43], s70 offen sc1
  s_xor_b32 s70, s60, 368640
  buffer_store_dwordx4 v[52:55], v3, s[40:43], s70 offen sc1
L_h_e0:
  s_bitcmp0_b32 s58, 0
  s_cbranch_scc1 L_h_e1
  ds_read_b128 v[56:59], v3 offset:12288
  ds_read_b128 v[60:63], v3 offset:13312
  ds_read_b128 v[64:67], v3 offset:14336
  ds_read_b128 v[68:71], v3 offset:15360
  ds_read_b128 v[72:75], v3 offset:16384
  ds_read_b128 v[76:79], v3 offset:17408
  ds_read_b128 v[80:83], v3 offset:18432
  ds_read_b128 v[84:87], v3 offset:19456
  ds_read_b128 v[88:91], v3 offset:20480
  ds_read_b128 v[92:95], v3 offset:21504
  ds_read_b128 v[96:99], v3 offset:22528
  ds_read_b128 v[100:103], v3 offset:23552
  s_waitcnt lgkmcnt(0)
  s_xor_b32 s70, s60, 408576
  buffer_store_dwordx4 v[56:59], v3, s[40:43], s70 offen sc1
  s_xor_b32 s70, s60, 441344
  buffer_store_dwordx4 v[60:63], v3, s[40:43], s70 offen sc1
  s_xor_b32 s70, s60, 472064
  buffer_store_dwordx4 v[64:67], v3, s[40:43], s70 offen sc1
  s_xor_b32 s70, s60, 504832
  buffer_store_dwordx4 v[68:71], v3, s[40:43], s70 offen sc1
  s_xor_b32 s70, s60, 525312
  buffer_store_dwordx4 v[72:75], v3, s[40:43], s70 offen sc1
  s_xor_b32 s70, s60, 558080
  buffer_store_dwordx4 v[76:79], v3, s[40:43], s70 offen sc1
  s_xor_b32 s70, s60, 592896
  buffer_store_dwordx4 v[80:83], v3, s[40:43], s70 offen sc1
  s_xor_b32 s70, s60, 625664
  buffer_store_dwordx4 v[84:87], v3, s[40:43], s70 offen sc1
  s_xor_b32 s70, s60, 659456
  buffer_store_dwordx4 v[88:91], v3, s[40:43], s70 offen sc1
  s_xor_b32 s70, s60, 692224
  buffer_store_dwordx4 v[92:95], v3, s[40:43], s70 offen sc1
  s_xor_b32 s70, s60, 727040
  buffer_store_dwordx4 v[96:99], v3, s[40:43], s70 offen sc1
  s_xor_b32 s70, s60, 759808
  buffer_store_dwordx4 v[100:103], v3, s[40:43], s70 offen sc1
L_h_e1:
  s_add_u32 s54, s74, 1
  v_lshlrev_b32 v5, 3, v0
  s_waitcnt vmcnt(0)
  v_mov_b32 v8, s54
  v_mov_b32 v9, s75
  s_mov_b64 exec, 0xffff
  buffer_store_dwordx2 v[8:9], v5, s[40:43], s62 offen sc1
  s_mov_b64 exec, 1
  s_mov_b32 s59, 0
L_h_flaga:
  buffer_load_dwordx2 v[10:11], v5, s[40:43], s63 offen sc1
  s_waitcnt vmcnt(0)
  v_readfirstlane_b32 s56, v10
  v_readfirstlane_b32 s57, v11
  s_nop 0
  s_sub_u32 s56, s56, s54
  s_xor_b32 s57, s57, s75
  s_lshr_b32 s56, s56, 1
  s_or_b32 s56, s56, s57
  s_cbranch_scc0 L_h_flaga_done
  s_add_u32 s59, s59, 1
  s_cmp_gt_u32 s59, 100000
  s_cbranch_scc1 L_h_flaga_done
  s_sleep 8
  s_branch L_h_flaga
L_h_flaga_done:
  s_mov_b64 exec, -1
  s_bfe_u32 s54, s96, 0x10005
  s_mul_i32 s54, s54, 384
  v_lshrrev_b32 v4, 3, v0
  v_add_u32 v5, 0, v4
  v_mul_u32_u24 v5, 21846, v5
  v_bfe_u32 v5, v5, 16, 1
  v_mul_u32_u24 v6, 384, v5
  v_sub_u32 v6, v3, v6
  v_add_u32 v6, s54, v6
  v_add_u32 v6, 0, v6
  v_mul_u32_u24 v5, 1024, v5
  v_xor_b32 v5, s44, v5
  v_bfe_u32 v2, v6, 10, 1
  v_mul_u32_u24 v2, 32768, v2
  v_xor_b32 v5, v5, v2
  v_bfe_u32 v2, v6, 11, 1
  v_mul_u32_u24 v2, 67584, v2
  v_xor_b32 v5, v5, v2
  v_and_b32 v6, 1023, v6
  v_add_u32 v5, v5, v6
  buffer_load_dwordx4 v[8:11], v5, s[40:43], 0 offen sc1
  v_add_u32 v5, 8, v4
  v_mul_u32_u24 v5, 21846, v5
  v_bfe_u32 v5, v5, 16, 1
  v_mul_u32_u24 v6, 384, v5
  v_sub_u32 v6, v3, v6
  v_add_u32 v6, s54, v6
  v_add_u32 v6, 1024, v6
  v_mul_u32_u24 v5, 1024, v5
  v_xor_b32 v5, s44, v5
  v_bfe_u32 v2, v6, 10, 1
  v_mul_u32_u24 v2, 32768, v2
  v_xor_b32 v5, v5, v2
  v_bfe_u32 v2, v6, 11, 1
  v_mul_u32_u24 v2, 67584, v2
  v_xor_b32 v5, v5, v2
  v_and_b32 v6, 1023, v6
  v_add_u32 v5, v5, v6
  buffer_load_dwordx4 v[12:15], v5, s[40:43], 0 offen sc1
  v_add_u32 v5, 16, v4
  v_mul_u32_u24 v5, 21846, v5
  v_bfe_u32 v5, v5, 16, 1
  v_mul_u32_u24 v6, 384, v5
  v_sub_u32 v6, v3, v6
  v_add_u32 v6, s54, v6
  v_add_u32 v6, 2048, v6
  v_mul_u32_u24 v5, 1024, v5
  v_xor_b32 v5, s44, v5
  v_bfe_u32 v2, v6, 10, 1
  v_mul_u32_u24 v2, 32768, v2
  v_xor_b32 v5, v5, v2
  v_bfe_u32 v2, v6, 11, 1
  v_mul_u32_u24 v2, 67584, v2
  v_xor_b32 v5, v5, v2
  v_and_b32 v6, 1023, v6
  v_add_u32 v5, v5, v6
  buffer_load_dwordx4 v[16:19], v5, s[40:43], 0 offen sc1
  s_bitcmp0_b32 s58, 2
  s_cbranch_scc1 L_h_i0
  s_xor_b32 s70, s61, 100352
  buffer_load_dwordx4 v[20:23], v3, s[40:43], s70 offen sc1
  s_xor_b32 s70, s61, 136192
  buffer_load_dwordx4 v[24:27], v3, s[40:43], s70 offen sc1
  s_xor_b32 s70, s61, 168960
  buffer_load_dwordx4 v[28:31], v3, s[40:43], s70 offen sc1
  s_xor_b32 s70, s61, 203776
  buffer_load_dwordx4 v[32:35], v3, s[40:43], s70 offen sc1
  s_xor_b32 s70, s61, 236544
  buffer_load_dwordx4 v[36:39], v3, s[40:43], s70 offen sc1
  s_xor_b32 s70, s61, 272384
  buffer_load_dwordx4 v[40:43], v3, s[40:43], s70 offen sc1
  s_xor_b32 s70, s61, 305152
  buffer_load_dwordx4 v[44:47], v3, s[40:43], s70 offen sc1
  s_xor_b32 s70, s61, 335872
  buffer_load_dwordx4 v[48:51], v3, s[40:43], s70 offen sc1
  s_xor_b32 s70, s61, 368640
  buffer_load_dwordx4 v[52:55], v3, s[40:43], s70 offen sc1
  s_waitcnt vmcnt(0)
  ds_write_b128 v3, v[20:23] offset:3072
  ds_write_b128 v3, v[24:27] offset:4096
  ds_write_b128 v3, v[28:31] offset:5120
  ds_write_b128 v3, v[32:35] offset:6144
  ds_write_b128 v3, v[36:39] offset:7168
  ds_write_b128 v3, v[40:43] offset:8192
  ds_write_b128 v3, v[44:47] offset:9216
  ds_write_b128 v3, v[48:51] offset:10240
  ds_write_b128 v3, v[52:55] offset:11264
L_h_i0:
  s_bitcmp0_b32 s58, 0
  s_cbranch_scc1 L_h_i1
  s_xor_b32 s70, s61, 408576
  buffer_load_dwordx4 v[56:59], v3, s[40:43], s70 offen sc1
  s_xor_b32 s70, s61, 441344
  buffer_load_dwordx4 v[60:63], v3, s[40:43], s70 offen sc1
  s_xor_b32 s70, s61, 472064
  buffer_load_dwordx4 v[64:67], v3, s[40:43], s70 offen sc1
  s_xor_b32 s70, s61, 504832
  buffer_load_dwordx4 v[68:71], v3, s[40:43], s70 offen sc1
  s_xor_b32 s70, s61, 525312
  buffer_load_dwordx4 v[72:75], v3, s[40:43], s70 offen sc1
  s_xor_b32 s70, s61, 558080
  buffer_load_dwordx4 v[76:79], v3, s[40:43], s70 offen sc1
  s_xor_b32 s70, s61, 592896
  buffer_load_dwordx4 v[80:83], v3, s[40:43], s70 offen sc1
  s_xor_b32 s70, s61, 625664
  buffer_load_dwordx4 v[84:87], v3, s[40:43], s70 offen sc1
  s_xor_b32 s70, s61, 659456
  buffer_load_dwordx4 v[88:91], v3, s[40:43], s70 offen sc1
  s_xor_b32 s70, s61, 692224
  buffer_load_dwordx4 v[92:95], v3, s[40:43], s70 offen sc1
  s_xor_b32 s70, s61, 727040
  buffer_load_dwordx4 v[96:99], v3, s[40:43], s70 offen sc1
  s_xor_b32 s70, s61, 759808
  buffer_load_dwordx4 v[100:103], v3, s[40:43], s70 offen sc1
  s_waitcnt vmcnt(0)
  ds_write_b128 v3, v[56:59] offset:12288
  ds_write_b128 v3, v[60:63] offset:13312
  ds_write_b128 v3, v[64:67] offset:14336
  ds_write_b128 v3, v[68:71] offset:15360
  ds_write_b128 v3, v[72:75] offset:16384
  ds_write_b128 v3, v[76:79] offset:17408
  ds_write_b128 v3, v[80:83] offset:18432
  ds_write_b128 v3, v[84:87] offset:19456
  ds_write_b128 v3, v[88:91] offset:20480
  ds_write_b128 v3, v[92:95] offset:21504
  ds_write_b128 v3, v[96:99] offset:22528
  ds_write_b128 v3, v[100:103] offset:23552
L_h_i1:
  s_waitcnt vmcnt(0)
  ds_write_b128 v3, v[8:11] offset:0
  ds_write_b128 v3, v[12:15] offset:1024
  ds_write_b128 v3, v[16:19] offset:2048
  s_bitcmp0_b32 s58, 1
  s_cselect_b32 s70, 255, 32
  v_mov_b32 v1, 61700
  v_mov_b32 v5, s70
  ds_write_b32 v1, v5
  s_mov_b32 s78, 94
  s_swappc_b64 s[84:85], s[86:87]
  s_bitcmp0_b32 s58, 1
  s_cbranch_scc1 L_h_all
L_h_progb:
  s_sleep 4
  ds_read_b32 v8, v112
  s_waitcnt lgkmcnt(0)
  v_cmp_gt_u32 vcc, 96, v8
  s_nop 1
  s_cmp_lg_u32 vcc_lo, 0
  s_cbranch_scc1 L_h_progb
  ds_read_b128 v[8:11], v3 offset:24576
  ds_read_b128 v[12:15], v3 offset:25600
  ds_read_b128 v[16:19], v3 offset:26624
  ds_read_b128 v[20:23], v3 offset:27648
  ds_read_b128 v[24:27], v3 offset:28672
  ds_read_b128 v[28:31], v3 offset:29696
  ds_read_b128 v[32:35], v3 offset:30720
  ds_read_b128 v[36:39], v3 offset:31744
  ds_read_b128 v[40:43], v3 offset:32768
  ds_read_b128 v[44:47], v3 offset:33792
  ds_read_b128 v[48:51], v3 offset:34816
  ds_read_b128 v[52:55], v3 offset:35840
  s_waitcnt lgkmcnt(0)
  s_xor_b32 s70, s60, 797696
  buffer_store_dwordx4 v[8:11], v3, s[40:43], s70 offen sc1
  s_xor_b32 s70, s60, 830464
  buffer_store_dwordx4 v[12:15], v3, s[40:43], s70 offen sc1
  s_xor_b32 s70, s60, 861184
  buffer_store_dwordx4 v[16:19], v3, s[40:43], s70 offen sc1
  s_xor_b32 s70, s60, 893952
  buffer_store_dwordx4 v[20:23], v3, s[40:43], s70 offen sc1
  s_xor_b32 s70, s60, 931840
  buffer_store_dwordx4 v[24:27], v3, s[40:43], s70 offen sc1
  s_xor_b32 s70, s60, 964608
  buffer_store_dwordx4 v[28:31], v3, s[40:43], s70 offen sc1
  s_xor_b32 s70, s60, 995328
  buffer_store_dwordx4 v[32:35], v3, s[40:43], s70 offen sc1
  s_xor_b32 s70, s60, 1028096
  buffer_store_dwordx4 v[36:39], v3, s[40:43], s70 offen sc1
  s_xor_b32 s70, s60, 1052672
  buffer_store_dwordx4 v[40:43], v3, s[40:43], s70 offen sc1
  s_xor_b32 s70, s60, 1085440
  buffer_store_dwordx4 v[44:47], v3, s[40:43], s70 offen sc1
  s_xor_b32 s70, s60, 1120256
  buffer_store_dwordx4 v[48:51], v3, s[40:43], s70 offen sc1
  s_xor_b32 s70, s60, 1153024
  buffer_store_dwordx4 v[52:55], v3, s[40:43], s70 offen sc1
  s_add_u32 s54, s74, 2
  v_lshlrev_b32 v5, 3, v0
  s_waitcnt vmcnt(0)
  v_mov_b32 v8, s54
  v_mov_b32 v9, s75
  s_mov_b64 exec, 0xffff
  buffer_store_dwordx2 v[8:9], v5, s[40:43], s62 offen sc1
  s_mov_b64 exec, 1
  s_mov_b32 s59, 0
L_h_flagb:
  buffer_load_dwordx2 v[10:11], v5, s[40:43], s63 offen sc1
  s_waitcnt vmcnt(0)
  v_readfirstlane_b32 s56, v10
  v_readfirstlane_b32 s57, v11
  s_nop 0
  s_sub_u32 s56, s56, s54
  s_xor_b32 s57, s57, s75
  s_lshr_b32 s56, s56, 1
  s_or_b32 s56, s56, s57
  s_cbranch_scc0 L_h_flagb_done
  s_add_u32 s59, s59, 1
  s_cmp_gt_u32 s59, 100000
  s_cbranch_scc1 L_h_flagb_done
  s_sleep 8
  s_branch L_h_flagb
L_h_flagb_done:
  s_mov_b64 exec, -1
  s_xor_b32 s70, s61, 797696
  buffer_load_dwordx4 v[8:11], v3, s[40:43], s70 offen sc1
  s_xor_b32 s70, s61, 830464
  buffer_load_dwordx4 v[12:15], v3, s[40:43], s70 offen sc1
  s_xor_b32 s70, s61, 861184
  buffer_load_dwordx4 v[16:19], v3, s[40:43], s70 offen sc1
  s_xor_b32 s70, s61, 893952
  buffer_load_dwordx4 v[20:23], v3, s[40:43], s70 offen sc1
  s_xor_b32 s70, s61, 931840
  buffer_load_dwordx4 v[24:27], v3, s[40:43], s70 offen sc1
  s_xor_b32 s70, s61, 964608
  buffer_load_dwordx4 v[28:31], v3, s[40:43], s70 offen sc1
  s_xor_b32 s70, s61, 995328
  buffer_load_dwordx4 v[32:35], v3, s[40:43], s70 offen sc1
  s_xor_b32 s70, s61, 1028096
  buffer_load_dwordx4 v[36:39], v3, s[40:43], s70 offen sc1
  s_xor_b32 s70, s61, 1052672
  buffer_load_dwordx4 v[40:43], v3, s[40:43], s70 offen sc1
  s_xor_b32 s70, s61, 1085440
  buffer_load_dwordx4 v[44:47], v3, s[40:43], s70 offen sc1
  s_xor_b32 s70, s61, 1120256
  buffer_load_dwordx4 v[48:51], v3, s[40:43], s70 offen sc1
  s_xor_b32 s70, s61, 1153024
  buffer_load_dwordx4 v[52:55], v3, s[40:43], s70 offen sc1
  s_waitcnt vmcnt(0)
  ds_write_b128 v3, v[8:11] offset:24576
  ds_write_b128 v3, v[12:15] offset:25600
  ds_write_b128 v3, v[16:19] offset:26624
  ds_write_b128 v3, v[20:23] offset:27648
  ds_write_b128 v3, v[24:27] offset:28672
  ds_write_b128 v3, v[28:31] offset:29696
  ds_write_b128 v3, v[32:35] offset:30720
  ds_write_b128 v3, v[36:39] offset:31744
  ds_write_b128 v3, v[40:43] offset:32768
  ds_write_b128 v3, v[44:47] offset:33792
  ds_write_b128 v3, v[48:51] offset:34816
  ds_write_b128 v3, v[52:55] offset:35840
  v_mov_b32 v1, 61700
  v_mov_b32 v5, 255
  ds_write_b32 v1, v5
L_h_all:
  s_mov_b32 s78, 186
  s_swappc_b64 s[84:85], s[86:87]
  s_branch L_finish
L_h_cp:
  s_cmp_gt_u32 s76, s78
  s_cbranch_scc0 L_h_cpgo
  s_setpc_b64 s[84:85]
L_h_cpgo:
  ds_read_b32 v8, v112
  s_waitcnt lgkmcnt(0)
  v_cmp_gt_u32 vcc, s76, v8
  s_nop 1
  s_cmp_eq_u32 vcc_lo, 0
  s_cbranch_scc1 L_h_cpnext
L_h_first:
  s_sleep 2
  ds_read_b32 v8, v112
  s_waitcnt lgkmcnt(0)
  v_cmp_gt_u32 s[48:49], s76, v8
  s_nop 1
  s_cmp_eq_u32 s48, -1
  s_cbranch_scc1 L_h_first
  s_memrealtime s[54:55]
L_h_progm:
  s_sleep 2
  ds_read_b32 v8, v112
  s_waitcnt lgkmcnt(0)
  v_cmp_gt_u32 vcc, s76, v8
  s_nop 1
  s_cmp_lg_u32 vcc_lo, 0
  s_cbranch_scc1 L_h_progm
  s_memrealtime s[56:57]
  v_mov_b32 v114, s54
  v_mov_b32 v115, s55
  s_mov_b64 exec, s[48:49]
  s_waitcnt lgkmcnt(0)
  v_mov_b32 v114, s56
  v_mov_b32 v115, s57
  s_mov_b64 exec, -1
  s_cmp_ge_u32 s2, 8
  s_cbranch_scc1 L_h_np
  s_mov_b64 exec, 0xff
  buffer_store_dwordx2 v[114:115], v104, s[40:43], s77 offen sc1
  s_mov_b64 exec, -1
L_h_np:
  s_add_u32 s50, s76, 2
L_h_progc:
  s_sleep 4
  ds_read_b32 v8, v112
  s_waitcnt lgkmcnt(0)
  v_cmp_gt_u32 vcc, s50, v8
  s_nop 1
  s_cmp_lg_u32 vcc_lo, 0
  s_cbranch_scc1 L_h_progc
  buffer_load_dwordx2 v[8:9], v105, s[40:43], s77 offen
  v_mov_b32 v10, s73
  s_waitcnt vmcnt(0)
  ds_read_b32 v12, v112
  v_subrev_co_u32 v8, vcc, s72, v8
  s_nop 1
  v_subb_co_u32 v9, vcc, v9, v10, vcc
  v_lshrrev_b32 v10, 24, v8
  v_or_b32 v9, v9, v10
  v_cmp_eq_u32 vcc, 0, v9
  s_nop 1
  v_cndmask_b32 v8, 0, v8, vcc
  s_and_b32 s56, vcc_lo, 0xffff
  s_bcnt1_i32_b32 s56, s56
  v_add_u32_dpp v8, v8, v8 row_ror:8 row_mask:0xf bank_mask:0xf
  s_nop 1
  v_add_u32_dpp v8, v8, v8 row_ror:4 row_mask:0xf bank_mask:0xf
  s_nop 1
  v_add_u32_dpp v8, v8, v8 row_ror:2 row_mask:0xf bank_mask:0xf
  s_nop 1
  v_add_u32_dpp v8, v8, v8 row_ror:1 row_mask:0xf bank_mask:0xf
  v_subrev_u32 v9, s72, v114
  v_mul_lo_u32 v9, v9, s56
  s_max_u32 s56, s56, 1
  v_sub_u32 v8, v9, v8
  v_cvt_f32_u32 v9, s56
  v_cvt_f32_i32 v8, v8
  v_rcp_f32 v9, v9
  s_nop 0
  v_mul_f32 v8, v8, v9
  v_cvt_i32_f32 v8, v8
  s_waitcnt lgkmcnt(0)
  v_add_u32 v12, 2, v12
  v_min_u32 v9, v113, v12
  v_subrev_u32 v9, s76, v9
  v_max_i32 v9, 0, v9
  v_lshrrev_b32 v9, 1, v9
  v_mul_u32_u24 v9, 32, v9
  v_sub_u32 v8, v8, v9
  v_add_u32 v9, 46, v8
  v_max_i32 v9, 0, v9
  v_min_i32 v9, 2000, v9
  v_mul_u32_u24 v9, 2048, v9
  v_lshrrev_b32 v9, 16, v9
  v_cmp_ne_u32 vcc, 0, v9
  v_lshl_add_u32 v9, v9, 1, v12
  s_nop 0
  v_cndmask_b32 v113, 0, v9, vcc
  ds_write_b32 v112, v113 offset:8
L_h_cpnext:
  s_add_u32 s76, s76, 4
  s_add_u32 s77, s77, 512
  s_branch L_h_cp
L_code_end:
.section .rodata,"a"
.p2align 6
.amdhsa_kernel standalone__kv_cache_quant_int4_int2_kv_with_per_channel_or_per_token_scales__sampling_kernel
  .amdhsa_next_free_vgpr 256
  .amdhsa_next_free_sgpr 102
  .amdhsa_accum_offset 256
  .amdhsa_group_segment_fixed_size 0
  .amdhsa_kernarg_size 80
  .amdhsa_user_sgpr_count 2
  .amdhsa_user_sgpr_kernarg_segment_ptr 1
  .amdhsa_system_sgpr_workgroup_id_x 1
  .amdhsa_float_denorm_mode_32 3
.end_amdhsa_kernel
```
